```python
import torch

def _softmax(x, axis=-1):
    return torch.softmax(x, dim=axis)
def _gelu(x):
    return torch.nn.functional.gelu(x, approximate="tanh")
def _silu(x):
    return torch.nn.functional.silu(x)
def _sigmoid(x):
    return torch.sigmoid(x)
def _layernorm(x, axis=-1, eps=1e-5):
    m = x.mean(dim=axis, keepdim=True)
    v = x.var(dim=axis, keepdim=True, unbiased=False)
    return (x - m) / torch.sqrt(v + eps)
def _scatter_add(tgt, idx, src, axis=0):
    return tgt.clone().index_add_(axis, idx, src)
def _segment_sum(src, seg, n):
    out = torch.zeros((n,) + src.shape[1:], dtype=src.dtype)
    return out.index_add_(0, seg, src)
def _pad(x, pw):
    flat = tuple(v for pair in reversed(pw) for v in pair)
    return torch.nn.functional.pad(x, flat)

kernel_name = 'standalone__depthwise_separable__vision'

def setup_inputs():

    _w = (lambda a: (lambda t: t.to(torch.bfloat16) if t.is_floating_point() else t)(torch.as_tensor(a)))
    H = W = 384
    C = 384
    k = 1
    return {
        "x": _w((lambda *s: torch.randn(*s, dtype=torch.bfloat16) * 0.05)(1, H, W, C)),
        "dw": _w((lambda *s: torch.randn(*s, dtype=torch.bfloat16) * 0.05)(k, k, C)),
        "pw": _w((lambda *s: torch.randn(*s, dtype=torch.bfloat16) * 0.05)(C, C)),
    }

def reference(x, dw, pw):
    B, H, W, C = x.shape
    k = dw.shape[0]
    pad = k // 2
    xp = _pad(x, ((0,0),(pad,pad),(pad,pad),(0,0)))
    out = torch.zeros_like(x)
    for i in range(k):
        for j in range(k):
            out = out + xp[:, i:i+H, j:j+W, :] * dw[i, j][None, None, None, :]
    return torch.einsum('bhwc,cd->bhwd', out, pw)
```

```asm
; @launch grid=(256,1,1) block=(256,1,1) lds=151552
.amdgcn_target "amdgcn-amd-amdhsa--gfx950"
.text
.globl standalone__depthwise_separable__vision_kernel
.p2align 8
.type standalone__depthwise_separable__vision_kernel,@function
standalone__depthwise_separable__vision_kernel:
  s_load_dwordx8 s[24:31], s[0:1], 0
  s_cmp_ge_u32 s2, 256
  s_cbranch_scc1 L_done
  v_lshrrev_b32 v80, 6, v0
  v_and_b32 v71, 63, v0
  v_readfirstlane_b32 s20, v80
  s_lshr_b32 s50, s2, 3
  s_and_b32 s55, s50, 3
  s_lshr_b32 s54, s50, 2
  s_mul_i32 s51, s54, 11
  s_lshr_b32 s51, s51, 5
  s_mul_i32 s51, s51, 3
  s_sub_u32 s54, s54, s51
  s_mul_i32 s52, s20, 192
  v_mul_u32_u24 v82, 0xaaab, v71
  v_lshrrev_b32 v82, 19, v82
  v_mul_u32_u24 v83, 576, v82
  v_lshl_add_u32 v83, v71, 4, v83
  v_add_u32 v64, s52, v83
  v_add_u32 v81, 64, v71
  v_mul_u32_u24 v82, 0xaaab, v81
  v_lshrrev_b32 v82, 19, v82
  v_mul_u32_u24 v83, 576, v82
  v_lshl_add_u32 v83, v71, 4, v83
  v_add_u32 v65, s52, v83
  v_add_u32 v81, 128, v71
  v_mul_u32_u24 v82, 0xaaab, v81
  v_lshrrev_b32 v82, 19, v82
  v_mul_u32_u24 v83, 576, v82
  v_lshl_add_u32 v83, v71, 4, v83
  v_add_u32 v66, s52, v83
  s_mul_i32 s42, s54, 98304
  s_add_u32 s43, s42, 98304
  s_cmp_eq_u32 s54, 2
  s_cselect_b32 s43, 0, s43
  s_add_u32 s44, s43, 98304
  s_cmp_eq_u32 s54, 1
  s_cselect_b32 s44, 0, s44
  s_xor_b32 s45, s55, 0
  s_mul_i32 s45, s45, 24576
  s_xor_b32 s46, s55, 1
  s_mul_i32 s46, s46, 24576
  s_xor_b32 s47, s55, 2
  s_mul_i32 s47, s47, 24576
  s_xor_b32 s48, s55, 3
  s_mul_i32 s48, s48, 24576
  s_mul_i32 s49, s20, 6144
  s_lshl_b32 s53, s55, 2
  v_lshrrev_b32 v81, 4, v71
  v_add_u32 v82, s54, v81
  v_subrev_u32 v83, 3, v82
  v_min_u32 v82, v82, v83
  v_and_b32 v84, 15, v71
  v_xor_b32 v83, s53, v84
  v_lshlrev_b32 v83, 4, v83
  v_lshl_add_u32 v83, v82, 8, v83
  v_cmp_lt_u32 vcc, 47, v71
  s_lshl_b32 s50, s20, 10
  s_add_u32 m0, s50, 147456
  v_cndmask_b32 v83, v83, v66, vcc
  s_waitcnt lgkmcnt(0)
  s_mov_b32 s16, s26
  s_and_b32 s17, s27, 0xffff
  s_mov_b32 s18, 768
  s_mov_b32 s19, 0x00020000
  s_mov_b32 s12, s28
  s_and_b32 s13, s29, 0xffff
  s_mov_b32 s14, 294912
  s_mov_b32 s15, 0x00020000
  buffer_load_dwordx4 v83, s[16:19], 0 offen lds
  s_add_u32 m0, s49, 49152
  s_add_u32 s50, s42, s45
  buffer_load_dwordx4 v64, s[12:15], s50 offen offset:0 lds
  buffer_load_dwordx4 v65, s[12:15], s50 offen offset:1024 lds
  buffer_load_dwordx4 v66, s[12:15], s50 offen offset:2048 lds
  s_add_u32 m0, s49, 52224
  s_add_u32 s50, s50, 12288
  buffer_load_dwordx4 v64, s[12:15], s50 offen offset:0 lds
  buffer_load_dwordx4 v65, s[12:15], s50 offen offset:1024 lds
  buffer_load_dwordx4 v66, s[12:15], s50 offen offset:2048 lds
  s_add_u32 m0, s49, 73728
  s_add_u32 s50, s42, s46
  buffer_load_dwordx4 v64, s[12:15], s50 offen offset:0 lds
  buffer_load_dwordx4 v65, s[12:15], s50 offen offset:1024 lds
  buffer_load_dwordx4 v66, s[12:15], s50 offen offset:2048 lds
  s_add_u32 m0, s49, 76800
  s_add_u32 s50, s50, 12288
  buffer_load_dwordx4 v64, s[12:15], s50 offen offset:0 lds
  buffer_load_dwordx4 v65, s[12:15], s50 offen offset:1024 lds
  buffer_load_dwordx4 v66, s[12:15], s50 offen offset:2048 lds
  s_mov_b32 s4, s24
  s_and_b32 s5, s25, 0xffff
  s_mov_b32 s6, 113246208
  s_mov_b32 s7, 0x00020000
  s_mov_b32 s8, s30
  s_and_b32 s9, s31, 0xffff
  s_mov_b32 s10, 113246208
  s_mov_b32 s11, 0x00020000
  s_and_b32 s51, s2, 7
  s_lshl_b32 s51, s51, 5
  s_lshr_b32 s52, s2, 3
  s_add_u32 s51, s51, s52
  s_mul_i32 s41, s51, 24576
  s_mov_b32 s40, 113246208
  s_lshl_b32 s39, s20, 10
  v_lshrrev_b32 v80, 4, v0
  v_mul_u32_u24 v82, 43, v80
  v_lshrrev_b32 v82, 7, v82
  v_mul_u32_u24 v83, 3, v82
  v_sub_u32 v83, v80, v83
  v_and_b32 v85, 7, v82
  v_xor_b32 v85, v85, v84
  v_lshlrev_b32 v85, 4, v85
  v_lshl_add_u32 v85, v80, 8, v85
  v_add_u32 v7, 98304, v85
  v_add_u32 v83, s54, v83
  v_subrev_u32 v85, 3, v83
  v_min_u32 v83, v83, v85
  v_xor_b32 v85, v82, v84
  v_xor_b32 v85, s53, v85
  v_lshlrev_b32 v85, 4, v85
  v_lshl_add_u32 v85, v83, 8, v85
  v_mul_u32_u24 v82, 0x300, v82
  v_add_u32 v10, v82, v85
  v_lshrrev_b32 v80, 4, v0
  v_add_u32 v80, 16, v80
  v_mul_u32_u24 v82, 43, v80
  v_lshrrev_b32 v82, 7, v82
  v_mul_u32_u24 v83, 3, v82
  v_sub_u32 v83, v80, v83
  v_and_b32 v85, 7, v82
  v_xor_b32 v85, v85, v84
  v_lshlrev_b32 v85, 4, v85
  v_lshl_add_u32 v85, v80, 8, v85
  v_add_u32 v8, 98304, v85
  v_add_u32 v83, s54, v83
  v_subrev_u32 v85, 3, v83
  v_min_u32 v83, v83, v85
  v_xor_b32 v85, v82, v84
  v_xor_b32 v85, s53, v85
  v_lshlrev_b32 v85, 4, v85
  v_lshl_add_u32 v85, v83, 8, v85
  v_mul_u32_u24 v82, 0x300, v82
  v_add_u32 v11, v82, v85
  v_lshrrev_b32 v80, 4, v0
  v_add_u32 v80, 32, v80
  v_mul_u32_u24 v82, 43, v80
  v_lshrrev_b32 v82, 7, v82
  v_mul_u32_u24 v83, 3, v82
  v_sub_u32 v83, v80, v83
  v_and_b32 v85, 7, v82
  v_xor_b32 v85, v85, v84
  v_lshlrev_b32 v85, 4, v85
  v_lshl_add_u32 v85, v80, 8, v85
  v_add_u32 v9, 98304, v85
  v_add_u32 v83, s54, v83
  v_subrev_u32 v85, 3, v83
  v_min_u32 v83, v83, v85
  v_xor_b32 v85, v82, v84
  v_xor_b32 v85, s53, v85
  v_lshlrev_b32 v85, 4, v85
  v_lshl_add_u32 v85, v83, 8, v85
  v_mul_u32_u24 v82, 0x300, v82
  v_add_u32 v12, v82, v85
  s_add_u32 m0, s49, 98304
  s_add_u32 s50, s42, s47
  buffer_load_dwordx4 v64, s[12:15], s50 offen offset:0 lds
  buffer_load_dwordx4 v65, s[12:15], s50 offen offset:1024 lds
  buffer_load_dwordx4 v66, s[12:15], s50 offen offset:2048 lds
  s_add_u32 m0, s49, 101376
  s_add_u32 s50, s50, 12288
  buffer_load_dwordx4 v64, s[12:15], s50 offen offset:0 lds
  buffer_load_dwordx4 v65, s[12:15], s50 offen offset:1024 lds
  buffer_load_dwordx4 v66, s[12:15], s50 offen offset:2048 lds
  s_add_u32 m0, s49, 122880
  s_add_u32 s50, s42, s48
  buffer_load_dwordx4 v64, s[12:15], s50 offen offset:0 lds
  buffer_load_dwordx4 v65, s[12:15], s50 offen offset:1024 lds
  buffer_load_dwordx4 v66, s[12:15], s50 offen offset:2048 lds
  s_add_u32 m0, s49, 125952
  s_add_u32 s50, s50, 12288
  buffer_load_dwordx4 v64, s[12:15], s50 offen offset:0 lds
  buffer_load_dwordx4 v65, s[12:15], s50 offen offset:1024 lds
  buffer_load_dwordx4 v66, s[12:15], s50 offen offset:2048 lds
  v_lshlrev_b32 v13, 4, v0
  v_add_u32 v14, 4096, v13
  v_add_u32 v15, 8192, v13
  v_mul_u32_u24 v80, 0x300, v84
  v_xor_b32 v82, v81, v84
  v_lshl_add_u32 v1, v82, 4, v80
  v_xor_b32 v2, 64, v1
  v_xor_b32 v3, 128, v1
  v_xor_b32 v4, 192, v1
  s_mul_i32 s51, s20, 12
  v_and_b32 v82, 7, v84
  v_add_u32 v83, s51, v81
  v_xor_b32 v83, v83, v82
  v_lshl_add_u32 v5, v83, 4, v80
  v_add_u32 v5, 98304, v5
  v_add_u32 v83, s51, v81
  v_add_u32 v83, 4, v83
  v_xor_b32 v83, v83, v82
  v_lshl_add_u32 v6, v83, 4, v80
  v_add_u32 v6, 98304, v6
  v_bfe_u32 v82, v71, 2, 2
  v_and_b32 v83, 3, v71
  v_lshl_add_u32 v85, v81, 3, v82
  v_mul_u32_u24 v85, 192, v85
  v_lshl_add_u32 v85, v83, 4, v85
  s_add_u32 s51, s49, 49152
  v_add_u32 v67, s51, v85
  v_add_u32 v86, 49152, v67
  s_add_u32 s51, s39, 147456
  v_lshl_add_u32 v68, v81, 4, s51
  v_and_b32 v85, 1, v71
  v_lshlrev_b32 v85, 4, v85
  v_mov_b32 v87, 0xffff
  v_lshlrev_b32 v85, v85, v87
  v_lshlrev_b32 v80, 1, v81
  v_bfe_u32 v87, v71, 1, 3
  v_cmp_eq_u32 vcc, v80, v87
  v_add_u32 v80, 1, v80
  s_nop 0
  v_cndmask_b32 v69, 0, v85, vcc
  v_cmp_eq_u32 vcc, v80, v87
  s_sub_u32 s32, s41, 6291456
  s_sub_u32 s33, s41, 12570624
  v_cndmask_b32 v70, 0, v85, vcc
  s_mov_b32 s38, s41
  s_mov_b32 s34, s40
  s_mov_b32 s35, s40
  s_waitcnt vmcnt(18)
  ds_read_b128 v[72:75], v68 offset:0
  ds_read_b64_tr_b16 a[168:169], v67 offset:0
  ds_read_b64_tr_b16 a[170:171], v67 offset:768
  ds_read_b64_tr_b16 a[172:173], v67 offset:8
  ds_read_b64_tr_b16 a[174:175], v67 offset:776
  ds_read_b64_tr_b16 a[176:177], v67 offset:64
  ds_read_b64_tr_b16 a[178:179], v67 offset:832
  ds_read_b64_tr_b16 a[180:181], v67 offset:72
  ds_read_b64_tr_b16 a[182:183], v67 offset:840
  ds_read_b64_tr_b16 a[184:185], v67 offset:128
  ds_read_b64_tr_b16 a[186:187], v67 offset:896
  ds_read_b64_tr_b16 a[188:189], v67 offset:136
  ds_read_b64_tr_b16 a[190:191], v67 offset:904
  s_waitcnt vmcnt(12)
  ds_read_b128 v[76:79], v68 offset:64
  ds_read_b64_tr_b16 a[192:193], v67 offset:24576
  ds_read_b64_tr_b16 a[194:195], v67 offset:25344
  ds_read_b64_tr_b16 a[196:197], v67 offset:24584
  ds_read_b64_tr_b16 a[198:199], v67 offset:25352
  ds_read_b64_tr_b16 a[200:201], v67 offset:24640
  ds_read_b64_tr_b16 a[202:203], v67 offset:25408
  ds_read_b64_tr_b16 a[204:205], v67 offset:24648
  ds_read_b64_tr_b16 a[206:207], v67 offset:25416
  ds_read_b64_tr_b16 a[208:209], v67 offset:24704
  ds_read_b64_tr_b16 a[210:211], v67 offset:25472
  ds_read_b64_tr_b16 a[212:213], v67 offset:24712
  ds_read_b64_tr_b16 a[214:215], v67 offset:25480
  s_waitcnt lgkmcnt(13)
  v_and_b32 v72, v69, v72
  v_and_b32 v73, v70, v73
  v_and_b32 v74, v69, v74
  v_and_b32 v75, v70, v75
  s_add_u32 m0, s49, 49152
  s_add_u32 s50, s43, s45
  buffer_load_dwordx4 v64, s[12:15], s50 offen offset:0 lds
  buffer_load_dwordx4 v65, s[12:15], s50 offen offset:1024 lds
  buffer_load_dwordx4 v66, s[12:15], s50 offen offset:2048 lds
  s_add_u32 m0, s49, 52224
  s_add_u32 s50, s50, 12288
  buffer_load_dwordx4 v64, s[12:15], s50 offen offset:0 lds
  buffer_load_dwordx4 v65, s[12:15], s50 offen offset:1024 lds
  buffer_load_dwordx4 v66, s[12:15], s50 offen offset:2048 lds
  v_mfma_f32_16x16x16_bf16 v[16:19], v[72:73], a[168:169], 0
  v_mfma_f32_16x16x16_bf16 v[20:23], v[74:75], a[170:171], 0
  v_mfma_f32_16x16x16_bf16 v[24:27], v[72:73], a[172:173], 0
  v_mfma_f32_16x16x16_bf16 v[28:31], v[74:75], a[174:175], 0
  v_mfma_f32_16x16x16_bf16 v[32:35], v[72:73], a[176:177], 0
  v_mfma_f32_16x16x16_bf16 v[36:39], v[74:75], a[178:179], 0
  v_mfma_f32_16x16x16_bf16 v[40:43], v[72:73], a[180:181], 0
  v_mfma_f32_16x16x16_bf16 v[44:47], v[74:75], a[182:183], 0
  v_mfma_f32_16x16x16_bf16 v[48:51], v[72:73], a[184:185], 0
  v_cvt_pk_bf16_f32 v88, v16, v17
  v_cvt_pk_bf16_f32 v89, v18, v19
  v_mfma_f32_16x16x16_bf16 v[52:55], v[74:75], a[186:187], 0
  v_cvt_pk_bf16_f32 v90, v20, v21
  v_cvt_pk_bf16_f32 v91, v22, v23
  v_mfma_f32_16x16x16_bf16 v[56:59], v[72:73], a[188:189], 0
  v_cvt_pk_bf16_f32 v92, v24, v25
  v_cvt_pk_bf16_f32 v93, v26, v27
  v_mfma_f32_16x16x16_bf16 v[60:63], v[74:75], a[190:191], 0
  v_cvt_pk_bf16_f32 v94, v28, v29
  v_cvt_pk_bf16_f32 v95, v30, v31
  s_waitcnt vmcnt(12)
  ds_read_b128 v[72:75], v68 offset:128
  ds_read_b64_tr_b16 a[168:169], v86 offset:0
  ds_read_b64_tr_b16 a[170:171], v86 offset:768
  ds_read_b64_tr_b16 a[172:173], v86 offset:8
  ds_read_b64_tr_b16 a[174:175], v86 offset:776
  ds_read_b64_tr_b16 a[176:177], v86 offset:64
  ds_read_b64_tr_b16 a[178:179], v86 offset:832
  ds_read_b64_tr_b16 a[180:181], v86 offset:72
  ds_read_b64_tr_b16 a[182:183], v86 offset:840
  ds_read_b64_tr_b16 a[184:185], v86 offset:128
  ds_read_b64_tr_b16 a[186:187], v86 offset:896
  ds_read_b64_tr_b16 a[188:189], v86 offset:136
  ds_read_b64_tr_b16 a[190:191], v86 offset:904
  s_waitcnt lgkmcnt(13)
  v_and_b32 v76, v69, v76
  v_and_b32 v77, v70, v77
  v_and_b32 v78, v69, v78
  v_and_b32 v79, v70, v79
  s_add_u32 m0, s49, 73728
  s_add_u32 s50, s43, s46
  buffer_load_dwordx4 v64, s[12:15], s50 offen offset:0 lds
  buffer_load_dwordx4 v65, s[12:15], s50 offen offset:1024 lds
  buffer_load_dwordx4 v66, s[12:15], s50 offen offset:2048 lds
  s_add_u32 m0, s49, 76800
  s_add_u32 s50, s50, 12288
  buffer_load_dwordx4 v64, s[12:15], s50 offen offset:0 lds
  buffer_load_dwordx4 v65, s[12:15], s50 offen offset:1024 lds
  buffer_load_dwordx4 v66, s[12:15], s50 offen offset:2048 lds
  v_mfma_f32_16x16x16_bf16 v[16:19], v[76:77], a[192:193], 0
  v_cvt_pk_bf16_f32 v96, v32, v33
  v_cvt_pk_bf16_f32 v97, v34, v35
  v_mfma_f32_16x16x16_bf16 v[20:23], v[78:79], a[194:195], 0
  v_cvt_pk_bf16_f32 v98, v36, v37
  v_cvt_pk_bf16_f32 v99, v38, v39
  v_mfma_f32_16x16x16_bf16 v[24:27], v[76:77], a[196:197], 0
  v_cvt_pk_bf16_f32 v100, v40, v41
  v_cvt_pk_bf16_f32 v101, v42, v43
  v_mfma_f32_16x16x16_bf16 v[28:31], v[78:79], a[198:199], 0
  v_cvt_pk_bf16_f32 v102, v44, v45
  v_cvt_pk_bf16_f32 v103, v46, v47
  v_mfma_f32_16x16x16_bf16 v[32:35], v[76:77], a[200:201], 0
  v_cvt_pk_bf16_f32 v104, v48, v49
  v_cvt_pk_bf16_f32 v105, v50, v51
  v_mfma_f32_16x16x16_bf16 v[36:39], v[78:79], a[202:203], 0
  v_cvt_pk_bf16_f32 v106, v52, v53
  v_cvt_pk_bf16_f32 v107, v54, v55
  v_mfma_f32_16x16x16_bf16 v[40:43], v[76:77], a[204:205], 0
  v_cvt_pk_bf16_f32 v108, v56, v57
  v_cvt_pk_bf16_f32 v109, v58, v59
  v_mfma_f32_16x16x16_bf16 v[44:47], v[78:79], a[206:207], 0
  v_cvt_pk_bf16_f32 v110, v60, v61
  v_cvt_pk_bf16_f32 v111, v62, v63
  v_mfma_f32_16x16x16_bf16 v[48:51], v[76:77], a[208:209], 0
  v_cvt_pk_bf16_f32 v16, v16, v17
  v_cvt_pk_bf16_f32 v17, v18, v19
  v_accvgpr_write_b32 a0, v16
  v_accvgpr_write_b32 a1, v17
  v_mfma_f32_16x16x16_bf16 v[52:55], v[78:79], a[210:211], 0
  v_cvt_pk_bf16_f32 v20, v20, v21
  v_cvt_pk_bf16_f32 v21, v22, v23
  v_accvgpr_write_b32 a2, v20
  v_accvgpr_write_b32 a3, v21
  v_mfma_f32_16x16x16_bf16 v[56:59], v[76:77], a[212:213], 0
  v_cvt_pk_bf16_f32 v24, v24, v25
  v_cvt_pk_bf16_f32 v25, v26, v27
  v_accvgpr_write_b32 a4, v24
  v_accvgpr_write_b32 a5, v25
  v_mfma_f32_16x16x16_bf16 v[60:63], v[78:79], a[214:215], 0
  v_cvt_pk_bf16_f32 v28, v28, v29
  v_cvt_pk_bf16_f32 v29, v30, v31
  v_accvgpr_write_b32 a6, v28
  v_accvgpr_write_b32 a7, v29
  s_waitcnt vmcnt(12)
  ds_read_b128 v[76:79], v68 offset:192
  ds_read_b64_tr_b16 a[192:193], v86 offset:24576
  ds_read_b64_tr_b16 a[194:195], v86 offset:25344
  ds_read_b64_tr_b16 a[196:197], v86 offset:24584
  ds_read_b64_tr_b16 a[198:199], v86 offset:25352
  ds_read_b64_tr_b16 a[200:201], v86 offset:24640
  ds_read_b64_tr_b16 a[202:203], v86 offset:25408
  ds_read_b64_tr_b16 a[204:205], v86 offset:24648
  ds_read_b64_tr_b16 a[206:207], v86 offset:25416
  ds_read_b64_tr_b16 a[208:209], v86 offset:24704
  ds_read_b64_tr_b16 a[210:211], v86 offset:25472
  ds_read_b64_tr_b16 a[212:213], v86 offset:24712
  ds_read_b64_tr_b16 a[214:215], v86 offset:25480
  s_waitcnt lgkmcnt(13)
  v_and_b32 v72, v69, v72
  v_and_b32 v73, v70, v73
  v_and_b32 v74, v69, v74
  v_and_b32 v75, v70, v75
  s_add_u32 m0, s49, 98304
  s_add_u32 s50, s43, s47
  buffer_load_dwordx4 v64, s[12:15], s50 offen offset:0 lds
  buffer_load_dwordx4 v65, s[12:15], s50 offen offset:1024 lds
  buffer_load_dwordx4 v66, s[12:15], s50 offen offset:2048 lds
  s_add_u32 m0, s49, 101376
  s_add_u32 s50, s50, 12288
  buffer_load_dwordx4 v64, s[12:15], s50 offen offset:0 lds
  buffer_load_dwordx4 v65, s[12:15], s50 offen offset:1024 lds
  buffer_load_dwordx4 v66, s[12:15], s50 offen offset:2048 lds
  v_mfma_f32_16x16x16_bf16 v[16:19], v[72:73], a[168:169], 0
  v_cvt_pk_bf16_f32 v32, v32, v33
  v_cvt_pk_bf16_f32 v33, v34, v35
  v_accvgpr_write_b32 a8, v32
  v_accvgpr_write_b32 a9, v33
  v_mfma_f32_16x16x16_bf16 v[20:23], v[74:75], a[170:171], 0
  v_cvt_pk_bf16_f32 v36, v36, v37
  v_cvt_pk_bf16_f32 v37, v38, v39
  v_accvgpr_write_b32 a10, v36
  v_accvgpr_write_b32 a11, v37
  v_mfma_f32_16x16x16_bf16 v[24:27], v[72:73], a[172:173], 0
  v_cvt_pk_bf16_f32 v40, v40, v41
  v_cvt_pk_bf16_f32 v41, v42, v43
  v_accvgpr_write_b32 a12, v40
  v_accvgpr_write_b32 a13, v41
  v_mfma_f32_16x16x16_bf16 v[28:31], v[74:75], a[174:175], 0
  v_cvt_pk_bf16_f32 v44, v44, v45
  v_cvt_pk_bf16_f32 v45, v46, v47
  v_accvgpr_write_b32 a14, v44
  v_accvgpr_write_b32 a15, v45
  v_mfma_f32_16x16x16_bf16 v[32:35], v[72:73], a[176:177], 0
  v_cvt_pk_bf16_f32 v48, v48, v49
  v_cvt_pk_bf16_f32 v49, v50, v51
  v_accvgpr_write_b32 a16, v48
  v_accvgpr_write_b32 a17, v49
  v_mfma_f32_16x16x16_bf16 v[36:39], v[74:75], a[178:179], 0
  v_cvt_pk_bf16_f32 v52, v52, v53
  v_cvt_pk_bf16_f32 v53, v54, v55
  v_accvgpr_write_b32 a18, v52
  v_accvgpr_write_b32 a19, v53
  v_mfma_f32_16x16x16_bf16 v[40:43], v[72:73], a[180:181], 0
  v_cvt_pk_bf16_f32 v56, v56, v57
  v_cvt_pk_bf16_f32 v57, v58, v59
  v_accvgpr_write_b32 a20, v56
  v_accvgpr_write_b32 a21, v57
  v_mfma_f32_16x16x16_bf16 v[44:47], v[74:75], a[182:183], 0
  v_cvt_pk_bf16_f32 v60, v60, v61
  v_cvt_pk_bf16_f32 v61, v62, v63
  v_accvgpr_write_b32 a22, v60
  v_accvgpr_write_b32 a23, v61
  v_mfma_f32_16x16x16_bf16 v[48:51], v[72:73], a[184:185], 0
  v_cvt_pk_bf16_f32 v112, v16, v17
  v_cvt_pk_bf16_f32 v113, v18, v19
  v_mfma_f32_16x16x16_bf16 v[52:55], v[74:75], a[186:187], 0
  v_cvt_pk_bf16_f32 v114, v20, v21
  v_cvt_pk_bf16_f32 v115, v22, v23
  v_mfma_f32_16x16x16_bf16 v[56:59], v[72:73], a[188:189], 0
  v_cvt_pk_bf16_f32 v116, v24, v25
  v_cvt_pk_bf16_f32 v117, v26, v27
  v_mfma_f32_16x16x16_bf16 v[60:63], v[74:75], a[190:191], 0
  v_cvt_pk_bf16_f32 v118, v28, v29
  v_cvt_pk_bf16_f32 v119, v30, v31
  s_waitcnt vmcnt(12)
  ds_read_b128 v[72:75], v68 offset:256
  ds_read_b64_tr_b16 a[168:169], v67 offset:0
  ds_read_b64_tr_b16 a[170:171], v67 offset:768
  ds_read_b64_tr_b16 a[172:173], v67 offset:8
  ds_read_b64_tr_b16 a[174:175], v67 offset:776
  ds_read_b64_tr_b16 a[176:177], v67 offset:64
  ds_read_b64_tr_b16 a[178:179], v67 offset:832
  ds_read_b64_tr_b16 a[180:181], v67 offset:72
  ds_read_b64_tr_b16 a[182:183], v67 offset:840
  ds_read_b64_tr_b16 a[184:185], v67 offset:128
  ds_read_b64_tr_b16 a[186:187], v67 offset:896
  ds_read_b64_tr_b16 a[188:189], v67 offset:136
  ds_read_b64_tr_b16 a[190:191], v67 offset:904
  s_waitcnt lgkmcnt(13)
  v_and_b32 v76, v69, v76
  v_and_b32 v77, v70, v77
  v_and_b32 v78, v69, v78
  v_and_b32 v79, v70, v79
  s_add_u32 m0, s49, 122880
  s_add_u32 s50, s43, s48
  buffer_load_dwordx4 v64, s[12:15], s50 offen offset:0 lds
  buffer_load_dwordx4 v65, s[12:15], s50 offen offset:1024 lds
  buffer_load_dwordx4 v66, s[12:15], s50 offen offset:2048 lds
  s_add_u32 m0, s49, 125952
  s_add_u32 s50, s50, 12288
  buffer_load_dwordx4 v64, s[12:15], s50 offen offset:0 lds
  buffer_load_dwordx4 v65, s[12:15], s50 offen offset:1024 lds
  buffer_load_dwordx4 v66, s[12:15], s50 offen offset:2048 lds
  v_mfma_f32_16x16x16_bf16 v[16:19], v[76:77], a[192:193], 0
  v_cvt_pk_bf16_f32 v120, v32, v33
  v_cvt_pk_bf16_f32 v121, v34, v35
  v_mfma_f32_16x16x16_bf16 v[20:23], v[78:79], a[194:195], 0
  v_cvt_pk_bf16_f32 v122, v36, v37
  v_cvt_pk_bf16_f32 v123, v38, v39
  v_mfma_f32_16x16x16_bf16 v[24:27], v[76:77], a[196:197], 0
  v_cvt_pk_bf16_f32 v124, v40, v41
  v_cvt_pk_bf16_f32 v125, v42, v43
  v_mfma_f32_16x16x16_bf16 v[28:31], v[78:79], a[198:199], 0
  v_cvt_pk_bf16_f32 v126, v44, v45
  v_cvt_pk_bf16_f32 v127, v46, v47
  v_mfma_f32_16x16x16_bf16 v[32:35], v[76:77], a[200:201], 0
  v_cvt_pk_bf16_f32 v128, v48, v49
  v_cvt_pk_bf16_f32 v129, v50, v51
  v_mfma_f32_16x16x16_bf16 v[36:39], v[78:79], a[202:203], 0
  v_cvt_pk_bf16_f32 v130, v52, v53
  v_cvt_pk_bf16_f32 v131, v54, v55
  v_mfma_f32_16x16x16_bf16 v[40:43], v[76:77], a[204:205], 0
  v_cvt_pk_bf16_f32 v132, v56, v57
  v_cvt_pk_bf16_f32 v133, v58, v59
  v_mfma_f32_16x16x16_bf16 v[44:47], v[78:79], a[206:207], 0
  v_cvt_pk_bf16_f32 v134, v60, v61
  v_cvt_pk_bf16_f32 v135, v62, v63
  v_mfma_f32_16x16x16_bf16 v[48:51], v[76:77], a[208:209], 0
  v_cvt_pk_bf16_f32 v16, v16, v17
  v_cvt_pk_bf16_f32 v17, v18, v19
  v_accvgpr_write_b32 a24, v16
  v_accvgpr_write_b32 a25, v17
  v_mfma_f32_16x16x16_bf16 v[52:55], v[78:79], a[210:211], 0
  v_cvt_pk_bf16_f32 v20, v20, v21
  v_cvt_pk_bf16_f32 v21, v22, v23
  v_accvgpr_write_b32 a26, v20
  v_accvgpr_write_b32 a27, v21
  v_mfma_f32_16x16x16_bf16 v[56:59], v[76:77], a[212:213], 0
  v_cvt_pk_bf16_f32 v24, v24, v25
  v_cvt_pk_bf16_f32 v25, v26, v27
  v_accvgpr_write_b32 a28, v24
  v_accvgpr_write_b32 a29, v25
  v_mfma_f32_16x16x16_bf16 v[60:63], v[78:79], a[214:215], 0
  v_cvt_pk_bf16_f32 v28, v28, v29
  v_cvt_pk_bf16_f32 v29, v30, v31
  v_accvgpr_write_b32 a30, v28
  v_accvgpr_write_b32 a31, v29
  s_waitcnt vmcnt(12)
  ds_read_b128 v[76:79], v68 offset:320
  ds_read_b64_tr_b16 a[192:193], v67 offset:24576
  ds_read_b64_tr_b16 a[194:195], v67 offset:25344
  ds_read_b64_tr_b16 a[196:197], v67 offset:24584
  ds_read_b64_tr_b16 a[198:199], v67 offset:25352
  ds_read_b64_tr_b16 a[200:201], v67 offset:24640
  ds_read_b64_tr_b16 a[202:203], v67 offset:25408
  ds_read_b64_tr_b16 a[204:205], v67 offset:24648
  ds_read_b64_tr_b16 a[206:207], v67 offset:25416
  ds_read_b64_tr_b16 a[208:209], v67 offset:24704
  ds_read_b64_tr_b16 a[210:211], v67 offset:25472
  ds_read_b64_tr_b16 a[212:213], v67 offset:24712
  ds_read_b64_tr_b16 a[214:215], v67 offset:25480
  s_waitcnt lgkmcnt(13)
  v_and_b32 v72, v69, v72
  v_and_b32 v73, v70, v73
  v_and_b32 v74, v69, v74
  v_and_b32 v75, v70, v75
  s_add_u32 m0, s49, 49152
  s_add_u32 s50, s44, s45
  buffer_load_dwordx4 v64, s[12:15], s50 offen offset:0 lds
  buffer_load_dwordx4 v65, s[12:15], s50 offen offset:1024 lds
  buffer_load_dwordx4 v66, s[12:15], s50 offen offset:2048 lds
  s_add_u32 m0, s49, 52224
  s_add_u32 s50, s50, 12288
  buffer_load_dwordx4 v64, s[12:15], s50 offen offset:0 lds
  buffer_load_dwordx4 v65, s[12:15], s50 offen offset:1024 lds
  buffer_load_dwordx4 v66, s[12:15], s50 offen offset:2048 lds
  v_mfma_f32_16x16x16_bf16 v[16:19], v[72:73], a[168:169], 0
  v_cvt_pk_bf16_f32 v32, v32, v33
  v_cvt_pk_bf16_f32 v33, v34, v35
  v_accvgpr_write_b32 a32, v32
  v_accvgpr_write_b32 a33, v33
  v_mfma_f32_16x16x16_bf16 v[20:23], v[74:75], a[170:171], 0
  v_cvt_pk_bf16_f32 v36, v36, v37
  v_cvt_pk_bf16_f32 v37, v38, v39
  v_accvgpr_write_b32 a34, v36
  v_accvgpr_write_b32 a35, v37
  v_mfma_f32_16x16x16_bf16 v[24:27], v[72:73], a[172:173], 0
  v_cvt_pk_bf16_f32 v40, v40, v41
  v_cvt_pk_bf16_f32 v41, v42, v43
  v_accvgpr_write_b32 a36, v40
  v_accvgpr_write_b32 a37, v41
  v_mfma_f32_16x16x16_bf16 v[28:31], v[74:75], a[174:175], 0
  v_cvt_pk_bf16_f32 v44, v44, v45
  v_cvt_pk_bf16_f32 v45, v46, v47
  v_accvgpr_write_b32 a38, v44
  v_accvgpr_write_b32 a39, v45
  v_mfma_f32_16x16x16_bf16 v[32:35], v[72:73], a[176:177], 0
  v_cvt_pk_bf16_f32 v48, v48, v49
  v_cvt_pk_bf16_f32 v49, v50, v51
  v_accvgpr_write_b32 a40, v48
  v_accvgpr_write_b32 a41, v49
  v_mfma_f32_16x16x16_bf16 v[36:39], v[74:75], a[178:179], 0
  v_cvt_pk_bf16_f32 v52, v52, v53
  v_cvt_pk_bf16_f32 v53, v54, v55
  v_accvgpr_write_b32 a42, v52
  v_accvgpr_write_b32 a43, v53
  v_mfma_f32_16x16x16_bf16 v[40:43], v[72:73], a[180:181], 0
  v_cvt_pk_bf16_f32 v56, v56, v57
  v_cvt_pk_bf16_f32 v57, v58, v59
  v_accvgpr_write_b32 a44, v56
  v_accvgpr_write_b32 a45, v57
  v_mfma_f32_16x16x16_bf16 v[44:47], v[74:75], a[182:183], 0
  v_cvt_pk_bf16_f32 v60, v60, v61
  v_cvt_pk_bf16_f32 v61, v62, v63
  v_accvgpr_write_b32 a46, v60
  v_accvgpr_write_b32 a47, v61
  v_mfma_f32_16x16x16_bf16 v[48:51], v[72:73], a[184:185], 0
  v_cvt_pk_bf16_f32 v136, v16, v17
  v_cvt_pk_bf16_f32 v137, v18, v19
  v_mfma_f32_16x16x16_bf16 v[52:55], v[74:75], a[186:187], 0
  v_cvt_pk_bf16_f32 v138, v20, v21
  v_cvt_pk_bf16_f32 v139, v22, v23
  v_mfma_f32_16x16x16_bf16 v[56:59], v[72:73], a[188:189], 0
  v_cvt_pk_bf16_f32 v140, v24, v25
  v_cvt_pk_bf16_f32 v141, v26, v27
  v_mfma_f32_16x16x16_bf16 v[60:63], v[74:75], a[190:191], 0
  v_cvt_pk_bf16_f32 v142, v28, v29
  v_cvt_pk_bf16_f32 v143, v30, v31
  s_waitcnt vmcnt(12)
  ds_read_b128 v[72:75], v68 offset:384
  ds_read_b64_tr_b16 a[168:169], v86 offset:0
  ds_read_b64_tr_b16 a[170:171], v86 offset:768
  ds_read_b64_tr_b16 a[172:173], v86 offset:8
  ds_read_b64_tr_b16 a[174:175], v86 offset:776
  ds_read_b64_tr_b16 a[176:177], v86 offset:64
  ds_read_b64_tr_b16 a[178:179], v86 offset:832
  ds_read_b64_tr_b16 a[180:181], v86 offset:72
  ds_read_b64_tr_b16 a[182:183], v86 offset:840
  ds_read_b64_tr_b16 a[184:185], v86 offset:128
  ds_read_b64_tr_b16 a[186:187], v86 offset:896
  ds_read_b64_tr_b16 a[188:189], v86 offset:136
  ds_read_b64_tr_b16 a[190:191], v86 offset:904
  s_waitcnt lgkmcnt(13)
  v_and_b32 v76, v69, v76
  v_and_b32 v77, v70, v77
  v_and_b32 v78, v69, v78
  v_and_b32 v79, v70, v79
  s_add_u32 m0, s49, 73728
  s_add_u32 s50, s44, s46
  buffer_load_dwordx4 v64, s[12:15], s50 offen offset:0 lds
  buffer_load_dwordx4 v65, s[12:15], s50 offen offset:1024 lds
  buffer_load_dwordx4 v66, s[12:15], s50 offen offset:2048 lds
  s_add_u32 m0, s49, 76800
  s_add_u32 s50, s50, 12288
  buffer_load_dwordx4 v64, s[12:15], s50 offen offset:0 lds
  buffer_load_dwordx4 v65, s[12:15], s50 offen offset:1024 lds
  buffer_load_dwordx4 v66, s[12:15], s50 offen offset:2048 lds
  v_mfma_f32_16x16x16_bf16 v[16:19], v[76:77], a[192:193], 0
  v_cvt_pk_bf16_f32 v144, v32, v33
  v_cvt_pk_bf16_f32 v145, v34, v35
  v_mfma_f32_16x16x16_bf16 v[20:23], v[78:79], a[194:195], 0
  v_cvt_pk_bf16_f32 v146, v36, v37
  v_cvt_pk_bf16_f32 v147, v38, v39
  v_mfma_f32_16x16x16_bf16 v[24:27], v[76:77], a[196:197], 0
  v_cvt_pk_bf16_f32 v148, v40, v41
  v_cvt_pk_bf16_f32 v149, v42, v43
  v_mfma_f32_16x16x16_bf16 v[28:31], v[78:79], a[198:199], 0
  v_cvt_pk_bf16_f32 v150, v44, v45
  v_cvt_pk_bf16_f32 v151, v46, v47
  v_mfma_f32_16x16x16_bf16 v[32:35], v[76:77], a[200:201], 0
  v_cvt_pk_bf16_f32 v152, v48, v49
  v_cvt_pk_bf16_f32 v153, v50, v51
  v_mfma_f32_16x16x16_bf16 v[36:39], v[78:79], a[202:203], 0
  v_cvt_pk_bf16_f32 v154, v52, v53
  v_cvt_pk_bf16_f32 v155, v54, v55
  v_mfma_f32_16x16x16_bf16 v[40:43], v[76:77], a[204:205], 0
  v_cvt_pk_bf16_f32 v156, v56, v57
  v_cvt_pk_bf16_f32 v157, v58, v59
  v_mfma_f32_16x16x16_bf16 v[44:47], v[78:79], a[206:207], 0
  v_cvt_pk_bf16_f32 v158, v60, v61
  v_cvt_pk_bf16_f32 v159, v62, v63
  v_mfma_f32_16x16x16_bf16 v[48:51], v[76:77], a[208:209], 0
  v_cvt_pk_bf16_f32 v16, v16, v17
  v_cvt_pk_bf16_f32 v17, v18, v19
  v_accvgpr_write_b32 a48, v16
  v_accvgpr_write_b32 a49, v17
  v_mfma_f32_16x16x16_bf16 v[52:55], v[78:79], a[210:211], 0
  v_cvt_pk_bf16_f32 v20, v20, v21
  v_cvt_pk_bf16_f32 v21, v22, v23
  v_accvgpr_write_b32 a50, v20
  v_accvgpr_write_b32 a51, v21
  v_mfma_f32_16x16x16_bf16 v[56:59], v[76:77], a[212:213], 0
  v_cvt_pk_bf16_f32 v24, v24, v25
  v_cvt_pk_bf16_f32 v25, v26, v27
  v_accvgpr_write_b32 a52, v24
  v_accvgpr_write_b32 a53, v25
  v_mfma_f32_16x16x16_bf16 v[60:63], v[78:79], a[214:215], 0
  v_cvt_pk_bf16_f32 v28, v28, v29
  v_cvt_pk_bf16_f32 v29, v30, v31
  v_accvgpr_write_b32 a54, v28
  v_accvgpr_write_b32 a55, v29
  s_waitcnt vmcnt(12)
  ds_read_b128 v[76:79], v68 offset:448
  ds_read_b64_tr_b16 a[192:193], v86 offset:24576
  ds_read_b64_tr_b16 a[194:195], v86 offset:25344
  ds_read_b64_tr_b16 a[196:197], v86 offset:24584
  ds_read_b64_tr_b16 a[198:199], v86 offset:25352
  ds_read_b64_tr_b16 a[200:201], v86 offset:24640
  ds_read_b64_tr_b16 a[202:203], v86 offset:25408
  ds_read_b64_tr_b16 a[204:205], v86 offset:24648
  ds_read_b64_tr_b16 a[206:207], v86 offset:25416
  ds_read_b64_tr_b16 a[208:209], v86 offset:24704
  ds_read_b64_tr_b16 a[210:211], v86 offset:25472
  ds_read_b64_tr_b16 a[212:213], v86 offset:24712
  ds_read_b64_tr_b16 a[214:215], v86 offset:25480
  s_waitcnt lgkmcnt(13)
  v_and_b32 v72, v69, v72
  v_and_b32 v73, v70, v73
  v_and_b32 v74, v69, v74
  v_and_b32 v75, v70, v75
  s_add_u32 m0, s49, 98304
  s_add_u32 s50, s44, s47
  buffer_load_dwordx4 v64, s[12:15], s50 offen offset:0 lds
  buffer_load_dwordx4 v65, s[12:15], s50 offen offset:1024 lds
  buffer_load_dwordx4 v66, s[12:15], s50 offen offset:2048 lds
  s_add_u32 m0, s49, 101376
  s_add_u32 s50, s50, 12288
  buffer_load_dwordx4 v64, s[12:15], s50 offen offset:0 lds
  buffer_load_dwordx4 v65, s[12:15], s50 offen offset:1024 lds
  buffer_load_dwordx4 v66, s[12:15], s50 offen offset:2048 lds
  v_mfma_f32_16x16x16_bf16 v[16:19], v[72:73], a[168:169], 0
  v_cvt_pk_bf16_f32 v32, v32, v33
  v_cvt_pk_bf16_f32 v33, v34, v35
  v_accvgpr_write_b32 a56, v32
  v_accvgpr_write_b32 a57, v33
  v_mfma_f32_16x16x16_bf16 v[20:23], v[74:75], a[170:171], 0
  v_cvt_pk_bf16_f32 v36, v36, v37
  v_cvt_pk_bf16_f32 v37, v38, v39
  v_accvgpr_write_b32 a58, v36
  v_accvgpr_write_b32 a59, v37
  v_mfma_f32_16x16x16_bf16 v[24:27], v[72:73], a[172:173], 0
  v_cvt_pk_bf16_f32 v40, v40, v41
  v_cvt_pk_bf16_f32 v41, v42, v43
  v_accvgpr_write_b32 a60, v40
  v_accvgpr_write_b32 a61, v41
  v_mfma_f32_16x16x16_bf16 v[28:31], v[74:75], a[174:175], 0
  v_cvt_pk_bf16_f32 v44, v44, v45
  v_cvt_pk_bf16_f32 v45, v46, v47
  v_accvgpr_write_b32 a62, v44
  v_accvgpr_write_b32 a63, v45
  v_mfma_f32_16x16x16_bf16 v[32:35], v[72:73], a[176:177], 0
  v_cvt_pk_bf16_f32 v48, v48, v49
  v_cvt_pk_bf16_f32 v49, v50, v51
  v_accvgpr_write_b32 a64, v48
  v_accvgpr_write_b32 a65, v49
  v_mfma_f32_16x16x16_bf16 v[36:39], v[74:75], a[178:179], 0
  v_cvt_pk_bf16_f32 v52, v52, v53
  v_cvt_pk_bf16_f32 v53, v54, v55
  v_accvgpr_write_b32 a66, v52
  v_accvgpr_write_b32 a67, v53
  v_mfma_f32_16x16x16_bf16 v[40:43], v[72:73], a[180:181], 0
  v_cvt_pk_bf16_f32 v56, v56, v57
  v_cvt_pk_bf16_f32 v57, v58, v59
  v_accvgpr_write_b32 a68, v56
  v_accvgpr_write_b32 a69, v57
  v_mfma_f32_16x16x16_bf16 v[44:47], v[74:75], a[182:183], 0
  v_cvt_pk_bf16_f32 v60, v60, v61
  v_cvt_pk_bf16_f32 v61, v62, v63
  v_accvgpr_write_b32 a70, v60
  v_accvgpr_write_b32 a71, v61
  v_mfma_f32_16x16x16_bf16 v[48:51], v[72:73], a[184:185], 0
  v_cvt_pk_bf16_f32 v160, v16, v17
  v_cvt_pk_bf16_f32 v161, v18, v19
  v_mfma_f32_16x16x16_bf16 v[52:55], v[74:75], a[186:187], 0
  v_cvt_pk_bf16_f32 v162, v20, v21
  v_cvt_pk_bf16_f32 v163, v22, v23
  v_mfma_f32_16x16x16_bf16 v[56:59], v[72:73], a[188:189], 0
  v_cvt_pk_bf16_f32 v164, v24, v25
  v_cvt_pk_bf16_f32 v165, v26, v27
  v_mfma_f32_16x16x16_bf16 v[60:63], v[74:75], a[190:191], 0
  v_cvt_pk_bf16_f32 v166, v28, v29
  v_cvt_pk_bf16_f32 v167, v30, v31
  s_waitcnt vmcnt(12)
  ds_read_b128 v[72:75], v68 offset:512
  ds_read_b64_tr_b16 a[168:169], v67 offset:0
  ds_read_b64_tr_b16 a[170:171], v67 offset:768
  ds_read_b64_tr_b16 a[172:173], v67 offset:8
  ds_read_b64_tr_b16 a[174:175], v67 offset:776
  ds_read_b64_tr_b16 a[176:177], v67 offset:64
  ds_read_b64_tr_b16 a[178:179], v67 offset:832
  ds_read_b64_tr_b16 a[180:181], v67 offset:72
  ds_read_b64_tr_b16 a[182:183], v67 offset:840
  ds_read_b64_tr_b16 a[184:185], v67 offset:128
  ds_read_b64_tr_b16 a[186:187], v67 offset:896
  ds_read_b64_tr_b16 a[188:189], v67 offset:136
  ds_read_b64_tr_b16 a[190:191], v67 offset:904
  s_waitcnt lgkmcnt(13)
  v_and_b32 v76, v69, v76
  v_and_b32 v77, v70, v77
  v_and_b32 v78, v69, v78
  v_and_b32 v79, v70, v79
  s_add_u32 m0, s49, 122880
  s_add_u32 s50, s44, s48
  buffer_load_dwordx4 v64, s[12:15], s50 offen offset:0 lds
  buffer_load_dwordx4 v65, s[12:15], s50 offen offset:1024 lds
  buffer_load_dwordx4 v66, s[12:15], s50 offen offset:2048 lds
  s_add_u32 m0, s49, 125952
  s_add_u32 s50, s50, 12288
  buffer_load_dwordx4 v64, s[12:15], s50 offen offset:0 lds
  buffer_load_dwordx4 v65, s[12:15], s50 offen offset:1024 lds
  buffer_load_dwordx4 v66, s[12:15], s50 offen offset:2048 lds
  v_mfma_f32_16x16x16_bf16 v[16:19], v[76:77], a[192:193], 0
  v_cvt_pk_bf16_f32 v168, v32, v33
  v_cvt_pk_bf16_f32 v169, v34, v35
  v_mfma_f32_16x16x16_bf16 v[20:23], v[78:79], a[194:195], 0
  v_cvt_pk_bf16_f32 v170, v36, v37
  v_cvt_pk_bf16_f32 v171, v38, v39
  v_mfma_f32_16x16x16_bf16 v[24:27], v[76:77], a[196:197], 0
  v_cvt_pk_bf16_f32 v172, v40, v41
  v_cvt_pk_bf16_f32 v173, v42, v43
  v_mfma_f32_16x16x16_bf16 v[28:31], v[78:79], a[198:199], 0
  v_cvt_pk_bf16_f32 v174, v44, v45
  v_cvt_pk_bf16_f32 v175, v46, v47
  v_mfma_f32_16x16x16_bf16 v[32:35], v[76:77], a[200:201], 0
  v_cvt_pk_bf16_f32 v176, v48, v49
  v_cvt_pk_bf16_f32 v177, v50, v51
  v_mfma_f32_16x16x16_bf16 v[36:39], v[78:79], a[202:203], 0
  v_cvt_pk_bf16_f32 v178, v52, v53
  v_cvt_pk_bf16_f32 v179, v54, v55
  v_mfma_f32_16x16x16_bf16 v[40:43], v[76:77], a[204:205], 0
  v_cvt_pk_bf16_f32 v180, v56, v57
  v_cvt_pk_bf16_f32 v181, v58, v59
  v_mfma_f32_16x16x16_bf16 v[44:47], v[78:79], a[206:207], 0
  v_cvt_pk_bf16_f32 v182, v60, v61
  v_cvt_pk_bf16_f32 v183, v62, v63
  v_mfma_f32_16x16x16_bf16 v[48:51], v[76:77], a[208:209], 0
  v_cvt_pk_bf16_f32 v16, v16, v17
  v_cvt_pk_bf16_f32 v17, v18, v19
  v_accvgpr_write_b32 a72, v16
  v_accvgpr_write_b32 a73, v17
  v_mfma_f32_16x16x16_bf16 v[52:55], v[78:79], a[210:211], 0
  v_cvt_pk_bf16_f32 v20, v20, v21
  v_cvt_pk_bf16_f32 v21, v22, v23
  v_accvgpr_write_b32 a74, v20
  v_accvgpr_write_b32 a75, v21
  v_mfma_f32_16x16x16_bf16 v[56:59], v[76:77], a[212:213], 0
  v_cvt_pk_bf16_f32 v24, v24, v25
  v_cvt_pk_bf16_f32 v25, v26, v27
  v_accvgpr_write_b32 a76, v24
  v_accvgpr_write_b32 a77, v25
  v_mfma_f32_16x16x16_bf16 v[60:63], v[78:79], a[214:215], 0
  v_cvt_pk_bf16_f32 v28, v28, v29
  v_cvt_pk_bf16_f32 v29, v30, v31
  v_accvgpr_write_b32 a78, v28
  v_accvgpr_write_b32 a79, v29
  s_waitcnt vmcnt(12)
  ds_read_b128 v[76:79], v68 offset:576
  ds_read_b64_tr_b16 a[192:193], v67 offset:24576
  ds_read_b64_tr_b16 a[194:195], v67 offset:25344
  ds_read_b64_tr_b16 a[196:197], v67 offset:24584
  ds_read_b64_tr_b16 a[198:199], v67 offset:25352
  ds_read_b64_tr_b16 a[200:201], v67 offset:24640
  ds_read_b64_tr_b16 a[202:203], v67 offset:25408
  ds_read_b64_tr_b16 a[204:205], v67 offset:24648
  ds_read_b64_tr_b16 a[206:207], v67 offset:25416
  ds_read_b64_tr_b16 a[208:209], v67 offset:24704
  ds_read_b64_tr_b16 a[210:211], v67 offset:25472
  ds_read_b64_tr_b16 a[212:213], v67 offset:24712
  ds_read_b64_tr_b16 a[214:215], v67 offset:25480
  s_waitcnt lgkmcnt(13)
  v_and_b32 v72, v69, v72
  v_and_b32 v73, v70, v73
  v_and_b32 v74, v69, v74
  v_and_b32 v75, v70, v75
  s_min_u32 s36, s38, s40
  s_add_u32 s37, s36, 12288
  s_min_u32 s37, s37, s40
  s_add_u32 s38, s38, 6291456
  s_add_u32 m0, s39, 0
  s_nop 0
  buffer_load_dwordx4 v10, s[4:7], s36 offen nt lds
  s_add_u32 m0, s39, 4096
  s_nop 0
  buffer_load_dwordx4 v11, s[4:7], s36 offen nt lds
  s_add_u32 m0, s39, 8192
  s_nop 0
  buffer_load_dwordx4 v12, s[4:7], s36 offen nt lds
  s_add_u32 m0, s39, 12288
  s_nop 0
  buffer_load_dwordx4 v10, s[4:7], s37 offen nt lds
  s_add_u32 m0, s39, 16384
  s_nop 0
  buffer_load_dwordx4 v11, s[4:7], s37 offen nt lds
  s_add_u32 m0, s39, 20480
  s_nop 0
  buffer_load_dwordx4 v12, s[4:7], s37 offen nt lds
  v_mfma_f32_16x16x16_bf16 v[16:19], v[72:73], a[168:169], 0
  v_cvt_pk_bf16_f32 v32, v32, v33
  v_cvt_pk_bf16_f32 v33, v34, v35
  v_accvgpr_write_b32 a80, v32
  v_accvgpr_write_b32 a81, v33
  v_mfma_f32_16x16x16_bf16 v[20:23], v[74:75], a[170:171], 0
  v_cvt_pk_bf16_f32 v36, v36, v37
  v_cvt_pk_bf16_f32 v37, v38, v39
  v_accvgpr_write_b32 a82, v36
  v_accvgpr_write_b32 a83, v37
  v_mfma_f32_16x16x16_bf16 v[24:27], v[72:73], a[172:173], 0
  v_cvt_pk_bf16_f32 v40, v40, v41
  v_cvt_pk_bf16_f32 v41, v42, v43
  v_accvgpr_write_b32 a84, v40
  v_accvgpr_write_b32 a85, v41
  v_mfma_f32_16x16x16_bf16 v[28:31], v[74:75], a[174:175], 0
  v_cvt_pk_bf16_f32 v44, v44, v45
  v_cvt_pk_bf16_f32 v45, v46, v47
  v_accvgpr_write_b32 a86, v44
  v_accvgpr_write_b32 a87, v45
  v_mfma_f32_16x16x16_bf16 v[32:35], v[72:73], a[176:177], 0
  v_cvt_pk_bf16_f32 v48, v48, v49
  v_cvt_pk_bf16_f32 v49, v50, v51
  v_accvgpr_write_b32 a88, v48
  v_accvgpr_write_b32 a89, v49
  v_mfma_f32_16x16x16_bf16 v[36:39], v[74:75], a[178:179], 0
  v_cvt_pk_bf16_f32 v52, v52, v53
  v_cvt_pk_bf16_f32 v53, v54, v55
  v_accvgpr_write_b32 a90, v52
  v_accvgpr_write_b32 a91, v53
  v_mfma_f32_16x16x16_bf16 v[40:43], v[72:73], a[180:181], 0
  v_cvt_pk_bf16_f32 v56, v56, v57
  v_cvt_pk_bf16_f32 v57, v58, v59
  v_accvgpr_write_b32 a92, v56
  v_accvgpr_write_b32 a93, v57
  v_mfma_f32_16x16x16_bf16 v[44:47], v[74:75], a[182:183], 0
  v_cvt_pk_bf16_f32 v60, v60, v61
  v_cvt_pk_bf16_f32 v61, v62, v63
  v_accvgpr_write_b32 a94, v60
  v_accvgpr_write_b32 a95, v61
  v_mfma_f32_16x16x16_bf16 v[48:51], v[72:73], a[184:185], 0
  v_cvt_pk_bf16_f32 v184, v16, v17
  v_cvt_pk_bf16_f32 v185, v18, v19
  v_mfma_f32_16x16x16_bf16 v[52:55], v[74:75], a[186:187], 0
  v_cvt_pk_bf16_f32 v186, v20, v21
  v_cvt_pk_bf16_f32 v187, v22, v23
  v_mfma_f32_16x16x16_bf16 v[56:59], v[72:73], a[188:189], 0
  v_cvt_pk_bf16_f32 v188, v24, v25
  v_cvt_pk_bf16_f32 v189, v26, v27
  v_mfma_f32_16x16x16_bf16 v[60:63], v[74:75], a[190:191], 0
  v_cvt_pk_bf16_f32 v190, v28, v29
  v_cvt_pk_bf16_f32 v191, v30, v31
  s_waitcnt vmcnt(12)
  ds_read_b128 v[72:75], v68 offset:640
  ds_read_b64_tr_b16 a[168:169], v86 offset:0
  ds_read_b64_tr_b16 a[170:171], v86 offset:768
  ds_read_b64_tr_b16 a[172:173], v86 offset:8
  ds_read_b64_tr_b16 a[174:175], v86 offset:776
  ds_read_b64_tr_b16 a[176:177], v86 offset:64
  ds_read_b64_tr_b16 a[178:179], v86 offset:832
  ds_read_b64_tr_b16 a[180:181], v86 offset:72
  ds_read_b64_tr_b16 a[182:183], v86 offset:840
  ds_read_b64_tr_b16 a[184:185], v86 offset:128
  ds_read_b64_tr_b16 a[186:187], v86 offset:896
  ds_read_b64_tr_b16 a[188:189], v86 offset:136
  ds_read_b64_tr_b16 a[190:191], v86 offset:904
  s_waitcnt lgkmcnt(13)
  v_and_b32 v76, v69, v76
  v_and_b32 v77, v70, v77
  v_and_b32 v78, v69, v78
  v_and_b32 v79, v70, v79
  s_min_u32 s36, s38, s40
  s_add_u32 s37, s36, 12288
  s_min_u32 s37, s37, s40
  s_add_u32 s38, s38, 6291456
  s_add_u32 m0, s39, 24576
  s_nop 0
  buffer_load_dwordx4 v10, s[4:7], s36 offen nt lds
  s_add_u32 m0, s39, 28672
  s_nop 0
  buffer_load_dwordx4 v11, s[4:7], s36 offen nt lds
  s_add_u32 m0, s39, 32768
  s_nop 0
  buffer_load_dwordx4 v12, s[4:7], s36 offen nt lds
  s_add_u32 m0, s39, 36864
  s_nop 0
  buffer_load_dwordx4 v10, s[4:7], s37 offen nt lds
  s_add_u32 m0, s39, 40960
  s_nop 0
  buffer_load_dwordx4 v11, s[4:7], s37 offen nt lds
  s_add_u32 m0, s39, 45056
  s_xor_b32 s39, s39, 49152
  buffer_load_dwordx4 v12, s[4:7], s37 offen nt lds
  v_mfma_f32_16x16x16_bf16 v[16:19], v[76:77], a[192:193], 0
  v_cvt_pk_bf16_f32 v192, v32, v33
  v_cvt_pk_bf16_f32 v193, v34, v35
  v_mfma_f32_16x16x16_bf16 v[20:23], v[78:79], a[194:195], 0
  v_cvt_pk_bf16_f32 v194, v36, v37
  v_cvt_pk_bf16_f32 v195, v38, v39
  v_mfma_f32_16x16x16_bf16 v[24:27], v[76:77], a[196:197], 0
  v_cvt_pk_bf16_f32 v196, v40, v41
  v_cvt_pk_bf16_f32 v197, v42, v43
  v_mfma_f32_16x16x16_bf16 v[28:31], v[78:79], a[198:199], 0
  v_cvt_pk_bf16_f32 v198, v44, v45
  v_cvt_pk_bf16_f32 v199, v46, v47
  v_mfma_f32_16x16x16_bf16 v[32:35], v[76:77], a[200:201], 0
  v_cvt_pk_bf16_f32 v200, v48, v49
  v_cvt_pk_bf16_f32 v201, v50, v51
  v_mfma_f32_16x16x16_bf16 v[36:39], v[78:79], a[202:203], 0
  v_cvt_pk_bf16_f32 v202, v52, v53
  v_cvt_pk_bf16_f32 v203, v54, v55
  v_mfma_f32_16x16x16_bf16 v[40:43], v[76:77], a[204:205], 0
  v_cvt_pk_bf16_f32 v204, v56, v57
  v_cvt_pk_bf16_f32 v205, v58, v59
  v_mfma_f32_16x16x16_bf16 v[44:47], v[78:79], a[206:207], 0
  v_cvt_pk_bf16_f32 v206, v60, v61
  v_cvt_pk_bf16_f32 v207, v62, v63
  v_mfma_f32_16x16x16_bf16 v[48:51], v[76:77], a[208:209], 0
  v_cvt_pk_bf16_f32 v16, v16, v17
  v_cvt_pk_bf16_f32 v17, v18, v19
  v_accvgpr_write_b32 a96, v16
  v_accvgpr_write_b32 a97, v17
  v_mfma_f32_16x16x16_bf16 v[52:55], v[78:79], a[210:211], 0
  v_cvt_pk_bf16_f32 v20, v20, v21
  v_cvt_pk_bf16_f32 v21, v22, v23
  v_accvgpr_write_b32 a98, v20
  v_accvgpr_write_b32 a99, v21
  v_mfma_f32_16x16x16_bf16 v[56:59], v[76:77], a[212:213], 0
  v_cvt_pk_bf16_f32 v24, v24, v25
  v_cvt_pk_bf16_f32 v25, v26, v27
  v_accvgpr_write_b32 a100, v24
  v_accvgpr_write_b32 a101, v25
  v_mfma_f32_16x16x16_bf16 v[60:63], v[78:79], a[214:215], 0
  v_cvt_pk_bf16_f32 v28, v28, v29
  v_cvt_pk_bf16_f32 v29, v30, v31
  v_accvgpr_write_b32 a102, v28
  v_accvgpr_write_b32 a103, v29
  s_waitcnt vmcnt(12)
  ds_read_b128 v[76:79], v68 offset:704
  ds_read_b64_tr_b16 a[192:193], v86 offset:24576
  ds_read_b64_tr_b16 a[194:195], v86 offset:25344
  ds_read_b64_tr_b16 a[196:197], v86 offset:24584
  ds_read_b64_tr_b16 a[198:199], v86 offset:25352
  ds_read_b64_tr_b16 a[200:201], v86 offset:24640
  ds_read_b64_tr_b16 a[202:203], v86 offset:25408
  ds_read_b64_tr_b16 a[204:205], v86 offset:24648
  ds_read_b64_tr_b16 a[206:207], v86 offset:25416
  ds_read_b64_tr_b16 a[208:209], v86 offset:24704
  ds_read_b64_tr_b16 a[210:211], v86 offset:25472
  ds_read_b64_tr_b16 a[212:213], v86 offset:24712
  ds_read_b64_tr_b16 a[214:215], v86 offset:25480
  s_waitcnt lgkmcnt(13)
  v_and_b32 v72, v69, v72
  v_and_b32 v73, v70, v73
  v_and_b32 v74, v69, v74
  v_and_b32 v75, v70, v75
  s_nop 1
  v_mfma_f32_16x16x16_bf16 v[16:19], v[72:73], a[168:169], 0
  v_cvt_pk_bf16_f32 v32, v32, v33
  v_cvt_pk_bf16_f32 v33, v34, v35
  v_accvgpr_write_b32 a104, v32
  v_accvgpr_write_b32 a105, v33
  v_mfma_f32_16x16x16_bf16 v[20:23], v[74:75], a[170:171], 0
  v_cvt_pk_bf16_f32 v36, v36, v37
  v_cvt_pk_bf16_f32 v37, v38, v39
  v_accvgpr_write_b32 a106, v36
  v_accvgpr_write_b32 a107, v37
  v_mfma_f32_16x16x16_bf16 v[24:27], v[72:73], a[172:173], 0
  v_cvt_pk_bf16_f32 v40, v40, v41
  v_cvt_pk_bf16_f32 v41, v42, v43
  v_accvgpr_write_b32 a108, v40
  v_accvgpr_write_b32 a109, v41
  v_mfma_f32_16x16x16_bf16 v[28:31], v[74:75], a[174:175], 0
  v_cvt_pk_bf16_f32 v44, v44, v45
  v_cvt_pk_bf16_f32 v45, v46, v47
  v_accvgpr_write_b32 a110, v44
  v_accvgpr_write_b32 a111, v45
  v_mfma_f32_16x16x16_bf16 v[32:35], v[72:73], a[176:177], 0
  v_cvt_pk_bf16_f32 v48, v48, v49
  v_cvt_pk_bf16_f32 v49, v50, v51
  v_accvgpr_write_b32 a112, v48
  v_accvgpr_write_b32 a113, v49
  v_mfma_f32_16x16x16_bf16 v[36:39], v[74:75], a[178:179], 0
  v_cvt_pk_bf16_f32 v52, v52, v53
  v_cvt_pk_bf16_f32 v53, v54, v55
  v_accvgpr_write_b32 a114, v52
  v_accvgpr_write_b32 a115, v53
  v_mfma_f32_16x16x16_bf16 v[40:43], v[72:73], a[180:181], 0
  v_cvt_pk_bf16_f32 v56, v56, v57
  v_cvt_pk_bf16_f32 v57, v58, v59
  v_accvgpr_write_b32 a116, v56
  v_accvgpr_write_b32 a117, v57
  v_mfma_f32_16x16x16_bf16 v[44:47], v[74:75], a[182:183], 0
  v_cvt_pk_bf16_f32 v60, v60, v61
  v_cvt_pk_bf16_f32 v61, v62, v63
  v_accvgpr_write_b32 a118, v60
  v_accvgpr_write_b32 a119, v61
  v_mfma_f32_16x16x16_bf16 v[48:51], v[72:73], a[184:185], 0
  v_cvt_pk_bf16_f32 v208, v16, v17
  v_cvt_pk_bf16_f32 v209, v18, v19
  v_mfma_f32_16x16x16_bf16 v[52:55], v[74:75], a[186:187], 0
  v_cvt_pk_bf16_f32 v210, v20, v21
  v_cvt_pk_bf16_f32 v211, v22, v23
  v_mfma_f32_16x16x16_bf16 v[56:59], v[72:73], a[188:189], 0
  v_cvt_pk_bf16_f32 v212, v24, v25
  v_cvt_pk_bf16_f32 v213, v26, v27
  v_mfma_f32_16x16x16_bf16 v[60:63], v[74:75], a[190:191], 0
  v_cvt_pk_bf16_f32 v214, v28, v29
  v_cvt_pk_bf16_f32 v215, v30, v31
  s_waitcnt lgkmcnt(0)
  v_and_b32 v76, v69, v76
  v_and_b32 v77, v70, v77
  v_and_b32 v78, v69, v78
  v_and_b32 v79, v70, v79
  s_nop 1
  v_mfma_f32_16x16x16_bf16 v[16:19], v[76:77], a[192:193], 0
  v_cvt_pk_bf16_f32 v216, v32, v33
  v_cvt_pk_bf16_f32 v217, v34, v35
  v_mfma_f32_16x16x16_bf16 v[20:23], v[78:79], a[194:195], 0
  v_cvt_pk_bf16_f32 v218, v36, v37
  v_cvt_pk_bf16_f32 v219, v38, v39
  v_mfma_f32_16x16x16_bf16 v[24:27], v[76:77], a[196:197], 0
  v_cvt_pk_bf16_f32 v220, v40, v41
  v_cvt_pk_bf16_f32 v221, v42, v43
  v_mfma_f32_16x16x16_bf16 v[28:31], v[78:79], a[198:199], 0
  v_cvt_pk_bf16_f32 v222, v44, v45
  v_cvt_pk_bf16_f32 v223, v46, v47
  v_mfma_f32_16x16x16_bf16 v[32:35], v[76:77], a[200:201], 0
  v_cvt_pk_bf16_f32 v224, v48, v49
  v_cvt_pk_bf16_f32 v225, v50, v51
  v_mfma_f32_16x16x16_bf16 v[36:39], v[78:79], a[202:203], 0
  v_cvt_pk_bf16_f32 v226, v52, v53
  v_cvt_pk_bf16_f32 v227, v54, v55
  v_mfma_f32_16x16x16_bf16 v[40:43], v[76:77], a[204:205], 0
  v_cvt_pk_bf16_f32 v228, v56, v57
  v_cvt_pk_bf16_f32 v229, v58, v59
  v_mfma_f32_16x16x16_bf16 v[44:47], v[78:79], a[206:207], 0
  v_cvt_pk_bf16_f32 v230, v60, v61
  v_cvt_pk_bf16_f32 v231, v62, v63
  v_mfma_f32_16x16x16_bf16 v[48:51], v[76:77], a[208:209], 0
  v_cvt_pk_bf16_f32 v232, v16, v17
  v_cvt_pk_bf16_f32 v233, v18, v19
  v_mfma_f32_16x16x16_bf16 v[52:55], v[78:79], a[210:211], 0
  v_cvt_pk_bf16_f32 v234, v20, v21
  v_cvt_pk_bf16_f32 v235, v22, v23
  v_mfma_f32_16x16x16_bf16 v[56:59], v[76:77], a[212:213], 0
  v_cvt_pk_bf16_f32 v236, v24, v25
  v_cvt_pk_bf16_f32 v237, v26, v27
  v_mfma_f32_16x16x16_bf16 v[60:63], v[78:79], a[214:215], 0
  v_cvt_pk_bf16_f32 v238, v28, v29
  v_cvt_pk_bf16_f32 v239, v30, v31
  v_cvt_pk_bf16_f32 v240, v32, v33
  v_cvt_pk_bf16_f32 v241, v34, v35
  v_cvt_pk_bf16_f32 v242, v36, v37
  v_cvt_pk_bf16_f32 v243, v38, v39
  v_cvt_pk_bf16_f32 v244, v40, v41
  v_cvt_pk_bf16_f32 v245, v42, v43
  v_cvt_pk_bf16_f32 v246, v44, v45
  v_cvt_pk_bf16_f32 v247, v46, v47
  s_waitcnt vmcnt(6)
  s_barrier
  ds_read_b128 a[120:123], v1 offset:0
  ds_read_b128 a[124:127], v2 offset:0
  ds_read_b128 a[128:131], v3 offset:0
  ds_read_b128 a[132:135], v4 offset:0
  v_cvt_pk_bf16_f32 v248, v48, v49
  v_cvt_pk_bf16_f32 v249, v50, v51
  v_cvt_pk_bf16_f32 v250, v52, v53
  v_cvt_pk_bf16_f32 v251, v54, v55
  v_cvt_pk_bf16_f32 v252, v56, v57
  v_cvt_pk_bf16_f32 v253, v58, v59
  v_cvt_pk_bf16_f32 v254, v60, v61
  v_cvt_pk_bf16_f32 v255, v62, v63
  s_mov_b32 s21, 9
L_loop:
  s_waitcnt lgkmcnt(2)
  v_mfma_f32_16x16x32_bf16 v[16:19], v[88:91], a[120:123], 0
  ds_read_b128 a[136:139], v1 offset:256
  v_mfma_f32_16x16x32_bf16 v[16:19], a[0:3], a[124:127], v[16:19]
  ds_read_b128 a[140:143], v2 offset:256
  v_mfma_f32_16x16x32_bf16 v[20:23], v[92:95], a[120:123], 0
  ds_read_b128 a[160:163], v8 offset:36864
  s_min_u32 s36, s38, s40
  v_mfma_f32_16x16x32_bf16 v[20:23], a[4:7], a[124:127], v[20:23]
  s_add_u32 s37, s36, 12288
  v_cvt_pk_bf16_f32 v40, v40, v41
  v_mfma_f32_16x16x32_bf16 v[24:27], v[96:99], a[120:123], 0
  s_min_u32 s37, s37, s40
  v_cvt_pk_bf16_f32 v41, v42, v43
  v_mfma_f32_16x16x32_bf16 v[24:27], a[8:11], a[124:127], v[24:27]
  s_add_u32 s38, s38, 6291456
  v_cvt_pk_bf16_f32 v42, v44, v45
  v_mfma_f32_16x16x32_bf16 v[28:31], v[100:103], a[120:123], 0
  s_add_u32 m0, s39, 0
  v_cvt_pk_bf16_f32 v43, v46, v47
  v_mfma_f32_16x16x32_bf16 v[28:31], a[12:15], a[124:127], v[28:31]
  ds_write_b128 v5, v[40:43] offset:12288
  v_mfma_f32_16x16x32_bf16 v[32:35], v[104:107], a[120:123], 0
  buffer_load_dwordx4 v10, s[4:7], s36 offen nt lds
  v_mfma_f32_16x16x32_bf16 v[32:35], a[16:19], a[124:127], v[32:35]
  v_mfma_f32_16x16x32_bf16 v[36:39], v[108:111], a[120:123], 0
  v_mfma_f32_16x16x32_bf16 v[36:39], a[20:23], a[124:127], v[36:39]
  s_waitcnt lgkmcnt(1)
  buffer_store_dwordx4 a[160:163], v14, s[8:11], s35 offen sc1
  s_waitcnt lgkmcnt(4)
  v_mfma_f32_16x16x32_bf16 v[16:19], v[112:115], a[128:131], v[16:19]
  ds_read_b128 a[120:123], v3 offset:256
  v_mfma_f32_16x16x32_bf16 v[16:19], a[24:27], a[132:135], v[16:19]
  ds_read_b128 a[124:127], v4 offset:256
  v_mfma_f32_16x16x32_bf16 v[20:23], v[116:119], a[128:131], v[20:23]
  v_mfma_f32_16x16x32_bf16 v[20:23], a[28:31], a[132:135], v[20:23]
  v_cvt_pk_bf16_f32 v48, v48, v49
  v_mfma_f32_16x16x32_bf16 v[24:27], v[120:123], a[128:131], v[24:27]
  v_cvt_pk_bf16_f32 v49, v50, v51
  v_mfma_f32_16x16x32_bf16 v[24:27], a[32:35], a[132:135], v[24:27]
  v_cvt_pk_bf16_f32 v50, v52, v53
  v_mfma_f32_16x16x32_bf16 v[28:31], v[124:127], a[128:131], v[28:31]
  v_cvt_pk_bf16_f32 v51, v54, v55
  v_mfma_f32_16x16x32_bf16 v[28:31], a[36:39], a[132:135], v[28:31]
  ds_write_b128 v6, v[48:51] offset:12288
  v_mfma_f32_16x16x32_bf16 v[32:35], v[128:131], a[128:131], v[32:35]
  v_mfma_f32_16x16x32_bf16 v[32:35], a[40:43], a[132:135], v[32:35]
  v_mfma_f32_16x16x32_bf16 v[36:39], v[132:135], a[128:131], v[36:39]
  v_mfma_f32_16x16x32_bf16 v[36:39], a[44:47], a[132:135], v[36:39]
  s_waitcnt lgkmcnt(5)
  v_mfma_f32_16x16x32_bf16 v[16:19], v[136:139], a[136:139], v[16:19]
  ds_read_b128 a[128:131], v1 offset:512
  s_add_u32 m0, s39, 4096
  v_mfma_f32_16x16x32_bf16 v[16:19], a[48:51], a[140:143], v[16:19]
  ds_read_b128 a[132:135], v2 offset:512
  v_mfma_f32_16x16x32_bf16 v[20:23], v[140:143], a[136:139], v[20:23]
  ds_read_b128 a[164:167], v9 offset:36864
  buffer_load_dwordx4 v11, s[4:7], s36 offen nt lds
  v_mfma_f32_16x16x32_bf16 v[20:23], a[52:55], a[140:143], v[20:23]
  v_cvt_pk_bf16_f32 v56, v56, v57
  v_mfma_f32_16x16x32_bf16 v[24:27], v[144:147], a[136:139], v[24:27]
  v_cvt_pk_bf16_f32 v57, v58, v59
  v_mfma_f32_16x16x32_bf16 v[24:27], a[56:59], a[140:143], v[24:27]
  v_cvt_pk_bf16_f32 v58, v60, v61
  v_mfma_f32_16x16x32_bf16 v[28:31], v[148:151], a[136:139], v[28:31]
  v_cvt_pk_bf16_f32 v59, v62, v63
  v_mfma_f32_16x16x32_bf16 v[28:31], a[60:63], a[140:143], v[28:31]
  ds_write_b128 v5, v[56:59] offset:12416
  v_mfma_f32_16x16x32_bf16 v[32:35], v[152:155], a[136:139], v[32:35]
  v_mfma_f32_16x16x32_bf16 v[32:35], a[64:67], a[140:143], v[32:35]
  v_mfma_f32_16x16x32_bf16 v[36:39], v[156:159], a[136:139], v[36:39]
  v_mfma_f32_16x16x32_bf16 v[36:39], a[68:71], a[140:143], v[36:39]
  s_waitcnt lgkmcnt(1)
  buffer_store_dwordx4 a[164:167], v15, s[8:11], s35 offen sc1
  s_waitcnt lgkmcnt(5)
  v_mfma_f32_16x16x32_bf16 v[16:19], v[160:163], a[120:123], v[16:19]
  ds_read_b128 a[136:139], v3 offset:512
  v_mfma_f32_16x16x32_bf16 v[16:19], a[72:75], a[124:127], v[16:19]
  ds_read_b128 a[140:143], v4 offset:512
  v_mfma_f32_16x16x32_bf16 v[20:23], v[164:167], a[120:123], v[20:23]
  v_mfma_f32_16x16x32_bf16 v[20:23], a[76:79], a[124:127], v[20:23]
  v_mfma_f32_16x16x32_bf16 v[24:27], v[168:171], a[120:123], v[24:27]
  v_mfma_f32_16x16x32_bf16 v[24:27], a[80:83], a[124:127], v[24:27]
  v_mfma_f32_16x16x32_bf16 v[28:31], v[172:175], a[120:123], v[28:31]
  s_add_u32 m0, s39, 8192
  v_mfma_f32_16x16x32_bf16 v[28:31], a[84:87], a[124:127], v[28:31]
  v_mfma_f32_16x16x32_bf16 v[32:35], v[176:179], a[120:123], v[32:35]
  buffer_load_dwordx4 v12, s[4:7], s36 offen nt lds
  v_mfma_f32_16x16x32_bf16 v[32:35], a[88:91], a[124:127], v[32:35]
  v_mfma_f32_16x16x32_bf16 v[36:39], v[180:183], a[120:123], v[36:39]
  v_mfma_f32_16x16x32_bf16 v[36:39], a[92:95], a[124:127], v[36:39]
  s_waitcnt lgkmcnt(4)
  v_mfma_f32_16x16x32_bf16 v[16:19], v[184:187], a[128:131], v[16:19]
  ds_read_b128 a[120:123], v1 offset:12288
  v_mfma_f32_16x16x32_bf16 v[16:19], a[96:99], a[132:135], v[16:19]
  ds_read_b128 a[124:127], v2 offset:12288
  v_mfma_f32_16x16x32_bf16 v[20:23], v[188:191], a[128:131], v[20:23]
  ds_read_b128 a[144:147], v7 offset:24576
  v_mfma_f32_16x16x32_bf16 v[20:23], a[100:103], a[132:135], v[20:23]
  v_mfma_f32_16x16x32_bf16 v[24:27], v[192:195], a[128:131], v[24:27]
  v_mfma_f32_16x16x32_bf16 v[24:27], a[104:107], a[132:135], v[24:27]
  v_mfma_f32_16x16x32_bf16 v[28:31], v[196:199], a[128:131], v[28:31]
  v_mfma_f32_16x16x32_bf16 v[28:31], a[108:111], a[132:135], v[28:31]
  v_mfma_f32_16x16x32_bf16 v[32:35], v[200:203], a[128:131], v[32:35]
  v_mfma_f32_16x16x32_bf16 v[32:35], a[112:115], a[132:135], v[32:35]
  v_mfma_f32_16x16x32_bf16 v[36:39], v[204:207], a[128:131], v[36:39]
  v_mfma_f32_16x16x32_bf16 v[36:39], a[116:119], a[132:135], v[36:39]
  s_waitcnt lgkmcnt(0)
  buffer_store_dwordx4 a[144:147], v13, s[8:11], s34 offen sc1
  s_waitcnt lgkmcnt(3)
  v_mfma_f32_16x16x32_bf16 v[16:19], v[208:211], a[136:139], v[16:19]
  ds_read_b128 a[128:131], v3 offset:12288
  s_add_u32 m0, s39, 12288
  v_mfma_f32_16x16x32_bf16 v[16:19], v[232:235], a[140:143], v[16:19]
  ds_read_b128 a[132:135], v4 offset:12288
  v_mfma_f32_16x16x32_bf16 v[20:23], v[212:215], a[136:139], v[20:23]
  buffer_load_dwordx4 v10, s[4:7], s37 offen nt lds
  v_mfma_f32_16x16x32_bf16 v[20:23], v[236:239], a[140:143], v[20:23]
  v_mfma_f32_16x16x32_bf16 v[24:27], v[216:219], a[136:139], v[24:27]
  v_mfma_f32_16x16x32_bf16 v[24:27], v[240:243], a[140:143], v[24:27]
  v_mfma_f32_16x16x32_bf16 v[28:31], v[220:223], a[136:139], v[28:31]
  v_mfma_f32_16x16x32_bf16 v[28:31], v[244:247], a[140:143], v[28:31]
  v_mfma_f32_16x16x32_bf16 v[32:35], v[224:227], a[136:139], v[32:35]
  v_mfma_f32_16x16x32_bf16 v[32:35], v[248:251], a[140:143], v[32:35]
  v_mfma_f32_16x16x32_bf16 v[36:39], v[228:231], a[136:139], v[36:39]
  v_mfma_f32_16x16x32_bf16 v[36:39], v[252:255], a[140:143], v[36:39]
  s_waitcnt lgkmcnt(3)
  v_mfma_f32_16x16x32_bf16 v[40:43], v[88:91], a[120:123], 0
  ds_read_b128 a[136:139], v1 offset:12544
  v_mfma_f32_16x16x32_bf16 v[40:43], a[0:3], a[124:127], v[40:43]
  ds_read_b128 a[140:143], v2 offset:12544
  v_mfma_f32_16x16x32_bf16 v[44:47], v[92:95], a[120:123], 0
  ds_read_b128 a[148:151], v8 offset:24576
  v_mfma_f32_16x16x32_bf16 v[44:47], a[4:7], a[124:127], v[44:47]
  v_cvt_pk_bf16_f32 v16, v16, v17
  v_mfma_f32_16x16x32_bf16 v[48:51], v[96:99], a[120:123], 0
  v_cvt_pk_bf16_f32 v17, v18, v19
  v_mfma_f32_16x16x32_bf16 v[48:51], a[8:11], a[124:127], v[48:51]
  v_cvt_pk_bf16_f32 v18, v20, v21
  v_mfma_f32_16x16x32_bf16 v[52:55], v[100:103], a[120:123], 0
  s_add_u32 m0, s39, 16384
  v_cvt_pk_bf16_f32 v19, v22, v23
  v_mfma_f32_16x16x32_bf16 v[52:55], a[12:15], a[124:127], v[52:55]
  ds_write_b128 v5, v[16:19] offset:0
  v_mfma_f32_16x16x32_bf16 v[56:59], v[104:107], a[120:123], 0
  buffer_load_dwordx4 v11, s[4:7], s37 offen nt lds
  v_mfma_f32_16x16x32_bf16 v[56:59], a[16:19], a[124:127], v[56:59]
  v_mfma_f32_16x16x32_bf16 v[60:63], v[108:111], a[120:123], 0
  v_mfma_f32_16x16x32_bf16 v[60:63], a[20:23], a[124:127], v[60:63]
  s_waitcnt lgkmcnt(1)
  buffer_store_dwordx4 a[148:151], v14, s[8:11], s34 offen sc1
  s_waitcnt lgkmcnt(4)
  v_mfma_f32_16x16x32_bf16 v[40:43], v[112:115], a[128:131], v[40:43]
  ds_read_b128 a[120:123], v3 offset:12544
  v_mfma_f32_16x16x32_bf16 v[40:43], a[24:27], a[132:135], v[40:43]
  ds_read_b128 a[124:127], v4 offset:12544
  v_mfma_f32_16x16x32_bf16 v[44:47], v[116:119], a[128:131], v[44:47]
  v_mfma_f32_16x16x32_bf16 v[44:47], a[28:31], a[132:135], v[44:47]
  v_cvt_pk_bf16_f32 v24, v24, v25
  v_mfma_f32_16x16x32_bf16 v[48:51], v[120:123], a[128:131], v[48:51]
  v_cvt_pk_bf16_f32 v25, v26, v27
  v_mfma_f32_16x16x32_bf16 v[48:51], a[32:35], a[132:135], v[48:51]
  v_cvt_pk_bf16_f32 v26, v28, v29
  v_mfma_f32_16x16x32_bf16 v[52:55], v[124:127], a[128:131], v[52:55]
  v_cvt_pk_bf16_f32 v27, v30, v31
  v_mfma_f32_16x16x32_bf16 v[52:55], a[36:39], a[132:135], v[52:55]
  ds_write_b128 v6, v[24:27] offset:0
  v_mfma_f32_16x16x32_bf16 v[56:59], v[128:131], a[128:131], v[56:59]
  v_mfma_f32_16x16x32_bf16 v[56:59], a[40:43], a[132:135], v[56:59]
  v_mfma_f32_16x16x32_bf16 v[60:63], v[132:135], a[128:131], v[60:63]
  v_mfma_f32_16x16x32_bf16 v[60:63], a[44:47], a[132:135], v[60:63]
  s_waitcnt lgkmcnt(5)
  v_mfma_f32_16x16x32_bf16 v[40:43], v[136:139], a[136:139], v[40:43]
  ds_read_b128 a[128:131], v1 offset:12800
  s_add_u32 m0, s39, 20480
  v_mfma_f32_16x16x32_bf16 v[40:43], a[48:51], a[140:143], v[40:43]
  ds_read_b128 a[132:135], v2 offset:12800
  v_mfma_f32_16x16x32_bf16 v[44:47], v[140:143], a[136:139], v[44:47]
  ds_read_b128 a[152:155], v9 offset:24576
  buffer_load_dwordx4 v12, s[4:7], s37 offen nt lds
  v_mfma_f32_16x16x32_bf16 v[44:47], a[52:55], a[140:143], v[44:47]
  v_cvt_pk_bf16_f32 v32, v32, v33
  v_mfma_f32_16x16x32_bf16 v[48:51], v[144:147], a[136:139], v[48:51]
  v_cvt_pk_bf16_f32 v33, v34, v35
  v_mfma_f32_16x16x32_bf16 v[48:51], a[56:59], a[140:143], v[48:51]
  v_cvt_pk_bf16_f32 v34, v36, v37
  v_mfma_f32_16x16x32_bf16 v[52:55], v[148:151], a[136:139], v[52:55]
  v_cvt_pk_bf16_f32 v35, v38, v39
  v_mfma_f32_16x16x32_bf16 v[52:55], a[60:63], a[140:143], v[52:55]
  ds_write_b128 v5, v[32:35] offset:128
  v_mfma_f32_16x16x32_bf16 v[56:59], v[152:155], a[136:139], v[56:59]
  v_mfma_f32_16x16x32_bf16 v[56:59], a[64:67], a[140:143], v[56:59]
  v_mfma_f32_16x16x32_bf16 v[60:63], v[156:159], a[136:139], v[60:63]
  v_mfma_f32_16x16x32_bf16 v[60:63], a[68:71], a[140:143], v[60:63]
  s_waitcnt lgkmcnt(1)
  buffer_store_dwordx4 a[152:155], v15, s[8:11], s34 offen sc1
  s_waitcnt lgkmcnt(5)
  v_mfma_f32_16x16x32_bf16 v[40:43], v[160:163], a[120:123], v[40:43]
  ds_read_b128 a[136:139], v3 offset:12800
  s_add_u32 s32, s32, 6291456
  v_mfma_f32_16x16x32_bf16 v[40:43], a[72:75], a[124:127], v[40:43]
  ds_read_b128 a[140:143], v4 offset:12800
  s_add_u32 s33, s33, 6291456
  v_mfma_f32_16x16x32_bf16 v[44:47], v[164:167], a[120:123], v[44:47]
  s_min_u32 s34, s32, s40
  v_mfma_f32_16x16x32_bf16 v[44:47], a[76:79], a[124:127], v[44:47]
  s_min_u32 s35, s33, s40
  v_mfma_f32_16x16x32_bf16 v[48:51], v[168:171], a[120:123], v[48:51]
  v_mfma_f32_16x16x32_bf16 v[48:51], a[80:83], a[124:127], v[48:51]
  v_mfma_f32_16x16x32_bf16 v[52:55], v[172:175], a[120:123], v[52:55]
  v_mfma_f32_16x16x32_bf16 v[52:55], a[84:87], a[124:127], v[52:55]
  v_mfma_f32_16x16x32_bf16 v[56:59], v[176:179], a[120:123], v[56:59]
  v_mfma_f32_16x16x32_bf16 v[56:59], a[88:91], a[124:127], v[56:59]
  v_mfma_f32_16x16x32_bf16 v[60:63], v[180:183], a[120:123], v[60:63]
  v_mfma_f32_16x16x32_bf16 v[60:63], a[92:95], a[124:127], v[60:63]
  s_waitcnt vmcnt(11) lgkmcnt(2)
  s_barrier
  s_waitcnt lgkmcnt(4)
  v_mfma_f32_16x16x32_bf16 v[40:43], v[184:187], a[128:131], v[40:43]
  ds_read_b128 a[120:123], v1 offset:24576
  v_mfma_f32_16x16x32_bf16 v[40:43], a[96:99], a[132:135], v[40:43]
  ds_read_b128 a[124:127], v2 offset:24576
  v_mfma_f32_16x16x32_bf16 v[44:47], v[188:191], a[128:131], v[44:47]
  ds_read_b128 a[156:159], v7 offset:12288
  v_mfma_f32_16x16x32_bf16 v[44:47], a[100:103], a[132:135], v[44:47]
  v_mfma_f32_16x16x32_bf16 v[48:51], v[192:195], a[128:131], v[48:51]
  v_mfma_f32_16x16x32_bf16 v[48:51], a[104:107], a[132:135], v[48:51]
  v_mfma_f32_16x16x32_bf16 v[52:55], v[196:199], a[128:131], v[52:55]
  v_mfma_f32_16x16x32_bf16 v[52:55], a[108:111], a[132:135], v[52:55]
  v_mfma_f32_16x16x32_bf16 v[56:59], v[200:203], a[128:131], v[56:59]
  v_mfma_f32_16x16x32_bf16 v[56:59], a[112:115], a[132:135], v[56:59]
  v_mfma_f32_16x16x32_bf16 v[60:63], v[204:207], a[128:131], v[60:63]
  v_mfma_f32_16x16x32_bf16 v[60:63], a[116:119], a[132:135], v[60:63]
  s_waitcnt lgkmcnt(0)
  buffer_store_dwordx4 a[156:159], v13, s[8:11], s35 offen sc1
  s_waitcnt lgkmcnt(3)
  v_mfma_f32_16x16x32_bf16 v[40:43], v[208:211], a[136:139], v[40:43]
  ds_read_b128 a[128:131], v3 offset:24576
  v_mfma_f32_16x16x32_bf16 v[40:43], v[232:235], a[140:143], v[40:43]
  ds_read_b128 a[132:135], v4 offset:24576
  v_mfma_f32_16x16x32_bf16 v[44:47], v[212:215], a[136:139], v[44:47]
  v_mfma_f32_16x16x32_bf16 v[44:47], v[236:239], a[140:143], v[44:47]
  v_mfma_f32_16x16x32_bf16 v[48:51], v[216:219], a[136:139], v[48:51]
  v_mfma_f32_16x16x32_bf16 v[48:51], v[240:243], a[140:143], v[48:51]
  v_mfma_f32_16x16x32_bf16 v[52:55], v[220:223], a[136:139], v[52:55]
  v_mfma_f32_16x16x32_bf16 v[52:55], v[244:247], a[140:143], v[52:55]
  v_mfma_f32_16x16x32_bf16 v[56:59], v[224:227], a[136:139], v[56:59]
  v_mfma_f32_16x16x32_bf16 v[56:59], v[248:251], a[140:143], v[56:59]
  v_mfma_f32_16x16x32_bf16 v[60:63], v[228:231], a[136:139], v[60:63]
  v_mfma_f32_16x16x32_bf16 v[60:63], v[252:255], a[140:143], v[60:63]
  s_waitcnt lgkmcnt(3)
  v_mfma_f32_16x16x32_bf16 v[16:19], v[88:91], a[120:123], 0
  ds_read_b128 a[136:139], v1 offset:24832
  v_mfma_f32_16x16x32_bf16 v[16:19], a[0:3], a[124:127], v[16:19]
  ds_read_b128 a[140:143], v2 offset:24832
  v_mfma_f32_16x16x32_bf16 v[20:23], v[92:95], a[120:123], 0
  ds_read_b128 a[160:163], v8 offset:12288
  s_min_u32 s36, s38, s40
  v_mfma_f32_16x16x32_bf16 v[20:23], a[4:7], a[124:127], v[20:23]
  s_add_u32 s37, s36, 12288
  v_cvt_pk_bf16_f32 v40, v40, v41
  v_mfma_f32_16x16x32_bf16 v[24:27], v[96:99], a[120:123], 0
  s_min_u32 s37, s37, s40
  v_cvt_pk_bf16_f32 v41, v42, v43
  v_mfma_f32_16x16x32_bf16 v[24:27], a[8:11], a[124:127], v[24:27]
  s_add_u32 s38, s38, 6291456
  v_cvt_pk_bf16_f32 v42, v44, v45
  v_mfma_f32_16x16x32_bf16 v[28:31], v[100:103], a[120:123], 0
  s_add_u32 m0, s39, 24576
  v_cvt_pk_bf16_f32 v43, v46, v47
  v_mfma_f32_16x16x32_bf16 v[28:31], a[12:15], a[124:127], v[28:31]
  ds_write_b128 v5, v[40:43] offset:36864
  v_mfma_f32_16x16x32_bf16 v[32:35], v[104:107], a[120:123], 0
  buffer_load_dwordx4 v10, s[4:7], s36 offen nt lds
  v_mfma_f32_16x16x32_bf16 v[32:35], a[16:19], a[124:127], v[32:35]
  v_mfma_f32_16x16x32_bf16 v[36:39], v[108:111], a[120:123], 0
  v_mfma_f32_16x16x32_bf16 v[36:39], a[20:23], a[124:127], v[36:39]
  s_waitcnt lgkmcnt(1)
  buffer_store_dwordx4 a[160:163], v14, s[8:11], s35 offen sc1
  s_waitcnt lgkmcnt(4)
  v_mfma_f32_16x16x32_bf16 v[16:19], v[112:115], a[128:131], v[16:19]
  ds_read_b128 a[120:123], v3 offset:24832
  v_mfma_f32_16x16x32_bf16 v[16:19], a[24:27], a[132:135], v[16:19]
  ds_read_b128 a[124:127], v4 offset:24832
  v_mfma_f32_16x16x32_bf16 v[20:23], v[116:119], a[128:131], v[20:23]
  v_mfma_f32_16x16x32_bf16 v[20:23], a[28:31], a[132:135], v[20:23]
  v_cvt_pk_bf16_f32 v48, v48, v49
  v_mfma_f32_16x16x32_bf16 v[24:27], v[120:123], a[128:131], v[24:27]
  v_cvt_pk_bf16_f32 v49, v50, v51
  v_mfma_f32_16x16x32_bf16 v[24:27], a[32:35], a[132:135], v[24:27]
  v_cvt_pk_bf16_f32 v50, v52, v53
  v_mfma_f32_16x16x32_bf16 v[28:31], v[124:127], a[128:131], v[28:31]
  v_cvt_pk_bf16_f32 v51, v54, v55
  v_mfma_f32_16x16x32_bf16 v[28:31], a[36:39], a[132:135], v[28:31]
  ds_write_b128 v6, v[48:51] offset:36864
  v_mfma_f32_16x16x32_bf16 v[32:35], v[128:131], a[128:131], v[32:35]
  v_mfma_f32_16x16x32_bf16 v[32:35], a[40:43], a[132:135], v[32:35]
  v_mfma_f32_16x16x32_bf16 v[36:39], v[132:135], a[128:131], v[36:39]
  v_mfma_f32_16x16x32_bf16 v[36:39], a[44:47], a[132:135], v[36:39]
  s_waitcnt lgkmcnt(5)
  v_mfma_f32_16x16x32_bf16 v[16:19], v[136:139], a[136:139], v[16:19]
  ds_read_b128 a[128:131], v1 offset:25088
  s_add_u32 m0, s39, 28672
  v_mfma_f32_16x16x32_bf16 v[16:19], a[48:51], a[140:143], v[16:19]
  ds_read_b128 a[132:135], v2 offset:25088
  v_mfma_f32_16x16x32_bf16 v[20:23], v[140:143], a[136:139], v[20:23]
  ds_read_b128 a[164:167], v9 offset:12288
  buffer_load_dwordx4 v11, s[4:7], s36 offen nt lds
  v_mfma_f32_16x16x32_bf16 v[20:23], a[52:55], a[140:143], v[20:23]
  v_cvt_pk_bf16_f32 v56, v56, v57
  v_mfma_f32_16x16x32_bf16 v[24:27], v[144:147], a[136:139], v[24:27]
  v_cvt_pk_bf16_f32 v57, v58, v59
  v_mfma_f32_16x16x32_bf16 v[24:27], a[56:59], a[140:143], v[24:27]
  v_cvt_pk_bf16_f32 v58, v60, v61
  v_mfma_f32_16x16x32_bf16 v[28:31], v[148:151], a[136:139], v[28:31]
  v_cvt_pk_bf16_f32 v59, v62, v63
  v_mfma_f32_16x16x32_bf16 v[28:31], a[60:63], a[140:143], v[28:31]
  ds_write_b128 v5, v[56:59] offset:36992
  v_mfma_f32_16x16x32_bf16 v[32:35], v[152:155], a[136:139], v[32:35]
  v_mfma_f32_16x16x32_bf16 v[32:35], a[64:67], a[140:143], v[32:35]
  v_mfma_f32_16x16x32_bf16 v[36:39], v[156:159], a[136:139], v[36:39]
  v_mfma_f32_16x16x32_bf16 v[36:39], a[68:71], a[140:143], v[36:39]
  s_waitcnt lgkmcnt(1)
  buffer_store_dwordx4 a[164:167], v15, s[8:11], s35 offen sc1
  s_waitcnt lgkmcnt(5)
  v_mfma_f32_16x16x32_bf16 v[16:19], v[160:163], a[120:123], v[16:19]
  ds_read_b128 a[136:139], v3 offset:25088
  v_mfma_f32_16x16x32_bf16 v[16:19], a[72:75], a[124:127], v[16:19]
  ds_read_b128 a[140:143], v4 offset:25088
  v_mfma_f32_16x16x32_bf16 v[20:23], v[164:167], a[120:123], v[20:23]
  v_mfma_f32_16x16x32_bf16 v[20:23], a[76:79], a[124:127], v[20:23]
  v_mfma_f32_16x16x32_bf16 v[24:27], v[168:171], a[120:123], v[24:27]
  v_mfma_f32_16x16x32_bf16 v[24:27], a[80:83], a[124:127], v[24:27]
  v_mfma_f32_16x16x32_bf16 v[28:31], v[172:175], a[120:123], v[28:31]
  s_add_u32 m0, s39, 32768
  v_mfma_f32_16x16x32_bf16 v[28:31], a[84:87], a[124:127], v[28:31]
  v_mfma_f32_16x16x32_bf16 v[32:35], v[176:179], a[120:123], v[32:35]
  buffer_load_dwordx4 v12, s[4:7], s36 offen nt lds
  v_mfma_f32_16x16x32_bf16 v[32:35], a[88:91], a[124:127], v[32:35]
  v_mfma_f32_16x16x32_bf16 v[36:39], v[180:183], a[120:123], v[36:39]
  v_mfma_f32_16x16x32_bf16 v[36:39], a[92:95], a[124:127], v[36:39]
  s_waitcnt lgkmcnt(4)
  v_mfma_f32_16x16x32_bf16 v[16:19], v[184:187], a[128:131], v[16:19]
  ds_read_b128 a[120:123], v1 offset:36864
  v_mfma_f32_16x16x32_bf16 v[16:19], a[96:99], a[132:135], v[16:19]
  ds_read_b128 a[124:127], v2 offset:36864
  v_mfma_f32_16x16x32_bf16 v[20:23], v[188:191], a[128:131], v[20:23]
  ds_read_b128 a[144:147], v7 offset:0
  v_mfma_f32_16x16x32_bf16 v[20:23], a[100:103], a[132:135], v[20:23]
  v_mfma_f32_16x16x32_bf16 v[24:27], v[192:195], a[128:131], v[24:27]
  v_mfma_f32_16x16x32_bf16 v[24:27], a[104:107], a[132:135], v[24:27]
  v_mfma_f32_16x16x32_bf16 v[28:31], v[196:199], a[128:131], v[28:31]
  v_mfma_f32_16x16x32_bf16 v[28:31], a[108:111], a[132:135], v[28:31]
  v_mfma_f32_16x16x32_bf16 v[32:35], v[200:203], a[128:131], v[32:35]
  v_mfma_f32_16x16x32_bf16 v[32:35], a[112:115], a[132:135], v[32:35]
  v_mfma_f32_16x16x32_bf16 v[36:39], v[204:207], a[128:131], v[36:39]
  v_mfma_f32_16x16x32_bf16 v[36:39], a[116:119], a[132:135], v[36:39]
  s_waitcnt lgkmcnt(0)
  buffer_store_dwordx4 a[144:147], v13, s[8:11], s34 offen sc1
  s_waitcnt lgkmcnt(3)
  v_mfma_f32_16x16x32_bf16 v[16:19], v[208:211], a[136:139], v[16:19]
  ds_read_b128 a[128:131], v3 offset:36864
  s_add_u32 m0, s39, 36864
  v_mfma_f32_16x16x32_bf16 v[16:19], v[232:235], a[140:143], v[16:19]
  ds_read_b128 a[132:135], v4 offset:36864
  v_mfma_f32_16x16x32_bf16 v[20:23], v[212:215], a[136:139], v[20:23]
  buffer_load_dwordx4 v10, s[4:7], s37 offen nt lds
  v_mfma_f32_16x16x32_bf16 v[20:23], v[236:239], a[140:143], v[20:23]
  v_mfma_f32_16x16x32_bf16 v[24:27], v[216:219], a[136:139], v[24:27]
  v_mfma_f32_16x16x32_bf16 v[24:27], v[240:243], a[140:143], v[24:27]
  v_mfma_f32_16x16x32_bf16 v[28:31], v[220:223], a[136:139], v[28:31]
  v_mfma_f32_16x16x32_bf16 v[28:31], v[244:247], a[140:143], v[28:31]
  v_mfma_f32_16x16x32_bf16 v[32:35], v[224:227], a[136:139], v[32:35]
  v_mfma_f32_16x16x32_bf16 v[32:35], v[248:251], a[140:143], v[32:35]
  v_mfma_f32_16x16x32_bf16 v[36:39], v[228:231], a[136:139], v[36:39]
  v_mfma_f32_16x16x32_bf16 v[36:39], v[252:255], a[140:143], v[36:39]
  s_waitcnt lgkmcnt(3)
  v_mfma_f32_16x16x32_bf16 v[40:43], v[88:91], a[120:123], 0
  ds_read_b128 a[136:139], v1 offset:37120
  v_mfma_f32_16x16x32_bf16 v[40:43], a[0:3], a[124:127], v[40:43]
  ds_read_b128 a[140:143], v2 offset:37120
  v_mfma_f32_16x16x32_bf16 v[44:47], v[92:95], a[120:123], 0
  ds_read_b128 a[148:151], v8 offset:0
  v_mfma_f32_16x16x32_bf16 v[44:47], a[4:7], a[124:127], v[44:47]
  v_cvt_pk_bf16_f32 v16, v16, v17
  v_mfma_f32_16x16x32_bf16 v[48:51], v[96:99], a[120:123], 0
  v_cvt_pk_bf16_f32 v17, v18, v19
  v_mfma_f32_16x16x32_bf16 v[48:51], a[8:11], a[124:127], v[48:51]
  v_cvt_pk_bf16_f32 v18, v20, v21
  v_mfma_f32_16x16x32_bf16 v[52:55], v[100:103], a[120:123], 0
  s_add_u32 m0, s39, 40960
  v_cvt_pk_bf16_f32 v19, v22, v23
  v_mfma_f32_16x16x32_bf16 v[52:55], a[12:15], a[124:127], v[52:55]
  ds_write_b128 v5, v[16:19] offset:24576
  v_mfma_f32_16x16x32_bf16 v[56:59], v[104:107], a[120:123], 0
  buffer_load_dwordx4 v11, s[4:7], s37 offen nt lds
  v_mfma_f32_16x16x32_bf16 v[56:59], a[16:19], a[124:127], v[56:59]
  v_mfma_f32_16x16x32_bf16 v[60:63], v[108:111], a[120:123], 0
  v_mfma_f32_16x16x32_bf16 v[60:63], a[20:23], a[124:127], v[60:63]
  s_waitcnt lgkmcnt(1)
  buffer_store_dwordx4 a[148:151], v14, s[8:11], s34 offen sc1
  s_waitcnt lgkmcnt(4)
  v_mfma_f32_16x16x32_bf16 v[40:43], v[112:115], a[128:131], v[40:43]
  ds_read_b128 a[120:123], v3 offset:37120
  v_mfma_f32_16x16x32_bf16 v[40:43], a[24:27], a[132:135], v[40:43]
  ds_read_b128 a[124:127], v4 offset:37120
  v_mfma_f32_16x16x32_bf16 v[44:47], v[116:119], a[128:131], v[44:47]
  v_mfma_f32_16x16x32_bf16 v[44:47], a[28:31], a[132:135], v[44:47]
  v_cvt_pk_bf16_f32 v24, v24, v25
  v_mfma_f32_16x16x32_bf16 v[48:51], v[120:123], a[128:131], v[48:51]
  v_cvt_pk_bf16_f32 v25, v26, v27
  v_mfma_f32_16x16x32_bf16 v[48:51], a[32:35], a[132:135], v[48:51]
  v_cvt_pk_bf16_f32 v26, v28, v29
  v_mfma_f32_16x16x32_bf16 v[52:55], v[124:127], a[128:131], v[52:55]
  v_cvt_pk_bf16_f32 v27, v30, v31
  v_mfma_f32_16x16x32_bf16 v[52:55], a[36:39], a[132:135], v[52:55]
  ds_write_b128 v6, v[24:27] offset:24576
  v_mfma_f32_16x16x32_bf16 v[56:59], v[128:131], a[128:131], v[56:59]
  v_mfma_f32_16x16x32_bf16 v[56:59], a[40:43], a[132:135], v[56:59]
  v_mfma_f32_16x16x32_bf16 v[60:63], v[132:135], a[128:131], v[60:63]
  v_mfma_f32_16x16x32_bf16 v[60:63], a[44:47], a[132:135], v[60:63]
  s_waitcnt lgkmcnt(5)
  v_mfma_f32_16x16x32_bf16 v[40:43], v[136:139], a[136:139], v[40:43]
  ds_read_b128 a[128:131], v1 offset:37376
  s_add_u32 m0, s39, 45056
  v_mfma_f32_16x16x32_bf16 v[40:43], a[48:51], a[140:143], v[40:43]
  ds_read_b128 a[132:135], v2 offset:37376
  s_xor_b32 s39, s39, 49152
  v_mfma_f32_16x16x32_bf16 v[44:47], v[140:143], a[136:139], v[44:47]
  ds_read_b128 a[152:155], v9 offset:0
  buffer_load_dwordx4 v12, s[4:7], s37 offen nt lds
  v_mfma_f32_16x16x32_bf16 v[44:47], a[52:55], a[140:143], v[44:47]
  v_cvt_pk_bf16_f32 v32, v32, v33
  v_mfma_f32_16x16x32_bf16 v[48:51], v[144:147], a[136:139], v[48:51]
  v_cvt_pk_bf16_f32 v33, v34, v35
  v_mfma_f32_16x16x32_bf16 v[48:51], a[56:59], a[140:143], v[48:51]
  v_cvt_pk_bf16_f32 v34, v36, v37
  v_mfma_f32_16x16x32_bf16 v[52:55], v[148:151], a[136:139], v[52:55]
  v_cvt_pk_bf16_f32 v35, v38, v39
  v_mfma_f32_16x16x32_bf16 v[52:55], a[60:63], a[140:143], v[52:55]
  ds_write_b128 v5, v[32:35] offset:24704
  v_mfma_f32_16x16x32_bf16 v[56:59], v[152:155], a[136:139], v[56:59]
  v_mfma_f32_16x16x32_bf16 v[56:59], a[64:67], a[140:143], v[56:59]
  v_mfma_f32_16x16x32_bf16 v[60:63], v[156:159], a[136:139], v[60:63]
  v_mfma_f32_16x16x32_bf16 v[60:63], a[68:71], a[140:143], v[60:63]
  s_waitcnt lgkmcnt(1)
  buffer_store_dwordx4 a[152:155], v15, s[8:11], s34 offen sc1
  s_waitcnt lgkmcnt(5)
  v_mfma_f32_16x16x32_bf16 v[40:43], v[160:163], a[120:123], v[40:43]
  ds_read_b128 a[136:139], v3 offset:37376
  s_add_u32 s32, s32, 6291456
  v_mfma_f32_16x16x32_bf16 v[40:43], a[72:75], a[124:127], v[40:43]
  ds_read_b128 a[140:143], v4 offset:37376
  s_add_u32 s33, s33, 6291456
  v_mfma_f32_16x16x32_bf16 v[44:47], v[164:167], a[120:123], v[44:47]
  s_min_u32 s34, s32, s40
  v_mfma_f32_16x16x32_bf16 v[44:47], a[76:79], a[124:127], v[44:47]
  s_min_u32 s35, s33, s40
  v_mfma_f32_16x16x32_bf16 v[48:51], v[168:171], a[120:123], v[48:51]
  v_mfma_f32_16x16x32_bf16 v[48:51], a[80:83], a[124:127], v[48:51]
  v_mfma_f32_16x16x32_bf16 v[52:55], v[172:175], a[120:123], v[52:55]
  v_mfma_f32_16x16x32_bf16 v[52:55], a[84:87], a[124:127], v[52:55]
  v_mfma_f32_16x16x32_bf16 v[56:59], v[176:179], a[120:123], v[56:59]
  v_mfma_f32_16x16x32_bf16 v[56:59], a[88:91], a[124:127], v[56:59]
  v_mfma_f32_16x16x32_bf16 v[60:63], v[180:183], a[120:123], v[60:63]
  v_mfma_f32_16x16x32_bf16 v[60:63], a[92:95], a[124:127], v[60:63]
  s_waitcnt vmcnt(13) lgkmcnt(2)
  s_barrier
  v_xor_b32 v1, 49152, v1
  v_xor_b32 v2, 49152, v2
  v_xor_b32 v3, 49152, v3
  v_xor_b32 v4, 49152, v4
  s_waitcnt lgkmcnt(4)
  v_mfma_f32_16x16x32_bf16 v[40:43], v[184:187], a[128:131], v[40:43]
  ds_read_b128 a[120:123], v1 offset:0
  v_mfma_f32_16x16x32_bf16 v[40:43], a[96:99], a[132:135], v[40:43]
  ds_read_b128 a[124:127], v2 offset:0
  v_mfma_f32_16x16x32_bf16 v[44:47], v[188:191], a[128:131], v[44:47]
  ds_read_b128 a[156:159], v7 offset:36864
  v_mfma_f32_16x16x32_bf16 v[44:47], a[100:103], a[132:135], v[44:47]
  v_mfma_f32_16x16x32_bf16 v[48:51], v[192:195], a[128:131], v[48:51]
  v_mfma_f32_16x16x32_bf16 v[48:51], a[104:107], a[132:135], v[48:51]
  v_mfma_f32_16x16x32_bf16 v[52:55], v[196:199], a[128:131], v[52:55]
  v_mfma_f32_16x16x32_bf16 v[52:55], a[108:111], a[132:135], v[52:55]
  v_mfma_f32_16x16x32_bf16 v[56:59], v[200:203], a[128:131], v[56:59]
  v_mfma_f32_16x16x32_bf16 v[56:59], a[112:115], a[132:135], v[56:59]
  v_mfma_f32_16x16x32_bf16 v[60:63], v[204:207], a[128:131], v[60:63]
  v_mfma_f32_16x16x32_bf16 v[60:63], a[116:119], a[132:135], v[60:63]
  s_waitcnt lgkmcnt(0)
  buffer_store_dwordx4 a[156:159], v13, s[8:11], s35 offen sc1
  s_waitcnt lgkmcnt(3)
  v_mfma_f32_16x16x32_bf16 v[40:43], v[208:211], a[136:139], v[40:43]
  ds_read_b128 a[128:131], v3 offset:0
  v_mfma_f32_16x16x32_bf16 v[40:43], v[232:235], a[140:143], v[40:43]
  ds_read_b128 a[132:135], v4 offset:0
  v_mfma_f32_16x16x32_bf16 v[44:47], v[212:215], a[136:139], v[44:47]
  v_mfma_f32_16x16x32_bf16 v[44:47], v[236:239], a[140:143], v[44:47]
  v_mfma_f32_16x16x32_bf16 v[48:51], v[216:219], a[136:139], v[48:51]
  v_mfma_f32_16x16x32_bf16 v[48:51], v[240:243], a[140:143], v[48:51]
  v_mfma_f32_16x16x32_bf16 v[52:55], v[220:223], a[136:139], v[52:55]
  v_mfma_f32_16x16x32_bf16 v[52:55], v[244:247], a[140:143], v[52:55]
  v_mfma_f32_16x16x32_bf16 v[56:59], v[224:227], a[136:139], v[56:59]
  v_mfma_f32_16x16x32_bf16 v[56:59], v[248:251], a[140:143], v[56:59]
  v_mfma_f32_16x16x32_bf16 v[60:63], v[228:231], a[136:139], v[60:63]
  v_mfma_f32_16x16x32_bf16 v[60:63], v[252:255], a[140:143], v[60:63]
  s_sub_u32 s21, s21, 1
  s_cmp_lg_u32 s21, 0
  s_cbranch_scc1 L_loop
L_tail:
  ds_read_b128 a[160:163], v8 offset:36864
  ds_read_b128 a[164:167], v9 offset:36864
  ds_read_b128 a[144:147], v7 offset:24576
  ds_read_b128 a[148:151], v8 offset:24576
  ds_read_b128 a[152:155], v9 offset:24576
  s_nop 3
  v_cvt_pk_bf16_f32 v40, v40, v41
  v_cvt_pk_bf16_f32 v41, v42, v43
  v_cvt_pk_bf16_f32 v42, v44, v45
  v_cvt_pk_bf16_f32 v43, v46, v47
  ds_write_b128 v5, v[40:43] offset:12288
  v_cvt_pk_bf16_f32 v48, v48, v49
  v_cvt_pk_bf16_f32 v49, v50, v51
  v_cvt_pk_bf16_f32 v50, v52, v53
  v_cvt_pk_bf16_f32 v51, v54, v55
  ds_write_b128 v6, v[48:51] offset:12288
  v_cvt_pk_bf16_f32 v56, v56, v57
  v_cvt_pk_bf16_f32 v57, v58, v59
  v_cvt_pk_bf16_f32 v58, v60, v61
  v_cvt_pk_bf16_f32 v59, v62, v63
  ds_write_b128 v5, v[56:59] offset:12416
  s_waitcnt lgkmcnt(7)
  buffer_store_dwordx4 a[160:163], v14, s[8:11], s35 offen sc1
  s_waitcnt lgkmcnt(6)
  buffer_store_dwordx4 a[164:167], v15, s[8:11], s35 offen sc1
  s_waitcnt lgkmcnt(5)
  buffer_store_dwordx4 a[144:147], v13, s[8:11], s34 offen sc1
  s_waitcnt lgkmcnt(4)
  buffer_store_dwordx4 a[148:151], v14, s[8:11], s34 offen sc1
  s_waitcnt lgkmcnt(3)
  buffer_store_dwordx4 a[152:155], v15, s[8:11], s34 offen sc1
  s_add_u32 s35, s34, 12288
  s_waitcnt lgkmcnt(0)
  s_barrier
  ds_read_b128 a[120:123], v7 offset:12288
  ds_read_b128 a[124:127], v8 offset:12288
  ds_read_b128 a[128:131], v9 offset:12288
  s_waitcnt lgkmcnt(2)
  buffer_store_dwordx4 a[120:123], v13, s[8:11], s35 offen sc1
  s_waitcnt lgkmcnt(1)
  buffer_store_dwordx4 a[124:127], v14, s[8:11], s35 offen sc1
  s_waitcnt lgkmcnt(0)
  buffer_store_dwordx4 a[128:131], v15, s[8:11], s35 offen sc1
L_done:
  s_endpgm
.section .rodata,"a"
.p2align 6
.amdhsa_kernel standalone__depthwise_separable__vision_kernel
  .amdhsa_next_free_vgpr 512
  .amdhsa_next_free_sgpr 100
  .amdhsa_accum_offset 256
  .amdhsa_group_segment_fixed_size 0
  .amdhsa_kernarg_size 48
  .amdhsa_user_sgpr_count 2
  .amdhsa_user_sgpr_kernarg_segment_ptr 1
  .amdhsa_system_sgpr_workgroup_id_x 1
  .amdhsa_float_denorm_mode_32 3
.end_amdhsa_kernel
```

```asm
; @launch grid=(256,1,1) block=(256,1,1) lds=151616
.amdgcn_target "amdgcn-amd-amdhsa--gfx950"
.text
.globl standalone__depthwise_separable__vision_kernel
.p2align 8
.type standalone__depthwise_separable__vision_kernel,@function
standalone__depthwise_separable__vision_kernel:
  s_load_dwordx8 s[24:31], s[0:1], 0
  s_load_dwordx2 s[92:93], s[0:1], 32
  s_cmp_ge_u32 s2, 256
  s_cbranch_scc1 L_done
  v_lshrrev_b32 v16, 6, v0
  v_and_b32 v28, 63, v0
  v_readfirstlane_b32 s20, v16
  s_getpc_b64 s[50:51]
L_pc:
  v_mul_u32_u24 v18, 64, v0
  v_min_u32 v18, L_done-L_pc, v18
  v_mov_b32 v19, s51
  v_add_co_u32 v18, vcc, s50, v18
  s_nop 1
  v_addc_co_u32 v19, vcc, 0, v19, vcc
  global_load_dword v88, v[18:19], off
  s_lshr_b32 s50, s2, 3
  s_and_b32 s55, s50, 3
  s_lshr_b32 s54, s50, 2
  s_mul_i32 s51, s54, 11
  s_lshr_b32 s51, s51, 5
  s_mul_i32 s51, s51, 3
  s_sub_u32 s54, s54, s51
  s_mul_i32 s52, s20, 192
  v_mul_u32_u24 v18, 0xaaab, v28
  v_lshrrev_b32 v18, 19, v18
  v_mul_u32_u24 v19, 576, v18
  v_lshl_add_u32 v19, v28, 4, v19
  v_add_u32 v64, s52, v19
  v_add_u32 v17, 64, v28
  v_mul_u32_u24 v18, 0xaaab, v17
  v_lshrrev_b32 v18, 19, v18
  v_mul_u32_u24 v19, 576, v18
  v_lshl_add_u32 v19, v28, 4, v19
  v_add_u32 v65, s52, v19
  v_add_u32 v17, 128, v28
  v_mul_u32_u24 v18, 0xaaab, v17
  v_lshrrev_b32 v18, 19, v18
  v_mul_u32_u24 v19, 576, v18
  v_lshl_add_u32 v19, v28, 4, v19
  v_add_u32 v66, s52, v19
  s_mul_i32 s42, s54, 98304
  s_add_u32 s43, s42, 98304
  s_cmp_eq_u32 s54, 2
  s_cselect_b32 s43, 0, s43
  s_add_u32 s44, s43, 98304
  s_cmp_eq_u32 s54, 1
  s_cselect_b32 s44, 0, s44
  s_xor_b32 s45, s55, 0
  s_mul_i32 s45, s45, 24576
  s_xor_b32 s46, s55, 1
  s_mul_i32 s46, s46, 24576
  s_xor_b32 s47, s55, 2
  s_mul_i32 s47, s47, 24576
  s_xor_b32 s48, s55, 3
  s_mul_i32 s48, s48, 24576
  s_mul_i32 s49, s20, 6144
  s_lshl_b32 s53, s55, 2
  v_lshrrev_b32 v17, 4, v28
  v_add_u32 v18, s54, v17
  v_subrev_u32 v19, 3, v18
  v_min_u32 v18, v18, v19
  v_and_b32 v20, 15, v28
  v_xor_b32 v19, s53, v20
  v_lshlrev_b32 v19, 4, v19
  v_lshl_add_u32 v19, v18, 8, v19
  v_cmp_lt_u32 vcc, 47, v28
  s_lshl_b32 s50, s20, 10
  s_add_u32 m0, s50, 147456
  v_cndmask_b32 v19, v19, v66, vcc
  s_lshr_b32 s51, s2, 5
  s_and_b32 s52, s2, 3
  s_lshl2_add_u32 s36, s51, s52
  s_lshl_b32 s36, s36, 2
  s_mul_i32 s51, s51, 288
  s_lshl2_add_u32 s52, s55, s52
  s_add_u32 s51, s51, s52
  s_mul_i32 s32, s51, 49152
  s_add_u32 s35, s32, 14155776
  s_lshl_b32 s51, s20, 11
  s_and_b32 s52, s2, 4
  s_lshl_b32 s52, s52, 6
  s_add_u32 s51, s51, s52
  s_add_u32 s37, s32, s51
  s_add_u32 s37, s37, 7077888
  s_add_u32 s38, s37, 8192
  s_and_b32 s23, s2, 28
  s_cmp_lg_u32 s23, 0
  s_waitcnt lgkmcnt(0)
  s_cbranch_scc1 L_np0
  s_load_dword s84, s[24:25], s37 glc
  s_load_dword s85, s[24:25], s38 glc
L_np0:
  s_mov_b32 s16, s26
  s_and_b32 s17, s27, 0xffff
  s_mov_b32 s18, 768
  s_mov_b32 s19, 0x00020000
  s_mov_b32 s12, s28
  s_and_b32 s13, s29, 0xffff
  s_mov_b32 s14, 294912
  s_mov_b32 s15, 0x00020000
  buffer_load_dwordx4 v19, s[16:19], 0 offen lds
  s_add_u32 m0, s49, 49152
  s_add_u32 s50, s42, s45
  buffer_load_dwordx4 v64, s[12:15], s50 offen offset:0 lds
  buffer_load_dwordx4 v65, s[12:15], s50 offen offset:1024 lds
  buffer_load_dwordx4 v66, s[12:15], s50 offen offset:2048 lds
  s_add_u32 m0, s49, 52224
  s_add_u32 s50, s50, 12288
  buffer_load_dwordx4 v64, s[12:15], s50 offen offset:0 lds
  buffer_load_dwordx4 v65, s[12:15], s50 offen offset:1024 lds
  buffer_load_dwordx4 v66, s[12:15], s50 offen offset:2048 lds
  s_add_u32 m0, s49, 73728
  s_add_u32 s50, s42, s46
  buffer_load_dwordx4 v64, s[12:15], s50 offen offset:0 lds
  buffer_load_dwordx4 v65, s[12:15], s50 offen offset:1024 lds
  buffer_load_dwordx4 v66, s[12:15], s50 offen offset:2048 lds
  s_add_u32 m0, s49, 76800
  s_add_u32 s50, s50, 12288
  buffer_load_dwordx4 v64, s[12:15], s50 offen offset:0 lds
  buffer_load_dwordx4 v65, s[12:15], s50 offen offset:1024 lds
  buffer_load_dwordx4 v66, s[12:15], s50 offen offset:2048 lds
  s_mov_b32 s4, s24
  s_and_b32 s5, s25, 0xffff
  s_mov_b32 s6, 113246208
  s_mov_b32 s7, 0x00020000
  s_mov_b32 s8, s30
  s_and_b32 s9, s31, 0xffff
  s_mov_b32 s10, 113246208
  s_mov_b32 s11, 0x00020000
  s_add_u32 s33, s24, 24576
  s_mov_b32 s40, 113246208
  s_lshl_b32 s39, s20, 10
  v_lshrrev_b32 v16, 4, v0
  v_mul_u32_u24 v18, 43, v16
  v_lshrrev_b32 v18, 7, v18
  v_mul_u32_u24 v19, 3, v18
  v_sub_u32 v19, v16, v19
  v_and_b32 v21, 7, v18
  v_xor_b32 v21, v21, v20
  v_lshlrev_b32 v21, 4, v21
  v_lshl_add_u32 v21, v16, 8, v21
  v_add_u32 v5, 98304, v21
  v_mul_u32_u24 v23, 0x300, v18
  v_lshlrev_b32 v21, 4, v20
  v_lshl_add_u32 v21, v19, 8, v21
  v_add_u32 v80, v23, v21
  v_add_u32 v19, s54, v19
  v_subrev_u32 v21, 3, v19
  v_min_u32 v19, v19, v21
  v_xor_b32 v21, v18, v20
  v_xor_b32 v21, s53, v21
  v_and_b32 v21, 15, v21
  v_lshlrev_b32 v21, 4, v21
  v_lshl_add_u32 v21, v19, 8, v21
  v_add_u32 v8, v23, v21
  v_lshrrev_b32 v16, 4, v0
  v_add_u32 v16, 16, v16
  v_mul_u32_u24 v18, 43, v16
  v_lshrrev_b32 v18, 7, v18
  v_mul_u32_u24 v19, 3, v18
  v_sub_u32 v19, v16, v19
  v_and_b32 v21, 7, v18
  v_xor_b32 v21, v21, v20
  v_lshlrev_b32 v21, 4, v21
  v_lshl_add_u32 v21, v16, 8, v21
  v_add_u32 v6, 98304, v21
  v_mul_u32_u24 v23, 0x300, v18
  v_lshlrev_b32 v21, 4, v20
  v_lshl_add_u32 v21, v19, 8, v21
  v_add_u32 v81, v23, v21
  v_add_u32 v19, s54, v19
  v_subrev_u32 v21, 3, v19
  v_min_u32 v19, v19, v21
  v_xor_b32 v21, v18, v20
  v_xor_b32 v21, s53, v21
  v_and_b32 v21, 15, v21
  v_lshlrev_b32 v21, 4, v21
  v_lshl_add_u32 v21, v19, 8, v21
  v_add_u32 v9, v23, v21
  v_lshrrev_b32 v16, 4, v0
  v_add_u32 v16, 32, v16
  v_mul_u32_u24 v18, 43, v16
  v_lshrrev_b32 v18, 7, v18
  v_mul_u32_u24 v19, 3, v18
  v_sub_u32 v19, v16, v19
  v_and_b32 v21, 7, v18
  v_xor_b32 v21, v21, v20
  v_lshlrev_b32 v21, 4, v21
  v_lshl_add_u32 v21, v16, 8, v21
  v_add_u32 v7, 98304, v21
  v_mul_u32_u24 v23, 0x300, v18
  v_cmp_lt_u32 vcc, 10, v18
  v_add_u32 v24, 7680, v23
  s_nop 0
  v_cndmask_b32 v23, v23, v24, vcc
  v_lshlrev_b32 v21, 4, v20
  v_lshl_add_u32 v21, v19, 8, v21
  v_add_u32 v82, v23, v21
  v_add_u32 v19, s54, v19
  v_subrev_u32 v21, 3, v19
  v_min_u32 v19, v19, v21
  v_xor_b32 v21, v18, v20
  v_xor_b32 v21, s53, v21
  v_and_b32 v21, 15, v21
  v_lshlrev_b32 v21, 4, v21
  v_lshl_add_u32 v21, v19, 8, v21
  v_add_u32 v10, v23, v21
  v_lshrrev_b32 v16, 4, v0
  v_add_u32 v16, 48, v16
  v_mul_u32_u24 v18, 43, v16
  v_lshrrev_b32 v18, 7, v18
  v_mul_u32_u24 v19, 3, v18
  v_sub_u32 v19, v16, v19
  v_mul_u32_u24 v23, 0x300, v18
  v_add_u32 v23, 7680, v23
  v_lshlrev_b32 v21, 4, v20
  v_lshl_add_u32 v21, v19, 8, v21
  v_add_u32 v83, v23, v21
  v_add_u32 v19, s54, v19
  v_subrev_u32 v21, 3, v19
  v_min_u32 v19, v19, v21
  v_xor_b32 v21, v18, v20
  v_xor_b32 v21, s53, v21
  v_and_b32 v21, 15, v21
  v_lshlrev_b32 v21, 4, v21
  v_lshl_add_u32 v21, v19, 8, v21
  v_add_u32 v11, v23, v21
  v_lshrrev_b32 v16, 4, v0
  v_add_u32 v16, 64, v16
  v_mul_u32_u24 v18, 43, v16
  v_lshrrev_b32 v18, 7, v18
  v_mul_u32_u24 v19, 3, v18
  v_sub_u32 v19, v16, v19
  v_mul_u32_u24 v23, 0x300, v18
  v_cmp_lt_u32 vcc, 21, v18
  v_subrev_u32 v24, 8448, v23
  v_add_u32 v25, 32256, v23
  v_cndmask_b32 v24, v25, v24, vcc
  v_add_u32 v25, 16128, v23
  v_add_u32 v23, 7680, v23
  v_cndmask_b32 v23, v23, v25, vcc
  v_lshlrev_b32 v21, 4, v20
  v_lshl_add_u32 v21, v19, 8, v21
  v_add_u32 v84, v23, v21
  v_add_u32 v19, s54, v19
  v_subrev_u32 v21, 3, v19
  v_min_u32 v19, v19, v21
  v_xor_b32 v21, v18, v20
  v_xor_b32 v21, s53, v21
  v_and_b32 v21, 15, v21
  v_lshlrev_b32 v21, 4, v21
  v_lshl_add_u32 v21, v19, 8, v21
  v_add_u32 v12, v23, v21
  v_add_u32 v14, v24, v21
  v_lshrrev_b32 v16, 4, v0
  v_add_u32 v16, 80, v16
  v_mul_u32_u24 v18, 43, v16
  v_lshrrev_b32 v18, 7, v18
  v_mul_u32_u24 v19, 3, v18
  v_sub_u32 v19, v16, v19
  v_mul_u32_u24 v23, 0x300, v18
  v_subrev_u32 v23, 8448, v23
  v_lshlrev_b32 v21, 4, v20
  v_lshl_add_u32 v21, v19, 8, v21
  v_add_u32 v85, v23, v21
  v_add_u32 v19, s54, v19
  v_subrev_u32 v21, 3, v19
  v_min_u32 v19, v19, v21
  v_xor_b32 v21, v18, v20
  v_xor_b32 v21, s53, v21
  v_and_b32 v21, 15, v21
  v_lshlrev_b32 v21, 4, v21
  v_lshl_add_u32 v21, v19, 8, v21
  v_add_u32 v13, v23, v21
  v_mul_u32_u24 v16, 0x300, v20
  v_xor_b32 v18, v17, v20
  v_lshl_add_u32 v1, v18, 4, v16
  v_xor_b32 v2, 64, v1
  v_xor_b32 v3, 128, v1
  v_xor_b32 v4, 192, v1
  s_mul_i32 s51, s20, 12
  v_and_b32 v18, 7, v20
  v_add_u32 v19, s51, v17
  v_xor_b32 v19, v19, v18
  v_lshl_add_u32 v86, v19, 4, v16
  v_add_u32 v86, 98304, v86
  v_add_u32 v19, s51, v17
  v_add_u32 v19, 4, v19
  v_xor_b32 v19, v19, v18
  v_lshl_add_u32 v87, v19, 4, v16
  v_add_u32 v87, 98304, v87
  v_bfe_u32 v18, v28, 2, 2
  v_and_b32 v19, 3, v28
  v_lshl_add_u32 v21, v17, 3, v18
  v_mul_u32_u24 v21, 192, v21
  v_lshl_add_u32 v21, v19, 4, v21
  s_add_u32 s51, s49, 49152
  v_add_u32 v67, s51, v21
  v_add_u32 v71, 49152, v67
  s_add_u32 s51, s39, 147456
  v_lshl_add_u32 v68, v17, 4, s51
  v_and_b32 v21, 1, v28
  v_lshlrev_b32 v21, 4, v21
  v_mov_b32 v23, 0xffff
  v_lshlrev_b32 v21, v21, v23
  v_lshlrev_b32 v16, 1, v17
  v_bfe_u32 v23, v28, 1, 3
  v_cmp_eq_u32 vcc, v16, v23
  v_add_u32 v16, 1, v16
  s_nop 0
  v_cndmask_b32 v69, 0, v21, vcc
  v_cmp_eq_u32 vcc, v16, v23
  s_mov_b32 s58, s40
  s_mov_b32 s59, s40
  s_mov_b32 s62, s40
  s_mov_b32 s63, s40
  s_mov_b32 s76, s40
  s_mov_b32 s77, s40
  s_mov_b32 s78, s40
  s_mov_b32 s79, s40
  v_cndmask_b32 v70, 0, v21, vcc
  s_mov_b64 s[90:91], 0
  s_mov_b32 s16, s92
  s_and_b32 s17, s93, 0xffff
  s_mov_b32 s18, 256
  s_mov_b32 s19, 0x00020000
  s_cmp_lg_u32 s23, 0
  s_cbranch_scc1 L_npr0
  s_waitcnt lgkmcnt(0)
  s_memtime s[84:85]
  s_load_dword s52, s[24:25], s37 glc
  s_waitcnt lgkmcnt(0)
  s_memtime s[86:87]
  s_waitcnt lgkmcnt(0)
  s_sub_u32 s84, s86, s84
  s_min_u32 s84, s84, 0xffff
  s_lshl_b32 s41, s84, 16
L_npr0:
  s_add_u32 m0, s49, 98304
  s_add_u32 s50, s42, s47
  buffer_load_dwordx4 v64, s[12:15], s50 offen offset:0 lds
  buffer_load_dwordx4 v65, s[12:15], s50 offen offset:1024 lds
  buffer_load_dwordx4 v66, s[12:15], s50 offen offset:2048 lds
  s_add_u32 m0, s49, 101376
  s_add_u32 s50, s50, 12288
  buffer_load_dwordx4 v64, s[12:15], s50 offen offset:0 lds
  buffer_load_dwordx4 v65, s[12:15], s50 offen offset:1024 lds
  buffer_load_dwordx4 v66, s[12:15], s50 offen offset:2048 lds
  s_cmp_lg_u32 s23, 0
  s_cbranch_scc1 L_npr1
  s_memtime s[84:85]
  s_load_dword s52, s[24:25], s38 glc
  s_waitcnt lgkmcnt(0)
  s_memtime s[86:87]
  s_lshl_b32 s52, s20, 2
  s_add_u32 s52, s52, 151552
  v_mov_b32 v16, s52
  s_waitcnt lgkmcnt(0)
  s_sub_u32 s84, s86, s84
  s_min_u32 s84, s84, 0xffff
  s_or_b32 s41, s41, s84
  v_mov_b32 v18, s41
  ds_write_b32 v16, v18
L_npr1:
  s_add_u32 m0, s49, 122880
  s_add_u32 s50, s42, s48
  buffer_load_dwordx4 v64, s[12:15], s50 offen offset:0 lds
  buffer_load_dwordx4 v65, s[12:15], s50 offen offset:1024 lds
  buffer_load_dwordx4 v66, s[12:15], s50 offen offset:2048 lds
  s_add_u32 m0, s49, 125952
  s_add_u32 s50, s50, 12288
  buffer_load_dwordx4 v64, s[12:15], s50 offen offset:0 lds
  buffer_load_dwordx4 v65, s[12:15], s50 offen offset:1024 lds
  buffer_load_dwordx4 v66, s[12:15], s50 offen offset:2048 lds
  s_waitcnt vmcnt(18)
  ds_read_b128 v[72:75], v68 offset:0
  ds_read_b64_tr_b16 a[168:169], v67 offset:0
  ds_read_b64_tr_b16 a[170:171], v67 offset:768
  ds_read_b64_tr_b16 a[172:173], v67 offset:8
  ds_read_b64_tr_b16 a[174:175], v67 offset:776
  ds_read_b64_tr_b16 a[176:177], v67 offset:64
  ds_read_b64_tr_b16 a[178:179], v67 offset:832
  ds_read_b64_tr_b16 a[180:181], v67 offset:72
  ds_read_b64_tr_b16 a[182:183], v67 offset:840
  ds_read_b64_tr_b16 a[184:185], v67 offset:128
  ds_read_b64_tr_b16 a[186:187], v67 offset:896
  ds_read_b64_tr_b16 a[188:189], v67 offset:136
  ds_read_b64_tr_b16 a[190:191], v67 offset:904
  s_waitcnt vmcnt(12)
  ds_read_b128 v[76:79], v68 offset:64
  ds_read_b64_tr_b16 a[192:193], v67 offset:24576
  ds_read_b64_tr_b16 a[194:195], v67 offset:25344
  ds_read_b64_tr_b16 a[196:197], v67 offset:24584
  ds_read_b64_tr_b16 a[198:199], v67 offset:25352
  ds_read_b64_tr_b16 a[200:201], v67 offset:24640
  ds_read_b64_tr_b16 a[202:203], v67 offset:25408
  ds_read_b64_tr_b16 a[204:205], v67 offset:24648
  ds_read_b64_tr_b16 a[206:207], v67 offset:25416
  ds_read_b64_tr_b16 a[208:209], v67 offset:24704
  ds_read_b64_tr_b16 a[210:211], v67 offset:25472
  ds_read_b64_tr_b16 a[212:213], v67 offset:24712
  ds_read_b64_tr_b16 a[214:215], v67 offset:25480
  s_waitcnt lgkmcnt(13)
  v_and_b32 v72, v69, v72
  v_and_b32 v73, v70, v73
  v_and_b32 v74, v69, v74
  v_and_b32 v75, v70, v75
  s_add_u32 m0, s49, 49152
  s_add_u32 s50, s43, s45
  buffer_load_dwordx4 v64, s[12:15], s50 offen offset:0 lds
  buffer_load_dwordx4 v65, s[12:15], s50 offen offset:1024 lds
  buffer_load_dwordx4 v66, s[12:15], s50 offen offset:2048 lds
  s_add_u32 m0, s49, 52224
  s_add_u32 s50, s50, 12288
  buffer_load_dwordx4 v64, s[12:15], s50 offen offset:0 lds
  buffer_load_dwordx4 v65, s[12:15], s50 offen offset:1024 lds
  buffer_load_dwordx4 v66, s[12:15], s50 offen offset:2048 lds
  v_mfma_f32_16x16x16_bf16 v[16:19], v[72:73], a[168:169], 0
  v_mfma_f32_16x16x16_bf16 v[20:23], v[74:75], a[170:171], 0
  v_mfma_f32_16x16x16_bf16 v[24:27], v[72:73], a[172:173], 0
  v_mfma_f32_16x16x16_bf16 v[28:31], v[74:75], a[174:175], 0
  v_mfma_f32_16x16x16_bf16 v[32:35], v[72:73], a[176:177], 0
  v_mfma_f32_16x16x16_bf16 v[36:39], v[74:75], a[178:179], 0
  v_mfma_f32_16x16x16_bf16 v[40:43], v[72:73], a[180:181], 0
  v_mfma_f32_16x16x16_bf16 v[44:47], v[74:75], a[182:183], 0
  v_mfma_f32_16x16x16_bf16 v[48:51], v[72:73], a[184:185], 0
  v_cvt_pk_bf16_f32 v88, v16, v17
  v_cvt_pk_bf16_f32 v89, v18, v19
  v_mfma_f32_16x16x16_bf16 v[52:55], v[74:75], a[186:187], 0
  v_cvt_pk_bf16_f32 v90, v20, v21
  v_cvt_pk_bf16_f32 v91, v22, v23
  v_mfma_f32_16x16x16_bf16 v[56:59], v[72:73], a[188:189], 0
  v_cvt_pk_bf16_f32 v92, v24, v25
  v_cvt_pk_bf16_f32 v93, v26, v27
  v_mfma_f32_16x16x16_bf16 v[60:63], v[74:75], a[190:191], 0
  v_cvt_pk_bf16_f32 v94, v28, v29
  v_cvt_pk_bf16_f32 v95, v30, v31
  s_cmp_lg_u32 s23, 0
  s_cbranch_scc1 L_np1
  s_barrier
  s_cmp_lg_u32 s20, 0
  s_cbranch_scc1 L_np1
  v_mov_b32 v252, 151552
  ds_read_b128 v[248:251], v252
  s_add_u32 s51, s33, s37
  s_lshr_b32 s51, s51, 21
  s_lshr_b32 s52, s2, 2
  s_xor_b32 s51, s51, s52
  s_and_b32 s51, s51, 1
  s_add_u32 s52, s51, 1
  s_sub_u32 s51, 2, s51
  v_mov_b32 v254, s52
  v_mov_b32 v253, s51
  v_mov_b32 v255, 0
  v_mov_b32 v252, s36
  s_waitcnt lgkmcnt(0)
  v_pk_min_u16 v248, v248, v249
  v_pk_min_u16 v250, v250, v251
  v_pk_min_u16 v248, v248, v250
  v_lshrrev_b32 v249, 16, v248
  v_and_b32 v248, 0xffff, v248
  v_cmp_gt_u32 vcc, v249, v248
  s_mov_b64 exec, 1
  s_nop 0
  v_cndmask_b32 v254, v254, v253, vcc
  buffer_atomic_cmpswap v[254:255], v252, s[16:19], 0 offen sc1
  s_mov_b64 exec, -1
L_np1:
  s_waitcnt vmcnt(12)
  ds_read_b128 v[72:75], v68 offset:128
  ds_read_b64_tr_b16 a[168:169], v71 offset:0
  ds_read_b64_tr_b16 a[170:171], v71 offset:768
  ds_read_b64_tr_b16 a[172:173], v71 offset:8
  ds_read_b64_tr_b16 a[174:175], v71 offset:776
  ds_read_b64_tr_b16 a[176:177], v71 offset:64
  ds_read_b64_tr_b16 a[178:179], v71 offset:832
  ds_read_b64_tr_b16 a[180:181], v71 offset:72
  ds_read_b64_tr_b16 a[182:183], v71 offset:840
  ds_read_b64_tr_b16 a[184:185], v71 offset:128
  ds_read_b64_tr_b16 a[186:187], v71 offset:896
  ds_read_b64_tr_b16 a[188:189], v71 offset:136
  ds_read_b64_tr_b16 a[190:191], v71 offset:904
  s_waitcnt lgkmcnt(13)
  v_and_b32 v76, v69, v76
  v_and_b32 v77, v70, v77
  v_and_b32 v78, v69, v78
  v_and_b32 v79, v70, v79
  s_add_u32 m0, s49, 73728
  s_add_u32 s50, s43, s46
  buffer_load_dwordx4 v64, s[12:15], s50 offen offset:0 lds
  buffer_load_dwordx4 v65, s[12:15], s50 offen offset:1024 lds
  buffer_load_dwordx4 v66, s[12:15], s50 offen offset:2048 lds
  s_add_u32 m0, s49, 76800
  s_add_u32 s50, s50, 12288
  buffer_load_dwordx4 v64, s[12:15], s50 offen offset:0 lds
  buffer_load_dwordx4 v65, s[12:15], s50 offen offset:1024 lds
  buffer_load_dwordx4 v66, s[12:15], s50 offen offset:2048 lds
  v_mfma_f32_16x16x16_bf16 v[16:19], v[76:77], a[192:193], 0
  v_cvt_pk_bf16_f32 v96, v32, v33
  v_cvt_pk_bf16_f32 v97, v34, v35
  v_mfma_f32_16x16x16_bf16 v[20:23], v[78:79], a[194:195], 0
  v_cvt_pk_bf16_f32 v98, v36, v37
  v_cvt_pk_bf16_f32 v99, v38, v39
  v_mfma_f32_16x16x16_bf16 v[24:27], v[76:77], a[196:197], 0
  v_cvt_pk_bf16_f32 v100, v40, v41
  v_cvt_pk_bf16_f32 v101, v42, v43
  v_mfma_f32_16x16x16_bf16 v[28:31], v[78:79], a[198:199], 0
  v_cvt_pk_bf16_f32 v102, v44, v45
  v_cvt_pk_bf16_f32 v103, v46, v47
  v_mfma_f32_16x16x16_bf16 v[32:35], v[76:77], a[200:201], 0
  v_cvt_pk_bf16_f32 v104, v48, v49
  v_cvt_pk_bf16_f32 v105, v50, v51
  v_mfma_f32_16x16x16_bf16 v[36:39], v[78:79], a[202:203], 0
  v_cvt_pk_bf16_f32 v106, v52, v53
  v_cvt_pk_bf16_f32 v107, v54, v55
  v_mfma_f32_16x16x16_bf16 v[40:43], v[76:77], a[204:205], 0
  v_cvt_pk_bf16_f32 v108, v56, v57
  v_cvt_pk_bf16_f32 v109, v58, v59
  v_mfma_f32_16x16x16_bf16 v[44:47], v[78:79], a[206:207], 0
  v_cvt_pk_bf16_f32 v110, v60, v61
  v_cvt_pk_bf16_f32 v111, v62, v63
  v_mfma_f32_16x16x16_bf16 v[48:51], v[76:77], a[208:209], 0
  v_cvt_pk_bf16_f32 v16, v16, v17
  v_cvt_pk_bf16_f32 v17, v18, v19
  v_accvgpr_write_b32 a0, v16
  v_accvgpr_write_b32 a1, v17
  v_mfma_f32_16x16x16_bf16 v[52:55], v[78:79], a[210:211], 0
  v_cvt_pk_bf16_f32 v20, v20, v21
  v_cvt_pk_bf16_f32 v21, v22, v23
  v_accvgpr_write_b32 a2, v20
  v_accvgpr_write_b32 a3, v21
  v_mfma_f32_16x16x16_bf16 v[56:59], v[76:77], a[212:213], 0
  v_cvt_pk_bf16_f32 v24, v24, v25
  v_cvt_pk_bf16_f32 v25, v26, v27
  v_accvgpr_write_b32 a4, v24
  v_accvgpr_write_b32 a5, v25
  v_mfma_f32_16x16x16_bf16 v[60:63], v[78:79], a[214:215], 0
  v_cvt_pk_bf16_f32 v28, v28, v29
  v_cvt_pk_bf16_f32 v29, v30, v31
  v_accvgpr_write_b32 a6, v28
  v_accvgpr_write_b32 a7, v29
  s_waitcnt vmcnt(12)
  ds_read_b128 v[76:79], v68 offset:192
  ds_read_b64_tr_b16 a[192:193], v71 offset:24576
  ds_read_b64_tr_b16 a[194:195], v71 offset:25344
  ds_read_b64_tr_b16 a[196:197], v71 offset:24584
  ds_read_b64_tr_b16 a[198:199], v71 offset:25352
  ds_read_b64_tr_b16 a[200:201], v71 offset:24640
  ds_read_b64_tr_b16 a[202:203], v71 offset:25408
  ds_read_b64_tr_b16 a[204:205], v71 offset:24648
  ds_read_b64_tr_b16 a[206:207], v71 offset:25416
  ds_read_b64_tr_b16 a[208:209], v71 offset:24704
  ds_read_b64_tr_b16 a[210:211], v71 offset:25472
  ds_read_b64_tr_b16 a[212:213], v71 offset:24712
  ds_read_b64_tr_b16 a[214:215], v71 offset:25480
  s_waitcnt lgkmcnt(13)
  v_and_b32 v72, v69, v72
  v_and_b32 v73, v70, v73
  v_and_b32 v74, v69, v74
  v_and_b32 v75, v70, v75
  s_add_u32 m0, s49, 98304
  s_add_u32 s50, s43, s47
  buffer_load_dwordx4 v64, s[12:15], s50 offen offset:0 lds
  buffer_load_dwordx4 v65, s[12:15], s50 offen offset:1024 lds
  buffer_load_dwordx4 v66, s[12:15], s50 offen offset:2048 lds
  s_add_u32 m0, s49, 101376
  s_add_u32 s50, s50, 12288
  buffer_load_dwordx4 v64, s[12:15], s50 offen offset:0 lds
  buffer_load_dwordx4 v65, s[12:15], s50 offen offset:1024 lds
  buffer_load_dwordx4 v66, s[12:15], s50 offen offset:2048 lds
  v_mfma_f32_16x16x16_bf16 v[16:19], v[72:73], a[168:169], 0
  v_cvt_pk_bf16_f32 v32, v32, v33
  v_cvt_pk_bf16_f32 v33, v34, v35
  v_accvgpr_write_b32 a8, v32
  v_accvgpr_write_b32 a9, v33
  v_mfma_f32_16x16x16_bf16 v[20:23], v[74:75], a[170:171], 0
  v_cvt_pk_bf16_f32 v36, v36, v37
  v_cvt_pk_bf16_f32 v37, v38, v39
  v_accvgpr_write_b32 a10, v36
  v_accvgpr_write_b32 a11, v37
  v_mfma_f32_16x16x16_bf16 v[24:27], v[72:73], a[172:173], 0
  v_cvt_pk_bf16_f32 v40, v40, v41
  v_cvt_pk_bf16_f32 v41, v42, v43
  v_accvgpr_write_b32 a12, v40
  v_accvgpr_write_b32 a13, v41
  v_mfma_f32_16x16x16_bf16 v[28:31], v[74:75], a[174:175], 0
  v_cvt_pk_bf16_f32 v44, v44, v45
  v_cvt_pk_bf16_f32 v45, v46, v47
  v_accvgpr_write_b32 a14, v44
  v_accvgpr_write_b32 a15, v45
  v_mfma_f32_16x16x16_bf16 v[32:35], v[72:73], a[176:177], 0
  v_cvt_pk_bf16_f32 v48, v48, v49
  v_cvt_pk_bf16_f32 v49, v50, v51
  v_accvgpr_write_b32 a16, v48
  v_accvgpr_write_b32 a17, v49
  v_mfma_f32_16x16x16_bf16 v[36:39], v[74:75], a[178:179], 0
  v_cvt_pk_bf16_f32 v52, v52, v53
  v_cvt_pk_bf16_f32 v53, v54, v55
  v_accvgpr_write_b32 a18, v52
  v_accvgpr_write_b32 a19, v53
  v_mfma_f32_16x16x16_bf16 v[40:43], v[72:73], a[180:181], 0
  v_cvt_pk_bf16_f32 v56, v56, v57
  v_cvt_pk_bf16_f32 v57, v58, v59
  v_accvgpr_write_b32 a20, v56
  v_accvgpr_write_b32 a21, v57
  v_mfma_f32_16x16x16_bf16 v[44:47], v[74:75], a[182:183], 0
  v_cvt_pk_bf16_f32 v60, v60, v61
  v_cvt_pk_bf16_f32 v61, v62, v63
  v_accvgpr_write_b32 a22, v60
  v_accvgpr_write_b32 a23, v61
  v_mfma_f32_16x16x16_bf16 v[48:51], v[72:73], a[184:185], 0
  v_cvt_pk_bf16_f32 v112, v16, v17
  v_cvt_pk_bf16_f32 v113, v18, v19
  v_mfma_f32_16x16x16_bf16 v[52:55], v[74:75], a[186:187], 0
  v_cvt_pk_bf16_f32 v114, v20, v21
  v_cvt_pk_bf16_f32 v115, v22, v23
  v_mfma_f32_16x16x16_bf16 v[56:59], v[72:73], a[188:189], 0
  v_cvt_pk_bf16_f32 v116, v24, v25
  v_cvt_pk_bf16_f32 v117, v26, v27
  v_mfma_f32_16x16x16_bf16 v[60:63], v[74:75], a[190:191], 0
  v_cvt_pk_bf16_f32 v118, v28, v29
  v_cvt_pk_bf16_f32 v119, v30, v31
  s_waitcnt vmcnt(12)
  ds_read_b128 v[72:75], v68 offset:256
  ds_read_b64_tr_b16 a[168:169], v67 offset:0
  ds_read_b64_tr_b16 a[170:171], v67 offset:768
  ds_read_b64_tr_b16 a[172:173], v67 offset:8
  ds_read_b64_tr_b16 a[174:175], v67 offset:776
  ds_read_b64_tr_b16 a[176:177], v67 offset:64
  ds_read_b64_tr_b16 a[178:179], v67 offset:832
  ds_read_b64_tr_b16 a[180:181], v67 offset:72
  ds_read_b64_tr_b16 a[182:183], v67 offset:840
  ds_read_b64_tr_b16 a[184:185], v67 offset:128
  ds_read_b64_tr_b16 a[186:187], v67 offset:896
  ds_read_b64_tr_b16 a[188:189], v67 offset:136
  ds_read_b64_tr_b16 a[190:191], v67 offset:904
  s_waitcnt lgkmcnt(13)
  v_and_b32 v76, v69, v76
  v_and_b32 v77, v70, v77
  v_and_b32 v78, v69, v78
  v_and_b32 v79, v70, v79
  s_add_u32 m0, s49, 122880
  s_add_u32 s50, s43, s48
  buffer_load_dwordx4 v64, s[12:15], s50 offen offset:0 lds
  buffer_load_dwordx4 v65, s[12:15], s50 offen offset:1024 lds
  buffer_load_dwordx4 v66, s[12:15], s50 offen offset:2048 lds
  s_add_u32 m0, s49, 125952
  s_add_u32 s50, s50, 12288
  buffer_load_dwordx4 v64, s[12:15], s50 offen offset:0 lds
  buffer_load_dwordx4 v65, s[12:15], s50 offen offset:1024 lds
  buffer_load_dwordx4 v66, s[12:15], s50 offen offset:2048 lds
  v_mfma_f32_16x16x16_bf16 v[16:19], v[76:77], a[192:193], 0
  v_cvt_pk_bf16_f32 v120, v32, v33
  v_cvt_pk_bf16_f32 v121, v34, v35
  v_mfma_f32_16x16x16_bf16 v[20:23], v[78:79], a[194:195], 0
  v_cvt_pk_bf16_f32 v122, v36, v37
  v_cvt_pk_bf16_f32 v123, v38, v39
  v_mfma_f32_16x16x16_bf16 v[24:27], v[76:77], a[196:197], 0
  v_cvt_pk_bf16_f32 v124, v40, v41
  v_cvt_pk_bf16_f32 v125, v42, v43
  v_mfma_f32_16x16x16_bf16 v[28:31], v[78:79], a[198:199], 0
  v_cvt_pk_bf16_f32 v126, v44, v45
  v_cvt_pk_bf16_f32 v127, v46, v47
  v_mfma_f32_16x16x16_bf16 v[32:35], v[76:77], a[200:201], 0
  v_cvt_pk_bf16_f32 v128, v48, v49
  v_cvt_pk_bf16_f32 v129, v50, v51
  v_mfma_f32_16x16x16_bf16 v[36:39], v[78:79], a[202:203], 0
  v_cvt_pk_bf16_f32 v130, v52, v53
  v_cvt_pk_bf16_f32 v131, v54, v55
  v_mfma_f32_16x16x16_bf16 v[40:43], v[76:77], a[204:205], 0
  v_cvt_pk_bf16_f32 v132, v56, v57
  v_cvt_pk_bf16_f32 v133, v58, v59
  v_mfma_f32_16x16x16_bf16 v[44:47], v[78:79], a[206:207], 0
  v_cvt_pk_bf16_f32 v134, v60, v61
  v_cvt_pk_bf16_f32 v135, v62, v63
  v_mfma_f32_16x16x16_bf16 v[48:51], v[76:77], a[208:209], 0
  v_cvt_pk_bf16_f32 v16, v16, v17
  v_cvt_pk_bf16_f32 v17, v18, v19
  v_accvgpr_write_b32 a24, v16
  v_accvgpr_write_b32 a25, v17
  v_mfma_f32_16x16x16_bf16 v[52:55], v[78:79], a[210:211], 0
  v_cvt_pk_bf16_f32 v20, v20, v21
  v_cvt_pk_bf16_f32 v21, v22, v23
  v_accvgpr_write_b32 a26, v20
  v_accvgpr_write_b32 a27, v21
  v_mfma_f32_16x16x16_bf16 v[56:59], v[76:77], a[212:213], 0
  v_cvt_pk_bf16_f32 v24, v24, v25
  v_cvt_pk_bf16_f32 v25, v26, v27
  v_accvgpr_write_b32 a28, v24
  v_accvgpr_write_b32 a29, v25
  v_mfma_f32_16x16x16_bf16 v[60:63], v[78:79], a[214:215], 0
  v_cvt_pk_bf16_f32 v28, v28, v29
  v_cvt_pk_bf16_f32 v29, v30, v31
  v_accvgpr_write_b32 a30, v28
  v_accvgpr_write_b32 a31, v29
  s_waitcnt vmcnt(12)
  ds_read_b128 v[76:79], v68 offset:320
  ds_read_b64_tr_b16 a[192:193], v67 offset:24576
  ds_read_b64_tr_b16 a[194:195], v67 offset:25344
  ds_read_b64_tr_b16 a[196:197], v67 offset:24584
  ds_read_b64_tr_b16 a[198:199], v67 offset:25352
  ds_read_b64_tr_b16 a[200:201], v67 offset:24640
  ds_read_b64_tr_b16 a[202:203], v67 offset:25408
  ds_read_b64_tr_b16 a[204:205], v67 offset:24648
  ds_read_b64_tr_b16 a[206:207], v67 offset:25416
  ds_read_b64_tr_b16 a[208:209], v67 offset:24704
  ds_read_b64_tr_b16 a[210:211], v67 offset:25472
  ds_read_b64_tr_b16 a[212:213], v67 offset:24712
  ds_read_b64_tr_b16 a[214:215], v67 offset:25480
  s_waitcnt lgkmcnt(13)
  v_and_b32 v72, v69, v72
  v_and_b32 v73, v70, v73
  v_and_b32 v74, v69, v74
  v_and_b32 v75, v70, v75
  s_add_u32 m0, s49, 49152
  s_add_u32 s50, s44, s45
  buffer_load_dwordx4 v64, s[12:15], s50 offen offset:0 lds
  buffer_load_dwordx4 v65, s[12:15], s50 offen offset:1024 lds
  buffer_load_dwordx4 v66, s[12:15], s50 offen offset:2048 lds
  s_add_u32 m0, s49, 52224
  s_add_u32 s50, s50, 12288
  buffer_load_dwordx4 v64, s[12:15], s50 offen offset:0 lds
  buffer_load_dwordx4 v65, s[12:15], s50 offen offset:1024 lds
  buffer_load_dwordx4 v66, s[12:15], s50 offen offset:2048 lds
  v_mfma_f32_16x16x16_bf16 v[16:19], v[72:73], a[168:169], 0
  v_cvt_pk_bf16_f32 v32, v32, v33
  v_cvt_pk_bf16_f32 v33, v34, v35
  v_accvgpr_write_b32 a32, v32
  v_accvgpr_write_b32 a33, v33
  v_mfma_f32_16x16x16_bf16 v[20:23], v[74:75], a[170:171], 0
  v_cvt_pk_bf16_f32 v36, v36, v37
  v_cvt_pk_bf16_f32 v37, v38, v39
  v_accvgpr_write_b32 a34, v36
  v_accvgpr_write_b32 a35, v37
  v_mfma_f32_16x16x16_bf16 v[24:27], v[72:73], a[172:173], 0
  v_cvt_pk_bf16_f32 v40, v40, v41
  v_cvt_pk_bf16_f32 v41, v42, v43
  v_accvgpr_write_b32 a36, v40
  v_accvgpr_write_b32 a37, v41
  v_mfma_f32_16x16x16_bf16 v[28:31], v[74:75], a[174:175], 0
  v_cvt_pk_bf16_f32 v44, v44, v45
  v_cvt_pk_bf16_f32 v45, v46, v47
  v_accvgpr_write_b32 a38, v44
  v_accvgpr_write_b32 a39, v45
  v_mfma_f32_16x16x16_bf16 v[32:35], v[72:73], a[176:177], 0
  v_cvt_pk_bf16_f32 v48, v48, v49
  v_cvt_pk_bf16_f32 v49, v50, v51
  v_accvgpr_write_b32 a40, v48
  v_accvgpr_write_b32 a41, v49
  v_mfma_f32_16x16x16_bf16 v[36:39], v[74:75], a[178:179], 0
  v_cvt_pk_bf16_f32 v52, v52, v53
  v_cvt_pk_bf16_f32 v53, v54, v55
  v_accvgpr_write_b32 a42, v52
  v_accvgpr_write_b32 a43, v53
  v_mfma_f32_16x16x16_bf16 v[40:43], v[72:73], a[180:181], 0
  v_cvt_pk_bf16_f32 v56, v56, v57
  v_cvt_pk_bf16_f32 v57, v58, v59
  v_accvgpr_write_b32 a44, v56
  v_accvgpr_write_b32 a45, v57
  v_mfma_f32_16x16x16_bf16 v[44:47], v[74:75], a[182:183], 0
  v_cvt_pk_bf16_f32 v60, v60, v61
  v_cvt_pk_bf16_f32 v61, v62, v63
  v_accvgpr_write_b32 a46, v60
  v_accvgpr_write_b32 a47, v61
  v_mfma_f32_16x16x16_bf16 v[48:51], v[72:73], a[184:185], 0
  v_cvt_pk_bf16_f32 v136, v16, v17
  v_cvt_pk_bf16_f32 v137, v18, v19
  v_mfma_f32_16x16x16_bf16 v[52:55], v[74:75], a[186:187], 0
  v_cvt_pk_bf16_f32 v138, v20, v21
  v_cvt_pk_bf16_f32 v139, v22, v23
  v_mfma_f32_16x16x16_bf16 v[56:59], v[72:73], a[188:189], 0
  v_cvt_pk_bf16_f32 v140, v24, v25
  v_cvt_pk_bf16_f32 v141, v26, v27
  v_mfma_f32_16x16x16_bf16 v[60:63], v[74:75], a[190:191], 0
  v_cvt_pk_bf16_f32 v142, v28, v29
  v_cvt_pk_bf16_f32 v143, v30, v31
  s_waitcnt vmcnt(12)
  ds_read_b128 v[72:75], v68 offset:384
  ds_read_b64_tr_b16 a[168:169], v71 offset:0
  ds_read_b64_tr_b16 a[170:171], v71 offset:768
  ds_read_b64_tr_b16 a[172:173], v71 offset:8
  ds_read_b64_tr_b16 a[174:175], v71 offset:776
  ds_read_b64_tr_b16 a[176:177], v71 offset:64
  ds_read_b64_tr_b16 a[178:179], v71 offset:832
  ds_read_b64_tr_b16 a[180:181], v71 offset:72
  ds_read_b64_tr_b16 a[182:183], v71 offset:840
  ds_read_b64_tr_b16 a[184:185], v71 offset:128
  ds_read_b64_tr_b16 a[186:187], v71 offset:896
  ds_read_b64_tr_b16 a[188:189], v71 offset:136
  ds_read_b64_tr_b16 a[190:191], v71 offset:904
  s_waitcnt lgkmcnt(13)
  v_and_b32 v76, v69, v76
  v_and_b32 v77, v70, v77
  v_and_b32 v78, v69, v78
  v_and_b32 v79, v70, v79
  s_add_u32 m0, s49, 73728
  s_add_u32 s50, s44, s46
  buffer_load_dwordx4 v64, s[12:15], s50 offen offset:0 lds
  buffer_load_dwordx4 v65, s[12:15], s50 offen offset:1024 lds
  buffer_load_dwordx4 v66, s[12:15], s50 offen offset:2048 lds
  s_add_u32 m0, s49, 76800
  s_add_u32 s50, s50, 12288
  buffer_load_dwordx4 v64, s[12:15], s50 offen offset:0 lds
  buffer_load_dwordx4 v65, s[12:15], s50 offen offset:1024 lds
  buffer_load_dwordx4 v66, s[12:15], s50 offen offset:2048 lds
  v_mfma_f32_16x16x16_bf16 v[16:19], v[76:77], a[192:193], 0
  v_cvt_pk_bf16_f32 v144, v32, v33
  v_cvt_pk_bf16_f32 v145, v34, v35
  v_mfma_f32_16x16x16_bf16 v[20:23], v[78:79], a[194:195], 0
  v_cvt_pk_bf16_f32 v146, v36, v37
  v_cvt_pk_bf16_f32 v147, v38, v39
  v_mfma_f32_16x16x16_bf16 v[24:27], v[76:77], a[196:197], 0
  v_cvt_pk_bf16_f32 v148, v40, v41
  v_cvt_pk_bf16_f32 v149, v42, v43
  v_mfma_f32_16x16x16_bf16 v[28:31], v[78:79], a[198:199], 0
  v_cvt_pk_bf16_f32 v150, v44, v45
  v_cvt_pk_bf16_f32 v151, v46, v47
  v_mfma_f32_16x16x16_bf16 v[32:35], v[76:77], a[200:201], 0
  v_cvt_pk_bf16_f32 v152, v48, v49
  v_cvt_pk_bf16_f32 v153, v50, v51
  v_mfma_f32_16x16x16_bf16 v[36:39], v[78:79], a[202:203], 0
  v_cvt_pk_bf16_f32 v154, v52, v53
  v_cvt_pk_bf16_f32 v155, v54, v55
  v_mfma_f32_16x16x16_bf16 v[40:43], v[76:77], a[204:205], 0
  v_cvt_pk_bf16_f32 v156, v56, v57
  v_cvt_pk_bf16_f32 v157, v58, v59
  v_mfma_f32_16x16x16_bf16 v[44:47], v[78:79], a[206:207], 0
  v_cvt_pk_bf16_f32 v158, v60, v61
  v_cvt_pk_bf16_f32 v159, v62, v63
  v_mfma_f32_16x16x16_bf16 v[48:51], v[76:77], a[208:209], 0
  v_cvt_pk_bf16_f32 v16, v16, v17
  v_cvt_pk_bf16_f32 v17, v18, v19
  v_accvgpr_write_b32 a48, v16
  v_accvgpr_write_b32 a49, v17
  v_mfma_f32_16x16x16_bf16 v[52:55], v[78:79], a[210:211], 0
  v_cvt_pk_bf16_f32 v20, v20, v21
  v_cvt_pk_bf16_f32 v21, v22, v23
  v_accvgpr_write_b32 a50, v20
  v_accvgpr_write_b32 a51, v21
  v_mfma_f32_16x16x16_bf16 v[56:59], v[76:77], a[212:213], 0
  v_cvt_pk_bf16_f32 v24, v24, v25
  v_cvt_pk_bf16_f32 v25, v26, v27
  v_accvgpr_write_b32 a52, v24
  v_accvgpr_write_b32 a53, v25
  v_mfma_f32_16x16x16_bf16 v[60:63], v[78:79], a[214:215], 0
  v_cvt_pk_bf16_f32 v28, v28, v29
  v_cvt_pk_bf16_f32 v29, v30, v31
  v_accvgpr_write_b32 a54, v28
  v_accvgpr_write_b32 a55, v29
  s_waitcnt vmcnt(12)
  ds_read_b128 v[76:79], v68 offset:448
  ds_read_b64_tr_b16 a[192:193], v71 offset:24576
  ds_read_b64_tr_b16 a[194:195], v71 offset:25344
  ds_read_b64_tr_b16 a[196:197], v71 offset:24584
  ds_read_b64_tr_b16 a[198:199], v71 offset:25352
  ds_read_b64_tr_b16 a[200:201], v71 offset:24640
  ds_read_b64_tr_b16 a[202:203], v71 offset:25408
  ds_read_b64_tr_b16 a[204:205], v71 offset:24648
  ds_read_b64_tr_b16 a[206:207], v71 offset:25416
  ds_read_b64_tr_b16 a[208:209], v71 offset:24704
  ds_read_b64_tr_b16 a[210:211], v71 offset:25472
  ds_read_b64_tr_b16 a[212:213], v71 offset:24712
  ds_read_b64_tr_b16 a[214:215], v71 offset:25480
  s_waitcnt lgkmcnt(13)
  v_and_b32 v72, v69, v72
  v_and_b32 v73, v70, v73
  v_and_b32 v74, v69, v74
  v_and_b32 v75, v70, v75
  s_add_u32 m0, s49, 98304
  s_add_u32 s50, s44, s47
  buffer_load_dwordx4 v64, s[12:15], s50 offen offset:0 lds
  buffer_load_dwordx4 v65, s[12:15], s50 offen offset:1024 lds
  buffer_load_dwordx4 v66, s[12:15], s50 offen offset:2048 lds
  s_add_u32 m0, s49, 101376
  s_add_u32 s50, s50, 12288
  buffer_load_dwordx4 v64, s[12:15], s50 offen offset:0 lds
  buffer_load_dwordx4 v65, s[12:15], s50 offen offset:1024 lds
  buffer_load_dwordx4 v66, s[12:15], s50 offen offset:2048 lds
  v_mfma_f32_16x16x16_bf16 v[16:19], v[72:73], a[168:169], 0
  v_cvt_pk_bf16_f32 v32, v32, v33
  v_cvt_pk_bf16_f32 v33, v34, v35
  v_accvgpr_write_b32 a56, v32
  v_accvgpr_write_b32 a57, v33
  v_mfma_f32_16x16x16_bf16 v[20:23], v[74:75], a[170:171], 0
  v_cvt_pk_bf16_f32 v36, v36, v37
  v_cvt_pk_bf16_f32 v37, v38, v39
  v_accvgpr_write_b32 a58, v36
  v_accvgpr_write_b32 a59, v37
  v_mfma_f32_16x16x16_bf16 v[24:27], v[72:73], a[172:173], 0
  v_cvt_pk_bf16_f32 v40, v40, v41
  v_cvt_pk_bf16_f32 v41, v42, v43
  v_accvgpr_write_b32 a60, v40
  v_accvgpr_write_b32 a61, v41
  v_mfma_f32_16x16x16_bf16 v[28:31], v[74:75], a[174:175], 0
  v_cvt_pk_bf16_f32 v44, v44, v45
  v_cvt_pk_bf16_f32 v45, v46, v47
  v_accvgpr_write_b32 a62, v44
  v_accvgpr_write_b32 a63, v45
  v_mfma_f32_16x16x16_bf16 v[32:35], v[72:73], a[176:177], 0
  v_cvt_pk_bf16_f32 v48, v48, v49
  v_cvt_pk_bf16_f32 v49, v50, v51
  v_accvgpr_write_b32 a64, v48
  v_accvgpr_write_b32 a65, v49
  v_mfma_f32_16x16x16_bf16 v[36:39], v[74:75], a[178:179], 0
  v_cvt_pk_bf16_f32 v52, v52, v53
  v_cvt_pk_bf16_f32 v53, v54, v55
  v_accvgpr_write_b32 a66, v52
  v_accvgpr_write_b32 a67, v53
  v_mfma_f32_16x16x16_bf16 v[40:43], v[72:73], a[180:181], 0
  v_cvt_pk_bf16_f32 v56, v56, v57
  v_cvt_pk_bf16_f32 v57, v58, v59
  v_accvgpr_write_b32 a68, v56
  v_accvgpr_write_b32 a69, v57
  v_mfma_f32_16x16x16_bf16 v[44:47], v[74:75], a[182:183], 0
  v_cvt_pk_bf16_f32 v60, v60, v61
  v_cvt_pk_bf16_f32 v61, v62, v63
  v_accvgpr_write_b32 a70, v60
  v_accvgpr_write_b32 a71, v61
  v_mfma_f32_16x16x16_bf16 v[48:51], v[72:73], a[184:185], 0
  v_cvt_pk_bf16_f32 v160, v16, v17
  v_cvt_pk_bf16_f32 v161, v18, v19
  v_mfma_f32_16x16x16_bf16 v[52:55], v[74:75], a[186:187], 0
  v_cvt_pk_bf16_f32 v162, v20, v21
  v_cvt_pk_bf16_f32 v163, v22, v23
  v_mfma_f32_16x16x16_bf16 v[56:59], v[72:73], a[188:189], 0
  v_cvt_pk_bf16_f32 v164, v24, v25
  v_cvt_pk_bf16_f32 v165, v26, v27
  v_mfma_f32_16x16x16_bf16 v[60:63], v[74:75], a[190:191], 0
  v_cvt_pk_bf16_f32 v166, v28, v29
  v_cvt_pk_bf16_f32 v167, v30, v31
  s_waitcnt vmcnt(12)
  ds_read_b128 v[72:75], v68 offset:512
  ds_read_b64_tr_b16 a[168:169], v67 offset:0
  ds_read_b64_tr_b16 a[170:171], v67 offset:768
  ds_read_b64_tr_b16 a[172:173], v67 offset:8
  ds_read_b64_tr_b16 a[174:175], v67 offset:776
  ds_read_b64_tr_b16 a[176:177], v67 offset:64
  ds_read_b64_tr_b16 a[178:179], v67 offset:832
  ds_read_b64_tr_b16 a[180:181], v67 offset:72
  ds_read_b64_tr_b16 a[182:183], v67 offset:840
  ds_read_b64_tr_b16 a[184:185], v67 offset:128
  ds_read_b64_tr_b16 a[186:187], v67 offset:896
  ds_read_b64_tr_b16 a[188:189], v67 offset:136
  ds_read_b64_tr_b16 a[190:191], v67 offset:904
  s_load_dword s34, s[92:93], s36
  s_waitcnt lgkmcnt(13)
  v_and_b32 v76, v69, v76
  v_and_b32 v77, v70, v77
  v_and_b32 v78, v69, v78
  v_and_b32 v79, v70, v79
  s_add_u32 m0, s49, 122880
  s_add_u32 s50, s44, s48
  buffer_load_dwordx4 v64, s[12:15], s50 offen offset:0 lds
  buffer_load_dwordx4 v65, s[12:15], s50 offen offset:1024 lds
  buffer_load_dwordx4 v66, s[12:15], s50 offen offset:2048 lds
  s_add_u32 m0, s49, 125952
  s_add_u32 s50, s50, 12288
  buffer_load_dwordx4 v64, s[12:15], s50 offen offset:0 lds
  buffer_load_dwordx4 v65, s[12:15], s50 offen offset:1024 lds
  buffer_load_dwordx4 v66, s[12:15], s50 offen offset:2048 lds
  v_mfma_f32_16x16x16_bf16 v[16:19], v[76:77], a[192:193], 0
  v_cvt_pk_bf16_f32 v168, v32, v33
  v_cvt_pk_bf16_f32 v169, v34, v35
  v_mfma_f32_16x16x16_bf16 v[20:23], v[78:79], a[194:195], 0
  v_cvt_pk_bf16_f32 v170, v36, v37
  v_cvt_pk_bf16_f32 v171, v38, v39
  v_mfma_f32_16x16x16_bf16 v[24:27], v[76:77], a[196:197], 0
  v_cvt_pk_bf16_f32 v172, v40, v41
  v_cvt_pk_bf16_f32 v173, v42, v43
  v_mfma_f32_16x16x16_bf16 v[28:31], v[78:79], a[198:199], 0
  v_cvt_pk_bf16_f32 v174, v44, v45
  v_cvt_pk_bf16_f32 v175, v46, v47
  v_mfma_f32_16x16x16_bf16 v[32:35], v[76:77], a[200:201], 0
  v_cvt_pk_bf16_f32 v176, v48, v49
  v_cvt_pk_bf16_f32 v177, v50, v51
  v_mfma_f32_16x16x16_bf16 v[36:39], v[78:79], a[202:203], 0
  v_cvt_pk_bf16_f32 v178, v52, v53
  v_cvt_pk_bf16_f32 v179, v54, v55
  v_mfma_f32_16x16x16_bf16 v[40:43], v[76:77], a[204:205], 0
  v_cvt_pk_bf16_f32 v180, v56, v57
  v_cvt_pk_bf16_f32 v181, v58, v59
  v_mfma_f32_16x16x16_bf16 v[44:47], v[78:79], a[206:207], 0
  v_cvt_pk_bf16_f32 v182, v60, v61
  v_cvt_pk_bf16_f32 v183, v62, v63
  v_mfma_f32_16x16x16_bf16 v[48:51], v[76:77], a[208:209], 0
  v_cvt_pk_bf16_f32 v16, v16, v17
  v_cvt_pk_bf16_f32 v17, v18, v19
  v_accvgpr_write_b32 a72, v16
  v_accvgpr_write_b32 a73, v17
  v_mfma_f32_16x16x16_bf16 v[52:55], v[78:79], a[210:211], 0
  v_cvt_pk_bf16_f32 v20, v20, v21
  v_cvt_pk_bf16_f32 v21, v22, v23
  v_accvgpr_write_b32 a74, v20
  v_accvgpr_write_b32 a75, v21
  v_mfma_f32_16x16x16_bf16 v[56:59], v[76:77], a[212:213], 0
  v_cvt_pk_bf16_f32 v24, v24, v25
  v_cvt_pk_bf16_f32 v25, v26, v27
  v_accvgpr_write_b32 a76, v24
  v_accvgpr_write_b32 a77, v25
  v_mfma_f32_16x16x16_bf16 v[60:63], v[78:79], a[214:215], 0
  v_cvt_pk_bf16_f32 v28, v28, v29
  v_cvt_pk_bf16_f32 v29, v30, v31
  v_accvgpr_write_b32 a78, v28
  v_accvgpr_write_b32 a79, v29
  s_waitcnt lgkmcnt(0)
  s_cmp_eq_u32 s34, 0
  s_cbranch_scc1 L_slow
L_back:
  s_lshr_b32 s51, s2, 1
  s_xor_b32 s34, s34, s51
  s_and_b32 s34, s34, 2
  s_lshl_b32 s34, s34, 20
  s_waitcnt vmcnt(12)
  ds_read_b128 v[76:79], v68 offset:576
  ds_read_b64_tr_b16 a[192:193], v67 offset:24576
  ds_read_b64_tr_b16 a[194:195], v67 offset:25344
  ds_read_b64_tr_b16 a[196:197], v67 offset:24584
  ds_read_b64_tr_b16 a[198:199], v67 offset:25352
  ds_read_b64_tr_b16 a[200:201], v67 offset:24640
  ds_read_b64_tr_b16 a[202:203], v67 offset:25408
  ds_read_b64_tr_b16 a[204:205], v67 offset:24648
  ds_read_b64_tr_b16 a[206:207], v67 offset:25416
  ds_read_b64_tr_b16 a[208:209], v67 offset:24704
  ds_read_b64_tr_b16 a[210:211], v67 offset:25472
  ds_read_b64_tr_b16 a[212:213], v67 offset:24712
  ds_read_b64_tr_b16 a[214:215], v67 offset:25480
  s_waitcnt lgkmcnt(13)
  v_and_b32 v72, v69, v72
  v_and_b32 v73, v70, v73
  v_and_b32 v74, v69, v74
  v_and_b32 v75, v70, v75
  s_mov_b64 s[82:83], s[80:81]
  s_mov_b64 s[80:81], s[78:79]
  s_mov_b64 s[78:79], s[76:77]
  s_add_u32 s76, s33, s32
  s_xor_b32 s76, s76, s34
  s_add_u32 s77, s32, 24576
  s_cmp_lt_u32 s32, s35
  s_cselect_b32 s22, s32, s40
  s_cselect_b32 s77, s77, s40
  s_bitcmp1_b32 s76, 21
  s_cselect_b32 s76, s77, s22
  s_cselect_b32 s77, s22, s77
  s_cselect_b64 s[56:57], -1, 0
  s_add_u32 s32, s32, 786432
  s_add_u32 m0, s39, 0
  s_nop 0
  buffer_load_dwordx4 v8, s[4:7], s76 offen nt lds
  s_add_u32 m0, s39, 4096
  s_nop 0
  buffer_load_dwordx4 v9, s[4:7], s76 offen nt lds
  s_add_u32 m0, s39, 8192
  s_nop 0
  buffer_load_dwordx4 v10, s[4:7], s76 offen nt lds
  s_add_u32 m0, s39, 12288
  s_nop 0
  buffer_load_dwordx4 v11, s[4:7], s76 offen nt lds
  v_cndmask_b32 v15, v12, v14, s[56:57]
  s_add_u32 m0, s39, 16384
  s_nop 0
  buffer_load_dwordx4 v15, s[4:7], s22 offen nt lds
  s_add_u32 m0, s39, 20480
  s_nop 0
  buffer_load_dwordx4 v13, s[4:7], s77 offen nt lds
  v_mfma_f32_16x16x16_bf16 v[16:19], v[72:73], a[168:169], 0
  v_cvt_pk_bf16_f32 v32, v32, v33
  v_cvt_pk_bf16_f32 v33, v34, v35
  v_accvgpr_write_b32 a80, v32
  v_accvgpr_write_b32 a81, v33
  v_mfma_f32_16x16x16_bf16 v[20:23], v[74:75], a[170:171], 0
  v_cvt_pk_bf16_f32 v36, v36, v37
  v_cvt_pk_bf16_f32 v37, v38, v39
  v_accvgpr_write_b32 a82, v36
  v_accvgpr_write_b32 a83, v37
  v_mfma_f32_16x16x16_bf16 v[24:27], v[72:73], a[172:173], 0
  v_cvt_pk_bf16_f32 v40, v40, v41
  v_cvt_pk_bf16_f32 v41, v42, v43
  v_accvgpr_write_b32 a84, v40
  v_accvgpr_write_b32 a85, v41
  v_mfma_f32_16x16x16_bf16 v[28:31], v[74:75], a[174:175], 0
  v_cvt_pk_bf16_f32 v44, v44, v45
  v_cvt_pk_bf16_f32 v45, v46, v47
  v_accvgpr_write_b32 a86, v44
  v_accvgpr_write_b32 a87, v45
  v_mfma_f32_16x16x16_bf16 v[32:35], v[72:73], a[176:177], 0
  v_cvt_pk_bf16_f32 v48, v48, v49
  v_cvt_pk_bf16_f32 v49, v50, v51
  v_accvgpr_write_b32 a88, v48
  v_accvgpr_write_b32 a89, v49
  v_mfma_f32_16x16x16_bf16 v[36:39], v[74:75], a[178:179], 0
  v_cvt_pk_bf16_f32 v52, v52, v53
  v_cvt_pk_bf16_f32 v53, v54, v55
  v_accvgpr_write_b32 a90, v52
  v_accvgpr_write_b32 a91, v53
  v_mfma_f32_16x16x16_bf16 v[40:43], v[72:73], a[180:181], 0
  v_cvt_pk_bf16_f32 v56, v56, v57
  v_cvt_pk_bf16_f32 v57, v58, v59
  v_accvgpr_write_b32 a92, v56
  v_accvgpr_write_b32 a93, v57
  v_mfma_f32_16x16x16_bf16 v[44:47], v[74:75], a[182:183], 0
  v_cvt_pk_bf16_f32 v60, v60, v61
  v_cvt_pk_bf16_f32 v61, v62, v63
  v_accvgpr_write_b32 a94, v60
  v_accvgpr_write_b32 a95, v61
  v_mfma_f32_16x16x16_bf16 v[48:51], v[72:73], a[184:185], 0
  v_cvt_pk_bf16_f32 v184, v16, v17
  v_cvt_pk_bf16_f32 v185, v18, v19
  v_mfma_f32_16x16x16_bf16 v[52:55], v[74:75], a[186:187], 0
  v_cvt_pk_bf16_f32 v186, v20, v21
  v_cvt_pk_bf16_f32 v187, v22, v23
  v_mfma_f32_16x16x16_bf16 v[56:59], v[72:73], a[188:189], 0
  v_cvt_pk_bf16_f32 v188, v24, v25
  v_cvt_pk_bf16_f32 v189, v26, v27
  v_mfma_f32_16x16x16_bf16 v[60:63], v[74:75], a[190:191], 0
  v_cvt_pk_bf16_f32 v190, v28, v29
  v_cvt_pk_bf16_f32 v191, v30, v31
  s_waitcnt vmcnt(12)
  ds_read_b128 v[72:75], v68 offset:640
  ds_read_b64_tr_b16 a[168:169], v71 offset:0
  ds_read_b64_tr_b16 a[170:171], v71 offset:768
  ds_read_b64_tr_b16 a[172:173], v71 offset:8
  ds_read_b64_tr_b16 a[174:175], v71 offset:776
  ds_read_b64_tr_b16 a[176:177], v71 offset:64
  ds_read_b64_tr_b16 a[178:179], v71 offset:832
  ds_read_b64_tr_b16 a[180:181], v71 offset:72
  ds_read_b64_tr_b16 a[182:183], v71 offset:840
  ds_read_b64_tr_b16 a[184:185], v71 offset:128
  ds_read_b64_tr_b16 a[186:187], v71 offset:896
  ds_read_b64_tr_b16 a[188:189], v71 offset:136
  ds_read_b64_tr_b16 a[190:191], v71 offset:904
  s_waitcnt lgkmcnt(13)
  v_and_b32 v76, v69, v76
  v_and_b32 v77, v70, v77
  v_and_b32 v78, v69, v78
  v_and_b32 v79, v70, v79
  s_nop 1
  v_mfma_f32_16x16x16_bf16 v[16:19], v[76:77], a[192:193], 0
  v_cvt_pk_bf16_f32 v192, v32, v33
  v_cvt_pk_bf16_f32 v193, v34, v35
  v_mfma_f32_16x16x16_bf16 v[20:23], v[78:79], a[194:195], 0
  v_cvt_pk_bf16_f32 v194, v36, v37
  v_cvt_pk_bf16_f32 v195, v38, v39
  v_mfma_f32_16x16x16_bf16 v[24:27], v[76:77], a[196:197], 0
  v_cvt_pk_bf16_f32 v196, v40, v41
  v_cvt_pk_bf16_f32 v197, v42, v43
  v_mfma_f32_16x16x16_bf16 v[28:31], v[78:79], a[198:199], 0
  v_cvt_pk_bf16_f32 v198, v44, v45
  v_cvt_pk_bf16_f32 v199, v46, v47
  v_mfma_f32_16x16x16_bf16 v[32:35], v[76:77], a[200:201], 0
  v_cvt_pk_bf16_f32 v200, v48, v49
  v_cvt_pk_bf16_f32 v201, v50, v51
  v_mfma_f32_16x16x16_bf16 v[36:39], v[78:79], a[202:203], 0
  v_cvt_pk_bf16_f32 v202, v52, v53
  v_cvt_pk_bf16_f32 v203, v54, v55
  v_mfma_f32_16x16x16_bf16 v[40:43], v[76:77], a[204:205], 0
  v_cvt_pk_bf16_f32 v204, v56, v57
  v_cvt_pk_bf16_f32 v205, v58, v59
  v_mfma_f32_16x16x16_bf16 v[44:47], v[78:79], a[206:207], 0
  v_cvt_pk_bf16_f32 v206, v60, v61
  v_cvt_pk_bf16_f32 v207, v62, v63
  v_mfma_f32_16x16x16_bf16 v[48:51], v[76:77], a[208:209], 0
  v_cvt_pk_bf16_f32 v16, v16, v17
  v_cvt_pk_bf16_f32 v17, v18, v19
  v_accvgpr_write_b32 a96, v16
  v_accvgpr_write_b32 a97, v17
  v_mfma_f32_16x16x16_bf16 v[52:55], v[78:79], a[210:211], 0
  v_cvt_pk_bf16_f32 v20, v20, v21
  v_cvt_pk_bf16_f32 v21, v22, v23
  v_accvgpr_write_b32 a98, v20
  v_accvgpr_write_b32 a99, v21
  v_mfma_f32_16x16x16_bf16 v[56:59], v[76:77], a[212:213], 0
  v_cvt_pk_bf16_f32 v24, v24, v25
  v_cvt_pk_bf16_f32 v25, v26, v27
  v_accvgpr_write_b32 a100, v24
  v_accvgpr_write_b32 a101, v25
  v_mfma_f32_16x16x16_bf16 v[60:63], v[78:79], a[214:215], 0
  v_cvt_pk_bf16_f32 v28, v28, v29
  v_cvt_pk_bf16_f32 v29, v30, v31
  v_accvgpr_write_b32 a102, v28
  v_accvgpr_write_b32 a103, v29
  s_waitcnt vmcnt(6)
  ds_read_b128 v[76:79], v68 offset:704
  ds_read_b64_tr_b16 a[192:193], v71 offset:24576
  ds_read_b64_tr_b16 a[194:195], v71 offset:25344
  ds_read_b64_tr_b16 a[196:197], v71 offset:24584
  ds_read_b64_tr_b16 a[198:199], v71 offset:25352
  ds_read_b64_tr_b16 a[200:201], v71 offset:24640
  ds_read_b64_tr_b16 a[202:203], v71 offset:25408
  ds_read_b64_tr_b16 a[204:205], v71 offset:24648
  ds_read_b64_tr_b16 a[206:207], v71 offset:25416
  ds_read_b64_tr_b16 a[208:209], v71 offset:24704
  ds_read_b64_tr_b16 a[210:211], v71 offset:25472
  ds_read_b64_tr_b16 a[212:213], v71 offset:24712
  ds_read_b64_tr_b16 a[214:215], v71 offset:25480
  s_waitcnt lgkmcnt(13)
  v_and_b32 v72, v69, v72
  v_and_b32 v73, v70, v73
  v_and_b32 v74, v69, v74
  v_and_b32 v75, v70, v75
  s_nop 1
  v_mfma_f32_16x16x16_bf16 v[16:19], v[72:73], a[168:169], 0
  v_cvt_pk_bf16_f32 v32, v32, v33
  v_cvt_pk_bf16_f32 v33, v34, v35
  v_accvgpr_write_b32 a104, v32
  v_accvgpr_write_b32 a105, v33
  v_mfma_f32_16x16x16_bf16 v[20:23], v[74:75], a[170:171], 0
  v_cvt_pk_bf16_f32 v36, v36, v37
  v_cvt_pk_bf16_f32 v37, v38, v39
  v_accvgpr_write_b32 a106, v36
  v_accvgpr_write_b32 a107, v37
  v_mfma_f32_16x16x16_bf16 v[24:27], v[72:73], a[172:173], 0
  v_cvt_pk_bf16_f32 v40, v40, v41
  v_cvt_pk_bf16_f32 v41, v42, v43
  v_accvgpr_write_b32 a108, v40
  v_accvgpr_write_b32 a109, v41
  v_mfma_f32_16x16x16_bf16 v[28:31], v[74:75], a[174:175], 0
  v_cvt_pk_bf16_f32 v44, v44, v45
  v_cvt_pk_bf16_f32 v45, v46, v47
  v_accvgpr_write_b32 a110, v44
  v_accvgpr_write_b32 a111, v45
  v_mfma_f32_16x16x16_bf16 v[32:35], v[72:73], a[176:177], 0
  v_cvt_pk_bf16_f32 v48, v48, v49
  v_cvt_pk_bf16_f32 v49, v50, v51
  v_accvgpr_write_b32 a112, v48
  v_accvgpr_write_b32 a113, v49
  v_mfma_f32_16x16x16_bf16 v[36:39], v[74:75], a[178:179], 0
  v_cvt_pk_bf16_f32 v52, v52, v53
  v_cvt_pk_bf16_f32 v53, v54, v55
  v_accvgpr_write_b32 a114, v52
  v_accvgpr_write_b32 a115, v53
  v_mfma_f32_16x16x16_bf16 v[40:43], v[72:73], a[180:181], 0
  v_cvt_pk_bf16_f32 v56, v56, v57
  v_cvt_pk_bf16_f32 v57, v58, v59
  v_accvgpr_write_b32 a116, v56
  v_accvgpr_write_b32 a117, v57
  v_mfma_f32_16x16x16_bf16 v[44:47], v[74:75], a[182:183], 0
  v_cvt_pk_bf16_f32 v60, v60, v61
  v_cvt_pk_bf16_f32 v61, v62, v63
  v_accvgpr_write_b32 a118, v60
  v_accvgpr_write_b32 a119, v61
  v_mfma_f32_16x16x16_bf16 v[48:51], v[72:73], a[184:185], 0
  v_cvt_pk_bf16_f32 v208, v16, v17
  v_cvt_pk_bf16_f32 v209, v18, v19
  v_mfma_f32_16x16x16_bf16 v[52:55], v[74:75], a[186:187], 0
  v_cvt_pk_bf16_f32 v210, v20, v21
  v_cvt_pk_bf16_f32 v211, v22, v23
  v_mfma_f32_16x16x16_bf16 v[56:59], v[72:73], a[188:189], 0
  v_cvt_pk_bf16_f32 v212, v24, v25
  v_cvt_pk_bf16_f32 v213, v26, v27
  v_mfma_f32_16x16x16_bf16 v[60:63], v[74:75], a[190:191], 0
  v_cvt_pk_bf16_f32 v214, v28, v29
  v_cvt_pk_bf16_f32 v215, v30, v31
  s_waitcnt lgkmcnt(0)
  v_and_b32 v76, v69, v76
  v_and_b32 v77, v70, v77
  v_and_b32 v78, v69, v78
  v_and_b32 v79, v70, v79
  s_nop 1
  v_mfma_f32_16x16x16_bf16 v[16:19], v[76:77], a[192:193], 0
  v_cvt_pk_bf16_f32 v216, v32, v33
  v_cvt_pk_bf16_f32 v217, v34, v35
  v_mfma_f32_16x16x16_bf16 v[20:23], v[78:79], a[194:195], 0
  v_cvt_pk_bf16_f32 v218, v36, v37
  v_cvt_pk_bf16_f32 v219, v38, v39
  v_mfma_f32_16x16x16_bf16 v[24:27], v[76:77], a[196:197], 0
  v_cvt_pk_bf16_f32 v220, v40, v41
  v_cvt_pk_bf16_f32 v221, v42, v43
  v_mfma_f32_16x16x16_bf16 v[28:31], v[78:79], a[198:199], 0
  v_cvt_pk_bf16_f32 v222, v44, v45
  v_cvt_pk_bf16_f32 v223, v46, v47
  v_mfma_f32_16x16x16_bf16 v[32:35], v[76:77], a[200:201], 0
  v_cvt_pk_bf16_f32 v224, v48, v49
  v_cvt_pk_bf16_f32 v225, v50, v51
  v_mfma_f32_16x16x16_bf16 v[36:39], v[78:79], a[202:203], 0
  v_cvt_pk_bf16_f32 v226, v52, v53
  v_cvt_pk_bf16_f32 v227, v54, v55
  v_mfma_f32_16x16x16_bf16 v[40:43], v[76:77], a[204:205], 0
  v_cvt_pk_bf16_f32 v228, v56, v57
  v_cvt_pk_bf16_f32 v229, v58, v59
  v_mfma_f32_16x16x16_bf16 v[44:47], v[78:79], a[206:207], 0
  v_cvt_pk_bf16_f32 v230, v60, v61
  v_cvt_pk_bf16_f32 v231, v62, v63
  v_mfma_f32_16x16x16_bf16 v[48:51], v[76:77], a[208:209], 0
  v_cvt_pk_bf16_f32 v232, v16, v17
  v_cvt_pk_bf16_f32 v233, v18, v19
  v_mfma_f32_16x16x16_bf16 v[52:55], v[78:79], a[210:211], 0
  v_cvt_pk_bf16_f32 v234, v20, v21
  v_cvt_pk_bf16_f32 v235, v22, v23
  v_mfma_f32_16x16x16_bf16 v[56:59], v[76:77], a[212:213], 0
  v_cvt_pk_bf16_f32 v236, v24, v25
  v_cvt_pk_bf16_f32 v237, v26, v27
  v_mfma_f32_16x16x16_bf16 v[60:63], v[78:79], a[214:215], 0
  v_cvt_pk_bf16_f32 v238, v28, v29
  v_cvt_pk_bf16_f32 v239, v30, v31
  v_cvt_pk_bf16_f32 v240, v32, v33
  v_cvt_pk_bf16_f32 v241, v34, v35
  v_cvt_pk_bf16_f32 v242, v36, v37
  v_cvt_pk_bf16_f32 v243, v38, v39
  v_cvt_pk_bf16_f32 v244, v40, v41
  v_cvt_pk_bf16_f32 v245, v42, v43
  v_cvt_pk_bf16_f32 v246, v44, v45
  v_cvt_pk_bf16_f32 v247, v46, v47
  s_waitcnt vmcnt(0)
  s_barrier
  ds_read_b128 a[120:123], v1 offset:0
  ds_read_b128 a[124:127], v2 offset:0
  ds_read_b128 a[128:131], v3 offset:0
  ds_read_b128 a[132:135], v4 offset:0
  s_mov_b64 s[82:83], s[80:81]
  s_mov_b64 s[80:81], s[78:79]
  s_mov_b64 s[78:79], s[76:77]
  s_add_u32 s76, s33, s32
  s_xor_b32 s76, s76, s34
  s_add_u32 s77, s32, 24576
  s_cmp_lt_u32 s32, s35
  s_cselect_b32 s22, s32, s40
  s_cselect_b32 s77, s77, s40
  s_bitcmp1_b32 s76, 21
  s_cselect_b32 s76, s77, s22
  s_cselect_b32 s77, s22, s77
  s_cselect_b64 s[56:57], -1, 0
  s_add_u32 s32, s32, 786432
  s_add_u32 m0, s39, 24576
  s_nop 0
  buffer_load_dwordx4 v8, s[4:7], s76 offen nt lds
  s_add_u32 m0, s39, 28672
  s_nop 0
  buffer_load_dwordx4 v9, s[4:7], s76 offen nt lds
  s_add_u32 m0, s39, 32768
  s_nop 0
  buffer_load_dwordx4 v10, s[4:7], s76 offen nt lds
  s_add_u32 m0, s39, 36864
  s_nop 0
  buffer_load_dwordx4 v11, s[4:7], s76 offen nt lds
  v_cndmask_b32 v15, v12, v14, s[56:57]
  s_add_u32 m0, s39, 40960
  s_nop 0
  buffer_load_dwordx4 v15, s[4:7], s22 offen nt lds
  s_add_u32 m0, s39, 45056
  s_xor_b32 s39, s39, 49152
  buffer_load_dwordx4 v13, s[4:7], s77 offen nt lds
  v_cvt_pk_bf16_f32 v248, v48, v49
  v_cvt_pk_bf16_f32 v249, v50, v51
  v_cvt_pk_bf16_f32 v250, v52, v53
  v_cvt_pk_bf16_f32 v251, v54, v55
  v_cvt_pk_bf16_f32 v252, v56, v57
  v_cvt_pk_bf16_f32 v253, v58, v59
  v_cvt_pk_bf16_f32 v254, v60, v61
  v_cvt_pk_bf16_f32 v255, v62, v63
  v_sub_u32 v64, v14, v12
  v_add_u32 v64, v64, v84
L_loop:
  s_waitcnt lgkmcnt(2)
  v_mfma_f32_16x16x32_bf16 v[16:19], v[88:91], a[120:123], 0
  ds_read_b128 a[136:139], v1 offset:256
  v_mfma_f32_16x16x32_bf16 v[16:19], a[0:3], a[124:127], v[16:19]
  ds_read_b128 a[140:143], v2 offset:256
  v_mfma_f32_16x16x32_bf16 v[20:23], v[92:95], a[120:123], 0
  v_mfma_f32_16x16x32_bf16 v[20:23], a[4:7], a[124:127], v[20:23]
  v_cvt_pk_bf16_f32 v40, v40, v41
  v_mfma_f32_16x16x32_bf16 v[24:27], v[96:99], a[120:123], 0
  v_cvt_pk_bf16_f32 v41, v42, v43
  v_mfma_f32_16x16x32_bf16 v[24:27], a[8:11], a[124:127], v[24:27]
  v_cvt_pk_bf16_f32 v42, v44, v45
  v_mfma_f32_16x16x32_bf16 v[28:31], v[100:103], a[120:123], 0
  buffer_store_dwordx4 a[164:167], v85, s[8:11], s63 offen sc1
  v_mfma_f32_16x16x32_bf16 v[28:31], a[12:15], a[124:127], v[28:31]
  v_cvt_pk_bf16_f32 v43, v46, v47
  v_mfma_f32_16x16x32_bf16 v[32:35], v[104:107], a[120:123], 0
  ds_write_b128 v86, v[40:43] offset:12288
  v_mfma_f32_16x16x32_bf16 v[32:35], a[16:19], a[124:127], v[32:35]
  v_mfma_f32_16x16x32_bf16 v[36:39], v[108:111], a[120:123], 0
  v_mfma_f32_16x16x32_bf16 v[36:39], a[20:23], a[124:127], v[36:39]
  s_waitcnt lgkmcnt(3)
  v_mfma_f32_16x16x32_bf16 v[16:19], v[112:115], a[128:131], v[16:19]
  ds_read_b128 a[120:123], v3 offset:256
  v_mfma_f32_16x16x32_bf16 v[16:19], a[24:27], a[132:135], v[16:19]
  ds_read_b128 a[124:127], v4 offset:256
  v_mfma_f32_16x16x32_bf16 v[20:23], v[116:119], a[128:131], v[20:23]
  v_mfma_f32_16x16x32_bf16 v[20:23], a[28:31], a[132:135], v[20:23]
  v_cvt_pk_bf16_f32 v48, v48, v49
  v_mfma_f32_16x16x32_bf16 v[24:27], v[120:123], a[128:131], v[24:27]
  buffer_store_dwordx4 a[144:147], v80, s[8:11], s58 offen sc1
  v_mfma_f32_16x16x32_bf16 v[24:27], a[32:35], a[132:135], v[24:27]
  v_cvt_pk_bf16_f32 v49, v50, v51
  v_mfma_f32_16x16x32_bf16 v[28:31], v[124:127], a[128:131], v[28:31]
  v_cvt_pk_bf16_f32 v50, v52, v53
  v_mfma_f32_16x16x32_bf16 v[28:31], a[36:39], a[132:135], v[28:31]
  v_cvt_pk_bf16_f32 v51, v54, v55
  v_mfma_f32_16x16x32_bf16 v[32:35], v[128:131], a[128:131], v[32:35]
  ds_write_b128 v87, v[48:51] offset:12288
  v_mfma_f32_16x16x32_bf16 v[32:35], a[40:43], a[132:135], v[32:35]
  v_mfma_f32_16x16x32_bf16 v[36:39], v[132:135], a[128:131], v[36:39]
  v_mfma_f32_16x16x32_bf16 v[36:39], a[44:47], a[132:135], v[36:39]
  s_waitcnt lgkmcnt(4)
  v_mfma_f32_16x16x32_bf16 v[16:19], v[136:139], a[136:139], v[16:19]
  ds_read_b128 a[128:131], v1 offset:512
  v_mfma_f32_16x16x32_bf16 v[16:19], a[48:51], a[140:143], v[16:19]
  ds_read_b128 a[132:135], v2 offset:512
  v_mfma_f32_16x16x32_bf16 v[20:23], v[140:143], a[136:139], v[20:23]
  v_mfma_f32_16x16x32_bf16 v[20:23], a[52:55], a[140:143], v[20:23]
  v_mfma_f32_16x16x32_bf16 v[24:27], v[144:147], a[136:139], v[24:27]
  buffer_store_dwordx4 a[148:151], v81, s[8:11], s58 offen sc1
  v_mfma_f32_16x16x32_bf16 v[24:27], a[56:59], a[140:143], v[24:27]
  v_mfma_f32_16x16x32_bf16 v[28:31], v[148:151], a[136:139], v[28:31]
  v_mfma_f32_16x16x32_bf16 v[28:31], a[60:63], a[140:143], v[28:31]
  v_mfma_f32_16x16x32_bf16 v[32:35], v[152:155], a[136:139], v[32:35]
  v_mfma_f32_16x16x32_bf16 v[32:35], a[64:67], a[140:143], v[32:35]
  v_mfma_f32_16x16x32_bf16 v[36:39], v[156:159], a[136:139], v[36:39]
  v_mfma_f32_16x16x32_bf16 v[36:39], a[68:71], a[140:143], v[36:39]
  s_waitcnt lgkmcnt(3)
  v_mfma_f32_16x16x32_bf16 v[16:19], v[160:163], a[120:123], v[16:19]
  ds_read_b128 a[136:139], v3 offset:512
  v_mfma_f32_16x16x32_bf16 v[16:19], a[72:75], a[124:127], v[16:19]
  ds_read_b128 a[140:143], v4 offset:512
  v_mfma_f32_16x16x32_bf16 v[20:23], v[164:167], a[120:123], v[20:23]
  v_cvt_pk_bf16_f32 v56, v56, v57
  v_mfma_f32_16x16x32_bf16 v[20:23], a[76:79], a[124:127], v[20:23]
  v_cvt_pk_bf16_f32 v57, v58, v59
  v_mfma_f32_16x16x32_bf16 v[24:27], v[168:171], a[120:123], v[24:27]
  buffer_store_dwordx4 a[152:155], v82, s[8:11], s58 offen sc1
  v_mfma_f32_16x16x32_bf16 v[24:27], a[80:83], a[124:127], v[24:27]
  s_mov_b64 s[82:83], s[80:81]
  v_cvt_pk_bf16_f32 v58, v60, v61
  v_mfma_f32_16x16x32_bf16 v[28:31], v[172:175], a[120:123], v[28:31]
  s_mov_b64 s[80:81], s[78:79]
  v_cvt_pk_bf16_f32 v59, v62, v63
  v_mfma_f32_16x16x32_bf16 v[28:31], a[84:87], a[124:127], v[28:31]
  ds_write_b128 v86, v[56:59] offset:12416
  v_mfma_f32_16x16x32_bf16 v[32:35], v[176:179], a[120:123], v[32:35]
  s_mov_b64 s[78:79], s[76:77]
  s_add_u32 s76, s33, s32
  v_mfma_f32_16x16x32_bf16 v[32:35], a[88:91], a[124:127], v[32:35]
  s_xor_b32 s76, s76, s34
  s_add_u32 s77, s32, 24576
  v_mfma_f32_16x16x32_bf16 v[36:39], v[180:183], a[120:123], v[36:39]
  s_cmp_lt_u32 s32, s35
  s_cselect_b32 s22, s32, s40
  v_mfma_f32_16x16x32_bf16 v[36:39], a[92:95], a[124:127], v[36:39]
  s_cselect_b32 s77, s77, s40
  s_waitcnt lgkmcnt(3)
  v_mfma_f32_16x16x32_bf16 v[16:19], v[184:187], a[128:131], v[16:19]
  ds_read_b128 a[120:123], v1 offset:12288
  s_bitcmp1_b32 s76, 21
  v_mfma_f32_16x16x32_bf16 v[16:19], a[96:99], a[132:135], v[16:19]
  ds_read_b128 a[124:127], v2 offset:12288
  s_cselect_b32 s76, s77, s22
  v_mfma_f32_16x16x32_bf16 v[20:23], v[188:191], a[128:131], v[20:23]
  s_cselect_b32 s77, s22, s77
  s_cselect_b64 s[56:57], -1, 0
  v_mfma_f32_16x16x32_bf16 v[20:23], a[100:103], a[132:135], v[20:23]
  s_add_u32 s32, s32, 786432
  s_add_u32 m0, s39, 0
  v_mfma_f32_16x16x32_bf16 v[24:27], v[192:195], a[128:131], v[24:27]
  buffer_load_dwordx4 v8, s[4:7], s76 offen nt lds
  v_mfma_f32_16x16x32_bf16 v[24:27], a[104:107], a[132:135], v[24:27]
  s_mov_b32 s58, s80
  s_mov_b32 s59, s82
  v_mfma_f32_16x16x32_bf16 v[28:31], v[196:199], a[128:131], v[28:31]
  s_mov_b32 s63, s83
  s_min_u32 s62, s82, s83
  v_mfma_f32_16x16x32_bf16 v[28:31], a[108:111], a[132:135], v[28:31]
  s_cmp_gt_u32 s82, s83
  s_cselect_b64 s[90:91], -1, 0
  v_mfma_f32_16x16x32_bf16 v[32:35], v[200:203], a[128:131], v[32:35]
  v_cndmask_b32 v65, v84, v64, s[90:91]
  v_mfma_f32_16x16x32_bf16 v[32:35], a[112:115], a[132:135], v[32:35]
  v_mfma_f32_16x16x32_bf16 v[36:39], v[204:207], a[128:131], v[36:39]
  v_mfma_f32_16x16x32_bf16 v[36:39], a[116:119], a[132:135], v[36:39]
  s_waitcnt lgkmcnt(3)
  v_mfma_f32_16x16x32_bf16 v[16:19], v[208:211], a[136:139], v[16:19]
  ds_read_b128 a[128:131], v3 offset:12288
  v_mfma_f32_16x16x32_bf16 v[16:19], v[232:235], a[140:143], v[16:19]
  ds_read_b128 a[132:135], v4 offset:12288
  v_mfma_f32_16x16x32_bf16 v[20:23], v[212:215], a[136:139], v[20:23]
  v_mfma_f32_16x16x32_bf16 v[20:23], v[236:239], a[140:143], v[20:23]
  s_add_u32 m0, s39, 4096
  v_mfma_f32_16x16x32_bf16 v[24:27], v[216:219], a[136:139], v[24:27]
  buffer_load_dwordx4 v9, s[4:7], s76 offen nt lds
  v_mfma_f32_16x16x32_bf16 v[24:27], v[240:243], a[140:143], v[24:27]
  v_mfma_f32_16x16x32_bf16 v[28:31], v[220:223], a[136:139], v[28:31]
  v_mfma_f32_16x16x32_bf16 v[28:31], v[244:247], a[140:143], v[28:31]
  v_mfma_f32_16x16x32_bf16 v[32:35], v[224:227], a[136:139], v[32:35]
  v_mfma_f32_16x16x32_bf16 v[32:35], v[248:251], a[140:143], v[32:35]
  v_mfma_f32_16x16x32_bf16 v[36:39], v[228:231], a[136:139], v[36:39]
  v_mfma_f32_16x16x32_bf16 v[36:39], v[252:255], a[140:143], v[36:39]
  s_waitcnt lgkmcnt(2)
  v_mfma_f32_16x16x32_bf16 v[40:43], v[88:91], a[120:123], 0
  ds_read_b128 a[136:139], v1 offset:12544
  v_mfma_f32_16x16x32_bf16 v[40:43], a[0:3], a[124:127], v[40:43]
  ds_read_b128 a[140:143], v2 offset:12544
  v_mfma_f32_16x16x32_bf16 v[44:47], v[92:95], a[120:123], 0
  s_add_u32 m0, s39, 8192
  v_mfma_f32_16x16x32_bf16 v[44:47], a[4:7], a[124:127], v[44:47]
  v_cvt_pk_bf16_f32 v16, v16, v17
  v_mfma_f32_16x16x32_bf16 v[48:51], v[96:99], a[120:123], 0
  buffer_load_dwordx4 v10, s[4:7], s76 offen nt lds
  v_mfma_f32_16x16x32_bf16 v[48:51], a[8:11], a[124:127], v[48:51]
  v_cvt_pk_bf16_f32 v17, v18, v19
  v_mfma_f32_16x16x32_bf16 v[52:55], v[100:103], a[120:123], 0
  v_cvt_pk_bf16_f32 v18, v20, v21
  v_mfma_f32_16x16x32_bf16 v[52:55], a[12:15], a[124:127], v[52:55]
  v_cvt_pk_bf16_f32 v19, v22, v23
  v_mfma_f32_16x16x32_bf16 v[56:59], v[104:107], a[120:123], 0
  ds_write_b128 v86, v[16:19] offset:0
  v_mfma_f32_16x16x32_bf16 v[56:59], a[16:19], a[124:127], v[56:59]
  s_add_u32 m0, s39, 12288
  v_mfma_f32_16x16x32_bf16 v[60:63], v[108:111], a[120:123], 0
  v_cvt_pk_bf16_f32 v24, v24, v25
  v_mfma_f32_16x16x32_bf16 v[60:63], a[20:23], a[124:127], v[60:63]
  s_waitcnt lgkmcnt(3)
  v_mfma_f32_16x16x32_bf16 v[40:43], v[112:115], a[128:131], v[40:43]
  ds_read_b128 a[120:123], v3 offset:12544
  v_mfma_f32_16x16x32_bf16 v[40:43], a[24:27], a[132:135], v[40:43]
  ds_read_b128 a[124:127], v4 offset:12544
  v_mfma_f32_16x16x32_bf16 v[44:47], v[116:119], a[128:131], v[44:47]
  v_cvt_pk_bf16_f32 v25, v26, v27
  v_mfma_f32_16x16x32_bf16 v[44:47], a[28:31], a[132:135], v[44:47]
  v_cvt_pk_bf16_f32 v26, v28, v29
  v_mfma_f32_16x16x32_bf16 v[48:51], v[120:123], a[128:131], v[48:51]
  buffer_load_dwordx4 v11, s[4:7], s76 offen nt lds
  v_mfma_f32_16x16x32_bf16 v[48:51], a[32:35], a[132:135], v[48:51]
  v_cvt_pk_bf16_f32 v27, v30, v31
  v_mfma_f32_16x16x32_bf16 v[52:55], v[124:127], a[128:131], v[52:55]
  ds_write_b128 v87, v[24:27] offset:0
  v_mfma_f32_16x16x32_bf16 v[52:55], a[36:39], a[132:135], v[52:55]
  v_mfma_f32_16x16x32_bf16 v[56:59], v[128:131], a[128:131], v[56:59]
  v_mfma_f32_16x16x32_bf16 v[56:59], a[40:43], a[132:135], v[56:59]
  v_mfma_f32_16x16x32_bf16 v[60:63], v[132:135], a[128:131], v[60:63]
  v_cndmask_b32 v15, v12, v14, s[56:57]
  v_mfma_f32_16x16x32_bf16 v[60:63], a[44:47], a[132:135], v[60:63]
  s_waitcnt lgkmcnt(4)
  v_mfma_f32_16x16x32_bf16 v[40:43], v[136:139], a[136:139], v[40:43]
  ds_read_b128 a[128:131], v1 offset:12800
  v_mfma_f32_16x16x32_bf16 v[40:43], a[48:51], a[140:143], v[40:43]
  ds_read_b128 a[132:135], v2 offset:12800
  v_mfma_f32_16x16x32_bf16 v[44:47], v[140:143], a[136:139], v[44:47]
  s_add_u32 m0, s39, 16384
  v_mfma_f32_16x16x32_bf16 v[44:47], a[52:55], a[140:143], v[44:47]
  v_cvt_pk_bf16_f32 v32, v32, v33
  v_mfma_f32_16x16x32_bf16 v[48:51], v[144:147], a[136:139], v[48:51]
  buffer_load_dwordx4 v15, s[4:7], s22 offen nt lds
  v_mfma_f32_16x16x32_bf16 v[48:51], a[56:59], a[140:143], v[48:51]
  v_cvt_pk_bf16_f32 v33, v34, v35
  v_mfma_f32_16x16x32_bf16 v[52:55], v[148:151], a[136:139], v[52:55]
  v_cvt_pk_bf16_f32 v34, v36, v37
  v_mfma_f32_16x16x32_bf16 v[52:55], a[60:63], a[140:143], v[52:55]
  v_cvt_pk_bf16_f32 v35, v38, v39
  v_mfma_f32_16x16x32_bf16 v[56:59], v[152:155], a[136:139], v[56:59]
  ds_write_b128 v86, v[32:35] offset:128
  v_mfma_f32_16x16x32_bf16 v[56:59], a[64:67], a[140:143], v[56:59]
  v_mfma_f32_16x16x32_bf16 v[60:63], v[156:159], a[136:139], v[60:63]
  v_mfma_f32_16x16x32_bf16 v[60:63], a[68:71], a[140:143], v[60:63]
  s_waitcnt lgkmcnt(4)
  v_mfma_f32_16x16x32_bf16 v[40:43], v[160:163], a[120:123], v[40:43]
  ds_read_b128 a[136:139], v3 offset:12800
  v_mfma_f32_16x16x32_bf16 v[40:43], a[72:75], a[124:127], v[40:43]
  ds_read_b128 a[140:143], v4 offset:12800
  v_mfma_f32_16x16x32_bf16 v[44:47], v[164:167], a[120:123], v[44:47]
  v_mfma_f32_16x16x32_bf16 v[44:47], a[76:79], a[124:127], v[44:47]
  s_add_u32 m0, s39, 20480
  v_mfma_f32_16x16x32_bf16 v[48:51], v[168:171], a[120:123], v[48:51]
  buffer_load_dwordx4 v13, s[4:7], s77 offen nt lds
  v_mfma_f32_16x16x32_bf16 v[48:51], a[80:83], a[124:127], v[48:51]
  v_mfma_f32_16x16x32_bf16 v[52:55], v[172:175], a[120:123], v[52:55]
  v_mfma_f32_16x16x32_bf16 v[52:55], a[84:87], a[124:127], v[52:55]
  v_mfma_f32_16x16x32_bf16 v[56:59], v[176:179], a[120:123], v[56:59]
  v_mfma_f32_16x16x32_bf16 v[56:59], a[88:91], a[124:127], v[56:59]
  v_mfma_f32_16x16x32_bf16 v[60:63], v[180:183], a[120:123], v[60:63]
  v_mfma_f32_16x16x32_bf16 v[60:63], a[92:95], a[124:127], v[60:63]
  s_waitcnt vmcnt(10) lgkmcnt(2)
  s_barrier
  s_waitcnt lgkmcnt(3)
  v_mfma_f32_16x16x32_bf16 v[40:43], v[184:187], a[128:131], v[40:43]
  ds_read_b128 a[120:123], v1 offset:24576
  v_mfma_f32_16x16x32_bf16 v[40:43], a[96:99], a[132:135], v[40:43]
  ds_read_b128 a[124:127], v2 offset:24576
  v_mfma_f32_16x16x32_bf16 v[44:47], v[188:191], a[128:131], v[44:47]
  ds_read_b128 a[156:159], v5 offset:12288
  v_mfma_f32_16x16x32_bf16 v[44:47], a[100:103], a[132:135], v[44:47]
  ds_read_b128 a[160:163], v6 offset:12288
  v_mfma_f32_16x16x32_bf16 v[48:51], v[192:195], a[128:131], v[48:51]
  ds_read_b128 a[164:167], v7 offset:12288
  v_mfma_f32_16x16x32_bf16 v[48:51], a[104:107], a[132:135], v[48:51]
  ds_read_b128 a[144:147], v5 offset:0
  v_mfma_f32_16x16x32_bf16 v[52:55], v[196:199], a[128:131], v[52:55]
  ds_read_b128 a[148:151], v6 offset:0
  v_mfma_f32_16x16x32_bf16 v[52:55], a[108:111], a[132:135], v[52:55]
  ds_read_b128 a[152:155], v7 offset:0
  v_mfma_f32_16x16x32_bf16 v[56:59], v[200:203], a[128:131], v[56:59]
  v_mfma_f32_16x16x32_bf16 v[56:59], a[112:115], a[132:135], v[56:59]
  v_mfma_f32_16x16x32_bf16 v[60:63], v[204:207], a[128:131], v[60:63]
  v_mfma_f32_16x16x32_bf16 v[60:63], a[116:119], a[132:135], v[60:63]
  s_waitcnt lgkmcnt(8)
  v_mfma_f32_16x16x32_bf16 v[40:43], v[208:211], a[136:139], v[40:43]
  ds_read_b128 a[128:131], v3 offset:24576
  v_mfma_f32_16x16x32_bf16 v[40:43], v[232:235], a[140:143], v[40:43]
  ds_read_b128 a[132:135], v4 offset:24576
  v_mfma_f32_16x16x32_bf16 v[44:47], v[212:215], a[136:139], v[44:47]
  s_waitcnt lgkmcnt(7)
  buffer_store_dwordx4 a[156:159], v83, s[8:11], s59 offen sc1
  v_mfma_f32_16x16x32_bf16 v[44:47], v[236:239], a[140:143], v[44:47]
  v_mfma_f32_16x16x32_bf16 v[48:51], v[216:219], a[136:139], v[48:51]
  v_mfma_f32_16x16x32_bf16 v[48:51], v[240:243], a[140:143], v[48:51]
  v_mfma_f32_16x16x32_bf16 v[52:55], v[220:223], a[136:139], v[52:55]
  v_mfma_f32_16x16x32_bf16 v[52:55], v[244:247], a[140:143], v[52:55]
  v_mfma_f32_16x16x32_bf16 v[56:59], v[224:227], a[136:139], v[56:59]
  s_waitcnt lgkmcnt(6)
  buffer_store_dwordx4 a[160:163], v65, s[8:11], s62 offen sc1
  v_mfma_f32_16x16x32_bf16 v[56:59], v[248:251], a[140:143], v[56:59]
  v_mfma_f32_16x16x32_bf16 v[60:63], v[228:231], a[136:139], v[60:63]
  v_mfma_f32_16x16x32_bf16 v[60:63], v[252:255], a[140:143], v[60:63]
  s_waitcnt lgkmcnt(8)
  v_mfma_f32_16x16x32_bf16 v[16:19], v[88:91], a[120:123], 0
  ds_read_b128 a[136:139], v1 offset:24832
  v_mfma_f32_16x16x32_bf16 v[16:19], a[0:3], a[124:127], v[16:19]
  ds_read_b128 a[140:143], v2 offset:24832
  v_mfma_f32_16x16x32_bf16 v[20:23], v[92:95], a[120:123], 0
  v_mfma_f32_16x16x32_bf16 v[20:23], a[4:7], a[124:127], v[20:23]
  v_cvt_pk_bf16_f32 v40, v40, v41
  v_mfma_f32_16x16x32_bf16 v[24:27], v[96:99], a[120:123], 0
  v_cvt_pk_bf16_f32 v41, v42, v43
  v_mfma_f32_16x16x32_bf16 v[24:27], a[8:11], a[124:127], v[24:27]
  v_cvt_pk_bf16_f32 v42, v44, v45
  v_mfma_f32_16x16x32_bf16 v[28:31], v[100:103], a[120:123], 0
  s_waitcnt lgkmcnt(7)
  buffer_store_dwordx4 a[164:167], v85, s[8:11], s63 offen sc1
  v_mfma_f32_16x16x32_bf16 v[28:31], a[12:15], a[124:127], v[28:31]
  v_cvt_pk_bf16_f32 v43, v46, v47
  v_mfma_f32_16x16x32_bf16 v[32:35], v[104:107], a[120:123], 0
  ds_write_b128 v86, v[40:43] offset:36864
  v_mfma_f32_16x16x32_bf16 v[32:35], a[16:19], a[124:127], v[32:35]
  v_mfma_f32_16x16x32_bf16 v[36:39], v[108:111], a[120:123], 0
  v_mfma_f32_16x16x32_bf16 v[36:39], a[20:23], a[124:127], v[36:39]
  s_waitcnt lgkmcnt(3)
  v_mfma_f32_16x16x32_bf16 v[16:19], v[112:115], a[128:131], v[16:19]
  ds_read_b128 a[120:123], v3 offset:24832
  v_mfma_f32_16x16x32_bf16 v[16:19], a[24:27], a[132:135], v[16:19]
  ds_read_b128 a[124:127], v4 offset:24832
  v_mfma_f32_16x16x32_bf16 v[20:23], v[116:119], a[128:131], v[20:23]
  v_mfma_f32_16x16x32_bf16 v[20:23], a[28:31], a[132:135], v[20:23]
  v_cvt_pk_bf16_f32 v48, v48, v49
  v_mfma_f32_16x16x32_bf16 v[24:27], v[120:123], a[128:131], v[24:27]
  buffer_store_dwordx4 a[144:147], v80, s[8:11], s58 offen sc1
  v_mfma_f32_16x16x32_bf16 v[24:27], a[32:35], a[132:135], v[24:27]
  v_cvt_pk_bf16_f32 v49, v50, v51
  v_mfma_f32_16x16x32_bf16 v[28:31], v[124:127], a[128:131], v[28:31]
  v_cvt_pk_bf16_f32 v50, v52, v53
  v_mfma_f32_16x16x32_bf16 v[28:31], a[36:39], a[132:135], v[28:31]
  v_cvt_pk_bf16_f32 v51, v54, v55
  v_mfma_f32_16x16x32_bf16 v[32:35], v[128:131], a[128:131], v[32:35]
  ds_write_b128 v87, v[48:51] offset:36864
  v_mfma_f32_16x16x32_bf16 v[32:35], a[40:43], a[132:135], v[32:35]
  v_mfma_f32_16x16x32_bf16 v[36:39], v[132:135], a[128:131], v[36:39]
  v_mfma_f32_16x16x32_bf16 v[36:39], a[44:47], a[132:135], v[36:39]
  s_waitcnt lgkmcnt(4)
  v_mfma_f32_16x16x32_bf16 v[16:19], v[136:139], a[136:139], v[16:19]
  ds_read_b128 a[128:131], v1 offset:25088
  v_mfma_f32_16x16x32_bf16 v[16:19], a[48:51], a[140:143], v[16:19]
  ds_read_b128 a[132:135], v2 offset:25088
  v_mfma_f32_16x16x32_bf16 v[20:23], v[140:143], a[136:139], v[20:23]
  v_mfma_f32_16x16x32_bf16 v[20:23], a[52:55], a[140:143], v[20:23]
  v_mfma_f32_16x16x32_bf16 v[24:27], v[144:147], a[136:139], v[24:27]
  buffer_store_dwordx4 a[148:151], v81, s[8:11], s58 offen sc1
  v_mfma_f32_16x16x32_bf16 v[24:27], a[56:59], a[140:143], v[24:27]
  v_mfma_f32_16x16x32_bf16 v[28:31], v[148:151], a[136:139], v[28:31]
  v_mfma_f32_16x16x32_bf16 v[28:31], a[60:63], a[140:143], v[28:31]
  v_mfma_f32_16x16x32_bf16 v[32:35], v[152:155], a[136:139], v[32:35]
  v_mfma_f32_16x16x32_bf16 v[32:35], a[64:67], a[140:143], v[32:35]
  v_mfma_f32_16x16x32_bf16 v[36:39], v[156:159], a[136:139], v[36:39]
  v_mfma_f32_16x16x32_bf16 v[36:39], a[68:71], a[140:143], v[36:39]
  s_waitcnt lgkmcnt(3)
  v_mfma_f32_16x16x32_bf16 v[16:19], v[160:163], a[120:123], v[16:19]
  ds_read_b128 a[136:139], v3 offset:25088
  v_mfma_f32_16x16x32_bf16 v[16:19], a[72:75], a[124:127], v[16:19]
  ds_read_b128 a[140:143], v4 offset:25088
  v_mfma_f32_16x16x32_bf16 v[20:23], v[164:167], a[120:123], v[20:23]
  v_cvt_pk_bf16_f32 v56, v56, v57
  v_mfma_f32_16x16x32_bf16 v[20:23], a[76:79], a[124:127], v[20:23]
  v_cvt_pk_bf16_f32 v57, v58, v59
  v_mfma_f32_16x16x32_bf16 v[24:27], v[168:171], a[120:123], v[24:27]
  buffer_store_dwordx4 a[152:155], v82, s[8:11], s58 offen sc1
  v_mfma_f32_16x16x32_bf16 v[24:27], a[80:83], a[124:127], v[24:27]
  s_mov_b64 s[82:83], s[80:81]
  v_cvt_pk_bf16_f32 v58, v60, v61
  v_mfma_f32_16x16x32_bf16 v[28:31], v[172:175], a[120:123], v[28:31]
  s_mov_b64 s[80:81], s[78:79]
  v_cvt_pk_bf16_f32 v59, v62, v63
  v_mfma_f32_16x16x32_bf16 v[28:31], a[84:87], a[124:127], v[28:31]
  ds_write_b128 v86, v[56:59] offset:36992
  v_mfma_f32_16x16x32_bf16 v[32:35], v[176:179], a[120:123], v[32:35]
  s_mov_b64 s[78:79], s[76:77]
  s_add_u32 s76, s33, s32
  v_mfma_f32_16x16x32_bf16 v[32:35], a[88:91], a[124:127], v[32:35]
  s_xor_b32 s76, s76, s34
  s_add_u32 s77, s32, 24576
  v_mfma_f32_16x16x32_bf16 v[36:39], v[180:183], a[120:123], v[36:39]
  s_cmp_lt_u32 s32, s35
  s_cselect_b32 s22, s32, s40
  v_mfma_f32_16x16x32_bf16 v[36:39], a[92:95], a[124:127], v[36:39]
  s_cselect_b32 s77, s77, s40
  s_waitcnt lgkmcnt(3)
  v_mfma_f32_16x16x32_bf16 v[16:19], v[184:187], a[128:131], v[16:19]
  ds_read_b128 a[120:123], v1 offset:36864
  s_bitcmp1_b32 s76, 21
  v_mfma_f32_16x16x32_bf16 v[16:19], a[96:99], a[132:135], v[16:19]
  ds_read_b128 a[124:127], v2 offset:36864
  s_cselect_b32 s76, s77, s22
  v_mfma_f32_16x16x32_bf16 v[20:23], v[188:191], a[128:131], v[20:23]
  s_cselect_b32 s77, s22, s77
  s_cselect_b64 s[56:57], -1, 0
  v_mfma_f32_16x16x32_bf16 v[20:23], a[100:103], a[132:135], v[20:23]
  s_add_u32 s32, s32, 786432
  s_add_u32 m0, s39, 24576
  v_mfma_f32_16x16x32_bf16 v[24:27], v[192:195], a[128:131], v[24:27]
  buffer_load_dwordx4 v8, s[4:7], s76 offen nt lds
  v_mfma_f32_16x16x32_bf16 v[24:27], a[104:107], a[132:135], v[24:27]
  s_mov_b32 s58, s80
  s_mov_b32 s59, s82
  v_mfma_f32_16x16x32_bf16 v[28:31], v[196:199], a[128:131], v[28:31]
  s_mov_b32 s63, s83
  s_min_u32 s62, s82, s83
  v_mfma_f32_16x16x32_bf16 v[28:31], a[108:111], a[132:135], v[28:31]
  s_cmp_gt_u32 s82, s83
  s_cselect_b64 s[90:91], -1, 0
  v_mfma_f32_16x16x32_bf16 v[32:35], v[200:203], a[128:131], v[32:35]
  v_cndmask_b32 v65, v84, v64, s[90:91]
  v_mfma_f32_16x16x32_bf16 v[32:35], a[112:115], a[132:135], v[32:35]
  v_mfma_f32_16x16x32_bf16 v[36:39], v[204:207], a[128:131], v[36:39]
  v_mfma_f32_16x16x32_bf16 v[36:39], a[116:119], a[132:135], v[36:39]
  s_waitcnt lgkmcnt(3)
  v_mfma_f32_16x16x32_bf16 v[16:19], v[208:211], a[136:139], v[16:19]
  ds_read_b128 a[128:131], v3 offset:36864
  v_mfma_f32_16x16x32_bf16 v[16:19], v[232:235], a[140:143], v[16:19]
  ds_read_b128 a[132:135], v4 offset:36864
  v_mfma_f32_16x16x32_bf16 v[20:23], v[212:215], a[136:139], v[20:23]
  v_mfma_f32_16x16x32_bf16 v[20:23], v[236:239], a[140:143], v[20:23]
  s_add_u32 m0, s39, 28672
  v_mfma_f32_16x16x32_bf16 v[24:27], v[216:219], a[136:139], v[24:27]
  buffer_load_dwordx4 v9, s[4:7], s76 offen nt lds
  v_mfma_f32_16x16x32_bf16 v[24:27], v[240:243], a[140:143], v[24:27]
  v_mfma_f32_16x16x32_bf16 v[28:31], v[220:223], a[136:139], v[28:31]
  v_mfma_f32_16x16x32_bf16 v[28:31], v[244:247], a[140:143], v[28:31]
  v_mfma_f32_16x16x32_bf16 v[32:35], v[224:227], a[136:139], v[32:35]
  v_mfma_f32_16x16x32_bf16 v[32:35], v[248:251], a[140:143], v[32:35]
  v_mfma_f32_16x16x32_bf16 v[36:39], v[228:231], a[136:139], v[36:39]
  v_mfma_f32_16x16x32_bf16 v[36:39], v[252:255], a[140:143], v[36:39]
  s_waitcnt lgkmcnt(2)
  v_mfma_f32_16x16x32_bf16 v[40:43], v[88:91], a[120:123], 0
  ds_read_b128 a[136:139], v1 offset:37120
  v_mfma_f32_16x16x32_bf16 v[40:43], a[0:3], a[124:127], v[40:43]
  ds_read_b128 a[140:143], v2 offset:37120
  v_mfma_f32_16x16x32_bf16 v[44:47], v[92:95], a[120:123], 0
  s_add_u32 m0, s39, 32768
  v_mfma_f32_16x16x32_bf16 v[44:47], a[4:7], a[124:127], v[44:47]
  v_cvt_pk_bf16_f32 v16, v16, v17
  v_mfma_f32_16x16x32_bf16 v[48:51], v[96:99], a[120:123], 0
  buffer_load_dwordx4 v10, s[4:7], s76 offen nt lds
  v_mfma_f32_16x16x32_bf16 v[48:51], a[8:11], a[124:127], v[48:51]
  v_cvt_pk_bf16_f32 v17, v18, v19
  v_mfma_f32_16x16x32_bf16 v[52:55], v[100:103], a[120:123], 0
  v_cvt_pk_bf16_f32 v18, v20, v21
  v_mfma_f32_16x16x32_bf16 v[52:55], a[12:15], a[124:127], v[52:55]
  v_cvt_pk_bf16_f32 v19, v22, v23
  v_mfma_f32_16x16x32_bf16 v[56:59], v[104:107], a[120:123], 0
  ds_write_b128 v86, v[16:19] offset:24576
  v_mfma_f32_16x16x32_bf16 v[56:59], a[16:19], a[124:127], v[56:59]
  s_add_u32 m0, s39, 36864
  v_mfma_f32_16x16x32_bf16 v[60:63], v[108:111], a[120:123], 0
  v_cvt_pk_bf16_f32 v24, v24, v25
  v_mfma_f32_16x16x32_bf16 v[60:63], a[20:23], a[124:127], v[60:63]
  s_waitcnt lgkmcnt(3)
  v_mfma_f32_16x16x32_bf16 v[40:43], v[112:115], a[128:131], v[40:43]
  ds_read_b128 a[120:123], v3 offset:37120
  v_mfma_f32_16x16x32_bf16 v[40:43], a[24:27], a[132:135], v[40:43]
  ds_read_b128 a[124:127], v4 offset:37120
  v_mfma_f32_16x16x32_bf16 v[44:47], v[116:119], a[128:131], v[44:47]
  v_cvt_pk_bf16_f32 v25, v26, v27
  v_mfma_f32_16x16x32_bf16 v[44:47], a[28:31], a[132:135], v[44:47]
  v_cvt_pk_bf16_f32 v26, v28, v29
  v_mfma_f32_16x16x32_bf16 v[48:51], v[120:123], a[128:131], v[48:51]
  buffer_load_dwordx4 v11, s[4:7], s76 offen nt lds
  v_mfma_f32_16x16x32_bf16 v[48:51], a[32:35], a[132:135], v[48:51]
  v_cvt_pk_bf16_f32 v27, v30, v31
  v_mfma_f32_16x16x32_bf16 v[52:55], v[124:127], a[128:131], v[52:55]
  ds_write_b128 v87, v[24:27] offset:24576
  v_mfma_f32_16x16x32_bf16 v[52:55], a[36:39], a[132:135], v[52:55]
  v_mfma_f32_16x16x32_bf16 v[56:59], v[128:131], a[128:131], v[56:59]
  v_mfma_f32_16x16x32_bf16 v[56:59], a[40:43], a[132:135], v[56:59]
  v_mfma_f32_16x16x32_bf16 v[60:63], v[132:135], a[128:131], v[60:63]
  v_cndmask_b32 v15, v12, v14, s[56:57]
  v_mfma_f32_16x16x32_bf16 v[60:63], a[44:47], a[132:135], v[60:63]
  s_waitcnt lgkmcnt(4)
  v_mfma_f32_16x16x32_bf16 v[40:43], v[136:139], a[136:139], v[40:43]
  ds_read_b128 a[128:131], v1 offset:37376
  v_mfma_f32_16x16x32_bf16 v[40:43], a[48:51], a[140:143], v[40:43]
  ds_read_b128 a[132:135], v2 offset:37376
  v_mfma_f32_16x16x32_bf16 v[44:47], v[140:143], a[136:139], v[44:47]
  s_add_u32 m0, s39, 40960
  v_mfma_f32_16x16x32_bf16 v[44:47], a[52:55], a[140:143], v[44:47]
  v_cvt_pk_bf16_f32 v32, v32, v33
  v_mfma_f32_16x16x32_bf16 v[48:51], v[144:147], a[136:139], v[48:51]
  buffer_load_dwordx4 v15, s[4:7], s22 offen nt lds
  v_mfma_f32_16x16x32_bf16 v[48:51], a[56:59], a[140:143], v[48:51]
  v_cvt_pk_bf16_f32 v33, v34, v35
  v_mfma_f32_16x16x32_bf16 v[52:55], v[148:151], a[136:139], v[52:55]
  v_cvt_pk_bf16_f32 v34, v36, v37
  v_mfma_f32_16x16x32_bf16 v[52:55], a[60:63], a[140:143], v[52:55]
  v_cvt_pk_bf16_f32 v35, v38, v39
  v_mfma_f32_16x16x32_bf16 v[56:59], v[152:155], a[136:139], v[56:59]
  ds_write_b128 v86, v[32:35] offset:24704
  v_mfma_f32_16x16x32_bf16 v[56:59], a[64:67], a[140:143], v[56:59]
  v_mfma_f32_16x16x32_bf16 v[60:63], v[156:159], a[136:139], v[60:63]
  v_mfma_f32_16x16x32_bf16 v[60:63], a[68:71], a[140:143], v[60:63]
  s_waitcnt lgkmcnt(4)
  v_mfma_f32_16x16x32_bf16 v[40:43], v[160:163], a[120:123], v[40:43]
  ds_read_b128 a[136:139], v3 offset:37376
  v_mfma_f32_16x16x32_bf16 v[40:43], a[72:75], a[124:127], v[40:43]
  ds_read_b128 a[140:143], v4 offset:37376
  v_mfma_f32_16x16x32_bf16 v[44:47], v[164:167], a[120:123], v[44:47]
  s_add_u32 m0, s39, 45056
  v_mfma_f32_16x16x32_bf16 v[44:47], a[76:79], a[124:127], v[44:47]
  s_xor_b32 s39, s39, 49152
  v_mfma_f32_16x16x32_bf16 v[48:51], v[168:171], a[120:123], v[48:51]
  buffer_load_dwordx4 v13, s[4:7], s77 offen nt lds
  v_mfma_f32_16x16x32_bf16 v[48:51], a[80:83], a[124:127], v[48:51]
  v_mfma_f32_16x16x32_bf16 v[52:55], v[172:175], a[120:123], v[52:55]
  v_mfma_f32_16x16x32_bf16 v[52:55], a[84:87], a[124:127], v[52:55]
  v_mfma_f32_16x16x32_bf16 v[56:59], v[176:179], a[120:123], v[56:59]
  v_mfma_f32_16x16x32_bf16 v[56:59], a[88:91], a[124:127], v[56:59]
  v_mfma_f32_16x16x32_bf16 v[60:63], v[180:183], a[120:123], v[60:63]
  v_mfma_f32_16x16x32_bf16 v[60:63], a[92:95], a[124:127], v[60:63]
  s_waitcnt vmcnt(12) lgkmcnt(2)
  s_barrier
  v_xor_b32 v1, 49152, v1
  v_xor_b32 v2, 49152, v2
  v_xor_b32 v3, 49152, v3
  v_xor_b32 v4, 49152, v4
  s_waitcnt lgkmcnt(3)
  v_mfma_f32_16x16x32_bf16 v[40:43], v[184:187], a[128:131], v[40:43]
  ds_read_b128 a[120:123], v1 offset:0
  v_mfma_f32_16x16x32_bf16 v[40:43], a[96:99], a[132:135], v[40:43]
  ds_read_b128 a[124:127], v2 offset:0
  v_mfma_f32_16x16x32_bf16 v[44:47], v[188:191], a[128:131], v[44:47]
  ds_read_b128 a[156:159], v5 offset:36864
  v_mfma_f32_16x16x32_bf16 v[44:47], a[100:103], a[132:135], v[44:47]
  ds_read_b128 a[160:163], v6 offset:36864
  v_mfma_f32_16x16x32_bf16 v[48:51], v[192:195], a[128:131], v[48:51]
  ds_read_b128 a[164:167], v7 offset:36864
  v_mfma_f32_16x16x32_bf16 v[48:51], a[104:107], a[132:135], v[48:51]
  ds_read_b128 a[144:147], v5 offset:24576
  v_mfma_f32_16x16x32_bf16 v[52:55], v[196:199], a[128:131], v[52:55]
  ds_read_b128 a[148:151], v6 offset:24576
  v_mfma_f32_16x16x32_bf16 v[52:55], a[108:111], a[132:135], v[52:55]
  ds_read_b128 a[152:155], v7 offset:24576
  v_mfma_f32_16x16x32_bf16 v[56:59], v[200:203], a[128:131], v[56:59]
  v_mfma_f32_16x16x32_bf16 v[56:59], a[112:115], a[132:135], v[56:59]
  v_mfma_f32_16x16x32_bf16 v[60:63], v[204:207], a[128:131], v[60:63]
  v_mfma_f32_16x16x32_bf16 v[60:63], a[116:119], a[132:135], v[60:63]
  s_waitcnt lgkmcnt(8)
  v_mfma_f32_16x16x32_bf16 v[40:43], v[208:211], a[136:139], v[40:43]
  ds_read_b128 a[128:131], v3 offset:0
  v_mfma_f32_16x16x32_bf16 v[40:43], v[232:235], a[140:143], v[40:43]
  ds_read_b128 a[132:135], v4 offset:0
  v_mfma_f32_16x16x32_bf16 v[44:47], v[212:215], a[136:139], v[44:47]
  s_waitcnt lgkmcnt(7)
  buffer_store_dwordx4 a[156:159], v83, s[8:11], s59 offen sc1
  v_mfma_f32_16x16x32_bf16 v[44:47], v[236:239], a[140:143], v[44:47]
  v_mfma_f32_16x16x32_bf16 v[48:51], v[216:219], a[136:139], v[48:51]
  v_mfma_f32_16x16x32_bf16 v[48:51], v[240:243], a[140:143], v[48:51]
  v_mfma_f32_16x16x32_bf16 v[52:55], v[220:223], a[136:139], v[52:55]
  v_mfma_f32_16x16x32_bf16 v[52:55], v[244:247], a[140:143], v[52:55]
  v_mfma_f32_16x16x32_bf16 v[56:59], v[224:227], a[136:139], v[56:59]
  s_waitcnt lgkmcnt(6)
  buffer_store_dwordx4 a[160:163], v65, s[8:11], s62 offen sc1
  v_mfma_f32_16x16x32_bf16 v[56:59], v[248:251], a[140:143], v[56:59]
  v_mfma_f32_16x16x32_bf16 v[60:63], v[228:231], a[136:139], v[60:63]
  v_mfma_f32_16x16x32_bf16 v[60:63], v[252:255], a[140:143], v[60:63]
  s_cmp_lt_u32 s78, s40
  s_cbranch_scc1 L_loop
L_tail:
  s_nop 3
  v_cvt_pk_bf16_f32 v40, v40, v41
  v_cvt_pk_bf16_f32 v41, v42, v43
  v_cvt_pk_bf16_f32 v42, v44, v45
  v_cvt_pk_bf16_f32 v43, v46, v47
  ds_write_b128 v86, v[40:43] offset:12288
  v_cvt_pk_bf16_f32 v48, v48, v49
  v_cvt_pk_bf16_f32 v49, v50, v51
  v_cvt_pk_bf16_f32 v50, v52, v53
  v_cvt_pk_bf16_f32 v51, v54, v55
  ds_write_b128 v87, v[48:51] offset:12288
  v_cvt_pk_bf16_f32 v56, v56, v57
  v_cvt_pk_bf16_f32 v57, v58, v59
  v_cvt_pk_bf16_f32 v58, v60, v61
  v_cvt_pk_bf16_f32 v59, v62, v63
  ds_write_b128 v86, v[56:59] offset:12416
  s_waitcnt lgkmcnt(8)
  buffer_store_dwordx4 a[164:167], v85, s[8:11], s63 offen sc1
  s_waitcnt lgkmcnt(7)
  buffer_store_dwordx4 a[144:147], v80, s[8:11], s58 offen sc1
  s_waitcnt lgkmcnt(6)
  buffer_store_dwordx4 a[148:151], v81, s[8:11], s58 offen sc1
  s_waitcnt lgkmcnt(5)
  buffer_store_dwordx4 a[152:155], v82, s[8:11], s58 offen sc1
  s_mov_b32 s58, s78
  s_mov_b32 s59, s80
  s_mov_b32 s63, s81
  s_min_u32 s62, s80, s81
  s_cmp_gt_u32 s80, s81
  s_cselect_b64 s[90:91], -1, 0
  s_nop 0
  v_cndmask_b32 v65, v84, v64, s[90:91]
  s_waitcnt lgkmcnt(0)
  s_barrier
  ds_read_b128 a[120:123], v5 offset:12288
  ds_read_b128 a[124:127], v6 offset:12288
  ds_read_b128 a[128:131], v7 offset:12288
  s_waitcnt lgkmcnt(2)
  buffer_store_dwordx4 a[120:123], v83, s[8:11], s59 offen sc1
  s_waitcnt lgkmcnt(1)
  buffer_store_dwordx4 a[124:127], v65, s[8:11], s62 offen sc1
  s_waitcnt lgkmcnt(0)
  buffer_store_dwordx4 a[128:131], v85, s[8:11], s63 offen sc1
  s_endpgm
L_slow:
  v_mov_b32 v15, s36
  v_mov_b32 v254, 1
  v_mov_b32 v255, 0
  s_mov_b64 exec, 1
  buffer_atomic_cmpswap v[254:255], v15, s[16:19], 0 offen sc0 sc1
  s_waitcnt vmcnt(0)
  v_readfirstlane_b32 s34, v254
  s_mov_b64 exec, -1
  s_branch L_back
L_done:
  s_endpgm
.section .rodata,"a"
.p2align 6
.amdhsa_kernel standalone__depthwise_separable__vision_kernel
  .amdhsa_next_free_vgpr 512
  .amdhsa_next_free_sgpr 100
  .amdhsa_accum_offset 256
  .amdhsa_group_segment_fixed_size 0
  .amdhsa_kernarg_size 48
  .amdhsa_user_sgpr_count 2
  .amdhsa_user_sgpr_kernarg_segment_ptr 1
  .amdhsa_system_sgpr_workgroup_id_x 1
  .amdhsa_float_denorm_mode_32 3
.end_amdhsa_kernel
```

```asm
; @launch grid=(256,1,1) block=(256,1,1) lds=152128
.amdgcn_target "amdgcn-amd-amdhsa--gfx950"
.text
.globl standalone__depthwise_separable__vision_kernel
.p2align 8
.type standalone__depthwise_separable__vision_kernel,@function
standalone__depthwise_separable__vision_kernel:
  s_load_dwordx8 s[24:31], s[0:1], 0
  s_load_dwordx2 s[92:93], s[0:1], 32
  s_cmp_ge_u32 s2, 256
  s_cbranch_scc1 L_done
  v_lshrrev_b32 v16, 6, v0
  v_and_b32 v28, 63, v0
  v_readfirstlane_b32 s20, v16
  s_getpc_b64 s[50:51]
L_pc:
  v_mul_u32_u24 v18, 64, v0
  v_min_u32 v18, L_done-L_pc, v18
  v_mov_b32 v19, s51
  v_add_co_u32 v18, vcc, s50, v18
  s_nop 1
  v_addc_co_u32 v19, vcc, 0, v19, vcc
  global_load_dword v88, v[18:19], off
  s_lshr_b32 s50, s2, 3
  s_and_b32 s55, s50, 3
  s_lshr_b32 s54, s50, 2
  s_mul_i32 s51, s54, 11
  s_lshr_b32 s51, s51, 5
  s_mul_i32 s51, s51, 3
  s_sub_u32 s54, s54, s51
  s_mul_i32 s52, s20, 192
  v_mul_u32_u24 v18, 0xaaab, v28
  v_lshrrev_b32 v18, 19, v18
  v_mul_u32_u24 v19, 576, v18
  v_lshl_add_u32 v19, v28, 4, v19
  v_add_u32 v64, s52, v19
  v_add_u32 v17, 64, v28
  v_mul_u32_u24 v18, 0xaaab, v17
  v_lshrrev_b32 v18, 19, v18
  v_mul_u32_u24 v19, 576, v18
  v_lshl_add_u32 v19, v28, 4, v19
  v_lshrrev_b32 v18, 3, v18
  v_mul_u32_u24 v18, 6144, v18
  v_add_u32 v19, v19, v18
  v_add_u32 v65, s52, v19
  v_add_u32 v17, 128, v28
  v_mul_u32_u24 v18, 0xaaab, v17
  v_lshrrev_b32 v18, 19, v18
  v_mul_u32_u24 v19, 576, v18
  v_lshl_add_u32 v19, v28, 4, v19
  v_add_u32 v19, 6144, v19
  v_add_u32 v66, s52, v19
  s_mul_i32 s42, s54, 98304
  s_add_u32 s43, s42, 98304
  s_cmp_eq_u32 s54, 2
  s_cselect_b32 s43, 0, s43
  s_add_u32 s44, s43, 98304
  s_cmp_eq_u32 s54, 1
  s_cselect_b32 s44, 0, s44
  s_xor_b32 s45, s55, 0
  s_mul_i32 s45, s45, 24576
  s_xor_b32 s46, s55, 1
  s_mul_i32 s46, s46, 24576
  s_xor_b32 s47, s55, 2
  s_mul_i32 s47, s47, 24576
  s_xor_b32 s48, s55, 3
  s_mul_i32 s48, s48, 24576
  s_mul_i32 s49, s20, 6160
  s_lshl_b32 s53, s55, 2
  v_lshrrev_b32 v17, 4, v28
  v_add_u32 v18, s54, v17
  v_subrev_u32 v19, 3, v18
  v_min_u32 v18, v18, v19
  v_and_b32 v20, 15, v28
  v_xor_b32 v19, s53, v20
  v_lshlrev_b32 v19, 4, v19
  v_lshl_add_u32 v19, v18, 8, v19
  v_cmp_lt_u32 vcc, 47, v28
  s_lshl_b32 s50, s20, 10
  s_add_u32 m0, s50, 147968
  v_cndmask_b32 v19, v19, v66, vcc
  s_lshr_b32 s51, s2, 5
  s_and_b32 s52, s2, 3
  s_lshl2_add_u32 s36, s51, s52
  s_lshl_b32 s36, s36, 2
  s_mul_i32 s51, s51, 288
  s_lshl2_add_u32 s52, s55, s52
  s_add_u32 s51, s51, s52
  s_mul_i32 s32, s51, 49152
  s_add_u32 s35, s32, 14155776
  s_lshl_b32 s51, s20, 11
  s_and_b32 s52, s2, 4
  s_lshl_b32 s52, s52, 6
  s_add_u32 s51, s51, s52
  s_add_u32 s37, s32, s51
  s_add_u32 s37, s37, 7077888
  s_add_u32 s38, s37, 8192
  s_and_b32 s23, s2, 28
  s_cmp_lg_u32 s23, 0
  s_waitcnt lgkmcnt(0)
  s_cbranch_scc1 L_np0
  s_load_dword s84, s[24:25], s37 glc
  s_load_dword s85, s[24:25], s38 glc
L_np0:
  s_mov_b32 s16, s26
  s_and_b32 s17, s27, 0xffff
  s_mov_b32 s18, 768
  s_mov_b32 s19, 0x00020000
  s_mov_b32 s12, s28
  s_and_b32 s13, s29, 0xffff
  s_mov_b32 s14, 294912
  s_mov_b32 s15, 0x00020000
  buffer_load_dwordx4 v19, s[16:19], 0 offen lds
  s_add_u32 m0, s49, 98560
  s_add_u32 s50, s42, s45
  buffer_load_dwordx4 v64, s[12:15], s50 offen offset:0 lds
  buffer_load_dwordx4 v65, s[12:15], s50 offen offset:1024 lds
  buffer_load_dwordx4 v66, s[12:15], s50 offen offset:2048 lds
  s_add_u32 m0, s49, 101640
  s_add_u32 s50, s50, 6144
  buffer_load_dwordx4 v64, s[12:15], s50 offen offset:0 lds
  buffer_load_dwordx4 v65, s[12:15], s50 offen offset:1024 lds
  buffer_load_dwordx4 v66, s[12:15], s50 offen offset:2048 lds
  s_add_u32 m0, s49, 123200
  s_add_u32 s50, s42, s46
  buffer_load_dwordx4 v64, s[12:15], s50 offen offset:0 lds
  buffer_load_dwordx4 v65, s[12:15], s50 offen offset:1024 lds
  buffer_load_dwordx4 v66, s[12:15], s50 offen offset:2048 lds
  s_add_u32 m0, s49, 126280
  s_add_u32 s50, s50, 6144
  buffer_load_dwordx4 v64, s[12:15], s50 offen offset:0 lds
  buffer_load_dwordx4 v65, s[12:15], s50 offen offset:1024 lds
  buffer_load_dwordx4 v66, s[12:15], s50 offen offset:2048 lds
  s_mov_b32 s4, s24
  s_and_b32 s5, s25, 0xffff
  s_mov_b32 s6, 113246208
  s_mov_b32 s7, 0x00020000
  s_add_u32 s33, s24, 24576
  s_mov_b32 s40, 113246208
  s_lshl_b32 s39, s20, 10
  s_mov_b32 s76, s40
  s_mov_b32 s77, s40
  s_mov_b32 s78, s40
  s_mov_b32 s79, s40
  s_mov_b32 s80, s40
  s_mov_b32 s81, s40
  s_lshr_b32 s34, s2, 1
  s_xor_b32 s34, s34, s2
  s_and_b32 s34, s34, 4
  s_lshl_b32 s34, s34, 19
  v_lshrrev_b32 v35, 4, v0
  v_xor_b32 v22, s53, v20
  v_mul_u32_u24 v32, 43, v35
  v_lshrrev_b32 v32, 7, v32
  v_mul_u32_u24 v18, 3, v32
  v_sub_u32 v19, v35, v18
  v_add_u32 v19, s54, v19
  v_subrev_u32 v21, 3, v19
  v_min_u32 v19, v19, v21
  v_add_u32 v19, v19, v18
  v_xor_b32 v21, v32, v22
  v_lshlrev_b32 v21, 4, v21
  v_lshl_add_u32 v8, v19, 8, v21
  v_add_u32 v11, 19968, v8
  v_add_u32 v36, 16, v35
  v_mul_u32_u24 v33, 43, v36
  v_lshrrev_b32 v33, 7, v33
  v_mul_u32_u24 v18, 3, v33
  v_sub_u32 v19, v36, v18
  v_add_u32 v19, s54, v19
  v_subrev_u32 v21, 3, v19
  v_min_u32 v19, v19, v21
  v_add_u32 v19, v19, v18
  v_xor_b32 v21, v33, v22
  v_lshlrev_b32 v21, 4, v21
  v_lshl_add_u32 v9, v19, 8, v21
  v_cmp_lt_u32 vcc, 5, v33
  v_add_u32 v24, 19968, v9
  v_add_u32 v25, 28416, v9
  v_cndmask_b32 v12, v24, v25, vcc
  v_add_u32 v24, 44544, v9
  v_add_u32 v25, 3840, v9
  v_cndmask_b32 v14, v24, v25, vcc
  v_add_u32 v37, 32, v35
  v_mul_u32_u24 v34, 43, v37
  v_lshrrev_b32 v34, 7, v34
  v_mul_u32_u24 v18, 3, v34
  v_sub_u32 v19, v37, v18
  v_add_u32 v19, s54, v19
  v_subrev_u32 v21, 3, v19
  v_min_u32 v19, v19, v21
  v_add_u32 v19, v19, v18
  v_xor_b32 v21, v34, v22
  v_lshlrev_b32 v21, 4, v21
  v_lshl_add_u32 v10, v19, 8, v21
  v_cmp_lt_u32 vcc, 10, v34
  v_add_u32 v24, 7680, v10
  v_add_u32 v13, 3840, v10
  v_cndmask_b32 v10, v10, v24, vcc
  s_mov_b32 s8, s30
  s_and_b32 s9, s31, 0xffff
  s_mov_b32 s10, 113246208
  s_mov_b32 s11, 0x00020000
  v_lshlrev_b32 v80, 4, v0
  v_and_b32 v21, 7, v32
  v_xor_b32 v21, v21, v20
  v_lshlrev_b32 v21, 4, v21
  v_lshl_add_u32 v21, v35, 8, v21
  v_add_u32 v5, 98560, v21
  v_add_u32 v81, 4096, v80
  v_and_b32 v21, 7, v33
  v_xor_b32 v21, v21, v20
  v_lshlrev_b32 v21, 4, v21
  v_lshl_add_u32 v21, v36, 8, v21
  v_add_u32 v6, 98560, v21
  v_add_u32 v82, 8192, v80
  v_and_b32 v21, 7, v34
  v_xor_b32 v21, v21, v20
  v_lshlrev_b32 v21, 4, v21
  v_lshl_add_u32 v21, v37, 8, v21
  v_add_u32 v7, 98560, v21
  v_add_u32 v83, 19968, v80
  v_cmp_lt_u32 vcc, 5, v33
  v_add_u32 v24, 19968, v81
  v_add_u32 v25, 28416, v81
  v_cndmask_b32 v84, v24, v25, vcc
  v_cmp_lt_u32 vcc, 10, v34
  v_add_u32 v24, 7680, v82
  v_add_u32 v85, 3840, v82
  v_cndmask_b32 v82, v82, v24, vcc
  v_mul_u32_u24 v16, 0x300, v20
  v_xor_b32 v18, v17, v20
  v_lshl_add_u32 v1, v18, 4, v16
  v_xor_b32 v2, 64, v1
  v_xor_b32 v3, 128, v1
  v_xor_b32 v4, 192, v1
  s_mul_i32 s51, s20, 12
  v_and_b32 v18, 7, v20
  v_add_u32 v19, s51, v17
  v_xor_b32 v19, v19, v18
  v_lshl_add_u32 v86, v19, 4, v16
  v_add_u32 v86, 98560, v86
  v_add_u32 v19, s51, v17
  v_add_u32 v19, 4, v19
  v_xor_b32 v19, v19, v18
  v_lshl_add_u32 v87, v19, 4, v16
  v_add_u32 v87, 98560, v87
  v_bfe_u32 v18, v28, 2, 2
  v_and_b32 v19, 3, v28
  v_lshrrev_b32 v21, 1, v17
  v_lshl_add_u32 v21, v21, 3, v18
  v_mul_u32_u24 v21, 192, v21
  v_and_b32 v23, 1, v17
  v_mul_u32_u24 v23, 3080, v23
  v_add_u32 v21, v21, v23
  v_lshl_add_u32 v21, v19, 4, v21
  s_add_u32 s51, s49, 49152
  v_add_u32 v71, s51, v21
  v_add_u32 v67, 49408, v71
  s_add_u32 s51, s39, 147968
  v_lshl_add_u32 v68, v17, 4, s51
  v_and_b32 v21, 1, v28
  v_lshlrev_b32 v21, 4, v21
  v_mov_b32 v23, 0xffff
  v_lshlrev_b32 v21, v21, v23
  v_lshlrev_b32 v16, 1, v17
  v_bfe_u32 v23, v28, 1, 3
  v_cmp_eq_u32 vcc, v16, v23
  v_add_u32 v16, 1, v16
  s_nop 0
  v_cndmask_b32 v69, 0, v21, vcc
  v_cmp_eq_u32 vcc, v16, v23
  s_mov_b32 s16, s92
  s_and_b32 s17, s93, 0xffff
  s_mov_b32 s18, 256
  s_mov_b32 s19, 0x00020000
  v_cndmask_b32 v70, 0, v21, vcc
  s_cmp_lg_u32 s23, 0
  s_cbranch_scc1 L_npr
  s_mov_b32 s41, 0xffff
  s_mov_b32 s95, 0xffff
  s_lshl_b32 s52, s20, 2
  s_add_u32 s52, s52, 152064
  v_mov_b32 v16, s52
  s_waitcnt lgkmcnt(0)
  s_memtime s[84:85]
  s_load_dword s52, s[24:25], s37 glc
  s_waitcnt lgkmcnt(0)
  s_memtime s[86:87]
  s_load_dword s52, s[24:25], s38 glc
  s_waitcnt lgkmcnt(0)
  s_sub_u32 s51, s86, s84
  s_memtime s[84:85]
  s_min_u32 s41, s41, s51
  s_waitcnt lgkmcnt(0)
  s_sub_u32 s51, s84, s86
  s_min_u32 s95, s95, s51
  s_lshl_b32 s41, s41, 16
  s_or_b32 s41, s41, s95
  v_mov_b32 v18, s41
  ds_write_b32 v16, v18
  s_waitcnt lgkmcnt(0)
L_npr:
  s_add_u32 m0, s49, 49152
  s_add_u32 s50, s42, s47
  buffer_load_dwordx4 v64, s[12:15], s50 offen offset:0 lds
  buffer_load_dwordx4 v65, s[12:15], s50 offen offset:1024 lds
  buffer_load_dwordx4 v66, s[12:15], s50 offen offset:2048 lds
  s_add_u32 m0, s49, 52232
  s_add_u32 s50, s50, 6144
  buffer_load_dwordx4 v64, s[12:15], s50 offen offset:0 lds
  buffer_load_dwordx4 v65, s[12:15], s50 offen offset:1024 lds
  buffer_load_dwordx4 v66, s[12:15], s50 offen offset:2048 lds
  s_add_u32 m0, s49, 73792
  s_add_u32 s50, s42, s48
  buffer_load_dwordx4 v64, s[12:15], s50 offen offset:0 lds
  buffer_load_dwordx4 v65, s[12:15], s50 offen offset:1024 lds
  buffer_load_dwordx4 v66, s[12:15], s50 offen offset:2048 lds
  s_add_u32 m0, s49, 76872
  s_add_u32 s50, s50, 6144
  buffer_load_dwordx4 v64, s[12:15], s50 offen offset:0 lds
  buffer_load_dwordx4 v65, s[12:15], s50 offen offset:1024 lds
  buffer_load_dwordx4 v66, s[12:15], s50 offen offset:2048 lds
  s_waitcnt vmcnt(18)
  ds_read_b128 v[72:75], v68 offset:0
  ds_read_b64_tr_b16 a[192:193], v67 offset:0
  ds_read_b64_tr_b16 a[194:195], v67 offset:768
  ds_read_b64_tr_b16 a[196:197], v67 offset:8
  ds_read_b64_tr_b16 a[198:199], v67 offset:776
  ds_read_b64_tr_b16 a[200:201], v67 offset:64
  ds_read_b64_tr_b16 a[202:203], v67 offset:832
  ds_read_b64_tr_b16 a[204:205], v67 offset:72
  ds_read_b64_tr_b16 a[206:207], v67 offset:840
  ds_read_b64_tr_b16 a[208:209], v67 offset:128
  ds_read_b64_tr_b16 a[210:211], v67 offset:896
  ds_read_b64_tr_b16 a[212:213], v67 offset:136
  ds_read_b64_tr_b16 a[214:215], v67 offset:904
  s_waitcnt lgkmcnt(0)
  v_and_b32 v72, v69, v72
  v_and_b32 v73, v70, v73
  v_and_b32 v74, v69, v74
  v_and_b32 v75, v70, v75
  s_waitcnt vmcnt(12)
  ds_read_b128 v[76:79], v68 offset:64
  v_mfma_f32_16x16x16_bf16 v[16:19], v[72:73], a[192:193], 0
  ds_read_b64_tr_b16 a[216:217], v67 offset:24640
  ds_read_b64_tr_b16 a[218:219], v67 offset:25408
  v_mfma_f32_16x16x16_bf16 v[20:23], v[74:75], a[194:195], 0
  ds_read_b64_tr_b16 a[220:221], v67 offset:24648
  ds_read_b64_tr_b16 a[222:223], v67 offset:25416
  v_mfma_f32_16x16x16_bf16 v[24:27], v[72:73], a[196:197], 0
  ds_read_b64_tr_b16 a[224:225], v67 offset:24704
  ds_read_b64_tr_b16 a[226:227], v67 offset:25472
  v_mfma_f32_16x16x16_bf16 v[28:31], v[74:75], a[198:199], 0
  ds_read_b64_tr_b16 a[228:229], v67 offset:24712
  ds_read_b64_tr_b16 a[230:231], v67 offset:25480
  v_mfma_f32_16x16x16_bf16 v[32:35], v[72:73], a[200:201], 0
  ds_read_b64_tr_b16 a[232:233], v67 offset:24768
  ds_read_b64_tr_b16 a[234:235], v67 offset:25536
  v_cvt_pk_bf16_f32 v88, v16, v17
  v_cvt_pk_bf16_f32 v89, v18, v19
  v_mfma_f32_16x16x16_bf16 v[36:39], v[74:75], a[202:203], 0
  ds_read_b64_tr_b16 a[236:237], v67 offset:24776
  ds_read_b64_tr_b16 a[238:239], v67 offset:25544
  v_cvt_pk_bf16_f32 v90, v20, v21
  v_cvt_pk_bf16_f32 v91, v22, v23
  v_mfma_f32_16x16x16_bf16 v[40:43], v[72:73], a[204:205], 0
  s_add_u32 m0, s49, 98560
  s_add_u32 s50, s43, s45
  v_cvt_pk_bf16_f32 v92, v24, v25
  v_cvt_pk_bf16_f32 v93, v26, v27
  v_mfma_f32_16x16x16_bf16 v[44:47], v[74:75], a[206:207], 0
  buffer_load_dwordx4 v64, s[12:15], s50 offen offset:0 lds
  buffer_load_dwordx4 v65, s[12:15], s50 offen offset:1024 lds
  v_cvt_pk_bf16_f32 v94, v28, v29
  v_cvt_pk_bf16_f32 v95, v30, v31
  v_mfma_f32_16x16x16_bf16 v[48:51], v[72:73], a[208:209], 0
  buffer_load_dwordx4 v66, s[12:15], s50 offen offset:2048 lds
  s_add_u32 m0, s49, 101640
  v_cvt_pk_bf16_f32 v96, v32, v33
  v_cvt_pk_bf16_f32 v97, v34, v35
  v_mfma_f32_16x16x16_bf16 v[52:55], v[74:75], a[210:211], 0
  s_add_u32 s50, s50, 6144
  buffer_load_dwordx4 v64, s[12:15], s50 offen offset:0 lds
  v_cvt_pk_bf16_f32 v98, v36, v37
  v_cvt_pk_bf16_f32 v99, v38, v39
  v_mfma_f32_16x16x16_bf16 v[56:59], v[72:73], a[212:213], 0
  buffer_load_dwordx4 v65, s[12:15], s50 offen offset:1024 lds
  v_cvt_pk_bf16_f32 v100, v40, v41
  v_cvt_pk_bf16_f32 v101, v42, v43
  v_mfma_f32_16x16x16_bf16 v[60:63], v[74:75], a[214:215], 0
  buffer_load_dwordx4 v66, s[12:15], s50 offen offset:2048 lds
  v_cvt_pk_bf16_f32 v102, v44, v45
  v_cvt_pk_bf16_f32 v103, v46, v47
  s_cmp_lg_u32 s23, 0
  s_cbranch_scc1 L_np1
  s_barrier
  s_or_b32 s51, s23, s20
  s_cmp_lg_u32 s51, 0
  s_cbranch_scc1 L_np1
  v_mov_b32 v252, 152064
  ds_read_b128 v[248:251], v252
  s_add_u32 s51, s33, s37
  s_lshr_b32 s51, s51, 21
  s_lshr_b32 s52, s2, 2
  s_xor_b32 s51, s51, s52
  s_and_b32 s51, s51, 1
  s_add_u32 s52, s51, 1
  s_sub_u32 s51, 2, s51
  v_mov_b32 v254, s52
  v_mov_b32 v253, s51
  v_mov_b32 v255, 0
  v_mov_b32 v252, s36
  s_waitcnt lgkmcnt(0)
  v_pk_min_u16 v248, v248, v249
  v_pk_min_u16 v250, v250, v251
  v_pk_min_u16 v248, v248, v250
  v_lshrrev_b32 v249, 16, v248
  v_and_b32 v248, 0xffff, v248
  v_cmp_gt_u32 vcc, v249, v248
  s_mov_b64 exec, 1
  s_nop 0
  v_cndmask_b32 v254, v254, v253, vcc
  buffer_atomic_cmpswap v[254:255], v252, s[16:19], 0 offen sc1
  s_mov_b64 exec, -1
L_np1:
  s_waitcnt lgkmcnt(0)
  v_and_b32 v76, v69, v76
  v_and_b32 v77, v70, v77
  v_and_b32 v78, v69, v78
  v_and_b32 v79, v70, v79
  s_waitcnt vmcnt(12)
  ds_read_b128 v[72:75], v68 offset:128
  v_mfma_f32_16x16x16_bf16 v[16:19], v[76:77], a[216:217], 0
  ds_read_b64_tr_b16 a[192:193], v71 offset:0
  ds_read_b64_tr_b16 a[194:195], v71 offset:768
  v_cvt_pk_bf16_f32 v104, v48, v49
  v_cvt_pk_bf16_f32 v105, v50, v51
  v_mfma_f32_16x16x16_bf16 v[20:23], v[78:79], a[218:219], 0
  ds_read_b64_tr_b16 a[196:197], v71 offset:8
  ds_read_b64_tr_b16 a[198:199], v71 offset:776
  v_cvt_pk_bf16_f32 v106, v52, v53
  v_cvt_pk_bf16_f32 v107, v54, v55
  v_mfma_f32_16x16x16_bf16 v[24:27], v[76:77], a[220:221], 0
  ds_read_b64_tr_b16 a[200:201], v71 offset:64
  ds_read_b64_tr_b16 a[202:203], v71 offset:832
  v_cvt_pk_bf16_f32 v108, v56, v57
  v_cvt_pk_bf16_f32 v109, v58, v59
  v_mfma_f32_16x16x16_bf16 v[28:31], v[78:79], a[222:223], 0
  ds_read_b64_tr_b16 a[204:205], v71 offset:72
  ds_read_b64_tr_b16 a[206:207], v71 offset:840
  v_cvt_pk_bf16_f32 v110, v60, v61
  v_cvt_pk_bf16_f32 v111, v62, v63
  v_mfma_f32_16x16x16_bf16 v[32:35], v[76:77], a[224:225], 0
  ds_read_b64_tr_b16 a[208:209], v71 offset:128
  ds_read_b64_tr_b16 a[210:211], v71 offset:896
  v_cvt_pk_bf16_f32 v16, v16, v17
  v_cvt_pk_bf16_f32 v17, v18, v19
  v_accvgpr_write_b32 a0, v16
  v_accvgpr_write_b32 a1, v17
  v_mfma_f32_16x16x16_bf16 v[36:39], v[78:79], a[226:227], 0
  ds_read_b64_tr_b16 a[212:213], v71 offset:136
  ds_read_b64_tr_b16 a[214:215], v71 offset:904
  v_cvt_pk_bf16_f32 v20, v20, v21
  v_cvt_pk_bf16_f32 v21, v22, v23
  v_accvgpr_write_b32 a2, v20
  v_accvgpr_write_b32 a3, v21
  v_mfma_f32_16x16x16_bf16 v[40:43], v[76:77], a[228:229], 0
  s_add_u32 m0, s49, 123200
  s_add_u32 s50, s43, s46
  v_cvt_pk_bf16_f32 v24, v24, v25
  v_cvt_pk_bf16_f32 v25, v26, v27
  v_accvgpr_write_b32 a4, v24
  v_accvgpr_write_b32 a5, v25
  v_mfma_f32_16x16x16_bf16 v[44:47], v[78:79], a[230:231], 0
  buffer_load_dwordx4 v64, s[12:15], s50 offen offset:0 lds
  buffer_load_dwordx4 v65, s[12:15], s50 offen offset:1024 lds
  v_cvt_pk_bf16_f32 v28, v28, v29
  v_cvt_pk_bf16_f32 v29, v30, v31
  v_accvgpr_write_b32 a6, v28
  v_accvgpr_write_b32 a7, v29
  v_mfma_f32_16x16x16_bf16 v[48:51], v[76:77], a[232:233], 0
  buffer_load_dwordx4 v66, s[12:15], s50 offen offset:2048 lds
  s_add_u32 m0, s49, 126280
  v_cvt_pk_bf16_f32 v32, v32, v33
  v_cvt_pk_bf16_f32 v33, v34, v35
  v_accvgpr_write_b32 a8, v32
  v_accvgpr_write_b32 a9, v33
  v_mfma_f32_16x16x16_bf16 v[52:55], v[78:79], a[234:235], 0
  s_add_u32 s50, s50, 6144
  buffer_load_dwordx4 v64, s[12:15], s50 offen offset:0 lds
  v_cvt_pk_bf16_f32 v36, v36, v37
  v_cvt_pk_bf16_f32 v37, v38, v39
  v_accvgpr_write_b32 a10, v36
  v_accvgpr_write_b32 a11, v37
  v_mfma_f32_16x16x16_bf16 v[56:59], v[76:77], a[236:237], 0
  buffer_load_dwordx4 v65, s[12:15], s50 offen offset:1024 lds
  v_cvt_pk_bf16_f32 v40, v40, v41
  v_cvt_pk_bf16_f32 v41, v42, v43
  v_accvgpr_write_b32 a12, v40
  v_accvgpr_write_b32 a13, v41
  v_mfma_f32_16x16x16_bf16 v[60:63], v[78:79], a[238:239], 0
  buffer_load_dwordx4 v66, s[12:15], s50 offen offset:2048 lds
  v_cvt_pk_bf16_f32 v44, v44, v45
  v_cvt_pk_bf16_f32 v45, v46, v47
  v_accvgpr_write_b32 a14, v44
  v_accvgpr_write_b32 a15, v45
  s_waitcnt lgkmcnt(0)
  v_and_b32 v72, v69, v72
  v_and_b32 v73, v70, v73
  v_and_b32 v74, v69, v74
  v_and_b32 v75, v70, v75
  s_waitcnt vmcnt(12)
  ds_read_b128 v[76:79], v68 offset:192
  v_mfma_f32_16x16x16_bf16 v[16:19], v[72:73], a[192:193], 0
  ds_read_b64_tr_b16 a[216:217], v71 offset:24640
  ds_read_b64_tr_b16 a[218:219], v71 offset:25408
  v_cvt_pk_bf16_f32 v48, v48, v49
  v_cvt_pk_bf16_f32 v49, v50, v51
  v_accvgpr_write_b32 a16, v48
  v_accvgpr_write_b32 a17, v49
  v_mfma_f32_16x16x16_bf16 v[20:23], v[74:75], a[194:195], 0
  ds_read_b64_tr_b16 a[220:221], v71 offset:24648
  ds_read_b64_tr_b16 a[222:223], v71 offset:25416
  v_cvt_pk_bf16_f32 v52, v52, v53
  v_cvt_pk_bf16_f32 v53, v54, v55
  v_accvgpr_write_b32 a18, v52
  v_accvgpr_write_b32 a19, v53
  v_mfma_f32_16x16x16_bf16 v[24:27], v[72:73], a[196:197], 0
  ds_read_b64_tr_b16 a[224:225], v71 offset:24704
  ds_read_b64_tr_b16 a[226:227], v71 offset:25472
  v_cvt_pk_bf16_f32 v56, v56, v57
  v_cvt_pk_bf16_f32 v57, v58, v59
  v_accvgpr_write_b32 a20, v56
  v_accvgpr_write_b32 a21, v57
  v_mfma_f32_16x16x16_bf16 v[28:31], v[74:75], a[198:199], 0
  ds_read_b64_tr_b16 a[228:229], v71 offset:24712
  ds_read_b64_tr_b16 a[230:231], v71 offset:25480
  v_cvt_pk_bf16_f32 v60, v60, v61
  v_cvt_pk_bf16_f32 v61, v62, v63
  v_accvgpr_write_b32 a22, v60
  v_accvgpr_write_b32 a23, v61
  v_mfma_f32_16x16x16_bf16 v[32:35], v[72:73], a[200:201], 0
  ds_read_b64_tr_b16 a[232:233], v71 offset:24768
  ds_read_b64_tr_b16 a[234:235], v71 offset:25536
  v_cvt_pk_bf16_f32 v112, v16, v17
  v_cvt_pk_bf16_f32 v113, v18, v19
  v_mfma_f32_16x16x16_bf16 v[36:39], v[74:75], a[202:203], 0
  ds_read_b64_tr_b16 a[236:237], v71 offset:24776
  ds_read_b64_tr_b16 a[238:239], v71 offset:25544
  v_cvt_pk_bf16_f32 v114, v20, v21
  v_cvt_pk_bf16_f32 v115, v22, v23
  v_mfma_f32_16x16x16_bf16 v[40:43], v[72:73], a[204:205], 0
  s_add_u32 m0, s49, 49152
  s_add_u32 s50, s43, s47
  v_cvt_pk_bf16_f32 v116, v24, v25
  v_cvt_pk_bf16_f32 v117, v26, v27
  v_mfma_f32_16x16x16_bf16 v[44:47], v[74:75], a[206:207], 0
  buffer_load_dwordx4 v64, s[12:15], s50 offen offset:0 lds
  buffer_load_dwordx4 v65, s[12:15], s50 offen offset:1024 lds
  v_cvt_pk_bf16_f32 v118, v28, v29
  v_cvt_pk_bf16_f32 v119, v30, v31
  v_mfma_f32_16x16x16_bf16 v[48:51], v[72:73], a[208:209], 0
  buffer_load_dwordx4 v66, s[12:15], s50 offen offset:2048 lds
  s_add_u32 m0, s49, 52232
  v_cvt_pk_bf16_f32 v120, v32, v33
  v_cvt_pk_bf16_f32 v121, v34, v35
  v_mfma_f32_16x16x16_bf16 v[52:55], v[74:75], a[210:211], 0
  s_add_u32 s50, s50, 6144
  buffer_load_dwordx4 v64, s[12:15], s50 offen offset:0 lds
  v_cvt_pk_bf16_f32 v122, v36, v37
  v_cvt_pk_bf16_f32 v123, v38, v39
  v_mfma_f32_16x16x16_bf16 v[56:59], v[72:73], a[212:213], 0
  buffer_load_dwordx4 v65, s[12:15], s50 offen offset:1024 lds
  v_cvt_pk_bf16_f32 v124, v40, v41
  v_cvt_pk_bf16_f32 v125, v42, v43
  v_mfma_f32_16x16x16_bf16 v[60:63], v[74:75], a[214:215], 0
  buffer_load_dwordx4 v66, s[12:15], s50 offen offset:2048 lds
  v_cvt_pk_bf16_f32 v126, v44, v45
  v_cvt_pk_bf16_f32 v127, v46, v47
  s_waitcnt lgkmcnt(0)
  v_and_b32 v76, v69, v76
  v_and_b32 v77, v70, v77
  v_and_b32 v78, v69, v78
  v_and_b32 v79, v70, v79
  s_waitcnt vmcnt(12)
  ds_read_b128 v[72:75], v68 offset:256
  v_mfma_f32_16x16x16_bf16 v[16:19], v[76:77], a[216:217], 0
  ds_read_b64_tr_b16 a[192:193], v67 offset:0
  ds_read_b64_tr_b16 a[194:195], v67 offset:768
  v_cvt_pk_bf16_f32 v128, v48, v49
  v_cvt_pk_bf16_f32 v129, v50, v51
  v_mfma_f32_16x16x16_bf16 v[20:23], v[78:79], a[218:219], 0
  ds_read_b64_tr_b16 a[196:197], v67 offset:8
  ds_read_b64_tr_b16 a[198:199], v67 offset:776
  v_cvt_pk_bf16_f32 v130, v52, v53
  v_cvt_pk_bf16_f32 v131, v54, v55
  v_mfma_f32_16x16x16_bf16 v[24:27], v[76:77], a[220:221], 0
  ds_read_b64_tr_b16 a[200:201], v67 offset:64
  ds_read_b64_tr_b16 a[202:203], v67 offset:832
  v_cvt_pk_bf16_f32 v132, v56, v57
  v_cvt_pk_bf16_f32 v133, v58, v59
  v_mfma_f32_16x16x16_bf16 v[28:31], v[78:79], a[222:223], 0
  ds_read_b64_tr_b16 a[204:205], v67 offset:72
  ds_read_b64_tr_b16 a[206:207], v67 offset:840
  v_cvt_pk_bf16_f32 v134, v60, v61
  v_cvt_pk_bf16_f32 v135, v62, v63
  v_mfma_f32_16x16x16_bf16 v[32:35], v[76:77], a[224:225], 0
  ds_read_b64_tr_b16 a[208:209], v67 offset:128
  ds_read_b64_tr_b16 a[210:211], v67 offset:896
  v_cvt_pk_bf16_f32 v16, v16, v17
  v_cvt_pk_bf16_f32 v17, v18, v19
  v_accvgpr_write_b32 a24, v16
  v_accvgpr_write_b32 a25, v17
  v_mfma_f32_16x16x16_bf16 v[36:39], v[78:79], a[226:227], 0
  ds_read_b64_tr_b16 a[212:213], v67 offset:136
  ds_read_b64_tr_b16 a[214:215], v67 offset:904
  v_cvt_pk_bf16_f32 v20, v20, v21
  v_cvt_pk_bf16_f32 v21, v22, v23
  v_accvgpr_write_b32 a26, v20
  v_accvgpr_write_b32 a27, v21
  v_mfma_f32_16x16x16_bf16 v[40:43], v[76:77], a[228:229], 0
  s_add_u32 m0, s49, 73792
  s_add_u32 s50, s43, s48
  v_cvt_pk_bf16_f32 v24, v24, v25
  v_cvt_pk_bf16_f32 v25, v26, v27
  v_accvgpr_write_b32 a28, v24
  v_accvgpr_write_b32 a29, v25
  v_mfma_f32_16x16x16_bf16 v[44:47], v[78:79], a[230:231], 0
  buffer_load_dwordx4 v64, s[12:15], s50 offen offset:0 lds
  buffer_load_dwordx4 v65, s[12:15], s50 offen offset:1024 lds
  v_cvt_pk_bf16_f32 v28, v28, v29
  v_cvt_pk_bf16_f32 v29, v30, v31
  v_accvgpr_write_b32 a30, v28
  v_accvgpr_write_b32 a31, v29
  v_mfma_f32_16x16x16_bf16 v[48:51], v[76:77], a[232:233], 0
  buffer_load_dwordx4 v66, s[12:15], s50 offen offset:2048 lds
  s_add_u32 m0, s49, 76872
  v_cvt_pk_bf16_f32 v32, v32, v33
  v_cvt_pk_bf16_f32 v33, v34, v35
  v_accvgpr_write_b32 a32, v32
  v_accvgpr_write_b32 a33, v33
  v_mfma_f32_16x16x16_bf16 v[52:55], v[78:79], a[234:235], 0
  s_add_u32 s50, s50, 6144
  buffer_load_dwordx4 v64, s[12:15], s50 offen offset:0 lds
  v_cvt_pk_bf16_f32 v36, v36, v37
  v_cvt_pk_bf16_f32 v37, v38, v39
  v_accvgpr_write_b32 a34, v36
  v_accvgpr_write_b32 a35, v37
  v_mfma_f32_16x16x16_bf16 v[56:59], v[76:77], a[236:237], 0
  buffer_load_dwordx4 v65, s[12:15], s50 offen offset:1024 lds
  v_cvt_pk_bf16_f32 v40, v40, v41
  v_cvt_pk_bf16_f32 v41, v42, v43
  v_accvgpr_write_b32 a36, v40
  v_accvgpr_write_b32 a37, v41
  v_mfma_f32_16x16x16_bf16 v[60:63], v[78:79], a[238:239], 0
  buffer_load_dwordx4 v66, s[12:15], s50 offen offset:2048 lds
  v_cvt_pk_bf16_f32 v44, v44, v45
  v_cvt_pk_bf16_f32 v45, v46, v47
  v_accvgpr_write_b32 a38, v44
  v_accvgpr_write_b32 a39, v45
  s_waitcnt lgkmcnt(0)
  v_and_b32 v72, v69, v72
  v_and_b32 v73, v70, v73
  v_and_b32 v74, v69, v74
  v_and_b32 v75, v70, v75
  s_waitcnt vmcnt(12)
  ds_read_b128 v[76:79], v68 offset:320
  v_mfma_f32_16x16x16_bf16 v[16:19], v[72:73], a[192:193], 0
  ds_read_b64_tr_b16 a[216:217], v67 offset:24640
  ds_read_b64_tr_b16 a[218:219], v67 offset:25408
  v_cvt_pk_bf16_f32 v48, v48, v49
  v_cvt_pk_bf16_f32 v49, v50, v51
  v_accvgpr_write_b32 a40, v48
  v_accvgpr_write_b32 a41, v49
  v_mfma_f32_16x16x16_bf16 v[20:23], v[74:75], a[194:195], 0
  ds_read_b64_tr_b16 a[220:221], v67 offset:24648
  ds_read_b64_tr_b16 a[222:223], v67 offset:25416
  v_cvt_pk_bf16_f32 v52, v52, v53
  v_cvt_pk_bf16_f32 v53, v54, v55
  v_accvgpr_write_b32 a42, v52
  v_accvgpr_write_b32 a43, v53
  v_mfma_f32_16x16x16_bf16 v[24:27], v[72:73], a[196:197], 0
  ds_read_b64_tr_b16 a[224:225], v67 offset:24704
  ds_read_b64_tr_b16 a[226:227], v67 offset:25472
  v_cvt_pk_bf16_f32 v56, v56, v57
  v_cvt_pk_bf16_f32 v57, v58, v59
  v_accvgpr_write_b32 a44, v56
  v_accvgpr_write_b32 a45, v57
  v_mfma_f32_16x16x16_bf16 v[28:31], v[74:75], a[198:199], 0
  ds_read_b64_tr_b16 a[228:229], v67 offset:24712
  ds_read_b64_tr_b16 a[230:231], v67 offset:25480
  v_cvt_pk_bf16_f32 v60, v60, v61
  v_cvt_pk_bf16_f32 v61, v62, v63
  v_accvgpr_write_b32 a46, v60
  v_accvgpr_write_b32 a47, v61
  v_mfma_f32_16x16x16_bf16 v[32:35], v[72:73], a[200:201], 0
  ds_read_b64_tr_b16 a[232:233], v67 offset:24768
  ds_read_b64_tr_b16 a[234:235], v67 offset:25536
  v_cvt_pk_bf16_f32 v136, v16, v17
  v_cvt_pk_bf16_f32 v137, v18, v19
  v_mfma_f32_16x16x16_bf16 v[36:39], v[74:75], a[202:203], 0
  ds_read_b64_tr_b16 a[236:237], v67 offset:24776
  ds_read_b64_tr_b16 a[238:239], v67 offset:25544
  v_cvt_pk_bf16_f32 v138, v20, v21
  v_cvt_pk_bf16_f32 v139, v22, v23
  v_mfma_f32_16x16x16_bf16 v[40:43], v[72:73], a[204:205], 0
  s_add_u32 m0, s49, 98560
  s_add_u32 s50, s44, s45
  v_cvt_pk_bf16_f32 v140, v24, v25
  v_cvt_pk_bf16_f32 v141, v26, v27
  v_mfma_f32_16x16x16_bf16 v[44:47], v[74:75], a[206:207], 0
  buffer_load_dwordx4 v64, s[12:15], s50 offen offset:0 lds
  buffer_load_dwordx4 v65, s[12:15], s50 offen offset:1024 lds
  v_cvt_pk_bf16_f32 v142, v28, v29
  v_cvt_pk_bf16_f32 v143, v30, v31
  v_mfma_f32_16x16x16_bf16 v[48:51], v[72:73], a[208:209], 0
  buffer_load_dwordx4 v66, s[12:15], s50 offen offset:2048 lds
  s_add_u32 m0, s49, 101640
  v_cvt_pk_bf16_f32 v144, v32, v33
  v_cvt_pk_bf16_f32 v145, v34, v35
  v_mfma_f32_16x16x16_bf16 v[52:55], v[74:75], a[210:211], 0
  s_add_u32 s50, s50, 6144
  buffer_load_dwordx4 v64, s[12:15], s50 offen offset:0 lds
  v_cvt_pk_bf16_f32 v146, v36, v37
  v_cvt_pk_bf16_f32 v147, v38, v39
  v_mfma_f32_16x16x16_bf16 v[56:59], v[72:73], a[212:213], 0
  buffer_load_dwordx4 v65, s[12:15], s50 offen offset:1024 lds
  v_cvt_pk_bf16_f32 v148, v40, v41
  v_cvt_pk_bf16_f32 v149, v42, v43
  v_mfma_f32_16x16x16_bf16 v[60:63], v[74:75], a[214:215], 0
  buffer_load_dwordx4 v66, s[12:15], s50 offen offset:2048 lds
  v_cvt_pk_bf16_f32 v150, v44, v45
  v_cvt_pk_bf16_f32 v151, v46, v47
  s_waitcnt lgkmcnt(0)
  v_and_b32 v76, v69, v76
  v_and_b32 v77, v70, v77
  v_and_b32 v78, v69, v78
  v_and_b32 v79, v70, v79
  s_waitcnt vmcnt(12)
  ds_read_b128 v[72:75], v68 offset:384
  v_mfma_f32_16x16x16_bf16 v[16:19], v[76:77], a[216:217], 0
  ds_read_b64_tr_b16 a[192:193], v71 offset:0
  ds_read_b64_tr_b16 a[194:195], v71 offset:768
  v_cvt_pk_bf16_f32 v152, v48, v49
  v_cvt_pk_bf16_f32 v153, v50, v51
  v_mfma_f32_16x16x16_bf16 v[20:23], v[78:79], a[218:219], 0
  ds_read_b64_tr_b16 a[196:197], v71 offset:8
  ds_read_b64_tr_b16 a[198:199], v71 offset:776
  v_cvt_pk_bf16_f32 v154, v52, v53
  v_cvt_pk_bf16_f32 v155, v54, v55
  v_mfma_f32_16x16x16_bf16 v[24:27], v[76:77], a[220:221], 0
  ds_read_b64_tr_b16 a[200:201], v71 offset:64
  ds_read_b64_tr_b16 a[202:203], v71 offset:832
  v_cvt_pk_bf16_f32 v156, v56, v57
  v_cvt_pk_bf16_f32 v157, v58, v59
  v_mfma_f32_16x16x16_bf16 v[28:31], v[78:79], a[222:223], 0
  ds_read_b64_tr_b16 a[204:205], v71 offset:72
  ds_read_b64_tr_b16 a[206:207], v71 offset:840
  v_cvt_pk_bf16_f32 v158, v60, v61
  v_cvt_pk_bf16_f32 v159, v62, v63
  v_mfma_f32_16x16x16_bf16 v[32:35], v[76:77], a[224:225], 0
  ds_read_b64_tr_b16 a[208:209], v71 offset:128
  ds_read_b64_tr_b16 a[210:211], v71 offset:896
  v_cvt_pk_bf16_f32 v16, v16, v17
  v_cvt_pk_bf16_f32 v17, v18, v19
  v_accvgpr_write_b32 a48, v16
  v_accvgpr_write_b32 a49, v17
  v_mfma_f32_16x16x16_bf16 v[36:39], v[78:79], a[226:227], 0
  ds_read_b64_tr_b16 a[212:213], v71 offset:136
  ds_read_b64_tr_b16 a[214:215], v71 offset:904
  v_cvt_pk_bf16_f32 v20, v20, v21
  v_cvt_pk_bf16_f32 v21, v22, v23
  v_accvgpr_write_b32 a50, v20
  v_accvgpr_write_b32 a51, v21
  v_mfma_f32_16x16x16_bf16 v[40:43], v[76:77], a[228:229], 0
  s_add_u32 m0, s49, 123200
  s_add_u32 s50, s44, s46
  v_cvt_pk_bf16_f32 v24, v24, v25
  v_cvt_pk_bf16_f32 v25, v26, v27
  v_accvgpr_write_b32 a52, v24
  v_accvgpr_write_b32 a53, v25
  v_mfma_f32_16x16x16_bf16 v[44:47], v[78:79], a[230:231], 0
  buffer_load_dwordx4 v64, s[12:15], s50 offen offset:0 lds
  buffer_load_dwordx4 v65, s[12:15], s50 offen offset:1024 lds
  v_cvt_pk_bf16_f32 v28, v28, v29
  v_cvt_pk_bf16_f32 v29, v30, v31
  v_accvgpr_write_b32 a54, v28
  v_accvgpr_write_b32 a55, v29
  v_mfma_f32_16x16x16_bf16 v[48:51], v[76:77], a[232:233], 0
  buffer_load_dwordx4 v66, s[12:15], s50 offen offset:2048 lds
  s_add_u32 m0, s49, 126280
  v_cvt_pk_bf16_f32 v32, v32, v33
  v_cvt_pk_bf16_f32 v33, v34, v35
  v_accvgpr_write_b32 a56, v32
  v_accvgpr_write_b32 a57, v33
  v_mfma_f32_16x16x16_bf16 v[52:55], v[78:79], a[234:235], 0
  s_add_u32 s50, s50, 6144
  buffer_load_dwordx4 v64, s[12:15], s50 offen offset:0 lds
  v_cvt_pk_bf16_f32 v36, v36, v37
  v_cvt_pk_bf16_f32 v37, v38, v39
  v_accvgpr_write_b32 a58, v36
  v_accvgpr_write_b32 a59, v37
  v_mfma_f32_16x16x16_bf16 v[56:59], v[76:77], a[236:237], 0
  buffer_load_dwordx4 v65, s[12:15], s50 offen offset:1024 lds
  v_cvt_pk_bf16_f32 v40, v40, v41
  v_cvt_pk_bf16_f32 v41, v42, v43
  v_accvgpr_write_b32 a60, v40
  v_accvgpr_write_b32 a61, v41
  v_mfma_f32_16x16x16_bf16 v[60:63], v[78:79], a[238:239], 0
  buffer_load_dwordx4 v66, s[12:15], s50 offen offset:2048 lds
  v_cvt_pk_bf16_f32 v44, v44, v45
  v_cvt_pk_bf16_f32 v45, v46, v47
  v_accvgpr_write_b32 a62, v44
  v_accvgpr_write_b32 a63, v45
  s_waitcnt lgkmcnt(0)
  v_and_b32 v72, v69, v72
  v_and_b32 v73, v70, v73
  v_and_b32 v74, v69, v74
  v_and_b32 v75, v70, v75
  s_waitcnt vmcnt(12)
  ds_read_b128 v[76:79], v68 offset:448
  v_mfma_f32_16x16x16_bf16 v[16:19], v[72:73], a[192:193], 0
  ds_read_b64_tr_b16 a[216:217], v71 offset:24640
  ds_read_b64_tr_b16 a[218:219], v71 offset:25408
  v_cvt_pk_bf16_f32 v48, v48, v49
  v_cvt_pk_bf16_f32 v49, v50, v51
  v_accvgpr_write_b32 a64, v48
  v_accvgpr_write_b32 a65, v49
  v_mfma_f32_16x16x16_bf16 v[20:23], v[74:75], a[194:195], 0
  ds_read_b64_tr_b16 a[220:221], v71 offset:24648
  ds_read_b64_tr_b16 a[222:223], v71 offset:25416
  v_cvt_pk_bf16_f32 v52, v52, v53
  v_cvt_pk_bf16_f32 v53, v54, v55
  v_accvgpr_write_b32 a66, v52
  v_accvgpr_write_b32 a67, v53
  v_mfma_f32_16x16x16_bf16 v[24:27], v[72:73], a[196:197], 0
  ds_read_b64_tr_b16 a[224:225], v71 offset:24704
  ds_read_b64_tr_b16 a[226:227], v71 offset:25472
  v_cvt_pk_bf16_f32 v56, v56, v57
  v_cvt_pk_bf16_f32 v57, v58, v59
  v_accvgpr_write_b32 a68, v56
  v_accvgpr_write_b32 a69, v57
  v_mfma_f32_16x16x16_bf16 v[28:31], v[74:75], a[198:199], 0
  ds_read_b64_tr_b16 a[228:229], v71 offset:24712
  ds_read_b64_tr_b16 a[230:231], v71 offset:25480
  v_cvt_pk_bf16_f32 v60, v60, v61
  v_cvt_pk_bf16_f32 v61, v62, v63
  v_accvgpr_write_b32 a70, v60
  v_accvgpr_write_b32 a71, v61
  v_mfma_f32_16x16x16_bf16 v[32:35], v[72:73], a[200:201], 0
  ds_read_b64_tr_b16 a[232:233], v71 offset:24768
  ds_read_b64_tr_b16 a[234:235], v71 offset:25536
  v_cvt_pk_bf16_f32 v160, v16, v17
  v_cvt_pk_bf16_f32 v161, v18, v19
  v_mfma_f32_16x16x16_bf16 v[36:39], v[74:75], a[202:203], 0
  ds_read_b64_tr_b16 a[236:237], v71 offset:24776
  ds_read_b64_tr_b16 a[238:239], v71 offset:25544
  v_cvt_pk_bf16_f32 v162, v20, v21
  v_cvt_pk_bf16_f32 v163, v22, v23
  v_mfma_f32_16x16x16_bf16 v[40:43], v[72:73], a[204:205], 0
  s_add_u32 m0, s49, 49152
  s_add_u32 s50, s44, s47
  v_cvt_pk_bf16_f32 v164, v24, v25
  v_cvt_pk_bf16_f32 v165, v26, v27
  v_mfma_f32_16x16x16_bf16 v[44:47], v[74:75], a[206:207], 0
  buffer_load_dwordx4 v64, s[12:15], s50 offen offset:0 lds
  buffer_load_dwordx4 v65, s[12:15], s50 offen offset:1024 lds
  v_cvt_pk_bf16_f32 v166, v28, v29
  v_cvt_pk_bf16_f32 v167, v30, v31
  v_mfma_f32_16x16x16_bf16 v[48:51], v[72:73], a[208:209], 0
  buffer_load_dwordx4 v66, s[12:15], s50 offen offset:2048 lds
  s_add_u32 m0, s49, 52232
  v_cvt_pk_bf16_f32 v168, v32, v33
  v_cvt_pk_bf16_f32 v169, v34, v35
  v_mfma_f32_16x16x16_bf16 v[52:55], v[74:75], a[210:211], 0
  s_add_u32 s50, s50, 6144
  buffer_load_dwordx4 v64, s[12:15], s50 offen offset:0 lds
  v_cvt_pk_bf16_f32 v170, v36, v37
  v_cvt_pk_bf16_f32 v171, v38, v39
  v_mfma_f32_16x16x16_bf16 v[56:59], v[72:73], a[212:213], 0
  buffer_load_dwordx4 v65, s[12:15], s50 offen offset:1024 lds
  v_cvt_pk_bf16_f32 v172, v40, v41
  v_cvt_pk_bf16_f32 v173, v42, v43
  v_mfma_f32_16x16x16_bf16 v[60:63], v[74:75], a[214:215], 0
  buffer_load_dwordx4 v66, s[12:15], s50 offen offset:2048 lds
  v_cvt_pk_bf16_f32 v174, v44, v45
  v_cvt_pk_bf16_f32 v175, v46, v47
  s_waitcnt lgkmcnt(0)
  v_and_b32 v76, v69, v76
  v_and_b32 v77, v70, v77
  v_and_b32 v78, v69, v78
  v_and_b32 v79, v70, v79
  s_waitcnt vmcnt(12)
  ds_read_b128 v[72:75], v68 offset:512
  v_mfma_f32_16x16x16_bf16 v[16:19], v[76:77], a[216:217], 0
  ds_read_b64_tr_b16 a[192:193], v67 offset:0
  ds_read_b64_tr_b16 a[194:195], v67 offset:768
  ds_read_b64_tr_b16 a[196:197], v67 offset:8
  ds_read_b64_tr_b16 a[198:199], v67 offset:776
  ds_read_b64_tr_b16 a[200:201], v67 offset:64
  v_cvt_pk_bf16_f32 v176, v48, v49
  v_cvt_pk_bf16_f32 v177, v50, v51
  v_mfma_f32_16x16x16_bf16 v[20:23], v[78:79], a[218:219], 0
  ds_read_b64_tr_b16 a[202:203], v67 offset:832
  ds_read_b64_tr_b16 a[204:205], v67 offset:72
  ds_read_b64_tr_b16 a[206:207], v67 offset:840
  ds_read_b64_tr_b16 a[208:209], v67 offset:128
  ds_read_b64_tr_b16 a[210:211], v67 offset:896
  v_cvt_pk_bf16_f32 v178, v52, v53
  v_cvt_pk_bf16_f32 v179, v54, v55
  v_mfma_f32_16x16x16_bf16 v[24:27], v[76:77], a[220:221], 0
  ds_read_b64_tr_b16 a[212:213], v67 offset:136
  ds_read_b64_tr_b16 a[214:215], v67 offset:904
  s_add_u32 m0, s49, 73792
  s_add_u32 s50, s44, s48
  buffer_load_dwordx4 v64, s[12:15], s50 offen offset:0 lds
  v_cvt_pk_bf16_f32 v180, v56, v57
  v_cvt_pk_bf16_f32 v181, v58, v59
  v_mfma_f32_16x16x16_bf16 v[28:31], v[78:79], a[222:223], 0
  buffer_load_dwordx4 v65, s[12:15], s50 offen offset:1024 lds
  buffer_load_dwordx4 v66, s[12:15], s50 offen offset:2048 lds
  s_add_u32 m0, s49, 76872
  s_add_u32 s50, s50, 6144
  buffer_load_dwordx4 v64, s[12:15], s50 offen offset:0 lds
  v_cvt_pk_bf16_f32 v182, v60, v61
  v_cvt_pk_bf16_f32 v183, v62, v63
  v_mfma_f32_16x16x16_bf16 v[32:35], v[76:77], a[224:225], 0
  buffer_load_dwordx4 v65, s[12:15], s50 offen offset:1024 lds
  buffer_load_dwordx4 v66, s[12:15], s50 offen offset:2048 lds
  s_mov_b64 s[82:83], s[80:81]
  s_mov_b64 s[80:81], s[78:79]
  s_mov_b64 s[78:79], s[76:77]
  v_cvt_pk_bf16_f32 v16, v16, v17
  v_cvt_pk_bf16_f32 v17, v18, v19
  v_accvgpr_write_b32 a72, v16
  v_accvgpr_write_b32 a73, v17
  v_mfma_f32_16x16x16_bf16 v[36:39], v[78:79], a[226:227], 0
  s_add_u32 s76, s33, s32
  s_xor_b32 s76, s76, s34
  s_add_u32 s77, s32, 24576
  s_cmp_lt_u32 s32, s35
  s_cselect_b32 s22, s32, s40
  v_cvt_pk_bf16_f32 v20, v20, v21
  v_cvt_pk_bf16_f32 v21, v22, v23
  v_accvgpr_write_b32 a74, v20
  v_accvgpr_write_b32 a75, v21
  v_mfma_f32_16x16x16_bf16 v[40:43], v[76:77], a[228:229], 0
  s_cselect_b32 s77, s77, s40
  s_bitcmp1_b32 s76, 21
  s_cselect_b32 s76, s77, s22
  s_cselect_b32 s77, s22, s77
  s_cselect_b64 s[56:57], -1, 0
  v_cvt_pk_bf16_f32 v24, v24, v25
  v_cvt_pk_bf16_f32 v25, v26, v27
  v_accvgpr_write_b32 a76, v24
  v_accvgpr_write_b32 a77, v25
  v_mfma_f32_16x16x16_bf16 v[44:47], v[78:79], a[230:231], 0
  s_add_u32 s32, s32, 786432
  s_add_u32 m0, s39, 0
  s_nop 0
  buffer_load_dwordx4 v8, s[4:7], s76 offen nt lds
  v_cvt_pk_bf16_f32 v28, v28, v29
  v_cvt_pk_bf16_f32 v29, v30, v31
  v_accvgpr_write_b32 a78, v28
  v_accvgpr_write_b32 a79, v29
  v_mfma_f32_16x16x16_bf16 v[48:51], v[76:77], a[232:233], 0
  s_add_u32 m0, s39, 4096
  s_nop 0
  buffer_load_dwordx4 v9, s[4:7], s76 offen nt lds
  s_add_u32 m0, s39, 8192
  v_cvt_pk_bf16_f32 v32, v32, v33
  v_cvt_pk_bf16_f32 v33, v34, v35
  v_accvgpr_write_b32 a80, v32
  v_accvgpr_write_b32 a81, v33
  v_mfma_f32_16x16x16_bf16 v[52:55], v[78:79], a[234:235], 0
  s_nop 0
  buffer_load_dwordx4 v10, s[4:7], s76 offen nt lds
  s_add_u32 m0, s39, 12288
  s_nop 0
  v_cvt_pk_bf16_f32 v36, v36, v37
  v_cvt_pk_bf16_f32 v37, v38, v39
  v_accvgpr_write_b32 a82, v36
  v_accvgpr_write_b32 a83, v37
  v_mfma_f32_16x16x16_bf16 v[56:59], v[76:77], a[236:237], 0
  buffer_load_dwordx4 v11, s[4:7], s76 offen nt lds
  v_cndmask_b32 v15, v12, v14, s[56:57]
  s_add_u32 m0, s39, 16384
  s_nop 0
  v_cvt_pk_bf16_f32 v40, v40, v41
  v_cvt_pk_bf16_f32 v41, v42, v43
  v_accvgpr_write_b32 a84, v40
  v_accvgpr_write_b32 a85, v41
  v_mfma_f32_16x16x16_bf16 v[60:63], v[78:79], a[238:239], 0
  buffer_load_dwordx4 v15, s[4:7], s22 offen nt lds
  s_add_u32 m0, s39, 20480
  s_nop 0
  buffer_load_dwordx4 v13, s[4:7], s77 offen nt lds
  v_cvt_pk_bf16_f32 v44, v44, v45
  v_cvt_pk_bf16_f32 v45, v46, v47
  v_accvgpr_write_b32 a86, v44
  v_accvgpr_write_b32 a87, v45
  s_waitcnt lgkmcnt(0)
  v_and_b32 v72, v69, v72
  v_and_b32 v73, v70, v73
  v_and_b32 v74, v69, v74
  v_and_b32 v75, v70, v75
  s_waitcnt vmcnt(18)
  ds_read_b128 v[76:79], v68 offset:576
  v_mfma_f32_16x16x16_bf16 v[16:19], v[72:73], a[192:193], 0
  ds_read_b64_tr_b16 a[216:217], v67 offset:24640
  v_cvt_pk_bf16_f32 v48, v48, v49
  v_cvt_pk_bf16_f32 v49, v50, v51
  v_accvgpr_write_b32 a88, v48
  v_accvgpr_write_b32 a89, v49
  v_mfma_f32_16x16x16_bf16 v[20:23], v[74:75], a[194:195], 0
  ds_read_b64_tr_b16 a[218:219], v67 offset:25408
  v_cvt_pk_bf16_f32 v52, v52, v53
  v_cvt_pk_bf16_f32 v53, v54, v55
  v_accvgpr_write_b32 a90, v52
  v_accvgpr_write_b32 a91, v53
  v_mfma_f32_16x16x16_bf16 v[24:27], v[72:73], a[196:197], 0
  ds_read_b64_tr_b16 a[220:221], v67 offset:24648
  v_cvt_pk_bf16_f32 v56, v56, v57
  v_cvt_pk_bf16_f32 v57, v58, v59
  v_accvgpr_write_b32 a92, v56
  v_accvgpr_write_b32 a93, v57
  v_mfma_f32_16x16x16_bf16 v[28:31], v[74:75], a[198:199], 0
  ds_read_b64_tr_b16 a[222:223], v67 offset:25416
  v_cvt_pk_bf16_f32 v60, v60, v61
  v_cvt_pk_bf16_f32 v61, v62, v63
  v_accvgpr_write_b32 a94, v60
  v_accvgpr_write_b32 a95, v61
  v_mfma_f32_16x16x16_bf16 v[32:35], v[72:73], a[200:201], 0
  ds_read_b64_tr_b16 a[224:225], v67 offset:24704
  v_cvt_pk_bf16_f32 v184, v16, v17
  v_cvt_pk_bf16_f32 v185, v18, v19
  v_mfma_f32_16x16x16_bf16 v[36:39], v[74:75], a[202:203], 0
  ds_read_b64_tr_b16 a[226:227], v67 offset:25472
  v_cvt_pk_bf16_f32 v186, v20, v21
  v_cvt_pk_bf16_f32 v187, v22, v23
  v_mfma_f32_16x16x16_bf16 v[40:43], v[72:73], a[204:205], 0
  ds_read_b64_tr_b16 a[228:229], v67 offset:24712
  v_cvt_pk_bf16_f32 v188, v24, v25
  v_cvt_pk_bf16_f32 v189, v26, v27
  v_mfma_f32_16x16x16_bf16 v[44:47], v[74:75], a[206:207], 0
  ds_read_b64_tr_b16 a[230:231], v67 offset:25480
  v_cvt_pk_bf16_f32 v190, v28, v29
  v_cvt_pk_bf16_f32 v191, v30, v31
  v_mfma_f32_16x16x16_bf16 v[48:51], v[72:73], a[208:209], 0
  ds_read_b64_tr_b16 a[232:233], v67 offset:24768
  v_cvt_pk_bf16_f32 v192, v32, v33
  v_cvt_pk_bf16_f32 v193, v34, v35
  v_mfma_f32_16x16x16_bf16 v[52:55], v[74:75], a[210:211], 0
  ds_read_b64_tr_b16 a[234:235], v67 offset:25536
  v_cvt_pk_bf16_f32 v194, v36, v37
  v_cvt_pk_bf16_f32 v195, v38, v39
  v_mfma_f32_16x16x16_bf16 v[56:59], v[72:73], a[212:213], 0
  ds_read_b64_tr_b16 a[236:237], v67 offset:24776
  v_cvt_pk_bf16_f32 v196, v40, v41
  v_cvt_pk_bf16_f32 v197, v42, v43
  v_mfma_f32_16x16x16_bf16 v[60:63], v[74:75], a[214:215], 0
  ds_read_b64_tr_b16 a[238:239], v67 offset:25544
  v_cvt_pk_bf16_f32 v198, v44, v45
  v_cvt_pk_bf16_f32 v199, v46, v47
  s_waitcnt lgkmcnt(0)
  v_and_b32 v76, v69, v76
  v_and_b32 v77, v70, v77
  v_and_b32 v78, v69, v78
  v_and_b32 v79, v70, v79
  s_waitcnt vmcnt(12)
  ds_read_b128 v[72:75], v68 offset:640
  v_mfma_f32_16x16x16_bf16 v[16:19], v[76:77], a[216:217], 0
  ds_read_b64_tr_b16 a[192:193], v71 offset:0
  ds_read_b64_tr_b16 a[194:195], v71 offset:768
  v_cvt_pk_bf16_f32 v200, v48, v49
  v_cvt_pk_bf16_f32 v201, v50, v51
  v_mfma_f32_16x16x16_bf16 v[20:23], v[78:79], a[218:219], 0
  ds_read_b64_tr_b16 a[196:197], v71 offset:8
  v_cvt_pk_bf16_f32 v202, v52, v53
  v_cvt_pk_bf16_f32 v203, v54, v55
  v_mfma_f32_16x16x16_bf16 v[24:27], v[76:77], a[220:221], 0
  ds_read_b64_tr_b16 a[198:199], v71 offset:776
  v_cvt_pk_bf16_f32 v204, v56, v57
  v_cvt_pk_bf16_f32 v205, v58, v59
  v_mfma_f32_16x16x16_bf16 v[28:31], v[78:79], a[222:223], 0
  ds_read_b64_tr_b16 a[200:201], v71 offset:64
  v_cvt_pk_bf16_f32 v206, v60, v61
  v_cvt_pk_bf16_f32 v207, v62, v63
  v_mfma_f32_16x16x16_bf16 v[32:35], v[76:77], a[224:225], 0
  ds_read_b64_tr_b16 a[202:203], v71 offset:832
  v_cvt_pk_bf16_f32 v16, v16, v17
  v_cvt_pk_bf16_f32 v17, v18, v19
  v_accvgpr_write_b32 a96, v16
  v_accvgpr_write_b32 a97, v17
  v_mfma_f32_16x16x16_bf16 v[36:39], v[78:79], a[226:227], 0
  ds_read_b64_tr_b16 a[204:205], v71 offset:72
  v_cvt_pk_bf16_f32 v20, v20, v21
  v_cvt_pk_bf16_f32 v21, v22, v23
  v_accvgpr_write_b32 a98, v20
  v_accvgpr_write_b32 a99, v21
  v_mfma_f32_16x16x16_bf16 v[40:43], v[76:77], a[228:229], 0
  ds_read_b64_tr_b16 a[206:207], v71 offset:840
  v_cvt_pk_bf16_f32 v24, v24, v25
  v_cvt_pk_bf16_f32 v25, v26, v27
  v_accvgpr_write_b32 a100, v24
  v_accvgpr_write_b32 a101, v25
  v_mfma_f32_16x16x16_bf16 v[44:47], v[78:79], a[230:231], 0
  ds_read_b64_tr_b16 a[208:209], v71 offset:128
  v_cvt_pk_bf16_f32 v28, v28, v29
  v_cvt_pk_bf16_f32 v29, v30, v31
  v_accvgpr_write_b32 a102, v28
  v_accvgpr_write_b32 a103, v29
  v_mfma_f32_16x16x16_bf16 v[48:51], v[76:77], a[232:233], 0
  ds_read_b64_tr_b16 a[210:211], v71 offset:896
  v_cvt_pk_bf16_f32 v32, v32, v33
  v_cvt_pk_bf16_f32 v33, v34, v35
  v_accvgpr_write_b32 a104, v32
  v_accvgpr_write_b32 a105, v33
  v_mfma_f32_16x16x16_bf16 v[52:55], v[78:79], a[234:235], 0
  ds_read_b64_tr_b16 a[212:213], v71 offset:136
  v_cvt_pk_bf16_f32 v36, v36, v37
  v_cvt_pk_bf16_f32 v37, v38, v39
  v_accvgpr_write_b32 a106, v36
  v_accvgpr_write_b32 a107, v37
  v_mfma_f32_16x16x16_bf16 v[56:59], v[76:77], a[236:237], 0
  ds_read_b64_tr_b16 a[214:215], v71 offset:904
  v_cvt_pk_bf16_f32 v40, v40, v41
  v_cvt_pk_bf16_f32 v41, v42, v43
  v_accvgpr_write_b32 a108, v40
  v_accvgpr_write_b32 a109, v41
  v_mfma_f32_16x16x16_bf16 v[60:63], v[78:79], a[238:239], 0
  s_load_dword s95, s[92:93], s36
  v_cvt_pk_bf16_f32 v44, v44, v45
  v_cvt_pk_bf16_f32 v45, v46, v47
  v_accvgpr_write_b32 a110, v44
  v_accvgpr_write_b32 a111, v45
  s_waitcnt lgkmcnt(0)
  v_and_b32 v72, v69, v72
  v_and_b32 v73, v70, v73
  v_and_b32 v74, v69, v74
  v_and_b32 v75, v70, v75
  s_cmp_eq_u32 s95, 0
  s_cbranch_scc1 L_slow
L_back:
  s_lshr_b32 s51, s2, 1
  s_xor_b32 s34, s95, s51
  s_and_b32 s34, s34, 2
  s_lshl_b32 s34, s34, 20
  s_waitcnt vmcnt(6)
  ds_read_b128 v[76:79], v68 offset:704
  v_mfma_f32_16x16x16_bf16 v[16:19], v[72:73], a[192:193], 0
  ds_read_b64_tr_b16 a[216:217], v71 offset:24640
  v_cvt_pk_bf16_f32 v48, v48, v49
  v_cvt_pk_bf16_f32 v49, v50, v51
  v_accvgpr_write_b32 a112, v48
  v_accvgpr_write_b32 a113, v49
  v_mfma_f32_16x16x16_bf16 v[20:23], v[74:75], a[194:195], 0
  ds_read_b64_tr_b16 a[218:219], v71 offset:25408
  v_cvt_pk_bf16_f32 v52, v52, v53
  v_cvt_pk_bf16_f32 v53, v54, v55
  v_accvgpr_write_b32 a114, v52
  v_accvgpr_write_b32 a115, v53
  v_mfma_f32_16x16x16_bf16 v[24:27], v[72:73], a[196:197], 0
  ds_read_b64_tr_b16 a[220:221], v71 offset:24648
  v_cvt_pk_bf16_f32 v56, v56, v57
  v_cvt_pk_bf16_f32 v57, v58, v59
  v_accvgpr_write_b32 a116, v56
  v_accvgpr_write_b32 a117, v57
  v_mfma_f32_16x16x16_bf16 v[28:31], v[74:75], a[198:199], 0
  ds_read_b64_tr_b16 a[222:223], v71 offset:25416
  v_cvt_pk_bf16_f32 v60, v60, v61
  v_cvt_pk_bf16_f32 v61, v62, v63
  v_accvgpr_write_b32 a118, v60
  v_accvgpr_write_b32 a119, v61
  v_mfma_f32_16x16x16_bf16 v[32:35], v[72:73], a[200:201], 0
  ds_read_b64_tr_b16 a[224:225], v71 offset:24704
  v_cvt_pk_bf16_f32 v208, v16, v17
  v_cvt_pk_bf16_f32 v209, v18, v19
  v_mfma_f32_16x16x16_bf16 v[36:39], v[74:75], a[202:203], 0
  ds_read_b64_tr_b16 a[226:227], v71 offset:25472
  v_cvt_pk_bf16_f32 v210, v20, v21
  v_cvt_pk_bf16_f32 v211, v22, v23
  v_mfma_f32_16x16x16_bf16 v[40:43], v[72:73], a[204:205], 0
  ds_read_b64_tr_b16 a[228:229], v71 offset:24712
  v_cvt_pk_bf16_f32 v212, v24, v25
  v_cvt_pk_bf16_f32 v213, v26, v27
  v_mfma_f32_16x16x16_bf16 v[44:47], v[74:75], a[206:207], 0
  ds_read_b64_tr_b16 a[230:231], v71 offset:25480
  v_cvt_pk_bf16_f32 v214, v28, v29
  v_cvt_pk_bf16_f32 v215, v30, v31
  v_mfma_f32_16x16x16_bf16 v[48:51], v[72:73], a[208:209], 0
  ds_read_b64_tr_b16 a[232:233], v71 offset:24768
  v_cvt_pk_bf16_f32 v216, v32, v33
  v_cvt_pk_bf16_f32 v217, v34, v35
  v_mfma_f32_16x16x16_bf16 v[52:55], v[74:75], a[210:211], 0
  ds_read_b64_tr_b16 a[234:235], v71 offset:25536
  v_cvt_pk_bf16_f32 v218, v36, v37
  v_cvt_pk_bf16_f32 v219, v38, v39
  v_mfma_f32_16x16x16_bf16 v[56:59], v[72:73], a[212:213], 0
  ds_read_b64_tr_b16 a[236:237], v71 offset:24776
  v_cvt_pk_bf16_f32 v220, v40, v41
  v_cvt_pk_bf16_f32 v221, v42, v43
  v_mfma_f32_16x16x16_bf16 v[60:63], v[74:75], a[214:215], 0
  ds_read_b64_tr_b16 a[238:239], v71 offset:25544
  v_cvt_pk_bf16_f32 v222, v44, v45
  v_cvt_pk_bf16_f32 v223, v46, v47
  s_waitcnt lgkmcnt(0)
  v_and_b32 v76, v69, v76
  v_and_b32 v77, v70, v77
  v_and_b32 v78, v69, v78
  v_and_b32 v79, v70, v79
  s_mov_b64 s[82:83], s[80:81]
  s_mov_b64 s[80:81], s[78:79]
  v_mfma_f32_16x16x16_bf16 v[16:19], v[76:77], a[216:217], 0
  s_mov_b64 s[78:79], s[76:77]
  s_add_u32 s76, s33, s32
  s_xor_b32 s76, s76, s34
  v_cvt_pk_bf16_f32 v224, v48, v49
  v_cvt_pk_bf16_f32 v225, v50, v51
  v_mfma_f32_16x16x16_bf16 v[20:23], v[78:79], a[218:219], 0
  s_add_u32 s77, s32, 24576
  s_cmp_lt_u32 s32, s35
  s_cselect_b32 s22, s32, s40
  v_cvt_pk_bf16_f32 v226, v52, v53
  v_cvt_pk_bf16_f32 v227, v54, v55
  v_mfma_f32_16x16x16_bf16 v[24:27], v[76:77], a[220:221], 0
  s_cselect_b32 s77, s77, s40
  s_bitcmp1_b32 s76, 21
  s_cselect_b32 s76, s77, s22
  v_cvt_pk_bf16_f32 v228, v56, v57
  v_cvt_pk_bf16_f32 v229, v58, v59
  v_mfma_f32_16x16x16_bf16 v[28:31], v[78:79], a[222:223], 0
  s_cselect_b32 s77, s22, s77
  s_cselect_b64 s[56:57], -1, 0
  s_add_u32 s32, s32, 786432
  v_cvt_pk_bf16_f32 v230, v60, v61
  v_cvt_pk_bf16_f32 v231, v62, v63
  v_mfma_f32_16x16x16_bf16 v[32:35], v[76:77], a[224:225], 0
  s_add_u32 m0, s39, 24576
  s_nop 0
  buffer_load_dwordx4 v8, s[4:7], s76 offen nt lds
  v_cvt_pk_bf16_f32 v232, v16, v17
  v_cvt_pk_bf16_f32 v233, v18, v19
  v_mfma_f32_16x16x16_bf16 v[36:39], v[78:79], a[226:227], 0
  s_add_u32 m0, s39, 28672
  s_nop 0
  buffer_load_dwordx4 v9, s[4:7], s76 offen nt lds
  v_cvt_pk_bf16_f32 v234, v20, v21
  v_cvt_pk_bf16_f32 v235, v22, v23
  v_mfma_f32_16x16x16_bf16 v[40:43], v[76:77], a[228:229], 0
  s_add_u32 m0, s39, 32768
  s_nop 0
  buffer_load_dwordx4 v10, s[4:7], s76 offen nt lds
  v_cvt_pk_bf16_f32 v236, v24, v25
  v_cvt_pk_bf16_f32 v237, v26, v27
  v_mfma_f32_16x16x16_bf16 v[44:47], v[78:79], a[230:231], 0
  s_add_u32 m0, s39, 36864
  s_nop 0
  v_cvt_pk_bf16_f32 v238, v28, v29
  v_cvt_pk_bf16_f32 v239, v30, v31
  v_mfma_f32_16x16x16_bf16 v[48:51], v[76:77], a[232:233], 0
  buffer_load_dwordx4 v11, s[4:7], s76 offen nt lds
  v_cndmask_b32 v15, v12, v14, s[56:57]
  v_cvt_pk_bf16_f32 v240, v32, v33
  v_cvt_pk_bf16_f32 v241, v34, v35
  v_mfma_f32_16x16x16_bf16 v[52:55], v[78:79], a[234:235], 0
  s_add_u32 m0, s39, 40960
  s_nop 0
  v_cvt_pk_bf16_f32 v242, v36, v37
  v_cvt_pk_bf16_f32 v243, v38, v39
  v_mfma_f32_16x16x16_bf16 v[56:59], v[76:77], a[236:237], 0
  buffer_load_dwordx4 v15, s[4:7], s22 offen nt lds
  s_add_u32 m0, s39, 45056
  v_cvt_pk_bf16_f32 v244, v40, v41
  v_cvt_pk_bf16_f32 v245, v42, v43
  v_mfma_f32_16x16x16_bf16 v[60:63], v[78:79], a[238:239], 0
  s_xor_b32 s39, s39, 49152
  buffer_load_dwordx4 v13, s[4:7], s77 offen nt lds
  v_cvt_pk_bf16_f32 v246, v44, v45
  v_cvt_pk_bf16_f32 v247, v46, v47
  v_cvt_pk_bf16_f32 v248, v48, v49
  v_cvt_pk_bf16_f32 v249, v50, v51
  v_cvt_pk_bf16_f32 v250, v52, v53
  v_cvt_pk_bf16_f32 v251, v54, v55
  v_sub_u32 v64, v14, v12
  v_add_u32 v64, v64, v84
  s_mov_b32 s58, s40
  s_mov_b32 s59, s40
  s_mov_b32 s62, s40
  s_mov_b32 s63, s40
  s_waitcnt vmcnt(6)
  s_barrier
  ds_read_b128 a[144:147], v1 offset:0
  ds_read_b128 a[148:151], v2 offset:0
  ds_read_b128 a[152:155], v3 offset:0
  ds_read_b128 a[156:159], v4 offset:0
  v_cvt_pk_bf16_f32 v252, v56, v57
  v_cvt_pk_bf16_f32 v253, v58, v59
  v_cvt_pk_bf16_f32 v254, v60, v61
  v_cvt_pk_bf16_f32 v255, v62, v63
L_loop:
  s_waitcnt lgkmcnt(2)
  v_mfma_f32_16x16x32_bf16 v[16:19], v[88:91], a[144:147], 0
  ds_read_b128 a[160:163], v1 offset:256
  v_mfma_f32_16x16x32_bf16 v[16:19], a[0:3], a[148:151], v[16:19]
  ds_read_b128 a[164:167], v2 offset:256
  v_mfma_f32_16x16x32_bf16 v[20:23], v[92:95], a[144:147], 0
  v_mfma_f32_16x16x32_bf16 v[20:23], a[4:7], a[148:151], v[20:23]
  v_cvt_pk_bf16_f32 v40, v40, v41
  v_mfma_f32_16x16x32_bf16 v[24:27], v[96:99], a[144:147], 0
  v_cvt_pk_bf16_f32 v41, v42, v43
  v_mfma_f32_16x16x32_bf16 v[24:27], a[8:11], a[148:151], v[24:27]
  v_cvt_pk_bf16_f32 v42, v44, v45
  v_mfma_f32_16x16x32_bf16 v[28:31], v[100:103], a[144:147], 0
  buffer_store_dwordx4 a[188:191], v85, s[8:11], s63 offen sc1
  v_mfma_f32_16x16x32_bf16 v[28:31], a[12:15], a[148:151], v[28:31]
  v_cvt_pk_bf16_f32 v43, v46, v47
  v_mfma_f32_16x16x32_bf16 v[32:35], v[104:107], a[144:147], 0
  ds_write_b128 v86, v[40:43] offset:12288
  v_mfma_f32_16x16x32_bf16 v[32:35], a[16:19], a[148:151], v[32:35]
  v_mfma_f32_16x16x32_bf16 v[36:39], v[108:111], a[144:147], 0
  v_mfma_f32_16x16x32_bf16 v[36:39], a[20:23], a[148:151], v[36:39]
  s_waitcnt lgkmcnt(3)
  v_mfma_f32_16x16x32_bf16 v[16:19], v[112:115], a[152:155], v[16:19]
  ds_read_b128 a[144:147], v3 offset:256
  v_mfma_f32_16x16x32_bf16 v[16:19], a[24:27], a[156:159], v[16:19]
  ds_read_b128 a[148:151], v4 offset:256
  v_mfma_f32_16x16x32_bf16 v[20:23], v[116:119], a[152:155], v[20:23]
  v_mfma_f32_16x16x32_bf16 v[20:23], a[28:31], a[156:159], v[20:23]
  v_cvt_pk_bf16_f32 v48, v48, v49
  v_mfma_f32_16x16x32_bf16 v[24:27], v[120:123], a[152:155], v[24:27]
  buffer_store_dwordx4 a[168:171], v80, s[8:11], s58 offen sc1
  v_mfma_f32_16x16x32_bf16 v[24:27], a[32:35], a[156:159], v[24:27]
  v_cvt_pk_bf16_f32 v49, v50, v51
  v_mfma_f32_16x16x32_bf16 v[28:31], v[124:127], a[152:155], v[28:31]
  v_cvt_pk_bf16_f32 v50, v52, v53
  v_mfma_f32_16x16x32_bf16 v[28:31], a[36:39], a[156:159], v[28:31]
  v_cvt_pk_bf16_f32 v51, v54, v55
  v_mfma_f32_16x16x32_bf16 v[32:35], v[128:131], a[152:155], v[32:35]
  ds_write_b128 v87, v[48:51] offset:12288
  v_mfma_f32_16x16x32_bf16 v[32:35], a[40:43], a[156:159], v[32:35]
  v_mfma_f32_16x16x32_bf16 v[36:39], v[132:135], a[152:155], v[36:39]
  v_mfma_f32_16x16x32_bf16 v[36:39], a[44:47], a[156:159], v[36:39]
  s_waitcnt lgkmcnt(4)
  v_mfma_f32_16x16x32_bf16 v[16:19], v[136:139], a[160:163], v[16:19]
  ds_read_b128 a[152:155], v1 offset:512
  v_mfma_f32_16x16x32_bf16 v[16:19], a[48:51], a[164:167], v[16:19]
  ds_read_b128 a[156:159], v2 offset:512
  v_mfma_f32_16x16x32_bf16 v[20:23], v[140:143], a[160:163], v[20:23]
  v_mfma_f32_16x16x32_bf16 v[20:23], a[52:55], a[164:167], v[20:23]
  v_mfma_f32_16x16x32_bf16 v[24:27], v[144:147], a[160:163], v[24:27]
  buffer_store_dwordx4 a[172:175], v81, s[8:11], s58 offen sc1
  v_mfma_f32_16x16x32_bf16 v[24:27], a[56:59], a[164:167], v[24:27]
  v_mfma_f32_16x16x32_bf16 v[28:31], v[148:151], a[160:163], v[28:31]
  v_mfma_f32_16x16x32_bf16 v[28:31], a[60:63], a[164:167], v[28:31]
  v_mfma_f32_16x16x32_bf16 v[32:35], v[152:155], a[160:163], v[32:35]
  v_mfma_f32_16x16x32_bf16 v[32:35], a[64:67], a[164:167], v[32:35]
  v_mfma_f32_16x16x32_bf16 v[36:39], v[156:159], a[160:163], v[36:39]
  v_mfma_f32_16x16x32_bf16 v[36:39], a[68:71], a[164:167], v[36:39]
  s_waitcnt lgkmcnt(3)
  v_mfma_f32_16x16x32_bf16 v[16:19], v[160:163], a[144:147], v[16:19]
  ds_read_b128 a[160:163], v3 offset:512
  v_mfma_f32_16x16x32_bf16 v[16:19], a[72:75], a[148:151], v[16:19]
  ds_read_b128 a[164:167], v4 offset:512
  v_mfma_f32_16x16x32_bf16 v[20:23], v[164:167], a[144:147], v[20:23]
  v_cvt_pk_bf16_f32 v56, v56, v57
  v_mfma_f32_16x16x32_bf16 v[20:23], a[76:79], a[148:151], v[20:23]
  v_cvt_pk_bf16_f32 v57, v58, v59
  v_mfma_f32_16x16x32_bf16 v[24:27], v[168:171], a[144:147], v[24:27]
  buffer_store_dwordx4 a[176:179], v82, s[8:11], s58 offen sc1
  v_mfma_f32_16x16x32_bf16 v[24:27], a[80:83], a[148:151], v[24:27]
  s_mov_b64 s[82:83], s[80:81]
  v_cvt_pk_bf16_f32 v58, v60, v61
  v_mfma_f32_16x16x32_bf16 v[28:31], v[172:175], a[144:147], v[28:31]
  s_mov_b64 s[80:81], s[78:79]
  v_cvt_pk_bf16_f32 v59, v62, v63
  v_mfma_f32_16x16x32_bf16 v[28:31], a[84:87], a[148:151], v[28:31]
  ds_write_b128 v86, v[56:59] offset:12416
  v_mfma_f32_16x16x32_bf16 v[32:35], v[176:179], a[144:147], v[32:35]
  s_mov_b64 s[78:79], s[76:77]
  s_add_u32 s76, s33, s32
  v_mfma_f32_16x16x32_bf16 v[32:35], a[88:91], a[148:151], v[32:35]
  s_xor_b32 s76, s76, s34
  s_add_u32 s77, s32, 24576
  v_mfma_f32_16x16x32_bf16 v[36:39], v[180:183], a[144:147], v[36:39]
  s_cmp_lt_u32 s32, s35
  s_cselect_b32 s22, s32, s40
  v_mfma_f32_16x16x32_bf16 v[36:39], a[92:95], a[148:151], v[36:39]
  s_cselect_b32 s77, s77, s40
  s_waitcnt lgkmcnt(3)
  v_mfma_f32_16x16x32_bf16 v[16:19], v[184:187], a[152:155], v[16:19]
  ds_read_b128 a[144:147], v1 offset:12288
  s_bitcmp1_b32 s76, 21
  v_mfma_f32_16x16x32_bf16 v[16:19], a[96:99], a[156:159], v[16:19]
  ds_read_b128 a[148:151], v2 offset:12288
  s_cselect_b32 s76, s77, s22
  v_mfma_f32_16x16x32_bf16 v[20:23], v[188:191], a[152:155], v[20:23]
  s_cselect_b32 s77, s22, s77
  s_cselect_b64 s[56:57], -1, 0
  v_mfma_f32_16x16x32_bf16 v[20:23], a[100:103], a[156:159], v[20:23]
  s_add_u32 s32, s32, 786432
  s_add_u32 m0, s39, 0
  v_mfma_f32_16x16x32_bf16 v[24:27], v[192:195], a[152:155], v[24:27]
  buffer_load_dwordx4 v8, s[4:7], s76 offen nt lds
  v_mfma_f32_16x16x32_bf16 v[24:27], a[104:107], a[156:159], v[24:27]
  s_mov_b32 s58, s80
  s_mov_b32 s59, s82
  v_mfma_f32_16x16x32_bf16 v[28:31], v[196:199], a[152:155], v[28:31]
  s_mov_b32 s63, s83
  s_min_u32 s62, s82, s83
  v_mfma_f32_16x16x32_bf16 v[28:31], a[108:111], a[156:159], v[28:31]
  s_cmp_gt_u32 s82, s83
  s_cselect_b64 s[90:91], -1, 0
  v_mfma_f32_16x16x32_bf16 v[32:35], v[200:203], a[152:155], v[32:35]
  v_cndmask_b32 v65, v84, v64, s[90:91]
  v_mfma_f32_16x16x32_bf16 v[32:35], a[112:115], a[156:159], v[32:35]
  v_mfma_f32_16x16x32_bf16 v[36:39], v[204:207], a[152:155], v[36:39]
  v_mfma_f32_16x16x32_bf16 v[36:39], a[116:119], a[156:159], v[36:39]
  s_waitcnt lgkmcnt(3)
  v_mfma_f32_16x16x32_bf16 v[16:19], v[208:211], a[160:163], v[16:19]
  ds_read_b128 a[152:155], v3 offset:12288
  v_mfma_f32_16x16x32_bf16 v[16:19], v[232:235], a[164:167], v[16:19]
  ds_read_b128 a[156:159], v4 offset:12288
  v_mfma_f32_16x16x32_bf16 v[20:23], v[212:215], a[160:163], v[20:23]
  v_mfma_f32_16x16x32_bf16 v[20:23], v[236:239], a[164:167], v[20:23]
  s_add_u32 m0, s39, 4096
  v_mfma_f32_16x16x32_bf16 v[24:27], v[216:219], a[160:163], v[24:27]
  buffer_load_dwordx4 v9, s[4:7], s76 offen nt lds
  v_mfma_f32_16x16x32_bf16 v[24:27], v[240:243], a[164:167], v[24:27]
  v_mfma_f32_16x16x32_bf16 v[28:31], v[220:223], a[160:163], v[28:31]
  v_mfma_f32_16x16x32_bf16 v[28:31], v[244:247], a[164:167], v[28:31]
  v_mfma_f32_16x16x32_bf16 v[32:35], v[224:227], a[160:163], v[32:35]
  v_mfma_f32_16x16x32_bf16 v[32:35], v[248:251], a[164:167], v[32:35]
  v_mfma_f32_16x16x32_bf16 v[36:39], v[228:231], a[160:163], v[36:39]
  v_mfma_f32_16x16x32_bf16 v[36:39], v[252:255], a[164:167], v[36:39]
  s_waitcnt lgkmcnt(2)
  v_mfma_f32_16x16x32_bf16 v[40:43], v[88:91], a[144:147], 0
  ds_read_b128 a[160:163], v1 offset:12544
  v_mfma_f32_16x16x32_bf16 v[40:43], a[0:3], a[148:151], v[40:43]
  ds_read_b128 a[164:167], v2 offset:12544
  v_mfma_f32_16x16x32_bf16 v[44:47], v[92:95], a[144:147], 0
  s_add_u32 m0, s39, 8192
  v_mfma_f32_16x16x32_bf16 v[44:47], a[4:7], a[148:151], v[44:47]
  v_cvt_pk_bf16_f32 v16, v16, v17
  v_mfma_f32_16x16x32_bf16 v[48:51], v[96:99], a[144:147], 0
  buffer_load_dwordx4 v10, s[4:7], s76 offen nt lds
  v_mfma_f32_16x16x32_bf16 v[48:51], a[8:11], a[148:151], v[48:51]
  v_cvt_pk_bf16_f32 v17, v18, v19
  v_mfma_f32_16x16x32_bf16 v[52:55], v[100:103], a[144:147], 0
  v_cvt_pk_bf16_f32 v18, v20, v21
  v_mfma_f32_16x16x32_bf16 v[52:55], a[12:15], a[148:151], v[52:55]
  v_cvt_pk_bf16_f32 v19, v22, v23
  v_mfma_f32_16x16x32_bf16 v[56:59], v[104:107], a[144:147], 0
  ds_write_b128 v86, v[16:19] offset:0
  v_mfma_f32_16x16x32_bf16 v[56:59], a[16:19], a[148:151], v[56:59]
  s_add_u32 m0, s39, 12288
  v_mfma_f32_16x16x32_bf16 v[60:63], v[108:111], a[144:147], 0
  v_cvt_pk_bf16_f32 v24, v24, v25
  v_mfma_f32_16x16x32_bf16 v[60:63], a[20:23], a[148:151], v[60:63]
  s_waitcnt lgkmcnt(3)
  v_mfma_f32_16x16x32_bf16 v[40:43], v[112:115], a[152:155], v[40:43]
  ds_read_b128 a[144:147], v3 offset:12544
  v_mfma_f32_16x16x32_bf16 v[40:43], a[24:27], a[156:159], v[40:43]
  ds_read_b128 a[148:151], v4 offset:12544
  v_mfma_f32_16x16x32_bf16 v[44:47], v[116:119], a[152:155], v[44:47]
  v_cvt_pk_bf16_f32 v25, v26, v27
  v_mfma_f32_16x16x32_bf16 v[44:47], a[28:31], a[156:159], v[44:47]
  v_cvt_pk_bf16_f32 v26, v28, v29
  v_mfma_f32_16x16x32_bf16 v[48:51], v[120:123], a[152:155], v[48:51]
  buffer_load_dwordx4 v11, s[4:7], s76 offen nt lds
  v_mfma_f32_16x16x32_bf16 v[48:51], a[32:35], a[156:159], v[48:51]
  v_cvt_pk_bf16_f32 v27, v30, v31
  v_mfma_f32_16x16x32_bf16 v[52:55], v[124:127], a[152:155], v[52:55]
  ds_write_b128 v87, v[24:27] offset:0
  v_mfma_f32_16x16x32_bf16 v[52:55], a[36:39], a[156:159], v[52:55]
  v_mfma_f32_16x16x32_bf16 v[56:59], v[128:131], a[152:155], v[56:59]
  v_mfma_f32_16x16x32_bf16 v[56:59], a[40:43], a[156:159], v[56:59]
  v_mfma_f32_16x16x32_bf16 v[60:63], v[132:135], a[152:155], v[60:63]
  v_cndmask_b32 v15, v12, v14, s[56:57]
  v_mfma_f32_16x16x32_bf16 v[60:63], a[44:47], a[156:159], v[60:63]
  s_waitcnt lgkmcnt(4)
  v_mfma_f32_16x16x32_bf16 v[40:43], v[136:139], a[160:163], v[40:43]
  ds_read_b128 a[152:155], v1 offset:12800
  v_mfma_f32_16x16x32_bf16 v[40:43], a[48:51], a[164:167], v[40:43]
  ds_read_b128 a[156:159], v2 offset:12800
  v_mfma_f32_16x16x32_bf16 v[44:47], v[140:143], a[160:163], v[44:47]
  s_add_u32 m0, s39, 16384
  v_mfma_f32_16x16x32_bf16 v[44:47], a[52:55], a[164:167], v[44:47]
  v_cvt_pk_bf16_f32 v32, v32, v33
  v_mfma_f32_16x16x32_bf16 v[48:51], v[144:147], a[160:163], v[48:51]
  buffer_load_dwordx4 v15, s[4:7], s22 offen nt lds
  v_mfma_f32_16x16x32_bf16 v[48:51], a[56:59], a[164:167], v[48:51]
  v_cvt_pk_bf16_f32 v33, v34, v35
  v_mfma_f32_16x16x32_bf16 v[52:55], v[148:151], a[160:163], v[52:55]
  v_cvt_pk_bf16_f32 v34, v36, v37
  v_mfma_f32_16x16x32_bf16 v[52:55], a[60:63], a[164:167], v[52:55]
  v_cvt_pk_bf16_f32 v35, v38, v39
  v_mfma_f32_16x16x32_bf16 v[56:59], v[152:155], a[160:163], v[56:59]
  ds_write_b128 v86, v[32:35] offset:128
  v_mfma_f32_16x16x32_bf16 v[56:59], a[64:67], a[164:167], v[56:59]
  v_mfma_f32_16x16x32_bf16 v[60:63], v[156:159], a[160:163], v[60:63]
  v_mfma_f32_16x16x32_bf16 v[60:63], a[68:71], a[164:167], v[60:63]
  s_waitcnt lgkmcnt(4)
  v_mfma_f32_16x16x32_bf16 v[40:43], v[160:163], a[144:147], v[40:43]
  ds_read_b128 a[160:163], v3 offset:12800
  v_mfma_f32_16x16x32_bf16 v[40:43], a[72:75], a[148:151], v[40:43]
  ds_read_b128 a[164:167], v4 offset:12800
  v_mfma_f32_16x16x32_bf16 v[44:47], v[164:167], a[144:147], v[44:47]
  v_mfma_f32_16x16x32_bf16 v[44:47], a[76:79], a[148:151], v[44:47]
  s_add_u32 m0, s39, 20480
  v_mfma_f32_16x16x32_bf16 v[48:51], v[168:171], a[144:147], v[48:51]
  buffer_load_dwordx4 v13, s[4:7], s77 offen nt lds
  v_mfma_f32_16x16x32_bf16 v[48:51], a[80:83], a[148:151], v[48:51]
  v_mfma_f32_16x16x32_bf16 v[52:55], v[172:175], a[144:147], v[52:55]
  v_mfma_f32_16x16x32_bf16 v[52:55], a[84:87], a[148:151], v[52:55]
  v_mfma_f32_16x16x32_bf16 v[56:59], v[176:179], a[144:147], v[56:59]
  v_mfma_f32_16x16x32_bf16 v[56:59], a[88:91], a[148:151], v[56:59]
  v_mfma_f32_16x16x32_bf16 v[60:63], v[180:183], a[144:147], v[60:63]
  v_mfma_f32_16x16x32_bf16 v[60:63], a[92:95], a[148:151], v[60:63]
  s_waitcnt vmcnt(10) lgkmcnt(2)
L_ent:
  s_barrier
  s_waitcnt lgkmcnt(3)
  v_mfma_f32_16x16x32_bf16 v[40:43], v[184:187], a[152:155], v[40:43]
  ds_read_b128 a[144:147], v1 offset:24576
  v_mfma_f32_16x16x32_bf16 v[40:43], a[96:99], a[156:159], v[40:43]
  ds_read_b128 a[148:151], v2 offset:24576
  v_mfma_f32_16x16x32_bf16 v[44:47], v[188:191], a[152:155], v[44:47]
  ds_read_b128 a[180:183], v5 offset:12288
  v_mfma_f32_16x16x32_bf16 v[44:47], a[100:103], a[156:159], v[44:47]
  ds_read_b128 a[184:187], v6 offset:12288
  v_mfma_f32_16x16x32_bf16 v[48:51], v[192:195], a[152:155], v[48:51]
  ds_read_b128 a[188:191], v7 offset:12288
  v_mfma_f32_16x16x32_bf16 v[48:51], a[104:107], a[156:159], v[48:51]
  ds_read_b128 a[168:171], v5 offset:0
  v_mfma_f32_16x16x32_bf16 v[52:55], v[196:199], a[152:155], v[52:55]
  ds_read_b128 a[172:175], v6 offset:0
  v_mfma_f32_16x16x32_bf16 v[52:55], a[108:111], a[156:159], v[52:55]
  ds_read_b128 a[176:179], v7 offset:0
  v_mfma_f32_16x16x32_bf16 v[56:59], v[200:203], a[152:155], v[56:59]
  v_mfma_f32_16x16x32_bf16 v[56:59], a[112:115], a[156:159], v[56:59]
  v_mfma_f32_16x16x32_bf16 v[60:63], v[204:207], a[152:155], v[60:63]
  v_mfma_f32_16x16x32_bf16 v[60:63], a[116:119], a[156:159], v[60:63]
  s_waitcnt lgkmcnt(8)
  v_mfma_f32_16x16x32_bf16 v[40:43], v[208:211], a[160:163], v[40:43]
  ds_read_b128 a[152:155], v3 offset:24576
  v_mfma_f32_16x16x32_bf16 v[40:43], v[232:235], a[164:167], v[40:43]
  ds_read_b128 a[156:159], v4 offset:24576
  v_mfma_f32_16x16x32_bf16 v[44:47], v[212:215], a[160:163], v[44:47]
  s_waitcnt lgkmcnt(7)
  buffer_store_dwordx4 a[180:183], v83, s[8:11], s59 offen sc1
  v_mfma_f32_16x16x32_bf16 v[44:47], v[236:239], a[164:167], v[44:47]
  v_mfma_f32_16x16x32_bf16 v[48:51], v[216:219], a[160:163], v[48:51]
  v_mfma_f32_16x16x32_bf16 v[48:51], v[240:243], a[164:167], v[48:51]
  v_mfma_f32_16x16x32_bf16 v[52:55], v[220:223], a[160:163], v[52:55]
  v_mfma_f32_16x16x32_bf16 v[52:55], v[244:247], a[164:167], v[52:55]
  v_mfma_f32_16x16x32_bf16 v[56:59], v[224:227], a[160:163], v[56:59]
  s_waitcnt lgkmcnt(6)
  buffer_store_dwordx4 a[184:187], v65, s[8:11], s62 offen sc1
  v_mfma_f32_16x16x32_bf16 v[56:59], v[248:251], a[164:167], v[56:59]
  v_mfma_f32_16x16x32_bf16 v[60:63], v[228:231], a[160:163], v[60:63]
  v_mfma_f32_16x16x32_bf16 v[60:63], v[252:255], a[164:167], v[60:63]
  s_waitcnt lgkmcnt(8)
  v_mfma_f32_16x16x32_bf16 v[16:19], v[88:91], a[144:147], 0
  ds_read_b128 a[160:163], v1 offset:24832
  v_mfma_f32_16x16x32_bf16 v[16:19], a[0:3], a[148:151], v[16:19]
  ds_read_b128 a[164:167], v2 offset:24832
  v_mfma_f32_16x16x32_bf16 v[20:23], v[92:95], a[144:147], 0
  v_mfma_f32_16x16x32_bf16 v[20:23], a[4:7], a[148:151], v[20:23]
  v_cvt_pk_bf16_f32 v40, v40, v41
  v_mfma_f32_16x16x32_bf16 v[24:27], v[96:99], a[144:147], 0
  v_cvt_pk_bf16_f32 v41, v42, v43
  v_mfma_f32_16x16x32_bf16 v[24:27], a[8:11], a[148:151], v[24:27]
  v_cvt_pk_bf16_f32 v42, v44, v45
  v_mfma_f32_16x16x32_bf16 v[28:31], v[100:103], a[144:147], 0
  s_waitcnt lgkmcnt(7)
  buffer_store_dwordx4 a[188:191], v85, s[8:11], s63 offen sc1
  v_mfma_f32_16x16x32_bf16 v[28:31], a[12:15], a[148:151], v[28:31]
  v_cvt_pk_bf16_f32 v43, v46, v47
  v_mfma_f32_16x16x32_bf16 v[32:35], v[104:107], a[144:147], 0
  ds_write_b128 v86, v[40:43] offset:36864
  v_mfma_f32_16x16x32_bf16 v[32:35], a[16:19], a[148:151], v[32:35]
  v_mfma_f32_16x16x32_bf16 v[36:39], v[108:111], a[144:147], 0
  v_mfma_f32_16x16x32_bf16 v[36:39], a[20:23], a[148:151], v[36:39]
  s_waitcnt lgkmcnt(3)
  v_mfma_f32_16x16x32_bf16 v[16:19], v[112:115], a[152:155], v[16:19]
  ds_read_b128 a[144:147], v3 offset:24832
  v_mfma_f32_16x16x32_bf16 v[16:19], a[24:27], a[156:159], v[16:19]
  ds_read_b128 a[148:151], v4 offset:24832
  v_mfma_f32_16x16x32_bf16 v[20:23], v[116:119], a[152:155], v[20:23]
  v_mfma_f32_16x16x32_bf16 v[20:23], a[28:31], a[156:159], v[20:23]
  v_cvt_pk_bf16_f32 v48, v48, v49
  v_mfma_f32_16x16x32_bf16 v[24:27], v[120:123], a[152:155], v[24:27]
  buffer_store_dwordx4 a[168:171], v80, s[8:11], s58 offen sc1
  v_mfma_f32_16x16x32_bf16 v[24:27], a[32:35], a[156:159], v[24:27]
  v_cvt_pk_bf16_f32 v49, v50, v51
  v_mfma_f32_16x16x32_bf16 v[28:31], v[124:127], a[152:155], v[28:31]
  v_cvt_pk_bf16_f32 v50, v52, v53
  v_mfma_f32_16x16x32_bf16 v[28:31], a[36:39], a[156:159], v[28:31]
  v_cvt_pk_bf16_f32 v51, v54, v55
  v_mfma_f32_16x16x32_bf16 v[32:35], v[128:131], a[152:155], v[32:35]
  ds_write_b128 v87, v[48:51] offset:36864
  v_mfma_f32_16x16x32_bf16 v[32:35], a[40:43], a[156:159], v[32:35]
  v_mfma_f32_16x16x32_bf16 v[36:39], v[132:135], a[152:155], v[36:39]
  v_mfma_f32_16x16x32_bf16 v[36:39], a[44:47], a[156:159], v[36:39]
  s_waitcnt lgkmcnt(4)
  v_mfma_f32_16x16x32_bf16 v[16:19], v[136:139], a[160:163], v[16:19]
  ds_read_b128 a[152:155], v1 offset:25088
  v_mfma_f32_16x16x32_bf16 v[16:19], a[48:51], a[164:167], v[16:19]
  ds_read_b128 a[156:159], v2 offset:25088
  v_mfma_f32_16x16x32_bf16 v[20:23], v[140:143], a[160:163], v[20:23]
  v_mfma_f32_16x16x32_bf16 v[20:23], a[52:55], a[164:167], v[20:23]
  v_mfma_f32_16x16x32_bf16 v[24:27], v[144:147], a[160:163], v[24:27]
  buffer_store_dwordx4 a[172:175], v81, s[8:11], s58 offen sc1
  v_mfma_f32_16x16x32_bf16 v[24:27], a[56:59], a[164:167], v[24:27]
  v_mfma_f32_16x16x32_bf16 v[28:31], v[148:151], a[160:163], v[28:31]
  v_mfma_f32_16x16x32_bf16 v[28:31], a[60:63], a[164:167], v[28:31]
  v_mfma_f32_16x16x32_bf16 v[32:35], v[152:155], a[160:163], v[32:35]
  v_mfma_f32_16x16x32_bf16 v[32:35], a[64:67], a[164:167], v[32:35]
  v_mfma_f32_16x16x32_bf16 v[36:39], v[156:159], a[160:163], v[36:39]
  v_mfma_f32_16x16x32_bf16 v[36:39], a[68:71], a[164:167], v[36:39]
  s_waitcnt lgkmcnt(3)
  v_mfma_f32_16x16x32_bf16 v[16:19], v[160:163], a[144:147], v[16:19]
  ds_read_b128 a[160:163], v3 offset:25088
  v_mfma_f32_16x16x32_bf16 v[16:19], a[72:75], a[148:151], v[16:19]
  ds_read_b128 a[164:167], v4 offset:25088
  v_mfma_f32_16x16x32_bf16 v[20:23], v[164:167], a[144:147], v[20:23]
  v_cvt_pk_bf16_f32 v56, v56, v57
  v_mfma_f32_16x16x32_bf16 v[20:23], a[76:79], a[148:151], v[20:23]
  v_cvt_pk_bf16_f32 v57, v58, v59
  v_mfma_f32_16x16x32_bf16 v[24:27], v[168:171], a[144:147], v[24:27]
  buffer_store_dwordx4 a[176:179], v82, s[8:11], s58 offen sc1
  v_mfma_f32_16x16x32_bf16 v[24:27], a[80:83], a[148:151], v[24:27]
  s_mov_b64 s[82:83], s[80:81]
  v_cvt_pk_bf16_f32 v58, v60, v61
  v_mfma_f32_16x16x32_bf16 v[28:31], v[172:175], a[144:147], v[28:31]
  s_mov_b64 s[80:81], s[78:79]
  v_cvt_pk_bf16_f32 v59, v62, v63
  v_mfma_f32_16x16x32_bf16 v[28:31], a[84:87], a[148:151], v[28:31]
  ds_write_b128 v86, v[56:59] offset:36992
  v_mfma_f32_16x16x32_bf16 v[32:35], v[176:179], a[144:147], v[32:35]
  s_mov_b64 s[78:79], s[76:77]
  s_add_u32 s76, s33, s32
  v_mfma_f32_16x16x32_bf16 v[32:35], a[88:91], a[148:151], v[32:35]
  s_xor_b32 s76, s76, s34
  s_add_u32 s77, s32, 24576
  v_mfma_f32_16x16x32_bf16 v[36:39], v[180:183], a[144:147], v[36:39]
  s_cmp_lt_u32 s32, s35
  s_cselect_b32 s22, s32, s40
  v_mfma_f32_16x16x32_bf16 v[36:39], a[92:95], a[148:151], v[36:39]
  s_cselect_b32 s77, s77, s40
  s_waitcnt lgkmcnt(3)
  v_mfma_f32_16x16x32_bf16 v[16:19], v[184:187], a[152:155], v[16:19]
  ds_read_b128 a[144:147], v1 offset:36864
  s_bitcmp1_b32 s76, 21
  v_mfma_f32_16x16x32_bf16 v[16:19], a[96:99], a[156:159], v[16:19]
  ds_read_b128 a[148:151], v2 offset:36864
  s_cselect_b32 s76, s77, s22
  v_mfma_f32_16x16x32_bf16 v[20:23], v[188:191], a[152:155], v[20:23]
  s_cselect_b32 s77, s22, s77
  s_cselect_b64 s[56:57], -1, 0
  v_mfma_f32_16x16x32_bf16 v[20:23], a[100:103], a[156:159], v[20:23]
  s_add_u32 s32, s32, 786432
  s_add_u32 m0, s39, 24576
  v_mfma_f32_16x16x32_bf16 v[24:27], v[192:195], a[152:155], v[24:27]
  buffer_load_dwordx4 v8, s[4:7], s76 offen nt lds
  v_mfma_f32_16x16x32_bf16 v[24:27], a[104:107], a[156:159], v[24:27]
  s_mov_b32 s58, s80
  s_mov_b32 s59, s82
  v_mfma_f32_16x16x32_bf16 v[28:31], v[196:199], a[152:155], v[28:31]
  s_mov_b32 s63, s83
  s_min_u32 s62, s82, s83
  v_mfma_f32_16x16x32_bf16 v[28:31], a[108:111], a[156:159], v[28:31]
  s_cmp_gt_u32 s82, s83
  s_cselect_b64 s[90:91], -1, 0
  v_mfma_f32_16x16x32_bf16 v[32:35], v[200:203], a[152:155], v[32:35]
  v_cndmask_b32 v65, v84, v64, s[90:91]
  v_mfma_f32_16x16x32_bf16 v[32:35], a[112:115], a[156:159], v[32:35]
  v_mfma_f32_16x16x32_bf16 v[36:39], v[204:207], a[152:155], v[36:39]
  v_mfma_f32_16x16x32_bf16 v[36:39], a[116:119], a[156:159], v[36:39]
  s_waitcnt lgkmcnt(3)
  v_mfma_f32_16x16x32_bf16 v[16:19], v[208:211], a[160:163], v[16:19]
  ds_read_b128 a[152:155], v3 offset:36864
  v_mfma_f32_16x16x32_bf16 v[16:19], v[232:235], a[164:167], v[16:19]
  ds_read_b128 a[156:159], v4 offset:36864
  v_mfma_f32_16x16x32_bf16 v[20:23], v[212:215], a[160:163], v[20:23]
  v_mfma_f32_16x16x32_bf16 v[20:23], v[236:239], a[164:167], v[20:23]
  s_add_u32 m0, s39, 28672
  v_mfma_f32_16x16x32_bf16 v[24:27], v[216:219], a[160:163], v[24:27]
  buffer_load_dwordx4 v9, s[4:7], s76 offen nt lds
  v_mfma_f32_16x16x32_bf16 v[24:27], v[240:243], a[164:167], v[24:27]
  v_mfma_f32_16x16x32_bf16 v[28:31], v[220:223], a[160:163], v[28:31]
  v_mfma_f32_16x16x32_bf16 v[28:31], v[244:247], a[164:167], v[28:31]
  v_mfma_f32_16x16x32_bf16 v[32:35], v[224:227], a[160:163], v[32:35]
  v_mfma_f32_16x16x32_bf16 v[32:35], v[248:251], a[164:167], v[32:35]
  v_mfma_f32_16x16x32_bf16 v[36:39], v[228:231], a[160:163], v[36:39]
  v_mfma_f32_16x16x32_bf16 v[36:39], v[252:255], a[164:167], v[36:39]
  s_waitcnt lgkmcnt(2)
  v_mfma_f32_16x16x32_bf16 v[40:43], v[88:91], a[144:147], 0
  ds_read_b128 a[160:163], v1 offset:37120
  v_mfma_f32_16x16x32_bf16 v[40:43], a[0:3], a[148:151], v[40:43]
  ds_read_b128 a[164:167], v2 offset:37120
  v_mfma_f32_16x16x32_bf16 v[44:47], v[92:95], a[144:147], 0
  s_add_u32 m0, s39, 32768
  v_mfma_f32_16x16x32_bf16 v[44:47], a[4:7], a[148:151], v[44:47]
  v_cvt_pk_bf16_f32 v16, v16, v17
  v_mfma_f32_16x16x32_bf16 v[48:51], v[96:99], a[144:147], 0
  buffer_load_dwordx4 v10, s[4:7], s76 offen nt lds
  v_mfma_f32_16x16x32_bf16 v[48:51], a[8:11], a[148:151], v[48:51]
  v_cvt_pk_bf16_f32 v17, v18, v19
  v_mfma_f32_16x16x32_bf16 v[52:55], v[100:103], a[144:147], 0
  v_cvt_pk_bf16_f32 v18, v20, v21
  v_mfma_f32_16x16x32_bf16 v[52:55], a[12:15], a[148:151], v[52:55]
  v_cvt_pk_bf16_f32 v19, v22, v23
  v_mfma_f32_16x16x32_bf16 v[56:59], v[104:107], a[144:147], 0
  ds_write_b128 v86, v[16:19] offset:24576
  v_mfma_f32_16x16x32_bf16 v[56:59], a[16:19], a[148:151], v[56:59]
  s_add_u32 m0, s39, 36864
  v_mfma_f32_16x16x32_bf16 v[60:63], v[108:111], a[144:147], 0
  v_cvt_pk_bf16_f32 v24, v24, v25
  v_mfma_f32_16x16x32_bf16 v[60:63], a[20:23], a[148:151], v[60:63]
  s_waitcnt lgkmcnt(3)
  v_mfma_f32_16x16x32_bf16 v[40:43], v[112:115], a[152:155], v[40:43]
  ds_read_b128 a[144:147], v3 offset:37120
  v_mfma_f32_16x16x32_bf16 v[40:43], a[24:27], a[156:159], v[40:43]
  ds_read_b128 a[148:151], v4 offset:37120
  v_mfma_f32_16x16x32_bf16 v[44:47], v[116:119], a[152:155], v[44:47]
  v_cvt_pk_bf16_f32 v25, v26, v27
  v_mfma_f32_16x16x32_bf16 v[44:47], a[28:31], a[156:159], v[44:47]
  v_cvt_pk_bf16_f32 v26, v28, v29
  v_mfma_f32_16x16x32_bf16 v[48:51], v[120:123], a[152:155], v[48:51]
  buffer_load_dwordx4 v11, s[4:7], s76 offen nt lds
  v_mfma_f32_16x16x32_bf16 v[48:51], a[32:35], a[156:159], v[48:51]
  v_cvt_pk_bf16_f32 v27, v30, v31
  v_mfma_f32_16x16x32_bf16 v[52:55], v[124:127], a[152:155], v[52:55]
  ds_write_b128 v87, v[24:27] offset:24576
  v_mfma_f32_16x16x32_bf16 v[52:55], a[36:39], a[156:159], v[52:55]
  v_mfma_f32_16x16x32_bf16 v[56:59], v[128:131], a[152:155], v[56:59]
  v_mfma_f32_16x16x32_bf16 v[56:59], a[40:43], a[156:159], v[56:59]
  v_mfma_f32_16x16x32_bf16 v[60:63], v[132:135], a[152:155], v[60:63]
  v_cndmask_b32 v15, v12, v14, s[56:57]
  v_mfma_f32_16x16x32_bf16 v[60:63], a[44:47], a[156:159], v[60:63]
  s_waitcnt lgkmcnt(4)
  v_mfma_f32_16x16x32_bf16 v[40:43], v[136:139], a[160:163], v[40:43]
  ds_read_b128 a[152:155], v1 offset:37376
  v_mfma_f32_16x16x32_bf16 v[40:43], a[48:51], a[164:167], v[40:43]
  ds_read_b128 a[156:159], v2 offset:37376
  v_mfma_f32_16x16x32_bf16 v[44:47], v[140:143], a[160:163], v[44:47]
  s_add_u32 m0, s39, 40960
  v_mfma_f32_16x16x32_bf16 v[44:47], a[52:55], a[164:167], v[44:47]
  v_cvt_pk_bf16_f32 v32, v32, v33
  v_mfma_f32_16x16x32_bf16 v[48:51], v[144:147], a[160:163], v[48:51]
  buffer_load_dwordx4 v15, s[4:7], s22 offen nt lds
  v_mfma_f32_16x16x32_bf16 v[48:51], a[56:59], a[164:167], v[48:51]
  v_cvt_pk_bf16_f32 v33, v34, v35
  v_mfma_f32_16x16x32_bf16 v[52:55], v[148:151], a[160:163], v[52:55]
  v_cvt_pk_bf16_f32 v34, v36, v37
  v_mfma_f32_16x16x32_bf16 v[52:55], a[60:63], a[164:167], v[52:55]
  v_cvt_pk_bf16_f32 v35, v38, v39
  v_mfma_f32_16x16x32_bf16 v[56:59], v[152:155], a[160:163], v[56:59]
  ds_write_b128 v86, v[32:35] offset:24704
  v_mfma_f32_16x16x32_bf16 v[56:59], a[64:67], a[164:167], v[56:59]
  v_mfma_f32_16x16x32_bf16 v[60:63], v[156:159], a[160:163], v[60:63]
  v_mfma_f32_16x16x32_bf16 v[60:63], a[68:71], a[164:167], v[60:63]
  s_waitcnt lgkmcnt(4)
  v_mfma_f32_16x16x32_bf16 v[40:43], v[160:163], a[144:147], v[40:43]
  ds_read_b128 a[160:163], v3 offset:37376
  v_mfma_f32_16x16x32_bf16 v[40:43], a[72:75], a[148:151], v[40:43]
  ds_read_b128 a[164:167], v4 offset:37376
  v_mfma_f32_16x16x32_bf16 v[44:47], v[164:167], a[144:147], v[44:47]
  s_add_u32 m0, s39, 45056
  v_mfma_f32_16x16x32_bf16 v[44:47], a[76:79], a[148:151], v[44:47]
  s_xor_b32 s39, s39, 49152
  v_mfma_f32_16x16x32_bf16 v[48:51], v[168:171], a[144:147], v[48:51]
  buffer_load_dwordx4 v13, s[4:7], s77 offen nt lds
  v_mfma_f32_16x16x32_bf16 v[48:51], a[80:83], a[148:151], v[48:51]
  v_mfma_f32_16x16x32_bf16 v[52:55], v[172:175], a[144:147], v[52:55]
  v_mfma_f32_16x16x32_bf16 v[52:55], a[84:87], a[148:151], v[52:55]
  v_mfma_f32_16x16x32_bf16 v[56:59], v[176:179], a[144:147], v[56:59]
  v_mfma_f32_16x16x32_bf16 v[56:59], a[88:91], a[148:151], v[56:59]
  v_mfma_f32_16x16x32_bf16 v[60:63], v[180:183], a[144:147], v[60:63]
  v_mfma_f32_16x16x32_bf16 v[60:63], a[92:95], a[148:151], v[60:63]
  s_waitcnt vmcnt(12) lgkmcnt(2)
  s_barrier
  v_xor_b32 v1, 49152, v1
  v_xor_b32 v2, 49152, v2
  v_xor_b32 v3, 49152, v3
  v_xor_b32 v4, 49152, v4
  s_waitcnt lgkmcnt(3)
  v_mfma_f32_16x16x32_bf16 v[40:43], v[184:187], a[152:155], v[40:43]
  ds_read_b128 a[144:147], v1 offset:0
  v_mfma_f32_16x16x32_bf16 v[40:43], a[96:99], a[156:159], v[40:43]
  ds_read_b128 a[148:151], v2 offset:0
  v_mfma_f32_16x16x32_bf16 v[44:47], v[188:191], a[152:155], v[44:47]
  ds_read_b128 a[180:183], v5 offset:36864
  v_mfma_f32_16x16x32_bf16 v[44:47], a[100:103], a[156:159], v[44:47]
  ds_read_b128 a[184:187], v6 offset:36864
  v_mfma_f32_16x16x32_bf16 v[48:51], v[192:195], a[152:155], v[48:51]
  ds_read_b128 a[188:191], v7 offset:36864
  v_mfma_f32_16x16x32_bf16 v[48:51], a[104:107], a[156:159], v[48:51]
  ds_read_b128 a[168:171], v5 offset:24576
  v_mfma_f32_16x16x32_bf16 v[52:55], v[196:199], a[152:155], v[52:55]
  ds_read_b128 a[172:175], v6 offset:24576
  v_mfma_f32_16x16x32_bf16 v[52:55], a[108:111], a[156:159], v[52:55]
  ds_read_b128 a[176:179], v7 offset:24576
  v_mfma_f32_16x16x32_bf16 v[56:59], v[200:203], a[152:155], v[56:59]
  v_mfma_f32_16x16x32_bf16 v[56:59], a[112:115], a[156:159], v[56:59]
  v_mfma_f32_16x16x32_bf16 v[60:63], v[204:207], a[152:155], v[60:63]
  v_mfma_f32_16x16x32_bf16 v[60:63], a[116:119], a[156:159], v[60:63]
  s_waitcnt lgkmcnt(8)
  v_mfma_f32_16x16x32_bf16 v[40:43], v[208:211], a[160:163], v[40:43]
  ds_read_b128 a[152:155], v3 offset:0
  v_mfma_f32_16x16x32_bf16 v[40:43], v[232:235], a[164:167], v[40:43]
  ds_read_b128 a[156:159], v4 offset:0
  v_mfma_f32_16x16x32_bf16 v[44:47], v[212:215], a[160:163], v[44:47]
  s_waitcnt lgkmcnt(7)
  buffer_store_dwordx4 a[180:183], v83, s[8:11], s59 offen sc1
  v_mfma_f32_16x16x32_bf16 v[44:47], v[236:239], a[164:167], v[44:47]
  v_mfma_f32_16x16x32_bf16 v[48:51], v[216:219], a[160:163], v[48:51]
  v_mfma_f32_16x16x32_bf16 v[48:51], v[240:243], a[164:167], v[48:51]
  v_mfma_f32_16x16x32_bf16 v[52:55], v[220:223], a[160:163], v[52:55]
  v_mfma_f32_16x16x32_bf16 v[52:55], v[244:247], a[164:167], v[52:55]
  v_mfma_f32_16x16x32_bf16 v[56:59], v[224:227], a[160:163], v[56:59]
  s_waitcnt lgkmcnt(6)
  buffer_store_dwordx4 a[184:187], v65, s[8:11], s62 offen sc1
  v_mfma_f32_16x16x32_bf16 v[56:59], v[248:251], a[164:167], v[56:59]
  v_mfma_f32_16x16x32_bf16 v[60:63], v[228:231], a[160:163], v[60:63]
  v_mfma_f32_16x16x32_bf16 v[60:63], v[252:255], a[164:167], v[60:63]
  s_cmp_lt_u32 s78, s40
  s_cbranch_scc1 L_loop
L_tail:
  s_nop 3
  v_cvt_pk_bf16_f32 v40, v40, v41
  v_cvt_pk_bf16_f32 v41, v42, v43
  v_cvt_pk_bf16_f32 v42, v44, v45
  v_cvt_pk_bf16_f32 v43, v46, v47
  ds_write_b128 v86, v[40:43] offset:12288
  v_cvt_pk_bf16_f32 v48, v48, v49
  v_cvt_pk_bf16_f32 v49, v50, v51
  v_cvt_pk_bf16_f32 v50, v52, v53
  v_cvt_pk_bf16_f32 v51, v54, v55
  ds_write_b128 v87, v[48:51] offset:12288
  v_cvt_pk_bf16_f32 v56, v56, v57
  v_cvt_pk_bf16_f32 v57, v58, v59
  v_cvt_pk_bf16_f32 v58, v60, v61
  v_cvt_pk_bf16_f32 v59, v62, v63
  ds_write_b128 v86, v[56:59] offset:12416
  s_waitcnt lgkmcnt(8)
  buffer_store_dwordx4 a[188:191], v85, s[8:11], s63 offen sc1
  s_waitcnt lgkmcnt(7)
  buffer_store_dwordx4 a[168:171], v80, s[8:11], s58 offen sc1
  s_waitcnt lgkmcnt(6)
  buffer_store_dwordx4 a[172:175], v81, s[8:11], s58 offen sc1
  s_waitcnt lgkmcnt(5)
  buffer_store_dwordx4 a[176:179], v82, s[8:11], s58 offen sc1
  s_mov_b32 s58, s78
  s_mov_b32 s59, s80
  s_mov_b32 s63, s81
  s_min_u32 s62, s80, s81
  s_cmp_gt_u32 s80, s81
  s_cselect_b64 s[90:91], -1, 0
  s_nop 0
  v_cndmask_b32 v65, v84, v64, s[90:91]
  s_waitcnt lgkmcnt(0)
  s_barrier
  ds_read_b128 a[144:147], v5 offset:12288
  ds_read_b128 a[148:151], v6 offset:12288
  ds_read_b128 a[152:155], v7 offset:12288
  s_waitcnt lgkmcnt(2)
  buffer_store_dwordx4 a[144:147], v83, s[8:11], s59 offen sc1
  s_waitcnt lgkmcnt(1)
  buffer_store_dwordx4 a[148:151], v65, s[8:11], s62 offen sc1
  s_waitcnt lgkmcnt(0)
  buffer_store_dwordx4 a[152:155], v85, s[8:11], s63 offen sc1
  s_endpgm
L_slow:
  v_mov_b32 v15, s36
  v_mov_b32 v254, 1
  v_mov_b32 v255, 0
  s_mov_b64 exec, 1
  buffer_atomic_cmpswap v[254:255], v15, s[16:19], 0 offen sc0 sc1
  s_waitcnt vmcnt(0)
  v_readfirstlane_b32 s95, v254
  s_mov_b64 exec, -1
  s_branch L_back
L_done:
  s_endpgm
.section .rodata,"a"
.p2align 6
.amdhsa_kernel standalone__depthwise_separable__vision_kernel
  .amdhsa_next_free_vgpr 512
  .amdhsa_next_free_sgpr 100
  .amdhsa_accum_offset 256
  .amdhsa_group_segment_fixed_size 0
  .amdhsa_kernarg_size 48
  .amdhsa_user_sgpr_count 2
  .amdhsa_user_sgpr_kernarg_segment_ptr 1
  .amdhsa_system_sgpr_workgroup_id_x 1
  .amdhsa_float_denorm_mode_32 3
.end_amdhsa_kernel
```

```asm
; @launch grid=(256,1,1) block=(256,1,1) lds=152128
.amdgcn_target "amdgcn-amd-amdhsa--gfx950"
.text
.globl standalone__depthwise_separable__vision_kernel
.p2align 8
.type standalone__depthwise_separable__vision_kernel,@function
standalone__depthwise_separable__vision_kernel:
  s_load_dwordx8 s[24:31], s[0:1], 0
  s_load_dwordx2 s[92:93], s[0:1], 32
  s_cmp_ge_u32 s2, 256
  s_cbranch_scc1 L_done
  v_lshrrev_b32 v16, 6, v0
  v_and_b32 v28, 63, v0
  v_readfirstlane_b32 s20, v16
  s_getpc_b64 s[50:51]
L_pc:
  v_mul_u32_u24 v18, 128, v0
  v_min_u32 v18, L_done-L_pc, v18
  v_mov_b32 v19, s51
  v_add_co_u32 v18, vcc, s50, v18
  s_nop 1
  v_addc_co_u32 v19, vcc, 0, v19, vcc
  global_load_dword v88, v[18:19], off
  s_lshr_b32 s50, s2, 3
  s_and_b32 s55, s50, 3
  s_lshr_b32 s54, s50, 2
  s_mul_i32 s51, s54, 11
  s_lshr_b32 s51, s51, 5
  s_mul_i32 s51, s51, 3
  s_sub_u32 s54, s54, s51
  s_mul_i32 s52, s20, 192
  v_mul_u32_u24 v18, 0xaaab, v28
  v_lshrrev_b32 v18, 19, v18
  v_mul_u32_u24 v19, 576, v18
  v_lshl_add_u32 v19, v28, 4, v19
  v_add_u32 v64, s52, v19
  v_add_u32 v17, 64, v28
  v_mul_u32_u24 v18, 0xaaab, v17
  v_lshrrev_b32 v18, 19, v18
  v_mul_u32_u24 v19, 576, v18
  v_lshl_add_u32 v19, v28, 4, v19
  v_lshrrev_b32 v18, 3, v18
  v_mul_u32_u24 v18, 6144, v18
  v_add_u32 v19, v19, v18
  v_add_u32 v65, s52, v19
  v_add_u32 v17, 128, v28
  v_mul_u32_u24 v18, 0xaaab, v17
  v_lshrrev_b32 v18, 19, v18
  v_mul_u32_u24 v19, 576, v18
  v_lshl_add_u32 v19, v28, 4, v19
  v_add_u32 v19, 6144, v19
  v_add_u32 v66, s52, v19
  s_mul_i32 s42, s54, 98304
  s_mul_i32 s45, s55, 24576
  s_mul_i32 s49, s20, 6160
  s_waitcnt lgkmcnt(0)
  s_mov_b32 s12, s28
  s_and_b32 s13, s29, 0xffff
  s_mov_b32 s14, 294912
  s_mov_b32 s15, 0x00020000
  s_add_u32 m0, s49, 98560
  s_add_u32 s50, s42, s45
  buffer_load_dwordx4 v64, s[12:15], s50 offen offset:0 lds
  buffer_load_dwordx4 v65, s[12:15], s50 offen offset:1024 lds
  buffer_load_dwordx4 v66, s[12:15], s50 offen offset:2048 lds
  s_add_u32 m0, s49, 101640
  s_add_u32 s50, s50, 6144
  buffer_load_dwordx4 v64, s[12:15], s50 offen offset:0 lds
  buffer_load_dwordx4 v65, s[12:15], s50 offen offset:1024 lds
  buffer_load_dwordx4 v66, s[12:15], s50 offen offset:2048 lds
  s_lshr_b32 s51, s2, 5
  s_and_b32 s52, s2, 3
  s_lshl2_add_u32 s36, s51, s52
  s_lshl_b32 s36, s36, 2
  s_mul_i32 s51, s51, 288
  s_lshl2_add_u32 s52, s55, s52
  s_add_u32 s51, s51, s52
  s_mul_i32 s32, s51, 49152
  s_add_u32 s35, s32, 14155776
  s_lshl_b32 s51, s20, 11
  s_and_b32 s52, s2, 4
  s_lshl_b32 s52, s52, 6
  s_add_u32 s51, s51, s52
  s_add_u32 s37, s32, s51
  s_add_u32 s37, s37, 7077888
  s_add_u32 s38, s37, 8192
  s_and_b32 s23, s2, 28
  s_cmp_lg_u32 s23, 0
  s_cbranch_scc1 L_np0
  s_load_dword s84, s[24:25], s37 glc
  s_load_dword s85, s[24:25], s38 glc
L_np0:
  s_lshl_b32 s53, s55, 2
  v_lshrrev_b32 v17, 4, v28
  v_add_u32 v18, s54, v17
  v_subrev_u32 v19, 3, v18
  v_min_u32 v18, v18, v19
  v_and_b32 v20, 15, v28
  v_xor_b32 v19, s53, v20
  v_lshlrev_b32 v19, 4, v19
  v_lshl_add_u32 v19, v18, 8, v19
  v_cmp_lt_u32 vcc, 47, v28
  s_lshl_b32 s50, s20, 10
  s_add_u32 m0, s50, 147968
  v_cndmask_b32 v19, v19, v66, vcc
  s_mov_b32 s16, s26
  s_and_b32 s17, s27, 0xffff
  s_mov_b32 s18, 768
  s_mov_b32 s19, 0x00020000
  buffer_load_dwordx4 v19, s[16:19], 0 offen lds
  s_add_u32 s43, s42, 98304
  s_cmp_eq_u32 s54, 2
  s_cselect_b32 s43, 0, s43
  s_add_u32 s44, s43, 98304
  s_cmp_eq_u32 s54, 1
  s_cselect_b32 s44, 0, s44
  s_xor_b32 s46, s55, 1
  s_mul_i32 s46, s46, 24576
  s_xor_b32 s47, s55, 2
  s_mul_i32 s47, s47, 24576
  s_xor_b32 s48, s55, 3
  s_mul_i32 s48, s48, 24576
  s_mov_b32 s4, s24
  s_and_b32 s5, s25, 0xffff
  s_mov_b32 s6, 113246208
  s_mov_b32 s7, 0x00020000
  s_add_u32 s33, s24, 24576
  s_mov_b32 s40, 113246208
  s_lshl_b32 s39, s20, 10
  s_mov_b32 s76, s40
  s_mov_b32 s77, s40
  s_mov_b32 s78, s40
  s_mov_b32 s79, s40
  s_mov_b32 s80, s40
  s_mov_b32 s81, s40
  s_lshr_b32 s34, s2, 1
  s_xor_b32 s34, s34, s2
  s_and_b32 s34, s34, 4
  s_lshl_b32 s34, s34, 19
  v_lshrrev_b32 v35, 4, v0
  v_xor_b32 v22, s53, v20
  v_mul_u32_u24 v32, 43, v35
  v_lshrrev_b32 v32, 7, v32
  v_mul_u32_u24 v18, 3, v32
  v_sub_u32 v19, v35, v18
  v_add_u32 v19, s54, v19
  v_subrev_u32 v21, 3, v19
  v_min_u32 v19, v19, v21
  v_add_u32 v19, v19, v18
  v_xor_b32 v21, v32, v22
  v_lshlrev_b32 v21, 4, v21
  v_lshl_add_u32 v8, v19, 8, v21
  v_add_u32 v11, 19968, v8
  v_add_u32 v36, 16, v35
  v_mul_u32_u24 v33, 43, v36
  v_lshrrev_b32 v33, 7, v33
  v_mul_u32_u24 v18, 3, v33
  v_sub_u32 v19, v36, v18
  v_add_u32 v19, s54, v19
  v_subrev_u32 v21, 3, v19
  v_min_u32 v19, v19, v21
  v_add_u32 v19, v19, v18
  v_xor_b32 v21, v33, v22
  v_lshlrev_b32 v21, 4, v21
  v_lshl_add_u32 v9, v19, 8, v21
  v_cmp_lt_u32 vcc, 5, v33
  v_add_u32 v24, 19968, v9
  v_add_u32 v25, 28416, v9
  v_cndmask_b32 v12, v24, v25, vcc
  v_add_u32 v24, 44544, v9
  v_add_u32 v25, 3840, v9
  v_cndmask_b32 v14, v24, v25, vcc
  v_add_u32 v37, 32, v35
  v_mul_u32_u24 v34, 43, v37
  v_lshrrev_b32 v34, 7, v34
  v_mul_u32_u24 v18, 3, v34
  v_sub_u32 v19, v37, v18
  v_add_u32 v19, s54, v19
  v_subrev_u32 v21, 3, v19
  v_min_u32 v19, v19, v21
  v_add_u32 v19, v19, v18
  v_xor_b32 v21, v34, v22
  v_lshlrev_b32 v21, 4, v21
  v_lshl_add_u32 v10, v19, 8, v21
  v_cmp_lt_u32 vcc, 10, v34
  v_add_u32 v24, 7680, v10
  v_add_u32 v13, 3840, v10
  v_cndmask_b32 v10, v10, v24, vcc
  s_mov_b32 s8, s30
  s_and_b32 s9, s31, 0xffff
  s_mov_b32 s10, 113246208
  s_mov_b32 s11, 0x00020000
  v_lshlrev_b32 v80, 4, v0
  v_and_b32 v21, 7, v32
  v_xor_b32 v21, v21, v20
  v_lshlrev_b32 v21, 4, v21
  v_lshl_add_u32 v21, v35, 8, v21
  v_add_u32 v5, 98560, v21
  v_add_u32 v81, 4096, v80
  v_and_b32 v21, 7, v33
  v_xor_b32 v21, v21, v20
  v_lshlrev_b32 v21, 4, v21
  v_lshl_add_u32 v21, v36, 8, v21
  v_add_u32 v6, 98560, v21
  v_add_u32 v82, 8192, v80
  v_and_b32 v21, 7, v34
  v_xor_b32 v21, v21, v20
  v_lshlrev_b32 v21, 4, v21
  v_lshl_add_u32 v21, v37, 8, v21
  v_add_u32 v7, 98560, v21
  v_add_u32 v83, 19968, v80
  v_cmp_lt_u32 vcc, 5, v33
  v_add_u32 v24, 19968, v81
  v_add_u32 v25, 28416, v81
  v_cndmask_b32 v84, v24, v25, vcc
  v_cmp_lt_u32 vcc, 10, v34
  v_add_u32 v24, 7680, v82
  v_add_u32 v85, 3840, v82
  v_cndmask_b32 v82, v82, v24, vcc
  v_mul_u32_u24 v16, 0x300, v20
  v_xor_b32 v18, v17, v20
  v_lshl_add_u32 v1, v18, 4, v16
  v_xor_b32 v2, 64, v1
  v_xor_b32 v3, 128, v1
  v_xor_b32 v4, 192, v1
  s_mul_i32 s51, s20, 12
  v_and_b32 v18, 7, v20
  v_add_u32 v19, s51, v17
  v_xor_b32 v19, v19, v18
  v_lshl_add_u32 v86, v19, 4, v16
  v_add_u32 v86, 98560, v86
  v_add_u32 v19, s51, v17
  v_add_u32 v19, 4, v19
  v_xor_b32 v19, v19, v18
  v_lshl_add_u32 v87, v19, 4, v16
  v_add_u32 v87, 98560, v87
  v_bfe_u32 v18, v28, 2, 2
  v_and_b32 v19, 3, v28
  v_lshrrev_b32 v21, 1, v17
  v_lshl_add_u32 v21, v21, 3, v18
  v_mul_u32_u24 v21, 192, v21
  v_and_b32 v23, 1, v17
  v_mul_u32_u24 v23, 3080, v23
  v_add_u32 v21, v21, v23
  v_lshl_add_u32 v21, v19, 4, v21
  s_add_u32 s51, s49, 49152
  v_add_u32 v71, s51, v21
  v_add_u32 v67, 49408, v71
  s_add_u32 s51, s39, 147968
  v_lshl_add_u32 v68, v17, 4, s51
  v_and_b32 v21, 1, v28
  v_lshlrev_b32 v21, 4, v21
  v_mov_b32 v23, 0xffff
  v_lshlrev_b32 v21, v21, v23
  v_lshlrev_b32 v16, 1, v17
  v_bfe_u32 v23, v28, 1, 3
  v_cmp_eq_u32 vcc, v16, v23
  v_add_u32 v16, 1, v16
  s_nop 0
  v_cndmask_b32 v69, 0, v21, vcc
  v_cmp_eq_u32 vcc, v16, v23
  s_mov_b32 s16, s92
  s_and_b32 s17, s93, 0xffff
  s_mov_b32 s18, 256
  s_mov_b32 s19, 0x00020000
  v_cndmask_b32 v70, 0, v21, vcc
  s_add_u32 m0, s49, 123200
  s_add_u32 s50, s42, s46
  buffer_load_dwordx4 v64, s[12:15], s50 offen offset:0 lds
  buffer_load_dwordx4 v65, s[12:15], s50 offen offset:1024 lds
  buffer_load_dwordx4 v66, s[12:15], s50 offen offset:2048 lds
  s_add_u32 m0, s49, 126280
  s_add_u32 s50, s50, 6144
  buffer_load_dwordx4 v64, s[12:15], s50 offen offset:0 lds
  buffer_load_dwordx4 v65, s[12:15], s50 offen offset:1024 lds
  buffer_load_dwordx4 v66, s[12:15], s50 offen offset:2048 lds
  s_cmp_lg_u32 s23, 0
  s_cbranch_scc1 L_npr
  s_mov_b32 s41, 0xffff
  s_mov_b32 s95, 0xffff
  s_lshl_b32 s52, s20, 2
  s_add_u32 s52, s52, 152064
  v_mov_b32 v16, s52
  s_waitcnt lgkmcnt(0)
  s_memtime s[84:85]
  s_load_dword s52, s[24:25], s37 glc
  s_waitcnt lgkmcnt(0)
  s_memtime s[86:87]
  s_load_dword s52, s[24:25], s38 glc
  s_waitcnt lgkmcnt(0)
  s_sub_u32 s51, s86, s84
  s_memtime s[84:85]
  s_min_u32 s41, s41, s51
  s_waitcnt lgkmcnt(0)
  s_sub_u32 s51, s84, s86
  s_min_u32 s95, s95, s51
  s_lshl_b32 s41, s41, 16
  s_or_b32 s41, s41, s95
  v_mov_b32 v18, s41
  ds_write_b32 v16, v18
  s_waitcnt lgkmcnt(0)
L_npr:
  s_add_u32 m0, s49, 49152
  s_add_u32 s50, s42, s47
  buffer_load_dwordx4 v64, s[12:15], s50 offen offset:0 lds
  buffer_load_dwordx4 v65, s[12:15], s50 offen offset:1024 lds
  buffer_load_dwordx4 v66, s[12:15], s50 offen offset:2048 lds
  s_add_u32 m0, s49, 52232
  s_add_u32 s50, s50, 6144
  buffer_load_dwordx4 v64, s[12:15], s50 offen offset:0 lds
  buffer_load_dwordx4 v65, s[12:15], s50 offen offset:1024 lds
  buffer_load_dwordx4 v66, s[12:15], s50 offen offset:2048 lds
  s_add_u32 m0, s49, 73792
  s_add_u32 s50, s42, s48
  buffer_load_dwordx4 v64, s[12:15], s50 offen offset:0 lds
  buffer_load_dwordx4 v65, s[12:15], s50 offen offset:1024 lds
  buffer_load_dwordx4 v66, s[12:15], s50 offen offset:2048 lds
  s_add_u32 m0, s49, 76872
  s_add_u32 s50, s50, 6144
  buffer_load_dwordx4 v64, s[12:15], s50 offen offset:0 lds
  buffer_load_dwordx4 v65, s[12:15], s50 offen offset:1024 lds
  buffer_load_dwordx4 v66, s[12:15], s50 offen offset:2048 lds
  s_waitcnt vmcnt(18)
  ds_read_b128 v[72:75], v68 offset:0
  ds_read_b64_tr_b16 a[192:193], v67 offset:0
  ds_read_b64_tr_b16 a[194:195], v67 offset:768
  ds_read_b64_tr_b16 a[196:197], v67 offset:8
  ds_read_b64_tr_b16 a[198:199], v67 offset:776
  ds_read_b64_tr_b16 a[200:201], v67 offset:64
  ds_read_b64_tr_b16 a[202:203], v67 offset:832
  ds_read_b64_tr_b16 a[204:205], v67 offset:72
  ds_read_b64_tr_b16 a[206:207], v67 offset:840
  ds_read_b64_tr_b16 a[208:209], v67 offset:128
  ds_read_b64_tr_b16 a[210:211], v67 offset:896
  ds_read_b64_tr_b16 a[212:213], v67 offset:136
  ds_read_b64_tr_b16 a[214:215], v67 offset:904
  s_waitcnt lgkmcnt(0)
  v_and_b32 v72, v69, v72
  v_and_b32 v73, v70, v73
  v_and_b32 v74, v69, v74
  v_and_b32 v75, v70, v75
  s_waitcnt vmcnt(12)
  ds_read_b128 v[76:79], v68 offset:64
  v_mfma_f32_16x16x16_bf16 v[16:19], v[72:73], a[192:193], 0
  ds_read_b64_tr_b16 a[216:217], v67 offset:24640
  ds_read_b64_tr_b16 a[218:219], v67 offset:25408
  v_mfma_f32_16x16x16_bf16 v[20:23], v[74:75], a[194:195], 0
  ds_read_b64_tr_b16 a[220:221], v67 offset:24648
  ds_read_b64_tr_b16 a[222:223], v67 offset:25416
  v_mfma_f32_16x16x16_bf16 v[24:27], v[72:73], a[196:197], 0
  ds_read_b64_tr_b16 a[224:225], v67 offset:24704
  ds_read_b64_tr_b16 a[226:227], v67 offset:25472
  v_mfma_f32_16x16x16_bf16 v[28:31], v[74:75], a[198:199], 0
  ds_read_b64_tr_b16 a[228:229], v67 offset:24712
  ds_read_b64_tr_b16 a[230:231], v67 offset:25480
  v_mfma_f32_16x16x16_bf16 v[32:35], v[72:73], a[200:201], 0
  ds_read_b64_tr_b16 a[232:233], v67 offset:24768
  ds_read_b64_tr_b16 a[234:235], v67 offset:25536
  v_cvt_pk_bf16_f32 v88, v16, v17
  v_cvt_pk_bf16_f32 v89, v18, v19
  v_mfma_f32_16x16x16_bf16 v[36:39], v[74:75], a[202:203], 0
  ds_read_b64_tr_b16 a[236:237], v67 offset:24776
  ds_read_b64_tr_b16 a[238:239], v67 offset:25544
  v_cvt_pk_bf16_f32 v90, v20, v21
  v_cvt_pk_bf16_f32 v91, v22, v23
  v_mfma_f32_16x16x16_bf16 v[40:43], v[72:73], a[204:205], 0
  s_add_u32 m0, s49, 98560
  s_add_u32 s50, s43, s45
  v_cvt_pk_bf16_f32 v92, v24, v25
  v_cvt_pk_bf16_f32 v93, v26, v27
  v_mfma_f32_16x16x16_bf16 v[44:47], v[74:75], a[206:207], 0
  buffer_load_dwordx4 v64, s[12:15], s50 offen offset:0 lds
  buffer_load_dwordx4 v65, s[12:15], s50 offen offset:1024 lds
  v_cvt_pk_bf16_f32 v94, v28, v29
  v_cvt_pk_bf16_f32 v95, v30, v31
  v_mfma_f32_16x16x16_bf16 v[48:51], v[72:73], a[208:209], 0
  buffer_load_dwordx4 v66, s[12:15], s50 offen offset:2048 lds
  s_add_u32 m0, s49, 101640
  v_cvt_pk_bf16_f32 v96, v32, v33
  v_cvt_pk_bf16_f32 v97, v34, v35
  v_mfma_f32_16x16x16_bf16 v[52:55], v[74:75], a[210:211], 0
  s_add_u32 s50, s50, 6144
  buffer_load_dwordx4 v64, s[12:15], s50 offen offset:0 lds
  v_cvt_pk_bf16_f32 v98, v36, v37
  v_cvt_pk_bf16_f32 v99, v38, v39
  v_mfma_f32_16x16x16_bf16 v[56:59], v[72:73], a[212:213], 0
  buffer_load_dwordx4 v65, s[12:15], s50 offen offset:1024 lds
  v_cvt_pk_bf16_f32 v100, v40, v41
  v_cvt_pk_bf16_f32 v101, v42, v43
  v_mfma_f32_16x16x16_bf16 v[60:63], v[74:75], a[214:215], 0
  buffer_load_dwordx4 v66, s[12:15], s50 offen offset:2048 lds
  v_cvt_pk_bf16_f32 v102, v44, v45
  v_cvt_pk_bf16_f32 v103, v46, v47
  s_cmp_lg_u32 s23, 0
  s_cbranch_scc1 L_np1
  s_barrier
  s_or_b32 s51, s23, s20
  s_cmp_lg_u32 s51, 0
  s_cbranch_scc1 L_np1
  v_mov_b32 v252, 152064
  ds_read_b128 v[248:251], v252
  s_add_u32 s51, s33, s37
  s_lshr_b32 s51, s51, 21
  s_lshr_b32 s52, s2, 2
  s_xor_b32 s51, s51, s52
  s_and_b32 s51, s51, 1
  s_add_u32 s52, s51, 1
  s_sub_u32 s51, 2, s51
  v_mov_b32 v254, s52
  v_mov_b32 v253, s51
  v_mov_b32 v255, 0
  v_mov_b32 v252, s36
  s_waitcnt lgkmcnt(0)
  v_pk_min_u16 v248, v248, v249
  v_pk_min_u16 v250, v250, v251
  v_pk_min_u16 v248, v248, v250
  v_lshrrev_b32 v249, 16, v248
  v_and_b32 v248, 0xffff, v248
  v_cmp_gt_u32 vcc, v249, v248
  s_mov_b64 exec, 1
  s_nop 0
  v_cndmask_b32 v254, v254, v253, vcc
  buffer_atomic_cmpswap v[254:255], v252, s[16:19], 0 offen sc1
  s_mov_b64 exec, -1
L_np1:
  s_waitcnt lgkmcnt(0)
  v_and_b32 v76, v69, v76
  v_and_b32 v77, v70, v77
  v_and_b32 v78, v69, v78
  v_and_b32 v79, v70, v79
  s_waitcnt vmcnt(12)
  ds_read_b128 v[72:75], v68 offset:128
  v_mfma_f32_16x16x16_bf16 v[16:19], v[76:77], a[216:217], 0
  ds_read_b64_tr_b16 a[192:193], v71 offset:0
  ds_read_b64_tr_b16 a[194:195], v71 offset:768
  v_cvt_pk_bf16_f32 v104, v48, v49
  v_cvt_pk_bf16_f32 v105, v50, v51
  v_mfma_f32_16x16x16_bf16 v[20:23], v[78:79], a[218:219], 0
  ds_read_b64_tr_b16 a[196:197], v71 offset:8
  ds_read_b64_tr_b16 a[198:199], v71 offset:776
  v_cvt_pk_bf16_f32 v106, v52, v53
  v_cvt_pk_bf16_f32 v107, v54, v55
  v_mfma_f32_16x16x16_bf16 v[24:27], v[76:77], a[220:221], 0
  ds_read_b64_tr_b16 a[200:201], v71 offset:64
  ds_read_b64_tr_b16 a[202:203], v71 offset:832
  v_cvt_pk_bf16_f32 v108, v56, v57
  v_cvt_pk_bf16_f32 v109, v58, v59
  v_mfma_f32_16x16x16_bf16 v[28:31], v[78:79], a[222:223], 0
  ds_read_b64_tr_b16 a[204:205], v71 offset:72
  ds_read_b64_tr_b16 a[206:207], v71 offset:840
  v_cvt_pk_bf16_f32 v110, v60, v61
  v_cvt_pk_bf16_f32 v111, v62, v63
  v_mfma_f32_16x16x16_bf16 v[32:35], v[76:77], a[224:225], 0
  ds_read_b64_tr_b16 a[208:209], v71 offset:128
  ds_read_b64_tr_b16 a[210:211], v71 offset:896
  v_cvt_pk_bf16_f32 v16, v16, v17
  v_cvt_pk_bf16_f32 v17, v18, v19
  v_accvgpr_write_b32 a0, v16
  v_accvgpr_write_b32 a1, v17
  v_mfma_f32_16x16x16_bf16 v[36:39], v[78:79], a[226:227], 0
  ds_read_b64_tr_b16 a[212:213], v71 offset:136
  ds_read_b64_tr_b16 a[214:215], v71 offset:904
  v_cvt_pk_bf16_f32 v20, v20, v21
  v_cvt_pk_bf16_f32 v21, v22, v23
  v_accvgpr_write_b32 a2, v20
  v_accvgpr_write_b32 a3, v21
  v_mfma_f32_16x16x16_bf16 v[40:43], v[76:77], a[228:229], 0
  s_add_u32 m0, s49, 123200
  s_add_u32 s50, s43, s46
  v_cvt_pk_bf16_f32 v24, v24, v25
  v_cvt_pk_bf16_f32 v25, v26, v27
  v_accvgpr_write_b32 a4, v24
  v_accvgpr_write_b32 a5, v25
  v_mfma_f32_16x16x16_bf16 v[44:47], v[78:79], a[230:231], 0
  buffer_load_dwordx4 v64, s[12:15], s50 offen offset:0 lds
  buffer_load_dwordx4 v65, s[12:15], s50 offen offset:1024 lds
  v_cvt_pk_bf16_f32 v28, v28, v29
  v_cvt_pk_bf16_f32 v29, v30, v31
  v_accvgpr_write_b32 a6, v28
  v_accvgpr_write_b32 a7, v29
  v_mfma_f32_16x16x16_bf16 v[48:51], v[76:77], a[232:233], 0
  buffer_load_dwordx4 v66, s[12:15], s50 offen offset:2048 lds
  s_add_u32 m0, s49, 126280
  v_cvt_pk_bf16_f32 v32, v32, v33
  v_cvt_pk_bf16_f32 v33, v34, v35
  v_accvgpr_write_b32 a8, v32
  v_accvgpr_write_b32 a9, v33
  v_mfma_f32_16x16x16_bf16 v[52:55], v[78:79], a[234:235], 0
  s_add_u32 s50, s50, 6144
  buffer_load_dwordx4 v64, s[12:15], s50 offen offset:0 lds
  v_cvt_pk_bf16_f32 v36, v36, v37
  v_cvt_pk_bf16_f32 v37, v38, v39
  v_accvgpr_write_b32 a10, v36
  v_accvgpr_write_b32 a11, v37
  v_mfma_f32_16x16x16_bf16 v[56:59], v[76:77], a[236:237], 0
  buffer_load_dwordx4 v65, s[12:15], s50 offen offset:1024 lds
  v_cvt_pk_bf16_f32 v40, v40, v41
  v_cvt_pk_bf16_f32 v41, v42, v43
  v_accvgpr_write_b32 a12, v40
  v_accvgpr_write_b32 a13, v41
  v_mfma_f32_16x16x16_bf16 v[60:63], v[78:79], a[238:239], 0
  buffer_load_dwordx4 v66, s[12:15], s50 offen offset:2048 lds
  v_cvt_pk_bf16_f32 v44, v44, v45
  v_cvt_pk_bf16_f32 v45, v46, v47
  v_accvgpr_write_b32 a14, v44
  v_accvgpr_write_b32 a15, v45
  s_waitcnt lgkmcnt(0)
  v_and_b32 v72, v69, v72
  v_and_b32 v73, v70, v73
  v_and_b32 v74, v69, v74
  v_and_b32 v75, v70, v75
  s_waitcnt vmcnt(12)
  ds_read_b128 v[76:79], v68 offset:192
  v_mfma_f32_16x16x16_bf16 v[16:19], v[72:73], a[192:193], 0
  ds_read_b64_tr_b16 a[216:217], v71 offset:24640
  ds_read_b64_tr_b16 a[218:219], v71 offset:25408
  v_cvt_pk_bf16_f32 v48, v48, v49
  v_cvt_pk_bf16_f32 v49, v50, v51
  v_accvgpr_write_b32 a16, v48
  v_accvgpr_write_b32 a17, v49
  v_mfma_f32_16x16x16_bf16 v[20:23], v[74:75], a[194:195], 0
  ds_read_b64_tr_b16 a[220:221], v71 offset:24648
  ds_read_b64_tr_b16 a[222:223], v71 offset:25416
  v_cvt_pk_bf16_f32 v52, v52, v53
  v_cvt_pk_bf16_f32 v53, v54, v55
  v_accvgpr_write_b32 a18, v52
  v_accvgpr_write_b32 a19, v53
  v_mfma_f32_16x16x16_bf16 v[24:27], v[72:73], a[196:197], 0
  ds_read_b64_tr_b16 a[224:225], v71 offset:24704
  ds_read_b64_tr_b16 a[226:227], v71 offset:25472
  v_cvt_pk_bf16_f32 v56, v56, v57
  v_cvt_pk_bf16_f32 v57, v58, v59
  v_accvgpr_write_b32 a20, v56
  v_accvgpr_write_b32 a21, v57
  v_mfma_f32_16x16x16_bf16 v[28:31], v[74:75], a[198:199], 0
  ds_read_b64_tr_b16 a[228:229], v71 offset:24712
  ds_read_b64_tr_b16 a[230:231], v71 offset:25480
  v_cvt_pk_bf16_f32 v60, v60, v61
  v_cvt_pk_bf16_f32 v61, v62, v63
  v_accvgpr_write_b32 a22, v60
  v_accvgpr_write_b32 a23, v61
  v_mfma_f32_16x16x16_bf16 v[32:35], v[72:73], a[200:201], 0
  ds_read_b64_tr_b16 a[232:233], v71 offset:24768
  ds_read_b64_tr_b16 a[234:235], v71 offset:25536
  v_cvt_pk_bf16_f32 v112, v16, v17
  v_cvt_pk_bf16_f32 v113, v18, v19
  v_mfma_f32_16x16x16_bf16 v[36:39], v[74:75], a[202:203], 0
  ds_read_b64_tr_b16 a[236:237], v71 offset:24776
  ds_read_b64_tr_b16 a[238:239], v71 offset:25544
  v_cvt_pk_bf16_f32 v114, v20, v21
  v_cvt_pk_bf16_f32 v115, v22, v23
  v_mfma_f32_16x16x16_bf16 v[40:43], v[72:73], a[204:205], 0
  s_add_u32 m0, s49, 49152
  s_add_u32 s50, s43, s47
  v_cvt_pk_bf16_f32 v116, v24, v25
  v_cvt_pk_bf16_f32 v117, v26, v27
  v_mfma_f32_16x16x16_bf16 v[44:47], v[74:75], a[206:207], 0
  buffer_load_dwordx4 v64, s[12:15], s50 offen offset:0 lds
  buffer_load_dwordx4 v65, s[12:15], s50 offen offset:1024 lds
  v_cvt_pk_bf16_f32 v118, v28, v29
  v_cvt_pk_bf16_f32 v119, v30, v31
  v_mfma_f32_16x16x16_bf16 v[48:51], v[72:73], a[208:209], 0
  buffer_load_dwordx4 v66, s[12:15], s50 offen offset:2048 lds
  s_add_u32 m0, s49, 52232
  v_cvt_pk_bf16_f32 v120, v32, v33
  v_cvt_pk_bf16_f32 v121, v34, v35
  v_mfma_f32_16x16x16_bf16 v[52:55], v[74:75], a[210:211], 0
  s_add_u32 s50, s50, 6144
  buffer_load_dwordx4 v64, s[12:15], s50 offen offset:0 lds
  v_cvt_pk_bf16_f32 v122, v36, v37
  v_cvt_pk_bf16_f32 v123, v38, v39
  v_mfma_f32_16x16x16_bf16 v[56:59], v[72:73], a[212:213], 0
  buffer_load_dwordx4 v65, s[12:15], s50 offen offset:1024 lds
  v_cvt_pk_bf16_f32 v124, v40, v41
  v_cvt_pk_bf16_f32 v125, v42, v43
  v_mfma_f32_16x16x16_bf16 v[60:63], v[74:75], a[214:215], 0
  buffer_load_dwordx4 v66, s[12:15], s50 offen offset:2048 lds
  v_cvt_pk_bf16_f32 v126, v44, v45
  v_cvt_pk_bf16_f32 v127, v46, v47
  s_waitcnt lgkmcnt(0)
  v_and_b32 v76, v69, v76
  v_and_b32 v77, v70, v77
  v_and_b32 v78, v69, v78
  v_and_b32 v79, v70, v79
  s_waitcnt vmcnt(12)
  ds_read_b128 v[72:75], v68 offset:256
  v_mfma_f32_16x16x16_bf16 v[16:19], v[76:77], a[216:217], 0
  ds_read_b64_tr_b16 a[192:193], v67 offset:0
  ds_read_b64_tr_b16 a[194:195], v67 offset:768
  v_cvt_pk_bf16_f32 v128, v48, v49
  v_cvt_pk_bf16_f32 v129, v50, v51
  v_mfma_f32_16x16x16_bf16 v[20:23], v[78:79], a[218:219], 0
  ds_read_b64_tr_b16 a[196:197], v67 offset:8
  ds_read_b64_tr_b16 a[198:199], v67 offset:776
  v_cvt_pk_bf16_f32 v130, v52, v53
  v_cvt_pk_bf16_f32 v131, v54, v55
  v_mfma_f32_16x16x16_bf16 v[24:27], v[76:77], a[220:221], 0
  ds_read_b64_tr_b16 a[200:201], v67 offset:64
  ds_read_b64_tr_b16 a[202:203], v67 offset:832
  v_cvt_pk_bf16_f32 v132, v56, v57
  v_cvt_pk_bf16_f32 v133, v58, v59
  v_mfma_f32_16x16x16_bf16 v[28:31], v[78:79], a[222:223], 0
  ds_read_b64_tr_b16 a[204:205], v67 offset:72
  ds_read_b64_tr_b16 a[206:207], v67 offset:840
  v_cvt_pk_bf16_f32 v134, v60, v61
  v_cvt_pk_bf16_f32 v135, v62, v63
  v_mfma_f32_16x16x16_bf16 v[32:35], v[76:77], a[224:225], 0
  ds_read_b64_tr_b16 a[208:209], v67 offset:128
  ds_read_b64_tr_b16 a[210:211], v67 offset:896
  v_cvt_pk_bf16_f32 v16, v16, v17
  v_cvt_pk_bf16_f32 v17, v18, v19
  v_accvgpr_write_b32 a24, v16
  v_accvgpr_write_b32 a25, v17
  v_mfma_f32_16x16x16_bf16 v[36:39], v[78:79], a[226:227], 0
  ds_read_b64_tr_b16 a[212:213], v67 offset:136
  ds_read_b64_tr_b16 a[214:215], v67 offset:904
  v_cvt_pk_bf16_f32 v20, v20, v21
  v_cvt_pk_bf16_f32 v21, v22, v23
  v_accvgpr_write_b32 a26, v20
  v_accvgpr_write_b32 a27, v21
  v_mfma_f32_16x16x16_bf16 v[40:43], v[76:77], a[228:229], 0
  s_add_u32 m0, s49, 73792
  s_add_u32 s50, s43, s48
  v_cvt_pk_bf16_f32 v24, v24, v25
  v_cvt_pk_bf16_f32 v25, v26, v27
  v_accvgpr_write_b32 a28, v24
  v_accvgpr_write_b32 a29, v25
  v_mfma_f32_16x16x16_bf16 v[44:47], v[78:79], a[230:231], 0
  buffer_load_dwordx4 v64, s[12:15], s50 offen offset:0 lds
  buffer_load_dwordx4 v65, s[12:15], s50 offen offset:1024 lds
  v_cvt_pk_bf16_f32 v28, v28, v29
  v_cvt_pk_bf16_f32 v29, v30, v31
  v_accvgpr_write_b32 a30, v28
  v_accvgpr_write_b32 a31, v29
  v_mfma_f32_16x16x16_bf16 v[48:51], v[76:77], a[232:233], 0
  buffer_load_dwordx4 v66, s[12:15], s50 offen offset:2048 lds
  s_add_u32 m0, s49, 76872
  v_cvt_pk_bf16_f32 v32, v32, v33
  v_cvt_pk_bf16_f32 v33, v34, v35
  v_accvgpr_write_b32 a32, v32
  v_accvgpr_write_b32 a33, v33
  v_mfma_f32_16x16x16_bf16 v[52:55], v[78:79], a[234:235], 0
  s_add_u32 s50, s50, 6144
  buffer_load_dwordx4 v64, s[12:15], s50 offen offset:0 lds
  v_cvt_pk_bf16_f32 v36, v36, v37
  v_cvt_pk_bf16_f32 v37, v38, v39
  v_accvgpr_write_b32 a34, v36
  v_accvgpr_write_b32 a35, v37
  v_mfma_f32_16x16x16_bf16 v[56:59], v[76:77], a[236:237], 0
  buffer_load_dwordx4 v65, s[12:15], s50 offen offset:1024 lds
  v_cvt_pk_bf16_f32 v40, v40, v41
  v_cvt_pk_bf16_f32 v41, v42, v43
  v_accvgpr_write_b32 a36, v40
  v_accvgpr_write_b32 a37, v41
  v_mfma_f32_16x16x16_bf16 v[60:63], v[78:79], a[238:239], 0
  buffer_load_dwordx4 v66, s[12:15], s50 offen offset:2048 lds
  v_cvt_pk_bf16_f32 v44, v44, v45
  v_cvt_pk_bf16_f32 v45, v46, v47
  v_accvgpr_write_b32 a38, v44
  v_accvgpr_write_b32 a39, v45
  s_waitcnt lgkmcnt(0)
  v_and_b32 v72, v69, v72
  v_and_b32 v73, v70, v73
  v_and_b32 v74, v69, v74
  v_and_b32 v75, v70, v75
  s_waitcnt vmcnt(12)
  ds_read_b128 v[76:79], v68 offset:320
  v_mfma_f32_16x16x16_bf16 v[16:19], v[72:73], a[192:193], 0
  ds_read_b64_tr_b16 a[216:217], v67 offset:24640
  ds_read_b64_tr_b16 a[218:219], v67 offset:25408
  v_cvt_pk_bf16_f32 v48, v48, v49
  v_cvt_pk_bf16_f32 v49, v50, v51
  v_accvgpr_write_b32 a40, v48
  v_accvgpr_write_b32 a41, v49
  v_mfma_f32_16x16x16_bf16 v[20:23], v[74:75], a[194:195], 0
  ds_read_b64_tr_b16 a[220:221], v67 offset:24648
  ds_read_b64_tr_b16 a[222:223], v67 offset:25416
  v_cvt_pk_bf16_f32 v52, v52, v53
  v_cvt_pk_bf16_f32 v53, v54, v55
  v_accvgpr_write_b32 a42, v52
  v_accvgpr_write_b32 a43, v53
  v_mfma_f32_16x16x16_bf16 v[24:27], v[72:73], a[196:197], 0
  ds_read_b64_tr_b16 a[224:225], v67 offset:24704
  ds_read_b64_tr_b16 a[226:227], v67 offset:25472
  v_cvt_pk_bf16_f32 v56, v56, v57
  v_cvt_pk_bf16_f32 v57, v58, v59
  v_accvgpr_write_b32 a44, v56
  v_accvgpr_write_b32 a45, v57
  v_mfma_f32_16x16x16_bf16 v[28:31], v[74:75], a[198:199], 0
  ds_read_b64_tr_b16 a[228:229], v67 offset:24712
  ds_read_b64_tr_b16 a[230:231], v67 offset:25480
  v_cvt_pk_bf16_f32 v60, v60, v61
  v_cvt_pk_bf16_f32 v61, v62, v63
  v_accvgpr_write_b32 a46, v60
  v_accvgpr_write_b32 a47, v61
  v_mfma_f32_16x16x16_bf16 v[32:35], v[72:73], a[200:201], 0
  ds_read_b64_tr_b16 a[232:233], v67 offset:24768
  ds_read_b64_tr_b16 a[234:235], v67 offset:25536
  v_cvt_pk_bf16_f32 v136, v16, v17
  v_cvt_pk_bf16_f32 v137, v18, v19
  v_mfma_f32_16x16x16_bf16 v[36:39], v[74:75], a[202:203], 0
  ds_read_b64_tr_b16 a[236:237], v67 offset:24776
  ds_read_b64_tr_b16 a[238:239], v67 offset:25544
  v_cvt_pk_bf16_f32 v138, v20, v21
  v_cvt_pk_bf16_f32 v139, v22, v23
  v_mfma_f32_16x16x16_bf16 v[40:43], v[72:73], a[204:205], 0
  s_add_u32 m0, s49, 98560
  s_add_u32 s50, s44, s45
  v_cvt_pk_bf16_f32 v140, v24, v25
  v_cvt_pk_bf16_f32 v141, v26, v27
  v_mfma_f32_16x16x16_bf16 v[44:47], v[74:75], a[206:207], 0
  buffer_load_dwordx4 v64, s[12:15], s50 offen offset:0 lds
  buffer_load_dwordx4 v65, s[12:15], s50 offen offset:1024 lds
  v_cvt_pk_bf16_f32 v142, v28, v29
  v_cvt_pk_bf16_f32 v143, v30, v31
  v_mfma_f32_16x16x16_bf16 v[48:51], v[72:73], a[208:209], 0
  buffer_load_dwordx4 v66, s[12:15], s50 offen offset:2048 lds
  s_add_u32 m0, s49, 101640
  v_cvt_pk_bf16_f32 v144, v32, v33
  v_cvt_pk_bf16_f32 v145, v34, v35
  v_mfma_f32_16x16x16_bf16 v[52:55], v[74:75], a[210:211], 0
  s_add_u32 s50, s50, 6144
  buffer_load_dwordx4 v64, s[12:15], s50 offen offset:0 lds
  v_cvt_pk_bf16_f32 v146, v36, v37
  v_cvt_pk_bf16_f32 v147, v38, v39
  v_mfma_f32_16x16x16_bf16 v[56:59], v[72:73], a[212:213], 0
  buffer_load_dwordx4 v65, s[12:15], s50 offen offset:1024 lds
  v_cvt_pk_bf16_f32 v148, v40, v41
  v_cvt_pk_bf16_f32 v149, v42, v43
  v_mfma_f32_16x16x16_bf16 v[60:63], v[74:75], a[214:215], 0
  buffer_load_dwordx4 v66, s[12:15], s50 offen offset:2048 lds
  v_cvt_pk_bf16_f32 v150, v44, v45
  v_cvt_pk_bf16_f32 v151, v46, v47
  s_waitcnt lgkmcnt(0)
  v_and_b32 v76, v69, v76
  v_and_b32 v77, v70, v77
  v_and_b32 v78, v69, v78
  v_and_b32 v79, v70, v79
  s_waitcnt vmcnt(12)
  ds_read_b128 v[72:75], v68 offset:384
  v_mfma_f32_16x16x16_bf16 v[16:19], v[76:77], a[216:217], 0
  ds_read_b64_tr_b16 a[192:193], v71 offset:0
  ds_read_b64_tr_b16 a[194:195], v71 offset:768
  v_cvt_pk_bf16_f32 v152, v48, v49
  v_cvt_pk_bf16_f32 v153, v50, v51
  v_mfma_f32_16x16x16_bf16 v[20:23], v[78:79], a[218:219], 0
  ds_read_b64_tr_b16 a[196:197], v71 offset:8
  ds_read_b64_tr_b16 a[198:199], v71 offset:776
  v_cvt_pk_bf16_f32 v154, v52, v53
  v_cvt_pk_bf16_f32 v155, v54, v55
  v_mfma_f32_16x16x16_bf16 v[24:27], v[76:77], a[220:221], 0
  ds_read_b64_tr_b16 a[200:201], v71 offset:64
  ds_read_b64_tr_b16 a[202:203], v71 offset:832
  v_cvt_pk_bf16_f32 v156, v56, v57
  v_cvt_pk_bf16_f32 v157, v58, v59
  v_mfma_f32_16x16x16_bf16 v[28:31], v[78:79], a[222:223], 0
  ds_read_b64_tr_b16 a[204:205], v71 offset:72
  ds_read_b64_tr_b16 a[206:207], v71 offset:840
  v_cvt_pk_bf16_f32 v158, v60, v61
  v_cvt_pk_bf16_f32 v159, v62, v63
  v_mfma_f32_16x16x16_bf16 v[32:35], v[76:77], a[224:225], 0
  ds_read_b64_tr_b16 a[208:209], v71 offset:128
  ds_read_b64_tr_b16 a[210:211], v71 offset:896
  v_cvt_pk_bf16_f32 v16, v16, v17
  v_cvt_pk_bf16_f32 v17, v18, v19
  v_accvgpr_write_b32 a48, v16
  v_accvgpr_write_b32 a49, v17
  v_mfma_f32_16x16x16_bf16 v[36:39], v[78:79], a[226:227], 0
  ds_read_b64_tr_b16 a[212:213], v71 offset:136
  ds_read_b64_tr_b16 a[214:215], v71 offset:904
  v_cvt_pk_bf16_f32 v20, v20, v21
  v_cvt_pk_bf16_f32 v21, v22, v23
  v_accvgpr_write_b32 a50, v20
  v_accvgpr_write_b32 a51, v21
  v_mfma_f32_16x16x16_bf16 v[40:43], v[76:77], a[228:229], 0
  s_add_u32 m0, s49, 123200
  s_add_u32 s50, s44, s46
  v_cvt_pk_bf16_f32 v24, v24, v25
  v_cvt_pk_bf16_f32 v25, v26, v27
  v_accvgpr_write_b32 a52, v24
  v_accvgpr_write_b32 a53, v25
  v_mfma_f32_16x16x16_bf16 v[44:47], v[78:79], a[230:231], 0
  buffer_load_dwordx4 v64, s[12:15], s50 offen offset:0 lds
  buffer_load_dwordx4 v65, s[12:15], s50 offen offset:1024 lds
  v_cvt_pk_bf16_f32 v28, v28, v29
  v_cvt_pk_bf16_f32 v29, v30, v31
  v_accvgpr_write_b32 a54, v28
  v_accvgpr_write_b32 a55, v29
  v_mfma_f32_16x16x16_bf16 v[48:51], v[76:77], a[232:233], 0
  buffer_load_dwordx4 v66, s[12:15], s50 offen offset:2048 lds
  s_add_u32 m0, s49, 126280
  v_cvt_pk_bf16_f32 v32, v32, v33
  v_cvt_pk_bf16_f32 v33, v34, v35
  v_accvgpr_write_b32 a56, v32
  v_accvgpr_write_b32 a57, v33
  v_mfma_f32_16x16x16_bf16 v[52:55], v[78:79], a[234:235], 0
  s_add_u32 s50, s50, 6144
  buffer_load_dwordx4 v64, s[12:15], s50 offen offset:0 lds
  v_cvt_pk_bf16_f32 v36, v36, v37
  v_cvt_pk_bf16_f32 v37, v38, v39
  v_accvgpr_write_b32 a58, v36
  v_accvgpr_write_b32 a59, v37
  v_mfma_f32_16x16x16_bf16 v[56:59], v[76:77], a[236:237], 0
  buffer_load_dwordx4 v65, s[12:15], s50 offen offset:1024 lds
  v_cvt_pk_bf16_f32 v40, v40, v41
  v_cvt_pk_bf16_f32 v41, v42, v43
  v_accvgpr_write_b32 a60, v40
  v_accvgpr_write_b32 a61, v41
  v_mfma_f32_16x16x16_bf16 v[60:63], v[78:79], a[238:239], 0
  buffer_load_dwordx4 v66, s[12:15], s50 offen offset:2048 lds
  v_cvt_pk_bf16_f32 v44, v44, v45
  v_cvt_pk_bf16_f32 v45, v46, v47
  v_accvgpr_write_b32 a62, v44
  v_accvgpr_write_b32 a63, v45
  s_waitcnt lgkmcnt(0)
  v_and_b32 v72, v69, v72
  v_and_b32 v73, v70, v73
  v_and_b32 v74, v69, v74
  v_and_b32 v75, v70, v75
  s_waitcnt vmcnt(12)
  ds_read_b128 v[76:79], v68 offset:448
  v_mfma_f32_16x16x16_bf16 v[16:19], v[72:73], a[192:193], 0
  ds_read_b64_tr_b16 a[216:217], v71 offset:24640
  ds_read_b64_tr_b16 a[218:219], v71 offset:25408
  v_cvt_pk_bf16_f32 v48, v48, v49
  v_cvt_pk_bf16_f32 v49, v50, v51
  v_accvgpr_write_b32 a64, v48
  v_accvgpr_write_b32 a65, v49
  v_mfma_f32_16x16x16_bf16 v[20:23], v[74:75], a[194:195], 0
  ds_read_b64_tr_b16 a[220:221], v71 offset:24648
  ds_read_b64_tr_b16 a[222:223], v71 offset:25416
  v_cvt_pk_bf16_f32 v52, v52, v53
  v_cvt_pk_bf16_f32 v53, v54, v55
  v_accvgpr_write_b32 a66, v52
  v_accvgpr_write_b32 a67, v53
  v_mfma_f32_16x16x16_bf16 v[24:27], v[72:73], a[196:197], 0
  ds_read_b64_tr_b16 a[224:225], v71 offset:24704
  ds_read_b64_tr_b16 a[226:227], v71 offset:25472
  v_cvt_pk_bf16_f32 v56, v56, v57
  v_cvt_pk_bf16_f32 v57, v58, v59
  v_accvgpr_write_b32 a68, v56
  v_accvgpr_write_b32 a69, v57
  v_mfma_f32_16x16x16_bf16 v[28:31], v[74:75], a[198:199], 0
  ds_read_b64_tr_b16 a[228:229], v71 offset:24712
  ds_read_b64_tr_b16 a[230:231], v71 offset:25480
  v_cvt_pk_bf16_f32 v60, v60, v61
  v_cvt_pk_bf16_f32 v61, v62, v63
  v_accvgpr_write_b32 a70, v60
  v_accvgpr_write_b32 a71, v61
  v_mfma_f32_16x16x16_bf16 v[32:35], v[72:73], a[200:201], 0
  ds_read_b64_tr_b16 a[232:233], v71 offset:24768
  ds_read_b64_tr_b16 a[234:235], v71 offset:25536
  v_cvt_pk_bf16_f32 v160, v16, v17
  v_cvt_pk_bf16_f32 v161, v18, v19
  v_mfma_f32_16x16x16_bf16 v[36:39], v[74:75], a[202:203], 0
  ds_read_b64_tr_b16 a[236:237], v71 offset:24776
  ds_read_b64_tr_b16 a[238:239], v71 offset:25544
  v_cvt_pk_bf16_f32 v162, v20, v21
  v_cvt_pk_bf16_f32 v163, v22, v23
  v_mfma_f32_16x16x16_bf16 v[40:43], v[72:73], a[204:205], 0
  s_add_u32 m0, s49, 49152
  s_add_u32 s50, s44, s47
  v_cvt_pk_bf16_f32 v164, v24, v25
  v_cvt_pk_bf16_f32 v165, v26, v27
  v_mfma_f32_16x16x16_bf16 v[44:47], v[74:75], a[206:207], 0
  buffer_load_dwordx4 v64, s[12:15], s50 offen offset:0 lds
  buffer_load_dwordx4 v65, s[12:15], s50 offen offset:1024 lds
  v_cvt_pk_bf16_f32 v166, v28, v29
  v_cvt_pk_bf16_f32 v167, v30, v31
  v_mfma_f32_16x16x16_bf16 v[48:51], v[72:73], a[208:209], 0
  buffer_load_dwordx4 v66, s[12:15], s50 offen offset:2048 lds
  s_add_u32 m0, s49, 52232
  v_cvt_pk_bf16_f32 v168, v32, v33
  v_cvt_pk_bf16_f32 v169, v34, v35
  v_mfma_f32_16x16x16_bf16 v[52:55], v[74:75], a[210:211], 0
  s_add_u32 s50, s50, 6144
  buffer_load_dwordx4 v64, s[12:15], s50 offen offset:0 lds
  v_cvt_pk_bf16_f32 v170, v36, v37
  v_cvt_pk_bf16_f32 v171, v38, v39
  v_mfma_f32_16x16x16_bf16 v[56:59], v[72:73], a[212:213], 0
  buffer_load_dwordx4 v65, s[12:15], s50 offen offset:1024 lds
  v_cvt_pk_bf16_f32 v172, v40, v41
  v_cvt_pk_bf16_f32 v173, v42, v43
  v_mfma_f32_16x16x16_bf16 v[60:63], v[74:75], a[214:215], 0
  buffer_load_dwordx4 v66, s[12:15], s50 offen offset:2048 lds
  v_cvt_pk_bf16_f32 v174, v44, v45
  v_cvt_pk_bf16_f32 v175, v46, v47
  s_waitcnt lgkmcnt(0)
  v_and_b32 v76, v69, v76
  v_and_b32 v77, v70, v77
  v_and_b32 v78, v69, v78
  v_and_b32 v79, v70, v79
  s_waitcnt vmcnt(12)
  ds_read_b128 v[72:75], v68 offset:512
  v_mfma_f32_16x16x16_bf16 v[16:19], v[76:77], a[216:217], 0
  ds_read_b64_tr_b16 a[192:193], v67 offset:0
  ds_read_b64_tr_b16 a[194:195], v67 offset:768
  ds_read_b64_tr_b16 a[196:197], v67 offset:8
  ds_read_b64_tr_b16 a[198:199], v67 offset:776
  ds_read_b64_tr_b16 a[200:201], v67 offset:64
  v_cvt_pk_bf16_f32 v176, v48, v49
  v_cvt_pk_bf16_f32 v177, v50, v51
  v_mfma_f32_16x16x16_bf16 v[20:23], v[78:79], a[218:219], 0
  ds_read_b64_tr_b16 a[202:203], v67 offset:832
  ds_read_b64_tr_b16 a[204:205], v67 offset:72
  ds_read_b64_tr_b16 a[206:207], v67 offset:840
  ds_read_b64_tr_b16 a[208:209], v67 offset:128
  ds_read_b64_tr_b16 a[210:211], v67 offset:896
  v_cvt_pk_bf16_f32 v178, v52, v53
  v_cvt_pk_bf16_f32 v179, v54, v55
  v_mfma_f32_16x16x16_bf16 v[24:27], v[76:77], a[220:221], 0
  ds_read_b64_tr_b16 a[212:213], v67 offset:136
  ds_read_b64_tr_b16 a[214:215], v67 offset:904
  s_add_u32 m0, s49, 73792
  s_add_u32 s50, s44, s48
  buffer_load_dwordx4 v64, s[12:15], s50 offen offset:0 lds
  v_cvt_pk_bf16_f32 v180, v56, v57
  v_cvt_pk_bf16_f32 v181, v58, v59
  v_mfma_f32_16x16x16_bf16 v[28:31], v[78:79], a[222:223], 0
  buffer_load_dwordx4 v65, s[12:15], s50 offen offset:1024 lds
  buffer_load_dwordx4 v66, s[12:15], s50 offen offset:2048 lds
  s_add_u32 m0, s49, 76872
  s_add_u32 s50, s50, 6144
  buffer_load_dwordx4 v64, s[12:15], s50 offen offset:0 lds
  v_cvt_pk_bf16_f32 v182, v60, v61
  v_cvt_pk_bf16_f32 v183, v62, v63
  v_mfma_f32_16x16x16_bf16 v[32:35], v[76:77], a[224:225], 0
  buffer_load_dwordx4 v65, s[12:15], s50 offen offset:1024 lds
  buffer_load_dwordx4 v66, s[12:15], s50 offen offset:2048 lds
  s_mov_b64 s[82:83], s[80:81]
  s_mov_b64 s[80:81], s[78:79]
  s_mov_b64 s[78:79], s[76:77]
  v_cvt_pk_bf16_f32 v16, v16, v17
  v_cvt_pk_bf16_f32 v17, v18, v19
  v_accvgpr_write_b32 a72, v16
  v_accvgpr_write_b32 a73, v17
  v_mfma_f32_16x16x16_bf16 v[36:39], v[78:79], a[226:227], 0
  s_add_u32 s76, s33, s32
  s_xor_b32 s76, s76, s34
  s_add_u32 s77, s32, 24576
  s_cmp_lt_u32 s32, s35
  s_cselect_b32 s22, s32, s40
  v_cvt_pk_bf16_f32 v20, v20, v21
  v_cvt_pk_bf16_f32 v21, v22, v23
  v_accvgpr_write_b32 a74, v20
  v_accvgpr_write_b32 a75, v21
  v_mfma_f32_16x16x16_bf16 v[40:43], v[76:77], a[228:229], 0
  s_cselect_b32 s77, s77, s40
  s_bitcmp1_b32 s76, 21
  s_cselect_b32 s76, s77, s22
  s_cselect_b32 s77, s22, s77
  s_cselect_b64 s[56:57], -1, 0
  v_cvt_pk_bf16_f32 v24, v24, v25
  v_cvt_pk_bf16_f32 v25, v26, v27
  v_accvgpr_write_b32 a76, v24
  v_accvgpr_write_b32 a77, v25
  v_mfma_f32_16x16x16_bf16 v[44:47], v[78:79], a[230:231], 0
  s_add_u32 s32, s32, 786432
  s_add_u32 m0, s39, 0
  s_nop 0
  buffer_load_dwordx4 v8, s[4:7], s76 offen nt lds
  v_cvt_pk_bf16_f32 v28, v28, v29
  v_cvt_pk_bf16_f32 v29, v30, v31
  v_accvgpr_write_b32 a78, v28
  v_accvgpr_write_b32 a79, v29
  v_mfma_f32_16x16x16_bf16 v[48:51], v[76:77], a[232:233], 0
  s_add_u32 m0, s39, 4096
  s_nop 0
  buffer_load_dwordx4 v9, s[4:7], s76 offen nt lds
  s_add_u32 m0, s39, 8192
  v_cvt_pk_bf16_f32 v32, v32, v33
  v_cvt_pk_bf16_f32 v33, v34, v35
  v_accvgpr_write_b32 a80, v32
  v_accvgpr_write_b32 a81, v33
  v_mfma_f32_16x16x16_bf16 v[52:55], v[78:79], a[234:235], 0
  s_nop 0
  buffer_load_dwordx4 v10, s[4:7], s76 offen nt lds
  s_add_u32 m0, s39, 12288
  s_nop 0
  v_cvt_pk_bf16_f32 v36, v36, v37
  v_cvt_pk_bf16_f32 v37, v38, v39
  v_accvgpr_write_b32 a82, v36
  v_accvgpr_write_b32 a83, v37
  v_mfma_f32_16x16x16_bf16 v[56:59], v[76:77], a[236:237], 0
  buffer_load_dwordx4 v11, s[4:7], s76 offen nt lds
  v_cndmask_b32 v15, v12, v14, s[56:57]
  s_add_u32 m0, s39, 16384
  s_nop 0
  v_cvt_pk_bf16_f32 v40, v40, v41
  v_cvt_pk_bf16_f32 v41, v42, v43
  v_accvgpr_write_b32 a84, v40
  v_accvgpr_write_b32 a85, v41
  v_mfma_f32_16x16x16_bf16 v[60:63], v[78:79], a[238:239], 0
  buffer_load_dwordx4 v15, s[4:7], s22 offen nt lds
  s_add_u32 m0, s39, 20480
  s_nop 0
  buffer_load_dwordx4 v13, s[4:7], s77 offen nt lds
  v_cvt_pk_bf16_f32 v44, v44, v45
  v_cvt_pk_bf16_f32 v45, v46, v47
  v_accvgpr_write_b32 a86, v44
  v_accvgpr_write_b32 a87, v45
  s_waitcnt lgkmcnt(0)
  v_and_b32 v72, v69, v72
  v_and_b32 v73, v70, v73
  v_and_b32 v74, v69, v74
  v_and_b32 v75, v70, v75
  s_waitcnt vmcnt(18)
  ds_read_b128 v[76:79], v68 offset:576
  v_mfma_f32_16x16x16_bf16 v[16:19], v[72:73], a[192:193], 0
  ds_read_b64_tr_b16 a[216:217], v67 offset:24640
  v_cvt_pk_bf16_f32 v48, v48, v49
  v_cvt_pk_bf16_f32 v49, v50, v51
  v_accvgpr_write_b32 a88, v48
  v_accvgpr_write_b32 a89, v49
  v_mfma_f32_16x16x16_bf16 v[20:23], v[74:75], a[194:195], 0
  ds_read_b64_tr_b16 a[218:219], v67 offset:25408
  v_cvt_pk_bf16_f32 v52, v52, v53
  v_cvt_pk_bf16_f32 v53, v54, v55
  v_accvgpr_write_b32 a90, v52
  v_accvgpr_write_b32 a91, v53
  v_mfma_f32_16x16x16_bf16 v[24:27], v[72:73], a[196:197], 0
  ds_read_b64_tr_b16 a[220:221], v67 offset:24648
  v_cvt_pk_bf16_f32 v56, v56, v57
  v_cvt_pk_bf16_f32 v57, v58, v59
  v_accvgpr_write_b32 a92, v56
  v_accvgpr_write_b32 a93, v57
  v_mfma_f32_16x16x16_bf16 v[28:31], v[74:75], a[198:199], 0
  ds_read_b64_tr_b16 a[222:223], v67 offset:25416
  v_cvt_pk_bf16_f32 v60, v60, v61
  v_cvt_pk_bf16_f32 v61, v62, v63
  v_accvgpr_write_b32 a94, v60
  v_accvgpr_write_b32 a95, v61
  v_mfma_f32_16x16x16_bf16 v[32:35], v[72:73], a[200:201], 0
  ds_read_b64_tr_b16 a[224:225], v67 offset:24704
  v_cvt_pk_bf16_f32 v184, v16, v17
  v_cvt_pk_bf16_f32 v185, v18, v19
  v_mfma_f32_16x16x16_bf16 v[36:39], v[74:75], a[202:203], 0
  ds_read_b64_tr_b16 a[226:227], v67 offset:25472
  v_cvt_pk_bf16_f32 v186, v20, v21
  v_cvt_pk_bf16_f32 v187, v22, v23
  v_mfma_f32_16x16x16_bf16 v[40:43], v[72:73], a[204:205], 0
  ds_read_b64_tr_b16 a[228:229], v67 offset:24712
  v_cvt_pk_bf16_f32 v188, v24, v25
  v_cvt_pk_bf16_f32 v189, v26, v27
  v_mfma_f32_16x16x16_bf16 v[44:47], v[74:75], a[206:207], 0
  ds_read_b64_tr_b16 a[230:231], v67 offset:25480
  v_cvt_pk_bf16_f32 v190, v28, v29
  v_cvt_pk_bf16_f32 v191, v30, v31
  v_mfma_f32_16x16x16_bf16 v[48:51], v[72:73], a[208:209], 0
  ds_read_b64_tr_b16 a[232:233], v67 offset:24768
  v_cvt_pk_bf16_f32 v192, v32, v33
  v_cvt_pk_bf16_f32 v193, v34, v35
  v_mfma_f32_16x16x16_bf16 v[52:55], v[74:75], a[210:211], 0
  ds_read_b64_tr_b16 a[234:235], v67 offset:25536
  v_cvt_pk_bf16_f32 v194, v36, v37
  v_cvt_pk_bf16_f32 v195, v38, v39
  v_mfma_f32_16x16x16_bf16 v[56:59], v[72:73], a[212:213], 0
  ds_read_b64_tr_b16 a[236:237], v67 offset:24776
  v_cvt_pk_bf16_f32 v196, v40, v41
  v_cvt_pk_bf16_f32 v197, v42, v43
  v_mfma_f32_16x16x16_bf16 v[60:63], v[74:75], a[214:215], 0
  ds_read_b64_tr_b16 a[238:239], v67 offset:25544
  v_cvt_pk_bf16_f32 v198, v44, v45
  v_cvt_pk_bf16_f32 v199, v46, v47
  s_waitcnt lgkmcnt(0)
  v_and_b32 v76, v69, v76
  v_and_b32 v77, v70, v77
  v_and_b32 v78, v69, v78
  v_and_b32 v79, v70, v79
  s_waitcnt vmcnt(12)
  ds_read_b128 v[72:75], v68 offset:640
  v_mfma_f32_16x16x16_bf16 v[16:19], v[76:77], a[216:217], 0
  ds_read_b64_tr_b16 a[192:193], v71 offset:0
  ds_read_b64_tr_b16 a[194:195], v71 offset:768
  v_cvt_pk_bf16_f32 v200, v48, v49
  v_cvt_pk_bf16_f32 v201, v50, v51
  v_mfma_f32_16x16x16_bf16 v[20:23], v[78:79], a[218:219], 0
  ds_read_b64_tr_b16 a[196:197], v71 offset:8
  v_cvt_pk_bf16_f32 v202, v52, v53
  v_cvt_pk_bf16_f32 v203, v54, v55
  v_mfma_f32_16x16x16_bf16 v[24:27], v[76:77], a[220:221], 0
  ds_read_b64_tr_b16 a[198:199], v71 offset:776
  v_cvt_pk_bf16_f32 v204, v56, v57
  v_cvt_pk_bf16_f32 v205, v58, v59
  v_mfma_f32_16x16x16_bf16 v[28:31], v[78:79], a[222:223], 0
  ds_read_b64_tr_b16 a[200:201], v71 offset:64
  v_cvt_pk_bf16_f32 v206, v60, v61
  v_cvt_pk_bf16_f32 v207, v62, v63
  v_mfma_f32_16x16x16_bf16 v[32:35], v[76:77], a[224:225], 0
  ds_read_b64_tr_b16 a[202:203], v71 offset:832
  v_cvt_pk_bf16_f32 v16, v16, v17
  v_cvt_pk_bf16_f32 v17, v18, v19
  v_accvgpr_write_b32 a96, v16
  v_accvgpr_write_b32 a97, v17
  v_mfma_f32_16x16x16_bf16 v[36:39], v[78:79], a[226:227], 0
  ds_read_b64_tr_b16 a[204:205], v71 offset:72
  v_cvt_pk_bf16_f32 v20, v20, v21
  v_cvt_pk_bf16_f32 v21, v22, v23
  v_accvgpr_write_b32 a98, v20
  v_accvgpr_write_b32 a99, v21
  v_mfma_f32_16x16x16_bf16 v[40:43], v[76:77], a[228:229], 0
  ds_read_b64_tr_b16 a[206:207], v71 offset:840
  v_cvt_pk_bf16_f32 v24, v24, v25
  v_cvt_pk_bf16_f32 v25, v26, v27
  v_accvgpr_write_b32 a100, v24
  v_accvgpr_write_b32 a101, v25
  v_mfma_f32_16x16x16_bf16 v[44:47], v[78:79], a[230:231], 0
  ds_read_b64_tr_b16 a[208:209], v71 offset:128
  v_cvt_pk_bf16_f32 v28, v28, v29
  v_cvt_pk_bf16_f32 v29, v30, v31
  v_accvgpr_write_b32 a102, v28
  v_accvgpr_write_b32 a103, v29
  v_mfma_f32_16x16x16_bf16 v[48:51], v[76:77], a[232:233], 0
  ds_read_b64_tr_b16 a[210:211], v71 offset:896
  v_cvt_pk_bf16_f32 v32, v32, v33
  v_cvt_pk_bf16_f32 v33, v34, v35
  v_accvgpr_write_b32 a104, v32
  v_accvgpr_write_b32 a105, v33
  v_mfma_f32_16x16x16_bf16 v[52:55], v[78:79], a[234:235], 0
  ds_read_b64_tr_b16 a[212:213], v71 offset:136
  v_cvt_pk_bf16_f32 v36, v36, v37
  v_cvt_pk_bf16_f32 v37, v38, v39
  v_accvgpr_write_b32 a106, v36
  v_accvgpr_write_b32 a107, v37
  v_mfma_f32_16x16x16_bf16 v[56:59], v[76:77], a[236:237], 0
  ds_read_b64_tr_b16 a[214:215], v71 offset:904
  v_cvt_pk_bf16_f32 v40, v40, v41
  v_cvt_pk_bf16_f32 v41, v42, v43
  v_accvgpr_write_b32 a108, v40
  v_accvgpr_write_b32 a109, v41
  v_mfma_f32_16x16x16_bf16 v[60:63], v[78:79], a[238:239], 0
  s_load_dword s95, s[92:93], s36
  v_cvt_pk_bf16_f32 v44, v44, v45
  v_cvt_pk_bf16_f32 v45, v46, v47
  v_accvgpr_write_b32 a110, v44
  v_accvgpr_write_b32 a111, v45
  s_waitcnt lgkmcnt(0)
  v_and_b32 v72, v69, v72
  v_and_b32 v73, v70, v73
  v_and_b32 v74, v69, v74
  v_and_b32 v75, v70, v75
  s_cmp_eq_u32 s95, 0
  s_cbranch_scc1 L_slow
L_back:
  s_lshr_b32 s51, s2, 1
  s_xor_b32 s34, s95, s51
  s_and_b32 s34, s34, 2
  s_lshl_b32 s34, s34, 20
  s_waitcnt vmcnt(6)
  ds_read_b128 v[76:79], v68 offset:704
  v_mfma_f32_16x16x16_bf16 v[16:19], v[72:73], a[192:193], 0
  ds_read_b64_tr_b16 a[216:217], v71 offset:24640
  v_cvt_pk_bf16_f32 v48, v48, v49
  v_cvt_pk_bf16_f32 v49, v50, v51
  v_accvgpr_write_b32 a112, v48
  v_accvgpr_write_b32 a113, v49
  v_mfma_f32_16x16x16_bf16 v[20:23], v[74:75], a[194:195], 0
  ds_read_b64_tr_b16 a[218:219], v71 offset:25408
  v_cvt_pk_bf16_f32 v52, v52, v53
  v_cvt_pk_bf16_f32 v53, v54, v55
  v_accvgpr_write_b32 a114, v52
  v_accvgpr_write_b32 a115, v53
  v_mfma_f32_16x16x16_bf16 v[24:27], v[72:73], a[196:197], 0
  ds_read_b64_tr_b16 a[220:221], v71 offset:24648
  v_cvt_pk_bf16_f32 v56, v56, v57
  v_cvt_pk_bf16_f32 v57, v58, v59
  v_accvgpr_write_b32 a116, v56
  v_accvgpr_write_b32 a117, v57
  v_mfma_f32_16x16x16_bf16 v[28:31], v[74:75], a[198:199], 0
  ds_read_b64_tr_b16 a[222:223], v71 offset:25416
  v_cvt_pk_bf16_f32 v60, v60, v61
  v_cvt_pk_bf16_f32 v61, v62, v63
  v_accvgpr_write_b32 a118, v60
  v_accvgpr_write_b32 a119, v61
  v_mfma_f32_16x16x16_bf16 v[32:35], v[72:73], a[200:201], 0
  ds_read_b64_tr_b16 a[224:225], v71 offset:24704
  v_cvt_pk_bf16_f32 v208, v16, v17
  v_cvt_pk_bf16_f32 v209, v18, v19
  v_mfma_f32_16x16x16_bf16 v[36:39], v[74:75], a[202:203], 0
  ds_read_b64_tr_b16 a[226:227], v71 offset:25472
  v_cvt_pk_bf16_f32 v210, v20, v21
  v_cvt_pk_bf16_f32 v211, v22, v23
  v_mfma_f32_16x16x16_bf16 v[40:43], v[72:73], a[204:205], 0
  ds_read_b64_tr_b16 a[228:229], v71 offset:24712
  v_cvt_pk_bf16_f32 v212, v24, v25
  v_cvt_pk_bf16_f32 v213, v26, v27
  v_mfma_f32_16x16x16_bf16 v[44:47], v[74:75], a[206:207], 0
  ds_read_b64_tr_b16 a[230:231], v71 offset:25480
  v_cvt_pk_bf16_f32 v214, v28, v29
  v_cvt_pk_bf16_f32 v215, v30, v31
  v_mfma_f32_16x16x16_bf16 v[48:51], v[72:73], a[208:209], 0
  ds_read_b64_tr_b16 a[232:233], v71 offset:24768
  v_cvt_pk_bf16_f32 v216, v32, v33
  v_cvt_pk_bf16_f32 v217, v34, v35
  v_mfma_f32_16x16x16_bf16 v[52:55], v[74:75], a[210:211], 0
  ds_read_b64_tr_b16 a[234:235], v71 offset:25536
  v_cvt_pk_bf16_f32 v218, v36, v37
  v_cvt_pk_bf16_f32 v219, v38, v39
  v_mfma_f32_16x16x16_bf16 v[56:59], v[72:73], a[212:213], 0
  ds_read_b64_tr_b16 a[236:237], v71 offset:24776
  v_cvt_pk_bf16_f32 v220, v40, v41
  v_cvt_pk_bf16_f32 v221, v42, v43
  v_mfma_f32_16x16x16_bf16 v[60:63], v[74:75], a[214:215], 0
  ds_read_b64_tr_b16 a[238:239], v71 offset:25544
  v_cvt_pk_bf16_f32 v222, v44, v45
  v_cvt_pk_bf16_f32 v223, v46, v47
  s_waitcnt lgkmcnt(0)
  v_and_b32 v76, v69, v76
  v_and_b32 v77, v70, v77
  v_and_b32 v78, v69, v78
  v_and_b32 v79, v70, v79
  s_mov_b64 s[82:83], s[80:81]
  s_mov_b64 s[80:81], s[78:79]
  v_mfma_f32_16x16x16_bf16 v[16:19], v[76:77], a[216:217], 0
  s_mov_b64 s[78:79], s[76:77]
  s_add_u32 s76, s33, s32
  s_xor_b32 s76, s76, s34
  v_cvt_pk_bf16_f32 v224, v48, v49
  v_cvt_pk_bf16_f32 v225, v50, v51
  v_mfma_f32_16x16x16_bf16 v[20:23], v[78:79], a[218:219], 0
  s_add_u32 s77, s32, 24576
  s_cmp_lt_u32 s32, s35
  s_cselect_b32 s22, s32, s40
  v_cvt_pk_bf16_f32 v226, v52, v53
  v_cvt_pk_bf16_f32 v227, v54, v55
  v_mfma_f32_16x16x16_bf16 v[24:27], v[76:77], a[220:221], 0
  s_cselect_b32 s77, s77, s40
  s_bitcmp1_b32 s76, 21
  s_cselect_b32 s76, s77, s22
  v_cvt_pk_bf16_f32 v228, v56, v57
  v_cvt_pk_bf16_f32 v229, v58, v59
  v_mfma_f32_16x16x16_bf16 v[28:31], v[78:79], a[222:223], 0
  s_cselect_b32 s77, s22, s77
  s_cselect_b64 s[56:57], -1, 0
  s_add_u32 s32, s32, 786432
  v_cvt_pk_bf16_f32 v230, v60, v61
  v_cvt_pk_bf16_f32 v231, v62, v63
  v_mfma_f32_16x16x16_bf16 v[32:35], v[76:77], a[224:225], 0
  s_add_u32 m0, s39, 24576
  s_nop 0
  buffer_load_dwordx4 v8, s[4:7], s76 offen nt lds
  v_cvt_pk_bf16_f32 v232, v16, v17
  v_cvt_pk_bf16_f32 v233, v18, v19
  v_mfma_f32_16x16x16_bf16 v[36:39], v[78:79], a[226:227], 0
  s_add_u32 m0, s39, 28672
  s_nop 0
  buffer_load_dwordx4 v9, s[4:7], s76 offen nt lds
  v_cvt_pk_bf16_f32 v234, v20, v21
  v_cvt_pk_bf16_f32 v235, v22, v23
  v_mfma_f32_16x16x16_bf16 v[40:43], v[76:77], a[228:229], 0
  s_add_u32 m0, s39, 32768
  s_nop 0
  buffer_load_dwordx4 v10, s[4:7], s76 offen nt lds
  v_cvt_pk_bf16_f32 v236, v24, v25
  v_cvt_pk_bf16_f32 v237, v26, v27
  v_mfma_f32_16x16x16_bf16 v[44:47], v[78:79], a[230:231], 0
  s_add_u32 m0, s39, 36864
  s_nop 0
  v_cvt_pk_bf16_f32 v238, v28, v29
  v_cvt_pk_bf16_f32 v239, v30, v31
  v_mfma_f32_16x16x16_bf16 v[48:51], v[76:77], a[232:233], 0
  buffer_load_dwordx4 v11, s[4:7], s76 offen nt lds
  v_cndmask_b32 v15, v12, v14, s[56:57]
  v_cvt_pk_bf16_f32 v240, v32, v33
  v_cvt_pk_bf16_f32 v241, v34, v35
  v_mfma_f32_16x16x16_bf16 v[52:55], v[78:79], a[234:235], 0
  s_add_u32 m0, s39, 40960
  s_nop 0
  v_cvt_pk_bf16_f32 v242, v36, v37
  v_cvt_pk_bf16_f32 v243, v38, v39
  v_mfma_f32_16x16x16_bf16 v[56:59], v[76:77], a[236:237], 0
  buffer_load_dwordx4 v15, s[4:7], s22 offen nt lds
  s_add_u32 m0, s39, 45056
  v_cvt_pk_bf16_f32 v244, v40, v41
  v_cvt_pk_bf16_f32 v245, v42, v43
  v_mfma_f32_16x16x16_bf16 v[60:63], v[78:79], a[238:239], 0
  s_xor_b32 s39, s39, 49152
  buffer_load_dwordx4 v13, s[4:7], s77 offen nt lds
  v_cvt_pk_bf16_f32 v246, v44, v45
  v_cvt_pk_bf16_f32 v247, v46, v47
  v_cvt_pk_bf16_f32 v248, v48, v49
  v_cvt_pk_bf16_f32 v249, v50, v51
  v_cvt_pk_bf16_f32 v250, v52, v53
  v_cvt_pk_bf16_f32 v251, v54, v55
  v_sub_u32 v64, v14, v12
  v_add_u32 v64, v64, v84
  s_mov_b32 s58, s40
  s_mov_b32 s59, s40
  s_mov_b32 s62, s40
  s_mov_b32 s63, s40
  s_waitcnt vmcnt(6)
  s_barrier
  ds_read_b128 a[144:147], v1 offset:0
  ds_read_b128 a[148:151], v2 offset:0
  ds_read_b128 a[152:155], v3 offset:0
  ds_read_b128 a[156:159], v4 offset:0
  v_cvt_pk_bf16_f32 v252, v56, v57
  v_cvt_pk_bf16_f32 v253, v58, v59
  v_cvt_pk_bf16_f32 v254, v60, v61
  v_cvt_pk_bf16_f32 v255, v62, v63
L_loop:
  s_waitcnt lgkmcnt(2)
  v_mfma_f32_16x16x32_bf16 v[16:19], v[88:91], a[144:147], 0
  ds_read_b128 a[160:163], v1 offset:256
  v_mfma_f32_16x16x32_bf16 v[16:19], a[0:3], a[148:151], v[16:19]
  ds_read_b128 a[164:167], v2 offset:256
  v_mfma_f32_16x16x32_bf16 v[20:23], v[92:95], a[144:147], 0
  v_mfma_f32_16x16x32_bf16 v[20:23], a[4:7], a[148:151], v[20:23]
  v_cvt_pk_bf16_f32 v40, v40, v41
  v_mfma_f32_16x16x32_bf16 v[24:27], v[96:99], a[144:147], 0
  v_cvt_pk_bf16_f32 v41, v42, v43
  v_mfma_f32_16x16x32_bf16 v[24:27], a[8:11], a[148:151], v[24:27]
  v_cvt_pk_bf16_f32 v42, v44, v45
  v_mfma_f32_16x16x32_bf16 v[28:31], v[100:103], a[144:147], 0
  buffer_store_dwordx4 a[188:191], v85, s[8:11], s63 offen sc1
  v_mfma_f32_16x16x32_bf16 v[28:31], a[12:15], a[148:151], v[28:31]
  v_cvt_pk_bf16_f32 v43, v46, v47
  v_mfma_f32_16x16x32_bf16 v[32:35], v[104:107], a[144:147], 0
  ds_write_b128 v86, v[40:43] offset:12288
  v_mfma_f32_16x16x32_bf16 v[32:35], a[16:19], a[148:151], v[32:35]
  v_mfma_f32_16x16x32_bf16 v[36:39], v[108:111], a[144:147], 0
  v_mfma_f32_16x16x32_bf16 v[36:39], a[20:23], a[148:151], v[36:39]
  s_waitcnt lgkmcnt(3)
  v_mfma_f32_16x16x32_bf16 v[16:19], v[112:115], a[152:155], v[16:19]
  ds_read_b128 a[144:147], v3 offset:256
  v_mfma_f32_16x16x32_bf16 v[16:19], a[24:27], a[156:159], v[16:19]
  ds_read_b128 a[148:151], v4 offset:256
  v_mfma_f32_16x16x32_bf16 v[20:23], v[116:119], a[152:155], v[20:23]
  v_mfma_f32_16x16x32_bf16 v[20:23], a[28:31], a[156:159], v[20:23]
  v_cvt_pk_bf16_f32 v48, v48, v49
  v_mfma_f32_16x16x32_bf16 v[24:27], v[120:123], a[152:155], v[24:27]
  buffer_store_dwordx4 a[168:171], v80, s[8:11], s58 offen sc1
  v_mfma_f32_16x16x32_bf16 v[24:27], a[32:35], a[156:159], v[24:27]
  v_cvt_pk_bf16_f32 v49, v50, v51
  v_mfma_f32_16x16x32_bf16 v[28:31], v[124:127], a[152:155], v[28:31]
  v_cvt_pk_bf16_f32 v50, v52, v53
  v_mfma_f32_16x16x32_bf16 v[28:31], a[36:39], a[156:159], v[28:31]
  v_cvt_pk_bf16_f32 v51, v54, v55
  v_mfma_f32_16x16x32_bf16 v[32:35], v[128:131], a[152:155], v[32:35]
  ds_write_b128 v87, v[48:51] offset:12288
  v_mfma_f32_16x16x32_bf16 v[32:35], a[40:43], a[156:159], v[32:35]
  v_mfma_f32_16x16x32_bf16 v[36:39], v[132:135], a[152:155], v[36:39]
  v_mfma_f32_16x16x32_bf16 v[36:39], a[44:47], a[156:159], v[36:39]
  s_waitcnt lgkmcnt(4)
  v_mfma_f32_16x16x32_bf16 v[16:19], v[136:139], a[160:163], v[16:19]
  ds_read_b128 a[152:155], v1 offset:512
  v_mfma_f32_16x16x32_bf16 v[16:19], a[48:51], a[164:167], v[16:19]
  ds_read_b128 a[156:159], v2 offset:512
  v_mfma_f32_16x16x32_bf16 v[20:23], v[140:143], a[160:163], v[20:23]
  v_mfma_f32_16x16x32_bf16 v[20:23], a[52:55], a[164:167], v[20:23]
  v_mfma_f32_16x16x32_bf16 v[24:27], v[144:147], a[160:163], v[24:27]
  buffer_store_dwordx4 a[172:175], v81, s[8:11], s58 offen sc1
  v_mfma_f32_16x16x32_bf16 v[24:27], a[56:59], a[164:167], v[24:27]
  v_mfma_f32_16x16x32_bf16 v[28:31], v[148:151], a[160:163], v[28:31]
  v_mfma_f32_16x16x32_bf16 v[28:31], a[60:63], a[164:167], v[28:31]
  v_mfma_f32_16x16x32_bf16 v[32:35], v[152:155], a[160:163], v[32:35]
  v_mfma_f32_16x16x32_bf16 v[32:35], a[64:67], a[164:167], v[32:35]
  v_mfma_f32_16x16x32_bf16 v[36:39], v[156:159], a[160:163], v[36:39]
  v_mfma_f32_16x16x32_bf16 v[36:39], a[68:71], a[164:167], v[36:39]
  s_waitcnt lgkmcnt(3)
  v_mfma_f32_16x16x32_bf16 v[16:19], v[160:163], a[144:147], v[16:19]
  ds_read_b128 a[160:163], v3 offset:512
  v_mfma_f32_16x16x32_bf16 v[16:19], a[72:75], a[148:151], v[16:19]
  ds_read_b128 a[164:167], v4 offset:512
  v_mfma_f32_16x16x32_bf16 v[20:23], v[164:167], a[144:147], v[20:23]
  v_cvt_pk_bf16_f32 v56, v56, v57
  v_mfma_f32_16x16x32_bf16 v[20:23], a[76:79], a[148:151], v[20:23]
  v_cvt_pk_bf16_f32 v57, v58, v59
  v_mfma_f32_16x16x32_bf16 v[24:27], v[168:171], a[144:147], v[24:27]
  buffer_store_dwordx4 a[176:179], v82, s[8:11], s58 offen sc1
  v_mfma_f32_16x16x32_bf16 v[24:27], a[80:83], a[148:151], v[24:27]
  s_mov_b64 s[82:83], s[80:81]
  v_cvt_pk_bf16_f32 v58, v60, v61
  v_mfma_f32_16x16x32_bf16 v[28:31], v[172:175], a[144:147], v[28:31]
  s_mov_b64 s[80:81], s[78:79]
  v_cvt_pk_bf16_f32 v59, v62, v63
  v_mfma_f32_16x16x32_bf16 v[28:31], a[84:87], a[148:151], v[28:31]
  ds_write_b128 v86, v[56:59] offset:12416
  v_mfma_f32_16x16x32_bf16 v[32:35], v[176:179], a[144:147], v[32:35]
  s_mov_b64 s[78:79], s[76:77]
  s_add_u32 s76, s33, s32
  v_mfma_f32_16x16x32_bf16 v[32:35], a[88:91], a[148:151], v[32:35]
  s_xor_b32 s76, s76, s34
  s_add_u32 s77, s32, 24576
  v_mfma_f32_16x16x32_bf16 v[36:39], v[180:183], a[144:147], v[36:39]
  s_cmp_lt_u32 s32, s35
  s_cselect_b32 s22, s32, s40
  v_mfma_f32_16x16x32_bf16 v[36:39], a[92:95], a[148:151], v[36:39]
  s_cselect_b32 s77, s77, s40
  s_waitcnt lgkmcnt(3)
  v_mfma_f32_16x16x32_bf16 v[16:19], v[184:187], a[152:155], v[16:19]
  ds_read_b128 a[144:147], v1 offset:12288
  s_bitcmp1_b32 s76, 21
  v_mfma_f32_16x16x32_bf16 v[16:19], a[96:99], a[156:159], v[16:19]
  ds_read_b128 a[148:151], v2 offset:12288
  s_cselect_b32 s76, s77, s22
  v_mfma_f32_16x16x32_bf16 v[20:23], v[188:191], a[152:155], v[20:23]
  s_cselect_b32 s77, s22, s77
  s_cselect_b64 s[56:57], -1, 0
  v_mfma_f32_16x16x32_bf16 v[20:23], a[100:103], a[156:159], v[20:23]
  s_add_u32 s32, s32, 786432
  s_add_u32 m0, s39, 0
  v_mfma_f32_16x16x32_bf16 v[24:27], v[192:195], a[152:155], v[24:27]
  buffer_load_dwordx4 v8, s[4:7], s76 offen nt lds
  v_mfma_f32_16x16x32_bf16 v[24:27], a[104:107], a[156:159], v[24:27]
  s_mov_b32 s58, s80
  s_mov_b32 s59, s82
  v_mfma_f32_16x16x32_bf16 v[28:31], v[196:199], a[152:155], v[28:31]
  s_mov_b32 s63, s83
  s_min_u32 s62, s82, s83
  v_mfma_f32_16x16x32_bf16 v[28:31], a[108:111], a[156:159], v[28:31]
  s_cmp_gt_u32 s82, s83
  s_cselect_b64 s[90:91], -1, 0
  v_mfma_f32_16x16x32_bf16 v[32:35], v[200:203], a[152:155], v[32:35]
  v_cndmask_b32 v65, v84, v64, s[90:91]
  v_mfma_f32_16x16x32_bf16 v[32:35], a[112:115], a[156:159], v[32:35]
  v_mfma_f32_16x16x32_bf16 v[36:39], v[204:207], a[152:155], v[36:39]
  v_mfma_f32_16x16x32_bf16 v[36:39], a[116:119], a[156:159], v[36:39]
  s_waitcnt lgkmcnt(3)
  v_mfma_f32_16x16x32_bf16 v[16:19], v[208:211], a[160:163], v[16:19]
  ds_read_b128 a[152:155], v3 offset:12288
  v_mfma_f32_16x16x32_bf16 v[16:19], v[232:235], a[164:167], v[16:19]
  ds_read_b128 a[156:159], v4 offset:12288
  v_mfma_f32_16x16x32_bf16 v[20:23], v[212:215], a[160:163], v[20:23]
  v_mfma_f32_16x16x32_bf16 v[20:23], v[236:239], a[164:167], v[20:23]
  s_add_u32 m0, s39, 4096
  v_mfma_f32_16x16x32_bf16 v[24:27], v[216:219], a[160:163], v[24:27]
  buffer_load_dwordx4 v9, s[4:7], s76 offen nt lds
  v_mfma_f32_16x16x32_bf16 v[24:27], v[240:243], a[164:167], v[24:27]
  v_mfma_f32_16x16x32_bf16 v[28:31], v[220:223], a[160:163], v[28:31]
  v_mfma_f32_16x16x32_bf16 v[28:31], v[244:247], a[164:167], v[28:31]
  v_mfma_f32_16x16x32_bf16 v[32:35], v[224:227], a[160:163], v[32:35]
  v_mfma_f32_16x16x32_bf16 v[32:35], v[248:251], a[164:167], v[32:35]
  v_mfma_f32_16x16x32_bf16 v[36:39], v[228:231], a[160:163], v[36:39]
  v_mfma_f32_16x16x32_bf16 v[36:39], v[252:255], a[164:167], v[36:39]
  s_waitcnt lgkmcnt(2)
  v_mfma_f32_16x16x32_bf16 v[40:43], v[88:91], a[144:147], 0
  ds_read_b128 a[160:163], v1 offset:12544
  v_mfma_f32_16x16x32_bf16 v[40:43], a[0:3], a[148:151], v[40:43]
  ds_read_b128 a[164:167], v2 offset:12544
  v_mfma_f32_16x16x32_bf16 v[44:47], v[92:95], a[144:147], 0
  s_add_u32 m0, s39, 8192
  v_mfma_f32_16x16x32_bf16 v[44:47], a[4:7], a[148:151], v[44:47]
  v_cvt_pk_bf16_f32 v16, v16, v17
  v_mfma_f32_16x16x32_bf16 v[48:51], v[96:99], a[144:147], 0
  buffer_load_dwordx4 v10, s[4:7], s76 offen nt lds
  v_mfma_f32_16x16x32_bf16 v[48:51], a[8:11], a[148:151], v[48:51]
  v_cvt_pk_bf16_f32 v17, v18, v19
  v_mfma_f32_16x16x32_bf16 v[52:55], v[100:103], a[144:147], 0
  v_cvt_pk_bf16_f32 v18, v20, v21
  v_mfma_f32_16x16x32_bf16 v[52:55], a[12:15], a[148:151], v[52:55]
  v_cvt_pk_bf16_f32 v19, v22, v23
  v_mfma_f32_16x16x32_bf16 v[56:59], v[104:107], a[144:147], 0
  ds_write_b128 v86, v[16:19] offset:0
  v_mfma_f32_16x16x32_bf16 v[56:59], a[16:19], a[148:151], v[56:59]
  s_add_u32 m0, s39, 12288
  v_mfma_f32_16x16x32_bf16 v[60:63], v[108:111], a[144:147], 0
  v_cvt_pk_bf16_f32 v24, v24, v25
  v_mfma_f32_16x16x32_bf16 v[60:63], a[20:23], a[148:151], v[60:63]
  s_waitcnt lgkmcnt(3)
  v_mfma_f32_16x16x32_bf16 v[40:43], v[112:115], a[152:155], v[40:43]
  ds_read_b128 a[144:147], v3 offset:12544
  v_mfma_f32_16x16x32_bf16 v[40:43], a[24:27], a[156:159], v[40:43]
  ds_read_b128 a[148:151], v4 offset:12544
  v_mfma_f32_16x16x32_bf16 v[44:47], v[116:119], a[152:155], v[44:47]
  v_cvt_pk_bf16_f32 v25, v26, v27
  v_mfma_f32_16x16x32_bf16 v[44:47], a[28:31], a[156:159], v[44:47]
  v_cvt_pk_bf16_f32 v26, v28, v29
  v_mfma_f32_16x16x32_bf16 v[48:51], v[120:123], a[152:155], v[48:51]
  buffer_load_dwordx4 v11, s[4:7], s76 offen nt lds
  v_mfma_f32_16x16x32_bf16 v[48:51], a[32:35], a[156:159], v[48:51]
  v_cvt_pk_bf16_f32 v27, v30, v31
  v_mfma_f32_16x16x32_bf16 v[52:55], v[124:127], a[152:155], v[52:55]
  ds_write_b128 v87, v[24:27] offset:0
  v_mfma_f32_16x16x32_bf16 v[52:55], a[36:39], a[156:159], v[52:55]
  v_mfma_f32_16x16x32_bf16 v[56:59], v[128:131], a[152:155], v[56:59]
  v_mfma_f32_16x16x32_bf16 v[56:59], a[40:43], a[156:159], v[56:59]
  v_mfma_f32_16x16x32_bf16 v[60:63], v[132:135], a[152:155], v[60:63]
  v_cndmask_b32 v15, v12, v14, s[56:57]
  v_mfma_f32_16x16x32_bf16 v[60:63], a[44:47], a[156:159], v[60:63]
  s_waitcnt lgkmcnt(4)
  v_mfma_f32_16x16x32_bf16 v[40:43], v[136:139], a[160:163], v[40:43]
  ds_read_b128 a[152:155], v1 offset:12800
  v_mfma_f32_16x16x32_bf16 v[40:43], a[48:51], a[164:167], v[40:43]
  ds_read_b128 a[156:159], v2 offset:12800
  v_mfma_f32_16x16x32_bf16 v[44:47], v[140:143], a[160:163], v[44:47]
  s_add_u32 m0, s39, 16384
  v_mfma_f32_16x16x32_bf16 v[44:47], a[52:55], a[164:167], v[44:47]
  v_cvt_pk_bf16_f32 v32, v32, v33
  v_mfma_f32_16x16x32_bf16 v[48:51], v[144:147], a[160:163], v[48:51]
  buffer_load_dwordx4 v15, s[4:7], s22 offen nt lds
  v_mfma_f32_16x16x32_bf16 v[48:51], a[56:59], a[164:167], v[48:51]
  v_cvt_pk_bf16_f32 v33, v34, v35
  v_mfma_f32_16x16x32_bf16 v[52:55], v[148:151], a[160:163], v[52:55]
  v_cvt_pk_bf16_f32 v34, v36, v37
  v_mfma_f32_16x16x32_bf16 v[52:55], a[60:63], a[164:167], v[52:55]
  v_cvt_pk_bf16_f32 v35, v38, v39
  v_mfma_f32_16x16x32_bf16 v[56:59], v[152:155], a[160:163], v[56:59]
  ds_write_b128 v86, v[32:35] offset:128
  v_mfma_f32_16x16x32_bf16 v[56:59], a[64:67], a[164:167], v[56:59]
  v_mfma_f32_16x16x32_bf16 v[60:63], v[156:159], a[160:163], v[60:63]
  v_mfma_f32_16x16x32_bf16 v[60:63], a[68:71], a[164:167], v[60:63]
  s_waitcnt lgkmcnt(4)
  v_mfma_f32_16x16x32_bf16 v[40:43], v[160:163], a[144:147], v[40:43]
  ds_read_b128 a[160:163], v3 offset:12800
  v_mfma_f32_16x16x32_bf16 v[40:43], a[72:75], a[148:151], v[40:43]
  ds_read_b128 a[164:167], v4 offset:12800
  v_mfma_f32_16x16x32_bf16 v[44:47], v[164:167], a[144:147], v[44:47]
  v_mfma_f32_16x16x32_bf16 v[44:47], a[76:79], a[148:151], v[44:47]
  s_add_u32 m0, s39, 20480
  v_mfma_f32_16x16x32_bf16 v[48:51], v[168:171], a[144:147], v[48:51]
  buffer_load_dwordx4 v13, s[4:7], s77 offen nt lds
  v_mfma_f32_16x16x32_bf16 v[48:51], a[80:83], a[148:151], v[48:51]
  v_mfma_f32_16x16x32_bf16 v[52:55], v[172:175], a[144:147], v[52:55]
  v_mfma_f32_16x16x32_bf16 v[52:55], a[84:87], a[148:151], v[52:55]
  v_mfma_f32_16x16x32_bf16 v[56:59], v[176:179], a[144:147], v[56:59]
  v_mfma_f32_16x16x32_bf16 v[56:59], a[88:91], a[148:151], v[56:59]
  v_mfma_f32_16x16x32_bf16 v[60:63], v[180:183], a[144:147], v[60:63]
  v_mfma_f32_16x16x32_bf16 v[60:63], a[92:95], a[148:151], v[60:63]
  s_waitcnt vmcnt(10) lgkmcnt(2)
L_ent:
  s_barrier
  s_waitcnt lgkmcnt(3)
  v_mfma_f32_16x16x32_bf16 v[40:43], v[184:187], a[152:155], v[40:43]
  ds_read_b128 a[144:147], v1 offset:24576
  v_mfma_f32_16x16x32_bf16 v[40:43], a[96:99], a[156:159], v[40:43]
  ds_read_b128 a[148:151], v2 offset:24576
  v_mfma_f32_16x16x32_bf16 v[44:47], v[188:191], a[152:155], v[44:47]
  ds_read_b128 a[180:183], v5 offset:12288
  v_mfma_f32_16x16x32_bf16 v[44:47], a[100:103], a[156:159], v[44:47]
  ds_read_b128 a[184:187], v6 offset:12288
  v_mfma_f32_16x16x32_bf16 v[48:51], v[192:195], a[152:155], v[48:51]
  ds_read_b128 a[188:191], v7 offset:12288
  v_mfma_f32_16x16x32_bf16 v[48:51], a[104:107], a[156:159], v[48:51]
  ds_read_b128 a[168:171], v5 offset:0
  v_mfma_f32_16x16x32_bf16 v[52:55], v[196:199], a[152:155], v[52:55]
  ds_read_b128 a[172:175], v6 offset:0
  v_mfma_f32_16x16x32_bf16 v[52:55], a[108:111], a[156:159], v[52:55]
  ds_read_b128 a[176:179], v7 offset:0
  v_mfma_f32_16x16x32_bf16 v[56:59], v[200:203], a[152:155], v[56:59]
  v_mfma_f32_16x16x32_bf16 v[56:59], a[112:115], a[156:159], v[56:59]
  v_mfma_f32_16x16x32_bf16 v[60:63], v[204:207], a[152:155], v[60:63]
  v_mfma_f32_16x16x32_bf16 v[60:63], a[116:119], a[156:159], v[60:63]
  s_waitcnt lgkmcnt(8)
  v_mfma_f32_16x16x32_bf16 v[40:43], v[208:211], a[160:163], v[40:43]
  ds_read_b128 a[152:155], v3 offset:24576
  v_mfma_f32_16x16x32_bf16 v[40:43], v[232:235], a[164:167], v[40:43]
  ds_read_b128 a[156:159], v4 offset:24576
  v_mfma_f32_16x16x32_bf16 v[44:47], v[212:215], a[160:163], v[44:47]
  s_waitcnt lgkmcnt(7)
  buffer_store_dwordx4 a[180:183], v83, s[8:11], s59 offen sc1
  v_mfma_f32_16x16x32_bf16 v[44:47], v[236:239], a[164:167], v[44:47]
  v_mfma_f32_16x16x32_bf16 v[48:51], v[216:219], a[160:163], v[48:51]
  v_mfma_f32_16x16x32_bf16 v[48:51], v[240:243], a[164:167], v[48:51]
  v_mfma_f32_16x16x32_bf16 v[52:55], v[220:223], a[160:163], v[52:55]
  v_mfma_f32_16x16x32_bf16 v[52:55], v[244:247], a[164:167], v[52:55]
  v_mfma_f32_16x16x32_bf16 v[56:59], v[224:227], a[160:163], v[56:59]
  s_waitcnt lgkmcnt(6)
  buffer_store_dwordx4 a[184:187], v65, s[8:11], s62 offen sc1
  v_mfma_f32_16x16x32_bf16 v[56:59], v[248:251], a[164:167], v[56:59]
  v_mfma_f32_16x16x32_bf16 v[60:63], v[228:231], a[160:163], v[60:63]
  v_mfma_f32_16x16x32_bf16 v[60:63], v[252:255], a[164:167], v[60:63]
  s_waitcnt lgkmcnt(8)
  v_mfma_f32_16x16x32_bf16 v[16:19], v[88:91], a[144:147], 0
  ds_read_b128 a[160:163], v1 offset:24832
  v_mfma_f32_16x16x32_bf16 v[16:19], a[0:3], a[148:151], v[16:19]
  ds_read_b128 a[164:167], v2 offset:24832
  v_mfma_f32_16x16x32_bf16 v[20:23], v[92:95], a[144:147], 0
  v_mfma_f32_16x16x32_bf16 v[20:23], a[4:7], a[148:151], v[20:23]
  v_cvt_pk_bf16_f32 v40, v40, v41
  v_mfma_f32_16x16x32_bf16 v[24:27], v[96:99], a[144:147], 0
  v_cvt_pk_bf16_f32 v41, v42, v43
  v_mfma_f32_16x16x32_bf16 v[24:27], a[8:11], a[148:151], v[24:27]
  v_cvt_pk_bf16_f32 v42, v44, v45
  v_mfma_f32_16x16x32_bf16 v[28:31], v[100:103], a[144:147], 0
  s_waitcnt lgkmcnt(7)
  buffer_store_dwordx4 a[188:191], v85, s[8:11], s63 offen sc1
  v_mfma_f32_16x16x32_bf16 v[28:31], a[12:15], a[148:151], v[28:31]
  v_cvt_pk_bf16_f32 v43, v46, v47
  v_mfma_f32_16x16x32_bf16 v[32:35], v[104:107], a[144:147], 0
  ds_write_b128 v86, v[40:43] offset:36864
  v_mfma_f32_16x16x32_bf16 v[32:35], a[16:19], a[148:151], v[32:35]
  v_mfma_f32_16x16x32_bf16 v[36:39], v[108:111], a[144:147], 0
  v_mfma_f32_16x16x32_bf16 v[36:39], a[20:23], a[148:151], v[36:39]
  s_waitcnt lgkmcnt(3)
  v_mfma_f32_16x16x32_bf16 v[16:19], v[112:115], a[152:155], v[16:19]
  ds_read_b128 a[144:147], v3 offset:24832
  v_mfma_f32_16x16x32_bf16 v[16:19], a[24:27], a[156:159], v[16:19]
  ds_read_b128 a[148:151], v4 offset:24832
  v_mfma_f32_16x16x32_bf16 v[20:23], v[116:119], a[152:155], v[20:23]
  v_mfma_f32_16x16x32_bf16 v[20:23], a[28:31], a[156:159], v[20:23]
  v_cvt_pk_bf16_f32 v48, v48, v49
  v_mfma_f32_16x16x32_bf16 v[24:27], v[120:123], a[152:155], v[24:27]
  buffer_store_dwordx4 a[168:171], v80, s[8:11], s58 offen sc1
  v_mfma_f32_16x16x32_bf16 v[24:27], a[32:35], a[156:159], v[24:27]
  v_cvt_pk_bf16_f32 v49, v50, v51
  v_mfma_f32_16x16x32_bf16 v[28:31], v[124:127], a[152:155], v[28:31]
  v_cvt_pk_bf16_f32 v50, v52, v53
  v_mfma_f32_16x16x32_bf16 v[28:31], a[36:39], a[156:159], v[28:31]
  v_cvt_pk_bf16_f32 v51, v54, v55
  v_mfma_f32_16x16x32_bf16 v[32:35], v[128:131], a[152:155], v[32:35]
  ds_write_b128 v87, v[48:51] offset:36864
  v_mfma_f32_16x16x32_bf16 v[32:35], a[40:43], a[156:159], v[32:35]
  v_mfma_f32_16x16x32_bf16 v[36:39], v[132:135], a[152:155], v[36:39]
  v_mfma_f32_16x16x32_bf16 v[36:39], a[44:47], a[156:159], v[36:39]
  s_waitcnt lgkmcnt(4)
  v_mfma_f32_16x16x32_bf16 v[16:19], v[136:139], a[160:163], v[16:19]
  ds_read_b128 a[152:155], v1 offset:25088
  v_mfma_f32_16x16x32_bf16 v[16:19], a[48:51], a[164:167], v[16:19]
  ds_read_b128 a[156:159], v2 offset:25088
  v_mfma_f32_16x16x32_bf16 v[20:23], v[140:143], a[160:163], v[20:23]
  v_mfma_f32_16x16x32_bf16 v[20:23], a[52:55], a[164:167], v[20:23]
  v_mfma_f32_16x16x32_bf16 v[24:27], v[144:147], a[160:163], v[24:27]
  buffer_store_dwordx4 a[172:175], v81, s[8:11], s58 offen sc1
  v_mfma_f32_16x16x32_bf16 v[24:27], a[56:59], a[164:167], v[24:27]
  v_mfma_f32_16x16x32_bf16 v[28:31], v[148:151], a[160:163], v[28:31]
  v_mfma_f32_16x16x32_bf16 v[28:31], a[60:63], a[164:167], v[28:31]
  v_mfma_f32_16x16x32_bf16 v[32:35], v[152:155], a[160:163], v[32:35]
  v_mfma_f32_16x16x32_bf16 v[32:35], a[64:67], a[164:167], v[32:35]
  v_mfma_f32_16x16x32_bf16 v[36:39], v[156:159], a[160:163], v[36:39]
  v_mfma_f32_16x16x32_bf16 v[36:39], a[68:71], a[164:167], v[36:39]
  s_waitcnt lgkmcnt(3)
  v_mfma_f32_16x16x32_bf16 v[16:19], v[160:163], a[144:147], v[16:19]
  ds_read_b128 a[160:163], v3 offset:25088
  v_mfma_f32_16x16x32_bf16 v[16:19], a[72:75], a[148:151], v[16:19]
  ds_read_b128 a[164:167], v4 offset:25088
  v_mfma_f32_16x16x32_bf16 v[20:23], v[164:167], a[144:147], v[20:23]
  v_cvt_pk_bf16_f32 v56, v56, v57
  v_mfma_f32_16x16x32_bf16 v[20:23], a[76:79], a[148:151], v[20:23]
  v_cvt_pk_bf16_f32 v57, v58, v59
  v_mfma_f32_16x16x32_bf16 v[24:27], v[168:171], a[144:147], v[24:27]
  buffer_store_dwordx4 a[176:179], v82, s[8:11], s58 offen sc1
  v_mfma_f32_16x16x32_bf16 v[24:27], a[80:83], a[148:151], v[24:27]
  s_mov_b64 s[82:83], s[80:81]
  v_cvt_pk_bf16_f32 v58, v60, v61
  v_mfma_f32_16x16x32_bf16 v[28:31], v[172:175], a[144:147], v[28:31]
  s_mov_b64 s[80:81], s[78:79]
  v_cvt_pk_bf16_f32 v59, v62, v63
  v_mfma_f32_16x16x32_bf16 v[28:31], a[84:87], a[148:151], v[28:31]
  ds_write_b128 v86, v[56:59] offset:36992
  v_mfma_f32_16x16x32_bf16 v[32:35], v[176:179], a[144:147], v[32:35]
  s_mov_b64 s[78:79], s[76:77]
  s_add_u32 s76, s33, s32
  v_mfma_f32_16x16x32_bf16 v[32:35], a[88:91], a[148:151], v[32:35]
  s_xor_b32 s76, s76, s34
  s_add_u32 s77, s32, 24576
  v_mfma_f32_16x16x32_bf16 v[36:39], v[180:183], a[144:147], v[36:39]
  s_cmp_lt_u32 s32, s35
  s_cselect_b32 s22, s32, s40
  v_mfma_f32_16x16x32_bf16 v[36:39], a[92:95], a[148:151], v[36:39]
  s_cselect_b32 s77, s77, s40
  s_waitcnt lgkmcnt(3)
  v_mfma_f32_16x16x32_bf16 v[16:19], v[184:187], a[152:155], v[16:19]
  ds_read_b128 a[144:147], v1 offset:36864
  s_bitcmp1_b32 s76, 21
  v_mfma_f32_16x16x32_bf16 v[16:19], a[96:99], a[156:159], v[16:19]
  ds_read_b128 a[148:151], v2 offset:36864
  s_cselect_b32 s76, s77, s22
  v_mfma_f32_16x16x32_bf16 v[20:23], v[188:191], a[152:155], v[20:23]
  s_cselect_b32 s77, s22, s77
  s_cselect_b64 s[56:57], -1, 0
  v_mfma_f32_16x16x32_bf16 v[20:23], a[100:103], a[156:159], v[20:23]
  s_add_u32 s32, s32, 786432
  s_add_u32 m0, s39, 24576
  v_mfma_f32_16x16x32_bf16 v[24:27], v[192:195], a[152:155], v[24:27]
  buffer_load_dwordx4 v8, s[4:7], s76 offen nt lds
  v_mfma_f32_16x16x32_bf16 v[24:27], a[104:107], a[156:159], v[24:27]
  s_mov_b32 s58, s80
  s_mov_b32 s59, s82
  v_mfma_f32_16x16x32_bf16 v[28:31], v[196:199], a[152:155], v[28:31]
  s_mov_b32 s63, s83
  s_min_u32 s62, s82, s83
  v_mfma_f32_16x16x32_bf16 v[28:31], a[108:111], a[156:159], v[28:31]
  s_cmp_gt_u32 s82, s83
  s_cselect_b64 s[90:91], -1, 0
  v_mfma_f32_16x16x32_bf16 v[32:35], v[200:203], a[152:155], v[32:35]
  v_cndmask_b32 v65, v84, v64, s[90:91]
  v_mfma_f32_16x16x32_bf16 v[32:35], a[112:115], a[156:159], v[32:35]
  v_mfma_f32_16x16x32_bf16 v[36:39], v[204:207], a[152:155], v[36:39]
  v_mfma_f32_16x16x32_bf16 v[36:39], a[116:119], a[156:159], v[36:39]
  s_waitcnt lgkmcnt(3)
  v_mfma_f32_16x16x32_bf16 v[16:19], v[208:211], a[160:163], v[16:19]
  ds_read_b128 a[152:155], v3 offset:36864
  v_mfma_f32_16x16x32_bf16 v[16:19], v[232:235], a[164:167], v[16:19]
  ds_read_b128 a[156:159], v4 offset:36864
  v_mfma_f32_16x16x32_bf16 v[20:23], v[212:215], a[160:163], v[20:23]
  v_mfma_f32_16x16x32_bf16 v[20:23], v[236:239], a[164:167], v[20:23]
  s_add_u32 m0, s39, 28672
  v_mfma_f32_16x16x32_bf16 v[24:27], v[216:219], a[160:163], v[24:27]
  buffer_load_dwordx4 v9, s[4:7], s76 offen nt lds
  v_mfma_f32_16x16x32_bf16 v[24:27], v[240:243], a[164:167], v[24:27]
  v_mfma_f32_16x16x32_bf16 v[28:31], v[220:223], a[160:163], v[28:31]
  v_mfma_f32_16x16x32_bf16 v[28:31], v[244:247], a[164:167], v[28:31]
  v_mfma_f32_16x16x32_bf16 v[32:35], v[224:227], a[160:163], v[32:35]
  v_mfma_f32_16x16x32_bf16 v[32:35], v[248:251], a[164:167], v[32:35]
  v_mfma_f32_16x16x32_bf16 v[36:39], v[228:231], a[160:163], v[36:39]
  v_mfma_f32_16x16x32_bf16 v[36:39], v[252:255], a[164:167], v[36:39]
  s_waitcnt lgkmcnt(2)
  v_mfma_f32_16x16x32_bf16 v[40:43], v[88:91], a[144:147], 0
  ds_read_b128 a[160:163], v1 offset:37120
  v_mfma_f32_16x16x32_bf16 v[40:43], a[0:3], a[148:151], v[40:43]
  ds_read_b128 a[164:167], v2 offset:37120
  v_mfma_f32_16x16x32_bf16 v[44:47], v[92:95], a[144:147], 0
  s_add_u32 m0, s39, 32768
  v_mfma_f32_16x16x32_bf16 v[44:47], a[4:7], a[148:151], v[44:47]
  v_cvt_pk_bf16_f32 v16, v16, v17
  v_mfma_f32_16x16x32_bf16 v[48:51], v[96:99], a[144:147], 0
  buffer_load_dwordx4 v10, s[4:7], s76 offen nt lds
  v_mfma_f32_16x16x32_bf16 v[48:51], a[8:11], a[148:151], v[48:51]
  v_cvt_pk_bf16_f32 v17, v18, v19
  v_mfma_f32_16x16x32_bf16 v[52:55], v[100:103], a[144:147], 0
  v_cvt_pk_bf16_f32 v18, v20, v21
  v_mfma_f32_16x16x32_bf16 v[52:55], a[12:15], a[148:151], v[52:55]
  v_cvt_pk_bf16_f32 v19, v22, v23
  v_mfma_f32_16x16x32_bf16 v[56:59], v[104:107], a[144:147], 0
  ds_write_b128 v86, v[16:19] offset:24576
  v_mfma_f32_16x16x32_bf16 v[56:59], a[16:19], a[148:151], v[56:59]
  s_add_u32 m0, s39, 36864
  v_mfma_f32_16x16x32_bf16 v[60:63], v[108:111], a[144:147], 0
  v_cvt_pk_bf16_f32 v24, v24, v25
  v_mfma_f32_16x16x32_bf16 v[60:63], a[20:23], a[148:151], v[60:63]
  s_waitcnt lgkmcnt(3)
  v_mfma_f32_16x16x32_bf16 v[40:43], v[112:115], a[152:155], v[40:43]
  ds_read_b128 a[144:147], v3 offset:37120
  v_mfma_f32_16x16x32_bf16 v[40:43], a[24:27], a[156:159], v[40:43]
  ds_read_b128 a[148:151], v4 offset:37120
  v_mfma_f32_16x16x32_bf16 v[44:47], v[116:119], a[152:155], v[44:47]
  v_cvt_pk_bf16_f32 v25, v26, v27
  v_mfma_f32_16x16x32_bf16 v[44:47], a[28:31], a[156:159], v[44:47]
  v_cvt_pk_bf16_f32 v26, v28, v29
  v_mfma_f32_16x16x32_bf16 v[48:51], v[120:123], a[152:155], v[48:51]
  buffer_load_dwordx4 v11, s[4:7], s76 offen nt lds
  v_mfma_f32_16x16x32_bf16 v[48:51], a[32:35], a[156:159], v[48:51]
  v_cvt_pk_bf16_f32 v27, v30, v31
  v_mfma_f32_16x16x32_bf16 v[52:55], v[124:127], a[152:155], v[52:55]
  ds_write_b128 v87, v[24:27] offset:24576
  v_mfma_f32_16x16x32_bf16 v[52:55], a[36:39], a[156:159], v[52:55]
  v_mfma_f32_16x16x32_bf16 v[56:59], v[128:131], a[152:155], v[56:59]
  v_mfma_f32_16x16x32_bf16 v[56:59], a[40:43], a[156:159], v[56:59]
  v_mfma_f32_16x16x32_bf16 v[60:63], v[132:135], a[152:155], v[60:63]
  v_cndmask_b32 v15, v12, v14, s[56:57]
  v_mfma_f32_16x16x32_bf16 v[60:63], a[44:47], a[156:159], v[60:63]
  s_waitcnt lgkmcnt(4)
  v_mfma_f32_16x16x32_bf16 v[40:43], v[136:139], a[160:163], v[40:43]
  ds_read_b128 a[152:155], v1 offset:37376
  v_mfma_f32_16x16x32_bf16 v[40:43], a[48:51], a[164:167], v[40:43]
  ds_read_b128 a[156:159], v2 offset:37376
  v_mfma_f32_16x16x32_bf16 v[44:47], v[140:143], a[160:163], v[44:47]
  s_add_u32 m0, s39, 40960
  v_mfma_f32_16x16x32_bf16 v[44:47], a[52:55], a[164:167], v[44:47]
  v_cvt_pk_bf16_f32 v32, v32, v33
  v_mfma_f32_16x16x32_bf16 v[48:51], v[144:147], a[160:163], v[48:51]
  buffer_load_dwordx4 v15, s[4:7], s22 offen nt lds
  v_mfma_f32_16x16x32_bf16 v[48:51], a[56:59], a[164:167], v[48:51]
  v_cvt_pk_bf16_f32 v33, v34, v35
  v_mfma_f32_16x16x32_bf16 v[52:55], v[148:151], a[160:163], v[52:55]
  v_cvt_pk_bf16_f32 v34, v36, v37
  v_mfma_f32_16x16x32_bf16 v[52:55], a[60:63], a[164:167], v[52:55]
  v_cvt_pk_bf16_f32 v35, v38, v39
  v_mfma_f32_16x16x32_bf16 v[56:59], v[152:155], a[160:163], v[56:59]
  ds_write_b128 v86, v[32:35] offset:24704
  v_mfma_f32_16x16x32_bf16 v[56:59], a[64:67], a[164:167], v[56:59]
  v_mfma_f32_16x16x32_bf16 v[60:63], v[156:159], a[160:163], v[60:63]
  v_mfma_f32_16x16x32_bf16 v[60:63], a[68:71], a[164:167], v[60:63]
  s_waitcnt lgkmcnt(4)
  v_mfma_f32_16x16x32_bf16 v[40:43], v[160:163], a[144:147], v[40:43]
  ds_read_b128 a[160:163], v3 offset:37376
  v_mfma_f32_16x16x32_bf16 v[40:43], a[72:75], a[148:151], v[40:43]
  ds_read_b128 a[164:167], v4 offset:37376
  v_mfma_f32_16x16x32_bf16 v[44:47], v[164:167], a[144:147], v[44:47]
  s_add_u32 m0, s39, 45056
  v_mfma_f32_16x16x32_bf16 v[44:47], a[76:79], a[148:151], v[44:47]
  s_xor_b32 s39, s39, 49152
  v_mfma_f32_16x16x32_bf16 v[48:51], v[168:171], a[144:147], v[48:51]
  buffer_load_dwordx4 v13, s[4:7], s77 offen nt lds
  v_mfma_f32_16x16x32_bf16 v[48:51], a[80:83], a[148:151], v[48:51]
  v_mfma_f32_16x16x32_bf16 v[52:55], v[172:175], a[144:147], v[52:55]
  v_mfma_f32_16x16x32_bf16 v[52:55], a[84:87], a[148:151], v[52:55]
  v_mfma_f32_16x16x32_bf16 v[56:59], v[176:179], a[144:147], v[56:59]
  v_mfma_f32_16x16x32_bf16 v[56:59], a[88:91], a[148:151], v[56:59]
  v_mfma_f32_16x16x32_bf16 v[60:63], v[180:183], a[144:147], v[60:63]
  v_mfma_f32_16x16x32_bf16 v[60:63], a[92:95], a[148:151], v[60:63]
  s_waitcnt vmcnt(12) lgkmcnt(2)
  s_barrier
  v_xor_b32 v1, 49152, v1
  v_xor_b32 v2, 49152, v2
  v_xor_b32 v3, 49152, v3
  v_xor_b32 v4, 49152, v4
  s_waitcnt lgkmcnt(3)
  v_mfma_f32_16x16x32_bf16 v[40:43], v[184:187], a[152:155], v[40:43]
  ds_read_b128 a[144:147], v1 offset:0
  v_mfma_f32_16x16x32_bf16 v[40:43], a[96:99], a[156:159], v[40:43]
  ds_read_b128 a[148:151], v2 offset:0
  v_mfma_f32_16x16x32_bf16 v[44:47], v[188:191], a[152:155], v[44:47]
  ds_read_b128 a[180:183], v5 offset:36864
  v_mfma_f32_16x16x32_bf16 v[44:47], a[100:103], a[156:159], v[44:47]
  ds_read_b128 a[184:187], v6 offset:36864
  v_mfma_f32_16x16x32_bf16 v[48:51], v[192:195], a[152:155], v[48:51]
  ds_read_b128 a[188:191], v7 offset:36864
  v_mfma_f32_16x16x32_bf16 v[48:51], a[104:107], a[156:159], v[48:51]
  ds_read_b128 a[168:171], v5 offset:24576
  v_mfma_f32_16x16x32_bf16 v[52:55], v[196:199], a[152:155], v[52:55]
  ds_read_b128 a[172:175], v6 offset:24576
  v_mfma_f32_16x16x32_bf16 v[52:55], a[108:111], a[156:159], v[52:55]
  ds_read_b128 a[176:179], v7 offset:24576
  v_mfma_f32_16x16x32_bf16 v[56:59], v[200:203], a[152:155], v[56:59]
  v_mfma_f32_16x16x32_bf16 v[56:59], a[112:115], a[156:159], v[56:59]
  v_mfma_f32_16x16x32_bf16 v[60:63], v[204:207], a[152:155], v[60:63]
  v_mfma_f32_16x16x32_bf16 v[60:63], a[116:119], a[156:159], v[60:63]
  s_waitcnt lgkmcnt(8)
  v_mfma_f32_16x16x32_bf16 v[40:43], v[208:211], a[160:163], v[40:43]
  ds_read_b128 a[152:155], v3 offset:0
  v_mfma_f32_16x16x32_bf16 v[40:43], v[232:235], a[164:167], v[40:43]
  ds_read_b128 a[156:159], v4 offset:0
  v_mfma_f32_16x16x32_bf16 v[44:47], v[212:215], a[160:163], v[44:47]
  s_waitcnt lgkmcnt(7)
  buffer_store_dwordx4 a[180:183], v83, s[8:11], s59 offen sc1
  v_mfma_f32_16x16x32_bf16 v[44:47], v[236:239], a[164:167], v[44:47]
  v_mfma_f32_16x16x32_bf16 v[48:51], v[216:219], a[160:163], v[48:51]
  v_mfma_f32_16x16x32_bf16 v[48:51], v[240:243], a[164:167], v[48:51]
  v_mfma_f32_16x16x32_bf16 v[52:55], v[220:223], a[160:163], v[52:55]
  v_mfma_f32_16x16x32_bf16 v[52:55], v[244:247], a[164:167], v[52:55]
  v_mfma_f32_16x16x32_bf16 v[56:59], v[224:227], a[160:163], v[56:59]
  s_waitcnt lgkmcnt(6)
  buffer_store_dwordx4 a[184:187], v65, s[8:11], s62 offen sc1
  v_mfma_f32_16x16x32_bf16 v[56:59], v[248:251], a[164:167], v[56:59]
  v_mfma_f32_16x16x32_bf16 v[60:63], v[228:231], a[160:163], v[60:63]
  v_mfma_f32_16x16x32_bf16 v[60:63], v[252:255], a[164:167], v[60:63]
  s_cmp_lt_u32 s78, s40
  s_cbranch_scc1 L_loop
L_tail:
  s_nop 3
  v_cvt_pk_bf16_f32 v40, v40, v41
  v_cvt_pk_bf16_f32 v41, v42, v43
  v_cvt_pk_bf16_f32 v42, v44, v45
  v_cvt_pk_bf16_f32 v43, v46, v47
  ds_write_b128 v86, v[40:43] offset:12288
  v_cvt_pk_bf16_f32 v48, v48, v49
  v_cvt_pk_bf16_f32 v49, v50, v51
  v_cvt_pk_bf16_f32 v50, v52, v53
  v_cvt_pk_bf16_f32 v51, v54, v55
  ds_write_b128 v87, v[48:51] offset:12288
  v_cvt_pk_bf16_f32 v56, v56, v57
  v_cvt_pk_bf16_f32 v57, v58, v59
  v_cvt_pk_bf16_f32 v58, v60, v61
  v_cvt_pk_bf16_f32 v59, v62, v63
  ds_write_b128 v86, v[56:59] offset:12416
  s_waitcnt lgkmcnt(8)
  buffer_store_dwordx4 a[188:191], v85, s[8:11], s63 offen sc1
  s_waitcnt lgkmcnt(7)
  buffer_store_dwordx4 a[168:171], v80, s[8:11], s58 offen sc1
  s_waitcnt lgkmcnt(6)
  buffer_store_dwordx4 a[172:175], v81, s[8:11], s58 offen sc1
  s_waitcnt lgkmcnt(5)
  buffer_store_dwordx4 a[176:179], v82, s[8:11], s58 offen sc1
  s_mov_b32 s58, s78
  s_mov_b32 s59, s80
  s_mov_b32 s63, s81
  s_min_u32 s62, s80, s81
  s_cmp_gt_u32 s80, s81
  s_cselect_b64 s[90:91], -1, 0
  s_nop 0
  v_cndmask_b32 v65, v84, v64, s[90:91]
  s_waitcnt lgkmcnt(0)
  s_barrier
  ds_read_b128 a[144:147], v5 offset:12288
  ds_read_b128 a[148:151], v6 offset:12288
  ds_read_b128 a[152:155], v7 offset:12288
  s_waitcnt lgkmcnt(2)
  buffer_store_dwordx4 a[144:147], v83, s[8:11], s59 offen sc1
  s_waitcnt lgkmcnt(1)
  buffer_store_dwordx4 a[148:151], v65, s[8:11], s62 offen sc1
  s_waitcnt lgkmcnt(0)
  buffer_store_dwordx4 a[152:155], v85, s[8:11], s63 offen sc1
  s_endpgm
L_slow:
  v_mov_b32 v15, s36
  v_mov_b32 v254, 1
  v_mov_b32 v255, 0
  s_mov_b64 exec, 1
  buffer_atomic_cmpswap v[254:255], v15, s[16:19], 0 offen sc0 sc1
  s_waitcnt vmcnt(0)
  v_readfirstlane_b32 s95, v254
  s_mov_b64 exec, -1
  s_branch L_back
L_done:
  s_endpgm
.section .rodata,"a"
.p2align 6
.amdhsa_kernel standalone__depthwise_separable__vision_kernel
  .amdhsa_next_free_vgpr 512
  .amdhsa_next_free_sgpr 100
  .amdhsa_accum_offset 256
  .amdhsa_group_segment_fixed_size 0
  .amdhsa_kernarg_size 48
  .amdhsa_user_sgpr_count 2
  .amdhsa_user_sgpr_kernarg_segment_ptr 1
  .amdhsa_system_sgpr_workgroup_id_x 1
  .amdhsa_float_denorm_mode_32 3
.end_amdhsa_kernel
```

```asm
; @launch grid=(256,1,1) block=(256,1,1) lds=152128
.amdgcn_target "amdgcn-amd-amdhsa--gfx950"
.text
.globl standalone__depthwise_separable__vision_kernel
.p2align 8
.type standalone__depthwise_separable__vision_kernel,@function
standalone__depthwise_separable__vision_kernel:
  s_load_dwordx8 s[24:31], s[0:1], 0
  s_load_dwordx2 s[92:93], s[0:1], 32
  s_cmp_ge_u32 s2, 256
  s_cbranch_scc1 L_done
  v_lshrrev_b32 v16, 6, v0
  v_and_b32 v28, 63, v0
  v_readfirstlane_b32 s20, v16
  s_getpc_b64 s[50:51]
L_pc:
  v_mul_u32_u24 v18, 128, v0
  v_min_u32 v18, L_done-L_pc, v18
  v_mov_b32 v19, s51
  v_add_co_u32 v18, vcc, s50, v18
  s_nop 1
  v_addc_co_u32 v19, vcc, 0, v19, vcc
  global_load_dword v88, v[18:19], off
  s_lshr_b32 s50, s2, 3
  s_and_b32 s55, s50, 3
  s_lshr_b32 s54, s50, 2
  s_mul_i32 s51, s54, 11
  s_lshr_b32 s51, s51, 5
  s_mul_i32 s51, s51, 3
  s_sub_u32 s54, s54, s51
  s_mul_i32 s52, s20, 192
  v_mul_u32_u24 v18, 0xaaab, v28
  v_lshrrev_b32 v18, 19, v18
  v_mul_u32_u24 v19, 576, v18
  v_lshl_add_u32 v19, v28, 4, v19
  v_add_u32 v64, s52, v19
  v_add_u32 v17, 64, v28
  v_mul_u32_u24 v18, 0xaaab, v17
  v_lshrrev_b32 v18, 19, v18
  v_mul_u32_u24 v19, 576, v18
  v_lshl_add_u32 v19, v28, 4, v19
  v_lshrrev_b32 v18, 3, v18
  v_mul_u32_u24 v18, 6144, v18
  v_add_u32 v19, v19, v18
  v_add_u32 v65, s52, v19
  v_add_u32 v17, 128, v28
  v_mul_u32_u24 v18, 0xaaab, v17
  v_lshrrev_b32 v18, 19, v18
  v_mul_u32_u24 v19, 576, v18
  v_lshl_add_u32 v19, v28, 4, v19
  v_add_u32 v19, 6144, v19
  v_add_u32 v66, s52, v19
  s_mul_i32 s42, s54, 98304
  s_mul_i32 s45, s55, 24576
  s_mul_i32 s49, s20, 6160
  s_waitcnt lgkmcnt(0)
  s_mov_b32 s12, s28
  s_and_b32 s13, s29, 0xffff
  s_mov_b32 s14, 294912
  s_mov_b32 s15, 0x00020000
  s_add_u32 m0, s49, 98560
  s_add_u32 s50, s42, s45
  buffer_load_dwordx4 v64, s[12:15], s50 offen offset:0 lds
  buffer_load_dwordx4 v65, s[12:15], s50 offen offset:1024 lds
  buffer_load_dwordx4 v66, s[12:15], s50 offen offset:2048 lds
  s_add_u32 m0, s49, 101640
  s_add_u32 s50, s50, 6144
  buffer_load_dwordx4 v64, s[12:15], s50 offen offset:0 lds
  buffer_load_dwordx4 v65, s[12:15], s50 offen offset:1024 lds
  buffer_load_dwordx4 v66, s[12:15], s50 offen offset:2048 lds
  s_lshr_b32 s51, s2, 5
  s_and_b32 s52, s2, 3
  s_lshl2_add_u32 s36, s51, s52
  s_lshl_b32 s36, s36, 2
  s_mul_i32 s51, s51, 288
  s_lshl2_add_u32 s52, s55, s52
  s_add_u32 s51, s51, s52
  s_mul_i32 s32, s51, 49152
  s_add_u32 s35, s32, 14155776
  s_lshl_b32 s51, s20, 11
  s_and_b32 s52, s2, 4
  s_lshl_b32 s52, s52, 6
  s_add_u32 s51, s51, s52
  s_add_u32 s37, s32, s51
  s_add_u32 s37, s37, 7077888
  s_add_u32 s38, s37, 8192
  s_and_b32 s23, s2, 28
  s_cmp_lg_u32 s23, 0
  s_cbranch_scc1 L_np0
  s_load_dword s84, s[24:25], s37 glc
  s_load_dword s85, s[24:25], s38 glc
L_np0:
  s_lshl_b32 s53, s55, 2
  v_lshrrev_b32 v17, 4, v28
  v_add_u32 v18, s54, v17
  v_subrev_u32 v19, 3, v18
  v_min_u32 v18, v18, v19
  v_and_b32 v20, 15, v28
  v_xor_b32 v19, s53, v20
  v_lshlrev_b32 v19, 4, v19
  v_lshl_add_u32 v19, v18, 8, v19
  v_cmp_lt_u32 vcc, 47, v28
  s_lshl_b32 s50, s20, 10
  s_add_u32 m0, s50, 147968
  v_cndmask_b32 v19, v19, v66, vcc
  s_mov_b32 s16, s26
  s_and_b32 s17, s27, 0xffff
  s_mov_b32 s18, 768
  s_mov_b32 s19, 0x00020000
  buffer_load_dwordx4 v19, s[16:19], 0 offen lds
  s_add_u32 s43, s42, 98304
  s_cmp_eq_u32 s54, 2
  s_cselect_b32 s43, 0, s43
  s_add_u32 s44, s43, 98304
  s_cmp_eq_u32 s54, 1
  s_cselect_b32 s44, 0, s44
  s_xor_b32 s46, s55, 1
  s_mul_i32 s46, s46, 24576
  s_xor_b32 s47, s55, 2
  s_mul_i32 s47, s47, 24576
  s_xor_b32 s48, s55, 3
  s_mul_i32 s48, s48, 24576
  s_mov_b32 s4, s24
  s_and_b32 s5, s25, 0xffff
  s_mov_b32 s6, 113246208
  s_mov_b32 s7, 0x00020000
  s_add_u32 s33, s24, 24576
  s_mov_b32 s40, 113246208
  s_lshl_b32 s39, s20, 10
  s_mov_b32 s76, s40
  s_mov_b32 s77, s40
  s_mov_b32 s78, s40
  s_mov_b32 s79, s40
  s_mov_b32 s80, s40
  s_mov_b32 s81, s40
  s_lshr_b32 s34, s2, 1
  s_xor_b32 s34, s34, s2
  s_and_b32 s34, s34, 4
  s_lshl_b32 s34, s34, 19
  v_lshrrev_b32 v35, 4, v0
  v_xor_b32 v22, s53, v20
  v_mul_u32_u24 v32, 43, v35
  v_lshrrev_b32 v32, 7, v32
  v_mul_u32_u24 v18, 3, v32
  v_sub_u32 v19, v35, v18
  v_add_u32 v19, s54, v19
  v_subrev_u32 v21, 3, v19
  v_min_u32 v19, v19, v21
  v_add_u32 v19, v19, v18
  v_xor_b32 v21, v32, v22
  v_lshlrev_b32 v21, 4, v21
  v_lshl_add_u32 v8, v19, 8, v21
  v_add_u32 v11, 19968, v8
  v_add_u32 v36, 16, v35
  v_mul_u32_u24 v33, 43, v36
  v_lshrrev_b32 v33, 7, v33
  v_mul_u32_u24 v18, 3, v33
  v_sub_u32 v19, v36, v18
  v_add_u32 v19, s54, v19
  v_subrev_u32 v21, 3, v19
  v_min_u32 v19, v19, v21
  v_add_u32 v19, v19, v18
  v_xor_b32 v21, v33, v22
  v_lshlrev_b32 v21, 4, v21
  v_lshl_add_u32 v9, v19, 8, v21
  v_cmp_lt_u32 vcc, 5, v33
  v_add_u32 v24, 19968, v9
  v_add_u32 v25, 28416, v9
  v_cndmask_b32 v12, v24, v25, vcc
  v_add_u32 v24, 44544, v9
  v_add_u32 v25, 3840, v9
  v_cndmask_b32 v14, v24, v25, vcc
  v_add_u32 v37, 32, v35
  v_mul_u32_u24 v34, 43, v37
  v_lshrrev_b32 v34, 7, v34
  v_mul_u32_u24 v18, 3, v34
  v_sub_u32 v19, v37, v18
  v_add_u32 v19, s54, v19
  v_subrev_u32 v21, 3, v19
  v_min_u32 v19, v19, v21
  v_add_u32 v19, v19, v18
  v_xor_b32 v21, v34, v22
  v_lshlrev_b32 v21, 4, v21
  v_lshl_add_u32 v10, v19, 8, v21
  v_cmp_lt_u32 vcc, 10, v34
  v_add_u32 v24, 7680, v10
  v_add_u32 v13, 3840, v10
  v_cndmask_b32 v10, v10, v24, vcc
  s_mov_b32 s8, s30
  s_and_b32 s9, s31, 0xffff
  s_mov_b32 s10, 113246208
  s_mov_b32 s11, 0x00020000
  v_lshlrev_b32 v80, 4, v0
  v_and_b32 v21, 7, v32
  v_xor_b32 v21, v21, v20
  v_lshlrev_b32 v21, 4, v21
  v_lshl_add_u32 v21, v35, 8, v21
  v_add_u32 v5, 98560, v21
  v_add_u32 v81, 4096, v80
  v_and_b32 v21, 7, v33
  v_xor_b32 v21, v21, v20
  v_lshlrev_b32 v21, 4, v21
  v_lshl_add_u32 v21, v36, 8, v21
  v_add_u32 v6, 98560, v21
  v_add_u32 v82, 8192, v80
  v_and_b32 v21, 7, v34
  v_xor_b32 v21, v21, v20
  v_lshlrev_b32 v21, 4, v21
  v_lshl_add_u32 v21, v37, 8, v21
  v_add_u32 v7, 98560, v21
  v_add_u32 v83, 19968, v80
  v_cmp_lt_u32 vcc, 5, v33
  v_add_u32 v24, 19968, v81
  v_add_u32 v25, 28416, v81
  v_cndmask_b32 v84, v24, v25, vcc
  v_cmp_lt_u32 vcc, 10, v34
  v_add_u32 v24, 7680, v82
  v_add_u32 v85, 3840, v82
  v_cndmask_b32 v82, v82, v24, vcc
  v_mul_u32_u24 v16, 0x300, v20
  v_xor_b32 v18, v17, v20
  v_lshl_add_u32 v1, v18, 4, v16
  v_xor_b32 v2, 64, v1
  v_xor_b32 v3, 128, v1
  v_xor_b32 v4, 192, v1
  s_mul_i32 s51, s20, 12
  v_and_b32 v18, 7, v20
  v_add_u32 v19, s51, v17
  v_xor_b32 v19, v19, v18
  v_lshl_add_u32 v86, v19, 4, v16
  v_add_u32 v86, 98560, v86
  v_add_u32 v19, s51, v17
  v_add_u32 v19, 4, v19
  v_xor_b32 v19, v19, v18
  v_lshl_add_u32 v87, v19, 4, v16
  v_add_u32 v87, 98560, v87
  v_bfe_u32 v18, v28, 2, 2
  v_and_b32 v19, 3, v28
  v_lshrrev_b32 v21, 1, v17
  v_lshl_add_u32 v21, v21, 3, v18
  v_mul_u32_u24 v21, 192, v21
  v_and_b32 v23, 1, v17
  v_mul_u32_u24 v23, 3080, v23
  v_add_u32 v21, v21, v23
  v_lshl_add_u32 v21, v19, 4, v21
  s_add_u32 s51, s49, 49152
  v_add_u32 v71, s51, v21
  v_add_u32 v67, 49408, v71
  s_add_u32 s51, s39, 147968
  v_lshl_add_u32 v68, v17, 4, s51
  v_and_b32 v21, 1, v28
  v_lshlrev_b32 v21, 4, v21
  v_mov_b32 v23, 0xffff
  v_lshlrev_b32 v21, v21, v23
  v_lshlrev_b32 v16, 1, v17
  v_bfe_u32 v23, v28, 1, 3
  v_cmp_eq_u32 vcc, v16, v23
  v_add_u32 v16, 1, v16
  s_nop 0
  v_cndmask_b32 v69, 0, v21, vcc
  v_cmp_eq_u32 vcc, v16, v23
  s_mov_b32 s16, s92
  s_and_b32 s17, s93, 0xffff
  s_mov_b32 s18, 256
  s_mov_b32 s19, 0x00020000
  v_cndmask_b32 v70, 0, v21, vcc
  s_add_u32 m0, s49, 123200
  s_add_u32 s50, s42, s46
  buffer_load_dwordx4 v64, s[12:15], s50 offen offset:0 lds
  buffer_load_dwordx4 v65, s[12:15], s50 offen offset:1024 lds
  buffer_load_dwordx4 v66, s[12:15], s50 offen offset:2048 lds
  s_add_u32 m0, s49, 126280
  s_add_u32 s50, s50, 6144
  buffer_load_dwordx4 v64, s[12:15], s50 offen offset:0 lds
  buffer_load_dwordx4 v65, s[12:15], s50 offen offset:1024 lds
  buffer_load_dwordx4 v66, s[12:15], s50 offen offset:2048 lds
  s_cmp_lg_u32 s23, 0
  s_cbranch_scc1 L_npr
  s_mov_b32 s41, 0xffff
  s_mov_b32 s95, 0xffff
  s_lshl_b32 s52, s20, 2
  s_add_u32 s52, s52, 152064
  v_mov_b32 v16, s52
  s_waitcnt lgkmcnt(0)
  s_memtime s[84:85]
  s_load_dword s52, s[24:25], s37 glc
  s_waitcnt lgkmcnt(0)
  s_memtime s[86:87]
  s_load_dword s52, s[24:25], s38 glc
  s_waitcnt lgkmcnt(0)
  s_sub_u32 s51, s86, s84
  s_memtime s[84:85]
  s_min_u32 s41, s41, s51
  s_waitcnt lgkmcnt(0)
  s_sub_u32 s51, s84, s86
  s_min_u32 s95, s95, s51
  s_lshl_b32 s41, s41, 16
  s_or_b32 s41, s41, s95
  v_mov_b32 v18, s41
  ds_write_b32 v16, v18
  s_waitcnt lgkmcnt(0)
L_npr:
  s_add_u32 m0, s49, 49152
  s_add_u32 s50, s42, s47
  buffer_load_dwordx4 v64, s[12:15], s50 offen offset:0 lds
  buffer_load_dwordx4 v65, s[12:15], s50 offen offset:1024 lds
  buffer_load_dwordx4 v66, s[12:15], s50 offen offset:2048 lds
  s_add_u32 m0, s49, 52232
  s_add_u32 s50, s50, 6144
  buffer_load_dwordx4 v64, s[12:15], s50 offen offset:0 lds
  buffer_load_dwordx4 v65, s[12:15], s50 offen offset:1024 lds
  buffer_load_dwordx4 v66, s[12:15], s50 offen offset:2048 lds
  s_add_u32 m0, s49, 73792
  s_add_u32 s50, s42, s48
  buffer_load_dwordx4 v64, s[12:15], s50 offen offset:0 lds
  buffer_load_dwordx4 v65, s[12:15], s50 offen offset:1024 lds
  buffer_load_dwordx4 v66, s[12:15], s50 offen offset:2048 lds
  s_add_u32 m0, s49, 76872
  s_add_u32 s50, s50, 6144
  buffer_load_dwordx4 v64, s[12:15], s50 offen offset:0 lds
  buffer_load_dwordx4 v65, s[12:15], s50 offen offset:1024 lds
  buffer_load_dwordx4 v66, s[12:15], s50 offen offset:2048 lds
  s_waitcnt vmcnt(18)
  ds_read_b128 v[72:75], v68 offset:0
  ds_read_b64_tr_b16 a[192:193], v67 offset:0
  ds_read_b64_tr_b16 a[194:195], v67 offset:768
  ds_read_b64_tr_b16 a[196:197], v67 offset:8
  ds_read_b64_tr_b16 a[198:199], v67 offset:776
  ds_read_b64_tr_b16 a[200:201], v67 offset:64
  ds_read_b64_tr_b16 a[202:203], v67 offset:832
  ds_read_b64_tr_b16 a[204:205], v67 offset:72
  ds_read_b64_tr_b16 a[206:207], v67 offset:840
  ds_read_b64_tr_b16 a[208:209], v67 offset:128
  ds_read_b64_tr_b16 a[210:211], v67 offset:896
  ds_read_b64_tr_b16 a[212:213], v67 offset:136
  ds_read_b64_tr_b16 a[214:215], v67 offset:904
  s_waitcnt lgkmcnt(0)
  v_and_b32 v72, v69, v72
  v_and_b32 v73, v70, v73
  v_and_b32 v74, v69, v74
  v_and_b32 v75, v70, v75
  s_waitcnt vmcnt(12)
  ds_read_b128 v[76:79], v68 offset:64
  v_mfma_f32_16x16x16_bf16 v[16:19], v[72:73], a[192:193], 0
  ds_read_b64_tr_b16 a[216:217], v67 offset:24640
  ds_read_b64_tr_b16 a[218:219], v67 offset:25408
  v_mfma_f32_16x16x16_bf16 v[20:23], v[74:75], a[194:195], 0
  ds_read_b64_tr_b16 a[220:221], v67 offset:24648
  ds_read_b64_tr_b16 a[222:223], v67 offset:25416
  v_mfma_f32_16x16x16_bf16 v[24:27], v[72:73], a[196:197], 0
  ds_read_b64_tr_b16 a[224:225], v67 offset:24704
  ds_read_b64_tr_b16 a[226:227], v67 offset:25472
  v_mfma_f32_16x16x16_bf16 v[28:31], v[74:75], a[198:199], 0
  ds_read_b64_tr_b16 a[228:229], v67 offset:24712
  ds_read_b64_tr_b16 a[230:231], v67 offset:25480
  v_mfma_f32_16x16x16_bf16 v[32:35], v[72:73], a[200:201], 0
  ds_read_b64_tr_b16 a[232:233], v67 offset:24768
  ds_read_b64_tr_b16 a[234:235], v67 offset:25536
  v_cvt_pk_bf16_f32 v88, v16, v17
  v_cvt_pk_bf16_f32 v89, v18, v19
  v_mfma_f32_16x16x16_bf16 v[36:39], v[74:75], a[202:203], 0
  ds_read_b64_tr_b16 a[236:237], v67 offset:24776
  ds_read_b64_tr_b16 a[238:239], v67 offset:25544
  v_cvt_pk_bf16_f32 v90, v20, v21
  v_cvt_pk_bf16_f32 v91, v22, v23
  v_mfma_f32_16x16x16_bf16 v[40:43], v[72:73], a[204:205], 0
  s_add_u32 m0, s49, 98560
  s_add_u32 s50, s43, s45
  v_cvt_pk_bf16_f32 v92, v24, v25
  v_cvt_pk_bf16_f32 v93, v26, v27
  v_mfma_f32_16x16x16_bf16 v[44:47], v[74:75], a[206:207], 0
  buffer_load_dwordx4 v64, s[12:15], s50 offen offset:0 lds
  buffer_load_dwordx4 v65, s[12:15], s50 offen offset:1024 lds
  v_cvt_pk_bf16_f32 v94, v28, v29
  v_cvt_pk_bf16_f32 v95, v30, v31
  v_mfma_f32_16x16x16_bf16 v[48:51], v[72:73], a[208:209], 0
  buffer_load_dwordx4 v66, s[12:15], s50 offen offset:2048 lds
  s_add_u32 m0, s49, 101640
  v_cvt_pk_bf16_f32 v96, v32, v33
  v_cvt_pk_bf16_f32 v97, v34, v35
  v_mfma_f32_16x16x16_bf16 v[52:55], v[74:75], a[210:211], 0
  s_add_u32 s50, s50, 6144
  buffer_load_dwordx4 v64, s[12:15], s50 offen offset:0 lds
  v_cvt_pk_bf16_f32 v98, v36, v37
  v_cvt_pk_bf16_f32 v99, v38, v39
  v_mfma_f32_16x16x16_bf16 v[56:59], v[72:73], a[212:213], 0
  buffer_load_dwordx4 v65, s[12:15], s50 offen offset:1024 lds
  v_cvt_pk_bf16_f32 v100, v40, v41
  v_cvt_pk_bf16_f32 v101, v42, v43
  v_mfma_f32_16x16x16_bf16 v[60:63], v[74:75], a[214:215], 0
  buffer_load_dwordx4 v66, s[12:15], s50 offen offset:2048 lds
  v_cvt_pk_bf16_f32 v102, v44, v45
  v_cvt_pk_bf16_f32 v103, v46, v47
  s_cmp_lg_u32 s23, 0
  s_cbranch_scc1 L_np1
  s_barrier
  s_or_b32 s51, s23, s20
  s_cmp_lg_u32 s51, 0
  s_cbranch_scc1 L_np1
  v_mov_b32 v252, 152064
  ds_read_b128 v[248:251], v252
  s_add_u32 s51, s33, s37
  s_lshr_b32 s51, s51, 21
  s_lshr_b32 s52, s2, 2
  s_xor_b32 s51, s51, s52
  s_and_b32 s51, s51, 1
  s_add_u32 s52, s51, 1
  s_sub_u32 s51, 2, s51
  v_mov_b32 v254, s52
  v_mov_b32 v253, s51
  v_mov_b32 v255, 0
  v_mov_b32 v252, s36
  s_waitcnt lgkmcnt(0)
  v_pk_min_u16 v248, v248, v249
  v_pk_min_u16 v250, v250, v251
  v_pk_min_u16 v248, v248, v250
  v_lshrrev_b32 v249, 16, v248
  v_and_b32 v248, 0xffff, v248
  v_cmp_gt_u32 vcc, v249, v248
  s_mov_b64 exec, 1
  s_nop 0
  v_cndmask_b32 v254, v254, v253, vcc
  buffer_atomic_cmpswap v[254:255], v252, s[16:19], 0 offen sc1
  s_mov_b64 exec, -1
L_np1:
  s_waitcnt lgkmcnt(0)
  v_and_b32 v76, v69, v76
  v_and_b32 v77, v70, v77
  v_and_b32 v78, v69, v78
  v_and_b32 v79, v70, v79
  s_waitcnt vmcnt(12)
  ds_read_b128 v[72:75], v68 offset:128
  v_mfma_f32_16x16x16_bf16 v[16:19], v[76:77], a[216:217], 0
  ds_read_b64_tr_b16 a[192:193], v71 offset:0
  ds_read_b64_tr_b16 a[194:195], v71 offset:768
  v_cvt_pk_bf16_f32 v104, v48, v49
  v_cvt_pk_bf16_f32 v105, v50, v51
  v_mfma_f32_16x16x16_bf16 v[20:23], v[78:79], a[218:219], 0
  ds_read_b64_tr_b16 a[196:197], v71 offset:8
  ds_read_b64_tr_b16 a[198:199], v71 offset:776
  v_cvt_pk_bf16_f32 v106, v52, v53
  v_cvt_pk_bf16_f32 v107, v54, v55
  v_mfma_f32_16x16x16_bf16 v[24:27], v[76:77], a[220:221], 0
  ds_read_b64_tr_b16 a[200:201], v71 offset:64
  ds_read_b64_tr_b16 a[202:203], v71 offset:832
  v_cvt_pk_bf16_f32 v108, v56, v57
  v_cvt_pk_bf16_f32 v109, v58, v59
  v_mfma_f32_16x16x16_bf16 v[28:31], v[78:79], a[222:223], 0
  ds_read_b64_tr_b16 a[204:205], v71 offset:72
  ds_read_b64_tr_b16 a[206:207], v71 offset:840
  v_cvt_pk_bf16_f32 v110, v60, v61
  v_cvt_pk_bf16_f32 v111, v62, v63
  v_mfma_f32_16x16x16_bf16 v[32:35], v[76:77], a[224:225], 0
  ds_read_b64_tr_b16 a[208:209], v71 offset:128
  ds_read_b64_tr_b16 a[210:211], v71 offset:896
  v_cvt_pk_bf16_f32 v16, v16, v17
  v_cvt_pk_bf16_f32 v17, v18, v19
  v_accvgpr_write_b32 a0, v16
  v_accvgpr_write_b32 a1, v17
  v_mfma_f32_16x16x16_bf16 v[36:39], v[78:79], a[226:227], 0
  ds_read_b64_tr_b16 a[212:213], v71 offset:136
  ds_read_b64_tr_b16 a[214:215], v71 offset:904
  v_cvt_pk_bf16_f32 v20, v20, v21
  v_cvt_pk_bf16_f32 v21, v22, v23
  v_accvgpr_write_b32 a2, v20
  v_accvgpr_write_b32 a3, v21
  v_mfma_f32_16x16x16_bf16 v[40:43], v[76:77], a[228:229], 0
  s_add_u32 m0, s49, 123200
  s_add_u32 s50, s43, s46
  v_cvt_pk_bf16_f32 v24, v24, v25
  v_cvt_pk_bf16_f32 v25, v26, v27
  v_accvgpr_write_b32 a4, v24
  v_accvgpr_write_b32 a5, v25
  v_mfma_f32_16x16x16_bf16 v[44:47], v[78:79], a[230:231], 0
  buffer_load_dwordx4 v64, s[12:15], s50 offen offset:0 lds
  buffer_load_dwordx4 v65, s[12:15], s50 offen offset:1024 lds
  v_cvt_pk_bf16_f32 v28, v28, v29
  v_cvt_pk_bf16_f32 v29, v30, v31
  v_accvgpr_write_b32 a6, v28
  v_accvgpr_write_b32 a7, v29
  v_mfma_f32_16x16x16_bf16 v[48:51], v[76:77], a[232:233], 0
  buffer_load_dwordx4 v66, s[12:15], s50 offen offset:2048 lds
  s_add_u32 m0, s49, 126280
  v_cvt_pk_bf16_f32 v32, v32, v33
  v_cvt_pk_bf16_f32 v33, v34, v35
  v_accvgpr_write_b32 a8, v32
  v_accvgpr_write_b32 a9, v33
  v_mfma_f32_16x16x16_bf16 v[52:55], v[78:79], a[234:235], 0
  s_add_u32 s50, s50, 6144
  buffer_load_dwordx4 v64, s[12:15], s50 offen offset:0 lds
  v_cvt_pk_bf16_f32 v36, v36, v37
  v_cvt_pk_bf16_f32 v37, v38, v39
  v_accvgpr_write_b32 a10, v36
  v_accvgpr_write_b32 a11, v37
  v_mfma_f32_16x16x16_bf16 v[56:59], v[76:77], a[236:237], 0
  buffer_load_dwordx4 v65, s[12:15], s50 offen offset:1024 lds
  v_cvt_pk_bf16_f32 v40, v40, v41
  v_cvt_pk_bf16_f32 v41, v42, v43
  v_accvgpr_write_b32 a12, v40
  v_accvgpr_write_b32 a13, v41
  v_mfma_f32_16x16x16_bf16 v[60:63], v[78:79], a[238:239], 0
  buffer_load_dwordx4 v66, s[12:15], s50 offen offset:2048 lds
  v_cvt_pk_bf16_f32 v44, v44, v45
  v_cvt_pk_bf16_f32 v45, v46, v47
  v_accvgpr_write_b32 a14, v44
  v_accvgpr_write_b32 a15, v45
  s_waitcnt lgkmcnt(0)
  v_and_b32 v72, v69, v72
  v_and_b32 v73, v70, v73
  v_and_b32 v74, v69, v74
  v_and_b32 v75, v70, v75
  s_waitcnt vmcnt(12)
  ds_read_b128 v[76:79], v68 offset:192
  v_mfma_f32_16x16x16_bf16 v[16:19], v[72:73], a[192:193], 0
  ds_read_b64_tr_b16 a[216:217], v71 offset:24640
  ds_read_b64_tr_b16 a[218:219], v71 offset:25408
  v_cvt_pk_bf16_f32 v48, v48, v49
  v_cvt_pk_bf16_f32 v49, v50, v51
  v_accvgpr_write_b32 a16, v48
  v_accvgpr_write_b32 a17, v49
  v_mfma_f32_16x16x16_bf16 v[20:23], v[74:75], a[194:195], 0
  ds_read_b64_tr_b16 a[220:221], v71 offset:24648
  ds_read_b64_tr_b16 a[222:223], v71 offset:25416
  v_cvt_pk_bf16_f32 v52, v52, v53
  v_cvt_pk_bf16_f32 v53, v54, v55
  v_accvgpr_write_b32 a18, v52
  v_accvgpr_write_b32 a19, v53
  v_mfma_f32_16x16x16_bf16 v[24:27], v[72:73], a[196:197], 0
  ds_read_b64_tr_b16 a[224:225], v71 offset:24704
  ds_read_b64_tr_b16 a[226:227], v71 offset:25472
  v_cvt_pk_bf16_f32 v56, v56, v57
  v_cvt_pk_bf16_f32 v57, v58, v59
  v_accvgpr_write_b32 a20, v56
  v_accvgpr_write_b32 a21, v57
  v_mfma_f32_16x16x16_bf16 v[28:31], v[74:75], a[198:199], 0
  ds_read_b64_tr_b16 a[228:229], v71 offset:24712
  ds_read_b64_tr_b16 a[230:231], v71 offset:25480
  v_cvt_pk_bf16_f32 v60, v60, v61
  v_cvt_pk_bf16_f32 v61, v62, v63
  v_accvgpr_write_b32 a22, v60
  v_accvgpr_write_b32 a23, v61
  v_mfma_f32_16x16x16_bf16 v[32:35], v[72:73], a[200:201], 0
  ds_read_b64_tr_b16 a[232:233], v71 offset:24768
  ds_read_b64_tr_b16 a[234:235], v71 offset:25536
  v_cvt_pk_bf16_f32 v112, v16, v17
  v_cvt_pk_bf16_f32 v113, v18, v19
  v_mfma_f32_16x16x16_bf16 v[36:39], v[74:75], a[202:203], 0
  ds_read_b64_tr_b16 a[236:237], v71 offset:24776
  ds_read_b64_tr_b16 a[238:239], v71 offset:25544
  v_cvt_pk_bf16_f32 v114, v20, v21
  v_cvt_pk_bf16_f32 v115, v22, v23
  v_mfma_f32_16x16x16_bf16 v[40:43], v[72:73], a[204:205], 0
  s_add_u32 m0, s49, 49152
  s_add_u32 s50, s43, s47
  v_cvt_pk_bf16_f32 v116, v24, v25
  v_cvt_pk_bf16_f32 v117, v26, v27
  v_mfma_f32_16x16x16_bf16 v[44:47], v[74:75], a[206:207], 0
  buffer_load_dwordx4 v64, s[12:15], s50 offen offset:0 lds
  buffer_load_dwordx4 v65, s[12:15], s50 offen offset:1024 lds
  v_cvt_pk_bf16_f32 v118, v28, v29
  v_cvt_pk_bf16_f32 v119, v30, v31
  v_mfma_f32_16x16x16_bf16 v[48:51], v[72:73], a[208:209], 0
  buffer_load_dwordx4 v66, s[12:15], s50 offen offset:2048 lds
  s_add_u32 m0, s49, 52232
  v_cvt_pk_bf16_f32 v120, v32, v33
  v_cvt_pk_bf16_f32 v121, v34, v35
  v_mfma_f32_16x16x16_bf16 v[52:55], v[74:75], a[210:211], 0
  s_add_u32 s50, s50, 6144
  buffer_load_dwordx4 v64, s[12:15], s50 offen offset:0 lds
  v_cvt_pk_bf16_f32 v122, v36, v37
  v_cvt_pk_bf16_f32 v123, v38, v39
  v_mfma_f32_16x16x16_bf16 v[56:59], v[72:73], a[212:213], 0
  buffer_load_dwordx4 v65, s[12:15], s50 offen offset:1024 lds
  v_cvt_pk_bf16_f32 v124, v40, v41
  v_cvt_pk_bf16_f32 v125, v42, v43
  v_mfma_f32_16x16x16_bf16 v[60:63], v[74:75], a[214:215], 0
  buffer_load_dwordx4 v66, s[12:15], s50 offen offset:2048 lds
  v_cvt_pk_bf16_f32 v126, v44, v45
  v_cvt_pk_bf16_f32 v127, v46, v47
  s_waitcnt lgkmcnt(0)
  v_and_b32 v76, v69, v76
  v_and_b32 v77, v70, v77
  v_and_b32 v78, v69, v78
  v_and_b32 v79, v70, v79
  s_waitcnt vmcnt(12)
  ds_read_b128 v[72:75], v68 offset:256
  v_mfma_f32_16x16x16_bf16 v[16:19], v[76:77], a[216:217], 0
  ds_read_b64_tr_b16 a[192:193], v67 offset:0
  ds_read_b64_tr_b16 a[194:195], v67 offset:768
  v_cvt_pk_bf16_f32 v128, v48, v49
  v_cvt_pk_bf16_f32 v129, v50, v51
  v_mfma_f32_16x16x16_bf16 v[20:23], v[78:79], a[218:219], 0
  ds_read_b64_tr_b16 a[196:197], v67 offset:8
  ds_read_b64_tr_b16 a[198:199], v67 offset:776
  v_cvt_pk_bf16_f32 v130, v52, v53
  v_cvt_pk_bf16_f32 v131, v54, v55
  v_mfma_f32_16x16x16_bf16 v[24:27], v[76:77], a[220:221], 0
  ds_read_b64_tr_b16 a[200:201], v67 offset:64
  ds_read_b64_tr_b16 a[202:203], v67 offset:832
  v_cvt_pk_bf16_f32 v132, v56, v57
  v_cvt_pk_bf16_f32 v133, v58, v59
  v_mfma_f32_16x16x16_bf16 v[28:31], v[78:79], a[222:223], 0
  ds_read_b64_tr_b16 a[204:205], v67 offset:72
  ds_read_b64_tr_b16 a[206:207], v67 offset:840
  v_cvt_pk_bf16_f32 v134, v60, v61
  v_cvt_pk_bf16_f32 v135, v62, v63
  v_mfma_f32_16x16x16_bf16 v[32:35], v[76:77], a[224:225], 0
  ds_read_b64_tr_b16 a[208:209], v67 offset:128
  ds_read_b64_tr_b16 a[210:211], v67 offset:896
  v_cvt_pk_bf16_f32 v16, v16, v17
  v_cvt_pk_bf16_f32 v17, v18, v19
  v_accvgpr_write_b32 a24, v16
  v_accvgpr_write_b32 a25, v17
  v_mfma_f32_16x16x16_bf16 v[36:39], v[78:79], a[226:227], 0
  ds_read_b64_tr_b16 a[212:213], v67 offset:136
  ds_read_b64_tr_b16 a[214:215], v67 offset:904
  v_cvt_pk_bf16_f32 v20, v20, v21
  v_cvt_pk_bf16_f32 v21, v22, v23
  v_accvgpr_write_b32 a26, v20
  v_accvgpr_write_b32 a27, v21
  v_mfma_f32_16x16x16_bf16 v[40:43], v[76:77], a[228:229], 0
  s_add_u32 m0, s49, 73792
  s_add_u32 s50, s43, s48
  v_cvt_pk_bf16_f32 v24, v24, v25
  v_cvt_pk_bf16_f32 v25, v26, v27
  v_accvgpr_write_b32 a28, v24
  v_accvgpr_write_b32 a29, v25
  v_mfma_f32_16x16x16_bf16 v[44:47], v[78:79], a[230:231], 0
  buffer_load_dwordx4 v64, s[12:15], s50 offen offset:0 lds
  buffer_load_dwordx4 v65, s[12:15], s50 offen offset:1024 lds
  v_cvt_pk_bf16_f32 v28, v28, v29
  v_cvt_pk_bf16_f32 v29, v30, v31
  v_accvgpr_write_b32 a30, v28
  v_accvgpr_write_b32 a31, v29
  v_mfma_f32_16x16x16_bf16 v[48:51], v[76:77], a[232:233], 0
  buffer_load_dwordx4 v66, s[12:15], s50 offen offset:2048 lds
  s_add_u32 m0, s49, 76872
  v_cvt_pk_bf16_f32 v32, v32, v33
  v_cvt_pk_bf16_f32 v33, v34, v35
  v_accvgpr_write_b32 a32, v32
  v_accvgpr_write_b32 a33, v33
  v_mfma_f32_16x16x16_bf16 v[52:55], v[78:79], a[234:235], 0
  s_add_u32 s50, s50, 6144
  buffer_load_dwordx4 v64, s[12:15], s50 offen offset:0 lds
  v_cvt_pk_bf16_f32 v36, v36, v37
  v_cvt_pk_bf16_f32 v37, v38, v39
  v_accvgpr_write_b32 a34, v36
  v_accvgpr_write_b32 a35, v37
  v_mfma_f32_16x16x16_bf16 v[56:59], v[76:77], a[236:237], 0
  buffer_load_dwordx4 v65, s[12:15], s50 offen offset:1024 lds
  v_cvt_pk_bf16_f32 v40, v40, v41
  v_cvt_pk_bf16_f32 v41, v42, v43
  v_accvgpr_write_b32 a36, v40
  v_accvgpr_write_b32 a37, v41
  v_mfma_f32_16x16x16_bf16 v[60:63], v[78:79], a[238:239], 0
  buffer_load_dwordx4 v66, s[12:15], s50 offen offset:2048 lds
  v_cvt_pk_bf16_f32 v44, v44, v45
  v_cvt_pk_bf16_f32 v45, v46, v47
  v_accvgpr_write_b32 a38, v44
  v_accvgpr_write_b32 a39, v45
  s_waitcnt lgkmcnt(0)
  v_and_b32 v72, v69, v72
  v_and_b32 v73, v70, v73
  v_and_b32 v74, v69, v74
  v_and_b32 v75, v70, v75
  s_waitcnt vmcnt(12)
  ds_read_b128 v[76:79], v68 offset:320
  v_mfma_f32_16x16x16_bf16 v[16:19], v[72:73], a[192:193], 0
  ds_read_b64_tr_b16 a[216:217], v67 offset:24640
  ds_read_b64_tr_b16 a[218:219], v67 offset:25408
  v_cvt_pk_bf16_f32 v48, v48, v49
  v_cvt_pk_bf16_f32 v49, v50, v51
  v_accvgpr_write_b32 a40, v48
  v_accvgpr_write_b32 a41, v49
  v_mfma_f32_16x16x16_bf16 v[20:23], v[74:75], a[194:195], 0
  ds_read_b64_tr_b16 a[220:221], v67 offset:24648
  ds_read_b64_tr_b16 a[222:223], v67 offset:25416
  v_cvt_pk_bf16_f32 v52, v52, v53
  v_cvt_pk_bf16_f32 v53, v54, v55
  v_accvgpr_write_b32 a42, v52
  v_accvgpr_write_b32 a43, v53
  v_mfma_f32_16x16x16_bf16 v[24:27], v[72:73], a[196:197], 0
  ds_read_b64_tr_b16 a[224:225], v67 offset:24704
  ds_read_b64_tr_b16 a[226:227], v67 offset:25472
  v_cvt_pk_bf16_f32 v56, v56, v57
  v_cvt_pk_bf16_f32 v57, v58, v59
  v_accvgpr_write_b32 a44, v56
  v_accvgpr_write_b32 a45, v57
  v_mfma_f32_16x16x16_bf16 v[28:31], v[74:75], a[198:199], 0
  ds_read_b64_tr_b16 a[228:229], v67 offset:24712
  ds_read_b64_tr_b16 a[230:231], v67 offset:25480
  v_cvt_pk_bf16_f32 v60, v60, v61
  v_cvt_pk_bf16_f32 v61, v62, v63
  v_accvgpr_write_b32 a46, v60
  v_accvgpr_write_b32 a47, v61
  v_mfma_f32_16x16x16_bf16 v[32:35], v[72:73], a[200:201], 0
  ds_read_b64_tr_b16 a[232:233], v67 offset:24768
  ds_read_b64_tr_b16 a[234:235], v67 offset:25536
  v_cvt_pk_bf16_f32 v136, v16, v17
  v_cvt_pk_bf16_f32 v137, v18, v19
  v_mfma_f32_16x16x16_bf16 v[36:39], v[74:75], a[202:203], 0
  ds_read_b64_tr_b16 a[236:237], v67 offset:24776
  ds_read_b64_tr_b16 a[238:239], v67 offset:25544
  v_cvt_pk_bf16_f32 v138, v20, v21
  v_cvt_pk_bf16_f32 v139, v22, v23
  v_mfma_f32_16x16x16_bf16 v[40:43], v[72:73], a[204:205], 0
  s_add_u32 m0, s49, 98560
  s_add_u32 s50, s44, s45
  v_cvt_pk_bf16_f32 v140, v24, v25
  v_cvt_pk_bf16_f32 v141, v26, v27
  v_mfma_f32_16x16x16_bf16 v[44:47], v[74:75], a[206:207], 0
  buffer_load_dwordx4 v64, s[12:15], s50 offen offset:0 lds
  buffer_load_dwordx4 v65, s[12:15], s50 offen offset:1024 lds
  v_cvt_pk_bf16_f32 v142, v28, v29
  v_cvt_pk_bf16_f32 v143, v30, v31
  v_mfma_f32_16x16x16_bf16 v[48:51], v[72:73], a[208:209], 0
  buffer_load_dwordx4 v66, s[12:15], s50 offen offset:2048 lds
  s_add_u32 m0, s49, 101640
  v_cvt_pk_bf16_f32 v144, v32, v33
  v_cvt_pk_bf16_f32 v145, v34, v35
  v_mfma_f32_16x16x16_bf16 v[52:55], v[74:75], a[210:211], 0
  s_add_u32 s50, s50, 6144
  buffer_load_dwordx4 v64, s[12:15], s50 offen offset:0 lds
  v_cvt_pk_bf16_f32 v146, v36, v37
  v_cvt_pk_bf16_f32 v147, v38, v39
  v_mfma_f32_16x16x16_bf16 v[56:59], v[72:73], a[212:213], 0
  buffer_load_dwordx4 v65, s[12:15], s50 offen offset:1024 lds
  v_cvt_pk_bf16_f32 v148, v40, v41
  v_cvt_pk_bf16_f32 v149, v42, v43
  v_mfma_f32_16x16x16_bf16 v[60:63], v[74:75], a[214:215], 0
  buffer_load_dwordx4 v66, s[12:15], s50 offen offset:2048 lds
  v_cvt_pk_bf16_f32 v150, v44, v45
  v_cvt_pk_bf16_f32 v151, v46, v47
  s_waitcnt lgkmcnt(0)
  v_and_b32 v76, v69, v76
  v_and_b32 v77, v70, v77
  v_and_b32 v78, v69, v78
  v_and_b32 v79, v70, v79
  s_waitcnt vmcnt(12)
  ds_read_b128 v[72:75], v68 offset:384
  v_mfma_f32_16x16x16_bf16 v[16:19], v[76:77], a[216:217], 0
  ds_read_b64_tr_b16 a[192:193], v71 offset:0
  ds_read_b64_tr_b16 a[194:195], v71 offset:768
  v_cvt_pk_bf16_f32 v152, v48, v49
  v_cvt_pk_bf16_f32 v153, v50, v51
  v_mfma_f32_16x16x16_bf16 v[20:23], v[78:79], a[218:219], 0
  ds_read_b64_tr_b16 a[196:197], v71 offset:8
  ds_read_b64_tr_b16 a[198:199], v71 offset:776
  v_cvt_pk_bf16_f32 v154, v52, v53
  v_cvt_pk_bf16_f32 v155, v54, v55
  v_mfma_f32_16x16x16_bf16 v[24:27], v[76:77], a[220:221], 0
  ds_read_b64_tr_b16 a[200:201], v71 offset:64
  ds_read_b64_tr_b16 a[202:203], v71 offset:832
  v_cvt_pk_bf16_f32 v156, v56, v57
  v_cvt_pk_bf16_f32 v157, v58, v59
  v_mfma_f32_16x16x16_bf16 v[28:31], v[78:79], a[222:223], 0
  ds_read_b64_tr_b16 a[204:205], v71 offset:72
  ds_read_b64_tr_b16 a[206:207], v71 offset:840
  v_cvt_pk_bf16_f32 v158, v60, v61
  v_cvt_pk_bf16_f32 v159, v62, v63
  v_mfma_f32_16x16x16_bf16 v[32:35], v[76:77], a[224:225], 0
  ds_read_b64_tr_b16 a[208:209], v71 offset:128
  ds_read_b64_tr_b16 a[210:211], v71 offset:896
  v_cvt_pk_bf16_f32 v16, v16, v17
  v_cvt_pk_bf16_f32 v17, v18, v19
  v_accvgpr_write_b32 a48, v16
  v_accvgpr_write_b32 a49, v17
  v_mfma_f32_16x16x16_bf16 v[36:39], v[78:79], a[226:227], 0
  ds_read_b64_tr_b16 a[212:213], v71 offset:136
  ds_read_b64_tr_b16 a[214:215], v71 offset:904
  v_cvt_pk_bf16_f32 v20, v20, v21
  v_cvt_pk_bf16_f32 v21, v22, v23
  v_accvgpr_write_b32 a50, v20
  v_accvgpr_write_b32 a51, v21
  v_mfma_f32_16x16x16_bf16 v[40:43], v[76:77], a[228:229], 0
  s_add_u32 m0, s49, 123200
  s_add_u32 s50, s44, s46
  v_cvt_pk_bf16_f32 v24, v24, v25
  v_cvt_pk_bf16_f32 v25, v26, v27
  v_accvgpr_write_b32 a52, v24
  v_accvgpr_write_b32 a53, v25
  v_mfma_f32_16x16x16_bf16 v[44:47], v[78:79], a[230:231], 0
  buffer_load_dwordx4 v64, s[12:15], s50 offen offset:0 lds
  buffer_load_dwordx4 v65, s[12:15], s50 offen offset:1024 lds
  v_cvt_pk_bf16_f32 v28, v28, v29
  v_cvt_pk_bf16_f32 v29, v30, v31
  v_accvgpr_write_b32 a54, v28
  v_accvgpr_write_b32 a55, v29
  v_mfma_f32_16x16x16_bf16 v[48:51], v[76:77], a[232:233], 0
  buffer_load_dwordx4 v66, s[12:15], s50 offen offset:2048 lds
  s_add_u32 m0, s49, 126280
  v_cvt_pk_bf16_f32 v32, v32, v33
  v_cvt_pk_bf16_f32 v33, v34, v35
  v_accvgpr_write_b32 a56, v32
  v_accvgpr_write_b32 a57, v33
  v_mfma_f32_16x16x16_bf16 v[52:55], v[78:79], a[234:235], 0
  s_add_u32 s50, s50, 6144
  buffer_load_dwordx4 v64, s[12:15], s50 offen offset:0 lds
  v_cvt_pk_bf16_f32 v36, v36, v37
  v_cvt_pk_bf16_f32 v37, v38, v39
  v_accvgpr_write_b32 a58, v36
  v_accvgpr_write_b32 a59, v37
  v_mfma_f32_16x16x16_bf16 v[56:59], v[76:77], a[236:237], 0
  buffer_load_dwordx4 v65, s[12:15], s50 offen offset:1024 lds
  v_cvt_pk_bf16_f32 v40, v40, v41
  v_cvt_pk_bf16_f32 v41, v42, v43
  v_accvgpr_write_b32 a60, v40
  v_accvgpr_write_b32 a61, v41
  v_mfma_f32_16x16x16_bf16 v[60:63], v[78:79], a[238:239], 0
  buffer_load_dwordx4 v66, s[12:15], s50 offen offset:2048 lds
  v_cvt_pk_bf16_f32 v44, v44, v45
  v_cvt_pk_bf16_f32 v45, v46, v47
  v_accvgpr_write_b32 a62, v44
  v_accvgpr_write_b32 a63, v45
  s_waitcnt lgkmcnt(0)
  v_and_b32 v72, v69, v72
  v_and_b32 v73, v70, v73
  v_and_b32 v74, v69, v74
  v_and_b32 v75, v70, v75
  s_waitcnt vmcnt(12)
  ds_read_b128 v[76:79], v68 offset:448
  v_mfma_f32_16x16x16_bf16 v[16:19], v[72:73], a[192:193], 0
  ds_read_b64_tr_b16 a[216:217], v71 offset:24640
  ds_read_b64_tr_b16 a[218:219], v71 offset:25408
  v_cvt_pk_bf16_f32 v48, v48, v49
  v_cvt_pk_bf16_f32 v49, v50, v51
  v_accvgpr_write_b32 a64, v48
  v_accvgpr_write_b32 a65, v49
  v_mfma_f32_16x16x16_bf16 v[20:23], v[74:75], a[194:195], 0
  ds_read_b64_tr_b16 a[220:221], v71 offset:24648
  ds_read_b64_tr_b16 a[222:223], v71 offset:25416
  v_cvt_pk_bf16_f32 v52, v52, v53
  v_cvt_pk_bf16_f32 v53, v54, v55
  v_accvgpr_write_b32 a66, v52
  v_accvgpr_write_b32 a67, v53
  v_mfma_f32_16x16x16_bf16 v[24:27], v[72:73], a[196:197], 0
  ds_read_b64_tr_b16 a[224:225], v71 offset:24704
  ds_read_b64_tr_b16 a[226:227], v71 offset:25472
  v_cvt_pk_bf16_f32 v56, v56, v57
  v_cvt_pk_bf16_f32 v57, v58, v59
  v_accvgpr_write_b32 a68, v56
  v_accvgpr_write_b32 a69, v57
  v_mfma_f32_16x16x16_bf16 v[28:31], v[74:75], a[198:199], 0
  ds_read_b64_tr_b16 a[228:229], v71 offset:24712
  ds_read_b64_tr_b16 a[230:231], v71 offset:25480
  v_cvt_pk_bf16_f32 v60, v60, v61
  v_cvt_pk_bf16_f32 v61, v62, v63
  v_accvgpr_write_b32 a70, v60
  v_accvgpr_write_b32 a71, v61
  v_mfma_f32_16x16x16_bf16 v[32:35], v[72:73], a[200:201], 0
  ds_read_b64_tr_b16 a[232:233], v71 offset:24768
  ds_read_b64_tr_b16 a[234:235], v71 offset:25536
  v_cvt_pk_bf16_f32 v160, v16, v17
  v_cvt_pk_bf16_f32 v161, v18, v19
  v_mfma_f32_16x16x16_bf16 v[36:39], v[74:75], a[202:203], 0
  ds_read_b64_tr_b16 a[236:237], v71 offset:24776
  ds_read_b64_tr_b16 a[238:239], v71 offset:25544
  v_cvt_pk_bf16_f32 v162, v20, v21
  v_cvt_pk_bf16_f32 v163, v22, v23
  v_mfma_f32_16x16x16_bf16 v[40:43], v[72:73], a[204:205], 0
  s_add_u32 m0, s49, 49152
  s_add_u32 s50, s44, s47
  v_cvt_pk_bf16_f32 v164, v24, v25
  v_cvt_pk_bf16_f32 v165, v26, v27
  v_mfma_f32_16x16x16_bf16 v[44:47], v[74:75], a[206:207], 0
  buffer_load_dwordx4 v64, s[12:15], s50 offen offset:0 lds
  buffer_load_dwordx4 v65, s[12:15], s50 offen offset:1024 lds
  v_cvt_pk_bf16_f32 v166, v28, v29
  v_cvt_pk_bf16_f32 v167, v30, v31
  v_mfma_f32_16x16x16_bf16 v[48:51], v[72:73], a[208:209], 0
  buffer_load_dwordx4 v66, s[12:15], s50 offen offset:2048 lds
  s_add_u32 m0, s49, 52232
  v_cvt_pk_bf16_f32 v168, v32, v33
  v_cvt_pk_bf16_f32 v169, v34, v35
  v_mfma_f32_16x16x16_bf16 v[52:55], v[74:75], a[210:211], 0
  s_add_u32 s50, s50, 6144
  buffer_load_dwordx4 v64, s[12:15], s50 offen offset:0 lds
  v_cvt_pk_bf16_f32 v170, v36, v37
  v_cvt_pk_bf16_f32 v171, v38, v39
  v_mfma_f32_16x16x16_bf16 v[56:59], v[72:73], a[212:213], 0
  buffer_load_dwordx4 v65, s[12:15], s50 offen offset:1024 lds
  v_cvt_pk_bf16_f32 v172, v40, v41
  v_cvt_pk_bf16_f32 v173, v42, v43
  v_mfma_f32_16x16x16_bf16 v[60:63], v[74:75], a[214:215], 0
  buffer_load_dwordx4 v66, s[12:15], s50 offen offset:2048 lds
  v_cvt_pk_bf16_f32 v174, v44, v45
  v_cvt_pk_bf16_f32 v175, v46, v47
  s_waitcnt lgkmcnt(0)
  v_and_b32 v76, v69, v76
  v_and_b32 v77, v70, v77
  v_and_b32 v78, v69, v78
  v_and_b32 v79, v70, v79
  s_waitcnt vmcnt(12)
  ds_read_b128 v[72:75], v68 offset:512
  v_mfma_f32_16x16x16_bf16 v[16:19], v[76:77], a[216:217], 0
  ds_read_b64_tr_b16 a[192:193], v67 offset:0
  ds_read_b64_tr_b16 a[194:195], v67 offset:768
  ds_read_b64_tr_b16 a[196:197], v67 offset:8
  ds_read_b64_tr_b16 a[198:199], v67 offset:776
  ds_read_b64_tr_b16 a[200:201], v67 offset:64
  v_cvt_pk_bf16_f32 v176, v48, v49
  v_cvt_pk_bf16_f32 v177, v50, v51
  v_mfma_f32_16x16x16_bf16 v[20:23], v[78:79], a[218:219], 0
  ds_read_b64_tr_b16 a[202:203], v67 offset:832
  ds_read_b64_tr_b16 a[204:205], v67 offset:72
  ds_read_b64_tr_b16 a[206:207], v67 offset:840
  ds_read_b64_tr_b16 a[208:209], v67 offset:128
  ds_read_b64_tr_b16 a[210:211], v67 offset:896
  v_cvt_pk_bf16_f32 v178, v52, v53
  v_cvt_pk_bf16_f32 v179, v54, v55
  v_mfma_f32_16x16x16_bf16 v[24:27], v[76:77], a[220:221], 0
  ds_read_b64_tr_b16 a[212:213], v67 offset:136
  ds_read_b64_tr_b16 a[214:215], v67 offset:904
  s_add_u32 m0, s49, 73792
  s_add_u32 s50, s44, s48
  buffer_load_dwordx4 v64, s[12:15], s50 offen offset:0 lds
  v_cvt_pk_bf16_f32 v180, v56, v57
  v_cvt_pk_bf16_f32 v181, v58, v59
  v_mfma_f32_16x16x16_bf16 v[28:31], v[78:79], a[222:223], 0
  buffer_load_dwordx4 v65, s[12:15], s50 offen offset:1024 lds
  buffer_load_dwordx4 v66, s[12:15], s50 offen offset:2048 lds
  s_add_u32 m0, s49, 76872
  s_add_u32 s50, s50, 6144
  buffer_load_dwordx4 v64, s[12:15], s50 offen offset:0 lds
  v_cvt_pk_bf16_f32 v182, v60, v61
  v_cvt_pk_bf16_f32 v183, v62, v63
  v_mfma_f32_16x16x16_bf16 v[32:35], v[76:77], a[224:225], 0
  buffer_load_dwordx4 v65, s[12:15], s50 offen offset:1024 lds
  buffer_load_dwordx4 v66, s[12:15], s50 offen offset:2048 lds
  s_mov_b64 s[82:83], s[80:81]
  s_mov_b64 s[80:81], s[78:79]
  s_mov_b64 s[78:79], s[76:77]
  v_cvt_pk_bf16_f32 v16, v16, v17
  v_cvt_pk_bf16_f32 v17, v18, v19
  v_accvgpr_write_b32 a72, v16
  v_accvgpr_write_b32 a73, v17
  v_mfma_f32_16x16x16_bf16 v[36:39], v[78:79], a[226:227], 0
  s_add_u32 s76, s33, s32
  s_xor_b32 s76, s76, s34
  s_add_u32 s77, s32, 24576
  s_cmp_lt_u32 s32, s35
  s_cselect_b32 s22, s32, s40
  v_cvt_pk_bf16_f32 v20, v20, v21
  v_cvt_pk_bf16_f32 v21, v22, v23
  v_accvgpr_write_b32 a74, v20
  v_accvgpr_write_b32 a75, v21
  v_mfma_f32_16x16x16_bf16 v[40:43], v[76:77], a[228:229], 0
  s_cselect_b32 s77, s77, s40
  s_bitcmp1_b32 s76, 21
  s_cselect_b32 s76, s77, s22
  s_cselect_b32 s77, s22, s77
  s_cselect_b64 s[56:57], -1, 0
  v_cvt_pk_bf16_f32 v24, v24, v25
  v_cvt_pk_bf16_f32 v25, v26, v27
  v_accvgpr_write_b32 a76, v24
  v_accvgpr_write_b32 a77, v25
  v_mfma_f32_16x16x16_bf16 v[44:47], v[78:79], a[230:231], 0
  s_add_u32 s32, s32, 786432
  s_add_u32 m0, s39, 0
  s_nop 0
  buffer_load_dwordx4 v8, s[4:7], s76 offen nt lds
  v_cvt_pk_bf16_f32 v28, v28, v29
  v_cvt_pk_bf16_f32 v29, v30, v31
  v_accvgpr_write_b32 a78, v28
  v_accvgpr_write_b32 a79, v29
  v_mfma_f32_16x16x16_bf16 v[48:51], v[76:77], a[232:233], 0
  s_add_u32 m0, s39, 4096
  s_nop 0
  buffer_load_dwordx4 v9, s[4:7], s76 offen nt lds
  s_add_u32 m0, s39, 8192
  v_cvt_pk_bf16_f32 v32, v32, v33
  v_cvt_pk_bf16_f32 v33, v34, v35
  v_accvgpr_write_b32 a80, v32
  v_accvgpr_write_b32 a81, v33
  v_mfma_f32_16x16x16_bf16 v[52:55], v[78:79], a[234:235], 0
  s_nop 0
  buffer_load_dwordx4 v10, s[4:7], s76 offen nt lds
  s_add_u32 m0, s39, 12288
  s_nop 0
  v_cvt_pk_bf16_f32 v36, v36, v37
  v_cvt_pk_bf16_f32 v37, v38, v39
  v_accvgpr_write_b32 a82, v36
  v_accvgpr_write_b32 a83, v37
  v_mfma_f32_16x16x16_bf16 v[56:59], v[76:77], a[236:237], 0
  buffer_load_dwordx4 v11, s[4:7], s76 offen nt lds
  v_cndmask_b32 v15, v12, v14, s[56:57]
  s_add_u32 m0, s39, 16384
  s_nop 0
  v_cvt_pk_bf16_f32 v40, v40, v41
  v_cvt_pk_bf16_f32 v41, v42, v43
  v_accvgpr_write_b32 a84, v40
  v_accvgpr_write_b32 a85, v41
  v_mfma_f32_16x16x16_bf16 v[60:63], v[78:79], a[238:239], 0
  buffer_load_dwordx4 v15, s[4:7], s22 offen nt lds
  s_add_u32 m0, s39, 20480
  s_nop 0
  buffer_load_dwordx4 v13, s[4:7], s77 offen nt lds
  v_cvt_pk_bf16_f32 v44, v44, v45
  v_cvt_pk_bf16_f32 v45, v46, v47
  v_accvgpr_write_b32 a86, v44
  v_accvgpr_write_b32 a87, v45
  s_waitcnt lgkmcnt(0)
  v_and_b32 v72, v69, v72
  v_and_b32 v73, v70, v73
  v_and_b32 v74, v69, v74
  v_and_b32 v75, v70, v75
  s_waitcnt vmcnt(18)
  ds_read_b128 v[76:79], v68 offset:576
  v_mfma_f32_16x16x16_bf16 v[16:19], v[72:73], a[192:193], 0
  ds_read_b64_tr_b16 a[216:217], v67 offset:24640
  v_cvt_pk_bf16_f32 v48, v48, v49
  v_cvt_pk_bf16_f32 v49, v50, v51
  v_accvgpr_write_b32 a88, v48
  v_accvgpr_write_b32 a89, v49
  v_mfma_f32_16x16x16_bf16 v[20:23], v[74:75], a[194:195], 0
  ds_read_b64_tr_b16 a[218:219], v67 offset:25408
  v_cvt_pk_bf16_f32 v52, v52, v53
  v_cvt_pk_bf16_f32 v53, v54, v55
  v_accvgpr_write_b32 a90, v52
  v_accvgpr_write_b32 a91, v53
  v_mfma_f32_16x16x16_bf16 v[24:27], v[72:73], a[196:197], 0
  ds_read_b64_tr_b16 a[220:221], v67 offset:24648
  v_cvt_pk_bf16_f32 v56, v56, v57
  v_cvt_pk_bf16_f32 v57, v58, v59
  v_accvgpr_write_b32 a92, v56
  v_accvgpr_write_b32 a93, v57
  v_mfma_f32_16x16x16_bf16 v[28:31], v[74:75], a[198:199], 0
  ds_read_b64_tr_b16 a[222:223], v67 offset:25416
  v_cvt_pk_bf16_f32 v60, v60, v61
  v_cvt_pk_bf16_f32 v61, v62, v63
  v_accvgpr_write_b32 a94, v60
  v_accvgpr_write_b32 a95, v61
  v_mfma_f32_16x16x16_bf16 v[32:35], v[72:73], a[200:201], 0
  ds_read_b64_tr_b16 a[224:225], v67 offset:24704
  v_cvt_pk_bf16_f32 v184, v16, v17
  v_cvt_pk_bf16_f32 v185, v18, v19
  v_mfma_f32_16x16x16_bf16 v[36:39], v[74:75], a[202:203], 0
  ds_read_b64_tr_b16 a[226:227], v67 offset:25472
  v_cvt_pk_bf16_f32 v186, v20, v21
  v_cvt_pk_bf16_f32 v187, v22, v23
  v_mfma_f32_16x16x16_bf16 v[40:43], v[72:73], a[204:205], 0
  ds_read_b64_tr_b16 a[228:229], v67 offset:24712
  v_cvt_pk_bf16_f32 v188, v24, v25
  v_cvt_pk_bf16_f32 v189, v26, v27
  v_mfma_f32_16x16x16_bf16 v[44:47], v[74:75], a[206:207], 0
  ds_read_b64_tr_b16 a[230:231], v67 offset:25480
  v_cvt_pk_bf16_f32 v190, v28, v29
  v_cvt_pk_bf16_f32 v191, v30, v31
  v_mfma_f32_16x16x16_bf16 v[48:51], v[72:73], a[208:209], 0
  ds_read_b64_tr_b16 a[232:233], v67 offset:24768
  v_cvt_pk_bf16_f32 v192, v32, v33
  v_cvt_pk_bf16_f32 v193, v34, v35
  v_mfma_f32_16x16x16_bf16 v[52:55], v[74:75], a[210:211], 0
  ds_read_b64_tr_b16 a[234:235], v67 offset:25536
  v_cvt_pk_bf16_f32 v194, v36, v37
  v_cvt_pk_bf16_f32 v195, v38, v39
  v_mfma_f32_16x16x16_bf16 v[56:59], v[72:73], a[212:213], 0
  ds_read_b64_tr_b16 a[236:237], v67 offset:24776
  v_cvt_pk_bf16_f32 v196, v40, v41
  v_cvt_pk_bf16_f32 v197, v42, v43
  v_mfma_f32_16x16x16_bf16 v[60:63], v[74:75], a[214:215], 0
  ds_read_b64_tr_b16 a[238:239], v67 offset:25544
  v_cvt_pk_bf16_f32 v198, v44, v45
  v_cvt_pk_bf16_f32 v199, v46, v47
  s_waitcnt lgkmcnt(0)
  v_and_b32 v76, v69, v76
  v_and_b32 v77, v70, v77
  v_and_b32 v78, v69, v78
  v_and_b32 v79, v70, v79
  s_waitcnt vmcnt(12)
  ds_read_b128 v[72:75], v68 offset:640
  v_mfma_f32_16x16x16_bf16 v[16:19], v[76:77], a[216:217], 0
  ds_read_b64_tr_b16 a[192:193], v71 offset:0
  ds_read_b64_tr_b16 a[194:195], v71 offset:768
  v_cvt_pk_bf16_f32 v200, v48, v49
  v_cvt_pk_bf16_f32 v201, v50, v51
  v_mfma_f32_16x16x16_bf16 v[20:23], v[78:79], a[218:219], 0
  ds_read_b64_tr_b16 a[196:197], v71 offset:8
  v_cvt_pk_bf16_f32 v202, v52, v53
  v_cvt_pk_bf16_f32 v203, v54, v55
  v_mfma_f32_16x16x16_bf16 v[24:27], v[76:77], a[220:221], 0
  ds_read_b64_tr_b16 a[198:199], v71 offset:776
  v_cvt_pk_bf16_f32 v204, v56, v57
  v_cvt_pk_bf16_f32 v205, v58, v59
  v_mfma_f32_16x16x16_bf16 v[28:31], v[78:79], a[222:223], 0
  ds_read_b64_tr_b16 a[200:201], v71 offset:64
  v_cvt_pk_bf16_f32 v206, v60, v61
  v_cvt_pk_bf16_f32 v207, v62, v63
  v_mfma_f32_16x16x16_bf16 v[32:35], v[76:77], a[224:225], 0
  ds_read_b64_tr_b16 a[202:203], v71 offset:832
  v_cvt_pk_bf16_f32 v16, v16, v17
  v_cvt_pk_bf16_f32 v17, v18, v19
  v_accvgpr_write_b32 a96, v16
  v_accvgpr_write_b32 a97, v17
  v_mfma_f32_16x16x16_bf16 v[36:39], v[78:79], a[226:227], 0
  ds_read_b64_tr_b16 a[204:205], v71 offset:72
  v_cvt_pk_bf16_f32 v20, v20, v21
  v_cvt_pk_bf16_f32 v21, v22, v23
  v_accvgpr_write_b32 a98, v20
  v_accvgpr_write_b32 a99, v21
  v_mfma_f32_16x16x16_bf16 v[40:43], v[76:77], a[228:229], 0
  ds_read_b64_tr_b16 a[206:207], v71 offset:840
  v_cvt_pk_bf16_f32 v24, v24, v25
  v_cvt_pk_bf16_f32 v25, v26, v27
  v_accvgpr_write_b32 a100, v24
  v_accvgpr_write_b32 a101, v25
  v_mfma_f32_16x16x16_bf16 v[44:47], v[78:79], a[230:231], 0
  ds_read_b64_tr_b16 a[208:209], v71 offset:128
  v_cvt_pk_bf16_f32 v28, v28, v29
  v_cvt_pk_bf16_f32 v29, v30, v31
  v_accvgpr_write_b32 a102, v28
  v_accvgpr_write_b32 a103, v29
  v_mfma_f32_16x16x16_bf16 v[48:51], v[76:77], a[232:233], 0
  ds_read_b64_tr_b16 a[210:211], v71 offset:896
  v_cvt_pk_bf16_f32 v32, v32, v33
  v_cvt_pk_bf16_f32 v33, v34, v35
  v_accvgpr_write_b32 a104, v32
  v_accvgpr_write_b32 a105, v33
  v_mfma_f32_16x16x16_bf16 v[52:55], v[78:79], a[234:235], 0
  ds_read_b64_tr_b16 a[212:213], v71 offset:136
  v_cvt_pk_bf16_f32 v36, v36, v37
  v_cvt_pk_bf16_f32 v37, v38, v39
  v_accvgpr_write_b32 a106, v36
  v_accvgpr_write_b32 a107, v37
  v_mfma_f32_16x16x16_bf16 v[56:59], v[76:77], a[236:237], 0
  ds_read_b64_tr_b16 a[214:215], v71 offset:904
  v_cvt_pk_bf16_f32 v40, v40, v41
  v_cvt_pk_bf16_f32 v41, v42, v43
  v_accvgpr_write_b32 a108, v40
  v_accvgpr_write_b32 a109, v41
  v_mfma_f32_16x16x16_bf16 v[60:63], v[78:79], a[238:239], 0
  s_load_dword s95, s[92:93], s36
  v_cvt_pk_bf16_f32 v44, v44, v45
  v_cvt_pk_bf16_f32 v45, v46, v47
  v_accvgpr_write_b32 a110, v44
  v_accvgpr_write_b32 a111, v45
  s_waitcnt lgkmcnt(0)
  v_and_b32 v72, v69, v72
  v_and_b32 v73, v70, v73
  v_and_b32 v74, v69, v74
  v_and_b32 v75, v70, v75
  s_cmp_eq_u32 s95, 0
  s_cbranch_scc1 L_slow
L_back:
  s_lshr_b32 s51, s2, 1
  s_xor_b32 s34, s95, s51
  s_and_b32 s34, s34, 2
  s_lshl_b32 s34, s34, 20
  s_waitcnt vmcnt(6)
  ds_read_b128 v[76:79], v68 offset:704
  v_mfma_f32_16x16x16_bf16 v[16:19], v[72:73], a[192:193], 0
  ds_read_b64_tr_b16 a[216:217], v71 offset:24640
  v_cvt_pk_bf16_f32 v48, v48, v49
  v_cvt_pk_bf16_f32 v49, v50, v51
  v_accvgpr_write_b32 a112, v48
  v_accvgpr_write_b32 a113, v49
  v_mfma_f32_16x16x16_bf16 v[20:23], v[74:75], a[194:195], 0
  ds_read_b64_tr_b16 a[218:219], v71 offset:25408
  v_cvt_pk_bf16_f32 v52, v52, v53
  v_cvt_pk_bf16_f32 v53, v54, v55
  v_accvgpr_write_b32 a114, v52
  v_accvgpr_write_b32 a115, v53
  v_mfma_f32_16x16x16_bf16 v[24:27], v[72:73], a[196:197], 0
  ds_read_b64_tr_b16 a[220:221], v71 offset:24648
  v_cvt_pk_bf16_f32 v56, v56, v57
  v_cvt_pk_bf16_f32 v57, v58, v59
  v_accvgpr_write_b32 a116, v56
  v_accvgpr_write_b32 a117, v57
  v_mfma_f32_16x16x16_bf16 v[28:31], v[74:75], a[198:199], 0
  ds_read_b64_tr_b16 a[222:223], v71 offset:25416
  v_cvt_pk_bf16_f32 v60, v60, v61
  v_cvt_pk_bf16_f32 v61, v62, v63
  v_accvgpr_write_b32 a118, v60
  v_accvgpr_write_b32 a119, v61
  v_mfma_f32_16x16x16_bf16 v[32:35], v[72:73], a[200:201], 0
  ds_read_b64_tr_b16 a[224:225], v71 offset:24704
  v_cvt_pk_bf16_f32 v208, v16, v17
  v_cvt_pk_bf16_f32 v209, v18, v19
  v_mfma_f32_16x16x16_bf16 v[36:39], v[74:75], a[202:203], 0
  ds_read_b64_tr_b16 a[226:227], v71 offset:25472
  v_cvt_pk_bf16_f32 v210, v20, v21
  v_cvt_pk_bf16_f32 v211, v22, v23
  v_mfma_f32_16x16x16_bf16 v[40:43], v[72:73], a[204:205], 0
  ds_read_b64_tr_b16 a[228:229], v71 offset:24712
  v_cvt_pk_bf16_f32 v212, v24, v25
  v_cvt_pk_bf16_f32 v213, v26, v27
  v_mfma_f32_16x16x16_bf16 v[44:47], v[74:75], a[206:207], 0
  ds_read_b64_tr_b16 a[230:231], v71 offset:25480
  v_cvt_pk_bf16_f32 v214, v28, v29
  v_cvt_pk_bf16_f32 v215, v30, v31
  v_mfma_f32_16x16x16_bf16 v[48:51], v[72:73], a[208:209], 0
  ds_read_b64_tr_b16 a[232:233], v71 offset:24768
  v_cvt_pk_bf16_f32 v216, v32, v33
  v_cvt_pk_bf16_f32 v217, v34, v35
  v_mfma_f32_16x16x16_bf16 v[52:55], v[74:75], a[210:211], 0
  ds_read_b64_tr_b16 a[234:235], v71 offset:25536
  v_cvt_pk_bf16_f32 v218, v36, v37
  v_cvt_pk_bf16_f32 v219, v38, v39
  v_mfma_f32_16x16x16_bf16 v[56:59], v[72:73], a[212:213], 0
  ds_read_b64_tr_b16 a[236:237], v71 offset:24776
  v_cvt_pk_bf16_f32 v220, v40, v41
  v_cvt_pk_bf16_f32 v221, v42, v43
  v_mfma_f32_16x16x16_bf16 v[60:63], v[74:75], a[214:215], 0
  ds_read_b64_tr_b16 a[238:239], v71 offset:25544
  v_cvt_pk_bf16_f32 v222, v44, v45
  v_cvt_pk_bf16_f32 v223, v46, v47
  s_waitcnt lgkmcnt(0)
  v_and_b32 v76, v69, v76
  v_and_b32 v77, v70, v77
  v_and_b32 v78, v69, v78
  v_and_b32 v79, v70, v79
  s_mov_b64 s[82:83], s[80:81]
  s_mov_b64 s[80:81], s[78:79]
  v_mfma_f32_16x16x16_bf16 v[16:19], v[76:77], a[216:217], 0
  s_mov_b64 s[78:79], s[76:77]
  s_add_u32 s76, s33, s32
  s_xor_b32 s76, s76, s34
  v_cvt_pk_bf16_f32 v224, v48, v49
  v_cvt_pk_bf16_f32 v225, v50, v51
  v_mfma_f32_16x16x16_bf16 v[20:23], v[78:79], a[218:219], 0
  s_add_u32 s77, s32, 24576
  s_cmp_lt_u32 s32, s35
  s_cselect_b32 s22, s32, s40
  v_cvt_pk_bf16_f32 v226, v52, v53
  v_cvt_pk_bf16_f32 v227, v54, v55
  v_mfma_f32_16x16x16_bf16 v[24:27], v[76:77], a[220:221], 0
  s_cselect_b32 s77, s77, s40
  s_bitcmp1_b32 s76, 21
  s_cselect_b32 s76, s77, s22
  v_cvt_pk_bf16_f32 v228, v56, v57
  v_cvt_pk_bf16_f32 v229, v58, v59
  v_mfma_f32_16x16x16_bf16 v[28:31], v[78:79], a[222:223], 0
  s_cselect_b32 s77, s22, s77
  s_cselect_b64 s[56:57], -1, 0
  s_add_u32 s32, s32, 786432
  v_cvt_pk_bf16_f32 v230, v60, v61
  v_cvt_pk_bf16_f32 v231, v62, v63
  v_mfma_f32_16x16x16_bf16 v[32:35], v[76:77], a[224:225], 0
  s_add_u32 m0, s39, 24576
  s_nop 0
  buffer_load_dwordx4 v8, s[4:7], s76 offen nt lds
  v_cvt_pk_bf16_f32 v232, v16, v17
  v_cvt_pk_bf16_f32 v233, v18, v19
  v_mfma_f32_16x16x16_bf16 v[36:39], v[78:79], a[226:227], 0
  s_add_u32 m0, s39, 28672
  s_nop 0
  buffer_load_dwordx4 v9, s[4:7], s76 offen nt lds
  v_cvt_pk_bf16_f32 v234, v20, v21
  v_cvt_pk_bf16_f32 v235, v22, v23
  v_mfma_f32_16x16x16_bf16 v[40:43], v[76:77], a[228:229], 0
  s_add_u32 m0, s39, 32768
  s_nop 0
  buffer_load_dwordx4 v10, s[4:7], s76 offen nt lds
  v_cvt_pk_bf16_f32 v236, v24, v25
  v_cvt_pk_bf16_f32 v237, v26, v27
  v_mfma_f32_16x16x16_bf16 v[44:47], v[78:79], a[230:231], 0
  s_add_u32 m0, s39, 36864
  s_nop 0
  v_cvt_pk_bf16_f32 v238, v28, v29
  v_cvt_pk_bf16_f32 v239, v30, v31
  v_mfma_f32_16x16x16_bf16 v[48:51], v[76:77], a[232:233], 0
  buffer_load_dwordx4 v11, s[4:7], s76 offen nt lds
  v_cndmask_b32 v15, v12, v14, s[56:57]
  v_cvt_pk_bf16_f32 v240, v32, v33
  v_cvt_pk_bf16_f32 v241, v34, v35
  v_mfma_f32_16x16x16_bf16 v[52:55], v[78:79], a[234:235], 0
  s_add_u32 m0, s39, 40960
  s_nop 0
  v_cvt_pk_bf16_f32 v242, v36, v37
  v_cvt_pk_bf16_f32 v243, v38, v39
  v_mfma_f32_16x16x16_bf16 v[56:59], v[76:77], a[236:237], 0
  buffer_load_dwordx4 v15, s[4:7], s22 offen nt lds
  s_add_u32 m0, s39, 45056
  v_cvt_pk_bf16_f32 v244, v40, v41
  v_cvt_pk_bf16_f32 v245, v42, v43
  v_mfma_f32_16x16x16_bf16 v[60:63], v[78:79], a[238:239], 0
  s_xor_b32 s39, s39, 49152
  buffer_load_dwordx4 v13, s[4:7], s77 offen nt lds
  v_cvt_pk_bf16_f32 v246, v44, v45
  v_cvt_pk_bf16_f32 v247, v46, v47
  v_cvt_pk_bf16_f32 v248, v48, v49
  v_cvt_pk_bf16_f32 v249, v50, v51
  v_cvt_pk_bf16_f32 v250, v52, v53
  v_cvt_pk_bf16_f32 v251, v54, v55
  v_sub_u32 v64, v14, v12
  v_add_u32 v64, v64, v84
  s_mov_b32 s58, s40
  s_mov_b32 s59, s40
  s_mov_b32 s62, s40
  s_mov_b32 s63, s40
  s_waitcnt vmcnt(6)
  s_barrier
  ds_read_b128 a[144:147], v1 offset:0
  ds_read_b128 a[148:151], v2 offset:0
  ds_read_b128 a[152:155], v3 offset:0
  ds_read_b128 a[156:159], v4 offset:0
  v_cvt_pk_bf16_f32 v252, v56, v57
  v_cvt_pk_bf16_f32 v253, v58, v59
  v_cvt_pk_bf16_f32 v254, v60, v61
  v_cvt_pk_bf16_f32 v255, v62, v63
L_loop:
  s_waitcnt lgkmcnt(2)
  v_mfma_f32_16x16x32_bf16 v[16:19], v[88:91], a[144:147], 0
  ds_read_b128 a[160:163], v1 offset:256
  v_mfma_f32_16x16x32_bf16 v[16:19], a[0:3], a[148:151], v[16:19]
  ds_read_b128 a[164:167], v2 offset:256
  v_mfma_f32_16x16x32_bf16 v[20:23], v[92:95], a[144:147], 0
  v_mfma_f32_16x16x32_bf16 v[20:23], a[4:7], a[148:151], v[20:23]
  v_cvt_pk_bf16_f32 v40, v40, v41
  v_mfma_f32_16x16x32_bf16 v[24:27], v[96:99], a[144:147], 0
  v_cvt_pk_bf16_f32 v41, v42, v43
  v_mfma_f32_16x16x32_bf16 v[24:27], a[8:11], a[148:151], v[24:27]
  v_cvt_pk_bf16_f32 v42, v44, v45
  v_mfma_f32_16x16x32_bf16 v[28:31], v[100:103], a[144:147], 0
  buffer_store_dwordx4 a[188:191], v85, s[8:11], s63 offen sc1
  v_mfma_f32_16x16x32_bf16 v[28:31], a[12:15], a[148:151], v[28:31]
  v_cvt_pk_bf16_f32 v43, v46, v47
  v_mfma_f32_16x16x32_bf16 v[32:35], v[104:107], a[144:147], 0
  ds_write_b128 v86, v[40:43] offset:12288
  v_mfma_f32_16x16x32_bf16 v[32:35], a[16:19], a[148:151], v[32:35]
  v_mfma_f32_16x16x32_bf16 v[36:39], v[108:111], a[144:147], 0
  v_mfma_f32_16x16x32_bf16 v[36:39], a[20:23], a[148:151], v[36:39]
  s_waitcnt lgkmcnt(3)
  v_mfma_f32_16x16x32_bf16 v[16:19], v[112:115], a[152:155], v[16:19]
  ds_read_b128 a[144:147], v3 offset:256
  v_mfma_f32_16x16x32_bf16 v[16:19], a[24:27], a[156:159], v[16:19]
  ds_read_b128 a[148:151], v4 offset:256
  v_mfma_f32_16x16x32_bf16 v[20:23], v[116:119], a[152:155], v[20:23]
  v_mfma_f32_16x16x32_bf16 v[20:23], a[28:31], a[156:159], v[20:23]
  v_cvt_pk_bf16_f32 v48, v48, v49
  v_mfma_f32_16x16x32_bf16 v[24:27], v[120:123], a[152:155], v[24:27]
  buffer_store_dwordx4 a[168:171], v80, s[8:11], s58 offen sc1
  v_mfma_f32_16x16x32_bf16 v[24:27], a[32:35], a[156:159], v[24:27]
  v_cvt_pk_bf16_f32 v49, v50, v51
  v_mfma_f32_16x16x32_bf16 v[28:31], v[124:127], a[152:155], v[28:31]
  v_cvt_pk_bf16_f32 v50, v52, v53
  v_mfma_f32_16x16x32_bf16 v[28:31], a[36:39], a[156:159], v[28:31]
  v_cvt_pk_bf16_f32 v51, v54, v55
  v_mfma_f32_16x16x32_bf16 v[32:35], v[128:131], a[152:155], v[32:35]
  ds_write_b128 v87, v[48:51] offset:12288
  v_mfma_f32_16x16x32_bf16 v[32:35], a[40:43], a[156:159], v[32:35]
  v_mfma_f32_16x16x32_bf16 v[36:39], v[132:135], a[152:155], v[36:39]
  v_mfma_f32_16x16x32_bf16 v[36:39], a[44:47], a[156:159], v[36:39]
  s_waitcnt lgkmcnt(4)
  v_mfma_f32_16x16x32_bf16 v[16:19], v[136:139], a[160:163], v[16:19]
  ds_read_b128 a[152:155], v1 offset:512
  v_mfma_f32_16x16x32_bf16 v[16:19], a[48:51], a[164:167], v[16:19]
  ds_read_b128 a[156:159], v2 offset:512
  v_mfma_f32_16x16x32_bf16 v[20:23], v[140:143], a[160:163], v[20:23]
  v_mfma_f32_16x16x32_bf16 v[20:23], a[52:55], a[164:167], v[20:23]
  v_mfma_f32_16x16x32_bf16 v[24:27], v[144:147], a[160:163], v[24:27]
  buffer_store_dwordx4 a[172:175], v81, s[8:11], s58 offen sc1
  v_mfma_f32_16x16x32_bf16 v[24:27], a[56:59], a[164:167], v[24:27]
  v_mfma_f32_16x16x32_bf16 v[28:31], v[148:151], a[160:163], v[28:31]
  v_mfma_f32_16x16x32_bf16 v[28:31], a[60:63], a[164:167], v[28:31]
  v_mfma_f32_16x16x32_bf16 v[32:35], v[152:155], a[160:163], v[32:35]
  v_mfma_f32_16x16x32_bf16 v[32:35], a[64:67], a[164:167], v[32:35]
  v_mfma_f32_16x16x32_bf16 v[36:39], v[156:159], a[160:163], v[36:39]
  v_mfma_f32_16x16x32_bf16 v[36:39], a[68:71], a[164:167], v[36:39]
  s_waitcnt lgkmcnt(3)
  v_mfma_f32_16x16x32_bf16 v[16:19], v[160:163], a[144:147], v[16:19]
  ds_read_b128 a[160:163], v3 offset:512
  v_mfma_f32_16x16x32_bf16 v[16:19], a[72:75], a[148:151], v[16:19]
  ds_read_b128 a[164:167], v4 offset:512
  v_mfma_f32_16x16x32_bf16 v[20:23], v[164:167], a[144:147], v[20:23]
  v_cvt_pk_bf16_f32 v56, v56, v57
  v_mfma_f32_16x16x32_bf16 v[20:23], a[76:79], a[148:151], v[20:23]
  v_cvt_pk_bf16_f32 v57, v58, v59
  v_mfma_f32_16x16x32_bf16 v[24:27], v[168:171], a[144:147], v[24:27]
  buffer_store_dwordx4 a[176:179], v82, s[8:11], s58 offen sc1
  v_mfma_f32_16x16x32_bf16 v[24:27], a[80:83], a[148:151], v[24:27]
  s_mov_b64 s[82:83], s[80:81]
  v_cvt_pk_bf16_f32 v58, v60, v61
  v_mfma_f32_16x16x32_bf16 v[28:31], v[172:175], a[144:147], v[28:31]
  s_mov_b64 s[80:81], s[78:79]
  v_cvt_pk_bf16_f32 v59, v62, v63
  v_mfma_f32_16x16x32_bf16 v[28:31], a[84:87], a[148:151], v[28:31]
  ds_write_b128 v86, v[56:59] offset:12416
  v_mfma_f32_16x16x32_bf16 v[32:35], v[176:179], a[144:147], v[32:35]
  s_mov_b64 s[78:79], s[76:77]
  s_add_u32 s76, s33, s32
  v_mfma_f32_16x16x32_bf16 v[32:35], a[88:91], a[148:151], v[32:35]
  s_xor_b32 s76, s76, s34
  s_add_u32 s77, s32, 24576
  v_mfma_f32_16x16x32_bf16 v[36:39], v[180:183], a[144:147], v[36:39]
  s_cmp_lt_u32 s32, s35
  s_cselect_b32 s22, s32, s40
  v_mfma_f32_16x16x32_bf16 v[36:39], a[92:95], a[148:151], v[36:39]
  s_cselect_b32 s77, s77, s40
  s_waitcnt lgkmcnt(3)
  v_mfma_f32_16x16x32_bf16 v[16:19], v[184:187], a[152:155], v[16:19]
  ds_read_b128 a[144:147], v1 offset:12288
  s_bitcmp1_b32 s76, 21
  v_mfma_f32_16x16x32_bf16 v[16:19], a[96:99], a[156:159], v[16:19]
  ds_read_b128 a[148:151], v2 offset:12288
  s_cselect_b32 s76, s77, s22
  v_mfma_f32_16x16x32_bf16 v[20:23], v[188:191], a[152:155], v[20:23]
  s_cselect_b32 s77, s22, s77
  s_cselect_b64 s[56:57], -1, 0
  v_mfma_f32_16x16x32_bf16 v[20:23], a[100:103], a[156:159], v[20:23]
  s_add_u32 s32, s32, 786432
  s_add_u32 m0, s39, 0
  v_mfma_f32_16x16x32_bf16 v[24:27], v[192:195], a[152:155], v[24:27]
  buffer_load_dwordx4 v8, s[4:7], s76 offen nt lds
  v_mfma_f32_16x16x32_bf16 v[24:27], a[104:107], a[156:159], v[24:27]
  s_mov_b32 s58, s80
  s_mov_b32 s59, s82
  v_mfma_f32_16x16x32_bf16 v[28:31], v[196:199], a[152:155], v[28:31]
  s_mov_b32 s63, s83
  s_min_u32 s62, s82, s83
  v_mfma_f32_16x16x32_bf16 v[28:31], a[108:111], a[156:159], v[28:31]
  s_cmp_gt_u32 s82, s83
  s_cselect_b64 s[90:91], -1, 0
  v_mfma_f32_16x16x32_bf16 v[32:35], v[200:203], a[152:155], v[32:35]
  v_cndmask_b32 v65, v84, v64, s[90:91]
  v_mfma_f32_16x16x32_bf16 v[32:35], a[112:115], a[156:159], v[32:35]
  v_mfma_f32_16x16x32_bf16 v[36:39], v[204:207], a[152:155], v[36:39]
  v_mfma_f32_16x16x32_bf16 v[36:39], a[116:119], a[156:159], v[36:39]
  s_waitcnt lgkmcnt(3)
  v_mfma_f32_16x16x32_bf16 v[16:19], v[208:211], a[160:163], v[16:19]
  ds_read_b128 a[152:155], v3 offset:12288
  v_mfma_f32_16x16x32_bf16 v[16:19], v[232:235], a[164:167], v[16:19]
  ds_read_b128 a[156:159], v4 offset:12288
  v_mfma_f32_16x16x32_bf16 v[20:23], v[212:215], a[160:163], v[20:23]
  v_mfma_f32_16x16x32_bf16 v[20:23], v[236:239], a[164:167], v[20:23]
  s_add_u32 m0, s39, 4096
  v_mfma_f32_16x16x32_bf16 v[24:27], v[216:219], a[160:163], v[24:27]
  buffer_load_dwordx4 v9, s[4:7], s76 offen nt lds
  v_mfma_f32_16x16x32_bf16 v[24:27], v[240:243], a[164:167], v[24:27]
  v_mfma_f32_16x16x32_bf16 v[28:31], v[220:223], a[160:163], v[28:31]
  v_mfma_f32_16x16x32_bf16 v[28:31], v[244:247], a[164:167], v[28:31]
  v_mfma_f32_16x16x32_bf16 v[32:35], v[224:227], a[160:163], v[32:35]
  v_mfma_f32_16x16x32_bf16 v[32:35], v[248:251], a[164:167], v[32:35]
  v_mfma_f32_16x16x32_bf16 v[36:39], v[228:231], a[160:163], v[36:39]
  v_mfma_f32_16x16x32_bf16 v[36:39], v[252:255], a[164:167], v[36:39]
  s_waitcnt lgkmcnt(2)
  v_mfma_f32_16x16x32_bf16 v[40:43], v[88:91], a[144:147], 0
  ds_read_b128 a[160:163], v1 offset:12544
  v_mfma_f32_16x16x32_bf16 v[40:43], a[0:3], a[148:151], v[40:43]
  ds_read_b128 a[164:167], v2 offset:12544
  v_mfma_f32_16x16x32_bf16 v[44:47], v[92:95], a[144:147], 0
  s_add_u32 m0, s39, 8192
  v_mfma_f32_16x16x32_bf16 v[44:47], a[4:7], a[148:151], v[44:47]
  v_cvt_pk_bf16_f32 v16, v16, v17
  v_mfma_f32_16x16x32_bf16 v[48:51], v[96:99], a[144:147], 0
  buffer_load_dwordx4 v10, s[4:7], s76 offen nt lds
  v_mfma_f32_16x16x32_bf16 v[48:51], a[8:11], a[148:151], v[48:51]
  v_cvt_pk_bf16_f32 v17, v18, v19
  v_mfma_f32_16x16x32_bf16 v[52:55], v[100:103], a[144:147], 0
  v_cvt_pk_bf16_f32 v18, v20, v21
  v_mfma_f32_16x16x32_bf16 v[52:55], a[12:15], a[148:151], v[52:55]
  v_cvt_pk_bf16_f32 v19, v22, v23
  v_mfma_f32_16x16x32_bf16 v[56:59], v[104:107], a[144:147], 0
  ds_write_b128 v86, v[16:19] offset:0
  v_mfma_f32_16x16x32_bf16 v[56:59], a[16:19], a[148:151], v[56:59]
  s_add_u32 m0, s39, 12288
  v_mfma_f32_16x16x32_bf16 v[60:63], v[108:111], a[144:147], 0
  v_cvt_pk_bf16_f32 v24, v24, v25
  v_mfma_f32_16x16x32_bf16 v[60:63], a[20:23], a[148:151], v[60:63]
  s_waitcnt lgkmcnt(3)
  v_mfma_f32_16x16x32_bf16 v[40:43], v[112:115], a[152:155], v[40:43]
  ds_read_b128 a[144:147], v3 offset:12544
  v_mfma_f32_16x16x32_bf16 v[40:43], a[24:27], a[156:159], v[40:43]
  ds_read_b128 a[148:151], v4 offset:12544
  v_mfma_f32_16x16x32_bf16 v[44:47], v[116:119], a[152:155], v[44:47]
  v_cvt_pk_bf16_f32 v25, v26, v27
  v_mfma_f32_16x16x32_bf16 v[44:47], a[28:31], a[156:159], v[44:47]
  v_cvt_pk_bf16_f32 v26, v28, v29
  v_mfma_f32_16x16x32_bf16 v[48:51], v[120:123], a[152:155], v[48:51]
  buffer_load_dwordx4 v11, s[4:7], s76 offen nt lds
  v_mfma_f32_16x16x32_bf16 v[48:51], a[32:35], a[156:159], v[48:51]
  v_cvt_pk_bf16_f32 v27, v30, v31
  v_mfma_f32_16x16x32_bf16 v[52:55], v[124:127], a[152:155], v[52:55]
  ds_write_b128 v87, v[24:27] offset:0
  v_mfma_f32_16x16x32_bf16 v[52:55], a[36:39], a[156:159], v[52:55]
  v_mfma_f32_16x16x32_bf16 v[56:59], v[128:131], a[152:155], v[56:59]
  v_mfma_f32_16x16x32_bf16 v[56:59], a[40:43], a[156:159], v[56:59]
  v_mfma_f32_16x16x32_bf16 v[60:63], v[132:135], a[152:155], v[60:63]
  v_cndmask_b32 v15, v12, v14, s[56:57]
  v_mfma_f32_16x16x32_bf16 v[60:63], a[44:47], a[156:159], v[60:63]
  s_waitcnt lgkmcnt(4)
  v_mfma_f32_16x16x32_bf16 v[40:43], v[136:139], a[160:163], v[40:43]
  ds_read_b128 a[152:155], v1 offset:12800
  v_mfma_f32_16x16x32_bf16 v[40:43], a[48:51], a[164:167], v[40:43]
  ds_read_b128 a[156:159], v2 offset:12800
  v_mfma_f32_16x16x32_bf16 v[44:47], v[140:143], a[160:163], v[44:47]
  s_add_u32 m0, s39, 16384
  v_mfma_f32_16x16x32_bf16 v[44:47], a[52:55], a[164:167], v[44:47]
  v_cvt_pk_bf16_f32 v32, v32, v33
  v_mfma_f32_16x16x32_bf16 v[48:51], v[144:147], a[160:163], v[48:51]
  buffer_load_dwordx4 v15, s[4:7], s22 offen nt lds
  v_mfma_f32_16x16x32_bf16 v[48:51], a[56:59], a[164:167], v[48:51]
  v_cvt_pk_bf16_f32 v33, v34, v35
  v_mfma_f32_16x16x32_bf16 v[52:55], v[148:151], a[160:163], v[52:55]
  v_cvt_pk_bf16_f32 v34, v36, v37
  v_mfma_f32_16x16x32_bf16 v[52:55], a[60:63], a[164:167], v[52:55]
  v_cvt_pk_bf16_f32 v35, v38, v39
  v_mfma_f32_16x16x32_bf16 v[56:59], v[152:155], a[160:163], v[56:59]
  ds_write_b128 v86, v[32:35] offset:128
  v_mfma_f32_16x16x32_bf16 v[56:59], a[64:67], a[164:167], v[56:59]
  v_mfma_f32_16x16x32_bf16 v[60:63], v[156:159], a[160:163], v[60:63]
  v_mfma_f32_16x16x32_bf16 v[60:63], a[68:71], a[164:167], v[60:63]
  s_waitcnt lgkmcnt(4)
  v_mfma_f32_16x16x32_bf16 v[40:43], v[160:163], a[144:147], v[40:43]
  ds_read_b128 a[160:163], v3 offset:12800
  v_mfma_f32_16x16x32_bf16 v[40:43], a[72:75], a[148:151], v[40:43]
  ds_read_b128 a[164:167], v4 offset:12800
  v_mfma_f32_16x16x32_bf16 v[44:47], v[164:167], a[144:147], v[44:47]
  v_mfma_f32_16x16x32_bf16 v[44:47], a[76:79], a[148:151], v[44:47]
  s_add_u32 m0, s39, 20480
  v_mfma_f32_16x16x32_bf16 v[48:51], v[168:171], a[144:147], v[48:51]
  buffer_load_dwordx4 v13, s[4:7], s77 offen nt lds
  v_mfma_f32_16x16x32_bf16 v[48:51], a[80:83], a[148:151], v[48:51]
  v_mfma_f32_16x16x32_bf16 v[52:55], v[172:175], a[144:147], v[52:55]
  v_mfma_f32_16x16x32_bf16 v[52:55], a[84:87], a[148:151], v[52:55]
  v_mfma_f32_16x16x32_bf16 v[56:59], v[176:179], a[144:147], v[56:59]
  v_mfma_f32_16x16x32_bf16 v[56:59], a[88:91], a[148:151], v[56:59]
  v_mfma_f32_16x16x32_bf16 v[60:63], v[180:183], a[144:147], v[60:63]
  v_mfma_f32_16x16x32_bf16 v[60:63], a[92:95], a[148:151], v[60:63]
  s_waitcnt vmcnt(10) lgkmcnt(2)
L_ent:
  s_barrier
  s_waitcnt lgkmcnt(3)
  v_mfma_f32_16x16x32_bf16 v[40:43], v[184:187], a[152:155], v[40:43]
  ds_read_b128 a[144:147], v1 offset:24576
  v_mfma_f32_16x16x32_bf16 v[40:43], a[96:99], a[156:159], v[40:43]
  ds_read_b128 a[148:151], v2 offset:24576
  v_mfma_f32_16x16x32_bf16 v[44:47], v[188:191], a[152:155], v[44:47]
  ds_read_b128 a[180:183], v5 offset:12288
  v_mfma_f32_16x16x32_bf16 v[44:47], a[100:103], a[156:159], v[44:47]
  ds_read_b128 a[184:187], v6 offset:12288
  v_mfma_f32_16x16x32_bf16 v[48:51], v[192:195], a[152:155], v[48:51]
  ds_read_b128 a[188:191], v7 offset:12288
  v_mfma_f32_16x16x32_bf16 v[48:51], a[104:107], a[156:159], v[48:51]
  ds_read_b128 a[168:171], v5 offset:0
  v_mfma_f32_16x16x32_bf16 v[52:55], v[196:199], a[152:155], v[52:55]
  ds_read_b128 a[172:175], v6 offset:0
  v_mfma_f32_16x16x32_bf16 v[52:55], a[108:111], a[156:159], v[52:55]
  ds_read_b128 a[176:179], v7 offset:0
  v_mfma_f32_16x16x32_bf16 v[56:59], v[200:203], a[152:155], v[56:59]
  v_mfma_f32_16x16x32_bf16 v[56:59], a[112:115], a[156:159], v[56:59]
  v_mfma_f32_16x16x32_bf16 v[60:63], v[204:207], a[152:155], v[60:63]
  v_mfma_f32_16x16x32_bf16 v[60:63], a[116:119], a[156:159], v[60:63]
  s_waitcnt lgkmcnt(8)
  v_mfma_f32_16x16x32_bf16 v[40:43], v[208:211], a[160:163], v[40:43]
  ds_read_b128 a[152:155], v3 offset:24576
  v_mfma_f32_16x16x32_bf16 v[40:43], v[232:235], a[164:167], v[40:43]
  ds_read_b128 a[156:159], v4 offset:24576
  v_mfma_f32_16x16x32_bf16 v[44:47], v[212:215], a[160:163], v[44:47]
  s_waitcnt lgkmcnt(7)
  buffer_store_dwordx4 a[180:183], v83, s[8:11], s59 offen sc1
  v_mfma_f32_16x16x32_bf16 v[44:47], v[236:239], a[164:167], v[44:47]
  v_mfma_f32_16x16x32_bf16 v[48:51], v[216:219], a[160:163], v[48:51]
  v_mfma_f32_16x16x32_bf16 v[48:51], v[240:243], a[164:167], v[48:51]
  v_mfma_f32_16x16x32_bf16 v[52:55], v[220:223], a[160:163], v[52:55]
  v_mfma_f32_16x16x32_bf16 v[52:55], v[244:247], a[164:167], v[52:55]
  v_mfma_f32_16x16x32_bf16 v[56:59], v[224:227], a[160:163], v[56:59]
  s_waitcnt lgkmcnt(6)
  buffer_store_dwordx4 a[184:187], v65, s[8:11], s62 offen sc1
  v_mfma_f32_16x16x32_bf16 v[56:59], v[248:251], a[164:167], v[56:59]
  v_mfma_f32_16x16x32_bf16 v[60:63], v[228:231], a[160:163], v[60:63]
  v_mfma_f32_16x16x32_bf16 v[60:63], v[252:255], a[164:167], v[60:63]
  s_cmp_ge_u32 s76, s40
  s_cbranch_scc1 L_tail
  s_waitcnt lgkmcnt(8)
  v_mfma_f32_16x16x32_bf16 v[16:19], v[88:91], a[144:147], 0
  ds_read_b128 a[160:163], v1 offset:24832
  v_mfma_f32_16x16x32_bf16 v[16:19], a[0:3], a[148:151], v[16:19]
  ds_read_b128 a[164:167], v2 offset:24832
  v_mfma_f32_16x16x32_bf16 v[20:23], v[92:95], a[144:147], 0
  v_mfma_f32_16x16x32_bf16 v[20:23], a[4:7], a[148:151], v[20:23]
  v_cvt_pk_bf16_f32 v40, v40, v41
  v_mfma_f32_16x16x32_bf16 v[24:27], v[96:99], a[144:147], 0
  v_cvt_pk_bf16_f32 v41, v42, v43
  v_mfma_f32_16x16x32_bf16 v[24:27], a[8:11], a[148:151], v[24:27]
  v_cvt_pk_bf16_f32 v42, v44, v45
  v_mfma_f32_16x16x32_bf16 v[28:31], v[100:103], a[144:147], 0
  s_waitcnt lgkmcnt(7)
  buffer_store_dwordx4 a[188:191], v85, s[8:11], s63 offen sc1
  v_mfma_f32_16x16x32_bf16 v[28:31], a[12:15], a[148:151], v[28:31]
  v_cvt_pk_bf16_f32 v43, v46, v47
  v_mfma_f32_16x16x32_bf16 v[32:35], v[104:107], a[144:147], 0
  ds_write_b128 v86, v[40:43] offset:36864
  v_mfma_f32_16x16x32_bf16 v[32:35], a[16:19], a[148:151], v[32:35]
  v_mfma_f32_16x16x32_bf16 v[36:39], v[108:111], a[144:147], 0
  v_mfma_f32_16x16x32_bf16 v[36:39], a[20:23], a[148:151], v[36:39]
  s_waitcnt lgkmcnt(3)
  v_mfma_f32_16x16x32_bf16 v[16:19], v[112:115], a[152:155], v[16:19]
  ds_read_b128 a[144:147], v3 offset:24832
  v_mfma_f32_16x16x32_bf16 v[16:19], a[24:27], a[156:159], v[16:19]
  ds_read_b128 a[148:151], v4 offset:24832
  v_mfma_f32_16x16x32_bf16 v[20:23], v[116:119], a[152:155], v[20:23]
  v_mfma_f32_16x16x32_bf16 v[20:23], a[28:31], a[156:159], v[20:23]
  v_cvt_pk_bf16_f32 v48, v48, v49
  v_mfma_f32_16x16x32_bf16 v[24:27], v[120:123], a[152:155], v[24:27]
  buffer_store_dwordx4 a[168:171], v80, s[8:11], s58 offen sc1
  v_mfma_f32_16x16x32_bf16 v[24:27], a[32:35], a[156:159], v[24:27]
  v_cvt_pk_bf16_f32 v49, v50, v51
  v_mfma_f32_16x16x32_bf16 v[28:31], v[124:127], a[152:155], v[28:31]
  v_cvt_pk_bf16_f32 v50, v52, v53
  v_mfma_f32_16x16x32_bf16 v[28:31], a[36:39], a[156:159], v[28:31]
  v_cvt_pk_bf16_f32 v51, v54, v55
  v_mfma_f32_16x16x32_bf16 v[32:35], v[128:131], a[152:155], v[32:35]
  ds_write_b128 v87, v[48:51] offset:36864
  v_mfma_f32_16x16x32_bf16 v[32:35], a[40:43], a[156:159], v[32:35]
  v_mfma_f32_16x16x32_bf16 v[36:39], v[132:135], a[152:155], v[36:39]
  v_mfma_f32_16x16x32_bf16 v[36:39], a[44:47], a[156:159], v[36:39]
  s_waitcnt lgkmcnt(4)
  v_mfma_f32_16x16x32_bf16 v[16:19], v[136:139], a[160:163], v[16:19]
  ds_read_b128 a[152:155], v1 offset:25088
  v_mfma_f32_16x16x32_bf16 v[16:19], a[48:51], a[164:167], v[16:19]
  ds_read_b128 a[156:159], v2 offset:25088
  v_mfma_f32_16x16x32_bf16 v[20:23], v[140:143], a[160:163], v[20:23]
  v_mfma_f32_16x16x32_bf16 v[20:23], a[52:55], a[164:167], v[20:23]
  v_mfma_f32_16x16x32_bf16 v[24:27], v[144:147], a[160:163], v[24:27]
  buffer_store_dwordx4 a[172:175], v81, s[8:11], s58 offen sc1
  v_mfma_f32_16x16x32_bf16 v[24:27], a[56:59], a[164:167], v[24:27]
  v_mfma_f32_16x16x32_bf16 v[28:31], v[148:151], a[160:163], v[28:31]
  v_mfma_f32_16x16x32_bf16 v[28:31], a[60:63], a[164:167], v[28:31]
  v_mfma_f32_16x16x32_bf16 v[32:35], v[152:155], a[160:163], v[32:35]
  v_mfma_f32_16x16x32_bf16 v[32:35], a[64:67], a[164:167], v[32:35]
  v_mfma_f32_16x16x32_bf16 v[36:39], v[156:159], a[160:163], v[36:39]
  v_mfma_f32_16x16x32_bf16 v[36:39], a[68:71], a[164:167], v[36:39]
  s_waitcnt lgkmcnt(3)
  v_mfma_f32_16x16x32_bf16 v[16:19], v[160:163], a[144:147], v[16:19]
  ds_read_b128 a[160:163], v3 offset:25088
  v_mfma_f32_16x16x32_bf16 v[16:19], a[72:75], a[148:151], v[16:19]
  ds_read_b128 a[164:167], v4 offset:25088
  v_mfma_f32_16x16x32_bf16 v[20:23], v[164:167], a[144:147], v[20:23]
  v_cvt_pk_bf16_f32 v56, v56, v57
  v_mfma_f32_16x16x32_bf16 v[20:23], a[76:79], a[148:151], v[20:23]
  v_cvt_pk_bf16_f32 v57, v58, v59
  v_mfma_f32_16x16x32_bf16 v[24:27], v[168:171], a[144:147], v[24:27]
  buffer_store_dwordx4 a[176:179], v82, s[8:11], s58 offen sc1
  v_mfma_f32_16x16x32_bf16 v[24:27], a[80:83], a[148:151], v[24:27]
  s_mov_b64 s[82:83], s[80:81]
  v_cvt_pk_bf16_f32 v58, v60, v61
  v_mfma_f32_16x16x32_bf16 v[28:31], v[172:175], a[144:147], v[28:31]
  s_mov_b64 s[80:81], s[78:79]
  v_cvt_pk_bf16_f32 v59, v62, v63
  v_mfma_f32_16x16x32_bf16 v[28:31], a[84:87], a[148:151], v[28:31]
  ds_write_b128 v86, v[56:59] offset:36992
  v_mfma_f32_16x16x32_bf16 v[32:35], v[176:179], a[144:147], v[32:35]
  s_mov_b64 s[78:79], s[76:77]
  s_add_u32 s76, s33, s32
  v_mfma_f32_16x16x32_bf16 v[32:35], a[88:91], a[148:151], v[32:35]
  s_xor_b32 s76, s76, s34
  s_add_u32 s77, s32, 24576
  v_mfma_f32_16x16x32_bf16 v[36:39], v[180:183], a[144:147], v[36:39]
  s_cmp_lt_u32 s32, s35
  s_cselect_b32 s22, s32, s40
  v_mfma_f32_16x16x32_bf16 v[36:39], a[92:95], a[148:151], v[36:39]
  s_cselect_b32 s77, s77, s40
  s_waitcnt lgkmcnt(3)
  v_mfma_f32_16x16x32_bf16 v[16:19], v[184:187], a[152:155], v[16:19]
  ds_read_b128 a[144:147], v1 offset:36864
  s_bitcmp1_b32 s76, 21
  v_mfma_f32_16x16x32_bf16 v[16:19], a[96:99], a[156:159], v[16:19]
  ds_read_b128 a[148:151], v2 offset:36864
  s_cselect_b32 s76, s77, s22
  v_mfma_f32_16x16x32_bf16 v[20:23], v[188:191], a[152:155], v[20:23]
  s_cselect_b32 s77, s22, s77
  s_cselect_b64 s[56:57], -1, 0
  v_mfma_f32_16x16x32_bf16 v[20:23], a[100:103], a[156:159], v[20:23]
  s_add_u32 s32, s32, 786432
  s_add_u32 m0, s39, 24576
  v_mfma_f32_16x16x32_bf16 v[24:27], v[192:195], a[152:155], v[24:27]
  buffer_load_dwordx4 v8, s[4:7], s76 offen nt lds
  v_mfma_f32_16x16x32_bf16 v[24:27], a[104:107], a[156:159], v[24:27]
  s_mov_b32 s58, s80
  s_mov_b32 s59, s82
  v_mfma_f32_16x16x32_bf16 v[28:31], v[196:199], a[152:155], v[28:31]
  s_mov_b32 s63, s83
  s_min_u32 s62, s82, s83
  v_mfma_f32_16x16x32_bf16 v[28:31], a[108:111], a[156:159], v[28:31]
  s_cmp_gt_u32 s82, s83
  s_cselect_b64 s[90:91], -1, 0
  v_mfma_f32_16x16x32_bf16 v[32:35], v[200:203], a[152:155], v[32:35]
  v_cndmask_b32 v65, v84, v64, s[90:91]
  v_mfma_f32_16x16x32_bf16 v[32:35], a[112:115], a[156:159], v[32:35]
  v_mfma_f32_16x16x32_bf16 v[36:39], v[204:207], a[152:155], v[36:39]
  v_mfma_f32_16x16x32_bf16 v[36:39], a[116:119], a[156:159], v[36:39]
  s_waitcnt lgkmcnt(3)
  v_mfma_f32_16x16x32_bf16 v[16:19], v[208:211], a[160:163], v[16:19]
  ds_read_b128 a[152:155], v3 offset:36864
  v_mfma_f32_16x16x32_bf16 v[16:19], v[232:235], a[164:167], v[16:19]
  ds_read_b128 a[156:159], v4 offset:36864
  v_mfma_f32_16x16x32_bf16 v[20:23], v[212:215], a[160:163], v[20:23]
  v_mfma_f32_16x16x32_bf16 v[20:23], v[236:239], a[164:167], v[20:23]
  s_add_u32 m0, s39, 28672
  v_mfma_f32_16x16x32_bf16 v[24:27], v[216:219], a[160:163], v[24:27]
  buffer_load_dwordx4 v9, s[4:7], s76 offen nt lds
  v_mfma_f32_16x16x32_bf16 v[24:27], v[240:243], a[164:167], v[24:27]
  v_mfma_f32_16x16x32_bf16 v[28:31], v[220:223], a[160:163], v[28:31]
  v_mfma_f32_16x16x32_bf16 v[28:31], v[244:247], a[164:167], v[28:31]
  v_mfma_f32_16x16x32_bf16 v[32:35], v[224:227], a[160:163], v[32:35]
  v_mfma_f32_16x16x32_bf16 v[32:35], v[248:251], a[164:167], v[32:35]
  v_mfma_f32_16x16x32_bf16 v[36:39], v[228:231], a[160:163], v[36:39]
  v_mfma_f32_16x16x32_bf16 v[36:39], v[252:255], a[164:167], v[36:39]
  s_waitcnt lgkmcnt(2)
  v_mfma_f32_16x16x32_bf16 v[40:43], v[88:91], a[144:147], 0
  ds_read_b128 a[160:163], v1 offset:37120
  v_mfma_f32_16x16x32_bf16 v[40:43], a[0:3], a[148:151], v[40:43]
  ds_read_b128 a[164:167], v2 offset:37120
  v_mfma_f32_16x16x32_bf16 v[44:47], v[92:95], a[144:147], 0
  s_add_u32 m0, s39, 32768
  v_mfma_f32_16x16x32_bf16 v[44:47], a[4:7], a[148:151], v[44:47]
  v_cvt_pk_bf16_f32 v16, v16, v17
  v_mfma_f32_16x16x32_bf16 v[48:51], v[96:99], a[144:147], 0
  buffer_load_dwordx4 v10, s[4:7], s76 offen nt lds
  v_mfma_f32_16x16x32_bf16 v[48:51], a[8:11], a[148:151], v[48:51]
  v_cvt_pk_bf16_f32 v17, v18, v19
  v_mfma_f32_16x16x32_bf16 v[52:55], v[100:103], a[144:147], 0
  v_cvt_pk_bf16_f32 v18, v20, v21
  v_mfma_f32_16x16x32_bf16 v[52:55], a[12:15], a[148:151], v[52:55]
  v_cvt_pk_bf16_f32 v19, v22, v23
  v_mfma_f32_16x16x32_bf16 v[56:59], v[104:107], a[144:147], 0
  ds_write_b128 v86, v[16:19] offset:24576
  v_mfma_f32_16x16x32_bf16 v[56:59], a[16:19], a[148:151], v[56:59]
  s_add_u32 m0, s39, 36864
  v_mfma_f32_16x16x32_bf16 v[60:63], v[108:111], a[144:147], 0
  v_cvt_pk_bf16_f32 v24, v24, v25
  v_mfma_f32_16x16x32_bf16 v[60:63], a[20:23], a[148:151], v[60:63]
  s_waitcnt lgkmcnt(3)
  v_mfma_f32_16x16x32_bf16 v[40:43], v[112:115], a[152:155], v[40:43]
  ds_read_b128 a[144:147], v3 offset:37120
  v_mfma_f32_16x16x32_bf16 v[40:43], a[24:27], a[156:159], v[40:43]
  ds_read_b128 a[148:151], v4 offset:37120
  v_mfma_f32_16x16x32_bf16 v[44:47], v[116:119], a[152:155], v[44:47]
  v_cvt_pk_bf16_f32 v25, v26, v27
  v_mfma_f32_16x16x32_bf16 v[44:47], a[28:31], a[156:159], v[44:47]
  v_cvt_pk_bf16_f32 v26, v28, v29
  v_mfma_f32_16x16x32_bf16 v[48:51], v[120:123], a[152:155], v[48:51]
  buffer_load_dwordx4 v11, s[4:7], s76 offen nt lds
  v_mfma_f32_16x16x32_bf16 v[48:51], a[32:35], a[156:159], v[48:51]
  v_cvt_pk_bf16_f32 v27, v30, v31
  v_mfma_f32_16x16x32_bf16 v[52:55], v[124:127], a[152:155], v[52:55]
  ds_write_b128 v87, v[24:27] offset:24576
  v_mfma_f32_16x16x32_bf16 v[52:55], a[36:39], a[156:159], v[52:55]
  v_mfma_f32_16x16x32_bf16 v[56:59], v[128:131], a[152:155], v[56:59]
  v_mfma_f32_16x16x32_bf16 v[56:59], a[40:43], a[156:159], v[56:59]
  v_mfma_f32_16x16x32_bf16 v[60:63], v[132:135], a[152:155], v[60:63]
  v_cndmask_b32 v15, v12, v14, s[56:57]
  v_mfma_f32_16x16x32_bf16 v[60:63], a[44:47], a[156:159], v[60:63]
  s_waitcnt lgkmcnt(4)
  v_mfma_f32_16x16x32_bf16 v[40:43], v[136:139], a[160:163], v[40:43]
  ds_read_b128 a[152:155], v1 offset:37376
  v_mfma_f32_16x16x32_bf16 v[40:43], a[48:51], a[164:167], v[40:43]
  ds_read_b128 a[156:159], v2 offset:37376
  v_mfma_f32_16x16x32_bf16 v[44:47], v[140:143], a[160:163], v[44:47]
  s_add_u32 m0, s39, 40960
  v_mfma_f32_16x16x32_bf16 v[44:47], a[52:55], a[164:167], v[44:47]
  v_cvt_pk_bf16_f32 v32, v32, v33
  v_mfma_f32_16x16x32_bf16 v[48:51], v[144:147], a[160:163], v[48:51]
  buffer_load_dwordx4 v15, s[4:7], s22 offen nt lds
  v_mfma_f32_16x16x32_bf16 v[48:51], a[56:59], a[164:167], v[48:51]
  v_cvt_pk_bf16_f32 v33, v34, v35
  v_mfma_f32_16x16x32_bf16 v[52:55], v[148:151], a[160:163], v[52:55]
  v_cvt_pk_bf16_f32 v34, v36, v37
  v_mfma_f32_16x16x32_bf16 v[52:55], a[60:63], a[164:167], v[52:55]
  v_cvt_pk_bf16_f32 v35, v38, v39
  v_mfma_f32_16x16x32_bf16 v[56:59], v[152:155], a[160:163], v[56:59]
  ds_write_b128 v86, v[32:35] offset:24704
  v_mfma_f32_16x16x32_bf16 v[56:59], a[64:67], a[164:167], v[56:59]
  v_mfma_f32_16x16x32_bf16 v[60:63], v[156:159], a[160:163], v[60:63]
  v_mfma_f32_16x16x32_bf16 v[60:63], a[68:71], a[164:167], v[60:63]
  s_waitcnt lgkmcnt(4)
  v_mfma_f32_16x16x32_bf16 v[40:43], v[160:163], a[144:147], v[40:43]
  ds_read_b128 a[160:163], v3 offset:37376
  v_mfma_f32_16x16x32_bf16 v[40:43], a[72:75], a[148:151], v[40:43]
  ds_read_b128 a[164:167], v4 offset:37376
  v_mfma_f32_16x16x32_bf16 v[44:47], v[164:167], a[144:147], v[44:47]
  s_add_u32 m0, s39, 45056
  v_mfma_f32_16x16x32_bf16 v[44:47], a[76:79], a[148:151], v[44:47]
  s_xor_b32 s39, s39, 49152
  v_mfma_f32_16x16x32_bf16 v[48:51], v[168:171], a[144:147], v[48:51]
  buffer_load_dwordx4 v13, s[4:7], s77 offen nt lds
  v_mfma_f32_16x16x32_bf16 v[48:51], a[80:83], a[148:151], v[48:51]
  v_mfma_f32_16x16x32_bf16 v[52:55], v[172:175], a[144:147], v[52:55]
  v_mfma_f32_16x16x32_bf16 v[52:55], a[84:87], a[148:151], v[52:55]
  v_mfma_f32_16x16x32_bf16 v[56:59], v[176:179], a[144:147], v[56:59]
  v_mfma_f32_16x16x32_bf16 v[56:59], a[88:91], a[148:151], v[56:59]
  v_mfma_f32_16x16x32_bf16 v[60:63], v[180:183], a[144:147], v[60:63]
  v_mfma_f32_16x16x32_bf16 v[60:63], a[92:95], a[148:151], v[60:63]
  s_waitcnt vmcnt(12) lgkmcnt(2)
  s_barrier
  v_xor_b32 v1, 49152, v1
  v_xor_b32 v2, 49152, v2
  v_xor_b32 v3, 49152, v3
  v_xor_b32 v4, 49152, v4
  s_waitcnt lgkmcnt(3)
  v_mfma_f32_16x16x32_bf16 v[40:43], v[184:187], a[152:155], v[40:43]
  ds_read_b128 a[144:147], v1 offset:0
  v_mfma_f32_16x16x32_bf16 v[40:43], a[96:99], a[156:159], v[40:43]
  ds_read_b128 a[148:151], v2 offset:0
  v_mfma_f32_16x16x32_bf16 v[44:47], v[188:191], a[152:155], v[44:47]
  ds_read_b128 a[180:183], v5 offset:36864
  v_mfma_f32_16x16x32_bf16 v[44:47], a[100:103], a[156:159], v[44:47]
  ds_read_b128 a[184:187], v6 offset:36864
  v_mfma_f32_16x16x32_bf16 v[48:51], v[192:195], a[152:155], v[48:51]
  ds_read_b128 a[188:191], v7 offset:36864
  v_mfma_f32_16x16x32_bf16 v[48:51], a[104:107], a[156:159], v[48:51]
  ds_read_b128 a[168:171], v5 offset:24576
  v_mfma_f32_16x16x32_bf16 v[52:55], v[196:199], a[152:155], v[52:55]
  ds_read_b128 a[172:175], v6 offset:24576
  v_mfma_f32_16x16x32_bf16 v[52:55], a[108:111], a[156:159], v[52:55]
  ds_read_b128 a[176:179], v7 offset:24576
  v_mfma_f32_16x16x32_bf16 v[56:59], v[200:203], a[152:155], v[56:59]
  v_mfma_f32_16x16x32_bf16 v[56:59], a[112:115], a[156:159], v[56:59]
  v_mfma_f32_16x16x32_bf16 v[60:63], v[204:207], a[152:155], v[60:63]
  v_mfma_f32_16x16x32_bf16 v[60:63], a[116:119], a[156:159], v[60:63]
  s_waitcnt lgkmcnt(8)
  v_mfma_f32_16x16x32_bf16 v[40:43], v[208:211], a[160:163], v[40:43]
  ds_read_b128 a[152:155], v3 offset:0
  v_mfma_f32_16x16x32_bf16 v[40:43], v[232:235], a[164:167], v[40:43]
  ds_read_b128 a[156:159], v4 offset:0
  v_mfma_f32_16x16x32_bf16 v[44:47], v[212:215], a[160:163], v[44:47]
  s_waitcnt lgkmcnt(7)
  buffer_store_dwordx4 a[180:183], v83, s[8:11], s59 offen sc1
  v_mfma_f32_16x16x32_bf16 v[44:47], v[236:239], a[164:167], v[44:47]
  v_mfma_f32_16x16x32_bf16 v[48:51], v[216:219], a[160:163], v[48:51]
  v_mfma_f32_16x16x32_bf16 v[48:51], v[240:243], a[164:167], v[48:51]
  v_mfma_f32_16x16x32_bf16 v[52:55], v[220:223], a[160:163], v[52:55]
  v_mfma_f32_16x16x32_bf16 v[52:55], v[244:247], a[164:167], v[52:55]
  v_mfma_f32_16x16x32_bf16 v[56:59], v[224:227], a[160:163], v[56:59]
  s_waitcnt lgkmcnt(6)
  buffer_store_dwordx4 a[184:187], v65, s[8:11], s62 offen sc1
  v_mfma_f32_16x16x32_bf16 v[56:59], v[248:251], a[164:167], v[56:59]
  v_mfma_f32_16x16x32_bf16 v[60:63], v[228:231], a[160:163], v[60:63]
  v_mfma_f32_16x16x32_bf16 v[60:63], v[252:255], a[164:167], v[60:63]
  s_branch L_loop
L_tail:
  s_waitcnt lgkmcnt(8)
  v_mfma_f32_16x16x32_bf16 v[16:19], v[88:91], a[144:147], 0
  ds_read_b128 a[160:163], v1 offset:24832
  v_mfma_f32_16x16x32_bf16 v[16:19], a[0:3], a[148:151], v[16:19]
  ds_read_b128 a[164:167], v2 offset:24832
  v_mfma_f32_16x16x32_bf16 v[20:23], v[92:95], a[144:147], 0
  v_mfma_f32_16x16x32_bf16 v[20:23], a[4:7], a[148:151], v[20:23]
  v_cvt_pk_bf16_f32 v40, v40, v41
  v_mfma_f32_16x16x32_bf16 v[24:27], v[96:99], a[144:147], 0
  v_cvt_pk_bf16_f32 v41, v42, v43
  v_mfma_f32_16x16x32_bf16 v[24:27], a[8:11], a[148:151], v[24:27]
  v_cvt_pk_bf16_f32 v42, v44, v45
  v_mfma_f32_16x16x32_bf16 v[28:31], v[100:103], a[144:147], 0
  s_waitcnt lgkmcnt(7)
  buffer_store_dwordx4 a[188:191], v85, s[8:11], s63 offen sc1
  v_mfma_f32_16x16x32_bf16 v[28:31], a[12:15], a[148:151], v[28:31]
  v_cvt_pk_bf16_f32 v43, v46, v47
  v_mfma_f32_16x16x32_bf16 v[32:35], v[104:107], a[144:147], 0
  ds_write_b128 v86, v[40:43] offset:36864
  v_mfma_f32_16x16x32_bf16 v[32:35], a[16:19], a[148:151], v[32:35]
  v_cvt_pk_bf16_f32 v48, v48, v49
  v_mfma_f32_16x16x32_bf16 v[36:39], v[108:111], a[144:147], 0
  v_cvt_pk_bf16_f32 v49, v50, v51
  v_mfma_f32_16x16x32_bf16 v[36:39], a[20:23], a[148:151], v[36:39]
  s_waitcnt lgkmcnt(3)
  v_mfma_f32_16x16x32_bf16 v[16:19], v[112:115], a[152:155], v[16:19]
  ds_read_b128 a[144:147], v3 offset:24832
  v_mfma_f32_16x16x32_bf16 v[16:19], a[24:27], a[156:159], v[16:19]
  ds_read_b128 a[148:151], v4 offset:24832
  v_mfma_f32_16x16x32_bf16 v[20:23], v[116:119], a[152:155], v[20:23]
  v_cvt_pk_bf16_f32 v50, v52, v53
  v_mfma_f32_16x16x32_bf16 v[20:23], a[28:31], a[156:159], v[20:23]
  v_cvt_pk_bf16_f32 v51, v54, v55
  v_mfma_f32_16x16x32_bf16 v[24:27], v[120:123], a[152:155], v[24:27]
  buffer_store_dwordx4 a[168:171], v80, s[8:11], s58 offen sc1
  v_mfma_f32_16x16x32_bf16 v[24:27], a[32:35], a[156:159], v[24:27]
  ds_write_b128 v87, v[48:51] offset:36864
  v_mfma_f32_16x16x32_bf16 v[28:31], v[124:127], a[152:155], v[28:31]
  v_cvt_pk_bf16_f32 v56, v56, v57
  v_mfma_f32_16x16x32_bf16 v[28:31], a[36:39], a[156:159], v[28:31]
  v_cvt_pk_bf16_f32 v57, v58, v59
  v_mfma_f32_16x16x32_bf16 v[32:35], v[128:131], a[152:155], v[32:35]
  v_cvt_pk_bf16_f32 v58, v60, v61
  v_mfma_f32_16x16x32_bf16 v[32:35], a[40:43], a[156:159], v[32:35]
  v_cvt_pk_bf16_f32 v59, v62, v63
  v_mfma_f32_16x16x32_bf16 v[36:39], v[132:135], a[152:155], v[36:39]
  ds_write_b128 v86, v[56:59] offset:36992
  v_mfma_f32_16x16x32_bf16 v[36:39], a[44:47], a[156:159], v[36:39]
  s_waitcnt lgkmcnt(5)
  v_mfma_f32_16x16x32_bf16 v[16:19], v[136:139], a[160:163], v[16:19]
  ds_read_b128 a[152:155], v1 offset:25088
  v_mfma_f32_16x16x32_bf16 v[16:19], a[48:51], a[164:167], v[16:19]
  ds_read_b128 a[156:159], v2 offset:25088
  v_mfma_f32_16x16x32_bf16 v[20:23], v[140:143], a[160:163], v[20:23]
  s_mov_b32 s59, s80
  v_mfma_f32_16x16x32_bf16 v[20:23], a[52:55], a[164:167], v[20:23]
  s_mov_b32 s63, s81
  v_mfma_f32_16x16x32_bf16 v[24:27], v[144:147], a[160:163], v[24:27]
  buffer_store_dwordx4 a[172:175], v81, s[8:11], s58 offen sc1
  v_mfma_f32_16x16x32_bf16 v[24:27], a[56:59], a[164:167], v[24:27]
  s_min_u32 s62, s80, s81
  v_mfma_f32_16x16x32_bf16 v[28:31], v[148:151], a[160:163], v[28:31]
  s_cmp_gt_u32 s80, s81
  v_mfma_f32_16x16x32_bf16 v[28:31], a[60:63], a[164:167], v[28:31]
  s_cselect_b64 s[90:91], -1, 0
  v_mfma_f32_16x16x32_bf16 v[32:35], v[152:155], a[160:163], v[32:35]
  v_cndmask_b32 v65, v84, v64, s[90:91]
  v_mfma_f32_16x16x32_bf16 v[32:35], a[64:67], a[164:167], v[32:35]
  v_mfma_f32_16x16x32_bf16 v[36:39], v[156:159], a[160:163], v[36:39]
  v_mfma_f32_16x16x32_bf16 v[36:39], a[68:71], a[164:167], v[36:39]
  s_waitcnt lgkmcnt(4)
  v_mfma_f32_16x16x32_bf16 v[16:19], v[160:163], a[144:147], v[16:19]
  ds_read_b128 a[160:163], v3 offset:25088
  v_mfma_f32_16x16x32_bf16 v[16:19], a[72:75], a[148:151], v[16:19]
  ds_read_b128 a[164:167], v4 offset:25088
  v_mfma_f32_16x16x32_bf16 v[20:23], v[164:167], a[144:147], v[20:23]
  v_mfma_f32_16x16x32_bf16 v[20:23], a[76:79], a[148:151], v[20:23]
  v_mfma_f32_16x16x32_bf16 v[24:27], v[168:171], a[144:147], v[24:27]
  buffer_store_dwordx4 a[176:179], v82, s[8:11], s58 offen sc1
  v_mfma_f32_16x16x32_bf16 v[24:27], a[80:83], a[148:151], v[24:27]
  s_mov_b32 s58, s78
  v_mfma_f32_16x16x32_bf16 v[28:31], v[172:175], a[144:147], v[28:31]
  v_mfma_f32_16x16x32_bf16 v[28:31], a[84:87], a[148:151], v[28:31]
  v_mfma_f32_16x16x32_bf16 v[32:35], v[176:179], a[144:147], v[32:35]
  v_mfma_f32_16x16x32_bf16 v[32:35], a[88:91], a[148:151], v[32:35]
  v_mfma_f32_16x16x32_bf16 v[36:39], v[180:183], a[144:147], v[36:39]
  v_mfma_f32_16x16x32_bf16 v[36:39], a[92:95], a[148:151], v[36:39]
  s_waitcnt lgkmcnt(4)
  s_barrier
  s_waitcnt lgkmcnt(2)
  v_mfma_f32_16x16x32_bf16 v[16:19], v[184:187], a[152:155], v[16:19]
  ds_read_b128 a[144:147], v1 offset:36864
  v_mfma_f32_16x16x32_bf16 v[16:19], a[96:99], a[156:159], v[16:19]
  ds_read_b128 a[148:151], v2 offset:36864
  v_mfma_f32_16x16x32_bf16 v[20:23], v[188:191], a[152:155], v[20:23]
  ds_read_b128 a[180:183], v5 offset:36864
  v_mfma_f32_16x16x32_bf16 v[20:23], a[100:103], a[156:159], v[20:23]
  ds_read_b128 a[184:187], v6 offset:36864
  v_mfma_f32_16x16x32_bf16 v[24:27], v[192:195], a[152:155], v[24:27]
  ds_read_b128 a[188:191], v7 offset:36864
  v_mfma_f32_16x16x32_bf16 v[24:27], a[104:107], a[156:159], v[24:27]
  v_mfma_f32_16x16x32_bf16 v[28:31], v[196:199], a[152:155], v[28:31]
  v_mfma_f32_16x16x32_bf16 v[28:31], a[108:111], a[156:159], v[28:31]
  v_mfma_f32_16x16x32_bf16 v[32:35], v[200:203], a[152:155], v[32:35]
  v_mfma_f32_16x16x32_bf16 v[32:35], a[112:115], a[156:159], v[32:35]
  v_mfma_f32_16x16x32_bf16 v[36:39], v[204:207], a[152:155], v[36:39]
  v_mfma_f32_16x16x32_bf16 v[36:39], a[116:119], a[156:159], v[36:39]
  s_waitcnt lgkmcnt(5)
  v_mfma_f32_16x16x32_bf16 v[16:19], v[208:211], a[160:163], v[16:19]
  ds_read_b128 a[152:155], v3 offset:36864
  v_mfma_f32_16x16x32_bf16 v[16:19], v[232:235], a[164:167], v[16:19]
  ds_read_b128 a[156:159], v4 offset:36864
  v_mfma_f32_16x16x32_bf16 v[20:23], v[212:215], a[160:163], v[20:23]
  s_waitcnt lgkmcnt(4)
  buffer_store_dwordx4 a[180:183], v83, s[8:11], s59 offen sc1
  v_mfma_f32_16x16x32_bf16 v[20:23], v[236:239], a[164:167], v[20:23]
  v_mfma_f32_16x16x32_bf16 v[24:27], v[216:219], a[160:163], v[24:27]
  v_mfma_f32_16x16x32_bf16 v[24:27], v[240:243], a[164:167], v[24:27]
  v_mfma_f32_16x16x32_bf16 v[28:31], v[220:223], a[160:163], v[28:31]
  v_mfma_f32_16x16x32_bf16 v[28:31], v[244:247], a[164:167], v[28:31]
  v_mfma_f32_16x16x32_bf16 v[32:35], v[224:227], a[160:163], v[32:35]
  v_mfma_f32_16x16x32_bf16 v[32:35], v[248:251], a[164:167], v[32:35]
  v_mfma_f32_16x16x32_bf16 v[36:39], v[228:231], a[160:163], v[36:39]
  v_mfma_f32_16x16x32_bf16 v[36:39], v[252:255], a[164:167], v[36:39]
  s_waitcnt lgkmcnt(5)
  v_mfma_f32_16x16x32_bf16 v[40:43], v[88:91], a[144:147], 0
  ds_read_b128 a[160:163], v1 offset:37120
  v_mfma_f32_16x16x32_bf16 v[40:43], a[0:3], a[148:151], v[40:43]
  ds_read_b128 a[164:167], v2 offset:37120
  v_mfma_f32_16x16x32_bf16 v[44:47], v[92:95], a[144:147], 0
  s_waitcnt lgkmcnt(5)
  buffer_store_dwordx4 a[184:187], v65, s[8:11], s62 offen sc1
  v_mfma_f32_16x16x32_bf16 v[44:47], a[4:7], a[148:151], v[44:47]
  v_cvt_pk_bf16_f32 v16, v16, v17
  v_mfma_f32_16x16x32_bf16 v[48:51], v[96:99], a[144:147], 0
  v_cvt_pk_bf16_f32 v17, v18, v19
  v_mfma_f32_16x16x32_bf16 v[48:51], a[8:11], a[148:151], v[48:51]
  v_cvt_pk_bf16_f32 v18, v20, v21
  v_mfma_f32_16x16x32_bf16 v[52:55], v[100:103], a[144:147], 0
  v_cvt_pk_bf16_f32 v19, v22, v23
  v_mfma_f32_16x16x32_bf16 v[52:55], a[12:15], a[148:151], v[52:55]
  ds_write_b128 v86, v[16:19] offset:24576
  v_mfma_f32_16x16x32_bf16 v[56:59], v[104:107], a[144:147], 0
  v_cvt_pk_bf16_f32 v24, v24, v25
  v_mfma_f32_16x16x32_bf16 v[56:59], a[16:19], a[148:151], v[56:59]
  v_cvt_pk_bf16_f32 v25, v26, v27
  v_mfma_f32_16x16x32_bf16 v[60:63], v[108:111], a[144:147], 0
  v_cvt_pk_bf16_f32 v26, v28, v29
  v_mfma_f32_16x16x32_bf16 v[60:63], a[20:23], a[148:151], v[60:63]
  s_waitcnt lgkmcnt(3)
  v_mfma_f32_16x16x32_bf16 v[40:43], v[112:115], a[152:155], v[40:43]
  ds_read_b128 a[144:147], v3 offset:37120
  v_mfma_f32_16x16x32_bf16 v[40:43], a[24:27], a[156:159], v[40:43]
  ds_read_b128 a[148:151], v4 offset:37120
  v_mfma_f32_16x16x32_bf16 v[44:47], v[116:119], a[152:155], v[44:47]
  v_cvt_pk_bf16_f32 v27, v30, v31
  v_mfma_f32_16x16x32_bf16 v[44:47], a[28:31], a[156:159], v[44:47]
  ds_write_b128 v87, v[24:27] offset:24576
  v_mfma_f32_16x16x32_bf16 v[48:51], v[120:123], a[152:155], v[48:51]
  buffer_store_dwordx4 a[188:191], v85, s[8:11], s63 offen sc1
  v_mfma_f32_16x16x32_bf16 v[48:51], a[32:35], a[156:159], v[48:51]
  v_cvt_pk_bf16_f32 v32, v32, v33
  v_mfma_f32_16x16x32_bf16 v[52:55], v[124:127], a[152:155], v[52:55]
  v_cvt_pk_bf16_f32 v33, v34, v35
  v_mfma_f32_16x16x32_bf16 v[52:55], a[36:39], a[156:159], v[52:55]
  v_cvt_pk_bf16_f32 v34, v36, v37
  v_mfma_f32_16x16x32_bf16 v[56:59], v[128:131], a[152:155], v[56:59]
  v_cvt_pk_bf16_f32 v35, v38, v39
  v_mfma_f32_16x16x32_bf16 v[56:59], a[40:43], a[156:159], v[56:59]
  ds_write_b128 v86, v[32:35] offset:24704
  v_mfma_f32_16x16x32_bf16 v[60:63], v[132:135], a[152:155], v[60:63]
  s_mov_b32 s59, s78
  v_mfma_f32_16x16x32_bf16 v[60:63], a[44:47], a[156:159], v[60:63]
  s_waitcnt lgkmcnt(5)
  v_mfma_f32_16x16x32_bf16 v[40:43], v[136:139], a[160:163], v[40:43]
  ds_read_b128 a[152:155], v1 offset:37376
  v_mfma_f32_16x16x32_bf16 v[40:43], a[48:51], a[164:167], v[40:43]
  ds_read_b128 a[156:159], v2 offset:37376
  v_mfma_f32_16x16x32_bf16 v[44:47], v[140:143], a[160:163], v[44:47]
  s_mov_b32 s63, s79
  v_mfma_f32_16x16x32_bf16 v[44:47], a[52:55], a[164:167], v[44:47]
  s_min_u32 s62, s78, s79
  v_mfma_f32_16x16x32_bf16 v[48:51], v[144:147], a[160:163], v[48:51]
  s_cmp_gt_u32 s78, s79
  v_mfma_f32_16x16x32_bf16 v[48:51], a[56:59], a[164:167], v[48:51]
  s_cselect_b64 s[90:91], -1, 0
  v_mfma_f32_16x16x32_bf16 v[52:55], v[148:151], a[160:163], v[52:55]
  v_cndmask_b32 v65, v84, v64, s[90:91]
  v_mfma_f32_16x16x32_bf16 v[52:55], a[60:63], a[164:167], v[52:55]
  v_mfma_f32_16x16x32_bf16 v[56:59], v[152:155], a[160:163], v[56:59]
  v_mfma_f32_16x16x32_bf16 v[56:59], a[64:67], a[164:167], v[56:59]
  v_mfma_f32_16x16x32_bf16 v[60:63], v[156:159], a[160:163], v[60:63]
  v_mfma_f32_16x16x32_bf16 v[60:63], a[68:71], a[164:167], v[60:63]
  s_waitcnt lgkmcnt(2)
  s_barrier
  s_waitcnt lgkmcnt(4)
  v_mfma_f32_16x16x32_bf16 v[40:43], v[160:163], a[144:147], v[40:43]
  ds_read_b128 a[160:163], v3 offset:37376
  v_mfma_f32_16x16x32_bf16 v[40:43], a[72:75], a[148:151], v[40:43]
  ds_read_b128 a[164:167], v4 offset:37376
  v_mfma_f32_16x16x32_bf16 v[44:47], v[164:167], a[144:147], v[44:47]
  ds_read_b128 a[168:171], v5 offset:24576
  v_mfma_f32_16x16x32_bf16 v[44:47], a[76:79], a[148:151], v[44:47]
  ds_read_b128 a[172:175], v6 offset:24576
  v_mfma_f32_16x16x32_bf16 v[48:51], v[168:171], a[144:147], v[48:51]
  ds_read_b128 a[176:179], v7 offset:24576
  v_mfma_f32_16x16x32_bf16 v[48:51], a[80:83], a[148:151], v[48:51]
  v_mfma_f32_16x16x32_bf16 v[52:55], v[172:175], a[144:147], v[52:55]
  v_mfma_f32_16x16x32_bf16 v[52:55], a[84:87], a[148:151], v[52:55]
  v_mfma_f32_16x16x32_bf16 v[56:59], v[176:179], a[144:147], v[56:59]
  v_mfma_f32_16x16x32_bf16 v[56:59], a[88:91], a[148:151], v[56:59]
  v_mfma_f32_16x16x32_bf16 v[60:63], v[180:183], a[144:147], v[60:63]
  v_mfma_f32_16x16x32_bf16 v[60:63], a[92:95], a[148:151], v[60:63]
  s_waitcnt lgkmcnt(5)
  v_mfma_f32_16x16x32_bf16 v[40:43], v[184:187], a[152:155], v[40:43]
  s_waitcnt lgkmcnt(2)
  buffer_store_dwordx4 a[168:171], v80, s[8:11], s58 offen sc1
  v_mfma_f32_16x16x32_bf16 v[40:43], a[96:99], a[156:159], v[40:43]
  v_mfma_f32_16x16x32_bf16 v[44:47], v[188:191], a[152:155], v[44:47]
  v_mfma_f32_16x16x32_bf16 v[44:47], a[100:103], a[156:159], v[44:47]
  v_mfma_f32_16x16x32_bf16 v[48:51], v[192:195], a[152:155], v[48:51]
  v_mfma_f32_16x16x32_bf16 v[48:51], a[104:107], a[156:159], v[48:51]
  v_mfma_f32_16x16x32_bf16 v[52:55], v[196:199], a[152:155], v[52:55]
  v_mfma_f32_16x16x32_bf16 v[52:55], a[108:111], a[156:159], v[52:55]
  v_mfma_f32_16x16x32_bf16 v[56:59], v[200:203], a[152:155], v[56:59]
  s_waitcnt lgkmcnt(1)
  buffer_store_dwordx4 a[172:175], v81, s[8:11], s58 offen sc1
  v_mfma_f32_16x16x32_bf16 v[56:59], a[112:115], a[156:159], v[56:59]
  v_mfma_f32_16x16x32_bf16 v[60:63], v[204:207], a[152:155], v[60:63]
  v_mfma_f32_16x16x32_bf16 v[60:63], a[116:119], a[156:159], v[60:63]
  s_waitcnt lgkmcnt(3)
  v_mfma_f32_16x16x32_bf16 v[40:43], v[208:211], a[160:163], v[40:43]
  v_mfma_f32_16x16x32_bf16 v[40:43], v[232:235], a[164:167], v[40:43]
  v_mfma_f32_16x16x32_bf16 v[44:47], v[212:215], a[160:163], v[44:47]
  v_mfma_f32_16x16x32_bf16 v[44:47], v[236:239], a[164:167], v[44:47]
  v_mfma_f32_16x16x32_bf16 v[48:51], v[216:219], a[160:163], v[48:51]
  s_waitcnt lgkmcnt(0)
  buffer_store_dwordx4 a[176:179], v82, s[8:11], s58 offen sc1
  v_mfma_f32_16x16x32_bf16 v[48:51], v[240:243], a[164:167], v[48:51]
  v_mfma_f32_16x16x32_bf16 v[52:55], v[220:223], a[160:163], v[52:55]
  v_mfma_f32_16x16x32_bf16 v[52:55], v[244:247], a[164:167], v[52:55]
  v_mfma_f32_16x16x32_bf16 v[56:59], v[224:227], a[160:163], v[56:59]
  v_mfma_f32_16x16x32_bf16 v[56:59], v[248:251], a[164:167], v[56:59]
  v_mfma_f32_16x16x32_bf16 v[60:63], v[228:231], a[160:163], v[60:63]
  v_mfma_f32_16x16x32_bf16 v[60:63], v[252:255], a[164:167], v[60:63]
  s_nop 1
  v_cvt_pk_bf16_f32 v40, v40, v41
  v_cvt_pk_bf16_f32 v41, v42, v43
  v_cvt_pk_bf16_f32 v42, v44, v45
  v_cvt_pk_bf16_f32 v43, v46, v47
  ds_write_b128 v86, v[40:43] offset:12288
  v_cvt_pk_bf16_f32 v48, v48, v49
  v_cvt_pk_bf16_f32 v49, v50, v51
  v_cvt_pk_bf16_f32 v50, v52, v53
  v_cvt_pk_bf16_f32 v51, v54, v55
  ds_write_b128 v87, v[48:51] offset:12288
  v_cvt_pk_bf16_f32 v56, v56, v57
  v_cvt_pk_bf16_f32 v57, v58, v59
  v_cvt_pk_bf16_f32 v58, v60, v61
  v_cvt_pk_bf16_f32 v59, v62, v63
  ds_write_b128 v86, v[56:59] offset:12416
  s_waitcnt lgkmcnt(0)
  s_barrier
  ds_read_b128 a[144:147], v5 offset:12288
  ds_read_b128 a[148:151], v6 offset:12288
  ds_read_b128 a[152:155], v7 offset:12288
  s_waitcnt lgkmcnt(2)
  buffer_store_dwordx4 a[144:147], v83, s[8:11], s59 offen sc1
  s_waitcnt lgkmcnt(1)
  buffer_store_dwordx4 a[148:151], v65, s[8:11], s62 offen sc1
  s_waitcnt lgkmcnt(0)
  buffer_store_dwordx4 a[152:155], v85, s[8:11], s63 offen sc1
  s_endpgm
L_slow:
  v_mov_b32 v15, s36
  v_mov_b32 v254, 1
  v_mov_b32 v255, 0
  s_mov_b64 exec, 1
  buffer_atomic_cmpswap v[254:255], v15, s[16:19], 0 offen sc0 sc1
  s_waitcnt vmcnt(0)
  v_readfirstlane_b32 s95, v254
  s_mov_b64 exec, -1
  s_branch L_back
L_done:
  s_endpgm
.section .rodata,"a"
.p2align 6
.amdhsa_kernel standalone__depthwise_separable__vision_kernel
  .amdhsa_next_free_vgpr 512
  .amdhsa_next_free_sgpr 100
  .amdhsa_accum_offset 256
  .amdhsa_group_segment_fixed_size 0
  .amdhsa_kernarg_size 48
  .amdhsa_user_sgpr_count 2
  .amdhsa_user_sgpr_kernarg_segment_ptr 1
  .amdhsa_system_sgpr_workgroup_id_x 1
  .amdhsa_float_denorm_mode_32 3
.end_amdhsa_kernel
```

```asm
; @launch grid=(256,1,1) block=(256,1,1) lds=152128
.amdgcn_target "amdgcn-amd-amdhsa--gfx950"
.text
.globl standalone__depthwise_separable__vision_kernel
.p2align 8
.type standalone__depthwise_separable__vision_kernel,@function
standalone__depthwise_separable__vision_kernel:
  s_load_dwordx8 s[24:31], s[0:1], 0
  s_load_dwordx2 s[92:93], s[0:1], 32
  s_cmp_ge_u32 s2, 256
  s_cbranch_scc1 L_done
  v_lshrrev_b32 v16, 6, v0
  v_and_b32 v28, 63, v0
  v_readfirstlane_b32 s20, v16
  s_getpc_b64 s[50:51]
L_pc:
  v_mul_u32_u24 v18, 128, v0
  v_min_u32 v18, L_done-L_pc, v18
  v_mov_b32 v19, s51
  v_add_co_u32 v18, vcc, s50, v18
  s_nop 1
  v_addc_co_u32 v19, vcc, 0, v19, vcc
  global_load_dword v88, v[18:19], off
  s_lshr_b32 s50, s2, 3
  s_and_b32 s55, s50, 3
  s_lshr_b32 s54, s50, 2
  s_mul_i32 s51, s54, 11
  s_lshr_b32 s51, s51, 5
  s_mul_i32 s51, s51, 3
  s_sub_u32 s54, s54, s51
  s_mul_i32 s52, s20, 192
  v_mul_u32_u24 v18, 0xaaab, v28
  v_lshrrev_b32 v18, 19, v18
  v_mul_u32_u24 v19, 576, v18
  v_lshl_add_u32 v19, v28, 4, v19
  v_add_u32 v64, s52, v19
  v_add_u32 v17, 64, v28
  v_mul_u32_u24 v18, 0xaaab, v17
  v_lshrrev_b32 v18, 19, v18
  v_mul_u32_u24 v19, 576, v18
  v_lshl_add_u32 v19, v28, 4, v19
  v_lshrrev_b32 v18, 3, v18
  v_mul_u32_u24 v18, 6144, v18
  v_add_u32 v19, v19, v18
  v_add_u32 v65, s52, v19
  v_add_u32 v17, 128, v28
  v_mul_u32_u24 v18, 0xaaab, v17
  v_lshrrev_b32 v18, 19, v18
  v_mul_u32_u24 v19, 576, v18
  v_lshl_add_u32 v19, v28, 4, v19
  v_add_u32 v19, 6144, v19
  v_add_u32 v66, s52, v19
  s_mul_i32 s42, s54, 98304
  s_mul_i32 s45, s55, 24576
  s_mul_i32 s49, s20, 6160
  s_waitcnt lgkmcnt(0)
  s_mov_b32 s12, s28
  s_and_b32 s13, s29, 0xffff
  s_mov_b32 s14, 294912
  s_mov_b32 s15, 0x00020000
  s_add_u32 m0, s49, 98560
  s_add_u32 s50, s42, s45
  buffer_load_dwordx4 v64, s[12:15], s50 offen offset:0 lds
  buffer_load_dwordx4 v65, s[12:15], s50 offen offset:1024 lds
  buffer_load_dwordx4 v66, s[12:15], s50 offen offset:2048 lds
  s_add_u32 m0, s49, 101640
  s_add_u32 s50, s50, 6144
  buffer_load_dwordx4 v64, s[12:15], s50 offen offset:0 lds
  buffer_load_dwordx4 v65, s[12:15], s50 offen offset:1024 lds
  buffer_load_dwordx4 v66, s[12:15], s50 offen offset:2048 lds
  s_lshr_b32 s51, s2, 5
  s_and_b32 s52, s2, 3
  s_lshl2_add_u32 s36, s51, s52
  s_lshl_b32 s36, s36, 2
  s_mul_i32 s51, s51, 144
  s_lshr_b32 s52, s52, 1
  s_lshl1_add_u32 s52, s55, s52
  s_add_u32 s51, s51, s52
  s_mul_i32 s32, s51, 98304
  s_add_u32 s35, s32, 14155776
  s_lshl_b32 s51, s20, 11
  s_and_b32 s52, s2, 1
  s_lshl_b32 s52, s52, 8
  s_add_u32 s51, s51, s52
  s_add_u32 s37, s32, s51
  s_add_u32 s37, s37, 7110656
  s_and_b32 s23, s2, 28
  s_lshr_b32 s61, s2, 5
  s_lshl2_add_u32 s61, s61, 128
  s_and_b32 s51, s2, 31
  s_cmp_eq_u32 s51, 8
  s_cselect_b32 s23, 0, s23
  s_cselect_b32 s21, s61, s36
  s_cselect_b32 s51, 180224, 0
  s_sub_u32 s37, s37, s51
  s_add_u32 s38, s37, 8192
  s_cmp_lg_u32 s23, 0
  s_cbranch_scc1 L_np0
  s_load_dword s84, s[24:25], s37 glc
  s_load_dword s85, s[24:25], s38 glc
L_np0:
  s_lshl_b32 s53, s55, 2
  v_lshrrev_b32 v17, 4, v28
  v_add_u32 v18, s54, v17
  v_subrev_u32 v19, 3, v18
  v_min_u32 v18, v18, v19
  v_and_b32 v20, 15, v28
  v_xor_b32 v19, s53, v20
  v_lshlrev_b32 v19, 4, v19
  v_lshl_add_u32 v19, v18, 8, v19
  v_cmp_lt_u32 vcc, 47, v28
  s_lshl_b32 s50, s20, 10
  s_add_u32 m0, s50, 147968
  v_cndmask_b32 v19, v19, v66, vcc
  s_mov_b32 s16, s26
  s_and_b32 s17, s27, 0xffff
  s_mov_b32 s18, 768
  s_mov_b32 s19, 0x00020000
  buffer_load_dwordx4 v19, s[16:19], 0 offen lds
  s_add_u32 s43, s42, 98304
  s_cmp_eq_u32 s54, 2
  s_cselect_b32 s43, 0, s43
  s_add_u32 s44, s43, 98304
  s_cmp_eq_u32 s54, 1
  s_cselect_b32 s44, 0, s44
  s_xor_b32 s46, s55, 1
  s_mul_i32 s46, s46, 24576
  s_xor_b32 s47, s55, 2
  s_mul_i32 s47, s47, 24576
  s_xor_b32 s48, s55, 3
  s_mul_i32 s48, s48, 24576
  s_mov_b32 s4, s24
  s_and_b32 s5, s25, 0xffff
  s_mov_b32 s6, 113246208
  s_mov_b32 s7, 0x00020000
  s_add_u32 s33, s24, 49152
  s_mov_b32 s40, 113246208
  s_mov_b32 s26, 4294942720
  s_mov_b32 s27, 24576
  s_lshl_b32 s39, s20, 10
  s_mov_b32 s76, s40
  s_mov_b32 s77, 0
  s_mov_b32 s78, s40
  s_mov_b32 s79, 0
  s_mov_b32 s80, s40
  s_mov_b32 s81, 0
  s_lshr_b32 s34, s2, 1
  s_xor_b32 s34, s34, s2
  s_and_b32 s34, s34, 4
  s_and_b32 s51, s2, 1
  s_or_b32 s34, s34, s51
  s_lshl_b32 s34, s34, 19
  v_lshrrev_b32 v35, 4, v0
  v_xor_b32 v22, s53, v20
  v_mul_u32_u24 v32, 43, v35
  v_lshrrev_b32 v32, 7, v32
  v_mul_u32_u24 v18, 3, v32
  v_sub_u32 v19, v35, v18
  v_add_u32 v19, s54, v19
  v_subrev_u32 v21, 3, v19
  v_min_u32 v19, v19, v21
  v_add_u32 v19, v19, v18
  v_xor_b32 v21, v32, v22
  v_lshlrev_b32 v21, 4, v21
  v_lshl_add_u32 v8, v19, 8, v21
  v_cmp_eq_u32 vcc, 5, v32
  s_nop 1
  v_cndmask_b32 v12, 0, -1, vcc
  v_add_u32 v36, 16, v35
  v_mul_u32_u24 v33, 43, v36
  v_lshrrev_b32 v33, 7, v33
  v_mul_u32_u24 v18, 3, v33
  v_sub_u32 v19, v36, v18
  v_add_u32 v19, s54, v19
  v_subrev_u32 v21, 3, v19
  v_min_u32 v19, v19, v21
  v_add_u32 v19, v19, v18
  v_xor_b32 v21, v33, v22
  v_lshlrev_b32 v21, 4, v21
  v_lshl_add_u32 v9, v19, 8, v21
  v_add_u32 v37, 32, v35
  v_mul_u32_u24 v34, 43, v37
  v_lshrrev_b32 v34, 7, v34
  v_mul_u32_u24 v18, 3, v34
  v_sub_u32 v19, v37, v18
  v_add_u32 v19, s54, v19
  v_subrev_u32 v21, 3, v19
  v_min_u32 v19, v19, v21
  v_add_u32 v19, v19, v18
  v_xor_b32 v21, v34, v22
  v_lshlrev_b32 v21, 4, v21
  v_lshl_add_u32 v10, v19, 8, v21
  v_cmp_eq_u32 vcc, 10, v34
  s_nop 1
  v_cndmask_b32 v11, 0, -1, vcc
  s_mov_b32 s8, s30
  s_and_b32 s9, s31, 0xffff
  s_mov_b32 s10, 113246208
  s_mov_b32 s11, 0x00020000
  v_lshlrev_b32 v80, 4, v0
  v_and_b32 v21, 7, v32
  v_xor_b32 v21, v21, v20
  v_lshlrev_b32 v21, 4, v21
  v_lshl_add_u32 v21, v35, 8, v21
  v_add_u32 v5, 98560, v21
  v_add_u32 v81, 4096, v80
  v_and_b32 v21, 7, v33
  v_xor_b32 v21, v21, v20
  v_lshlrev_b32 v21, 4, v21
  v_lshl_add_u32 v21, v36, 8, v21
  v_add_u32 v6, 98560, v21
  v_add_u32 v82, 8192, v80
  v_and_b32 v21, 7, v34
  v_xor_b32 v21, v21, v20
  v_lshlrev_b32 v21, 4, v21
  v_lshl_add_u32 v21, v37, 8, v21
  v_add_u32 v7, 98560, v21
  v_mul_u32_u24 v16, 0x300, v20
  v_xor_b32 v18, v17, v20
  v_lshl_add_u32 v1, v18, 4, v16
  v_xor_b32 v2, 64, v1
  v_xor_b32 v3, 128, v1
  v_xor_b32 v4, 192, v1
  s_mul_i32 s51, s20, 12
  v_and_b32 v18, 7, v20
  v_add_u32 v19, s51, v17
  v_xor_b32 v19, v19, v18
  v_lshl_add_u32 v86, v19, 4, v16
  v_add_u32 v86, 98560, v86
  v_add_u32 v19, s51, v17
  v_add_u32 v19, 4, v19
  v_xor_b32 v19, v19, v18
  v_lshl_add_u32 v87, v19, 4, v16
  v_add_u32 v87, 98560, v87
  v_bfe_u32 v18, v28, 2, 2
  v_and_b32 v19, 3, v28
  v_lshrrev_b32 v21, 1, v17
  v_lshl_add_u32 v21, v21, 3, v18
  v_mul_u32_u24 v21, 192, v21
  v_and_b32 v23, 1, v17
  v_mul_u32_u24 v23, 3080, v23
  v_add_u32 v21, v21, v23
  v_lshl_add_u32 v21, v19, 4, v21
  s_add_u32 s51, s49, 49152
  v_add_u32 v71, s51, v21
  v_add_u32 v67, 49408, v71
  s_add_u32 s51, s39, 147968
  v_lshl_add_u32 v68, v17, 4, s51
  v_and_b32 v21, 1, v28
  v_lshlrev_b32 v21, 4, v21
  v_mov_b32 v23, 0xffff
  v_lshlrev_b32 v21, v21, v23
  v_lshlrev_b32 v16, 1, v17
  v_bfe_u32 v23, v28, 1, 3
  v_cmp_eq_u32 vcc, v16, v23
  v_add_u32 v16, 1, v16
  s_nop 0
  v_cndmask_b32 v69, 0, v21, vcc
  v_cmp_eq_u32 vcc, v16, v23
  s_mov_b32 s16, s92
  s_and_b32 s17, s93, 0xffff
  s_mov_b32 s18, 256
  s_mov_b32 s19, 0x00020000
  v_cndmask_b32 v70, 0, v21, vcc
  s_add_u32 m0, s49, 123200
  s_add_u32 s50, s42, s46
  buffer_load_dwordx4 v64, s[12:15], s50 offen offset:0 lds
  buffer_load_dwordx4 v65, s[12:15], s50 offen offset:1024 lds
  buffer_load_dwordx4 v66, s[12:15], s50 offen offset:2048 lds
  s_add_u32 m0, s49, 126280
  s_add_u32 s50, s50, 6144
  buffer_load_dwordx4 v64, s[12:15], s50 offen offset:0 lds
  buffer_load_dwordx4 v65, s[12:15], s50 offen offset:1024 lds
  buffer_load_dwordx4 v66, s[12:15], s50 offen offset:2048 lds
  s_add_u32 m0, s49, 49152
  s_add_u32 s50, s42, s47
  buffer_load_dwordx4 v64, s[12:15], s50 offen offset:0 lds
  buffer_load_dwordx4 v65, s[12:15], s50 offen offset:1024 lds
  buffer_load_dwordx4 v66, s[12:15], s50 offen offset:2048 lds
  s_add_u32 m0, s49, 52232
  s_add_u32 s50, s50, 6144
  buffer_load_dwordx4 v64, s[12:15], s50 offen offset:0 lds
  buffer_load_dwordx4 v65, s[12:15], s50 offen offset:1024 lds
  buffer_load_dwordx4 v66, s[12:15], s50 offen offset:2048 lds
  s_cmp_lg_u32 s23, 0
  s_cbranch_scc1 L_npr
  s_mov_b32 s41, 0xffff
  s_mov_b32 s88, 0xffff
  s_lshl_b32 s52, s20, 2
  s_add_u32 s52, s52, 152064
  v_mov_b32 v16, s52
  s_waitcnt lgkmcnt(0)
  s_memtime s[84:85]
  s_load_dword s52, s[24:25], s37 glc
  s_waitcnt lgkmcnt(0)
  s_memtime s[86:87]
  s_load_dword s52, s[24:25], s38 glc
  s_waitcnt lgkmcnt(0)
  s_sub_u32 s51, s86, s84
  s_memtime s[84:85]
  s_min_u32 s41, s41, s51
  s_waitcnt lgkmcnt(0)
  s_sub_u32 s51, s84, s86
  s_min_u32 s88, s88, s51
  s_lshl_b32 s41, s41, 16
  s_or_b32 s41, s41, s88
  v_mov_b32 v18, s41
  ds_write_b32 v16, v18
  s_waitcnt lgkmcnt(0)
L_npr:
  s_add_u32 m0, s49, 73792
  s_add_u32 s50, s42, s48
  buffer_load_dwordx4 v64, s[12:15], s50 offen offset:0 lds
  buffer_load_dwordx4 v65, s[12:15], s50 offen offset:1024 lds
  buffer_load_dwordx4 v66, s[12:15], s50 offen offset:2048 lds
  s_add_u32 m0, s49, 76872
  s_add_u32 s50, s50, 6144
  buffer_load_dwordx4 v64, s[12:15], s50 offen offset:0 lds
  buffer_load_dwordx4 v65, s[12:15], s50 offen offset:1024 lds
  buffer_load_dwordx4 v66, s[12:15], s50 offen offset:2048 lds
  s_waitcnt vmcnt(18)
  ds_read_b128 v[72:75], v68 offset:0
  ds_read_b64_tr_b16 a[192:193], v67 offset:0
  ds_read_b64_tr_b16 a[194:195], v67 offset:768
  ds_read_b64_tr_b16 a[196:197], v67 offset:8
  ds_read_b64_tr_b16 a[198:199], v67 offset:776
  ds_read_b64_tr_b16 a[200:201], v67 offset:64
  ds_read_b64_tr_b16 a[202:203], v67 offset:832
  ds_read_b64_tr_b16 a[204:205], v67 offset:72
  ds_read_b64_tr_b16 a[206:207], v67 offset:840
  ds_read_b64_tr_b16 a[208:209], v67 offset:128
  ds_read_b64_tr_b16 a[210:211], v67 offset:896
  ds_read_b64_tr_b16 a[212:213], v67 offset:136
  ds_read_b64_tr_b16 a[214:215], v67 offset:904
  s_waitcnt lgkmcnt(0)
  v_and_b32 v72, v69, v72
  v_and_b32 v73, v70, v73
  v_and_b32 v74, v69, v74
  v_and_b32 v75, v70, v75
  s_waitcnt vmcnt(12)
  ds_read_b128 v[76:79], v68 offset:64
  v_mfma_f32_16x16x16_bf16 v[16:19], v[72:73], a[192:193], 0
  ds_read_b64_tr_b16 a[216:217], v67 offset:24640
  ds_read_b64_tr_b16 a[218:219], v67 offset:25408
  v_mfma_f32_16x16x16_bf16 v[20:23], v[74:75], a[194:195], 0
  ds_read_b64_tr_b16 a[220:221], v67 offset:24648
  ds_read_b64_tr_b16 a[222:223], v67 offset:25416
  v_mfma_f32_16x16x16_bf16 v[24:27], v[72:73], a[196:197], 0
  ds_read_b64_tr_b16 a[224:225], v67 offset:24704
  ds_read_b64_tr_b16 a[226:227], v67 offset:25472
  v_mfma_f32_16x16x16_bf16 v[28:31], v[74:75], a[198:199], 0
  ds_read_b64_tr_b16 a[228:229], v67 offset:24712
  ds_read_b64_tr_b16 a[230:231], v67 offset:25480
  v_mfma_f32_16x16x16_bf16 v[32:35], v[72:73], a[200:201], 0
  ds_read_b64_tr_b16 a[232:233], v67 offset:24768
  ds_read_b64_tr_b16 a[234:235], v67 offset:25536
  v_cvt_pk_bf16_f32 v88, v16, v17
  v_cvt_pk_bf16_f32 v89, v18, v19
  v_mfma_f32_16x16x16_bf16 v[36:39], v[74:75], a[202:203], 0
  ds_read_b64_tr_b16 a[236:237], v67 offset:24776
  ds_read_b64_tr_b16 a[238:239], v67 offset:25544
  v_cvt_pk_bf16_f32 v90, v20, v21
  v_cvt_pk_bf16_f32 v91, v22, v23
  v_mfma_f32_16x16x16_bf16 v[40:43], v[72:73], a[204:205], 0
  s_add_u32 m0, s49, 98560
  s_add_u32 s50, s43, s45
  v_cvt_pk_bf16_f32 v92, v24, v25
  v_cvt_pk_bf16_f32 v93, v26, v27
  v_mfma_f32_16x16x16_bf16 v[44:47], v[74:75], a[206:207], 0
  buffer_load_dwordx4 v64, s[12:15], s50 offen offset:0 lds
  buffer_load_dwordx4 v65, s[12:15], s50 offen offset:1024 lds
  v_cvt_pk_bf16_f32 v94, v28, v29
  v_cvt_pk_bf16_f32 v95, v30, v31
  v_mfma_f32_16x16x16_bf16 v[48:51], v[72:73], a[208:209], 0
  buffer_load_dwordx4 v66, s[12:15], s50 offen offset:2048 lds
  s_add_u32 m0, s49, 101640
  v_cvt_pk_bf16_f32 v96, v32, v33
  v_cvt_pk_bf16_f32 v97, v34, v35
  v_mfma_f32_16x16x16_bf16 v[52:55], v[74:75], a[210:211], 0
  s_add_u32 s50, s50, 6144
  buffer_load_dwordx4 v64, s[12:15], s50 offen offset:0 lds
  v_cvt_pk_bf16_f32 v98, v36, v37
  v_cvt_pk_bf16_f32 v99, v38, v39
  v_mfma_f32_16x16x16_bf16 v[56:59], v[72:73], a[212:213], 0
  buffer_load_dwordx4 v65, s[12:15], s50 offen offset:1024 lds
  v_cvt_pk_bf16_f32 v100, v40, v41
  v_cvt_pk_bf16_f32 v101, v42, v43
  v_mfma_f32_16x16x16_bf16 v[60:63], v[74:75], a[214:215], 0
  buffer_load_dwordx4 v66, s[12:15], s50 offen offset:2048 lds
  v_cvt_pk_bf16_f32 v102, v44, v45
  v_cvt_pk_bf16_f32 v103, v46, v47
  s_cmp_lg_u32 s23, 0
  s_cbranch_scc1 L_np1
  s_barrier
  s_or_b32 s51, s23, s20
  s_cmp_lg_u32 s51, 0
  s_cbranch_scc1 L_np1
  v_mov_b32 v248, 152064
  ds_read_b128 v[240:243], v248
  s_add_u32 s51, s33, s32
  s_add_u32 s51, s51, 7077888
  s_lshr_b32 s52, s51, 20
  s_lshr_b32 s50, s2, 1
  s_xor_b32 s52, s52, s50
  s_and_b32 s52, s52, 2
  s_lshr_b32 s51, s51, 17
  s_and_b32 s51, s51, 4
  s_or_b32 s51, s51, s52
  s_or_b32 s51, s51, 1
  v_mov_b32 v251, 0
  v_mov_b32 v248, s21
  s_waitcnt lgkmcnt(0)
  v_pk_min_u16 v240, v240, v241
  v_pk_min_u16 v242, v242, v243
  v_pk_min_u16 v240, v240, v242
  v_lshrrev_b32 v241, 16, v240
  v_and_b32 v240, 0xffff, v240
  v_cmp_gt_u32 vcc, v241, v240
  v_min_u32 v242, v240, v241
  s_nop 0
  v_cndmask_b32 v250, 0, 2, vcc
  v_xor_b32 v250, s51, v250
  s_mov_b64 exec, 1
  v_lshl_or_b32 v250, v242, 16, v250
  buffer_atomic_cmpswap v[250:251], v248, s[16:19], 0 offen sc1
  s_mov_b64 exec, -1
L_np1:
  s_waitcnt lgkmcnt(0)
  v_and_b32 v76, v69, v76
  v_and_b32 v77, v70, v77
  v_and_b32 v78, v69, v78
  v_and_b32 v79, v70, v79
  s_waitcnt vmcnt(12)
  ds_read_b128 v[72:75], v68 offset:128
  v_mfma_f32_16x16x16_bf16 v[16:19], v[76:77], a[216:217], 0
  ds_read_b64_tr_b16 a[192:193], v71 offset:0
  ds_read_b64_tr_b16 a[194:195], v71 offset:768
  v_cvt_pk_bf16_f32 v104, v48, v49
  v_cvt_pk_bf16_f32 v105, v50, v51
  v_mfma_f32_16x16x16_bf16 v[20:23], v[78:79], a[218:219], 0
  ds_read_b64_tr_b16 a[196:197], v71 offset:8
  ds_read_b64_tr_b16 a[198:199], v71 offset:776
  v_cvt_pk_bf16_f32 v106, v52, v53
  v_cvt_pk_bf16_f32 v107, v54, v55
  v_mfma_f32_16x16x16_bf16 v[24:27], v[76:77], a[220:221], 0
  ds_read_b64_tr_b16 a[200:201], v71 offset:64
  ds_read_b64_tr_b16 a[202:203], v71 offset:832
  v_cvt_pk_bf16_f32 v108, v56, v57
  v_cvt_pk_bf16_f32 v109, v58, v59
  v_mfma_f32_16x16x16_bf16 v[28:31], v[78:79], a[222:223], 0
  ds_read_b64_tr_b16 a[204:205], v71 offset:72
  ds_read_b64_tr_b16 a[206:207], v71 offset:840
  v_cvt_pk_bf16_f32 v110, v60, v61
  v_cvt_pk_bf16_f32 v111, v62, v63
  v_mfma_f32_16x16x16_bf16 v[32:35], v[76:77], a[224:225], 0
  ds_read_b64_tr_b16 a[208:209], v71 offset:128
  ds_read_b64_tr_b16 a[210:211], v71 offset:896
  v_cvt_pk_bf16_f32 v16, v16, v17
  v_cvt_pk_bf16_f32 v17, v18, v19
  v_accvgpr_write_b32 a0, v16
  v_accvgpr_write_b32 a1, v17
  v_mfma_f32_16x16x16_bf16 v[36:39], v[78:79], a[226:227], 0
  ds_read_b64_tr_b16 a[212:213], v71 offset:136
  ds_read_b64_tr_b16 a[214:215], v71 offset:904
  v_cvt_pk_bf16_f32 v20, v20, v21
  v_cvt_pk_bf16_f32 v21, v22, v23
  v_accvgpr_write_b32 a2, v20
  v_accvgpr_write_b32 a3, v21
  v_mfma_f32_16x16x16_bf16 v[40:43], v[76:77], a[228:229], 0
  s_add_u32 m0, s49, 123200
  s_add_u32 s50, s43, s46
  v_cvt_pk_bf16_f32 v24, v24, v25
  v_cvt_pk_bf16_f32 v25, v26, v27
  v_accvgpr_write_b32 a4, v24
  v_accvgpr_write_b32 a5, v25
  v_mfma_f32_16x16x16_bf16 v[44:47], v[78:79], a[230:231], 0
  buffer_load_dwordx4 v64, s[12:15], s50 offen offset:0 lds
  buffer_load_dwordx4 v65, s[12:15], s50 offen offset:1024 lds
  v_cvt_pk_bf16_f32 v28, v28, v29
  v_cvt_pk_bf16_f32 v29, v30, v31
  v_accvgpr_write_b32 a6, v28
  v_accvgpr_write_b32 a7, v29
  v_mfma_f32_16x16x16_bf16 v[48:51], v[76:77], a[232:233], 0
  buffer_load_dwordx4 v66, s[12:15], s50 offen offset:2048 lds
  s_add_u32 m0, s49, 126280
  v_cvt_pk_bf16_f32 v32, v32, v33
  v_cvt_pk_bf16_f32 v33, v34, v35
  v_accvgpr_write_b32 a8, v32
  v_accvgpr_write_b32 a9, v33
  v_mfma_f32_16x16x16_bf16 v[52:55], v[78:79], a[234:235], 0
  s_add_u32 s50, s50, 6144
  buffer_load_dwordx4 v64, s[12:15], s50 offen offset:0 lds
  v_cvt_pk_bf16_f32 v36, v36, v37
  v_cvt_pk_bf16_f32 v37, v38, v39
  v_accvgpr_write_b32 a10, v36
  v_accvgpr_write_b32 a11, v37
  v_mfma_f32_16x16x16_bf16 v[56:59], v[76:77], a[236:237], 0
  buffer_load_dwordx4 v65, s[12:15], s50 offen offset:1024 lds
  v_cvt_pk_bf16_f32 v40, v40, v41
  v_cvt_pk_bf16_f32 v41, v42, v43
  v_accvgpr_write_b32 a12, v40
  v_accvgpr_write_b32 a13, v41
  v_mfma_f32_16x16x16_bf16 v[60:63], v[78:79], a[238:239], 0
  buffer_load_dwordx4 v66, s[12:15], s50 offen offset:2048 lds
  v_cvt_pk_bf16_f32 v44, v44, v45
  v_cvt_pk_bf16_f32 v45, v46, v47
  v_accvgpr_write_b32 a14, v44
  v_accvgpr_write_b32 a15, v45
  s_waitcnt lgkmcnt(0)
  v_and_b32 v72, v69, v72
  v_and_b32 v73, v70, v73
  v_and_b32 v74, v69, v74
  v_and_b32 v75, v70, v75
  s_waitcnt vmcnt(12)
  ds_read_b128 v[76:79], v68 offset:192
  v_mfma_f32_16x16x16_bf16 v[16:19], v[72:73], a[192:193], 0
  ds_read_b64_tr_b16 a[216:217], v71 offset:24640
  ds_read_b64_tr_b16 a[218:219], v71 offset:25408
  v_cvt_pk_bf16_f32 v48, v48, v49
  v_cvt_pk_bf16_f32 v49, v50, v51
  v_accvgpr_write_b32 a16, v48
  v_accvgpr_write_b32 a17, v49
  v_mfma_f32_16x16x16_bf16 v[20:23], v[74:75], a[194:195], 0
  ds_read_b64_tr_b16 a[220:221], v71 offset:24648
  ds_read_b64_tr_b16 a[222:223], v71 offset:25416
  v_cvt_pk_bf16_f32 v52, v52, v53
  v_cvt_pk_bf16_f32 v53, v54, v55
  v_accvgpr_write_b32 a18, v52
  v_accvgpr_write_b32 a19, v53
  v_mfma_f32_16x16x16_bf16 v[24:27], v[72:73], a[196:197], 0
  ds_read_b64_tr_b16 a[224:225], v71 offset:24704
  ds_read_b64_tr_b16 a[226:227], v71 offset:25472
  v_cvt_pk_bf16_f32 v56, v56, v57
  v_cvt_pk_bf16_f32 v57, v58, v59
  v_accvgpr_write_b32 a20, v56
  v_accvgpr_write_b32 a21, v57
  v_mfma_f32_16x16x16_bf16 v[28:31], v[74:75], a[198:199], 0
  ds_read_b64_tr_b16 a[228:229], v71 offset:24712
  ds_read_b64_tr_b16 a[230:231], v71 offset:25480
  v_cvt_pk_bf16_f32 v60, v60, v61
  v_cvt_pk_bf16_f32 v61, v62, v63
  v_accvgpr_write_b32 a22, v60
  v_accvgpr_write_b32 a23, v61
  v_mfma_f32_16x16x16_bf16 v[32:35], v[72:73], a[200:201], 0
  ds_read_b64_tr_b16 a[232:233], v71 offset:24768
  ds_read_b64_tr_b16 a[234:235], v71 offset:25536
  v_cvt_pk_bf16_f32 v112, v16, v17
  v_cvt_pk_bf16_f32 v113, v18, v19
  v_mfma_f32_16x16x16_bf16 v[36:39], v[74:75], a[202:203], 0
  ds_read_b64_tr_b16 a[236:237], v71 offset:24776
  ds_read_b64_tr_b16 a[238:239], v71 offset:25544
  v_cvt_pk_bf16_f32 v114, v20, v21
  v_cvt_pk_bf16_f32 v115, v22, v23
  v_mfma_f32_16x16x16_bf16 v[40:43], v[72:73], a[204:205], 0
  s_add_u32 m0, s49, 49152
  s_add_u32 s50, s43, s47
  v_cvt_pk_bf16_f32 v116, v24, v25
  v_cvt_pk_bf16_f32 v117, v26, v27
  v_mfma_f32_16x16x16_bf16 v[44:47], v[74:75], a[206:207], 0
  buffer_load_dwordx4 v64, s[12:15], s50 offen offset:0 lds
  buffer_load_dwordx4 v65, s[12:15], s50 offen offset:1024 lds
  v_cvt_pk_bf16_f32 v118, v28, v29
  v_cvt_pk_bf16_f32 v119, v30, v31
  v_mfma_f32_16x16x16_bf16 v[48:51], v[72:73], a[208:209], 0
  buffer_load_dwordx4 v66, s[12:15], s50 offen offset:2048 lds
  s_add_u32 m0, s49, 52232
  v_cvt_pk_bf16_f32 v120, v32, v33
  v_cvt_pk_bf16_f32 v121, v34, v35
  v_mfma_f32_16x16x16_bf16 v[52:55], v[74:75], a[210:211], 0
  s_add_u32 s50, s50, 6144
  buffer_load_dwordx4 v64, s[12:15], s50 offen offset:0 lds
  v_cvt_pk_bf16_f32 v122, v36, v37
  v_cvt_pk_bf16_f32 v123, v38, v39
  v_mfma_f32_16x16x16_bf16 v[56:59], v[72:73], a[212:213], 0
  buffer_load_dwordx4 v65, s[12:15], s50 offen offset:1024 lds
  v_cvt_pk_bf16_f32 v124, v40, v41
  v_cvt_pk_bf16_f32 v125, v42, v43
  v_mfma_f32_16x16x16_bf16 v[60:63], v[74:75], a[214:215], 0
  buffer_load_dwordx4 v66, s[12:15], s50 offen offset:2048 lds
  v_cvt_pk_bf16_f32 v126, v44, v45
  v_cvt_pk_bf16_f32 v127, v46, v47
  s_waitcnt lgkmcnt(0)
  v_and_b32 v76, v69, v76
  v_and_b32 v77, v70, v77
  v_and_b32 v78, v69, v78
  v_and_b32 v79, v70, v79
  s_waitcnt vmcnt(12)
  ds_read_b128 v[72:75], v68 offset:256
  v_mfma_f32_16x16x16_bf16 v[16:19], v[76:77], a[216:217], 0
  ds_read_b64_tr_b16 a[192:193], v67 offset:0
  ds_read_b64_tr_b16 a[194:195], v67 offset:768
  v_cvt_pk_bf16_f32 v128, v48, v49
  v_cvt_pk_bf16_f32 v129, v50, v51
  v_mfma_f32_16x16x16_bf16 v[20:23], v[78:79], a[218:219], 0
  ds_read_b64_tr_b16 a[196:197], v67 offset:8
  ds_read_b64_tr_b16 a[198:199], v67 offset:776
  v_cvt_pk_bf16_f32 v130, v52, v53
  v_cvt_pk_bf16_f32 v131, v54, v55
  v_mfma_f32_16x16x16_bf16 v[24:27], v[76:77], a[220:221], 0
  ds_read_b64_tr_b16 a[200:201], v67 offset:64
  ds_read_b64_tr_b16 a[202:203], v67 offset:832
  v_cvt_pk_bf16_f32 v132, v56, v57
  v_cvt_pk_bf16_f32 v133, v58, v59
  v_mfma_f32_16x16x16_bf16 v[28:31], v[78:79], a[222:223], 0
  ds_read_b64_tr_b16 a[204:205], v67 offset:72
  ds_read_b64_tr_b16 a[206:207], v67 offset:840
  v_cvt_pk_bf16_f32 v134, v60, v61
  v_cvt_pk_bf16_f32 v135, v62, v63
  v_mfma_f32_16x16x16_bf16 v[32:35], v[76:77], a[224:225], 0
  ds_read_b64_tr_b16 a[208:209], v67 offset:128
  ds_read_b64_tr_b16 a[210:211], v67 offset:896
  v_cvt_pk_bf16_f32 v16, v16, v17
  v_cvt_pk_bf16_f32 v17, v18, v19
  v_accvgpr_write_b32 a24, v16
  v_accvgpr_write_b32 a25, v17
  v_mfma_f32_16x16x16_bf16 v[36:39], v[78:79], a[226:227], 0
  ds_read_b64_tr_b16 a[212:213], v67 offset:136
  ds_read_b64_tr_b16 a[214:215], v67 offset:904
  v_cvt_pk_bf16_f32 v20, v20, v21
  v_cvt_pk_bf16_f32 v21, v22, v23
  v_accvgpr_write_b32 a26, v20
  v_accvgpr_write_b32 a27, v21
  v_mfma_f32_16x16x16_bf16 v[40:43], v[76:77], a[228:229], 0
  s_add_u32 m0, s49, 73792
  s_add_u32 s50, s43, s48
  v_cvt_pk_bf16_f32 v24, v24, v25
  v_cvt_pk_bf16_f32 v25, v26, v27
  v_accvgpr_write_b32 a28, v24
  v_accvgpr_write_b32 a29, v25
  v_mfma_f32_16x16x16_bf16 v[44:47], v[78:79], a[230:231], 0
  buffer_load_dwordx4 v64, s[12:15], s50 offen offset:0 lds
  buffer_load_dwordx4 v65, s[12:15], s50 offen offset:1024 lds
  v_cvt_pk_bf16_f32 v28, v28, v29
  v_cvt_pk_bf16_f32 v29, v30, v31
  v_accvgpr_write_b32 a30, v28
  v_accvgpr_write_b32 a31, v29
  v_mfma_f32_16x16x16_bf16 v[48:51], v[76:77], a[232:233], 0
  buffer_load_dwordx4 v66, s[12:15], s50 offen offset:2048 lds
  s_add_u32 m0, s49, 76872
  v_cvt_pk_bf16_f32 v32, v32, v33
  v_cvt_pk_bf16_f32 v33, v34, v35
  v_accvgpr_write_b32 a32, v32
  v_accvgpr_write_b32 a33, v33
  v_mfma_f32_16x16x16_bf16 v[52:55], v[78:79], a[234:235], 0
  s_add_u32 s50, s50, 6144
  buffer_load_dwordx4 v64, s[12:15], s50 offen offset:0 lds
  v_cvt_pk_bf16_f32 v36, v36, v37
  v_cvt_pk_bf16_f32 v37, v38, v39
  v_accvgpr_write_b32 a34, v36
  v_accvgpr_write_b32 a35, v37
  v_mfma_f32_16x16x16_bf16 v[56:59], v[76:77], a[236:237], 0
  buffer_load_dwordx4 v65, s[12:15], s50 offen offset:1024 lds
  v_cvt_pk_bf16_f32 v40, v40, v41
  v_cvt_pk_bf16_f32 v41, v42, v43
  v_accvgpr_write_b32 a36, v40
  v_accvgpr_write_b32 a37, v41
  v_mfma_f32_16x16x16_bf16 v[60:63], v[78:79], a[238:239], 0
  buffer_load_dwordx4 v66, s[12:15], s50 offen offset:2048 lds
  v_cvt_pk_bf16_f32 v44, v44, v45
  v_cvt_pk_bf16_f32 v45, v46, v47
  v_accvgpr_write_b32 a38, v44
  v_accvgpr_write_b32 a39, v45
  s_waitcnt lgkmcnt(0)
  v_and_b32 v72, v69, v72
  v_and_b32 v73, v70, v73
  v_and_b32 v74, v69, v74
  v_and_b32 v75, v70, v75
  s_waitcnt vmcnt(12)
  ds_read_b128 v[76:79], v68 offset:320
  v_mfma_f32_16x16x16_bf16 v[16:19], v[72:73], a[192:193], 0
  ds_read_b64_tr_b16 a[216:217], v67 offset:24640
  ds_read_b64_tr_b16 a[218:219], v67 offset:25408
  v_cvt_pk_bf16_f32 v48, v48, v49
  v_cvt_pk_bf16_f32 v49, v50, v51
  v_accvgpr_write_b32 a40, v48
  v_accvgpr_write_b32 a41, v49
  v_mfma_f32_16x16x16_bf16 v[20:23], v[74:75], a[194:195], 0
  ds_read_b64_tr_b16 a[220:221], v67 offset:24648
  ds_read_b64_tr_b16 a[222:223], v67 offset:25416
  v_cvt_pk_bf16_f32 v52, v52, v53
  v_cvt_pk_bf16_f32 v53, v54, v55
  v_accvgpr_write_b32 a42, v52
  v_accvgpr_write_b32 a43, v53
  v_mfma_f32_16x16x16_bf16 v[24:27], v[72:73], a[196:197], 0
  ds_read_b64_tr_b16 a[224:225], v67 offset:24704
  ds_read_b64_tr_b16 a[226:227], v67 offset:25472
  v_cvt_pk_bf16_f32 v56, v56, v57
  v_cvt_pk_bf16_f32 v57, v58, v59
  v_accvgpr_write_b32 a44, v56
  v_accvgpr_write_b32 a45, v57
  v_mfma_f32_16x16x16_bf16 v[28:31], v[74:75], a[198:199], 0
  ds_read_b64_tr_b16 a[228:229], v67 offset:24712
  ds_read_b64_tr_b16 a[230:231], v67 offset:25480
  v_cvt_pk_bf16_f32 v60, v60, v61
  v_cvt_pk_bf16_f32 v61, v62, v63
  v_accvgpr_write_b32 a46, v60
  v_accvgpr_write_b32 a47, v61
  v_mfma_f32_16x16x16_bf16 v[32:35], v[72:73], a[200:201], 0
  ds_read_b64_tr_b16 a[232:233], v67 offset:24768
  ds_read_b64_tr_b16 a[234:235], v67 offset:25536
  v_cvt_pk_bf16_f32 v136, v16, v17
  v_cvt_pk_bf16_f32 v137, v18, v19
  v_mfma_f32_16x16x16_bf16 v[36:39], v[74:75], a[202:203], 0
  ds_read_b64_tr_b16 a[236:237], v67 offset:24776
  ds_read_b64_tr_b16 a[238:239], v67 offset:25544
  v_cvt_pk_bf16_f32 v138, v20, v21
  v_cvt_pk_bf16_f32 v139, v22, v23
  v_mfma_f32_16x16x16_bf16 v[40:43], v[72:73], a[204:205], 0
  s_add_u32 m0, s49, 98560
  s_add_u32 s50, s44, s45
  v_cvt_pk_bf16_f32 v140, v24, v25
  v_cvt_pk_bf16_f32 v141, v26, v27
  v_mfma_f32_16x16x16_bf16 v[44:47], v[74:75], a[206:207], 0
  buffer_load_dwordx4 v64, s[12:15], s50 offen offset:0 lds
  buffer_load_dwordx4 v65, s[12:15], s50 offen offset:1024 lds
  v_cvt_pk_bf16_f32 v142, v28, v29
  v_cvt_pk_bf16_f32 v143, v30, v31
  v_mfma_f32_16x16x16_bf16 v[48:51], v[72:73], a[208:209], 0
  buffer_load_dwordx4 v66, s[12:15], s50 offen offset:2048 lds
  s_add_u32 m0, s49, 101640
  v_cvt_pk_bf16_f32 v144, v32, v33
  v_cvt_pk_bf16_f32 v145, v34, v35
  v_mfma_f32_16x16x16_bf16 v[52:55], v[74:75], a[210:211], 0
  s_add_u32 s50, s50, 6144
  buffer_load_dwordx4 v64, s[12:15], s50 offen offset:0 lds
  v_cvt_pk_bf16_f32 v146, v36, v37
  v_cvt_pk_bf16_f32 v147, v38, v39
  v_mfma_f32_16x16x16_bf16 v[56:59], v[72:73], a[212:213], 0
  buffer_load_dwordx4 v65, s[12:15], s50 offen offset:1024 lds
  v_cvt_pk_bf16_f32 v148, v40, v41
  v_cvt_pk_bf16_f32 v149, v42, v43
  v_mfma_f32_16x16x16_bf16 v[60:63], v[74:75], a[214:215], 0
  buffer_load_dwordx4 v66, s[12:15], s50 offen offset:2048 lds
  v_cvt_pk_bf16_f32 v150, v44, v45
  v_cvt_pk_bf16_f32 v151, v46, v47
  s_waitcnt lgkmcnt(0)
  v_and_b32 v76, v69, v76
  v_and_b32 v77, v70, v77
  v_and_b32 v78, v69, v78
  v_and_b32 v79, v70, v79
  s_waitcnt vmcnt(12)
  ds_read_b128 v[72:75], v68 offset:384
  v_mfma_f32_16x16x16_bf16 v[16:19], v[76:77], a[216:217], 0
  ds_read_b64_tr_b16 a[192:193], v71 offset:0
  ds_read_b64_tr_b16 a[194:195], v71 offset:768
  v_cvt_pk_bf16_f32 v152, v48, v49
  v_cvt_pk_bf16_f32 v153, v50, v51
  v_mfma_f32_16x16x16_bf16 v[20:23], v[78:79], a[218:219], 0
  ds_read_b64_tr_b16 a[196:197], v71 offset:8
  ds_read_b64_tr_b16 a[198:199], v71 offset:776
  v_cvt_pk_bf16_f32 v154, v52, v53
  v_cvt_pk_bf16_f32 v155, v54, v55
  v_mfma_f32_16x16x16_bf16 v[24:27], v[76:77], a[220:221], 0
  ds_read_b64_tr_b16 a[200:201], v71 offset:64
  ds_read_b64_tr_b16 a[202:203], v71 offset:832
  v_cvt_pk_bf16_f32 v156, v56, v57
  v_cvt_pk_bf16_f32 v157, v58, v59
  v_mfma_f32_16x16x16_bf16 v[28:31], v[78:79], a[222:223], 0
  ds_read_b64_tr_b16 a[204:205], v71 offset:72
  ds_read_b64_tr_b16 a[206:207], v71 offset:840
  v_cvt_pk_bf16_f32 v158, v60, v61
  v_cvt_pk_bf16_f32 v159, v62, v63
  v_mfma_f32_16x16x16_bf16 v[32:35], v[76:77], a[224:225], 0
  ds_read_b64_tr_b16 a[208:209], v71 offset:128
  ds_read_b64_tr_b16 a[210:211], v71 offset:896
  v_cvt_pk_bf16_f32 v16, v16, v17
  v_cvt_pk_bf16_f32 v17, v18, v19
  v_accvgpr_write_b32 a48, v16
  v_accvgpr_write_b32 a49, v17
  v_mfma_f32_16x16x16_bf16 v[36:39], v[78:79], a[226:227], 0
  ds_read_b64_tr_b16 a[212:213], v71 offset:136
  ds_read_b64_tr_b16 a[214:215], v71 offset:904
  v_cvt_pk_bf16_f32 v20, v20, v21
  v_cvt_pk_bf16_f32 v21, v22, v23
  v_accvgpr_write_b32 a50, v20
  v_accvgpr_write_b32 a51, v21
  v_mfma_f32_16x16x16_bf16 v[40:43], v[76:77], a[228:229], 0
  s_add_u32 m0, s49, 123200
  s_add_u32 s50, s44, s46
  v_cvt_pk_bf16_f32 v24, v24, v25
  v_cvt_pk_bf16_f32 v25, v26, v27
  v_accvgpr_write_b32 a52, v24
  v_accvgpr_write_b32 a53, v25
  v_mfma_f32_16x16x16_bf16 v[44:47], v[78:79], a[230:231], 0
  buffer_load_dwordx4 v64, s[12:15], s50 offen offset:0 lds
  buffer_load_dwordx4 v65, s[12:15], s50 offen offset:1024 lds
  v_cvt_pk_bf16_f32 v28, v28, v29
  v_cvt_pk_bf16_f32 v29, v30, v31
  v_accvgpr_write_b32 a54, v28
  v_accvgpr_write_b32 a55, v29
  v_mfma_f32_16x16x16_bf16 v[48:51], v[76:77], a[232:233], 0
  buffer_load_dwordx4 v66, s[12:15], s50 offen offset:2048 lds
  s_add_u32 m0, s49, 126280
  v_cvt_pk_bf16_f32 v32, v32, v33
  v_cvt_pk_bf16_f32 v33, v34, v35
  v_accvgpr_write_b32 a56, v32
  v_accvgpr_write_b32 a57, v33
  v_mfma_f32_16x16x16_bf16 v[52:55], v[78:79], a[234:235], 0
  s_add_u32 s50, s50, 6144
  buffer_load_dwordx4 v64, s[12:15], s50 offen offset:0 lds
  v_cvt_pk_bf16_f32 v36, v36, v37
  v_cvt_pk_bf16_f32 v37, v38, v39
  v_accvgpr_write_b32 a58, v36
  v_accvgpr_write_b32 a59, v37
  v_mfma_f32_16x16x16_bf16 v[56:59], v[76:77], a[236:237], 0
  buffer_load_dwordx4 v65, s[12:15], s50 offen offset:1024 lds
  v_cvt_pk_bf16_f32 v40, v40, v41
  v_cvt_pk_bf16_f32 v41, v42, v43
  v_accvgpr_write_b32 a60, v40
  v_accvgpr_write_b32 a61, v41
  v_mfma_f32_16x16x16_bf16 v[60:63], v[78:79], a[238:239], 0
  buffer_load_dwordx4 v66, s[12:15], s50 offen offset:2048 lds
  v_cvt_pk_bf16_f32 v44, v44, v45
  v_cvt_pk_bf16_f32 v45, v46, v47
  v_accvgpr_write_b32 a62, v44
  v_accvgpr_write_b32 a63, v45
  s_waitcnt lgkmcnt(0)
  v_and_b32 v72, v69, v72
  v_and_b32 v73, v70, v73
  v_and_b32 v74, v69, v74
  v_and_b32 v75, v70, v75
  s_waitcnt vmcnt(12)
  ds_read_b128 v[76:79], v68 offset:448
  v_mfma_f32_16x16x16_bf16 v[16:19], v[72:73], a[192:193], 0
  ds_read_b64_tr_b16 a[216:217], v71 offset:24640
  ds_read_b64_tr_b16 a[218:219], v71 offset:25408
  v_cvt_pk_bf16_f32 v48, v48, v49
  v_cvt_pk_bf16_f32 v49, v50, v51
  v_accvgpr_write_b32 a64, v48
  v_accvgpr_write_b32 a65, v49
  v_mfma_f32_16x16x16_bf16 v[20:23], v[74:75], a[194:195], 0
  ds_read_b64_tr_b16 a[220:221], v71 offset:24648
  ds_read_b64_tr_b16 a[222:223], v71 offset:25416
  v_cvt_pk_bf16_f32 v52, v52, v53
  v_cvt_pk_bf16_f32 v53, v54, v55
  v_accvgpr_write_b32 a66, v52
  v_accvgpr_write_b32 a67, v53
  v_mfma_f32_16x16x16_bf16 v[24:27], v[72:73], a[196:197], 0
  ds_read_b64_tr_b16 a[224:225], v71 offset:24704
  ds_read_b64_tr_b16 a[226:227], v71 offset:25472
  v_cvt_pk_bf16_f32 v56, v56, v57
  v_cvt_pk_bf16_f32 v57, v58, v59
  v_accvgpr_write_b32 a68, v56
  v_accvgpr_write_b32 a69, v57
  v_mfma_f32_16x16x16_bf16 v[28:31], v[74:75], a[198:199], 0
  ds_read_b64_tr_b16 a[228:229], v71 offset:24712
  ds_read_b64_tr_b16 a[230:231], v71 offset:25480
  v_cvt_pk_bf16_f32 v60, v60, v61
  v_cvt_pk_bf16_f32 v61, v62, v63
  v_accvgpr_write_b32 a70, v60
  v_accvgpr_write_b32 a71, v61
  v_mfma_f32_16x16x16_bf16 v[32:35], v[72:73], a[200:201], 0
  ds_read_b64_tr_b16 a[232:233], v71 offset:24768
  ds_read_b64_tr_b16 a[234:235], v71 offset:25536
  v_cvt_pk_bf16_f32 v160, v16, v17
  v_cvt_pk_bf16_f32 v161, v18, v19
  v_mfma_f32_16x16x16_bf16 v[36:39], v[74:75], a[202:203], 0
  ds_read_b64_tr_b16 a[236:237], v71 offset:24776
  ds_read_b64_tr_b16 a[238:239], v71 offset:25544
  v_cvt_pk_bf16_f32 v162, v20, v21
  v_cvt_pk_bf16_f32 v163, v22, v23
  v_mfma_f32_16x16x16_bf16 v[40:43], v[72:73], a[204:205], 0
  s_add_u32 m0, s49, 49152
  s_add_u32 s50, s44, s47
  v_cvt_pk_bf16_f32 v164, v24, v25
  v_cvt_pk_bf16_f32 v165, v26, v27
  v_mfma_f32_16x16x16_bf16 v[44:47], v[74:75], a[206:207], 0
  buffer_load_dwordx4 v64, s[12:15], s50 offen offset:0 lds
  buffer_load_dwordx4 v65, s[12:15], s50 offen offset:1024 lds
  v_cvt_pk_bf16_f32 v166, v28, v29
  v_cvt_pk_bf16_f32 v167, v30, v31
  v_mfma_f32_16x16x16_bf16 v[48:51], v[72:73], a[208:209], 0
  buffer_load_dwordx4 v66, s[12:15], s50 offen offset:2048 lds
  s_add_u32 m0, s49, 52232
  v_cvt_pk_bf16_f32 v168, v32, v33
  v_cvt_pk_bf16_f32 v169, v34, v35
  v_mfma_f32_16x16x16_bf16 v[52:55], v[74:75], a[210:211], 0
  s_add_u32 s50, s50, 6144
  buffer_load_dwordx4 v64, s[12:15], s50 offen offset:0 lds
  v_cvt_pk_bf16_f32 v170, v36, v37
  v_cvt_pk_bf16_f32 v171, v38, v39
  v_mfma_f32_16x16x16_bf16 v[56:59], v[72:73], a[212:213], 0
  buffer_load_dwordx4 v65, s[12:15], s50 offen offset:1024 lds
  v_cvt_pk_bf16_f32 v172, v40, v41
  v_cvt_pk_bf16_f32 v173, v42, v43
  v_mfma_f32_16x16x16_bf16 v[60:63], v[74:75], a[214:215], 0
  buffer_load_dwordx4 v66, s[12:15], s50 offen offset:2048 lds
  v_cvt_pk_bf16_f32 v174, v44, v45
  v_cvt_pk_bf16_f32 v175, v46, v47
  s_waitcnt lgkmcnt(0)
  v_and_b32 v76, v69, v76
  v_and_b32 v77, v70, v77
  v_and_b32 v78, v69, v78
  v_and_b32 v79, v70, v79
  s_waitcnt vmcnt(12)
  ds_read_b128 v[72:75], v68 offset:512
  v_mfma_f32_16x16x16_bf16 v[16:19], v[76:77], a[216:217], 0
  ds_read_b64_tr_b16 a[192:193], v67 offset:0
  ds_read_b64_tr_b16 a[194:195], v67 offset:768
  ds_read_b64_tr_b16 a[196:197], v67 offset:8
  ds_read_b64_tr_b16 a[198:199], v67 offset:776
  ds_read_b64_tr_b16 a[200:201], v67 offset:64
  ds_read_b64_tr_b16 a[202:203], v67 offset:832
  v_cvt_pk_bf16_f32 v176, v48, v49
  v_cvt_pk_bf16_f32 v177, v50, v51
  v_mfma_f32_16x16x16_bf16 v[20:23], v[78:79], a[218:219], 0
  ds_read_b64_tr_b16 a[204:205], v67 offset:72
  ds_read_b64_tr_b16 a[206:207], v67 offset:840
  ds_read_b64_tr_b16 a[208:209], v67 offset:128
  ds_read_b64_tr_b16 a[210:211], v67 offset:896
  ds_read_b64_tr_b16 a[212:213], v67 offset:136
  ds_read_b64_tr_b16 a[214:215], v67 offset:904
  v_cvt_pk_bf16_f32 v178, v52, v53
  v_cvt_pk_bf16_f32 v179, v54, v55
  v_mfma_f32_16x16x16_bf16 v[24:27], v[76:77], a[220:221], 0
  s_add_u32 m0, s49, 73792
  s_add_u32 s50, s44, s48
  buffer_load_dwordx4 v64, s[12:15], s50 offen offset:0 lds
  buffer_load_dwordx4 v65, s[12:15], s50 offen offset:1024 lds
  buffer_load_dwordx4 v66, s[12:15], s50 offen offset:2048 lds
  s_add_u32 m0, s49, 76872
  v_cvt_pk_bf16_f32 v180, v56, v57
  v_cvt_pk_bf16_f32 v181, v58, v59
  v_mfma_f32_16x16x16_bf16 v[28:31], v[78:79], a[222:223], 0
  s_add_u32 s50, s50, 6144
  buffer_load_dwordx4 v64, s[12:15], s50 offen offset:0 lds
  buffer_load_dwordx4 v65, s[12:15], s50 offen offset:1024 lds
  buffer_load_dwordx4 v66, s[12:15], s50 offen offset:2048 lds
  s_mov_b64 s[82:83], s[80:81]
  s_mov_b64 s[80:81], s[78:79]
  v_cvt_pk_bf16_f32 v182, v60, v61
  v_cvt_pk_bf16_f32 v183, v62, v63
  v_mfma_f32_16x16x16_bf16 v[32:35], v[76:77], a[224:225], 0
  s_mov_b64 s[78:79], s[76:77]
  s_add_u32 s76, s33, s32
  s_xor_b32 s76, s76, s34
  s_bfe_u32 s77, s76, 65557
  s_bfe_u32 s76, s76, 65555
  s_lshl1_add_u32 s77, s76, s77
  v_cvt_pk_bf16_f32 v16, v16, v17
  v_cvt_pk_bf16_f32 v17, v18, v19
  v_accvgpr_write_b32 a72, v16
  v_accvgpr_write_b32 a73, v17
  v_mfma_f32_16x16x16_bf16 v[36:39], v[78:79], a[226:227], 0
  s_sub_u32 s77, 1, s77
  s_and_b32 s77, s77, 3
  s_mul_i32 s77, s77, 24576
  s_cmp_lt_u32 s32, s35
  s_cselect_b32 s76, s32, s40
  s_add_u32 s32, s32, 786432
  v_cvt_pk_bf16_f32 v20, v20, v21
  v_cvt_pk_bf16_f32 v21, v22, v23
  v_accvgpr_write_b32 a74, v20
  v_accvgpr_write_b32 a75, v21
  v_mfma_f32_16x16x16_bf16 v[40:43], v[76:77], a[228:229], 0
  s_cmp_eq_u32 s77, 0
  s_cselect_b32 s57, 73728, s26
  s_add_u32 s22, s76, s77
  s_add_u32 s22, s22, s57
  s_min_u32 s22, s22, s40
  s_add_u32 m0, s39, 0
  v_cvt_pk_bf16_f32 v24, v24, v25
  v_cvt_pk_bf16_f32 v25, v26, v27
  v_accvgpr_write_b32 a76, v24
  v_accvgpr_write_b32 a77, v25
  v_mfma_f32_16x16x16_bf16 v[44:47], v[78:79], a[230:231], 0
  s_nop 0
  buffer_load_dwordx4 v8, s[4:7], s22 offen nt lds
  s_add_u32 m0, s39, 4096
  s_nop 0
  buffer_load_dwordx4 v9, s[4:7], s22 offen nt lds
  v_and_b32 v15, s57, v11
  v_cvt_pk_bf16_f32 v28, v28, v29
  v_cvt_pk_bf16_f32 v29, v30, v31
  v_accvgpr_write_b32 a78, v28
  v_accvgpr_write_b32 a79, v29
  v_mfma_f32_16x16x16_bf16 v[48:51], v[76:77], a[232:233], 0
  v_add3_u32 v15, v10, v15, s77
  s_add_u32 m0, s39, 8192
  s_nop 0
  buffer_load_dwordx4 v15, s[4:7], s76 offen nt lds
  s_cmp_eq_u32 s77, 73728
  s_cselect_b32 s57, 4294893568, s27
  v_cvt_pk_bf16_f32 v32, v32, v33
  v_cvt_pk_bf16_f32 v33, v34, v35
  v_accvgpr_write_b32 a80, v32
  v_accvgpr_write_b32 a81, v33
  v_mfma_f32_16x16x16_bf16 v[52:55], v[78:79], a[234:235], 0
  s_add_u32 s90, s77, 12288
  s_add_u32 s56, s76, s90
  s_add_u32 s56, s56, s57
  s_min_u32 s56, s56, s40
  v_and_b32 v15, s57, v12
  v_cvt_pk_bf16_f32 v36, v36, v37
  v_cvt_pk_bf16_f32 v37, v38, v39
  v_accvgpr_write_b32 a82, v36
  v_accvgpr_write_b32 a83, v37
  v_mfma_f32_16x16x16_bf16 v[56:59], v[76:77], a[236:237], 0
  v_add3_u32 v15, v8, v15, s90
  s_add_u32 m0, s39, 12288
  s_nop 0
  buffer_load_dwordx4 v15, s[4:7], s76 offen nt lds
  s_add_u32 m0, s39, 16384
  v_cvt_pk_bf16_f32 v40, v40, v41
  v_cvt_pk_bf16_f32 v41, v42, v43
  v_accvgpr_write_b32 a84, v40
  v_accvgpr_write_b32 a85, v41
  v_mfma_f32_16x16x16_bf16 v[60:63], v[78:79], a[238:239], 0
  s_nop 0
  buffer_load_dwordx4 v9, s[4:7], s56 offen nt lds
  s_add_u32 m0, s39, 20480
  s_nop 0
  buffer_load_dwordx4 v10, s[4:7], s56 offen nt lds
  v_cvt_pk_bf16_f32 v44, v44, v45
  v_cvt_pk_bf16_f32 v45, v46, v47
  v_accvgpr_write_b32 a86, v44
  v_accvgpr_write_b32 a87, v45
  s_waitcnt lgkmcnt(0)
  v_and_b32 v72, v69, v72
  v_and_b32 v73, v70, v73
  v_and_b32 v74, v69, v74
  v_and_b32 v75, v70, v75
  s_waitcnt vmcnt(18)
  ds_read_b128 v[76:79], v68 offset:576
  v_mfma_f32_16x16x16_bf16 v[16:19], v[72:73], a[192:193], 0
  ds_read_b64_tr_b16 a[216:217], v67 offset:24640
  v_cvt_pk_bf16_f32 v48, v48, v49
  v_cvt_pk_bf16_f32 v49, v50, v51
  v_accvgpr_write_b32 a88, v48
  v_accvgpr_write_b32 a89, v49
  v_mfma_f32_16x16x16_bf16 v[20:23], v[74:75], a[194:195], 0
  ds_read_b64_tr_b16 a[218:219], v67 offset:25408
  v_cvt_pk_bf16_f32 v52, v52, v53
  v_cvt_pk_bf16_f32 v53, v54, v55
  v_accvgpr_write_b32 a90, v52
  v_accvgpr_write_b32 a91, v53
  v_mfma_f32_16x16x16_bf16 v[24:27], v[72:73], a[196:197], 0
  ds_read_b64_tr_b16 a[220:221], v67 offset:24648
  v_cvt_pk_bf16_f32 v56, v56, v57
  v_cvt_pk_bf16_f32 v57, v58, v59
  v_accvgpr_write_b32 a92, v56
  v_accvgpr_write_b32 a93, v57
  v_mfma_f32_16x16x16_bf16 v[28:31], v[74:75], a[198:199], 0
  ds_read_b64_tr_b16 a[222:223], v67 offset:25416
  v_cvt_pk_bf16_f32 v60, v60, v61
  v_cvt_pk_bf16_f32 v61, v62, v63
  v_accvgpr_write_b32 a94, v60
  v_accvgpr_write_b32 a95, v61
  v_mfma_f32_16x16x16_bf16 v[32:35], v[72:73], a[200:201], 0
  ds_read_b64_tr_b16 a[224:225], v67 offset:24704
  v_cvt_pk_bf16_f32 v184, v16, v17
  v_cvt_pk_bf16_f32 v185, v18, v19
  v_mfma_f32_16x16x16_bf16 v[36:39], v[74:75], a[202:203], 0
  ds_read_b64_tr_b16 a[226:227], v67 offset:25472
  v_cvt_pk_bf16_f32 v186, v20, v21
  v_cvt_pk_bf16_f32 v187, v22, v23
  v_mfma_f32_16x16x16_bf16 v[40:43], v[72:73], a[204:205], 0
  ds_read_b64_tr_b16 a[228:229], v67 offset:24712
  v_cvt_pk_bf16_f32 v188, v24, v25
  v_cvt_pk_bf16_f32 v189, v26, v27
  v_mfma_f32_16x16x16_bf16 v[44:47], v[74:75], a[206:207], 0
  ds_read_b64_tr_b16 a[230:231], v67 offset:25480
  v_cvt_pk_bf16_f32 v190, v28, v29
  v_cvt_pk_bf16_f32 v191, v30, v31
  v_mfma_f32_16x16x16_bf16 v[48:51], v[72:73], a[208:209], 0
  ds_read_b64_tr_b16 a[232:233], v67 offset:24768
  v_cvt_pk_bf16_f32 v192, v32, v33
  v_cvt_pk_bf16_f32 v193, v34, v35
  v_mfma_f32_16x16x16_bf16 v[52:55], v[74:75], a[210:211], 0
  ds_read_b64_tr_b16 a[234:235], v67 offset:25536
  v_cvt_pk_bf16_f32 v194, v36, v37
  v_cvt_pk_bf16_f32 v195, v38, v39
  v_mfma_f32_16x16x16_bf16 v[56:59], v[72:73], a[212:213], 0
  ds_read_b64_tr_b16 a[236:237], v67 offset:24776
  v_cvt_pk_bf16_f32 v196, v40, v41
  v_cvt_pk_bf16_f32 v197, v42, v43
  v_mfma_f32_16x16x16_bf16 v[60:63], v[74:75], a[214:215], 0
  ds_read_b64_tr_b16 a[238:239], v67 offset:25544
  v_cvt_pk_bf16_f32 v198, v44, v45
  v_cvt_pk_bf16_f32 v199, v46, v47
  s_waitcnt lgkmcnt(0)
  v_and_b32 v76, v69, v76
  v_and_b32 v77, v70, v77
  v_and_b32 v78, v69, v78
  v_and_b32 v79, v70, v79
  s_waitcnt vmcnt(12)
  ds_read_b128 v[72:75], v68 offset:640
  v_mfma_f32_16x16x16_bf16 v[16:19], v[76:77], a[216:217], 0
  ds_read_b64_tr_b16 a[192:193], v71 offset:0
  ds_read_b64_tr_b16 a[194:195], v71 offset:768
  v_cvt_pk_bf16_f32 v200, v48, v49
  v_cvt_pk_bf16_f32 v201, v50, v51
  v_mfma_f32_16x16x16_bf16 v[20:23], v[78:79], a[218:219], 0
  ds_read_b64_tr_b16 a[196:197], v71 offset:8
  ds_read_b64_tr_b16 a[198:199], v71 offset:776
  v_cvt_pk_bf16_f32 v202, v52, v53
  v_cvt_pk_bf16_f32 v203, v54, v55
  v_mfma_f32_16x16x16_bf16 v[24:27], v[76:77], a[220:221], 0
  ds_read_b64_tr_b16 a[200:201], v71 offset:64
  ds_read_b64_tr_b16 a[202:203], v71 offset:832
  v_cvt_pk_bf16_f32 v204, v56, v57
  v_cvt_pk_bf16_f32 v205, v58, v59
  v_mfma_f32_16x16x16_bf16 v[28:31], v[78:79], a[222:223], 0
  ds_read_b64_tr_b16 a[204:205], v71 offset:72
  ds_read_b64_tr_b16 a[206:207], v71 offset:840
  v_cvt_pk_bf16_f32 v206, v60, v61
  v_cvt_pk_bf16_f32 v207, v62, v63
  v_mfma_f32_16x16x16_bf16 v[32:35], v[76:77], a[224:225], 0
  ds_read_b64_tr_b16 a[208:209], v71 offset:128
  v_cvt_pk_bf16_f32 v16, v16, v17
  v_cvt_pk_bf16_f32 v17, v18, v19
  v_accvgpr_write_b32 a96, v16
  v_accvgpr_write_b32 a97, v17
  v_mfma_f32_16x16x16_bf16 v[36:39], v[78:79], a[226:227], 0
  ds_read_b64_tr_b16 a[210:211], v71 offset:896
  v_cvt_pk_bf16_f32 v20, v20, v21
  v_cvt_pk_bf16_f32 v21, v22, v23
  v_accvgpr_write_b32 a98, v20
  v_accvgpr_write_b32 a99, v21
  v_mfma_f32_16x16x16_bf16 v[40:43], v[76:77], a[228:229], 0
  ds_read_b64_tr_b16 a[212:213], v71 offset:136
  v_cvt_pk_bf16_f32 v24, v24, v25
  v_cvt_pk_bf16_f32 v25, v26, v27
  v_accvgpr_write_b32 a100, v24
  v_accvgpr_write_b32 a101, v25
  v_mfma_f32_16x16x16_bf16 v[44:47], v[78:79], a[230:231], 0
  ds_read_b64_tr_b16 a[214:215], v71 offset:904
  v_cvt_pk_bf16_f32 v28, v28, v29
  v_cvt_pk_bf16_f32 v29, v30, v31
  v_accvgpr_write_b32 a102, v28
  v_accvgpr_write_b32 a103, v29
  v_mfma_f32_16x16x16_bf16 v[48:51], v[76:77], a[232:233], 0
  s_load_dword s88, s[92:93], s36
  v_cvt_pk_bf16_f32 v32, v32, v33
  v_cvt_pk_bf16_f32 v33, v34, v35
  v_accvgpr_write_b32 a104, v32
  v_accvgpr_write_b32 a105, v33
  v_mfma_f32_16x16x16_bf16 v[52:55], v[78:79], a[234:235], 0
  s_and_b32 s95, s36, -16
  v_cvt_pk_bf16_f32 v36, v36, v37
  v_cvt_pk_bf16_f32 v37, v38, v39
  v_accvgpr_write_b32 a106, v36
  v_accvgpr_write_b32 a107, v37
  v_mfma_f32_16x16x16_bf16 v[56:59], v[76:77], a[236:237], 0
  s_load_dword s89, s[92:93], s95
  v_cvt_pk_bf16_f32 v40, v40, v41
  v_cvt_pk_bf16_f32 v41, v42, v43
  v_accvgpr_write_b32 a108, v40
  v_accvgpr_write_b32 a109, v41
  v_mfma_f32_16x16x16_bf16 v[60:63], v[78:79], a[238:239], 0
  s_load_dword s60, s[92:93], s61
  v_cvt_pk_bf16_f32 v44, v44, v45
  v_cvt_pk_bf16_f32 v45, v46, v47
  v_accvgpr_write_b32 a110, v44
  v_accvgpr_write_b32 a111, v45
  s_waitcnt lgkmcnt(0)
  v_and_b32 v72, v69, v72
  v_and_b32 v73, v70, v73
  v_and_b32 v74, v69, v74
  v_and_b32 v75, v70, v75
  s_min_u32 s51, s88, s89
  s_min_u32 s51, s51, s60
  s_cmp_eq_u32 s51, 0
  s_cbranch_scc1 L_slow
L_back:
  s_lshr_b32 s51, s2, 1
  s_xor_b32 s34, s88, s51
  s_and_b32 s34, s34, 2
  s_lshl_b32 s34, s34, 20
  s_lshr_b32 s51, s89, 2
  s_cmp_gt_u32 s89, s60
  s_addc_u32 s51, s51, 0
  s_xor_b32 s51, s51, s2
  s_and_b32 s51, s51, 1
  s_lshl_b32 s51, s51, 19
  s_or_b32 s34, s34, s51
  s_waitcnt vmcnt(6)
  ds_read_b128 v[76:79], v68 offset:704
  v_mfma_f32_16x16x16_bf16 v[16:19], v[72:73], a[192:193], 0
  ds_read_b64_tr_b16 a[216:217], v71 offset:24640
  v_cvt_pk_bf16_f32 v48, v48, v49
  v_cvt_pk_bf16_f32 v49, v50, v51
  v_accvgpr_write_b32 a112, v48
  v_accvgpr_write_b32 a113, v49
  v_mfma_f32_16x16x16_bf16 v[20:23], v[74:75], a[194:195], 0
  ds_read_b64_tr_b16 a[218:219], v71 offset:25408
  v_cvt_pk_bf16_f32 v52, v52, v53
  v_cvt_pk_bf16_f32 v53, v54, v55
  v_accvgpr_write_b32 a114, v52
  v_accvgpr_write_b32 a115, v53
  v_mfma_f32_16x16x16_bf16 v[24:27], v[72:73], a[196:197], 0
  ds_read_b64_tr_b16 a[220:221], v71 offset:24648
  v_cvt_pk_bf16_f32 v56, v56, v57
  v_cvt_pk_bf16_f32 v57, v58, v59
  v_accvgpr_write_b32 a116, v56
  v_accvgpr_write_b32 a117, v57
  v_mfma_f32_16x16x16_bf16 v[28:31], v[74:75], a[198:199], 0
  ds_read_b64_tr_b16 a[222:223], v71 offset:25416
  v_cvt_pk_bf16_f32 v60, v60, v61
  v_cvt_pk_bf16_f32 v61, v62, v63
  v_accvgpr_write_b32 a118, v60
  v_accvgpr_write_b32 a119, v61
  v_mfma_f32_16x16x16_bf16 v[32:35], v[72:73], a[200:201], 0
  ds_read_b64_tr_b16 a[224:225], v71 offset:24704
  v_cvt_pk_bf16_f32 v208, v16, v17
  v_cvt_pk_bf16_f32 v209, v18, v19
  v_mfma_f32_16x16x16_bf16 v[36:39], v[74:75], a[202:203], 0
  ds_read_b64_tr_b16 a[226:227], v71 offset:25472
  v_cvt_pk_bf16_f32 v210, v20, v21
  v_cvt_pk_bf16_f32 v211, v22, v23
  v_mfma_f32_16x16x16_bf16 v[40:43], v[72:73], a[204:205], 0
  ds_read_b64_tr_b16 a[228:229], v71 offset:24712
  v_cvt_pk_bf16_f32 v212, v24, v25
  v_cvt_pk_bf16_f32 v213, v26, v27
  v_mfma_f32_16x16x16_bf16 v[44:47], v[74:75], a[206:207], 0
  ds_read_b64_tr_b16 a[230:231], v71 offset:25480
  v_cvt_pk_bf16_f32 v214, v28, v29
  v_cvt_pk_bf16_f32 v215, v30, v31
  v_mfma_f32_16x16x16_bf16 v[48:51], v[72:73], a[208:209], 0
  ds_read_b64_tr_b16 a[232:233], v71 offset:24768
  v_cvt_pk_bf16_f32 v216, v32, v33
  v_cvt_pk_bf16_f32 v217, v34, v35
  v_mfma_f32_16x16x16_bf16 v[52:55], v[74:75], a[210:211], 0
  ds_read_b64_tr_b16 a[234:235], v71 offset:25536
  v_cvt_pk_bf16_f32 v218, v36, v37
  v_cvt_pk_bf16_f32 v219, v38, v39
  v_mfma_f32_16x16x16_bf16 v[56:59], v[72:73], a[212:213], 0
  ds_read_b64_tr_b16 a[236:237], v71 offset:24776
  v_cvt_pk_bf16_f32 v220, v40, v41
  v_cvt_pk_bf16_f32 v221, v42, v43
  v_mfma_f32_16x16x16_bf16 v[60:63], v[74:75], a[214:215], 0
  ds_read_b64_tr_b16 a[238:239], v71 offset:25544
  v_cvt_pk_bf16_f32 v222, v44, v45
  v_cvt_pk_bf16_f32 v223, v46, v47
  s_waitcnt lgkmcnt(0)
  v_and_b32 v76, v69, v76
  v_and_b32 v77, v70, v77
  v_and_b32 v78, v69, v78
  v_and_b32 v79, v70, v79
  s_mov_b64 s[82:83], s[80:81]
  s_mov_b64 s[80:81], s[78:79]
  v_mfma_f32_16x16x16_bf16 v[16:19], v[76:77], a[216:217], 0
  s_mov_b64 s[78:79], s[76:77]
  s_add_u32 s76, s33, s32
  s_xor_b32 s76, s76, s34
  s_bfe_u32 s77, s76, 65557
  v_cvt_pk_bf16_f32 v224, v48, v49
  v_cvt_pk_bf16_f32 v225, v50, v51
  v_mfma_f32_16x16x16_bf16 v[20:23], v[78:79], a[218:219], 0
  s_bfe_u32 s76, s76, 65555
  s_lshl1_add_u32 s77, s76, s77
  s_sub_u32 s77, 1, s77
  s_and_b32 s77, s77, 3
  v_cvt_pk_bf16_f32 v226, v52, v53
  v_cvt_pk_bf16_f32 v227, v54, v55
  v_mfma_f32_16x16x16_bf16 v[24:27], v[76:77], a[220:221], 0
  s_mul_i32 s77, s77, 24576
  s_cmp_lt_u32 s32, s35
  s_cselect_b32 s76, s32, s40
  s_add_u32 s32, s32, 786432
  v_cvt_pk_bf16_f32 v228, v56, v57
  v_cvt_pk_bf16_f32 v229, v58, v59
  v_mfma_f32_16x16x16_bf16 v[28:31], v[78:79], a[222:223], 0
  s_cmp_eq_u32 s77, 0
  s_cselect_b32 s57, 73728, s26
  s_add_u32 s22, s76, s77
  s_add_u32 s22, s22, s57
  v_cvt_pk_bf16_f32 v230, v60, v61
  v_cvt_pk_bf16_f32 v231, v62, v63
  v_mfma_f32_16x16x16_bf16 v[32:35], v[76:77], a[224:225], 0
  s_min_u32 s22, s22, s40
  s_add_u32 m0, s39, 24576
  s_nop 0
  buffer_load_dwordx4 v8, s[4:7], s22 offen nt lds
  v_cvt_pk_bf16_f32 v232, v16, v17
  v_cvt_pk_bf16_f32 v233, v18, v19
  v_mfma_f32_16x16x16_bf16 v[36:39], v[78:79], a[226:227], 0
  s_add_u32 m0, s39, 28672
  s_nop 0
  buffer_load_dwordx4 v9, s[4:7], s22 offen nt lds
  v_and_b32 v15, s57, v11
  v_cvt_pk_bf16_f32 v234, v20, v21
  v_cvt_pk_bf16_f32 v235, v22, v23
  v_mfma_f32_16x16x16_bf16 v[40:43], v[76:77], a[228:229], 0
  v_add3_u32 v15, v10, v15, s77
  s_add_u32 m0, s39, 32768
  s_nop 0
  buffer_load_dwordx4 v15, s[4:7], s76 offen nt lds
  v_cvt_pk_bf16_f32 v236, v24, v25
  v_cvt_pk_bf16_f32 v237, v26, v27
  v_mfma_f32_16x16x16_bf16 v[44:47], v[78:79], a[230:231], 0
  s_cmp_eq_u32 s77, 73728
  s_cselect_b32 s57, 4294893568, s27
  s_add_u32 s90, s77, 12288
  s_add_u32 s56, s76, s90
  v_cvt_pk_bf16_f32 v238, v28, v29
  v_cvt_pk_bf16_f32 v239, v30, v31
  v_mfma_f32_16x16x16_bf16 v[48:51], v[76:77], a[232:233], 0
  s_add_u32 s56, s56, s57
  s_min_u32 s56, s56, s40
  v_and_b32 v15, s57, v12
  v_add3_u32 v15, v8, v15, s90
  v_cvt_pk_bf16_f32 v240, v32, v33
  v_cvt_pk_bf16_f32 v241, v34, v35
  v_mfma_f32_16x16x16_bf16 v[52:55], v[78:79], a[234:235], 0
  s_add_u32 m0, s39, 36864
  s_nop 0
  buffer_load_dwordx4 v15, s[4:7], s76 offen nt lds
  v_cvt_pk_bf16_f32 v242, v36, v37
  v_cvt_pk_bf16_f32 v243, v38, v39
  v_mfma_f32_16x16x16_bf16 v[56:59], v[76:77], a[236:237], 0
  s_add_u32 m0, s39, 40960
  s_nop 0
  buffer_load_dwordx4 v9, s[4:7], s56 offen nt lds
  v_cvt_pk_bf16_f32 v244, v40, v41
  v_cvt_pk_bf16_f32 v245, v42, v43
  v_mfma_f32_16x16x16_bf16 v[60:63], v[78:79], a[238:239], 0
  s_add_u32 m0, s39, 45056
  s_xor_b32 s39, s39, 49152
  buffer_load_dwordx4 v10, s[4:7], s56 offen nt lds
  v_cvt_pk_bf16_f32 v246, v44, v45
  v_cvt_pk_bf16_f32 v247, v46, v47
  v_cvt_pk_bf16_f32 v248, v48, v49
  v_cvt_pk_bf16_f32 v249, v50, v51
  v_cvt_pk_bf16_f32 v250, v52, v53
  v_cvt_pk_bf16_f32 v251, v54, v55
  v_mov_b32 v13, 0
  v_mov_b32 v14, 0
  s_mov_b32 s58, s40
  s_mov_b32 s59, s40
  s_mov_b32 s62, s40
  s_mov_b32 s63, s40
  s_waitcnt vmcnt(6)
  s_barrier
  ds_read_b128 a[144:147], v1 offset:0
  ds_read_b128 a[148:151], v2 offset:0
  ds_read_b128 a[152:155], v3 offset:0
  ds_read_b128 a[156:159], v4 offset:0
  v_cvt_pk_bf16_f32 v252, v56, v57
  v_cvt_pk_bf16_f32 v253, v58, v59
  v_cvt_pk_bf16_f32 v254, v60, v61
  v_cvt_pk_bf16_f32 v255, v62, v63
L_loop:
  s_waitcnt lgkmcnt(2)
  v_mfma_f32_16x16x32_bf16 v[16:19], v[88:91], a[144:147], 0
  ds_read_b128 a[160:163], v1 offset:256
  v_mfma_f32_16x16x32_bf16 v[16:19], a[0:3], a[148:151], v[16:19]
  ds_read_b128 a[164:167], v2 offset:256
  v_mfma_f32_16x16x32_bf16 v[20:23], v[92:95], a[144:147], 0
  v_mfma_f32_16x16x32_bf16 v[20:23], a[4:7], a[148:151], v[20:23]
  v_cvt_pk_bf16_f32 v40, v40, v41
  v_mfma_f32_16x16x32_bf16 v[24:27], v[96:99], a[144:147], 0
  v_cvt_pk_bf16_f32 v41, v42, v43
  v_mfma_f32_16x16x32_bf16 v[24:27], a[8:11], a[148:151], v[24:27]
  v_cvt_pk_bf16_f32 v42, v44, v45
  v_mfma_f32_16x16x32_bf16 v[28:31], v[100:103], a[144:147], 0
  buffer_store_dwordx4 a[188:191], v82, s[8:11], s63 offen sc1
  v_mfma_f32_16x16x32_bf16 v[28:31], a[12:15], a[148:151], v[28:31]
  v_cvt_pk_bf16_f32 v43, v46, v47
  v_mfma_f32_16x16x32_bf16 v[32:35], v[104:107], a[144:147], 0
  ds_write_b128 v86, v[40:43] offset:12288
  v_mfma_f32_16x16x32_bf16 v[32:35], a[16:19], a[148:151], v[32:35]
  v_mfma_f32_16x16x32_bf16 v[36:39], v[108:111], a[144:147], 0
  v_mfma_f32_16x16x32_bf16 v[36:39], a[20:23], a[148:151], v[36:39]
  s_waitcnt lgkmcnt(3)
  v_mfma_f32_16x16x32_bf16 v[16:19], v[112:115], a[152:155], v[16:19]
  ds_read_b128 a[144:147], v3 offset:256
  v_mfma_f32_16x16x32_bf16 v[16:19], a[24:27], a[156:159], v[16:19]
  ds_read_b128 a[148:151], v4 offset:256
  v_mfma_f32_16x16x32_bf16 v[20:23], v[116:119], a[152:155], v[20:23]
  v_mfma_f32_16x16x32_bf16 v[20:23], a[28:31], a[156:159], v[20:23]
  v_cvt_pk_bf16_f32 v48, v48, v49
  v_mfma_f32_16x16x32_bf16 v[24:27], v[120:123], a[152:155], v[24:27]
  buffer_store_dwordx4 a[168:171], v80, s[8:11], s58 offen sc1
  v_mfma_f32_16x16x32_bf16 v[24:27], a[32:35], a[156:159], v[24:27]
  v_cvt_pk_bf16_f32 v49, v50, v51
  v_mfma_f32_16x16x32_bf16 v[28:31], v[124:127], a[152:155], v[28:31]
  v_cvt_pk_bf16_f32 v50, v52, v53
  v_mfma_f32_16x16x32_bf16 v[28:31], a[36:39], a[156:159], v[28:31]
  v_cvt_pk_bf16_f32 v51, v54, v55
  v_mfma_f32_16x16x32_bf16 v[32:35], v[128:131], a[152:155], v[32:35]
  ds_write_b128 v87, v[48:51] offset:12288
  v_mfma_f32_16x16x32_bf16 v[32:35], a[40:43], a[156:159], v[32:35]
  v_mfma_f32_16x16x32_bf16 v[36:39], v[132:135], a[152:155], v[36:39]
  v_mfma_f32_16x16x32_bf16 v[36:39], a[44:47], a[156:159], v[36:39]
  s_waitcnt lgkmcnt(4)
  v_mfma_f32_16x16x32_bf16 v[16:19], v[136:139], a[160:163], v[16:19]
  ds_read_b128 a[152:155], v1 offset:512
  v_mfma_f32_16x16x32_bf16 v[16:19], a[48:51], a[164:167], v[16:19]
  ds_read_b128 a[156:159], v2 offset:512
  v_mfma_f32_16x16x32_bf16 v[20:23], v[140:143], a[160:163], v[20:23]
  v_mfma_f32_16x16x32_bf16 v[20:23], a[52:55], a[164:167], v[20:23]
  v_mfma_f32_16x16x32_bf16 v[24:27], v[144:147], a[160:163], v[24:27]
  buffer_store_dwordx4 a[172:175], v81, s[8:11], s58 offen sc1
  v_mfma_f32_16x16x32_bf16 v[24:27], a[56:59], a[164:167], v[24:27]
  v_mfma_f32_16x16x32_bf16 v[28:31], v[148:151], a[160:163], v[28:31]
  v_mfma_f32_16x16x32_bf16 v[28:31], a[60:63], a[164:167], v[28:31]
  v_mfma_f32_16x16x32_bf16 v[32:35], v[152:155], a[160:163], v[32:35]
  v_mfma_f32_16x16x32_bf16 v[32:35], a[64:67], a[164:167], v[32:35]
  v_mfma_f32_16x16x32_bf16 v[36:39], v[156:159], a[160:163], v[36:39]
  v_mfma_f32_16x16x32_bf16 v[36:39], a[68:71], a[164:167], v[36:39]
  s_mov_b64 s[82:83], s[80:81]
  s_waitcnt lgkmcnt(3)
  v_mfma_f32_16x16x32_bf16 v[16:19], v[160:163], a[144:147], v[16:19]
  ds_read_b128 a[160:163], v3 offset:512
  s_mov_b64 s[80:81], s[78:79]
  v_mfma_f32_16x16x32_bf16 v[16:19], a[72:75], a[148:151], v[16:19]
  ds_read_b128 a[164:167], v4 offset:512
  s_mov_b64 s[78:79], s[76:77]
  v_mfma_f32_16x16x32_bf16 v[20:23], v[164:167], a[144:147], v[20:23]
  s_add_u32 s76, s33, s32
  v_cvt_pk_bf16_f32 v56, v56, v57
  v_mfma_f32_16x16x32_bf16 v[20:23], a[76:79], a[148:151], v[20:23]
  s_xor_b32 s76, s76, s34
  v_cvt_pk_bf16_f32 v57, v58, v59
  v_mfma_f32_16x16x32_bf16 v[24:27], v[168:171], a[144:147], v[24:27]
  buffer_store_dwordx4 a[176:179], v13, s[8:11], s59 offen sc1
  v_mfma_f32_16x16x32_bf16 v[24:27], a[80:83], a[148:151], v[24:27]
  s_bfe_u32 s77, s76, 65557
  v_cvt_pk_bf16_f32 v58, v60, v61
  v_mfma_f32_16x16x32_bf16 v[28:31], v[172:175], a[144:147], v[28:31]
  s_bfe_u32 s76, s76, 65555
  v_cvt_pk_bf16_f32 v59, v62, v63
  v_mfma_f32_16x16x32_bf16 v[28:31], a[84:87], a[148:151], v[28:31]
  ds_write_b128 v86, v[56:59] offset:12416
  v_mfma_f32_16x16x32_bf16 v[32:35], v[176:179], a[144:147], v[32:35]
  s_lshl1_add_u32 s77, s76, s77
  s_sub_u32 s77, 1, s77
  v_mfma_f32_16x16x32_bf16 v[32:35], a[88:91], a[148:151], v[32:35]
  s_and_b32 s77, s77, 3
  s_mul_i32 s77, s77, 24576
  v_mfma_f32_16x16x32_bf16 v[36:39], v[180:183], a[144:147], v[36:39]
  s_cmp_lt_u32 s32, s35
  s_cselect_b32 s76, s32, s40
  v_mfma_f32_16x16x32_bf16 v[36:39], a[92:95], a[148:151], v[36:39]
  s_add_u32 s32, s32, 786432
  s_waitcnt lgkmcnt(3)
  v_mfma_f32_16x16x32_bf16 v[16:19], v[184:187], a[152:155], v[16:19]
  ds_read_b128 a[144:147], v1 offset:12288
  s_cmp_eq_u32 s77, 0
  v_mfma_f32_16x16x32_bf16 v[16:19], a[96:99], a[156:159], v[16:19]
  ds_read_b128 a[148:151], v2 offset:12288
  s_cselect_b32 s57, 73728, s26
  v_mfma_f32_16x16x32_bf16 v[20:23], v[188:191], a[152:155], v[20:23]
  s_add_u32 s22, s76, s77
  s_add_u32 s22, s22, s57
  v_mfma_f32_16x16x32_bf16 v[20:23], a[100:103], a[156:159], v[20:23]
  s_min_u32 s22, s22, s40
  s_add_u32 m0, s39, 0
  v_mfma_f32_16x16x32_bf16 v[24:27], v[192:195], a[152:155], v[24:27]
  buffer_load_dwordx4 v8, s[4:7], s22 offen nt lds
  v_mfma_f32_16x16x32_bf16 v[24:27], a[104:107], a[156:159], v[24:27]
  s_cmp_eq_u32 s81, 0
  s_cselect_b32 s91, 73728, s26
  v_mfma_f32_16x16x32_bf16 v[28:31], v[196:199], a[152:155], v[28:31]
  s_add_u32 s58, s80, s81
  s_add_u32 s58, s58, s91
  v_mfma_f32_16x16x32_bf16 v[28:31], a[108:111], a[156:159], v[28:31]
  s_min_u32 s58, s58, s40
  s_mov_b32 s59, s80
  v_mfma_f32_16x16x32_bf16 v[32:35], v[200:203], a[152:155], v[32:35]
  v_and_b32 v13, s91, v11
  v_add3_u32 v13, v82, v13, s81
  v_mfma_f32_16x16x32_bf16 v[32:35], a[112:115], a[156:159], v[32:35]
  s_cmp_eq_u32 s83, 73728
  s_cselect_b32 s91, 4294893568, s27
  v_mfma_f32_16x16x32_bf16 v[36:39], v[204:207], a[152:155], v[36:39]
  s_add_u32 s62, s83, 12288
  s_add_u32 s63, s82, s62
  v_mfma_f32_16x16x32_bf16 v[36:39], a[116:119], a[156:159], v[36:39]
  s_add_u32 s63, s63, s91
  s_waitcnt lgkmcnt(3)
  v_mfma_f32_16x16x32_bf16 v[16:19], v[208:211], a[160:163], v[16:19]
  ds_read_b128 a[152:155], v3 offset:12288
  s_min_u32 s63, s63, s40
  v_mfma_f32_16x16x32_bf16 v[16:19], v[232:235], a[164:167], v[16:19]
  ds_read_b128 a[156:159], v4 offset:12288
  v_and_b32 v14, s91, v12
  v_mfma_f32_16x16x32_bf16 v[20:23], v[212:215], a[160:163], v[20:23]
  v_add3_u32 v14, v80, v14, s62
  s_mov_b32 s62, s82
  v_mfma_f32_16x16x32_bf16 v[20:23], v[236:239], a[164:167], v[20:23]
  s_add_u32 m0, s39, 4096
  v_mfma_f32_16x16x32_bf16 v[24:27], v[216:219], a[160:163], v[24:27]
  buffer_load_dwordx4 v9, s[4:7], s22 offen nt lds
  v_mfma_f32_16x16x32_bf16 v[24:27], v[240:243], a[164:167], v[24:27]
  v_mfma_f32_16x16x32_bf16 v[28:31], v[220:223], a[160:163], v[28:31]
  v_mfma_f32_16x16x32_bf16 v[28:31], v[244:247], a[164:167], v[28:31]
  v_mfma_f32_16x16x32_bf16 v[32:35], v[224:227], a[160:163], v[32:35]
  v_mfma_f32_16x16x32_bf16 v[32:35], v[248:251], a[164:167], v[32:35]
  v_and_b32 v15, s57, v11
  v_mfma_f32_16x16x32_bf16 v[36:39], v[228:231], a[160:163], v[36:39]
  v_add3_u32 v15, v10, v15, s77
  v_mfma_f32_16x16x32_bf16 v[36:39], v[252:255], a[164:167], v[36:39]
  s_waitcnt lgkmcnt(2)
  v_mfma_f32_16x16x32_bf16 v[40:43], v[88:91], a[144:147], 0
  ds_read_b128 a[160:163], v1 offset:12544
  v_mfma_f32_16x16x32_bf16 v[40:43], a[0:3], a[148:151], v[40:43]
  ds_read_b128 a[164:167], v2 offset:12544
  v_mfma_f32_16x16x32_bf16 v[44:47], v[92:95], a[144:147], 0
  s_add_u32 m0, s39, 8192
  v_mfma_f32_16x16x32_bf16 v[44:47], a[4:7], a[148:151], v[44:47]
  v_cvt_pk_bf16_f32 v16, v16, v17
  v_mfma_f32_16x16x32_bf16 v[48:51], v[96:99], a[144:147], 0
  buffer_load_dwordx4 v15, s[4:7], s76 offen nt lds
  v_mfma_f32_16x16x32_bf16 v[48:51], a[8:11], a[148:151], v[48:51]
  v_cvt_pk_bf16_f32 v17, v18, v19
  v_mfma_f32_16x16x32_bf16 v[52:55], v[100:103], a[144:147], 0
  v_cvt_pk_bf16_f32 v18, v20, v21
  v_mfma_f32_16x16x32_bf16 v[52:55], a[12:15], a[148:151], v[52:55]
  s_cmp_eq_u32 s77, 73728
  v_cvt_pk_bf16_f32 v19, v22, v23
  v_mfma_f32_16x16x32_bf16 v[56:59], v[104:107], a[144:147], 0
  ds_write_b128 v86, v[16:19] offset:0
  v_mfma_f32_16x16x32_bf16 v[56:59], a[16:19], a[148:151], v[56:59]
  s_cselect_b32 s57, 4294893568, s27
  s_add_u32 s90, s77, 12288
  v_mfma_f32_16x16x32_bf16 v[60:63], v[108:111], a[144:147], 0
  s_add_u32 s56, s76, s90
  v_cvt_pk_bf16_f32 v24, v24, v25
  v_mfma_f32_16x16x32_bf16 v[60:63], a[20:23], a[148:151], v[60:63]
  s_add_u32 s56, s56, s57
  s_waitcnt lgkmcnt(3)
  v_mfma_f32_16x16x32_bf16 v[40:43], v[112:115], a[152:155], v[40:43]
  ds_read_b128 a[144:147], v3 offset:12544
  s_min_u32 s56, s56, s40
  v_mfma_f32_16x16x32_bf16 v[40:43], a[24:27], a[156:159], v[40:43]
  ds_read_b128 a[148:151], v4 offset:12544
  v_and_b32 v15, s57, v12
  v_mfma_f32_16x16x32_bf16 v[44:47], v[116:119], a[152:155], v[44:47]
  v_add3_u32 v15, v8, v15, s90
  v_cvt_pk_bf16_f32 v25, v26, v27
  v_mfma_f32_16x16x32_bf16 v[44:47], a[28:31], a[156:159], v[44:47]
  s_add_u32 m0, s39, 12288
  v_cvt_pk_bf16_f32 v26, v28, v29
  v_mfma_f32_16x16x32_bf16 v[48:51], v[120:123], a[152:155], v[48:51]
  buffer_load_dwordx4 v15, s[4:7], s76 offen nt lds
  v_mfma_f32_16x16x32_bf16 v[48:51], a[32:35], a[156:159], v[48:51]
  v_cvt_pk_bf16_f32 v27, v30, v31
  v_mfma_f32_16x16x32_bf16 v[52:55], v[124:127], a[152:155], v[52:55]
  ds_write_b128 v87, v[24:27] offset:0
  v_mfma_f32_16x16x32_bf16 v[52:55], a[36:39], a[156:159], v[52:55]
  v_mfma_f32_16x16x32_bf16 v[56:59], v[128:131], a[152:155], v[56:59]
  v_mfma_f32_16x16x32_bf16 v[56:59], a[40:43], a[156:159], v[56:59]
  v_mfma_f32_16x16x32_bf16 v[60:63], v[132:135], a[152:155], v[60:63]
  v_mfma_f32_16x16x32_bf16 v[60:63], a[44:47], a[156:159], v[60:63]
  s_waitcnt lgkmcnt(4)
  v_mfma_f32_16x16x32_bf16 v[40:43], v[136:139], a[160:163], v[40:43]
  ds_read_b128 a[152:155], v1 offset:12800
  v_mfma_f32_16x16x32_bf16 v[40:43], a[48:51], a[164:167], v[40:43]
  ds_read_b128 a[156:159], v2 offset:12800
  v_mfma_f32_16x16x32_bf16 v[44:47], v[140:143], a[160:163], v[44:47]
  s_add_u32 m0, s39, 16384
  v_mfma_f32_16x16x32_bf16 v[44:47], a[52:55], a[164:167], v[44:47]
  v_cvt_pk_bf16_f32 v32, v32, v33
  v_mfma_f32_16x16x32_bf16 v[48:51], v[144:147], a[160:163], v[48:51]
  buffer_load_dwordx4 v9, s[4:7], s56 offen nt lds
  v_mfma_f32_16x16x32_bf16 v[48:51], a[56:59], a[164:167], v[48:51]
  v_cvt_pk_bf16_f32 v33, v34, v35
  v_mfma_f32_16x16x32_bf16 v[52:55], v[148:151], a[160:163], v[52:55]
  v_cvt_pk_bf16_f32 v34, v36, v37
  v_mfma_f32_16x16x32_bf16 v[52:55], a[60:63], a[164:167], v[52:55]
  v_cvt_pk_bf16_f32 v35, v38, v39
  v_mfma_f32_16x16x32_bf16 v[56:59], v[152:155], a[160:163], v[56:59]
  ds_write_b128 v86, v[32:35] offset:128
  v_mfma_f32_16x16x32_bf16 v[56:59], a[64:67], a[164:167], v[56:59]
  v_mfma_f32_16x16x32_bf16 v[60:63], v[156:159], a[160:163], v[60:63]
  v_mfma_f32_16x16x32_bf16 v[60:63], a[68:71], a[164:167], v[60:63]
  s_waitcnt lgkmcnt(4)
  v_mfma_f32_16x16x32_bf16 v[40:43], v[160:163], a[144:147], v[40:43]
  ds_read_b128 a[160:163], v3 offset:12800
  v_mfma_f32_16x16x32_bf16 v[40:43], a[72:75], a[148:151], v[40:43]
  ds_read_b128 a[164:167], v4 offset:12800
  v_mfma_f32_16x16x32_bf16 v[44:47], v[164:167], a[144:147], v[44:47]
  v_mfma_f32_16x16x32_bf16 v[44:47], a[76:79], a[148:151], v[44:47]
  s_add_u32 m0, s39, 20480
  v_mfma_f32_16x16x32_bf16 v[48:51], v[168:171], a[144:147], v[48:51]
  buffer_load_dwordx4 v10, s[4:7], s56 offen nt lds
  v_mfma_f32_16x16x32_bf16 v[48:51], a[80:83], a[148:151], v[48:51]
  v_mfma_f32_16x16x32_bf16 v[52:55], v[172:175], a[144:147], v[52:55]
  v_mfma_f32_16x16x32_bf16 v[52:55], a[84:87], a[148:151], v[52:55]
  v_mfma_f32_16x16x32_bf16 v[56:59], v[176:179], a[144:147], v[56:59]
  v_mfma_f32_16x16x32_bf16 v[56:59], a[88:91], a[148:151], v[56:59]
  v_mfma_f32_16x16x32_bf16 v[60:63], v[180:183], a[144:147], v[60:63]
  v_mfma_f32_16x16x32_bf16 v[60:63], a[92:95], a[148:151], v[60:63]
  s_waitcnt vmcnt(10) lgkmcnt(2)
L_ent:
  s_barrier
  s_waitcnt lgkmcnt(3)
  v_mfma_f32_16x16x32_bf16 v[40:43], v[184:187], a[152:155], v[40:43]
  ds_read_b128 a[144:147], v1 offset:24576
  v_mfma_f32_16x16x32_bf16 v[40:43], a[96:99], a[156:159], v[40:43]
  ds_read_b128 a[148:151], v2 offset:24576
  v_mfma_f32_16x16x32_bf16 v[44:47], v[188:191], a[152:155], v[44:47]
  ds_read_b128 a[180:183], v5 offset:12288
  v_mfma_f32_16x16x32_bf16 v[44:47], a[100:103], a[156:159], v[44:47]
  ds_read_b128 a[184:187], v6 offset:12288
  v_mfma_f32_16x16x32_bf16 v[48:51], v[192:195], a[152:155], v[48:51]
  ds_read_b128 a[188:191], v7 offset:12288
  v_mfma_f32_16x16x32_bf16 v[48:51], a[104:107], a[156:159], v[48:51]
  ds_read_b128 a[168:171], v5 offset:0
  v_mfma_f32_16x16x32_bf16 v[52:55], v[196:199], a[152:155], v[52:55]
  ds_read_b128 a[172:175], v6 offset:0
  v_mfma_f32_16x16x32_bf16 v[52:55], a[108:111], a[156:159], v[52:55]
  ds_read_b128 a[176:179], v7 offset:0
  v_mfma_f32_16x16x32_bf16 v[56:59], v[200:203], a[152:155], v[56:59]
  v_mfma_f32_16x16x32_bf16 v[56:59], a[112:115], a[156:159], v[56:59]
  v_mfma_f32_16x16x32_bf16 v[60:63], v[204:207], a[152:155], v[60:63]
  v_mfma_f32_16x16x32_bf16 v[60:63], a[116:119], a[156:159], v[60:63]
  s_waitcnt lgkmcnt(8)
  v_mfma_f32_16x16x32_bf16 v[40:43], v[208:211], a[160:163], v[40:43]
  ds_read_b128 a[152:155], v3 offset:24576
  v_mfma_f32_16x16x32_bf16 v[40:43], v[232:235], a[164:167], v[40:43]
  ds_read_b128 a[156:159], v4 offset:24576
  v_mfma_f32_16x16x32_bf16 v[44:47], v[212:215], a[160:163], v[44:47]
  s_waitcnt lgkmcnt(7)
  buffer_store_dwordx4 a[180:183], v14, s[8:11], s62 offen sc1
  v_mfma_f32_16x16x32_bf16 v[44:47], v[236:239], a[164:167], v[44:47]
  v_mfma_f32_16x16x32_bf16 v[48:51], v[216:219], a[160:163], v[48:51]
  v_mfma_f32_16x16x32_bf16 v[48:51], v[240:243], a[164:167], v[48:51]
  v_mfma_f32_16x16x32_bf16 v[52:55], v[220:223], a[160:163], v[52:55]
  v_mfma_f32_16x16x32_bf16 v[52:55], v[244:247], a[164:167], v[52:55]
  v_mfma_f32_16x16x32_bf16 v[56:59], v[224:227], a[160:163], v[56:59]
  s_waitcnt lgkmcnt(6)
  buffer_store_dwordx4 a[184:187], v81, s[8:11], s63 offen sc1
  v_mfma_f32_16x16x32_bf16 v[56:59], v[248:251], a[164:167], v[56:59]
  v_mfma_f32_16x16x32_bf16 v[60:63], v[228:231], a[160:163], v[60:63]
  v_mfma_f32_16x16x32_bf16 v[60:63], v[252:255], a[164:167], v[60:63]
  s_waitcnt lgkmcnt(8)
  v_mfma_f32_16x16x32_bf16 v[16:19], v[88:91], a[144:147], 0
  ds_read_b128 a[160:163], v1 offset:24832
  v_mfma_f32_16x16x32_bf16 v[16:19], a[0:3], a[148:151], v[16:19]
  ds_read_b128 a[164:167], v2 offset:24832
  v_mfma_f32_16x16x32_bf16 v[20:23], v[92:95], a[144:147], 0
  v_mfma_f32_16x16x32_bf16 v[20:23], a[4:7], a[148:151], v[20:23]
  v_cvt_pk_bf16_f32 v40, v40, v41
  v_mfma_f32_16x16x32_bf16 v[24:27], v[96:99], a[144:147], 0
  v_cvt_pk_bf16_f32 v41, v42, v43
  v_mfma_f32_16x16x32_bf16 v[24:27], a[8:11], a[148:151], v[24:27]
  v_cvt_pk_bf16_f32 v42, v44, v45
  v_mfma_f32_16x16x32_bf16 v[28:31], v[100:103], a[144:147], 0
  s_waitcnt lgkmcnt(7)
  buffer_store_dwordx4 a[188:191], v82, s[8:11], s63 offen sc1
  v_mfma_f32_16x16x32_bf16 v[28:31], a[12:15], a[148:151], v[28:31]
  v_cvt_pk_bf16_f32 v43, v46, v47
  v_mfma_f32_16x16x32_bf16 v[32:35], v[104:107], a[144:147], 0
  ds_write_b128 v86, v[40:43] offset:36864
  v_mfma_f32_16x16x32_bf16 v[32:35], a[16:19], a[148:151], v[32:35]
  v_mfma_f32_16x16x32_bf16 v[36:39], v[108:111], a[144:147], 0
  v_mfma_f32_16x16x32_bf16 v[36:39], a[20:23], a[148:151], v[36:39]
  s_waitcnt lgkmcnt(3)
  v_mfma_f32_16x16x32_bf16 v[16:19], v[112:115], a[152:155], v[16:19]
  ds_read_b128 a[144:147], v3 offset:24832
  v_mfma_f32_16x16x32_bf16 v[16:19], a[24:27], a[156:159], v[16:19]
  ds_read_b128 a[148:151], v4 offset:24832
  v_mfma_f32_16x16x32_bf16 v[20:23], v[116:119], a[152:155], v[20:23]
  v_mfma_f32_16x16x32_bf16 v[20:23], a[28:31], a[156:159], v[20:23]
  v_cvt_pk_bf16_f32 v48, v48, v49
  v_mfma_f32_16x16x32_bf16 v[24:27], v[120:123], a[152:155], v[24:27]
  buffer_store_dwordx4 a[168:171], v80, s[8:11], s58 offen sc1
  v_mfma_f32_16x16x32_bf16 v[24:27], a[32:35], a[156:159], v[24:27]
  v_cvt_pk_bf16_f32 v49, v50, v51
  v_mfma_f32_16x16x32_bf16 v[28:31], v[124:127], a[152:155], v[28:31]
  v_cvt_pk_bf16_f32 v50, v52, v53
  v_mfma_f32_16x16x32_bf16 v[28:31], a[36:39], a[156:159], v[28:31]
  v_cvt_pk_bf16_f32 v51, v54, v55
  v_mfma_f32_16x16x32_bf16 v[32:35], v[128:131], a[152:155], v[32:35]
  ds_write_b128 v87, v[48:51] offset:36864
  v_mfma_f32_16x16x32_bf16 v[32:35], a[40:43], a[156:159], v[32:35]
  v_mfma_f32_16x16x32_bf16 v[36:39], v[132:135], a[152:155], v[36:39]
  v_mfma_f32_16x16x32_bf16 v[36:39], a[44:47], a[156:159], v[36:39]
  s_waitcnt lgkmcnt(4)
  v_mfma_f32_16x16x32_bf16 v[16:19], v[136:139], a[160:163], v[16:19]
  ds_read_b128 a[152:155], v1 offset:25088
  v_mfma_f32_16x16x32_bf16 v[16:19], a[48:51], a[164:167], v[16:19]
  ds_read_b128 a[156:159], v2 offset:25088
  v_mfma_f32_16x16x32_bf16 v[20:23], v[140:143], a[160:163], v[20:23]
  v_mfma_f32_16x16x32_bf16 v[20:23], a[52:55], a[164:167], v[20:23]
  v_mfma_f32_16x16x32_bf16 v[24:27], v[144:147], a[160:163], v[24:27]
  buffer_store_dwordx4 a[172:175], v81, s[8:11], s58 offen sc1
  v_mfma_f32_16x16x32_bf16 v[24:27], a[56:59], a[164:167], v[24:27]
  v_mfma_f32_16x16x32_bf16 v[28:31], v[148:151], a[160:163], v[28:31]
  v_mfma_f32_16x16x32_bf16 v[28:31], a[60:63], a[164:167], v[28:31]
  v_mfma_f32_16x16x32_bf16 v[32:35], v[152:155], a[160:163], v[32:35]
  v_mfma_f32_16x16x32_bf16 v[32:35], a[64:67], a[164:167], v[32:35]
  v_mfma_f32_16x16x32_bf16 v[36:39], v[156:159], a[160:163], v[36:39]
  v_mfma_f32_16x16x32_bf16 v[36:39], a[68:71], a[164:167], v[36:39]
  s_mov_b64 s[82:83], s[80:81]
  s_waitcnt lgkmcnt(3)
  v_mfma_f32_16x16x32_bf16 v[16:19], v[160:163], a[144:147], v[16:19]
  ds_read_b128 a[160:163], v3 offset:25088
  s_mov_b64 s[80:81], s[78:79]
  v_mfma_f32_16x16x32_bf16 v[16:19], a[72:75], a[148:151], v[16:19]
  ds_read_b128 a[164:167], v4 offset:25088
  s_mov_b64 s[78:79], s[76:77]
  v_mfma_f32_16x16x32_bf16 v[20:23], v[164:167], a[144:147], v[20:23]
  s_add_u32 s76, s33, s32
  v_cvt_pk_bf16_f32 v56, v56, v57
  v_mfma_f32_16x16x32_bf16 v[20:23], a[76:79], a[148:151], v[20:23]
  s_xor_b32 s76, s76, s34
  v_cvt_pk_bf16_f32 v57, v58, v59
  v_mfma_f32_16x16x32_bf16 v[24:27], v[168:171], a[144:147], v[24:27]
  buffer_store_dwordx4 a[176:179], v13, s[8:11], s59 offen sc1
  v_mfma_f32_16x16x32_bf16 v[24:27], a[80:83], a[148:151], v[24:27]
  s_bfe_u32 s77, s76, 65557
  v_cvt_pk_bf16_f32 v58, v60, v61
  v_mfma_f32_16x16x32_bf16 v[28:31], v[172:175], a[144:147], v[28:31]
  s_bfe_u32 s76, s76, 65555
  v_cvt_pk_bf16_f32 v59, v62, v63
  v_mfma_f32_16x16x32_bf16 v[28:31], a[84:87], a[148:151], v[28:31]
  ds_write_b128 v86, v[56:59] offset:36992
  v_mfma_f32_16x16x32_bf16 v[32:35], v[176:179], a[144:147], v[32:35]
  s_lshl1_add_u32 s77, s76, s77
  s_sub_u32 s77, 1, s77
  v_mfma_f32_16x16x32_bf16 v[32:35], a[88:91], a[148:151], v[32:35]
  s_and_b32 s77, s77, 3
  s_mul_i32 s77, s77, 24576
  v_mfma_f32_16x16x32_bf16 v[36:39], v[180:183], a[144:147], v[36:39]
  s_cmp_lt_u32 s32, s35
  s_cselect_b32 s76, s32, s40
  v_mfma_f32_16x16x32_bf16 v[36:39], a[92:95], a[148:151], v[36:39]
  s_add_u32 s32, s32, 786432
  s_waitcnt lgkmcnt(3)
  v_mfma_f32_16x16x32_bf16 v[16:19], v[184:187], a[152:155], v[16:19]
  ds_read_b128 a[144:147], v1 offset:36864
  s_cmp_eq_u32 s77, 0
  v_mfma_f32_16x16x32_bf16 v[16:19], a[96:99], a[156:159], v[16:19]
  ds_read_b128 a[148:151], v2 offset:36864
  s_cselect_b32 s57, 73728, s26
  v_mfma_f32_16x16x32_bf16 v[20:23], v[188:191], a[152:155], v[20:23]
  s_add_u32 s22, s76, s77
  s_add_u32 s22, s22, s57
  v_mfma_f32_16x16x32_bf16 v[20:23], a[100:103], a[156:159], v[20:23]
  s_min_u32 s22, s22, s40
  s_add_u32 m0, s39, 24576
  v_mfma_f32_16x16x32_bf16 v[24:27], v[192:195], a[152:155], v[24:27]
  buffer_load_dwordx4 v8, s[4:7], s22 offen nt lds
  v_mfma_f32_16x16x32_bf16 v[24:27], a[104:107], a[156:159], v[24:27]
  s_cmp_eq_u32 s81, 0
  s_cselect_b32 s91, 73728, s26
  v_mfma_f32_16x16x32_bf16 v[28:31], v[196:199], a[152:155], v[28:31]
  s_add_u32 s58, s80, s81
  s_add_u32 s58, s58, s91
  v_mfma_f32_16x16x32_bf16 v[28:31], a[108:111], a[156:159], v[28:31]
  s_min_u32 s58, s58, s40
  s_mov_b32 s59, s80
  v_mfma_f32_16x16x32_bf16 v[32:35], v[200:203], a[152:155], v[32:35]
  v_and_b32 v13, s91, v11
  v_add3_u32 v13, v82, v13, s81
  v_mfma_f32_16x16x32_bf16 v[32:35], a[112:115], a[156:159], v[32:35]
  s_cmp_eq_u32 s83, 73728
  s_cselect_b32 s91, 4294893568, s27
  v_mfma_f32_16x16x32_bf16 v[36:39], v[204:207], a[152:155], v[36:39]
  s_add_u32 s62, s83, 12288
  s_add_u32 s63, s82, s62
  v_mfma_f32_16x16x32_bf16 v[36:39], a[116:119], a[156:159], v[36:39]
  s_add_u32 s63, s63, s91
  s_waitcnt lgkmcnt(3)
  v_mfma_f32_16x16x32_bf16 v[16:19], v[208:211], a[160:163], v[16:19]
  ds_read_b128 a[152:155], v3 offset:36864
  s_min_u32 s63, s63, s40
  v_mfma_f32_16x16x32_bf16 v[16:19], v[232:235], a[164:167], v[16:19]
  ds_read_b128 a[156:159], v4 offset:36864
  v_and_b32 v14, s91, v12
  v_mfma_f32_16x16x32_bf16 v[20:23], v[212:215], a[160:163], v[20:23]
  v_add3_u32 v14, v80, v14, s62
  s_mov_b32 s62, s82
  v_mfma_f32_16x16x32_bf16 v[20:23], v[236:239], a[164:167], v[20:23]
  s_add_u32 m0, s39, 28672
  v_mfma_f32_16x16x32_bf16 v[24:27], v[216:219], a[160:163], v[24:27]
  buffer_load_dwordx4 v9, s[4:7], s22 offen nt lds
  v_mfma_f32_16x16x32_bf16 v[24:27], v[240:243], a[164:167], v[24:27]
  v_mfma_f32_16x16x32_bf16 v[28:31], v[220:223], a[160:163], v[28:31]
  v_mfma_f32_16x16x32_bf16 v[28:31], v[244:247], a[164:167], v[28:31]
  v_mfma_f32_16x16x32_bf16 v[32:35], v[224:227], a[160:163], v[32:35]
  v_mfma_f32_16x16x32_bf16 v[32:35], v[248:251], a[164:167], v[32:35]
  v_and_b32 v15, s57, v11
  v_mfma_f32_16x16x32_bf16 v[36:39], v[228:231], a[160:163], v[36:39]
  v_add3_u32 v15, v10, v15, s77
  v_mfma_f32_16x16x32_bf16 v[36:39], v[252:255], a[164:167], v[36:39]
  s_waitcnt lgkmcnt(2)
  v_mfma_f32_16x16x32_bf16 v[40:43], v[88:91], a[144:147], 0
  ds_read_b128 a[160:163], v1 offset:37120
  v_mfma_f32_16x16x32_bf16 v[40:43], a[0:3], a[148:151], v[40:43]
  ds_read_b128 a[164:167], v2 offset:37120
  v_mfma_f32_16x16x32_bf16 v[44:47], v[92:95], a[144:147], 0
  s_add_u32 m0, s39, 32768
  v_mfma_f32_16x16x32_bf16 v[44:47], a[4:7], a[148:151], v[44:47]
  v_cvt_pk_bf16_f32 v16, v16, v17
  v_mfma_f32_16x16x32_bf16 v[48:51], v[96:99], a[144:147], 0
  buffer_load_dwordx4 v15, s[4:7], s76 offen nt lds
  v_mfma_f32_16x16x32_bf16 v[48:51], a[8:11], a[148:151], v[48:51]
  v_cvt_pk_bf16_f32 v17, v18, v19
  v_mfma_f32_16x16x32_bf16 v[52:55], v[100:103], a[144:147], 0
  v_cvt_pk_bf16_f32 v18, v20, v21
  v_mfma_f32_16x16x32_bf16 v[52:55], a[12:15], a[148:151], v[52:55]
  s_cmp_eq_u32 s77, 73728
  v_cvt_pk_bf16_f32 v19, v22, v23
  v_mfma_f32_16x16x32_bf16 v[56:59], v[104:107], a[144:147], 0
  ds_write_b128 v86, v[16:19] offset:24576
  v_mfma_f32_16x16x32_bf16 v[56:59], a[16:19], a[148:151], v[56:59]
  s_cselect_b32 s57, 4294893568, s27
  s_add_u32 s90, s77, 12288
  v_mfma_f32_16x16x32_bf16 v[60:63], v[108:111], a[144:147], 0
  s_add_u32 s56, s76, s90
  v_cvt_pk_bf16_f32 v24, v24, v25
  v_mfma_f32_16x16x32_bf16 v[60:63], a[20:23], a[148:151], v[60:63]
  s_add_u32 s56, s56, s57
  s_waitcnt lgkmcnt(3)
  v_mfma_f32_16x16x32_bf16 v[40:43], v[112:115], a[152:155], v[40:43]
  ds_read_b128 a[144:147], v3 offset:37120
  s_min_u32 s56, s56, s40
  v_mfma_f32_16x16x32_bf16 v[40:43], a[24:27], a[156:159], v[40:43]
  ds_read_b128 a[148:151], v4 offset:37120
  v_and_b32 v15, s57, v12
  v_mfma_f32_16x16x32_bf16 v[44:47], v[116:119], a[152:155], v[44:47]
  v_add3_u32 v15, v8, v15, s90
  v_cvt_pk_bf16_f32 v25, v26, v27
  v_mfma_f32_16x16x32_bf16 v[44:47], a[28:31], a[156:159], v[44:47]
  s_add_u32 m0, s39, 36864
  v_cvt_pk_bf16_f32 v26, v28, v29
  v_mfma_f32_16x16x32_bf16 v[48:51], v[120:123], a[152:155], v[48:51]
  buffer_load_dwordx4 v15, s[4:7], s76 offen nt lds
  v_mfma_f32_16x16x32_bf16 v[48:51], a[32:35], a[156:159], v[48:51]
  v_cvt_pk_bf16_f32 v27, v30, v31
  v_mfma_f32_16x16x32_bf16 v[52:55], v[124:127], a[152:155], v[52:55]
  ds_write_b128 v87, v[24:27] offset:24576
  v_mfma_f32_16x16x32_bf16 v[52:55], a[36:39], a[156:159], v[52:55]
  v_mfma_f32_16x16x32_bf16 v[56:59], v[128:131], a[152:155], v[56:59]
  v_mfma_f32_16x16x32_bf16 v[56:59], a[40:43], a[156:159], v[56:59]
  v_mfma_f32_16x16x32_bf16 v[60:63], v[132:135], a[152:155], v[60:63]
  v_mfma_f32_16x16x32_bf16 v[60:63], a[44:47], a[156:159], v[60:63]
  s_waitcnt lgkmcnt(4)
  v_mfma_f32_16x16x32_bf16 v[40:43], v[136:139], a[160:163], v[40:43]
  ds_read_b128 a[152:155], v1 offset:37376
  v_mfma_f32_16x16x32_bf16 v[40:43], a[48:51], a[164:167], v[40:43]
  ds_read_b128 a[156:159], v2 offset:37376
  v_mfma_f32_16x16x32_bf16 v[44:47], v[140:143], a[160:163], v[44:47]
  s_add_u32 m0, s39, 40960
  v_mfma_f32_16x16x32_bf16 v[44:47], a[52:55], a[164:167], v[44:47]
  v_cvt_pk_bf16_f32 v32, v32, v33
  v_mfma_f32_16x16x32_bf16 v[48:51], v[144:147], a[160:163], v[48:51]
  buffer_load_dwordx4 v9, s[4:7], s56 offen nt lds
  v_mfma_f32_16x16x32_bf16 v[48:51], a[56:59], a[164:167], v[48:51]
  v_cvt_pk_bf16_f32 v33, v34, v35
  v_mfma_f32_16x16x32_bf16 v[52:55], v[148:151], a[160:163], v[52:55]
  v_cvt_pk_bf16_f32 v34, v36, v37
  v_mfma_f32_16x16x32_bf16 v[52:55], a[60:63], a[164:167], v[52:55]
  v_cvt_pk_bf16_f32 v35, v38, v39
  v_mfma_f32_16x16x32_bf16 v[56:59], v[152:155], a[160:163], v[56:59]
  ds_write_b128 v86, v[32:35] offset:24704
  v_mfma_f32_16x16x32_bf16 v[56:59], a[64:67], a[164:167], v[56:59]
  v_mfma_f32_16x16x32_bf16 v[60:63], v[156:159], a[160:163], v[60:63]
  v_mfma_f32_16x16x32_bf16 v[60:63], a[68:71], a[164:167], v[60:63]
  s_waitcnt lgkmcnt(4)
  v_mfma_f32_16x16x32_bf16 v[40:43], v[160:163], a[144:147], v[40:43]
  ds_read_b128 a[160:163], v3 offset:37376
  v_mfma_f32_16x16x32_bf16 v[40:43], a[72:75], a[148:151], v[40:43]
  ds_read_b128 a[164:167], v4 offset:37376
  v_mfma_f32_16x16x32_bf16 v[44:47], v[164:167], a[144:147], v[44:47]
  s_add_u32 m0, s39, 45056
  v_mfma_f32_16x16x32_bf16 v[44:47], a[76:79], a[148:151], v[44:47]
  s_xor_b32 s39, s39, 49152
  v_mfma_f32_16x16x32_bf16 v[48:51], v[168:171], a[144:147], v[48:51]
  buffer_load_dwordx4 v10, s[4:7], s56 offen nt lds
  v_mfma_f32_16x16x32_bf16 v[48:51], a[80:83], a[148:151], v[48:51]
  v_mfma_f32_16x16x32_bf16 v[52:55], v[172:175], a[144:147], v[52:55]
  v_mfma_f32_16x16x32_bf16 v[52:55], a[84:87], a[148:151], v[52:55]
  v_mfma_f32_16x16x32_bf16 v[56:59], v[176:179], a[144:147], v[56:59]
  v_mfma_f32_16x16x32_bf16 v[56:59], a[88:91], a[148:151], v[56:59]
  v_mfma_f32_16x16x32_bf16 v[60:63], v[180:183], a[144:147], v[60:63]
  v_mfma_f32_16x16x32_bf16 v[60:63], a[92:95], a[148:151], v[60:63]
  s_waitcnt vmcnt(12) lgkmcnt(2)
  s_barrier
  v_xor_b32 v1, 49152, v1
  v_xor_b32 v2, 49152, v2
  v_xor_b32 v3, 49152, v3
  v_xor_b32 v4, 49152, v4
  s_waitcnt lgkmcnt(3)
  v_mfma_f32_16x16x32_bf16 v[40:43], v[184:187], a[152:155], v[40:43]
  ds_read_b128 a[144:147], v1 offset:0
  v_mfma_f32_16x16x32_bf16 v[40:43], a[96:99], a[156:159], v[40:43]
  ds_read_b128 a[148:151], v2 offset:0
  v_mfma_f32_16x16x32_bf16 v[44:47], v[188:191], a[152:155], v[44:47]
  ds_read_b128 a[180:183], v5 offset:36864
  v_mfma_f32_16x16x32_bf16 v[44:47], a[100:103], a[156:159], v[44:47]
  ds_read_b128 a[184:187], v6 offset:36864
  v_mfma_f32_16x16x32_bf16 v[48:51], v[192:195], a[152:155], v[48:51]
  ds_read_b128 a[188:191], v7 offset:36864
  v_mfma_f32_16x16x32_bf16 v[48:51], a[104:107], a[156:159], v[48:51]
  ds_read_b128 a[168:171], v5 offset:24576
  v_mfma_f32_16x16x32_bf16 v[52:55], v[196:199], a[152:155], v[52:55]
  ds_read_b128 a[172:175], v6 offset:24576
  v_mfma_f32_16x16x32_bf16 v[52:55], a[108:111], a[156:159], v[52:55]
  ds_read_b128 a[176:179], v7 offset:24576
  v_mfma_f32_16x16x32_bf16 v[56:59], v[200:203], a[152:155], v[56:59]
  v_mfma_f32_16x16x32_bf16 v[56:59], a[112:115], a[156:159], v[56:59]
  v_mfma_f32_16x16x32_bf16 v[60:63], v[204:207], a[152:155], v[60:63]
  v_mfma_f32_16x16x32_bf16 v[60:63], a[116:119], a[156:159], v[60:63]
  s_waitcnt lgkmcnt(8)
  v_mfma_f32_16x16x32_bf16 v[40:43], v[208:211], a[160:163], v[40:43]
  ds_read_b128 a[152:155], v3 offset:0
  v_mfma_f32_16x16x32_bf16 v[40:43], v[232:235], a[164:167], v[40:43]
  ds_read_b128 a[156:159], v4 offset:0
  v_mfma_f32_16x16x32_bf16 v[44:47], v[212:215], a[160:163], v[44:47]
  s_waitcnt lgkmcnt(7)
  buffer_store_dwordx4 a[180:183], v14, s[8:11], s62 offen sc1
  v_mfma_f32_16x16x32_bf16 v[44:47], v[236:239], a[164:167], v[44:47]
  v_mfma_f32_16x16x32_bf16 v[48:51], v[216:219], a[160:163], v[48:51]
  v_mfma_f32_16x16x32_bf16 v[48:51], v[240:243], a[164:167], v[48:51]
  v_mfma_f32_16x16x32_bf16 v[52:55], v[220:223], a[160:163], v[52:55]
  v_mfma_f32_16x16x32_bf16 v[52:55], v[244:247], a[164:167], v[52:55]
  v_mfma_f32_16x16x32_bf16 v[56:59], v[224:227], a[160:163], v[56:59]
  s_waitcnt lgkmcnt(6)
  buffer_store_dwordx4 a[184:187], v81, s[8:11], s63 offen sc1
  v_mfma_f32_16x16x32_bf16 v[56:59], v[248:251], a[164:167], v[56:59]
  v_mfma_f32_16x16x32_bf16 v[60:63], v[228:231], a[160:163], v[60:63]
  v_mfma_f32_16x16x32_bf16 v[60:63], v[252:255], a[164:167], v[60:63]
  s_cmp_lt_u32 s78, s40
  s_cbranch_scc1 L_loop
L_tail:
  s_nop 3
  v_cvt_pk_bf16_f32 v40, v40, v41
  v_cvt_pk_bf16_f32 v41, v42, v43
  v_cvt_pk_bf16_f32 v42, v44, v45
  v_cvt_pk_bf16_f32 v43, v46, v47
  ds_write_b128 v86, v[40:43] offset:12288
  v_cvt_pk_bf16_f32 v48, v48, v49
  v_cvt_pk_bf16_f32 v49, v50, v51
  v_cvt_pk_bf16_f32 v50, v52, v53
  v_cvt_pk_bf16_f32 v51, v54, v55
  ds_write_b128 v87, v[48:51] offset:12288
  v_cvt_pk_bf16_f32 v56, v56, v57
  v_cvt_pk_bf16_f32 v57, v58, v59
  v_cvt_pk_bf16_f32 v58, v60, v61
  v_cvt_pk_bf16_f32 v59, v62, v63
  ds_write_b128 v86, v[56:59] offset:12416
  s_waitcnt lgkmcnt(8)
  buffer_store_dwordx4 a[188:191], v82, s[8:11], s63 offen sc1
  s_waitcnt lgkmcnt(7)
  buffer_store_dwordx4 a[168:171], v80, s[8:11], s58 offen sc1
  s_waitcnt lgkmcnt(6)
  buffer_store_dwordx4 a[172:175], v81, s[8:11], s58 offen sc1
  s_waitcnt lgkmcnt(5)
  buffer_store_dwordx4 a[176:179], v13, s[8:11], s59 offen sc1
  s_cmp_eq_u32 s79, 0
  s_cselect_b32 s91, 73728, s26
  s_add_u32 s58, s78, s79
  s_add_u32 s58, s58, s91
  s_min_u32 s58, s58, s40
  s_mov_b32 s59, s78
  v_and_b32 v13, s91, v11
  v_add3_u32 v13, v82, v13, s79
  s_cmp_eq_u32 s81, 73728
  s_cselect_b32 s91, 4294893568, s27
  s_add_u32 s62, s81, 12288
  s_add_u32 s63, s80, s62
  s_add_u32 s63, s63, s91
  s_min_u32 s63, s63, s40
  v_and_b32 v14, s91, v12
  v_add3_u32 v14, v80, v14, s62
  s_mov_b32 s62, s80
  s_waitcnt lgkmcnt(0)
  s_barrier
  ds_read_b128 a[144:147], v5 offset:12288
  ds_read_b128 a[148:151], v6 offset:12288
  ds_read_b128 a[152:155], v7 offset:12288
  s_waitcnt lgkmcnt(2)
  buffer_store_dwordx4 a[144:147], v14, s[8:11], s62 offen sc1
  s_waitcnt lgkmcnt(1)
  buffer_store_dwordx4 a[148:151], v81, s[8:11], s63 offen sc1
  s_waitcnt lgkmcnt(0)
  buffer_store_dwordx4 a[152:155], v82, s[8:11], s63 offen sc1
  s_endpgm
L_slow:
  v_mov_b32 v15, s36
  v_writelane_b32 v15, s95, 1
  v_writelane_b32 v15, s61, 2
  v_mov_b32 v254, 1
  v_mov_b32 v255, 0
  s_mov_b64 exec, 7
  buffer_atomic_cmpswap v[254:255], v15, s[16:19], 0 offen sc0 sc1
  s_waitcnt vmcnt(0)
  v_readlane_b32 s88, v254, 0
  v_readlane_b32 s89, v254, 1
  v_readlane_b32 s60, v254, 2
  s_nop 3
  s_max_u32 s89, s89, 1
  s_max_u32 s60, s60, 1
  s_mov_b64 exec, -1
  s_branch L_back
L_done:
  s_endpgm
.section .rodata,"a"
.p2align 6
.amdhsa_kernel standalone__depthwise_separable__vision_kernel
  .amdhsa_next_free_vgpr 512
  .amdhsa_next_free_sgpr 100
  .amdhsa_accum_offset 256
  .amdhsa_group_segment_fixed_size 0
  .amdhsa_kernarg_size 48
  .amdhsa_user_sgpr_count 2
  .amdhsa_user_sgpr_kernarg_segment_ptr 1
  .amdhsa_system_sgpr_workgroup_id_x 1
  .amdhsa_float_denorm_mode_32 3
.end_amdhsa_kernel
```

```asm
; @launch grid=(256,1,1) block=(256,1,1) lds=152128
.amdgcn_target "amdgcn-amd-amdhsa--gfx950"
.text
.globl standalone__depthwise_separable__vision_kernel
.p2align 8
.type standalone__depthwise_separable__vision_kernel,@function
standalone__depthwise_separable__vision_kernel:
  s_load_dwordx8 s[24:31], s[0:1], 0
  s_load_dwordx2 s[92:93], s[0:1], 32
  s_cmp_ge_u32 s2, 256
  s_cbranch_scc1 L_done
  v_lshrrev_b32 v16, 6, v0
  v_and_b32 v28, 63, v0
  v_readfirstlane_b32 s20, v16
  s_getpc_b64 s[50:51]
L_pc:
  v_mul_u32_u24 v18, 128, v0
  v_min_u32 v18, L_done-L_pc, v18
  v_mov_b32 v19, s51
  v_add_co_u32 v18, vcc, s50, v18
  s_nop 1
  v_addc_co_u32 v19, vcc, 0, v19, vcc
  global_load_dword v88, v[18:19], off
  s_lshr_b32 s50, s2, 3
  s_and_b32 s55, s50, 3
  s_lshr_b32 s54, s50, 2
  s_mul_i32 s51, s54, 11
  s_lshr_b32 s51, s51, 5
  s_mul_i32 s51, s51, 3
  s_sub_u32 s54, s54, s51
  s_mul_i32 s52, s20, 192
  v_mul_u32_u24 v18, 0xaaab, v28
  v_lshrrev_b32 v18, 19, v18
  v_mul_u32_u24 v19, 576, v18
  v_lshl_add_u32 v19, v28, 4, v19
  v_add_u32 v64, s52, v19
  v_add_u32 v17, 64, v28
  v_mul_u32_u24 v18, 0xaaab, v17
  v_lshrrev_b32 v18, 19, v18
  v_mul_u32_u24 v19, 576, v18
  v_lshl_add_u32 v19, v28, 4, v19
  v_lshrrev_b32 v18, 3, v18
  v_mul_u32_u24 v18, 6144, v18
  v_add_u32 v19, v19, v18
  v_add_u32 v65, s52, v19
  v_add_u32 v17, 128, v28
  v_mul_u32_u24 v18, 0xaaab, v17
  v_lshrrev_b32 v18, 19, v18
  v_mul_u32_u24 v19, 576, v18
  v_lshl_add_u32 v19, v28, 4, v19
  v_add_u32 v19, 6144, v19
  v_add_u32 v66, s52, v19
  s_mul_i32 s42, s54, 98304
  s_mul_i32 s45, s55, 24576
  s_mul_i32 s49, s20, 6160
  s_waitcnt lgkmcnt(0)
  s_mov_b32 s12, s28
  s_and_b32 s13, s29, 0xffff
  s_mov_b32 s14, 294912
  s_mov_b32 s15, 0x00020000
  s_add_u32 m0, s49, 98560
  s_add_u32 s50, s42, s45
  buffer_load_dwordx4 v64, s[12:15], s50 offen offset:0 lds
  buffer_load_dwordx4 v65, s[12:15], s50 offen offset:1024 lds
  buffer_load_dwordx4 v66, s[12:15], s50 offen offset:2048 lds
  s_add_u32 m0, s49, 101640
  s_add_u32 s50, s50, 6144
  buffer_load_dwordx4 v64, s[12:15], s50 offen offset:0 lds
  buffer_load_dwordx4 v65, s[12:15], s50 offen offset:1024 lds
  buffer_load_dwordx4 v66, s[12:15], s50 offen offset:2048 lds
  s_lshr_b32 s51, s2, 5
  s_and_b32 s52, s2, 3
  s_lshl2_add_u32 s36, s51, s52
  s_lshl_b32 s36, s36, 2
  s_mul_i32 s51, s51, 144
  s_lshr_b32 s52, s52, 1
  s_lshl1_add_u32 s52, s55, s52
  s_add_u32 s51, s51, s52
  s_mul_i32 s32, s51, 98304
  s_add_u32 s35, s32, 14155776
  s_lshl_b32 s51, s20, 11
  s_and_b32 s52, s2, 3
  s_lshl_b32 s52, s52, 8
  s_add_u32 s51, s51, s52
  s_add_u32 s37, s32, s51
  s_add_u32 s37, s37, 7110656
  s_and_b32 s23, s2, 28
  s_bitcmp1_b32 s2, 1
  s_cselect_b32 s21, 98304, 0
  s_sub_u32 s37, s37, s21
  s_add_u32 s38, s37, 8192
  s_cmp_lg_u32 s23, 0
  s_cbranch_scc1 L_np0
  s_load_dword s84, s[24:25], s37 glc
  s_load_dword s85, s[24:25], s38 glc
L_np0:
  s_lshl_b32 s53, s55, 2
  v_lshrrev_b32 v17, 4, v28
  v_add_u32 v18, s54, v17
  v_subrev_u32 v19, 3, v18
  v_min_u32 v18, v18, v19
  v_and_b32 v20, 15, v28
  v_xor_b32 v19, s53, v20
  v_lshlrev_b32 v19, 4, v19
  v_lshl_add_u32 v19, v18, 8, v19
  v_cmp_lt_u32 vcc, 47, v28
  s_lshl_b32 s50, s20, 10
  s_add_u32 m0, s50, 147968
  v_cndmask_b32 v19, v19, v66, vcc
  s_mov_b32 s16, s26
  s_and_b32 s17, s27, 0xffff
  s_mov_b32 s18, 768
  s_mov_b32 s19, 0x00020000
  buffer_load_dwordx4 v19, s[16:19], 0 offen lds
  s_add_u32 s43, s42, 98304
  s_cmp_eq_u32 s54, 2
  s_cselect_b32 s43, 0, s43
  s_add_u32 s44, s43, 98304
  s_cmp_eq_u32 s54, 1
  s_cselect_b32 s44, 0, s44
  s_xor_b32 s46, s55, 1
  s_mul_i32 s46, s46, 24576
  s_xor_b32 s47, s55, 2
  s_mul_i32 s47, s47, 24576
  s_xor_b32 s48, s55, 3
  s_mul_i32 s48, s48, 24576
  s_mov_b32 s4, s24
  s_and_b32 s5, s25, 0xffff
  s_mov_b32 s6, 113246208
  s_mov_b32 s7, 0x00020000
  s_add_u32 s33, s24, 49152
  s_mov_b32 s40, 113246208
  s_mov_b32 s26, 4294942720
  s_mov_b32 s27, 24576
  s_lshl_b32 s39, s20, 10
  s_mov_b32 s76, s40
  s_mov_b32 s77, 0
  s_mov_b32 s78, s40
  s_mov_b32 s79, 0
  s_mov_b32 s80, s40
  s_mov_b32 s81, 0
  s_lshr_b32 s34, s2, 1
  s_xor_b32 s34, s34, s2
  s_and_b32 s34, s34, 4
  s_and_b32 s51, s2, 1
  s_or_b32 s34, s34, s51
  s_lshl_b32 s34, s34, 19
  v_lshrrev_b32 v35, 4, v0
  v_xor_b32 v22, s53, v20
  v_mul_u32_u24 v32, 43, v35
  v_lshrrev_b32 v32, 7, v32
  v_mul_u32_u24 v18, 3, v32
  v_sub_u32 v19, v35, v18
  v_add_u32 v19, s54, v19
  v_subrev_u32 v21, 3, v19
  v_min_u32 v19, v19, v21
  v_add_u32 v19, v19, v18
  v_xor_b32 v21, v32, v22
  v_lshlrev_b32 v21, 4, v21
  v_lshl_add_u32 v8, v19, 8, v21
  v_cmp_eq_u32 vcc, 5, v32
  s_nop 1
  v_cndmask_b32 v12, 0, -1, vcc
  v_add_u32 v36, 16, v35
  v_mul_u32_u24 v33, 43, v36
  v_lshrrev_b32 v33, 7, v33
  v_mul_u32_u24 v18, 3, v33
  v_sub_u32 v19, v36, v18
  v_add_u32 v19, s54, v19
  v_subrev_u32 v21, 3, v19
  v_min_u32 v19, v19, v21
  v_add_u32 v19, v19, v18
  v_xor_b32 v21, v33, v22
  v_lshlrev_b32 v21, 4, v21
  v_lshl_add_u32 v9, v19, 8, v21
  v_add_u32 v37, 32, v35
  v_mul_u32_u24 v34, 43, v37
  v_lshrrev_b32 v34, 7, v34
  v_mul_u32_u24 v18, 3, v34
  v_sub_u32 v19, v37, v18
  v_add_u32 v19, s54, v19
  v_subrev_u32 v21, 3, v19
  v_min_u32 v19, v19, v21
  v_add_u32 v19, v19, v18
  v_xor_b32 v21, v34, v22
  v_lshlrev_b32 v21, 4, v21
  v_lshl_add_u32 v10, v19, 8, v21
  v_cmp_eq_u32 vcc, 10, v34
  s_nop 1
  v_cndmask_b32 v11, 0, -1, vcc
  s_mov_b32 s8, s30
  s_and_b32 s9, s31, 0xffff
  s_mov_b32 s10, 113246208
  s_mov_b32 s11, 0x00020000
  v_lshlrev_b32 v80, 4, v0
  v_and_b32 v21, 7, v32
  v_xor_b32 v21, v21, v20
  v_lshlrev_b32 v21, 4, v21
  v_lshl_add_u32 v21, v35, 8, v21
  v_add_u32 v5, 98560, v21
  v_add_u32 v81, 4096, v80
  v_and_b32 v21, 7, v33
  v_xor_b32 v21, v21, v20
  v_lshlrev_b32 v21, 4, v21
  v_lshl_add_u32 v21, v36, 8, v21
  v_add_u32 v6, 98560, v21
  v_add_u32 v82, 8192, v80
  v_and_b32 v21, 7, v34
  v_xor_b32 v21, v21, v20
  v_lshlrev_b32 v21, 4, v21
  v_lshl_add_u32 v21, v37, 8, v21
  v_add_u32 v7, 98560, v21
  v_mul_u32_u24 v16, 0x300, v20
  v_xor_b32 v18, v17, v20
  v_lshl_add_u32 v1, v18, 4, v16
  v_xor_b32 v2, 64, v1
  v_xor_b32 v3, 128, v1
  v_xor_b32 v4, 192, v1
  s_mul_i32 s51, s20, 12
  v_and_b32 v18, 7, v20
  v_add_u32 v19, s51, v17
  v_xor_b32 v19, v19, v18
  v_lshl_add_u32 v86, v19, 4, v16
  v_add_u32 v86, 98560, v86
  v_add_u32 v19, s51, v17
  v_add_u32 v19, 4, v19
  v_xor_b32 v19, v19, v18
  v_lshl_add_u32 v87, v19, 4, v16
  v_add_u32 v87, 98560, v87
  v_bfe_u32 v18, v28, 2, 2
  v_and_b32 v19, 3, v28
  v_lshrrev_b32 v21, 1, v17
  v_lshl_add_u32 v21, v21, 3, v18
  v_mul_u32_u24 v21, 192, v21
  v_and_b32 v23, 1, v17
  v_mul_u32_u24 v23, 3080, v23
  v_add_u32 v21, v21, v23
  v_lshl_add_u32 v21, v19, 4, v21
  s_add_u32 s51, s49, 49152
  v_add_u32 v71, s51, v21
  v_add_u32 v67, 49408, v71
  s_add_u32 s51, s39, 147968
  v_lshl_add_u32 v68, v17, 4, s51
  v_and_b32 v21, 1, v28
  v_lshlrev_b32 v21, 4, v21
  v_mov_b32 v23, 0xffff
  v_lshlrev_b32 v21, v21, v23
  v_lshlrev_b32 v16, 1, v17
  v_bfe_u32 v23, v28, 1, 3
  v_cmp_eq_u32 vcc, v16, v23
  v_add_u32 v16, 1, v16
  s_nop 0
  v_cndmask_b32 v69, 0, v21, vcc
  v_cmp_eq_u32 vcc, v16, v23
  s_mov_b32 s16, s92
  s_and_b32 s17, s93, 0xffff
  s_mov_b32 s18, 256
  s_mov_b32 s19, 0x00020000
  v_cndmask_b32 v70, 0, v21, vcc
  s_add_u32 m0, s49, 123200
  s_add_u32 s50, s42, s46
  buffer_load_dwordx4 v64, s[12:15], s50 offen offset:0 lds
  buffer_load_dwordx4 v65, s[12:15], s50 offen offset:1024 lds
  buffer_load_dwordx4 v66, s[12:15], s50 offen offset:2048 lds
  s_add_u32 m0, s49, 126280
  s_add_u32 s50, s50, 6144
  buffer_load_dwordx4 v64, s[12:15], s50 offen offset:0 lds
  buffer_load_dwordx4 v65, s[12:15], s50 offen offset:1024 lds
  buffer_load_dwordx4 v66, s[12:15], s50 offen offset:2048 lds
  s_add_u32 m0, s49, 49152
  s_add_u32 s50, s42, s47
  buffer_load_dwordx4 v64, s[12:15], s50 offen offset:0 lds
  buffer_load_dwordx4 v65, s[12:15], s50 offen offset:1024 lds
  buffer_load_dwordx4 v66, s[12:15], s50 offen offset:2048 lds
  s_add_u32 m0, s49, 52232
  s_add_u32 s50, s50, 6144
  buffer_load_dwordx4 v64, s[12:15], s50 offen offset:0 lds
  buffer_load_dwordx4 v65, s[12:15], s50 offen offset:1024 lds
  buffer_load_dwordx4 v66, s[12:15], s50 offen offset:2048 lds
  s_cmp_lg_u32 s23, 0
  s_cbranch_scc1 L_npr
  s_mov_b32 s41, 0xffff
  s_mov_b32 s88, 0xffff
  s_lshl_b32 s52, s20, 2
  s_add_u32 s52, s52, 152064
  v_mov_b32 v16, s52
  s_waitcnt lgkmcnt(0)
  s_memtime s[84:85]
  s_load_dword s52, s[24:25], s37 glc
  s_waitcnt lgkmcnt(0)
  s_memtime s[86:87]
  s_load_dword s52, s[24:25], s38 glc
  s_waitcnt lgkmcnt(0)
  s_sub_u32 s51, s86, s84
  s_memtime s[84:85]
  s_min_u32 s41, s41, s51
  s_waitcnt lgkmcnt(0)
  s_sub_u32 s51, s84, s86
  s_min_u32 s88, s88, s51
  s_lshl_b32 s41, s41, 16
  s_or_b32 s41, s41, s88
  v_mov_b32 v18, s41
  ds_write_b32 v16, v18
  s_waitcnt lgkmcnt(0)
L_npr:
  s_add_u32 m0, s49, 73792
  s_add_u32 s50, s42, s48
  buffer_load_dwordx4 v64, s[12:15], s50 offen offset:0 lds
  buffer_load_dwordx4 v65, s[12:15], s50 offen offset:1024 lds
  buffer_load_dwordx4 v66, s[12:15], s50 offen offset:2048 lds
  s_add_u32 m0, s49, 76872
  s_add_u32 s50, s50, 6144
  buffer_load_dwordx4 v64, s[12:15], s50 offen offset:0 lds
  buffer_load_dwordx4 v65, s[12:15], s50 offen offset:1024 lds
  buffer_load_dwordx4 v66, s[12:15], s50 offen offset:2048 lds
  s_waitcnt vmcnt(18)
  ds_read_b128 v[72:75], v68 offset:0
  ds_read_b64_tr_b16 a[192:193], v67 offset:0
  ds_read_b64_tr_b16 a[194:195], v67 offset:768
  ds_read_b64_tr_b16 a[196:197], v67 offset:8
  ds_read_b64_tr_b16 a[198:199], v67 offset:776
  ds_read_b64_tr_b16 a[200:201], v67 offset:64
  ds_read_b64_tr_b16 a[202:203], v67 offset:832
  ds_read_b64_tr_b16 a[204:205], v67 offset:72
  ds_read_b64_tr_b16 a[206:207], v67 offset:840
  ds_read_b64_tr_b16 a[208:209], v67 offset:128
  ds_read_b64_tr_b16 a[210:211], v67 offset:896
  ds_read_b64_tr_b16 a[212:213], v67 offset:136
  ds_read_b64_tr_b16 a[214:215], v67 offset:904
  s_waitcnt lgkmcnt(0)
  v_and_b32 v72, v69, v72
  v_and_b32 v73, v70, v73
  v_and_b32 v74, v69, v74
  v_and_b32 v75, v70, v75
  s_waitcnt vmcnt(12)
  ds_read_b128 v[76:79], v68 offset:64
  v_mfma_f32_16x16x16_bf16 v[16:19], v[72:73], a[192:193], 0
  ds_read_b64_tr_b16 a[216:217], v67 offset:24640
  ds_read_b64_tr_b16 a[218:219], v67 offset:25408
  v_mfma_f32_16x16x16_bf16 v[20:23], v[74:75], a[194:195], 0
  ds_read_b64_tr_b16 a[220:221], v67 offset:24648
  ds_read_b64_tr_b16 a[222:223], v67 offset:25416
  v_mfma_f32_16x16x16_bf16 v[24:27], v[72:73], a[196:197], 0
  ds_read_b64_tr_b16 a[224:225], v67 offset:24704
  ds_read_b64_tr_b16 a[226:227], v67 offset:25472
  v_mfma_f32_16x16x16_bf16 v[28:31], v[74:75], a[198:199], 0
  ds_read_b64_tr_b16 a[228:229], v67 offset:24712
  ds_read_b64_tr_b16 a[230:231], v67 offset:25480
  v_mfma_f32_16x16x16_bf16 v[32:35], v[72:73], a[200:201], 0
  ds_read_b64_tr_b16 a[232:233], v67 offset:24768
  ds_read_b64_tr_b16 a[234:235], v67 offset:25536
  v_cvt_pk_bf16_f32 v88, v16, v17
  v_cvt_pk_bf16_f32 v89, v18, v19
  v_mfma_f32_16x16x16_bf16 v[36:39], v[74:75], a[202:203], 0
  ds_read_b64_tr_b16 a[236:237], v67 offset:24776
  ds_read_b64_tr_b16 a[238:239], v67 offset:25544
  v_cvt_pk_bf16_f32 v90, v20, v21
  v_cvt_pk_bf16_f32 v91, v22, v23
  v_mfma_f32_16x16x16_bf16 v[40:43], v[72:73], a[204:205], 0
  s_add_u32 m0, s49, 98560
  s_add_u32 s50, s43, s45
  v_cvt_pk_bf16_f32 v92, v24, v25
  v_cvt_pk_bf16_f32 v93, v26, v27
  v_mfma_f32_16x16x16_bf16 v[44:47], v[74:75], a[206:207], 0
  buffer_load_dwordx4 v64, s[12:15], s50 offen offset:0 lds
  buffer_load_dwordx4 v65, s[12:15], s50 offen offset:1024 lds
  v_cvt_pk_bf16_f32 v94, v28, v29
  v_cvt_pk_bf16_f32 v95, v30, v31
  v_mfma_f32_16x16x16_bf16 v[48:51], v[72:73], a[208:209], 0
  buffer_load_dwordx4 v66, s[12:15], s50 offen offset:2048 lds
  s_add_u32 m0, s49, 101640
  v_cvt_pk_bf16_f32 v96, v32, v33
  v_cvt_pk_bf16_f32 v97, v34, v35
  v_mfma_f32_16x16x16_bf16 v[52:55], v[74:75], a[210:211], 0
  s_add_u32 s50, s50, 6144
  buffer_load_dwordx4 v64, s[12:15], s50 offen offset:0 lds
  v_cvt_pk_bf16_f32 v98, v36, v37
  v_cvt_pk_bf16_f32 v99, v38, v39
  v_mfma_f32_16x16x16_bf16 v[56:59], v[72:73], a[212:213], 0
  buffer_load_dwordx4 v65, s[12:15], s50 offen offset:1024 lds
  v_cvt_pk_bf16_f32 v100, v40, v41
  v_cvt_pk_bf16_f32 v101, v42, v43
  v_mfma_f32_16x16x16_bf16 v[60:63], v[74:75], a[214:215], 0
  buffer_load_dwordx4 v66, s[12:15], s50 offen offset:2048 lds
  v_cvt_pk_bf16_f32 v102, v44, v45
  v_cvt_pk_bf16_f32 v103, v46, v47
  s_cmp_lg_u32 s23, 0
  s_cbranch_scc1 L_np1
  s_barrier
  s_or_b32 s51, s23, s20
  s_cmp_lg_u32 s51, 0
  s_cbranch_scc1 L_np1
  v_mov_b32 v248, 152064
  ds_read_b128 v[240:243], v248
  s_add_u32 s51, s33, s32
  s_add_u32 s51, s51, 7077888
  s_sub_u32 s51, s51, s21
  s_lshr_b32 s52, s51, 20
  s_lshr_b32 s50, s2, 1
  s_xor_b32 s52, s52, s50
  s_and_b32 s52, s52, 2
  s_lshr_b32 s51, s51, 17
  s_and_b32 s51, s51, 4
  s_or_b32 s51, s51, s52
  s_or_b32 s51, s51, 1
  v_mov_b32 v251, 0
  v_mov_b32 v248, s36
  s_waitcnt lgkmcnt(0)
  v_pk_min_u16 v240, v240, v241
  v_pk_min_u16 v242, v242, v243
  v_pk_min_u16 v240, v240, v242
  v_lshrrev_b32 v241, 16, v240
  v_and_b32 v240, 0xffff, v240
  v_cmp_gt_u32 vcc, v241, v240
  v_min_u32 v242, v240, v241
  s_nop 0
  v_cndmask_b32 v250, 0, 2, vcc
  v_xor_b32 v250, s51, v250
  s_mov_b64 exec, 1
  v_lshl_or_b32 v250, v242, 16, v250
  buffer_atomic_cmpswap v[250:251], v248, s[16:19], 0 offen sc1
  s_mov_b64 exec, -1
L_np1:
  s_waitcnt lgkmcnt(0)
  v_and_b32 v76, v69, v76
  v_and_b32 v77, v70, v77
  v_and_b32 v78, v69, v78
  v_and_b32 v79, v70, v79
  s_waitcnt vmcnt(12)
  ds_read_b128 v[72:75], v68 offset:128
  v_mfma_f32_16x16x16_bf16 v[16:19], v[76:77], a[216:217], 0
  ds_read_b64_tr_b16 a[192:193], v71 offset:0
  ds_read_b64_tr_b16 a[194:195], v71 offset:768
  v_cvt_pk_bf16_f32 v104, v48, v49
  v_cvt_pk_bf16_f32 v105, v50, v51
  v_mfma_f32_16x16x16_bf16 v[20:23], v[78:79], a[218:219], 0
  ds_read_b64_tr_b16 a[196:197], v71 offset:8
  ds_read_b64_tr_b16 a[198:199], v71 offset:776
  v_cvt_pk_bf16_f32 v106, v52, v53
  v_cvt_pk_bf16_f32 v107, v54, v55
  v_mfma_f32_16x16x16_bf16 v[24:27], v[76:77], a[220:221], 0
  ds_read_b64_tr_b16 a[200:201], v71 offset:64
  ds_read_b64_tr_b16 a[202:203], v71 offset:832
  v_cvt_pk_bf16_f32 v108, v56, v57
  v_cvt_pk_bf16_f32 v109, v58, v59
  v_mfma_f32_16x16x16_bf16 v[28:31], v[78:79], a[222:223], 0
  ds_read_b64_tr_b16 a[204:205], v71 offset:72
  ds_read_b64_tr_b16 a[206:207], v71 offset:840
  v_cvt_pk_bf16_f32 v110, v60, v61
  v_cvt_pk_bf16_f32 v111, v62, v63
  v_mfma_f32_16x16x16_bf16 v[32:35], v[76:77], a[224:225], 0
  ds_read_b64_tr_b16 a[208:209], v71 offset:128
  ds_read_b64_tr_b16 a[210:211], v71 offset:896
  v_cvt_pk_bf16_f32 v16, v16, v17
  v_cvt_pk_bf16_f32 v17, v18, v19
  v_accvgpr_write_b32 a0, v16
  v_accvgpr_write_b32 a1, v17
  v_mfma_f32_16x16x16_bf16 v[36:39], v[78:79], a[226:227], 0
  ds_read_b64_tr_b16 a[212:213], v71 offset:136
  ds_read_b64_tr_b16 a[214:215], v71 offset:904
  v_cvt_pk_bf16_f32 v20, v20, v21
  v_cvt_pk_bf16_f32 v21, v22, v23
  v_accvgpr_write_b32 a2, v20
  v_accvgpr_write_b32 a3, v21
  v_mfma_f32_16x16x16_bf16 v[40:43], v[76:77], a[228:229], 0
  s_add_u32 m0, s49, 123200
  s_add_u32 s50, s43, s46
  v_cvt_pk_bf16_f32 v24, v24, v25
  v_cvt_pk_bf16_f32 v25, v26, v27
  v_accvgpr_write_b32 a4, v24
  v_accvgpr_write_b32 a5, v25
  v_mfma_f32_16x16x16_bf16 v[44:47], v[78:79], a[230:231], 0
  buffer_load_dwordx4 v64, s[12:15], s50 offen offset:0 lds
  buffer_load_dwordx4 v65, s[12:15], s50 offen offset:1024 lds
  v_cvt_pk_bf16_f32 v28, v28, v29
  v_cvt_pk_bf16_f32 v29, v30, v31
  v_accvgpr_write_b32 a6, v28
  v_accvgpr_write_b32 a7, v29
  v_mfma_f32_16x16x16_bf16 v[48:51], v[76:77], a[232:233], 0
  buffer_load_dwordx4 v66, s[12:15], s50 offen offset:2048 lds
  s_add_u32 m0, s49, 126280
  v_cvt_pk_bf16_f32 v32, v32, v33
  v_cvt_pk_bf16_f32 v33, v34, v35
  v_accvgpr_write_b32 a8, v32
  v_accvgpr_write_b32 a9, v33
  v_mfma_f32_16x16x16_bf16 v[52:55], v[78:79], a[234:235], 0
  s_add_u32 s50, s50, 6144
  buffer_load_dwordx4 v64, s[12:15], s50 offen offset:0 lds
  v_cvt_pk_bf16_f32 v36, v36, v37
  v_cvt_pk_bf16_f32 v37, v38, v39
  v_accvgpr_write_b32 a10, v36
  v_accvgpr_write_b32 a11, v37
  v_mfma_f32_16x16x16_bf16 v[56:59], v[76:77], a[236:237], 0
  buffer_load_dwordx4 v65, s[12:15], s50 offen offset:1024 lds
  v_cvt_pk_bf16_f32 v40, v40, v41
  v_cvt_pk_bf16_f32 v41, v42, v43
  v_accvgpr_write_b32 a12, v40
  v_accvgpr_write_b32 a13, v41
  v_mfma_f32_16x16x16_bf16 v[60:63], v[78:79], a[238:239], 0
  buffer_load_dwordx4 v66, s[12:15], s50 offen offset:2048 lds
  v_cvt_pk_bf16_f32 v44, v44, v45
  v_cvt_pk_bf16_f32 v45, v46, v47
  v_accvgpr_write_b32 a14, v44
  v_accvgpr_write_b32 a15, v45
  s_waitcnt lgkmcnt(0)
  v_and_b32 v72, v69, v72
  v_and_b32 v73, v70, v73
  v_and_b32 v74, v69, v74
  v_and_b32 v75, v70, v75
  s_waitcnt vmcnt(12)
  ds_read_b128 v[76:79], v68 offset:192
  v_mfma_f32_16x16x16_bf16 v[16:19], v[72:73], a[192:193], 0
  ds_read_b64_tr_b16 a[216:217], v71 offset:24640
  ds_read_b64_tr_b16 a[218:219], v71 offset:25408
  v_cvt_pk_bf16_f32 v48, v48, v49
  v_cvt_pk_bf16_f32 v49, v50, v51
  v_accvgpr_write_b32 a16, v48
  v_accvgpr_write_b32 a17, v49
  v_mfma_f32_16x16x16_bf16 v[20:23], v[74:75], a[194:195], 0
  ds_read_b64_tr_b16 a[220:221], v71 offset:24648
  ds_read_b64_tr_b16 a[222:223], v71 offset:25416
  v_cvt_pk_bf16_f32 v52, v52, v53
  v_cvt_pk_bf16_f32 v53, v54, v55
  v_accvgpr_write_b32 a18, v52
  v_accvgpr_write_b32 a19, v53
  v_mfma_f32_16x16x16_bf16 v[24:27], v[72:73], a[196:197], 0
  ds_read_b64_tr_b16 a[224:225], v71 offset:24704
  ds_read_b64_tr_b16 a[226:227], v71 offset:25472
  v_cvt_pk_bf16_f32 v56, v56, v57
  v_cvt_pk_bf16_f32 v57, v58, v59
  v_accvgpr_write_b32 a20, v56
  v_accvgpr_write_b32 a21, v57
  v_mfma_f32_16x16x16_bf16 v[28:31], v[74:75], a[198:199], 0
  ds_read_b64_tr_b16 a[228:229], v71 offset:24712
  ds_read_b64_tr_b16 a[230:231], v71 offset:25480
  v_cvt_pk_bf16_f32 v60, v60, v61
  v_cvt_pk_bf16_f32 v61, v62, v63
  v_accvgpr_write_b32 a22, v60
  v_accvgpr_write_b32 a23, v61
  v_mfma_f32_16x16x16_bf16 v[32:35], v[72:73], a[200:201], 0
  ds_read_b64_tr_b16 a[232:233], v71 offset:24768
  ds_read_b64_tr_b16 a[234:235], v71 offset:25536
  v_cvt_pk_bf16_f32 v112, v16, v17
  v_cvt_pk_bf16_f32 v113, v18, v19
  v_mfma_f32_16x16x16_bf16 v[36:39], v[74:75], a[202:203], 0
  ds_read_b64_tr_b16 a[236:237], v71 offset:24776
  ds_read_b64_tr_b16 a[238:239], v71 offset:25544
  v_cvt_pk_bf16_f32 v114, v20, v21
  v_cvt_pk_bf16_f32 v115, v22, v23
  v_mfma_f32_16x16x16_bf16 v[40:43], v[72:73], a[204:205], 0
  s_add_u32 m0, s49, 49152
  s_add_u32 s50, s43, s47
  v_cvt_pk_bf16_f32 v116, v24, v25
  v_cvt_pk_bf16_f32 v117, v26, v27
  v_mfma_f32_16x16x16_bf16 v[44:47], v[74:75], a[206:207], 0
  buffer_load_dwordx4 v64, s[12:15], s50 offen offset:0 lds
  buffer_load_dwordx4 v65, s[12:15], s50 offen offset:1024 lds
  v_cvt_pk_bf16_f32 v118, v28, v29
  v_cvt_pk_bf16_f32 v119, v30, v31
  v_mfma_f32_16x16x16_bf16 v[48:51], v[72:73], a[208:209], 0
  buffer_load_dwordx4 v66, s[12:15], s50 offen offset:2048 lds
  s_add_u32 m0, s49, 52232
  v_cvt_pk_bf16_f32 v120, v32, v33
  v_cvt_pk_bf16_f32 v121, v34, v35
  v_mfma_f32_16x16x16_bf16 v[52:55], v[74:75], a[210:211], 0
  s_add_u32 s50, s50, 6144
  buffer_load_dwordx4 v64, s[12:15], s50 offen offset:0 lds
  v_cvt_pk_bf16_f32 v122, v36, v37
  v_cvt_pk_bf16_f32 v123, v38, v39
  v_mfma_f32_16x16x16_bf16 v[56:59], v[72:73], a[212:213], 0
  buffer_load_dwordx4 v65, s[12:15], s50 offen offset:1024 lds
  v_cvt_pk_bf16_f32 v124, v40, v41
  v_cvt_pk_bf16_f32 v125, v42, v43
  v_mfma_f32_16x16x16_bf16 v[60:63], v[74:75], a[214:215], 0
  buffer_load_dwordx4 v66, s[12:15], s50 offen offset:2048 lds
  v_cvt_pk_bf16_f32 v126, v44, v45
  v_cvt_pk_bf16_f32 v127, v46, v47
  s_waitcnt lgkmcnt(0)
  v_and_b32 v76, v69, v76
  v_and_b32 v77, v70, v77
  v_and_b32 v78, v69, v78
  v_and_b32 v79, v70, v79
  s_waitcnt vmcnt(12)
  ds_read_b128 v[72:75], v68 offset:256
  v_mfma_f32_16x16x16_bf16 v[16:19], v[76:77], a[216:217], 0
  ds_read_b64_tr_b16 a[192:193], v67 offset:0
  ds_read_b64_tr_b16 a[194:195], v67 offset:768
  v_cvt_pk_bf16_f32 v128, v48, v49
  v_cvt_pk_bf16_f32 v129, v50, v51
  v_mfma_f32_16x16x16_bf16 v[20:23], v[78:79], a[218:219], 0
  ds_read_b64_tr_b16 a[196:197], v67 offset:8
  ds_read_b64_tr_b16 a[198:199], v67 offset:776
  v_cvt_pk_bf16_f32 v130, v52, v53
  v_cvt_pk_bf16_f32 v131, v54, v55
  v_mfma_f32_16x16x16_bf16 v[24:27], v[76:77], a[220:221], 0
  ds_read_b64_tr_b16 a[200:201], v67 offset:64
  ds_read_b64_tr_b16 a[202:203], v67 offset:832
  v_cvt_pk_bf16_f32 v132, v56, v57
  v_cvt_pk_bf16_f32 v133, v58, v59
  v_mfma_f32_16x16x16_bf16 v[28:31], v[78:79], a[222:223], 0
  ds_read_b64_tr_b16 a[204:205], v67 offset:72
  ds_read_b64_tr_b16 a[206:207], v67 offset:840
  v_cvt_pk_bf16_f32 v134, v60, v61
  v_cvt_pk_bf16_f32 v135, v62, v63
  v_mfma_f32_16x16x16_bf16 v[32:35], v[76:77], a[224:225], 0
  ds_read_b64_tr_b16 a[208:209], v67 offset:128
  ds_read_b64_tr_b16 a[210:211], v67 offset:896
  v_cvt_pk_bf16_f32 v16, v16, v17
  v_cvt_pk_bf16_f32 v17, v18, v19
  v_accvgpr_write_b32 a24, v16
  v_accvgpr_write_b32 a25, v17
  v_mfma_f32_16x16x16_bf16 v[36:39], v[78:79], a[226:227], 0
  ds_read_b64_tr_b16 a[212:213], v67 offset:136
  ds_read_b64_tr_b16 a[214:215], v67 offset:904
  v_cvt_pk_bf16_f32 v20, v20, v21
  v_cvt_pk_bf16_f32 v21, v22, v23
  v_accvgpr_write_b32 a26, v20
  v_accvgpr_write_b32 a27, v21
  v_mfma_f32_16x16x16_bf16 v[40:43], v[76:77], a[228:229], 0
  s_add_u32 m0, s49, 73792
  s_add_u32 s50, s43, s48
  v_cvt_pk_bf16_f32 v24, v24, v25
  v_cvt_pk_bf16_f32 v25, v26, v27
  v_accvgpr_write_b32 a28, v24
  v_accvgpr_write_b32 a29, v25
  v_mfma_f32_16x16x16_bf16 v[44:47], v[78:79], a[230:231], 0
  buffer_load_dwordx4 v64, s[12:15], s50 offen offset:0 lds
  buffer_load_dwordx4 v65, s[12:15], s50 offen offset:1024 lds
  v_cvt_pk_bf16_f32 v28, v28, v29
  v_cvt_pk_bf16_f32 v29, v30, v31
  v_accvgpr_write_b32 a30, v28
  v_accvgpr_write_b32 a31, v29
  v_mfma_f32_16x16x16_bf16 v[48:51], v[76:77], a[232:233], 0
  buffer_load_dwordx4 v66, s[12:15], s50 offen offset:2048 lds
  s_add_u32 m0, s49, 76872
  v_cvt_pk_bf16_f32 v32, v32, v33
  v_cvt_pk_bf16_f32 v33, v34, v35
  v_accvgpr_write_b32 a32, v32
  v_accvgpr_write_b32 a33, v33
  v_mfma_f32_16x16x16_bf16 v[52:55], v[78:79], a[234:235], 0
  s_add_u32 s50, s50, 6144
  buffer_load_dwordx4 v64, s[12:15], s50 offen offset:0 lds
  v_cvt_pk_bf16_f32 v36, v36, v37
  v_cvt_pk_bf16_f32 v37, v38, v39
  v_accvgpr_write_b32 a34, v36
  v_accvgpr_write_b32 a35, v37
  v_mfma_f32_16x16x16_bf16 v[56:59], v[76:77], a[236:237], 0
  buffer_load_dwordx4 v65, s[12:15], s50 offen offset:1024 lds
  v_cvt_pk_bf16_f32 v40, v40, v41
  v_cvt_pk_bf16_f32 v41, v42, v43
  v_accvgpr_write_b32 a36, v40
  v_accvgpr_write_b32 a37, v41
  v_mfma_f32_16x16x16_bf16 v[60:63], v[78:79], a[238:239], 0
  buffer_load_dwordx4 v66, s[12:15], s50 offen offset:2048 lds
  v_cvt_pk_bf16_f32 v44, v44, v45
  v_cvt_pk_bf16_f32 v45, v46, v47
  v_accvgpr_write_b32 a38, v44
  v_accvgpr_write_b32 a39, v45
  s_waitcnt lgkmcnt(0)
  v_and_b32 v72, v69, v72
  v_and_b32 v73, v70, v73
  v_and_b32 v74, v69, v74
  v_and_b32 v75, v70, v75
  s_waitcnt vmcnt(12)
  ds_read_b128 v[76:79], v68 offset:320
  v_mfma_f32_16x16x16_bf16 v[16:19], v[72:73], a[192:193], 0
  ds_read_b64_tr_b16 a[216:217], v67 offset:24640
  ds_read_b64_tr_b16 a[218:219], v67 offset:25408
  v_cvt_pk_bf16_f32 v48, v48, v49
  v_cvt_pk_bf16_f32 v49, v50, v51
  v_accvgpr_write_b32 a40, v48
  v_accvgpr_write_b32 a41, v49
  v_mfma_f32_16x16x16_bf16 v[20:23], v[74:75], a[194:195], 0
  ds_read_b64_tr_b16 a[220:221], v67 offset:24648
  ds_read_b64_tr_b16 a[222:223], v67 offset:25416
  v_cvt_pk_bf16_f32 v52, v52, v53
  v_cvt_pk_bf16_f32 v53, v54, v55
  v_accvgpr_write_b32 a42, v52
  v_accvgpr_write_b32 a43, v53
  v_mfma_f32_16x16x16_bf16 v[24:27], v[72:73], a[196:197], 0
  ds_read_b64_tr_b16 a[224:225], v67 offset:24704
  ds_read_b64_tr_b16 a[226:227], v67 offset:25472
  v_cvt_pk_bf16_f32 v56, v56, v57
  v_cvt_pk_bf16_f32 v57, v58, v59
  v_accvgpr_write_b32 a44, v56
  v_accvgpr_write_b32 a45, v57
  v_mfma_f32_16x16x16_bf16 v[28:31], v[74:75], a[198:199], 0
  ds_read_b64_tr_b16 a[228:229], v67 offset:24712
  ds_read_b64_tr_b16 a[230:231], v67 offset:25480
  v_cvt_pk_bf16_f32 v60, v60, v61
  v_cvt_pk_bf16_f32 v61, v62, v63
  v_accvgpr_write_b32 a46, v60
  v_accvgpr_write_b32 a47, v61
  v_mfma_f32_16x16x16_bf16 v[32:35], v[72:73], a[200:201], 0
  ds_read_b64_tr_b16 a[232:233], v67 offset:24768
  ds_read_b64_tr_b16 a[234:235], v67 offset:25536
  v_cvt_pk_bf16_f32 v136, v16, v17
  v_cvt_pk_bf16_f32 v137, v18, v19
  v_mfma_f32_16x16x16_bf16 v[36:39], v[74:75], a[202:203], 0
  ds_read_b64_tr_b16 a[236:237], v67 offset:24776
  ds_read_b64_tr_b16 a[238:239], v67 offset:25544
  v_cvt_pk_bf16_f32 v138, v20, v21
  v_cvt_pk_bf16_f32 v139, v22, v23
  v_mfma_f32_16x16x16_bf16 v[40:43], v[72:73], a[204:205], 0
  s_add_u32 m0, s49, 98560
  s_add_u32 s50, s44, s45
  v_cvt_pk_bf16_f32 v140, v24, v25
  v_cvt_pk_bf16_f32 v141, v26, v27
  v_mfma_f32_16x16x16_bf16 v[44:47], v[74:75], a[206:207], 0
  buffer_load_dwordx4 v64, s[12:15], s50 offen offset:0 lds
  buffer_load_dwordx4 v65, s[12:15], s50 offen offset:1024 lds
  v_cvt_pk_bf16_f32 v142, v28, v29
  v_cvt_pk_bf16_f32 v143, v30, v31
  v_mfma_f32_16x16x16_bf16 v[48:51], v[72:73], a[208:209], 0
  buffer_load_dwordx4 v66, s[12:15], s50 offen offset:2048 lds
  s_add_u32 m0, s49, 101640
  v_cvt_pk_bf16_f32 v144, v32, v33
  v_cvt_pk_bf16_f32 v145, v34, v35
  v_mfma_f32_16x16x16_bf16 v[52:55], v[74:75], a[210:211], 0
  s_add_u32 s50, s50, 6144
  buffer_load_dwordx4 v64, s[12:15], s50 offen offset:0 lds
  v_cvt_pk_bf16_f32 v146, v36, v37
  v_cvt_pk_bf16_f32 v147, v38, v39
  v_mfma_f32_16x16x16_bf16 v[56:59], v[72:73], a[212:213], 0
  buffer_load_dwordx4 v65, s[12:15], s50 offen offset:1024 lds
  v_cvt_pk_bf16_f32 v148, v40, v41
  v_cvt_pk_bf16_f32 v149, v42, v43
  v_mfma_f32_16x16x16_bf16 v[60:63], v[74:75], a[214:215], 0
  buffer_load_dwordx4 v66, s[12:15], s50 offen offset:2048 lds
  v_cvt_pk_bf16_f32 v150, v44, v45
  v_cvt_pk_bf16_f32 v151, v46, v47
  s_waitcnt lgkmcnt(0)
  v_and_b32 v76, v69, v76
  v_and_b32 v77, v70, v77
  v_and_b32 v78, v69, v78
  v_and_b32 v79, v70, v79
  s_waitcnt vmcnt(12)
  ds_read_b128 v[72:75], v68 offset:384
  v_mfma_f32_16x16x16_bf16 v[16:19], v[76:77], a[216:217], 0
  ds_read_b64_tr_b16 a[192:193], v71 offset:0
  ds_read_b64_tr_b16 a[194:195], v71 offset:768
  v_cvt_pk_bf16_f32 v152, v48, v49
  v_cvt_pk_bf16_f32 v153, v50, v51
  v_mfma_f32_16x16x16_bf16 v[20:23], v[78:79], a[218:219], 0
  ds_read_b64_tr_b16 a[196:197], v71 offset:8
  ds_read_b64_tr_b16 a[198:199], v71 offset:776
  v_cvt_pk_bf16_f32 v154, v52, v53
  v_cvt_pk_bf16_f32 v155, v54, v55
  v_mfma_f32_16x16x16_bf16 v[24:27], v[76:77], a[220:221], 0
  ds_read_b64_tr_b16 a[200:201], v71 offset:64
  ds_read_b64_tr_b16 a[202:203], v71 offset:832
  v_cvt_pk_bf16_f32 v156, v56, v57
  v_cvt_pk_bf16_f32 v157, v58, v59
  v_mfma_f32_16x16x16_bf16 v[28:31], v[78:79], a[222:223], 0
  ds_read_b64_tr_b16 a[204:205], v71 offset:72
  ds_read_b64_tr_b16 a[206:207], v71 offset:840
  v_cvt_pk_bf16_f32 v158, v60, v61
  v_cvt_pk_bf16_f32 v159, v62, v63
  v_mfma_f32_16x16x16_bf16 v[32:35], v[76:77], a[224:225], 0
  ds_read_b64_tr_b16 a[208:209], v71 offset:128
  ds_read_b64_tr_b16 a[210:211], v71 offset:896
  v_cvt_pk_bf16_f32 v16, v16, v17
  v_cvt_pk_bf16_f32 v17, v18, v19
  v_accvgpr_write_b32 a48, v16
  v_accvgpr_write_b32 a49, v17
  v_mfma_f32_16x16x16_bf16 v[36:39], v[78:79], a[226:227], 0
  ds_read_b64_tr_b16 a[212:213], v71 offset:136
  ds_read_b64_tr_b16 a[214:215], v71 offset:904
  v_cvt_pk_bf16_f32 v20, v20, v21
  v_cvt_pk_bf16_f32 v21, v22, v23
  v_accvgpr_write_b32 a50, v20
  v_accvgpr_write_b32 a51, v21
  v_mfma_f32_16x16x16_bf16 v[40:43], v[76:77], a[228:229], 0
  s_add_u32 m0, s49, 123200
  s_add_u32 s50, s44, s46
  v_cvt_pk_bf16_f32 v24, v24, v25
  v_cvt_pk_bf16_f32 v25, v26, v27
  v_accvgpr_write_b32 a52, v24
  v_accvgpr_write_b32 a53, v25
  v_mfma_f32_16x16x16_bf16 v[44:47], v[78:79], a[230:231], 0
  buffer_load_dwordx4 v64, s[12:15], s50 offen offset:0 lds
  buffer_load_dwordx4 v65, s[12:15], s50 offen offset:1024 lds
  v_cvt_pk_bf16_f32 v28, v28, v29
  v_cvt_pk_bf16_f32 v29, v30, v31
  v_accvgpr_write_b32 a54, v28
  v_accvgpr_write_b32 a55, v29
  v_mfma_f32_16x16x16_bf16 v[48:51], v[76:77], a[232:233], 0
  buffer_load_dwordx4 v66, s[12:15], s50 offen offset:2048 lds
  s_add_u32 m0, s49, 126280
  v_cvt_pk_bf16_f32 v32, v32, v33
  v_cvt_pk_bf16_f32 v33, v34, v35
  v_accvgpr_write_b32 a56, v32
  v_accvgpr_write_b32 a57, v33
  v_mfma_f32_16x16x16_bf16 v[52:55], v[78:79], a[234:235], 0
  s_add_u32 s50, s50, 6144
  buffer_load_dwordx4 v64, s[12:15], s50 offen offset:0 lds
  v_cvt_pk_bf16_f32 v36, v36, v37
  v_cvt_pk_bf16_f32 v37, v38, v39
  v_accvgpr_write_b32 a58, v36
  v_accvgpr_write_b32 a59, v37
  v_mfma_f32_16x16x16_bf16 v[56:59], v[76:77], a[236:237], 0
  buffer_load_dwordx4 v65, s[12:15], s50 offen offset:1024 lds
  v_cvt_pk_bf16_f32 v40, v40, v41
  v_cvt_pk_bf16_f32 v41, v42, v43
  v_accvgpr_write_b32 a60, v40
  v_accvgpr_write_b32 a61, v41
  v_mfma_f32_16x16x16_bf16 v[60:63], v[78:79], a[238:239], 0
  buffer_load_dwordx4 v66, s[12:15], s50 offen offset:2048 lds
  v_cvt_pk_bf16_f32 v44, v44, v45
  v_cvt_pk_bf16_f32 v45, v46, v47
  v_accvgpr_write_b32 a62, v44
  v_accvgpr_write_b32 a63, v45
  s_waitcnt lgkmcnt(0)
  v_and_b32 v72, v69, v72
  v_and_b32 v73, v70, v73
  v_and_b32 v74, v69, v74
  v_and_b32 v75, v70, v75
  s_waitcnt vmcnt(12)
  ds_read_b128 v[76:79], v68 offset:448
  v_mfma_f32_16x16x16_bf16 v[16:19], v[72:73], a[192:193], 0
  ds_read_b64_tr_b16 a[216:217], v71 offset:24640
  ds_read_b64_tr_b16 a[218:219], v71 offset:25408
  v_cvt_pk_bf16_f32 v48, v48, v49
  v_cvt_pk_bf16_f32 v49, v50, v51
  v_accvgpr_write_b32 a64, v48
  v_accvgpr_write_b32 a65, v49
  v_mfma_f32_16x16x16_bf16 v[20:23], v[74:75], a[194:195], 0
  ds_read_b64_tr_b16 a[220:221], v71 offset:24648
  ds_read_b64_tr_b16 a[222:223], v71 offset:25416
  v_cvt_pk_bf16_f32 v52, v52, v53
  v_cvt_pk_bf16_f32 v53, v54, v55
  v_accvgpr_write_b32 a66, v52
  v_accvgpr_write_b32 a67, v53
  v_mfma_f32_16x16x16_bf16 v[24:27], v[72:73], a[196:197], 0
  ds_read_b64_tr_b16 a[224:225], v71 offset:24704
  ds_read_b64_tr_b16 a[226:227], v71 offset:25472
  v_cvt_pk_bf16_f32 v56, v56, v57
  v_cvt_pk_bf16_f32 v57, v58, v59
  v_accvgpr_write_b32 a68, v56
  v_accvgpr_write_b32 a69, v57
  v_mfma_f32_16x16x16_bf16 v[28:31], v[74:75], a[198:199], 0
  ds_read_b64_tr_b16 a[228:229], v71 offset:24712
  ds_read_b64_tr_b16 a[230:231], v71 offset:25480
  v_cvt_pk_bf16_f32 v60, v60, v61
  v_cvt_pk_bf16_f32 v61, v62, v63
  v_accvgpr_write_b32 a70, v60
  v_accvgpr_write_b32 a71, v61
  v_mfma_f32_16x16x16_bf16 v[32:35], v[72:73], a[200:201], 0
  ds_read_b64_tr_b16 a[232:233], v71 offset:24768
  ds_read_b64_tr_b16 a[234:235], v71 offset:25536
  v_cvt_pk_bf16_f32 v160, v16, v17
  v_cvt_pk_bf16_f32 v161, v18, v19
  v_mfma_f32_16x16x16_bf16 v[36:39], v[74:75], a[202:203], 0
  ds_read_b64_tr_b16 a[236:237], v71 offset:24776
  ds_read_b64_tr_b16 a[238:239], v71 offset:25544
  v_cvt_pk_bf16_f32 v162, v20, v21
  v_cvt_pk_bf16_f32 v163, v22, v23
  v_mfma_f32_16x16x16_bf16 v[40:43], v[72:73], a[204:205], 0
  s_add_u32 m0, s49, 49152
  s_add_u32 s50, s44, s47
  v_cvt_pk_bf16_f32 v164, v24, v25
  v_cvt_pk_bf16_f32 v165, v26, v27
  v_mfma_f32_16x16x16_bf16 v[44:47], v[74:75], a[206:207], 0
  buffer_load_dwordx4 v64, s[12:15], s50 offen offset:0 lds
  buffer_load_dwordx4 v65, s[12:15], s50 offen offset:1024 lds
  v_cvt_pk_bf16_f32 v166, v28, v29
  v_cvt_pk_bf16_f32 v167, v30, v31
  v_mfma_f32_16x16x16_bf16 v[48:51], v[72:73], a[208:209], 0
  buffer_load_dwordx4 v66, s[12:15], s50 offen offset:2048 lds
  s_add_u32 m0, s49, 52232
  v_cvt_pk_bf16_f32 v168, v32, v33
  v_cvt_pk_bf16_f32 v169, v34, v35
  v_mfma_f32_16x16x16_bf16 v[52:55], v[74:75], a[210:211], 0
  s_add_u32 s50, s50, 6144
  buffer_load_dwordx4 v64, s[12:15], s50 offen offset:0 lds
  v_cvt_pk_bf16_f32 v170, v36, v37
  v_cvt_pk_bf16_f32 v171, v38, v39
  v_mfma_f32_16x16x16_bf16 v[56:59], v[72:73], a[212:213], 0
  buffer_load_dwordx4 v65, s[12:15], s50 offen offset:1024 lds
  v_cvt_pk_bf16_f32 v172, v40, v41
  v_cvt_pk_bf16_f32 v173, v42, v43
  v_mfma_f32_16x16x16_bf16 v[60:63], v[74:75], a[214:215], 0
  buffer_load_dwordx4 v66, s[12:15], s50 offen offset:2048 lds
  v_cvt_pk_bf16_f32 v174, v44, v45
  v_cvt_pk_bf16_f32 v175, v46, v47
  s_waitcnt lgkmcnt(0)
  v_and_b32 v76, v69, v76
  v_and_b32 v77, v70, v77
  v_and_b32 v78, v69, v78
  v_and_b32 v79, v70, v79
  s_waitcnt vmcnt(12)
  ds_read_b128 v[72:75], v68 offset:512
  v_mfma_f32_16x16x16_bf16 v[16:19], v[76:77], a[216:217], 0
  ds_read_b64_tr_b16 a[192:193], v67 offset:0
  ds_read_b64_tr_b16 a[194:195], v67 offset:768
  ds_read_b64_tr_b16 a[196:197], v67 offset:8
  ds_read_b64_tr_b16 a[198:199], v67 offset:776
  ds_read_b64_tr_b16 a[200:201], v67 offset:64
  ds_read_b64_tr_b16 a[202:203], v67 offset:832
  v_cvt_pk_bf16_f32 v176, v48, v49
  v_cvt_pk_bf16_f32 v177, v50, v51
  v_mfma_f32_16x16x16_bf16 v[20:23], v[78:79], a[218:219], 0
  ds_read_b64_tr_b16 a[204:205], v67 offset:72
  ds_read_b64_tr_b16 a[206:207], v67 offset:840
  ds_read_b64_tr_b16 a[208:209], v67 offset:128
  ds_read_b64_tr_b16 a[210:211], v67 offset:896
  ds_read_b64_tr_b16 a[212:213], v67 offset:136
  ds_read_b64_tr_b16 a[214:215], v67 offset:904
  v_cvt_pk_bf16_f32 v178, v52, v53
  v_cvt_pk_bf16_f32 v179, v54, v55
  v_mfma_f32_16x16x16_bf16 v[24:27], v[76:77], a[220:221], 0
  s_add_u32 m0, s49, 73792
  s_add_u32 s50, s44, s48
  buffer_load_dwordx4 v64, s[12:15], s50 offen offset:0 lds
  buffer_load_dwordx4 v65, s[12:15], s50 offen offset:1024 lds
  buffer_load_dwordx4 v66, s[12:15], s50 offen offset:2048 lds
  s_add_u32 m0, s49, 76872
  v_cvt_pk_bf16_f32 v180, v56, v57
  v_cvt_pk_bf16_f32 v181, v58, v59
  v_mfma_f32_16x16x16_bf16 v[28:31], v[78:79], a[222:223], 0
  s_add_u32 s50, s50, 6144
  buffer_load_dwordx4 v64, s[12:15], s50 offen offset:0 lds
  buffer_load_dwordx4 v65, s[12:15], s50 offen offset:1024 lds
  buffer_load_dwordx4 v66, s[12:15], s50 offen offset:2048 lds
  s_mov_b64 s[82:83], s[80:81]
  s_mov_b64 s[80:81], s[78:79]
  v_cvt_pk_bf16_f32 v182, v60, v61
  v_cvt_pk_bf16_f32 v183, v62, v63
  v_mfma_f32_16x16x16_bf16 v[32:35], v[76:77], a[224:225], 0
  s_mov_b64 s[78:79], s[76:77]
  s_add_u32 s76, s33, s32
  s_xor_b32 s76, s76, s34
  s_bfe_u32 s77, s76, 65557
  s_bfe_u32 s76, s76, 65555
  s_lshl1_add_u32 s77, s76, s77
  v_cvt_pk_bf16_f32 v16, v16, v17
  v_cvt_pk_bf16_f32 v17, v18, v19
  v_accvgpr_write_b32 a72, v16
  v_accvgpr_write_b32 a73, v17
  v_mfma_f32_16x16x16_bf16 v[36:39], v[78:79], a[226:227], 0
  s_sub_u32 s77, 1, s77
  s_and_b32 s77, s77, 3
  s_mul_i32 s77, s77, 24576
  s_cmp_lt_u32 s32, s35
  s_cselect_b32 s76, s32, s40
  s_add_u32 s32, s32, 786432
  v_cvt_pk_bf16_f32 v20, v20, v21
  v_cvt_pk_bf16_f32 v21, v22, v23
  v_accvgpr_write_b32 a74, v20
  v_accvgpr_write_b32 a75, v21
  v_mfma_f32_16x16x16_bf16 v[40:43], v[76:77], a[228:229], 0
  s_cmp_eq_u32 s77, 0
  s_cselect_b32 s57, 73728, s26
  s_add_u32 s22, s76, s77
  s_add_u32 s22, s22, s57
  s_min_u32 s22, s22, s40
  s_add_u32 m0, s39, 0
  v_cvt_pk_bf16_f32 v24, v24, v25
  v_cvt_pk_bf16_f32 v25, v26, v27
  v_accvgpr_write_b32 a76, v24
  v_accvgpr_write_b32 a77, v25
  v_mfma_f32_16x16x16_bf16 v[44:47], v[78:79], a[230:231], 0
  s_nop 0
  buffer_load_dwordx4 v8, s[4:7], s22 offen nt lds
  s_add_u32 m0, s39, 4096
  s_nop 0
  buffer_load_dwordx4 v9, s[4:7], s22 offen nt lds
  v_and_b32 v15, s57, v11
  v_cvt_pk_bf16_f32 v28, v28, v29
  v_cvt_pk_bf16_f32 v29, v30, v31
  v_accvgpr_write_b32 a78, v28
  v_accvgpr_write_b32 a79, v29
  v_mfma_f32_16x16x16_bf16 v[48:51], v[76:77], a[232:233], 0
  v_add3_u32 v15, v10, v15, s77
  s_add_u32 m0, s39, 8192
  s_nop 0
  buffer_load_dwordx4 v15, s[4:7], s76 offen nt lds
  s_cmp_eq_u32 s77, 73728
  s_cselect_b32 s57, 4294893568, s27
  v_cvt_pk_bf16_f32 v32, v32, v33
  v_cvt_pk_bf16_f32 v33, v34, v35
  v_accvgpr_write_b32 a80, v32
  v_accvgpr_write_b32 a81, v33
  v_mfma_f32_16x16x16_bf16 v[52:55], v[78:79], a[234:235], 0
  s_add_u32 s90, s77, 12288
  s_add_u32 s56, s76, s90
  s_add_u32 s56, s56, s57
  s_min_u32 s56, s56, s40
  v_and_b32 v15, s57, v12
  v_cvt_pk_bf16_f32 v36, v36, v37
  v_cvt_pk_bf16_f32 v37, v38, v39
  v_accvgpr_write_b32 a82, v36
  v_accvgpr_write_b32 a83, v37
  v_mfma_f32_16x16x16_bf16 v[56:59], v[76:77], a[236:237], 0
  v_add3_u32 v15, v8, v15, s90
  s_add_u32 m0, s39, 12288
  s_nop 0
  buffer_load_dwordx4 v15, s[4:7], s76 offen nt lds
  s_add_u32 m0, s39, 16384
  v_cvt_pk_bf16_f32 v40, v40, v41
  v_cvt_pk_bf16_f32 v41, v42, v43
  v_accvgpr_write_b32 a84, v40
  v_accvgpr_write_b32 a85, v41
  v_mfma_f32_16x16x16_bf16 v[60:63], v[78:79], a[238:239], 0
  s_nop 0
  buffer_load_dwordx4 v9, s[4:7], s56 offen nt lds
  s_add_u32 m0, s39, 20480
  s_nop 0
  buffer_load_dwordx4 v10, s[4:7], s56 offen nt lds
  v_cvt_pk_bf16_f32 v44, v44, v45
  v_cvt_pk_bf16_f32 v45, v46, v47
  v_accvgpr_write_b32 a86, v44
  v_accvgpr_write_b32 a87, v45
  s_waitcnt lgkmcnt(0)
  v_and_b32 v72, v69, v72
  v_and_b32 v73, v70, v73
  v_and_b32 v74, v69, v74
  v_and_b32 v75, v70, v75
  s_waitcnt vmcnt(18)
  ds_read_b128 v[76:79], v68 offset:576
  v_mfma_f32_16x16x16_bf16 v[16:19], v[72:73], a[192:193], 0
  ds_read_b64_tr_b16 a[216:217], v67 offset:24640
  v_cvt_pk_bf16_f32 v48, v48, v49
  v_cvt_pk_bf16_f32 v49, v50, v51
  v_accvgpr_write_b32 a88, v48
  v_accvgpr_write_b32 a89, v49
  v_mfma_f32_16x16x16_bf16 v[20:23], v[74:75], a[194:195], 0
  ds_read_b64_tr_b16 a[218:219], v67 offset:25408
  v_cvt_pk_bf16_f32 v52, v52, v53
  v_cvt_pk_bf16_f32 v53, v54, v55
  v_accvgpr_write_b32 a90, v52
  v_accvgpr_write_b32 a91, v53
  v_mfma_f32_16x16x16_bf16 v[24:27], v[72:73], a[196:197], 0
  ds_read_b64_tr_b16 a[220:221], v67 offset:24648
  v_cvt_pk_bf16_f32 v56, v56, v57
  v_cvt_pk_bf16_f32 v57, v58, v59
  v_accvgpr_write_b32 a92, v56
  v_accvgpr_write_b32 a93, v57
  v_mfma_f32_16x16x16_bf16 v[28:31], v[74:75], a[198:199], 0
  ds_read_b64_tr_b16 a[222:223], v67 offset:25416
  v_cvt_pk_bf16_f32 v60, v60, v61
  v_cvt_pk_bf16_f32 v61, v62, v63
  v_accvgpr_write_b32 a94, v60
  v_accvgpr_write_b32 a95, v61
  v_mfma_f32_16x16x16_bf16 v[32:35], v[72:73], a[200:201], 0
  ds_read_b64_tr_b16 a[224:225], v67 offset:24704
  v_cvt_pk_bf16_f32 v184, v16, v17
  v_cvt_pk_bf16_f32 v185, v18, v19
  v_mfma_f32_16x16x16_bf16 v[36:39], v[74:75], a[202:203], 0
  ds_read_b64_tr_b16 a[226:227], v67 offset:25472
  v_cvt_pk_bf16_f32 v186, v20, v21
  v_cvt_pk_bf16_f32 v187, v22, v23
  v_mfma_f32_16x16x16_bf16 v[40:43], v[72:73], a[204:205], 0
  ds_read_b64_tr_b16 a[228:229], v67 offset:24712
  v_cvt_pk_bf16_f32 v188, v24, v25
  v_cvt_pk_bf16_f32 v189, v26, v27
  v_mfma_f32_16x16x16_bf16 v[44:47], v[74:75], a[206:207], 0
  ds_read_b64_tr_b16 a[230:231], v67 offset:25480
  v_cvt_pk_bf16_f32 v190, v28, v29
  v_cvt_pk_bf16_f32 v191, v30, v31
  v_mfma_f32_16x16x16_bf16 v[48:51], v[72:73], a[208:209], 0
  ds_read_b64_tr_b16 a[232:233], v67 offset:24768
  v_cvt_pk_bf16_f32 v192, v32, v33
  v_cvt_pk_bf16_f32 v193, v34, v35
  v_mfma_f32_16x16x16_bf16 v[52:55], v[74:75], a[210:211], 0
  ds_read_b64_tr_b16 a[234:235], v67 offset:25536
  v_cvt_pk_bf16_f32 v194, v36, v37
  v_cvt_pk_bf16_f32 v195, v38, v39
  v_mfma_f32_16x16x16_bf16 v[56:59], v[72:73], a[212:213], 0
  ds_read_b64_tr_b16 a[236:237], v67 offset:24776
  v_cvt_pk_bf16_f32 v196, v40, v41
  v_cvt_pk_bf16_f32 v197, v42, v43
  v_mfma_f32_16x16x16_bf16 v[60:63], v[74:75], a[214:215], 0
  ds_read_b64_tr_b16 a[238:239], v67 offset:25544
  v_cvt_pk_bf16_f32 v198, v44, v45
  v_cvt_pk_bf16_f32 v199, v46, v47
  s_waitcnt lgkmcnt(0)
  v_and_b32 v76, v69, v76
  v_and_b32 v77, v70, v77
  v_and_b32 v78, v69, v78
  v_and_b32 v79, v70, v79
  s_waitcnt vmcnt(12)
  ds_read_b128 v[72:75], v68 offset:640
  v_mfma_f32_16x16x16_bf16 v[16:19], v[76:77], a[216:217], 0
  ds_read_b64_tr_b16 a[192:193], v71 offset:0
  ds_read_b64_tr_b16 a[194:195], v71 offset:768
  v_cvt_pk_bf16_f32 v200, v48, v49
  v_cvt_pk_bf16_f32 v201, v50, v51
  v_mfma_f32_16x16x16_bf16 v[20:23], v[78:79], a[218:219], 0
  ds_read_b64_tr_b16 a[196:197], v71 offset:8
  ds_read_b64_tr_b16 a[198:199], v71 offset:776
  v_cvt_pk_bf16_f32 v202, v52, v53
  v_cvt_pk_bf16_f32 v203, v54, v55
  v_mfma_f32_16x16x16_bf16 v[24:27], v[76:77], a[220:221], 0
  ds_read_b64_tr_b16 a[200:201], v71 offset:64
  v_cvt_pk_bf16_f32 v204, v56, v57
  v_cvt_pk_bf16_f32 v205, v58, v59
  v_mfma_f32_16x16x16_bf16 v[28:31], v[78:79], a[222:223], 0
  ds_read_b64_tr_b16 a[202:203], v71 offset:832
  v_cvt_pk_bf16_f32 v206, v60, v61
  v_cvt_pk_bf16_f32 v207, v62, v63
  v_mfma_f32_16x16x16_bf16 v[32:35], v[76:77], a[224:225], 0
  ds_read_b64_tr_b16 a[204:205], v71 offset:72
  v_cvt_pk_bf16_f32 v16, v16, v17
  v_cvt_pk_bf16_f32 v17, v18, v19
  v_accvgpr_write_b32 a96, v16
  v_accvgpr_write_b32 a97, v17
  v_mfma_f32_16x16x16_bf16 v[36:39], v[78:79], a[226:227], 0
  ds_read_b64_tr_b16 a[206:207], v71 offset:840
  v_cvt_pk_bf16_f32 v20, v20, v21
  v_cvt_pk_bf16_f32 v21, v22, v23
  v_accvgpr_write_b32 a98, v20
  v_accvgpr_write_b32 a99, v21
  v_mfma_f32_16x16x16_bf16 v[40:43], v[76:77], a[228:229], 0
  ds_read_b64_tr_b16 a[208:209], v71 offset:128
  v_cvt_pk_bf16_f32 v24, v24, v25
  v_cvt_pk_bf16_f32 v25, v26, v27
  v_accvgpr_write_b32 a100, v24
  v_accvgpr_write_b32 a101, v25
  v_mfma_f32_16x16x16_bf16 v[44:47], v[78:79], a[230:231], 0
  ds_read_b64_tr_b16 a[210:211], v71 offset:896
  v_cvt_pk_bf16_f32 v28, v28, v29
  v_cvt_pk_bf16_f32 v29, v30, v31
  v_accvgpr_write_b32 a102, v28
  v_accvgpr_write_b32 a103, v29
  v_mfma_f32_16x16x16_bf16 v[48:51], v[76:77], a[232:233], 0
  ds_read_b64_tr_b16 a[212:213], v71 offset:136
  v_cvt_pk_bf16_f32 v32, v32, v33
  v_cvt_pk_bf16_f32 v33, v34, v35
  v_accvgpr_write_b32 a104, v32
  v_accvgpr_write_b32 a105, v33
  v_mfma_f32_16x16x16_bf16 v[52:55], v[78:79], a[234:235], 0
  ds_read_b64_tr_b16 a[214:215], v71 offset:904
  v_cvt_pk_bf16_f32 v36, v36, v37
  v_cvt_pk_bf16_f32 v37, v38, v39
  v_accvgpr_write_b32 a106, v36
  v_accvgpr_write_b32 a107, v37
  v_mfma_f32_16x16x16_bf16 v[56:59], v[76:77], a[236:237], 0
  s_and_b32 s95, s36, -16
  v_cvt_pk_bf16_f32 v40, v40, v41
  v_cvt_pk_bf16_f32 v41, v42, v43
  v_accvgpr_write_b32 a108, v40
  v_accvgpr_write_b32 a109, v41
  v_mfma_f32_16x16x16_bf16 v[60:63], v[78:79], a[238:239], 0
  s_load_dwordx4 s[84:87], s[92:93], s95
  v_cvt_pk_bf16_f32 v44, v44, v45
  v_cvt_pk_bf16_f32 v45, v46, v47
  v_accvgpr_write_b32 a110, v44
  v_accvgpr_write_b32 a111, v45
  s_waitcnt lgkmcnt(0)
  v_and_b32 v72, v69, v72
  v_and_b32 v73, v70, v73
  v_and_b32 v74, v69, v74
  v_and_b32 v75, v70, v75
  s_min_u32 s51, s84, s86
  s_min_u32 s52, s85, s87
  s_min_u32 s88, s51, s52
  s_cmp_eq_u32 s88, 0
  s_cbranch_scc1 L_slow
L_back:
  s_bitcmp1_b32 s2, 1
  s_cselect_b64 s[88:89], s[86:87], s[84:85]
  s_bitcmp1_b32 s2, 0
  s_cselect_b32 s88, s89, s88
  s_lshr_b32 s34, s2, 1
  s_xor_b32 s34, s88, s34
  s_and_b32 s34, s34, 2
  s_lshl_b32 s34, s34, 20
  s_cmp_gt_u32 s51, s52
  s_cselect_b32 s51, 1, 0
  s_lshr_b32 s52, s84, 2
  s_xor_b32 s51, s51, s52
  s_xor_b32 s51, s51, s2
  s_and_b32 s51, s51, 1
  s_lshl_b32 s51, s51, 19
  s_or_b32 s34, s34, s51
  s_waitcnt vmcnt(6)
  ds_read_b128 v[76:79], v68 offset:704
  v_mfma_f32_16x16x16_bf16 v[16:19], v[72:73], a[192:193], 0
  ds_read_b64_tr_b16 a[216:217], v71 offset:24640
  v_cvt_pk_bf16_f32 v48, v48, v49
  v_cvt_pk_bf16_f32 v49, v50, v51
  v_accvgpr_write_b32 a112, v48
  v_accvgpr_write_b32 a113, v49
  v_mfma_f32_16x16x16_bf16 v[20:23], v[74:75], a[194:195], 0
  ds_read_b64_tr_b16 a[218:219], v71 offset:25408
  v_cvt_pk_bf16_f32 v52, v52, v53
  v_cvt_pk_bf16_f32 v53, v54, v55
  v_accvgpr_write_b32 a114, v52
  v_accvgpr_write_b32 a115, v53
  v_mfma_f32_16x16x16_bf16 v[24:27], v[72:73], a[196:197], 0
  ds_read_b64_tr_b16 a[220:221], v71 offset:24648
  v_cvt_pk_bf16_f32 v56, v56, v57
  v_cvt_pk_bf16_f32 v57, v58, v59
  v_accvgpr_write_b32 a116, v56
  v_accvgpr_write_b32 a117, v57
  v_mfma_f32_16x16x16_bf16 v[28:31], v[74:75], a[198:199], 0
  ds_read_b64_tr_b16 a[222:223], v71 offset:25416
  v_cvt_pk_bf16_f32 v60, v60, v61
  v_cvt_pk_bf16_f32 v61, v62, v63
  v_accvgpr_write_b32 a118, v60
  v_accvgpr_write_b32 a119, v61
  v_mfma_f32_16x16x16_bf16 v[32:35], v[72:73], a[200:201], 0
  ds_read_b64_tr_b16 a[224:225], v71 offset:24704
  v_cvt_pk_bf16_f32 v208, v16, v17
  v_cvt_pk_bf16_f32 v209, v18, v19
  v_mfma_f32_16x16x16_bf16 v[36:39], v[74:75], a[202:203], 0
  ds_read_b64_tr_b16 a[226:227], v71 offset:25472
  v_cvt_pk_bf16_f32 v210, v20, v21
  v_cvt_pk_bf16_f32 v211, v22, v23
  v_mfma_f32_16x16x16_bf16 v[40:43], v[72:73], a[204:205], 0
  ds_read_b64_tr_b16 a[228:229], v71 offset:24712
  v_cvt_pk_bf16_f32 v212, v24, v25
  v_cvt_pk_bf16_f32 v213, v26, v27
  v_mfma_f32_16x16x16_bf16 v[44:47], v[74:75], a[206:207], 0
  ds_read_b64_tr_b16 a[230:231], v71 offset:25480
  v_cvt_pk_bf16_f32 v214, v28, v29
  v_cvt_pk_bf16_f32 v215, v30, v31
  v_mfma_f32_16x16x16_bf16 v[48:51], v[72:73], a[208:209], 0
  ds_read_b64_tr_b16 a[232:233], v71 offset:24768
  v_cvt_pk_bf16_f32 v216, v32, v33
  v_cvt_pk_bf16_f32 v217, v34, v35
  v_mfma_f32_16x16x16_bf16 v[52:55], v[74:75], a[210:211], 0
  ds_read_b64_tr_b16 a[234:235], v71 offset:25536
  v_cvt_pk_bf16_f32 v218, v36, v37
  v_cvt_pk_bf16_f32 v219, v38, v39
  v_mfma_f32_16x16x16_bf16 v[56:59], v[72:73], a[212:213], 0
  ds_read_b64_tr_b16 a[236:237], v71 offset:24776
  v_cvt_pk_bf16_f32 v220, v40, v41
  v_cvt_pk_bf16_f32 v221, v42, v43
  v_mfma_f32_16x16x16_bf16 v[60:63], v[74:75], a[214:215], 0
  ds_read_b64_tr_b16 a[238:239], v71 offset:25544
  v_cvt_pk_bf16_f32 v222, v44, v45
  v_cvt_pk_bf16_f32 v223, v46, v47
  s_waitcnt lgkmcnt(0)
  v_and_b32 v76, v69, v76
  v_and_b32 v77, v70, v77
  v_and_b32 v78, v69, v78
  v_and_b32 v79, v70, v79
  s_mov_b64 s[82:83], s[80:81]
  s_mov_b64 s[80:81], s[78:79]
  v_mfma_f32_16x16x16_bf16 v[16:19], v[76:77], a[216:217], 0
  s_mov_b64 s[78:79], s[76:77]
  s_add_u32 s76, s33, s32
  s_xor_b32 s76, s76, s34
  s_bfe_u32 s77, s76, 65557
  v_cvt_pk_bf16_f32 v224, v48, v49
  v_cvt_pk_bf16_f32 v225, v50, v51
  v_mfma_f32_16x16x16_bf16 v[20:23], v[78:79], a[218:219], 0
  s_bfe_u32 s76, s76, 65555
  s_lshl1_add_u32 s77, s76, s77
  s_sub_u32 s77, 1, s77
  s_and_b32 s77, s77, 3
  v_cvt_pk_bf16_f32 v226, v52, v53
  v_cvt_pk_bf16_f32 v227, v54, v55
  v_mfma_f32_16x16x16_bf16 v[24:27], v[76:77], a[220:221], 0
  s_mul_i32 s77, s77, 24576
  s_cmp_lt_u32 s32, s35
  s_cselect_b32 s76, s32, s40
  s_add_u32 s32, s32, 786432
  v_cvt_pk_bf16_f32 v228, v56, v57
  v_cvt_pk_bf16_f32 v229, v58, v59
  v_mfma_f32_16x16x16_bf16 v[28:31], v[78:79], a[222:223], 0
  s_cmp_eq_u32 s77, 0
  s_cselect_b32 s57, 73728, s26
  s_add_u32 s22, s76, s77
  s_add_u32 s22, s22, s57
  v_cvt_pk_bf16_f32 v230, v60, v61
  v_cvt_pk_bf16_f32 v231, v62, v63
  v_mfma_f32_16x16x16_bf16 v[32:35], v[76:77], a[224:225], 0
  s_min_u32 s22, s22, s40
  s_add_u32 m0, s39, 24576
  s_nop 0
  buffer_load_dwordx4 v8, s[4:7], s22 offen nt lds
  v_cvt_pk_bf16_f32 v232, v16, v17
  v_cvt_pk_bf16_f32 v233, v18, v19
  v_mfma_f32_16x16x16_bf16 v[36:39], v[78:79], a[226:227], 0
  s_add_u32 m0, s39, 28672
  s_nop 0
  buffer_load_dwordx4 v9, s[4:7], s22 offen nt lds
  v_and_b32 v15, s57, v11
  v_cvt_pk_bf16_f32 v234, v20, v21
  v_cvt_pk_bf16_f32 v235, v22, v23
  v_mfma_f32_16x16x16_bf16 v[40:43], v[76:77], a[228:229], 0
  v_add3_u32 v15, v10, v15, s77
  s_add_u32 m0, s39, 32768
  s_nop 0
  buffer_load_dwordx4 v15, s[4:7], s76 offen nt lds
  v_cvt_pk_bf16_f32 v236, v24, v25
  v_cvt_pk_bf16_f32 v237, v26, v27
  v_mfma_f32_16x16x16_bf16 v[44:47], v[78:79], a[230:231], 0
  s_cmp_eq_u32 s77, 73728
  s_cselect_b32 s57, 4294893568, s27
  s_add_u32 s90, s77, 12288
  s_add_u32 s56, s76, s90
  v_cvt_pk_bf16_f32 v238, v28, v29
  v_cvt_pk_bf16_f32 v239, v30, v31
  v_mfma_f32_16x16x16_bf16 v[48:51], v[76:77], a[232:233], 0
  s_add_u32 s56, s56, s57
  s_min_u32 s56, s56, s40
  v_and_b32 v15, s57, v12
  v_add3_u32 v15, v8, v15, s90
  v_cvt_pk_bf16_f32 v240, v32, v33
  v_cvt_pk_bf16_f32 v241, v34, v35
  v_mfma_f32_16x16x16_bf16 v[52:55], v[78:79], a[234:235], 0
  s_add_u32 m0, s39, 36864
  s_nop 0
  buffer_load_dwordx4 v15, s[4:7], s76 offen nt lds
  v_cvt_pk_bf16_f32 v242, v36, v37
  v_cvt_pk_bf16_f32 v243, v38, v39
  v_mfma_f32_16x16x16_bf16 v[56:59], v[76:77], a[236:237], 0
  s_add_u32 m0, s39, 40960
  s_nop 0
  buffer_load_dwordx4 v9, s[4:7], s56 offen nt lds
  v_cvt_pk_bf16_f32 v244, v40, v41
  v_cvt_pk_bf16_f32 v245, v42, v43
  v_mfma_f32_16x16x16_bf16 v[60:63], v[78:79], a[238:239], 0
  s_add_u32 m0, s39, 45056
  s_xor_b32 s39, s39, 49152
  buffer_load_dwordx4 v10, s[4:7], s56 offen nt lds
  v_cvt_pk_bf16_f32 v246, v44, v45
  v_cvt_pk_bf16_f32 v247, v46, v47
  v_cvt_pk_bf16_f32 v248, v48, v49
  v_cvt_pk_bf16_f32 v249, v50, v51
  v_cvt_pk_bf16_f32 v250, v52, v53
  v_cvt_pk_bf16_f32 v251, v54, v55
  v_mov_b32 v13, 0
  v_mov_b32 v14, 0
  s_mov_b32 s58, s40
  s_mov_b32 s59, s40
  s_mov_b32 s62, s40
  s_mov_b32 s63, s40
  s_waitcnt vmcnt(6)
  s_barrier
  ds_read_b128 a[144:147], v1 offset:0
  ds_read_b128 a[148:151], v2 offset:0
  ds_read_b128 a[152:155], v3 offset:0
  ds_read_b128 a[156:159], v4 offset:0
  v_cvt_pk_bf16_f32 v252, v56, v57
  v_cvt_pk_bf16_f32 v253, v58, v59
  v_cvt_pk_bf16_f32 v254, v60, v61
  v_cvt_pk_bf16_f32 v255, v62, v63
L_loop:
  s_waitcnt lgkmcnt(2)
  v_mfma_f32_16x16x32_bf16 v[16:19], v[88:91], a[144:147], 0
  ds_read_b128 a[160:163], v1 offset:256
  v_mfma_f32_16x16x32_bf16 v[16:19], a[0:3], a[148:151], v[16:19]
  ds_read_b128 a[164:167], v2 offset:256
  v_mfma_f32_16x16x32_bf16 v[20:23], v[92:95], a[144:147], 0
  v_mfma_f32_16x16x32_bf16 v[20:23], a[4:7], a[148:151], v[20:23]
  v_cvt_pk_bf16_f32 v40, v40, v41
  v_mfma_f32_16x16x32_bf16 v[24:27], v[96:99], a[144:147], 0
  v_cvt_pk_bf16_f32 v41, v42, v43
  v_mfma_f32_16x16x32_bf16 v[24:27], a[8:11], a[148:151], v[24:27]
  v_cvt_pk_bf16_f32 v42, v44, v45
  v_mfma_f32_16x16x32_bf16 v[28:31], v[100:103], a[144:147], 0
  buffer_store_dwordx4 a[188:191], v82, s[8:11], s63 offen sc1
  v_mfma_f32_16x16x32_bf16 v[28:31], a[12:15], a[148:151], v[28:31]
  v_cvt_pk_bf16_f32 v43, v46, v47
  v_mfma_f32_16x16x32_bf16 v[32:35], v[104:107], a[144:147], 0
  ds_write_b128 v86, v[40:43] offset:12288
  v_mfma_f32_16x16x32_bf16 v[32:35], a[16:19], a[148:151], v[32:35]
  v_mfma_f32_16x16x32_bf16 v[36:39], v[108:111], a[144:147], 0
  v_mfma_f32_16x16x32_bf16 v[36:39], a[20:23], a[148:151], v[36:39]
  s_waitcnt lgkmcnt(3)
  v_mfma_f32_16x16x32_bf16 v[16:19], v[112:115], a[152:155], v[16:19]
  ds_read_b128 a[144:147], v3 offset:256
  v_mfma_f32_16x16x32_bf16 v[16:19], a[24:27], a[156:159], v[16:19]
  ds_read_b128 a[148:151], v4 offset:256
  v_mfma_f32_16x16x32_bf16 v[20:23], v[116:119], a[152:155], v[20:23]
  v_mfma_f32_16x16x32_bf16 v[20:23], a[28:31], a[156:159], v[20:23]
  v_cvt_pk_bf16_f32 v48, v48, v49
  v_mfma_f32_16x16x32_bf16 v[24:27], v[120:123], a[152:155], v[24:27]
  buffer_store_dwordx4 a[168:171], v80, s[8:11], s58 offen sc1
  v_mfma_f32_16x16x32_bf16 v[24:27], a[32:35], a[156:159], v[24:27]
  v_cvt_pk_bf16_f32 v49, v50, v51
  v_mfma_f32_16x16x32_bf16 v[28:31], v[124:127], a[152:155], v[28:31]
  v_cvt_pk_bf16_f32 v50, v52, v53
  v_mfma_f32_16x16x32_bf16 v[28:31], a[36:39], a[156:159], v[28:31]
  v_cvt_pk_bf16_f32 v51, v54, v55
  v_mfma_f32_16x16x32_bf16 v[32:35], v[128:131], a[152:155], v[32:35]
  ds_write_b128 v87, v[48:51] offset:12288
  v_mfma_f32_16x16x32_bf16 v[32:35], a[40:43], a[156:159], v[32:35]
  v_mfma_f32_16x16x32_bf16 v[36:39], v[132:135], a[152:155], v[36:39]
  v_mfma_f32_16x16x32_bf16 v[36:39], a[44:47], a[156:159], v[36:39]
  s_waitcnt lgkmcnt(4)
  v_mfma_f32_16x16x32_bf16 v[16:19], v[136:139], a[160:163], v[16:19]
  ds_read_b128 a[152:155], v1 offset:512
  v_mfma_f32_16x16x32_bf16 v[16:19], a[48:51], a[164:167], v[16:19]
  ds_read_b128 a[156:159], v2 offset:512
  v_mfma_f32_16x16x32_bf16 v[20:23], v[140:143], a[160:163], v[20:23]
  v_mfma_f32_16x16x32_bf16 v[20:23], a[52:55], a[164:167], v[20:23]
  v_mfma_f32_16x16x32_bf16 v[24:27], v[144:147], a[160:163], v[24:27]
  buffer_store_dwordx4 a[172:175], v81, s[8:11], s58 offen sc1
  v_mfma_f32_16x16x32_bf16 v[24:27], a[56:59], a[164:167], v[24:27]
  v_mfma_f32_16x16x32_bf16 v[28:31], v[148:151], a[160:163], v[28:31]
  v_mfma_f32_16x16x32_bf16 v[28:31], a[60:63], a[164:167], v[28:31]
  v_mfma_f32_16x16x32_bf16 v[32:35], v[152:155], a[160:163], v[32:35]
  v_mfma_f32_16x16x32_bf16 v[32:35], a[64:67], a[164:167], v[32:35]
  v_mfma_f32_16x16x32_bf16 v[36:39], v[156:159], a[160:163], v[36:39]
  v_mfma_f32_16x16x32_bf16 v[36:39], a[68:71], a[164:167], v[36:39]
  s_mov_b64 s[82:83], s[80:81]
  s_waitcnt lgkmcnt(3)
  v_mfma_f32_16x16x32_bf16 v[16:19], v[160:163], a[144:147], v[16:19]
  ds_read_b128 a[160:163], v3 offset:512
  s_mov_b64 s[80:81], s[78:79]
  v_mfma_f32_16x16x32_bf16 v[16:19], a[72:75], a[148:151], v[16:19]
  ds_read_b128 a[164:167], v4 offset:512
  s_mov_b64 s[78:79], s[76:77]
  v_mfma_f32_16x16x32_bf16 v[20:23], v[164:167], a[144:147], v[20:23]
  s_add_u32 s76, s33, s32
  v_cvt_pk_bf16_f32 v56, v56, v57
  v_mfma_f32_16x16x32_bf16 v[20:23], a[76:79], a[148:151], v[20:23]
  s_xor_b32 s76, s76, s34
  v_cvt_pk_bf16_f32 v57, v58, v59
  v_mfma_f32_16x16x32_bf16 v[24:27], v[168:171], a[144:147], v[24:27]
  buffer_store_dwordx4 a[176:179], v13, s[8:11], s59 offen sc1
  v_mfma_f32_16x16x32_bf16 v[24:27], a[80:83], a[148:151], v[24:27]
  s_bfe_u32 s77, s76, 65557
  v_cvt_pk_bf16_f32 v58, v60, v61
  v_mfma_f32_16x16x32_bf16 v[28:31], v[172:175], a[144:147], v[28:31]
  s_bfe_u32 s76, s76, 65555
  v_cvt_pk_bf16_f32 v59, v62, v63
  v_mfma_f32_16x16x32_bf16 v[28:31], a[84:87], a[148:151], v[28:31]
  ds_write_b128 v86, v[56:59] offset:12416
  v_mfma_f32_16x16x32_bf16 v[32:35], v[176:179], a[144:147], v[32:35]
  s_lshl1_add_u32 s77, s76, s77
  s_sub_u32 s77, 1, s77
  v_mfma_f32_16x16x32_bf16 v[32:35], a[88:91], a[148:151], v[32:35]
  s_and_b32 s77, s77, 3
  s_mul_i32 s77, s77, 24576
  v_mfma_f32_16x16x32_bf16 v[36:39], v[180:183], a[144:147], v[36:39]
  s_cmp_lt_u32 s32, s35
  s_cselect_b32 s76, s32, s40
  v_mfma_f32_16x16x32_bf16 v[36:39], a[92:95], a[148:151], v[36:39]
  s_add_u32 s32, s32, 786432
  s_waitcnt lgkmcnt(3)
  v_mfma_f32_16x16x32_bf16 v[16:19], v[184:187], a[152:155], v[16:19]
  ds_read_b128 a[144:147], v1 offset:12288
  s_cmp_eq_u32 s77, 0
  v_mfma_f32_16x16x32_bf16 v[16:19], a[96:99], a[156:159], v[16:19]
  ds_read_b128 a[148:151], v2 offset:12288
  s_cselect_b32 s57, 73728, s26
  v_mfma_f32_16x16x32_bf16 v[20:23], v[188:191], a[152:155], v[20:23]
  s_add_u32 s22, s76, s77
  s_add_u32 s22, s22, s57
  v_mfma_f32_16x16x32_bf16 v[20:23], a[100:103], a[156:159], v[20:23]
  s_min_u32 s22, s22, s40
  s_add_u32 m0, s39, 0
  v_mfma_f32_16x16x32_bf16 v[24:27], v[192:195], a[152:155], v[24:27]
  buffer_load_dwordx4 v8, s[4:7], s22 offen nt lds
  v_mfma_f32_16x16x32_bf16 v[24:27], a[104:107], a[156:159], v[24:27]
  s_cmp_eq_u32 s81, 0
  s_cselect_b32 s91, 73728, s26
  v_mfma_f32_16x16x32_bf16 v[28:31], v[196:199], a[152:155], v[28:31]
  s_add_u32 s58, s80, s81
  s_add_u32 s58, s58, s91
  v_mfma_f32_16x16x32_bf16 v[28:31], a[108:111], a[156:159], v[28:31]
  s_min_u32 s58, s58, s40
  s_mov_b32 s59, s80
  v_mfma_f32_16x16x32_bf16 v[32:35], v[200:203], a[152:155], v[32:35]
  v_and_b32 v13, s91, v11
  v_add3_u32 v13, v82, v13, s81
  v_mfma_f32_16x16x32_bf16 v[32:35], a[112:115], a[156:159], v[32:35]
  s_cmp_eq_u32 s83, 73728
  s_cselect_b32 s91, 4294893568, s27
  v_mfma_f32_16x16x32_bf16 v[36:39], v[204:207], a[152:155], v[36:39]
  s_add_u32 s62, s83, 12288
  s_add_u32 s63, s82, s62
  v_mfma_f32_16x16x32_bf16 v[36:39], a[116:119], a[156:159], v[36:39]
  s_add_u32 s63, s63, s91
  s_waitcnt lgkmcnt(3)
  v_mfma_f32_16x16x32_bf16 v[16:19], v[208:211], a[160:163], v[16:19]
  ds_read_b128 a[152:155], v3 offset:12288
  s_min_u32 s63, s63, s40
  v_mfma_f32_16x16x32_bf16 v[16:19], v[232:235], a[164:167], v[16:19]
  ds_read_b128 a[156:159], v4 offset:12288
  v_and_b32 v14, s91, v12
  v_mfma_f32_16x16x32_bf16 v[20:23], v[212:215], a[160:163], v[20:23]
  v_add3_u32 v14, v80, v14, s62
  s_mov_b32 s62, s82
  v_mfma_f32_16x16x32_bf16 v[20:23], v[236:239], a[164:167], v[20:23]
  s_add_u32 m0, s39, 4096
  v_mfma_f32_16x16x32_bf16 v[24:27], v[216:219], a[160:163], v[24:27]
  buffer_load_dwordx4 v9, s[4:7], s22 offen nt lds
  v_mfma_f32_16x16x32_bf16 v[24:27], v[240:243], a[164:167], v[24:27]
  v_mfma_f32_16x16x32_bf16 v[28:31], v[220:223], a[160:163], v[28:31]
  v_mfma_f32_16x16x32_bf16 v[28:31], v[244:247], a[164:167], v[28:31]
  v_mfma_f32_16x16x32_bf16 v[32:35], v[224:227], a[160:163], v[32:35]
  v_mfma_f32_16x16x32_bf16 v[32:35], v[248:251], a[164:167], v[32:35]
  v_and_b32 v15, s57, v11
  v_mfma_f32_16x16x32_bf16 v[36:39], v[228:231], a[160:163], v[36:39]
  v_add3_u32 v15, v10, v15, s77
  v_mfma_f32_16x16x32_bf16 v[36:39], v[252:255], a[164:167], v[36:39]
  s_waitcnt lgkmcnt(2)
  v_mfma_f32_16x16x32_bf16 v[40:43], v[88:91], a[144:147], 0
  ds_read_b128 a[160:163], v1 offset:12544
  v_mfma_f32_16x16x32_bf16 v[40:43], a[0:3], a[148:151], v[40:43]
  ds_read_b128 a[164:167], v2 offset:12544
  v_mfma_f32_16x16x32_bf16 v[44:47], v[92:95], a[144:147], 0
  s_add_u32 m0, s39, 8192
  v_mfma_f32_16x16x32_bf16 v[44:47], a[4:7], a[148:151], v[44:47]
  v_cvt_pk_bf16_f32 v16, v16, v17
  v_mfma_f32_16x16x32_bf16 v[48:51], v[96:99], a[144:147], 0
  buffer_load_dwordx4 v15, s[4:7], s76 offen nt lds
  v_mfma_f32_16x16x32_bf16 v[48:51], a[8:11], a[148:151], v[48:51]
  v_cvt_pk_bf16_f32 v17, v18, v19
  v_mfma_f32_16x16x32_bf16 v[52:55], v[100:103], a[144:147], 0
  v_cvt_pk_bf16_f32 v18, v20, v21
  v_mfma_f32_16x16x32_bf16 v[52:55], a[12:15], a[148:151], v[52:55]
  s_cmp_eq_u32 s77, 73728
  v_cvt_pk_bf16_f32 v19, v22, v23
  v_mfma_f32_16x16x32_bf16 v[56:59], v[104:107], a[144:147], 0
  ds_write_b128 v86, v[16:19] offset:0
  v_mfma_f32_16x16x32_bf16 v[56:59], a[16:19], a[148:151], v[56:59]
  s_cselect_b32 s57, 4294893568, s27
  s_add_u32 s90, s77, 12288
  v_mfma_f32_16x16x32_bf16 v[60:63], v[108:111], a[144:147], 0
  s_add_u32 s56, s76, s90
  v_cvt_pk_bf16_f32 v24, v24, v25
  v_mfma_f32_16x16x32_bf16 v[60:63], a[20:23], a[148:151], v[60:63]
  s_add_u32 s56, s56, s57
  s_waitcnt lgkmcnt(3)
  v_mfma_f32_16x16x32_bf16 v[40:43], v[112:115], a[152:155], v[40:43]
  ds_read_b128 a[144:147], v3 offset:12544
  s_min_u32 s56, s56, s40
  v_mfma_f32_16x16x32_bf16 v[40:43], a[24:27], a[156:159], v[40:43]
  ds_read_b128 a[148:151], v4 offset:12544
  v_and_b32 v15, s57, v12
  v_mfma_f32_16x16x32_bf16 v[44:47], v[116:119], a[152:155], v[44:47]
  v_add3_u32 v15, v8, v15, s90
  v_cvt_pk_bf16_f32 v25, v26, v27
  v_mfma_f32_16x16x32_bf16 v[44:47], a[28:31], a[156:159], v[44:47]
  s_add_u32 m0, s39, 12288
  v_cvt_pk_bf16_f32 v26, v28, v29
  v_mfma_f32_16x16x32_bf16 v[48:51], v[120:123], a[152:155], v[48:51]
  buffer_load_dwordx4 v15, s[4:7], s76 offen nt lds
  v_mfma_f32_16x16x32_bf16 v[48:51], a[32:35], a[156:159], v[48:51]
  v_cvt_pk_bf16_f32 v27, v30, v31
  v_mfma_f32_16x16x32_bf16 v[52:55], v[124:127], a[152:155], v[52:55]
  ds_write_b128 v87, v[24:27] offset:0
  v_mfma_f32_16x16x32_bf16 v[52:55], a[36:39], a[156:159], v[52:55]
  v_mfma_f32_16x16x32_bf16 v[56:59], v[128:131], a[152:155], v[56:59]
  v_mfma_f32_16x16x32_bf16 v[56:59], a[40:43], a[156:159], v[56:59]
  v_mfma_f32_16x16x32_bf16 v[60:63], v[132:135], a[152:155], v[60:63]
  v_mfma_f32_16x16x32_bf16 v[60:63], a[44:47], a[156:159], v[60:63]
  s_waitcnt lgkmcnt(4)
  v_mfma_f32_16x16x32_bf16 v[40:43], v[136:139], a[160:163], v[40:43]
  ds_read_b128 a[152:155], v1 offset:12800
  v_mfma_f32_16x16x32_bf16 v[40:43], a[48:51], a[164:167], v[40:43]
  ds_read_b128 a[156:159], v2 offset:12800
  v_mfma_f32_16x16x32_bf16 v[44:47], v[140:143], a[160:163], v[44:47]
  s_add_u32 m0, s39, 16384
  v_mfma_f32_16x16x32_bf16 v[44:47], a[52:55], a[164:167], v[44:47]
  v_cvt_pk_bf16_f32 v32, v32, v33
  v_mfma_f32_16x16x32_bf16 v[48:51], v[144:147], a[160:163], v[48:51]
  buffer_load_dwordx4 v9, s[4:7], s56 offen nt lds
  v_mfma_f32_16x16x32_bf16 v[48:51], a[56:59], a[164:167], v[48:51]
  v_cvt_pk_bf16_f32 v33, v34, v35
  v_mfma_f32_16x16x32_bf16 v[52:55], v[148:151], a[160:163], v[52:55]
  v_cvt_pk_bf16_f32 v34, v36, v37
  v_mfma_f32_16x16x32_bf16 v[52:55], a[60:63], a[164:167], v[52:55]
  v_cvt_pk_bf16_f32 v35, v38, v39
  v_mfma_f32_16x16x32_bf16 v[56:59], v[152:155], a[160:163], v[56:59]
  ds_write_b128 v86, v[32:35] offset:128
  v_mfma_f32_16x16x32_bf16 v[56:59], a[64:67], a[164:167], v[56:59]
  v_mfma_f32_16x16x32_bf16 v[60:63], v[156:159], a[160:163], v[60:63]
  v_mfma_f32_16x16x32_bf16 v[60:63], a[68:71], a[164:167], v[60:63]
  s_waitcnt lgkmcnt(4)
  v_mfma_f32_16x16x32_bf16 v[40:43], v[160:163], a[144:147], v[40:43]
  ds_read_b128 a[160:163], v3 offset:12800
  v_mfma_f32_16x16x32_bf16 v[40:43], a[72:75], a[148:151], v[40:43]
  ds_read_b128 a[164:167], v4 offset:12800
  v_mfma_f32_16x16x32_bf16 v[44:47], v[164:167], a[144:147], v[44:47]
  v_mfma_f32_16x16x32_bf16 v[44:47], a[76:79], a[148:151], v[44:47]
  s_add_u32 m0, s39, 20480
  v_mfma_f32_16x16x32_bf16 v[48:51], v[168:171], a[144:147], v[48:51]
  buffer_load_dwordx4 v10, s[4:7], s56 offen nt lds
  v_mfma_f32_16x16x32_bf16 v[48:51], a[80:83], a[148:151], v[48:51]
  v_mfma_f32_16x16x32_bf16 v[52:55], v[172:175], a[144:147], v[52:55]
  v_mfma_f32_16x16x32_bf16 v[52:55], a[84:87], a[148:151], v[52:55]
  v_mfma_f32_16x16x32_bf16 v[56:59], v[176:179], a[144:147], v[56:59]
  v_mfma_f32_16x16x32_bf16 v[56:59], a[88:91], a[148:151], v[56:59]
  v_mfma_f32_16x16x32_bf16 v[60:63], v[180:183], a[144:147], v[60:63]
  v_mfma_f32_16x16x32_bf16 v[60:63], a[92:95], a[148:151], v[60:63]
  s_waitcnt vmcnt(10) lgkmcnt(2)
L_ent:
  s_barrier
  s_waitcnt lgkmcnt(3)
  v_mfma_f32_16x16x32_bf16 v[40:43], v[184:187], a[152:155], v[40:43]
  ds_read_b128 a[144:147], v1 offset:24576
  v_mfma_f32_16x16x32_bf16 v[40:43], a[96:99], a[156:159], v[40:43]
  ds_read_b128 a[148:151], v2 offset:24576
  v_mfma_f32_16x16x32_bf16 v[44:47], v[188:191], a[152:155], v[44:47]
  ds_read_b128 a[180:183], v5 offset:12288
  v_mfma_f32_16x16x32_bf16 v[44:47], a[100:103], a[156:159], v[44:47]
  ds_read_b128 a[184:187], v6 offset:12288
  v_mfma_f32_16x16x32_bf16 v[48:51], v[192:195], a[152:155], v[48:51]
  ds_read_b128 a[188:191], v7 offset:12288
  v_mfma_f32_16x16x32_bf16 v[48:51], a[104:107], a[156:159], v[48:51]
  ds_read_b128 a[168:171], v5 offset:0
  v_mfma_f32_16x16x32_bf16 v[52:55], v[196:199], a[152:155], v[52:55]
  ds_read_b128 a[172:175], v6 offset:0
  v_mfma_f32_16x16x32_bf16 v[52:55], a[108:111], a[156:159], v[52:55]
  ds_read_b128 a[176:179], v7 offset:0
  v_mfma_f32_16x16x32_bf16 v[56:59], v[200:203], a[152:155], v[56:59]
  v_mfma_f32_16x16x32_bf16 v[56:59], a[112:115], a[156:159], v[56:59]
  v_mfma_f32_16x16x32_bf16 v[60:63], v[204:207], a[152:155], v[60:63]
  v_mfma_f32_16x16x32_bf16 v[60:63], a[116:119], a[156:159], v[60:63]
  s_waitcnt lgkmcnt(8)
  v_mfma_f32_16x16x32_bf16 v[40:43], v[208:211], a[160:163], v[40:43]
  ds_read_b128 a[152:155], v3 offset:24576
  v_mfma_f32_16x16x32_bf16 v[40:43], v[232:235], a[164:167], v[40:43]
  ds_read_b128 a[156:159], v4 offset:24576
  v_mfma_f32_16x16x32_bf16 v[44:47], v[212:215], a[160:163], v[44:47]
  s_waitcnt lgkmcnt(7)
  buffer_store_dwordx4 a[180:183], v14, s[8:11], s62 offen sc1
  v_mfma_f32_16x16x32_bf16 v[44:47], v[236:239], a[164:167], v[44:47]
  v_mfma_f32_16x16x32_bf16 v[48:51], v[216:219], a[160:163], v[48:51]
  v_mfma_f32_16x16x32_bf16 v[48:51], v[240:243], a[164:167], v[48:51]
  v_mfma_f32_16x16x32_bf16 v[52:55], v[220:223], a[160:163], v[52:55]
  v_mfma_f32_16x16x32_bf16 v[52:55], v[244:247], a[164:167], v[52:55]
  v_mfma_f32_16x16x32_bf16 v[56:59], v[224:227], a[160:163], v[56:59]
  s_waitcnt lgkmcnt(6)
  buffer_store_dwordx4 a[184:187], v81, s[8:11], s63 offen sc1
  v_mfma_f32_16x16x32_bf16 v[56:59], v[248:251], a[164:167], v[56:59]
  v_mfma_f32_16x16x32_bf16 v[60:63], v[228:231], a[160:163], v[60:63]
  v_mfma_f32_16x16x32_bf16 v[60:63], v[252:255], a[164:167], v[60:63]
  s_waitcnt lgkmcnt(8)
  v_mfma_f32_16x16x32_bf16 v[16:19], v[88:91], a[144:147], 0
  ds_read_b128 a[160:163], v1 offset:24832
  v_mfma_f32_16x16x32_bf16 v[16:19], a[0:3], a[148:151], v[16:19]
  ds_read_b128 a[164:167], v2 offset:24832
  v_mfma_f32_16x16x32_bf16 v[20:23], v[92:95], a[144:147], 0
  v_mfma_f32_16x16x32_bf16 v[20:23], a[4:7], a[148:151], v[20:23]
  v_cvt_pk_bf16_f32 v40, v40, v41
  v_mfma_f32_16x16x32_bf16 v[24:27], v[96:99], a[144:147], 0
  v_cvt_pk_bf16_f32 v41, v42, v43
  v_mfma_f32_16x16x32_bf16 v[24:27], a[8:11], a[148:151], v[24:27]
  v_cvt_pk_bf16_f32 v42, v44, v45
  v_mfma_f32_16x16x32_bf16 v[28:31], v[100:103], a[144:147], 0
  s_waitcnt lgkmcnt(7)
  buffer_store_dwordx4 a[188:191], v82, s[8:11], s63 offen sc1
  v_mfma_f32_16x16x32_bf16 v[28:31], a[12:15], a[148:151], v[28:31]
  v_cvt_pk_bf16_f32 v43, v46, v47
  v_mfma_f32_16x16x32_bf16 v[32:35], v[104:107], a[144:147], 0
  ds_write_b128 v86, v[40:43] offset:36864
  v_mfma_f32_16x16x32_bf16 v[32:35], a[16:19], a[148:151], v[32:35]
  v_mfma_f32_16x16x32_bf16 v[36:39], v[108:111], a[144:147], 0
  v_mfma_f32_16x16x32_bf16 v[36:39], a[20:23], a[148:151], v[36:39]
  s_waitcnt lgkmcnt(3)
  v_mfma_f32_16x16x32_bf16 v[16:19], v[112:115], a[152:155], v[16:19]
  ds_read_b128 a[144:147], v3 offset:24832
  v_mfma_f32_16x16x32_bf16 v[16:19], a[24:27], a[156:159], v[16:19]
  ds_read_b128 a[148:151], v4 offset:24832
  v_mfma_f32_16x16x32_bf16 v[20:23], v[116:119], a[152:155], v[20:23]
  v_mfma_f32_16x16x32_bf16 v[20:23], a[28:31], a[156:159], v[20:23]
  v_cvt_pk_bf16_f32 v48, v48, v49
  v_mfma_f32_16x16x32_bf16 v[24:27], v[120:123], a[152:155], v[24:27]
  buffer_store_dwordx4 a[168:171], v80, s[8:11], s58 offen sc1
  v_mfma_f32_16x16x32_bf16 v[24:27], a[32:35], a[156:159], v[24:27]
  v_cvt_pk_bf16_f32 v49, v50, v51
  v_mfma_f32_16x16x32_bf16 v[28:31], v[124:127], a[152:155], v[28:31]
  v_cvt_pk_bf16_f32 v50, v52, v53
  v_mfma_f32_16x16x32_bf16 v[28:31], a[36:39], a[156:159], v[28:31]
  v_cvt_pk_bf16_f32 v51, v54, v55
  v_mfma_f32_16x16x32_bf16 v[32:35], v[128:131], a[152:155], v[32:35]
  ds_write_b128 v87, v[48:51] offset:36864
  v_mfma_f32_16x16x32_bf16 v[32:35], a[40:43], a[156:159], v[32:35]
  v_mfma_f32_16x16x32_bf16 v[36:39], v[132:135], a[152:155], v[36:39]
  v_mfma_f32_16x16x32_bf16 v[36:39], a[44:47], a[156:159], v[36:39]
  s_waitcnt lgkmcnt(4)
  v_mfma_f32_16x16x32_bf16 v[16:19], v[136:139], a[160:163], v[16:19]
  ds_read_b128 a[152:155], v1 offset:25088
  v_mfma_f32_16x16x32_bf16 v[16:19], a[48:51], a[164:167], v[16:19]
  ds_read_b128 a[156:159], v2 offset:25088
  v_mfma_f32_16x16x32_bf16 v[20:23], v[140:143], a[160:163], v[20:23]
  v_mfma_f32_16x16x32_bf16 v[20:23], a[52:55], a[164:167], v[20:23]
  v_mfma_f32_16x16x32_bf16 v[24:27], v[144:147], a[160:163], v[24:27]
  buffer_store_dwordx4 a[172:175], v81, s[8:11], s58 offen sc1
  v_mfma_f32_16x16x32_bf16 v[24:27], a[56:59], a[164:167], v[24:27]
  v_mfma_f32_16x16x32_bf16 v[28:31], v[148:151], a[160:163], v[28:31]
  v_mfma_f32_16x16x32_bf16 v[28:31], a[60:63], a[164:167], v[28:31]
  v_mfma_f32_16x16x32_bf16 v[32:35], v[152:155], a[160:163], v[32:35]
  v_mfma_f32_16x16x32_bf16 v[32:35], a[64:67], a[164:167], v[32:35]
  v_mfma_f32_16x16x32_bf16 v[36:39], v[156:159], a[160:163], v[36:39]
  v_mfma_f32_16x16x32_bf16 v[36:39], a[68:71], a[164:167], v[36:39]
  s_mov_b64 s[82:83], s[80:81]
  s_waitcnt lgkmcnt(3)
  v_mfma_f32_16x16x32_bf16 v[16:19], v[160:163], a[144:147], v[16:19]
  ds_read_b128 a[160:163], v3 offset:25088
  s_mov_b64 s[80:81], s[78:79]
  v_mfma_f32_16x16x32_bf16 v[16:19], a[72:75], a[148:151], v[16:19]
  ds_read_b128 a[164:167], v4 offset:25088
  s_mov_b64 s[78:79], s[76:77]
  v_mfma_f32_16x16x32_bf16 v[20:23], v[164:167], a[144:147], v[20:23]
  s_add_u32 s76, s33, s32
  v_cvt_pk_bf16_f32 v56, v56, v57
  v_mfma_f32_16x16x32_bf16 v[20:23], a[76:79], a[148:151], v[20:23]
  s_xor_b32 s76, s76, s34
  v_cvt_pk_bf16_f32 v57, v58, v59
  v_mfma_f32_16x16x32_bf16 v[24:27], v[168:171], a[144:147], v[24:27]
  buffer_store_dwordx4 a[176:179], v13, s[8:11], s59 offen sc1
  v_mfma_f32_16x16x32_bf16 v[24:27], a[80:83], a[148:151], v[24:27]
  s_bfe_u32 s77, s76, 65557
  v_cvt_pk_bf16_f32 v58, v60, v61
  v_mfma_f32_16x16x32_bf16 v[28:31], v[172:175], a[144:147], v[28:31]
  s_bfe_u32 s76, s76, 65555
  v_cvt_pk_bf16_f32 v59, v62, v63
  v_mfma_f32_16x16x32_bf16 v[28:31], a[84:87], a[148:151], v[28:31]
  ds_write_b128 v86, v[56:59] offset:36992
  v_mfma_f32_16x16x32_bf16 v[32:35], v[176:179], a[144:147], v[32:35]
  s_lshl1_add_u32 s77, s76, s77
  s_sub_u32 s77, 1, s77
  v_mfma_f32_16x16x32_bf16 v[32:35], a[88:91], a[148:151], v[32:35]
  s_and_b32 s77, s77, 3
  s_mul_i32 s77, s77, 24576
  v_mfma_f32_16x16x32_bf16 v[36:39], v[180:183], a[144:147], v[36:39]
  s_cmp_lt_u32 s32, s35
  s_cselect_b32 s76, s32, s40
  v_mfma_f32_16x16x32_bf16 v[36:39], a[92:95], a[148:151], v[36:39]
  s_add_u32 s32, s32, 786432
  s_waitcnt lgkmcnt(3)
  v_mfma_f32_16x16x32_bf16 v[16:19], v[184:187], a[152:155], v[16:19]
  ds_read_b128 a[144:147], v1 offset:36864
  s_cmp_eq_u32 s77, 0
  v_mfma_f32_16x16x32_bf16 v[16:19], a[96:99], a[156:159], v[16:19]
  ds_read_b128 a[148:151], v2 offset:36864
  s_cselect_b32 s57, 73728, s26
  v_mfma_f32_16x16x32_bf16 v[20:23], v[188:191], a[152:155], v[20:23]
  s_add_u32 s22, s76, s77
  s_add_u32 s22, s22, s57
  v_mfma_f32_16x16x32_bf16 v[20:23], a[100:103], a[156:159], v[20:23]
  s_min_u32 s22, s22, s40
  s_add_u32 m0, s39, 24576
  v_mfma_f32_16x16x32_bf16 v[24:27], v[192:195], a[152:155], v[24:27]
  buffer_load_dwordx4 v8, s[4:7], s22 offen nt lds
  v_mfma_f32_16x16x32_bf16 v[24:27], a[104:107], a[156:159], v[24:27]
  s_cmp_eq_u32 s81, 0
  s_cselect_b32 s91, 73728, s26
  v_mfma_f32_16x16x32_bf16 v[28:31], v[196:199], a[152:155], v[28:31]
  s_add_u32 s58, s80, s81
  s_add_u32 s58, s58, s91
  v_mfma_f32_16x16x32_bf16 v[28:31], a[108:111], a[156:159], v[28:31]
  s_min_u32 s58, s58, s40
  s_mov_b32 s59, s80
  v_mfma_f32_16x16x32_bf16 v[32:35], v[200:203], a[152:155], v[32:35]
  v_and_b32 v13, s91, v11
  v_add3_u32 v13, v82, v13, s81
  v_mfma_f32_16x16x32_bf16 v[32:35], a[112:115], a[156:159], v[32:35]
  s_cmp_eq_u32 s83, 73728
  s_cselect_b32 s91, 4294893568, s27
  v_mfma_f32_16x16x32_bf16 v[36:39], v[204:207], a[152:155], v[36:39]
  s_add_u32 s62, s83, 12288
  s_add_u32 s63, s82, s62
  v_mfma_f32_16x16x32_bf16 v[36:39], a[116:119], a[156:159], v[36:39]
  s_add_u32 s63, s63, s91
  s_waitcnt lgkmcnt(3)
  v_mfma_f32_16x16x32_bf16 v[16:19], v[208:211], a[160:163], v[16:19]
  ds_read_b128 a[152:155], v3 offset:36864
  s_min_u32 s63, s63, s40
  v_mfma_f32_16x16x32_bf16 v[16:19], v[232:235], a[164:167], v[16:19]
  ds_read_b128 a[156:159], v4 offset:36864
  v_and_b32 v14, s91, v12
  v_mfma_f32_16x16x32_bf16 v[20:23], v[212:215], a[160:163], v[20:23]
  v_add3_u32 v14, v80, v14, s62
  s_mov_b32 s62, s82
  v_mfma_f32_16x16x32_bf16 v[20:23], v[236:239], a[164:167], v[20:23]
  s_add_u32 m0, s39, 28672
  v_mfma_f32_16x16x32_bf16 v[24:27], v[216:219], a[160:163], v[24:27]
  buffer_load_dwordx4 v9, s[4:7], s22 offen nt lds
  v_mfma_f32_16x16x32_bf16 v[24:27], v[240:243], a[164:167], v[24:27]
  v_mfma_f32_16x16x32_bf16 v[28:31], v[220:223], a[160:163], v[28:31]
  v_mfma_f32_16x16x32_bf16 v[28:31], v[244:247], a[164:167], v[28:31]
  v_mfma_f32_16x16x32_bf16 v[32:35], v[224:227], a[160:163], v[32:35]
  v_mfma_f32_16x16x32_bf16 v[32:35], v[248:251], a[164:167], v[32:35]
  v_and_b32 v15, s57, v11
  v_mfma_f32_16x16x32_bf16 v[36:39], v[228:231], a[160:163], v[36:39]
  v_add3_u32 v15, v10, v15, s77
  v_mfma_f32_16x16x32_bf16 v[36:39], v[252:255], a[164:167], v[36:39]
  s_waitcnt lgkmcnt(2)
  v_mfma_f32_16x16x32_bf16 v[40:43], v[88:91], a[144:147], 0
  ds_read_b128 a[160:163], v1 offset:37120
  v_mfma_f32_16x16x32_bf16 v[40:43], a[0:3], a[148:151], v[40:43]
  ds_read_b128 a[164:167], v2 offset:37120
  v_mfma_f32_16x16x32_bf16 v[44:47], v[92:95], a[144:147], 0
  s_add_u32 m0, s39, 32768
  v_mfma_f32_16x16x32_bf16 v[44:47], a[4:7], a[148:151], v[44:47]
  v_cvt_pk_bf16_f32 v16, v16, v17
  v_mfma_f32_16x16x32_bf16 v[48:51], v[96:99], a[144:147], 0
  buffer_load_dwordx4 v15, s[4:7], s76 offen nt lds
  v_mfma_f32_16x16x32_bf16 v[48:51], a[8:11], a[148:151], v[48:51]
  v_cvt_pk_bf16_f32 v17, v18, v19
  v_mfma_f32_16x16x32_bf16 v[52:55], v[100:103], a[144:147], 0
  v_cvt_pk_bf16_f32 v18, v20, v21
  v_mfma_f32_16x16x32_bf16 v[52:55], a[12:15], a[148:151], v[52:55]
  s_cmp_eq_u32 s77, 73728
  v_cvt_pk_bf16_f32 v19, v22, v23
  v_mfma_f32_16x16x32_bf16 v[56:59], v[104:107], a[144:147], 0
  ds_write_b128 v86, v[16:19] offset:24576
  v_mfma_f32_16x16x32_bf16 v[56:59], a[16:19], a[148:151], v[56:59]
  s_cselect_b32 s57, 4294893568, s27
  s_add_u32 s90, s77, 12288
  v_mfma_f32_16x16x32_bf16 v[60:63], v[108:111], a[144:147], 0
  s_add_u32 s56, s76, s90
  v_cvt_pk_bf16_f32 v24, v24, v25
  v_mfma_f32_16x16x32_bf16 v[60:63], a[20:23], a[148:151], v[60:63]
  s_add_u32 s56, s56, s57
  s_waitcnt lgkmcnt(3)
  v_mfma_f32_16x16x32_bf16 v[40:43], v[112:115], a[152:155], v[40:43]
  ds_read_b128 a[144:147], v3 offset:37120
  s_min_u32 s56, s56, s40
  v_mfma_f32_16x16x32_bf16 v[40:43], a[24:27], a[156:159], v[40:43]
  ds_read_b128 a[148:151], v4 offset:37120
  v_and_b32 v15, s57, v12
  v_mfma_f32_16x16x32_bf16 v[44:47], v[116:119], a[152:155], v[44:47]
  v_add3_u32 v15, v8, v15, s90
  v_cvt_pk_bf16_f32 v25, v26, v27
  v_mfma_f32_16x16x32_bf16 v[44:47], a[28:31], a[156:159], v[44:47]
  s_add_u32 m0, s39, 36864
  v_cvt_pk_bf16_f32 v26, v28, v29
  v_mfma_f32_16x16x32_bf16 v[48:51], v[120:123], a[152:155], v[48:51]
  buffer_load_dwordx4 v15, s[4:7], s76 offen nt lds
  v_mfma_f32_16x16x32_bf16 v[48:51], a[32:35], a[156:159], v[48:51]
  v_cvt_pk_bf16_f32 v27, v30, v31
  v_mfma_f32_16x16x32_bf16 v[52:55], v[124:127], a[152:155], v[52:55]
  ds_write_b128 v87, v[24:27] offset:24576
  v_mfma_f32_16x16x32_bf16 v[52:55], a[36:39], a[156:159], v[52:55]
  v_mfma_f32_16x16x32_bf16 v[56:59], v[128:131], a[152:155], v[56:59]
  v_mfma_f32_16x16x32_bf16 v[56:59], a[40:43], a[156:159], v[56:59]
  v_mfma_f32_16x16x32_bf16 v[60:63], v[132:135], a[152:155], v[60:63]
  v_mfma_f32_16x16x32_bf16 v[60:63], a[44:47], a[156:159], v[60:63]
  s_waitcnt lgkmcnt(4)
  v_mfma_f32_16x16x32_bf16 v[40:43], v[136:139], a[160:163], v[40:43]
  ds_read_b128 a[152:155], v1 offset:37376
  v_mfma_f32_16x16x32_bf16 v[40:43], a[48:51], a[164:167], v[40:43]
  ds_read_b128 a[156:159], v2 offset:37376
  v_mfma_f32_16x16x32_bf16 v[44:47], v[140:143], a[160:163], v[44:47]
  s_add_u32 m0, s39, 40960
  v_mfma_f32_16x16x32_bf16 v[44:47], a[52:55], a[164:167], v[44:47]
  v_cvt_pk_bf16_f32 v32, v32, v33
  v_mfma_f32_16x16x32_bf16 v[48:51], v[144:147], a[160:163], v[48:51]
  buffer_load_dwordx4 v9, s[4:7], s56 offen nt lds
  v_mfma_f32_16x16x32_bf16 v[48:51], a[56:59], a[164:167], v[48:51]
  v_cvt_pk_bf16_f32 v33, v34, v35
  v_mfma_f32_16x16x32_bf16 v[52:55], v[148:151], a[160:163], v[52:55]
  v_cvt_pk_bf16_f32 v34, v36, v37
  v_mfma_f32_16x16x32_bf16 v[52:55], a[60:63], a[164:167], v[52:55]
  v_cvt_pk_bf16_f32 v35, v38, v39
  v_mfma_f32_16x16x32_bf16 v[56:59], v[152:155], a[160:163], v[56:59]
  ds_write_b128 v86, v[32:35] offset:24704
  v_mfma_f32_16x16x32_bf16 v[56:59], a[64:67], a[164:167], v[56:59]
  v_mfma_f32_16x16x32_bf16 v[60:63], v[156:159], a[160:163], v[60:63]
  v_mfma_f32_16x16x32_bf16 v[60:63], a[68:71], a[164:167], v[60:63]
  s_waitcnt lgkmcnt(4)
  v_mfma_f32_16x16x32_bf16 v[40:43], v[160:163], a[144:147], v[40:43]
  ds_read_b128 a[160:163], v3 offset:37376
  v_mfma_f32_16x16x32_bf16 v[40:43], a[72:75], a[148:151], v[40:43]
  ds_read_b128 a[164:167], v4 offset:37376
  v_mfma_f32_16x16x32_bf16 v[44:47], v[164:167], a[144:147], v[44:47]
  s_add_u32 m0, s39, 45056
  v_mfma_f32_16x16x32_bf16 v[44:47], a[76:79], a[148:151], v[44:47]
  s_xor_b32 s39, s39, 49152
  v_mfma_f32_16x16x32_bf16 v[48:51], v[168:171], a[144:147], v[48:51]
  buffer_load_dwordx4 v10, s[4:7], s56 offen nt lds
  v_mfma_f32_16x16x32_bf16 v[48:51], a[80:83], a[148:151], v[48:51]
  v_mfma_f32_16x16x32_bf16 v[52:55], v[172:175], a[144:147], v[52:55]
  v_mfma_f32_16x16x32_bf16 v[52:55], a[84:87], a[148:151], v[52:55]
  v_mfma_f32_16x16x32_bf16 v[56:59], v[176:179], a[144:147], v[56:59]
  v_mfma_f32_16x16x32_bf16 v[56:59], a[88:91], a[148:151], v[56:59]
  v_mfma_f32_16x16x32_bf16 v[60:63], v[180:183], a[144:147], v[60:63]
  v_mfma_f32_16x16x32_bf16 v[60:63], a[92:95], a[148:151], v[60:63]
  s_waitcnt vmcnt(12) lgkmcnt(2)
  s_barrier
  v_xor_b32 v1, 49152, v1
  v_xor_b32 v2, 49152, v2
  v_xor_b32 v3, 49152, v3
  v_xor_b32 v4, 49152, v4
  s_waitcnt lgkmcnt(3)
  v_mfma_f32_16x16x32_bf16 v[40:43], v[184:187], a[152:155], v[40:43]
  ds_read_b128 a[144:147], v1 offset:0
  v_mfma_f32_16x16x32_bf16 v[40:43], a[96:99], a[156:159], v[40:43]
  ds_read_b128 a[148:151], v2 offset:0
  v_mfma_f32_16x16x32_bf16 v[44:47], v[188:191], a[152:155], v[44:47]
  ds_read_b128 a[180:183], v5 offset:36864
  v_mfma_f32_16x16x32_bf16 v[44:47], a[100:103], a[156:159], v[44:47]
  ds_read_b128 a[184:187], v6 offset:36864
  v_mfma_f32_16x16x32_bf16 v[48:51], v[192:195], a[152:155], v[48:51]
  ds_read_b128 a[188:191], v7 offset:36864
  v_mfma_f32_16x16x32_bf16 v[48:51], a[104:107], a[156:159], v[48:51]
  ds_read_b128 a[168:171], v5 offset:24576
  v_mfma_f32_16x16x32_bf16 v[52:55], v[196:199], a[152:155], v[52:55]
  ds_read_b128 a[172:175], v6 offset:24576
  v_mfma_f32_16x16x32_bf16 v[52:55], a[108:111], a[156:159], v[52:55]
  ds_read_b128 a[176:179], v7 offset:24576
  v_mfma_f32_16x16x32_bf16 v[56:59], v[200:203], a[152:155], v[56:59]
  v_mfma_f32_16x16x32_bf16 v[56:59], a[112:115], a[156:159], v[56:59]
  v_mfma_f32_16x16x32_bf16 v[60:63], v[204:207], a[152:155], v[60:63]
  v_mfma_f32_16x16x32_bf16 v[60:63], a[116:119], a[156:159], v[60:63]
  s_waitcnt lgkmcnt(8)
  v_mfma_f32_16x16x32_bf16 v[40:43], v[208:211], a[160:163], v[40:43]
  ds_read_b128 a[152:155], v3 offset:0
  v_mfma_f32_16x16x32_bf16 v[40:43], v[232:235], a[164:167], v[40:43]
  ds_read_b128 a[156:159], v4 offset:0
  v_mfma_f32_16x16x32_bf16 v[44:47], v[212:215], a[160:163], v[44:47]
  s_waitcnt lgkmcnt(7)
  buffer_store_dwordx4 a[180:183], v14, s[8:11], s62 offen sc1
  v_mfma_f32_16x16x32_bf16 v[44:47], v[236:239], a[164:167], v[44:47]
  v_mfma_f32_16x16x32_bf16 v[48:51], v[216:219], a[160:163], v[48:51]
  v_mfma_f32_16x16x32_bf16 v[48:51], v[240:243], a[164:167], v[48:51]
  v_mfma_f32_16x16x32_bf16 v[52:55], v[220:223], a[160:163], v[52:55]
  v_mfma_f32_16x16x32_bf16 v[52:55], v[244:247], a[164:167], v[52:55]
  v_mfma_f32_16x16x32_bf16 v[56:59], v[224:227], a[160:163], v[56:59]
  s_waitcnt lgkmcnt(6)
  buffer_store_dwordx4 a[184:187], v81, s[8:11], s63 offen sc1
  v_mfma_f32_16x16x32_bf16 v[56:59], v[248:251], a[164:167], v[56:59]
  v_mfma_f32_16x16x32_bf16 v[60:63], v[228:231], a[160:163], v[60:63]
  v_mfma_f32_16x16x32_bf16 v[60:63], v[252:255], a[164:167], v[60:63]
  s_cmp_lt_u32 s78, s40
  s_cbranch_scc1 L_loop
L_tail:
  s_nop 3
  v_cvt_pk_bf16_f32 v40, v40, v41
  v_cvt_pk_bf16_f32 v41, v42, v43
  v_cvt_pk_bf16_f32 v42, v44, v45
  v_cvt_pk_bf16_f32 v43, v46, v47
  ds_write_b128 v86, v[40:43] offset:12288
  v_cvt_pk_bf16_f32 v48, v48, v49
  v_cvt_pk_bf16_f32 v49, v50, v51
  v_cvt_pk_bf16_f32 v50, v52, v53
  v_cvt_pk_bf16_f32 v51, v54, v55
  ds_write_b128 v87, v[48:51] offset:12288
  v_cvt_pk_bf16_f32 v56, v56, v57
  v_cvt_pk_bf16_f32 v57, v58, v59
  v_cvt_pk_bf16_f32 v58, v60, v61
  v_cvt_pk_bf16_f32 v59, v62, v63
  ds_write_b128 v86, v[56:59] offset:12416
  s_waitcnt lgkmcnt(8)
  buffer_store_dwordx4 a[188:191], v82, s[8:11], s63 offen sc1
  s_waitcnt lgkmcnt(7)
  buffer_store_dwordx4 a[168:171], v80, s[8:11], s58 offen sc1
  s_waitcnt lgkmcnt(6)
  buffer_store_dwordx4 a[172:175], v81, s[8:11], s58 offen sc1
  s_waitcnt lgkmcnt(5)
  buffer_store_dwordx4 a[176:179], v13, s[8:11], s59 offen sc1
  s_cmp_eq_u32 s79, 0
  s_cselect_b32 s91, 73728, s26
  s_add_u32 s58, s78, s79
  s_add_u32 s58, s58, s91
  s_min_u32 s58, s58, s40
  s_mov_b32 s59, s78
  v_and_b32 v13, s91, v11
  v_add3_u32 v13, v82, v13, s79
  s_cmp_eq_u32 s81, 73728
  s_cselect_b32 s91, 4294893568, s27
  s_add_u32 s62, s81, 12288
  s_add_u32 s63, s80, s62
  s_add_u32 s63, s63, s91
  s_min_u32 s63, s63, s40
  v_and_b32 v14, s91, v12
  v_add3_u32 v14, v80, v14, s62
  s_mov_b32 s62, s80
  s_waitcnt lgkmcnt(0)
  s_barrier
  ds_read_b128 a[144:147], v5 offset:12288
  ds_read_b128 a[148:151], v6 offset:12288
  ds_read_b128 a[152:155], v7 offset:12288
  s_waitcnt lgkmcnt(2)
  buffer_store_dwordx4 a[144:147], v14, s[8:11], s62 offen sc1
  s_waitcnt lgkmcnt(1)
  buffer_store_dwordx4 a[148:151], v81, s[8:11], s63 offen sc1
  s_waitcnt lgkmcnt(0)
  buffer_store_dwordx4 a[152:155], v82, s[8:11], s63 offen sc1
  s_endpgm
L_slow:
  v_mbcnt_lo_u32_b32 v15, -1, 0
  v_lshl_add_u32 v15, v15, 2, s95
  v_mov_b32 v254, 1
  v_mov_b32 v255, 0
  s_mov_b64 exec, 15
  buffer_atomic_cmpswap v[254:255], v15, s[16:19], 0 offen sc0 sc1
  s_waitcnt vmcnt(0)
  v_max_u32 v254, 1, v254
  s_nop 0
  v_readlane_b32 s84, v254, 0
  v_readlane_b32 s85, v254, 1
  v_readlane_b32 s86, v254, 2
  v_readlane_b32 s87, v254, 3
  s_nop 3
  s_min_u32 s51, s84, s86
  s_min_u32 s52, s85, s87
  s_mov_b64 exec, -1
  s_branch L_back
L_done:
  s_endpgm
.section .rodata,"a"
.p2align 6
.amdhsa_kernel standalone__depthwise_separable__vision_kernel
  .amdhsa_next_free_vgpr 512
  .amdhsa_next_free_sgpr 100
  .amdhsa_accum_offset 256
  .amdhsa_group_segment_fixed_size 0
  .amdhsa_kernarg_size 48
  .amdhsa_user_sgpr_count 2
  .amdhsa_user_sgpr_kernarg_segment_ptr 1
  .amdhsa_system_sgpr_workgroup_id_x 1
  .amdhsa_float_denorm_mode_32 3
.end_amdhsa_kernel
```

```asm
; @launch grid=(256,1,1) block=(256,1,1) lds=152128
.amdgcn_target "amdgcn-amd-amdhsa--gfx950"
.text
.globl standalone__depthwise_separable__vision_kernel
.p2align 8
.type standalone__depthwise_separable__vision_kernel,@function
standalone__depthwise_separable__vision_kernel:
  s_load_dwordx8 s[24:31], s[0:1], 0
  s_load_dwordx2 s[92:93], s[0:1], 32
  s_cmp_ge_u32 s2, 256
  s_cbranch_scc1 L_done
  v_lshrrev_b32 v16, 6, v0
  v_and_b32 v28, 63, v0
  v_readfirstlane_b32 s20, v16
  s_getpc_b64 s[50:51]
L_pc:
  v_mul_u32_u24 v18, 128, v0
  v_min_u32 v18, L_done-L_pc, v18
  v_mov_b32 v19, s51
  v_add_co_u32 v18, vcc, s50, v18
  s_nop 1
  v_addc_co_u32 v19, vcc, 0, v19, vcc
  global_load_dword v88, v[18:19], off
  s_lshr_b32 s50, s2, 3
  s_and_b32 s55, s50, 3
  s_lshr_b32 s54, s50, 2
  s_mul_i32 s51, s54, 11
  s_lshr_b32 s51, s51, 5
  s_mul_i32 s51, s51, 3
  s_sub_u32 s54, s54, s51
  s_mul_i32 s52, s20, 192
  v_mul_u32_u24 v18, 0xaaab, v28
  v_lshrrev_b32 v18, 19, v18
  v_mul_u32_u24 v19, 576, v18
  v_lshl_add_u32 v19, v28, 4, v19
  v_add_u32 v64, s52, v19
  v_add_u32 v17, 64, v28
  v_mul_u32_u24 v18, 0xaaab, v17
  v_lshrrev_b32 v18, 19, v18
  v_mul_u32_u24 v19, 576, v18
  v_lshl_add_u32 v19, v28, 4, v19
  v_lshrrev_b32 v18, 3, v18
  v_mul_u32_u24 v18, 6144, v18
  v_add_u32 v19, v19, v18
  v_add_u32 v65, s52, v19
  v_add_u32 v17, 128, v28
  v_mul_u32_u24 v18, 0xaaab, v17
  v_lshrrev_b32 v18, 19, v18
  v_mul_u32_u24 v19, 576, v18
  v_lshl_add_u32 v19, v28, 4, v19
  v_add_u32 v19, 6144, v19
  v_add_u32 v66, s52, v19
  s_mul_i32 s42, s54, 98304
  s_mul_i32 s45, s55, 24576
  s_mul_i32 s49, s20, 6160
  s_waitcnt lgkmcnt(0)
  s_mov_b32 s12, s28
  s_and_b32 s13, s29, 0xffff
  s_mov_b32 s14, 294912
  s_mov_b32 s15, 0x00020000
  s_add_u32 m0, s49, 98560
  s_add_u32 s50, s42, s45
  buffer_load_dwordx4 v64, s[12:15], s50 offen offset:0 lds
  buffer_load_dwordx4 v65, s[12:15], s50 offen offset:1024 lds
  buffer_load_dwordx4 v66, s[12:15], s50 offen offset:2048 lds
  s_add_u32 m0, s49, 101640
  s_add_u32 s50, s50, 6144
  buffer_load_dwordx4 v64, s[12:15], s50 offen offset:0 lds
  buffer_load_dwordx4 v65, s[12:15], s50 offen offset:1024 lds
  buffer_load_dwordx4 v66, s[12:15], s50 offen offset:2048 lds
  s_lshr_b32 s51, s2, 5
  s_and_b32 s52, s2, 3
  s_lshl2_add_u32 s36, s51, s52
  s_lshl_b32 s36, s36, 2
  s_mul_i32 s51, s51, 144
  s_lshr_b32 s52, s52, 1
  s_lshl1_add_u32 s52, s55, s52
  s_add_u32 s51, s51, s52
  s_mul_i32 s32, s51, 98304
  s_add_u32 s21, s32, 14155776
  s_lshl_b32 s51, s20, 11
  s_and_b32 s52, s2, 3
  s_lshl_b32 s52, s52, 8
  s_add_u32 s51, s51, s52
  s_lshr_b32 s52, s2, 5
  s_lshl_b32 s37, s52, 24
  s_add_u32 s37, s37, 8650752
  s_mul_i32 s52, s52, 6291456
  s_add_u32 s52, s52, 67371008
  s_min_u32 s37, s37, s52
  s_add_u32 s37, s37, s51
  s_and_b32 s23, s2, 28
  s_add_u32 s38, s37, 8192
  s_cmp_lg_u32 s23, 0
  s_cbranch_scc1 L_np0
  s_load_dword s84, s[24:25], s37 glc
  s_load_dword s85, s[24:25], s38 glc
L_np0:
  s_lshl_b32 s53, s55, 2
  v_lshrrev_b32 v17, 4, v28
  v_add_u32 v18, s54, v17
  v_subrev_u32 v19, 3, v18
  v_min_u32 v18, v18, v19
  v_and_b32 v20, 15, v28
  v_xor_b32 v19, s53, v20
  v_lshlrev_b32 v19, 4, v19
  v_lshl_add_u32 v19, v18, 8, v19
  v_cmp_lt_u32 vcc, 47, v28
  s_lshl_b32 s50, s20, 10
  s_add_u32 m0, s50, 147968
  v_cndmask_b32 v19, v19, v66, vcc
  s_mov_b32 s16, s26
  s_and_b32 s17, s27, 0xffff
  s_mov_b32 s18, 768
  s_mov_b32 s19, 0x00020000
  buffer_load_dwordx4 v19, s[16:19], 0 offen lds
  s_add_u32 s43, s42, 98304
  s_cmp_eq_u32 s54, 2
  s_cselect_b32 s43, 0, s43
  s_add_u32 s44, s43, 98304
  s_cmp_eq_u32 s54, 1
  s_cselect_b32 s44, 0, s44
  s_xor_b32 s46, s55, 1
  s_mul_i32 s46, s46, 24576
  s_xor_b32 s47, s55, 2
  s_mul_i32 s47, s47, 24576
  s_xor_b32 s48, s55, 3
  s_mul_i32 s48, s48, 24576
  s_mov_b32 s4, s24
  s_and_b32 s5, s25, 0xffff
  s_mov_b32 s6, 113246208
  s_mov_b32 s7, 0x00020000
  s_add_u32 s33, s24, 49152
  s_mov_b32 s40, 113246208
  s_mov_b32 s26, 4294942720
  s_mov_b32 s27, 24576
  s_lshl_b32 s39, s20, 10
  s_mov_b32 s76, s40
  s_mov_b32 s77, 0
  s_mov_b32 s78, s40
  s_mov_b32 s79, 0
  s_mov_b32 s80, s40
  s_mov_b32 s81, 0
  s_lshr_b32 s34, s2, 1
  s_xor_b32 s34, s34, s2
  s_and_b32 s34, s34, 4
  s_and_b32 s51, s2, 1
  s_or_b32 s34, s34, s51
  s_lshl_b32 s34, s34, 19
  s_mov_b32 s35, -1
  v_lshrrev_b32 v35, 4, v0
  v_xor_b32 v22, s53, v20
  v_mul_u32_u24 v32, 43, v35
  v_lshrrev_b32 v32, 7, v32
  v_mul_u32_u24 v18, 3, v32
  v_sub_u32 v19, v35, v18
  v_add_u32 v19, s54, v19
  v_subrev_u32 v21, 3, v19
  v_min_u32 v19, v19, v21
  v_add_u32 v19, v19, v18
  v_xor_b32 v21, v32, v22
  v_lshlrev_b32 v21, 4, v21
  v_lshl_add_u32 v8, v19, 8, v21
  v_cmp_eq_u32 vcc, 5, v32
  s_nop 1
  v_cndmask_b32 v12, 0, -1, vcc
  v_add_u32 v36, 16, v35
  v_mul_u32_u24 v33, 43, v36
  v_lshrrev_b32 v33, 7, v33
  v_mul_u32_u24 v18, 3, v33
  v_sub_u32 v19, v36, v18
  v_add_u32 v19, s54, v19
  v_subrev_u32 v21, 3, v19
  v_min_u32 v19, v19, v21
  v_add_u32 v19, v19, v18
  v_xor_b32 v21, v33, v22
  v_lshlrev_b32 v21, 4, v21
  v_lshl_add_u32 v9, v19, 8, v21
  v_add_u32 v37, 32, v35
  v_mul_u32_u24 v34, 43, v37
  v_lshrrev_b32 v34, 7, v34
  v_mul_u32_u24 v18, 3, v34
  v_sub_u32 v19, v37, v18
  v_add_u32 v19, s54, v19
  v_subrev_u32 v21, 3, v19
  v_min_u32 v19, v19, v21
  v_add_u32 v19, v19, v18
  v_xor_b32 v21, v34, v22
  v_lshlrev_b32 v21, 4, v21
  v_lshl_add_u32 v10, v19, 8, v21
  v_cmp_eq_u32 vcc, 10, v34
  s_nop 1
  v_cndmask_b32 v11, 0, -1, vcc
  s_mov_b32 s8, s30
  s_and_b32 s9, s31, 0xffff
  s_mov_b32 s10, 113246208
  s_mov_b32 s11, 0x00020000
  v_lshlrev_b32 v80, 4, v0
  v_and_b32 v21, 7, v32
  v_xor_b32 v21, v21, v20
  v_lshlrev_b32 v21, 4, v21
  v_lshl_add_u32 v21, v35, 8, v21
  v_add_u32 v5, 98560, v21
  v_add_u32 v81, 4096, v80
  v_and_b32 v21, 7, v33
  v_xor_b32 v21, v21, v20
  v_lshlrev_b32 v21, 4, v21
  v_lshl_add_u32 v21, v36, 8, v21
  v_add_u32 v6, 98560, v21
  v_add_u32 v82, 8192, v80
  v_and_b32 v21, 7, v34
  v_xor_b32 v21, v21, v20
  v_lshlrev_b32 v21, 4, v21
  v_lshl_add_u32 v21, v37, 8, v21
  v_add_u32 v7, 98560, v21
  v_mul_u32_u24 v16, 0x300, v20
  v_xor_b32 v18, v17, v20
  v_lshl_add_u32 v1, v18, 4, v16
  v_xor_b32 v2, 64, v1
  v_xor_b32 v3, 128, v1
  v_xor_b32 v4, 192, v1
  s_mul_i32 s51, s20, 12
  v_and_b32 v18, 7, v20
  v_add_u32 v19, s51, v17
  v_xor_b32 v19, v19, v18
  v_lshl_add_u32 v86, v19, 4, v16
  v_add_u32 v86, 98560, v86
  v_add_u32 v19, s51, v17
  v_add_u32 v19, 4, v19
  v_xor_b32 v19, v19, v18
  v_lshl_add_u32 v87, v19, 4, v16
  v_add_u32 v87, 98560, v87
  v_bfe_u32 v18, v28, 2, 2
  v_and_b32 v19, 3, v28
  v_lshrrev_b32 v21, 1, v17
  v_lshl_add_u32 v21, v21, 3, v18
  v_mul_u32_u24 v21, 192, v21
  v_and_b32 v23, 1, v17
  v_mul_u32_u24 v23, 3080, v23
  v_add_u32 v21, v21, v23
  v_lshl_add_u32 v21, v19, 4, v21
  s_add_u32 s51, s49, 49152
  v_add_u32 v71, s51, v21
  v_add_u32 v67, 49408, v71
  s_add_u32 s51, s39, 147968
  v_lshl_add_u32 v68, v17, 4, s51
  v_and_b32 v21, 1, v28
  v_lshlrev_b32 v21, 4, v21
  v_mov_b32 v23, 0xffff
  v_lshlrev_b32 v21, v21, v23
  v_lshlrev_b32 v16, 1, v17
  v_bfe_u32 v23, v28, 1, 3
  v_cmp_eq_u32 vcc, v16, v23
  v_add_u32 v16, 1, v16
  s_nop 0
  v_cndmask_b32 v69, 0, v21, vcc
  v_cmp_eq_u32 vcc, v16, v23
  s_mov_b32 s16, s92
  s_and_b32 s17, s93, 0xffff
  s_mov_b32 s18, 256
  s_mov_b32 s19, 0x00020000
  v_cndmask_b32 v70, 0, v21, vcc
  s_add_u32 m0, s49, 123200
  s_add_u32 s50, s42, s46
  buffer_load_dwordx4 v64, s[12:15], s50 offen offset:0 lds
  buffer_load_dwordx4 v65, s[12:15], s50 offen offset:1024 lds
  buffer_load_dwordx4 v66, s[12:15], s50 offen offset:2048 lds
  s_add_u32 m0, s49, 126280
  s_add_u32 s50, s50, 6144
  buffer_load_dwordx4 v64, s[12:15], s50 offen offset:0 lds
  buffer_load_dwordx4 v65, s[12:15], s50 offen offset:1024 lds
  buffer_load_dwordx4 v66, s[12:15], s50 offen offset:2048 lds
  s_add_u32 m0, s49, 49152
  s_add_u32 s50, s42, s47
  buffer_load_dwordx4 v64, s[12:15], s50 offen offset:0 lds
  buffer_load_dwordx4 v65, s[12:15], s50 offen offset:1024 lds
  buffer_load_dwordx4 v66, s[12:15], s50 offen offset:2048 lds
  s_add_u32 m0, s49, 52232
  s_add_u32 s50, s50, 6144
  buffer_load_dwordx4 v64, s[12:15], s50 offen offset:0 lds
  buffer_load_dwordx4 v65, s[12:15], s50 offen offset:1024 lds
  buffer_load_dwordx4 v66, s[12:15], s50 offen offset:2048 lds
  s_cmp_lg_u32 s23, 0
  s_cbranch_scc1 L_npr
  s_mov_b32 s41, 0xffff
  s_mov_b32 s88, 0xffff
  s_lshl_b32 s52, s20, 2
  s_add_u32 s52, s52, 152064
  v_mov_b32 v16, s52
  s_waitcnt lgkmcnt(0)
  s_memtime s[84:85]
  s_load_dword s52, s[24:25], s37 glc
  s_waitcnt lgkmcnt(0)
  s_memtime s[86:87]
  s_load_dword s52, s[24:25], s38 glc
  s_waitcnt lgkmcnt(0)
  s_sub_u32 s51, s86, s84
  s_memtime s[84:85]
  s_min_u32 s41, s41, s51
  s_waitcnt lgkmcnt(0)
  s_sub_u32 s51, s84, s86
  s_min_u32 s88, s88, s51
  s_lshl_b32 s41, s41, 16
  s_or_b32 s41, s41, s88
  v_mov_b32 v18, s41
  ds_write_b32 v16, v18
  s_waitcnt lgkmcnt(0)
L_npr:
  s_add_u32 m0, s49, 73792
  s_add_u32 s50, s42, s48
  buffer_load_dwordx4 v64, s[12:15], s50 offen offset:0 lds
  buffer_load_dwordx4 v65, s[12:15], s50 offen offset:1024 lds
  buffer_load_dwordx4 v66, s[12:15], s50 offen offset:2048 lds
  s_add_u32 m0, s49, 76872
  s_add_u32 s50, s50, 6144
  buffer_load_dwordx4 v64, s[12:15], s50 offen offset:0 lds
  buffer_load_dwordx4 v65, s[12:15], s50 offen offset:1024 lds
  buffer_load_dwordx4 v66, s[12:15], s50 offen offset:2048 lds
  s_waitcnt vmcnt(18)
  ds_read_b128 v[72:75], v68 offset:0
  ds_read_b64_tr_b16 a[192:193], v67 offset:0
  ds_read_b64_tr_b16 a[194:195], v67 offset:768
  ds_read_b64_tr_b16 a[196:197], v67 offset:8
  ds_read_b64_tr_b16 a[198:199], v67 offset:776
  ds_read_b64_tr_b16 a[200:201], v67 offset:64
  ds_read_b64_tr_b16 a[202:203], v67 offset:832
  ds_read_b64_tr_b16 a[204:205], v67 offset:72
  ds_read_b64_tr_b16 a[206:207], v67 offset:840
  ds_read_b64_tr_b16 a[208:209], v67 offset:128
  ds_read_b64_tr_b16 a[210:211], v67 offset:896
  ds_read_b64_tr_b16 a[212:213], v67 offset:136
  ds_read_b64_tr_b16 a[214:215], v67 offset:904
  s_waitcnt lgkmcnt(0)
  v_and_b32 v72, v69, v72
  v_and_b32 v73, v70, v73
  v_and_b32 v74, v69, v74
  v_and_b32 v75, v70, v75
  s_waitcnt vmcnt(12)
  ds_read_b128 v[76:79], v68 offset:64
  v_mfma_f32_16x16x16_bf16 v[16:19], v[72:73], a[192:193], 0
  ds_read_b64_tr_b16 a[216:217], v67 offset:24640
  ds_read_b64_tr_b16 a[218:219], v67 offset:25408
  v_mfma_f32_16x16x16_bf16 v[20:23], v[74:75], a[194:195], 0
  ds_read_b64_tr_b16 a[220:221], v67 offset:24648
  ds_read_b64_tr_b16 a[222:223], v67 offset:25416
  v_mfma_f32_16x16x16_bf16 v[24:27], v[72:73], a[196:197], 0
  ds_read_b64_tr_b16 a[224:225], v67 offset:24704
  ds_read_b64_tr_b16 a[226:227], v67 offset:25472
  v_mfma_f32_16x16x16_bf16 v[28:31], v[74:75], a[198:199], 0
  ds_read_b64_tr_b16 a[228:229], v67 offset:24712
  ds_read_b64_tr_b16 a[230:231], v67 offset:25480
  v_mfma_f32_16x16x16_bf16 v[32:35], v[72:73], a[200:201], 0
  ds_read_b64_tr_b16 a[232:233], v67 offset:24768
  ds_read_b64_tr_b16 a[234:235], v67 offset:25536
  v_cvt_pk_bf16_f32 v88, v16, v17
  v_cvt_pk_bf16_f32 v89, v18, v19
  v_mfma_f32_16x16x16_bf16 v[36:39], v[74:75], a[202:203], 0
  ds_read_b64_tr_b16 a[236:237], v67 offset:24776
  ds_read_b64_tr_b16 a[238:239], v67 offset:25544
  v_cvt_pk_bf16_f32 v90, v20, v21
  v_cvt_pk_bf16_f32 v91, v22, v23
  v_mfma_f32_16x16x16_bf16 v[40:43], v[72:73], a[204:205], 0
  s_add_u32 m0, s49, 98560
  s_add_u32 s50, s43, s45
  v_cvt_pk_bf16_f32 v92, v24, v25
  v_cvt_pk_bf16_f32 v93, v26, v27
  v_mfma_f32_16x16x16_bf16 v[44:47], v[74:75], a[206:207], 0
  buffer_load_dwordx4 v64, s[12:15], s50 offen offset:0 lds
  buffer_load_dwordx4 v65, s[12:15], s50 offen offset:1024 lds
  v_cvt_pk_bf16_f32 v94, v28, v29
  v_cvt_pk_bf16_f32 v95, v30, v31
  v_mfma_f32_16x16x16_bf16 v[48:51], v[72:73], a[208:209], 0
  buffer_load_dwordx4 v66, s[12:15], s50 offen offset:2048 lds
  s_add_u32 m0, s49, 101640
  v_cvt_pk_bf16_f32 v96, v32, v33
  v_cvt_pk_bf16_f32 v97, v34, v35
  v_mfma_f32_16x16x16_bf16 v[52:55], v[74:75], a[210:211], 0
  s_add_u32 s50, s50, 6144
  buffer_load_dwordx4 v64, s[12:15], s50 offen offset:0 lds
  v_cvt_pk_bf16_f32 v98, v36, v37
  v_cvt_pk_bf16_f32 v99, v38, v39
  v_mfma_f32_16x16x16_bf16 v[56:59], v[72:73], a[212:213], 0
  buffer_load_dwordx4 v65, s[12:15], s50 offen offset:1024 lds
  v_cvt_pk_bf16_f32 v100, v40, v41
  v_cvt_pk_bf16_f32 v101, v42, v43
  v_mfma_f32_16x16x16_bf16 v[60:63], v[74:75], a[214:215], 0
  buffer_load_dwordx4 v66, s[12:15], s50 offen offset:2048 lds
  v_cvt_pk_bf16_f32 v102, v44, v45
  v_cvt_pk_bf16_f32 v103, v46, v47
  s_cmp_lg_u32 s23, 0
  s_cbranch_scc1 L_np1
  s_barrier
  s_or_b32 s51, s23, s20
  s_cmp_lg_u32 s51, 0
  s_cbranch_scc1 L_np1
  v_mov_b32 v248, 152064
  ds_read_b128 v[240:243], v248
  s_add_u32 s51, s24, s37
  s_lshr_b32 s52, s51, 20
  s_lshr_b32 s50, s2, 1
  s_xor_b32 s52, s52, s50
  s_and_b32 s52, s52, 2
  s_lshr_b32 s51, s51, 17
  s_and_b32 s51, s51, 4
  s_or_b32 s51, s51, s52
  s_or_b32 s51, s51, 1
  v_mov_b32 v251, 0
  v_mov_b32 v248, s36
  s_waitcnt lgkmcnt(0)
  v_pk_min_u16 v240, v240, v241
  v_pk_min_u16 v242, v242, v243
  v_pk_min_u16 v240, v240, v242
  v_lshrrev_b32 v241, 16, v240
  v_and_b32 v240, 0xffff, v240
  v_cmp_gt_u32 vcc, v241, v240
  v_min_u32 v242, v240, v241
  s_nop 0
  v_cndmask_b32 v250, 0, 2, vcc
  v_xor_b32 v250, s51, v250
  s_mov_b64 exec, 1
  v_lshl_or_b32 v250, v242, 16, v250
  buffer_atomic_cmpswap v[250:251], v248, s[16:19], 0 offen sc1
  s_mov_b64 exec, -1
L_np1:
  s_waitcnt lgkmcnt(0)
  v_and_b32 v76, v69, v76
  v_and_b32 v77, v70, v77
  v_and_b32 v78, v69, v78
  v_and_b32 v79, v70, v79
  s_waitcnt vmcnt(12)
  ds_read_b128 v[72:75], v68 offset:128
  v_mfma_f32_16x16x16_bf16 v[16:19], v[76:77], a[216:217], 0
  ds_read_b64_tr_b16 a[192:193], v71 offset:0
  ds_read_b64_tr_b16 a[194:195], v71 offset:768
  v_cvt_pk_bf16_f32 v104, v48, v49
  v_cvt_pk_bf16_f32 v105, v50, v51
  v_mfma_f32_16x16x16_bf16 v[20:23], v[78:79], a[218:219], 0
  ds_read_b64_tr_b16 a[196:197], v71 offset:8
  ds_read_b64_tr_b16 a[198:199], v71 offset:776
  v_cvt_pk_bf16_f32 v106, v52, v53
  v_cvt_pk_bf16_f32 v107, v54, v55
  v_mfma_f32_16x16x16_bf16 v[24:27], v[76:77], a[220:221], 0
  ds_read_b64_tr_b16 a[200:201], v71 offset:64
  ds_read_b64_tr_b16 a[202:203], v71 offset:832
  v_cvt_pk_bf16_f32 v108, v56, v57
  v_cvt_pk_bf16_f32 v109, v58, v59
  v_mfma_f32_16x16x16_bf16 v[28:31], v[78:79], a[222:223], 0
  ds_read_b64_tr_b16 a[204:205], v71 offset:72
  ds_read_b64_tr_b16 a[206:207], v71 offset:840
  v_cvt_pk_bf16_f32 v110, v60, v61
  v_cvt_pk_bf16_f32 v111, v62, v63
  v_mfma_f32_16x16x16_bf16 v[32:35], v[76:77], a[224:225], 0
  ds_read_b64_tr_b16 a[208:209], v71 offset:128
  ds_read_b64_tr_b16 a[210:211], v71 offset:896
  v_cvt_pk_bf16_f32 v16, v16, v17
  v_cvt_pk_bf16_f32 v17, v18, v19
  v_accvgpr_write_b32 a0, v16
  v_accvgpr_write_b32 a1, v17
  v_mfma_f32_16x16x16_bf16 v[36:39], v[78:79], a[226:227], 0
  ds_read_b64_tr_b16 a[212:213], v71 offset:136
  ds_read_b64_tr_b16 a[214:215], v71 offset:904
  v_cvt_pk_bf16_f32 v20, v20, v21
  v_cvt_pk_bf16_f32 v21, v22, v23
  v_accvgpr_write_b32 a2, v20
  v_accvgpr_write_b32 a3, v21
  v_mfma_f32_16x16x16_bf16 v[40:43], v[76:77], a[228:229], 0
  s_add_u32 m0, s49, 123200
  s_add_u32 s50, s43, s46
  v_cvt_pk_bf16_f32 v24, v24, v25
  v_cvt_pk_bf16_f32 v25, v26, v27
  v_accvgpr_write_b32 a4, v24
  v_accvgpr_write_b32 a5, v25
  v_mfma_f32_16x16x16_bf16 v[44:47], v[78:79], a[230:231], 0
  buffer_load_dwordx4 v64, s[12:15], s50 offen offset:0 lds
  buffer_load_dwordx4 v65, s[12:15], s50 offen offset:1024 lds
  v_cvt_pk_bf16_f32 v28, v28, v29
  v_cvt_pk_bf16_f32 v29, v30, v31
  v_accvgpr_write_b32 a6, v28
  v_accvgpr_write_b32 a7, v29
  v_mfma_f32_16x16x16_bf16 v[48:51], v[76:77], a[232:233], 0
  buffer_load_dwordx4 v66, s[12:15], s50 offen offset:2048 lds
  s_add_u32 m0, s49, 126280
  v_cvt_pk_bf16_f32 v32, v32, v33
  v_cvt_pk_bf16_f32 v33, v34, v35
  v_accvgpr_write_b32 a8, v32
  v_accvgpr_write_b32 a9, v33
  v_mfma_f32_16x16x16_bf16 v[52:55], v[78:79], a[234:235], 0
  s_add_u32 s50, s50, 6144
  buffer_load_dwordx4 v64, s[12:15], s50 offen offset:0 lds
  v_cvt_pk_bf16_f32 v36, v36, v37
  v_cvt_pk_bf16_f32 v37, v38, v39
  v_accvgpr_write_b32 a10, v36
  v_accvgpr_write_b32 a11, v37
  v_mfma_f32_16x16x16_bf16 v[56:59], v[76:77], a[236:237], 0
  buffer_load_dwordx4 v65, s[12:15], s50 offen offset:1024 lds
  v_cvt_pk_bf16_f32 v40, v40, v41
  v_cvt_pk_bf16_f32 v41, v42, v43
  v_accvgpr_write_b32 a12, v40
  v_accvgpr_write_b32 a13, v41
  v_mfma_f32_16x16x16_bf16 v[60:63], v[78:79], a[238:239], 0
  buffer_load_dwordx4 v66, s[12:15], s50 offen offset:2048 lds
  v_cvt_pk_bf16_f32 v44, v44, v45
  v_cvt_pk_bf16_f32 v45, v46, v47
  v_accvgpr_write_b32 a14, v44
  v_accvgpr_write_b32 a15, v45
  s_waitcnt lgkmcnt(0)
  v_and_b32 v72, v69, v72
  v_and_b32 v73, v70, v73
  v_and_b32 v74, v69, v74
  v_and_b32 v75, v70, v75
  s_waitcnt vmcnt(12)
  ds_read_b128 v[76:79], v68 offset:192
  v_mfma_f32_16x16x16_bf16 v[16:19], v[72:73], a[192:193], 0
  ds_read_b64_tr_b16 a[216:217], v71 offset:24640
  ds_read_b64_tr_b16 a[218:219], v71 offset:25408
  v_cvt_pk_bf16_f32 v48, v48, v49
  v_cvt_pk_bf16_f32 v49, v50, v51
  v_accvgpr_write_b32 a16, v48
  v_accvgpr_write_b32 a17, v49
  v_mfma_f32_16x16x16_bf16 v[20:23], v[74:75], a[194:195], 0
  ds_read_b64_tr_b16 a[220:221], v71 offset:24648
  ds_read_b64_tr_b16 a[222:223], v71 offset:25416
  v_cvt_pk_bf16_f32 v52, v52, v53
  v_cvt_pk_bf16_f32 v53, v54, v55
  v_accvgpr_write_b32 a18, v52
  v_accvgpr_write_b32 a19, v53
  v_mfma_f32_16x16x16_bf16 v[24:27], v[72:73], a[196:197], 0
  ds_read_b64_tr_b16 a[224:225], v71 offset:24704
  ds_read_b64_tr_b16 a[226:227], v71 offset:25472
  v_cvt_pk_bf16_f32 v56, v56, v57
  v_cvt_pk_bf16_f32 v57, v58, v59
  v_accvgpr_write_b32 a20, v56
  v_accvgpr_write_b32 a21, v57
  v_mfma_f32_16x16x16_bf16 v[28:31], v[74:75], a[198:199], 0
  ds_read_b64_tr_b16 a[228:229], v71 offset:24712
  ds_read_b64_tr_b16 a[230:231], v71 offset:25480
  v_cvt_pk_bf16_f32 v60, v60, v61
  v_cvt_pk_bf16_f32 v61, v62, v63
  v_accvgpr_write_b32 a22, v60
  v_accvgpr_write_b32 a23, v61
  v_mfma_f32_16x16x16_bf16 v[32:35], v[72:73], a[200:201], 0
  ds_read_b64_tr_b16 a[232:233], v71 offset:24768
  ds_read_b64_tr_b16 a[234:235], v71 offset:25536
  v_cvt_pk_bf16_f32 v112, v16, v17
  v_cvt_pk_bf16_f32 v113, v18, v19
  v_mfma_f32_16x16x16_bf16 v[36:39], v[74:75], a[202:203], 0
  ds_read_b64_tr_b16 a[236:237], v71 offset:24776
  ds_read_b64_tr_b16 a[238:239], v71 offset:25544
  v_cvt_pk_bf16_f32 v114, v20, v21
  v_cvt_pk_bf16_f32 v115, v22, v23
  v_mfma_f32_16x16x16_bf16 v[40:43], v[72:73], a[204:205], 0
  s_add_u32 m0, s49, 49152
  s_add_u32 s50, s43, s47
  v_cvt_pk_bf16_f32 v116, v24, v25
  v_cvt_pk_bf16_f32 v117, v26, v27
  v_mfma_f32_16x16x16_bf16 v[44:47], v[74:75], a[206:207], 0
  buffer_load_dwordx4 v64, s[12:15], s50 offen offset:0 lds
  buffer_load_dwordx4 v65, s[12:15], s50 offen offset:1024 lds
  v_cvt_pk_bf16_f32 v118, v28, v29
  v_cvt_pk_bf16_f32 v119, v30, v31
  v_mfma_f32_16x16x16_bf16 v[48:51], v[72:73], a[208:209], 0
  buffer_load_dwordx4 v66, s[12:15], s50 offen offset:2048 lds
  s_add_u32 m0, s49, 52232
  v_cvt_pk_bf16_f32 v120, v32, v33
  v_cvt_pk_bf16_f32 v121, v34, v35
  v_mfma_f32_16x16x16_bf16 v[52:55], v[74:75], a[210:211], 0
  s_add_u32 s50, s50, 6144
  buffer_load_dwordx4 v64, s[12:15], s50 offen offset:0 lds
  v_cvt_pk_bf16_f32 v122, v36, v37
  v_cvt_pk_bf16_f32 v123, v38, v39
  v_mfma_f32_16x16x16_bf16 v[56:59], v[72:73], a[212:213], 0
  buffer_load_dwordx4 v65, s[12:15], s50 offen offset:1024 lds
  v_cvt_pk_bf16_f32 v124, v40, v41
  v_cvt_pk_bf16_f32 v125, v42, v43
  v_mfma_f32_16x16x16_bf16 v[60:63], v[74:75], a[214:215], 0
  buffer_load_dwordx4 v66, s[12:15], s50 offen offset:2048 lds
  v_cvt_pk_bf16_f32 v126, v44, v45
  v_cvt_pk_bf16_f32 v127, v46, v47
  s_waitcnt lgkmcnt(0)
  v_and_b32 v76, v69, v76
  v_and_b32 v77, v70, v77
  v_and_b32 v78, v69, v78
  v_and_b32 v79, v70, v79
  s_waitcnt vmcnt(12)
  ds_read_b128 v[72:75], v68 offset:256
  v_mfma_f32_16x16x16_bf16 v[16:19], v[76:77], a[216:217], 0
  ds_read_b64_tr_b16 a[192:193], v67 offset:0
  ds_read_b64_tr_b16 a[194:195], v67 offset:768
  v_cvt_pk_bf16_f32 v128, v48, v49
  v_cvt_pk_bf16_f32 v129, v50, v51
  v_mfma_f32_16x16x16_bf16 v[20:23], v[78:79], a[218:219], 0
  ds_read_b64_tr_b16 a[196:197], v67 offset:8
  ds_read_b64_tr_b16 a[198:199], v67 offset:776
  v_cvt_pk_bf16_f32 v130, v52, v53
  v_cvt_pk_bf16_f32 v131, v54, v55
  v_mfma_f32_16x16x16_bf16 v[24:27], v[76:77], a[220:221], 0
  ds_read_b64_tr_b16 a[200:201], v67 offset:64
  ds_read_b64_tr_b16 a[202:203], v67 offset:832
  v_cvt_pk_bf16_f32 v132, v56, v57
  v_cvt_pk_bf16_f32 v133, v58, v59
  v_mfma_f32_16x16x16_bf16 v[28:31], v[78:79], a[222:223], 0
  ds_read_b64_tr_b16 a[204:205], v67 offset:72
  ds_read_b64_tr_b16 a[206:207], v67 offset:840
  v_cvt_pk_bf16_f32 v134, v60, v61
  v_cvt_pk_bf16_f32 v135, v62, v63
  v_mfma_f32_16x16x16_bf16 v[32:35], v[76:77], a[224:225], 0
  ds_read_b64_tr_b16 a[208:209], v67 offset:128
  ds_read_b64_tr_b16 a[210:211], v67 offset:896
  v_cvt_pk_bf16_f32 v16, v16, v17
  v_cvt_pk_bf16_f32 v17, v18, v19
  v_accvgpr_write_b32 a24, v16
  v_accvgpr_write_b32 a25, v17
  v_mfma_f32_16x16x16_bf16 v[36:39], v[78:79], a[226:227], 0
  ds_read_b64_tr_b16 a[212:213], v67 offset:136
  ds_read_b64_tr_b16 a[214:215], v67 offset:904
  v_cvt_pk_bf16_f32 v20, v20, v21
  v_cvt_pk_bf16_f32 v21, v22, v23
  v_accvgpr_write_b32 a26, v20
  v_accvgpr_write_b32 a27, v21
  v_mfma_f32_16x16x16_bf16 v[40:43], v[76:77], a[228:229], 0
  s_add_u32 m0, s49, 73792
  s_add_u32 s50, s43, s48
  v_cvt_pk_bf16_f32 v24, v24, v25
  v_cvt_pk_bf16_f32 v25, v26, v27
  v_accvgpr_write_b32 a28, v24
  v_accvgpr_write_b32 a29, v25
  v_mfma_f32_16x16x16_bf16 v[44:47], v[78:79], a[230:231], 0
  buffer_load_dwordx4 v64, s[12:15], s50 offen offset:0 lds
  buffer_load_dwordx4 v65, s[12:15], s50 offen offset:1024 lds
  v_cvt_pk_bf16_f32 v28, v28, v29
  v_cvt_pk_bf16_f32 v29, v30, v31
  v_accvgpr_write_b32 a30, v28
  v_accvgpr_write_b32 a31, v29
  v_mfma_f32_16x16x16_bf16 v[48:51], v[76:77], a[232:233], 0
  buffer_load_dwordx4 v66, s[12:15], s50 offen offset:2048 lds
  s_add_u32 m0, s49, 76872
  v_cvt_pk_bf16_f32 v32, v32, v33
  v_cvt_pk_bf16_f32 v33, v34, v35
  v_accvgpr_write_b32 a32, v32
  v_accvgpr_write_b32 a33, v33
  v_mfma_f32_16x16x16_bf16 v[52:55], v[78:79], a[234:235], 0
  s_add_u32 s50, s50, 6144
  buffer_load_dwordx4 v64, s[12:15], s50 offen offset:0 lds
  v_cvt_pk_bf16_f32 v36, v36, v37
  v_cvt_pk_bf16_f32 v37, v38, v39
  v_accvgpr_write_b32 a34, v36
  v_accvgpr_write_b32 a35, v37
  v_mfma_f32_16x16x16_bf16 v[56:59], v[76:77], a[236:237], 0
  buffer_load_dwordx4 v65, s[12:15], s50 offen offset:1024 lds
  v_cvt_pk_bf16_f32 v40, v40, v41
  v_cvt_pk_bf16_f32 v41, v42, v43
  v_accvgpr_write_b32 a36, v40
  v_accvgpr_write_b32 a37, v41
  v_mfma_f32_16x16x16_bf16 v[60:63], v[78:79], a[238:239], 0
  buffer_load_dwordx4 v66, s[12:15], s50 offen offset:2048 lds
  v_cvt_pk_bf16_f32 v44, v44, v45
  v_cvt_pk_bf16_f32 v45, v46, v47
  v_accvgpr_write_b32 a38, v44
  v_accvgpr_write_b32 a39, v45
  s_waitcnt lgkmcnt(0)
  v_and_b32 v72, v69, v72
  v_and_b32 v73, v70, v73
  v_and_b32 v74, v69, v74
  v_and_b32 v75, v70, v75
  s_waitcnt vmcnt(12)
  ds_read_b128 v[76:79], v68 offset:320
  v_mfma_f32_16x16x16_bf16 v[16:19], v[72:73], a[192:193], 0
  ds_read_b64_tr_b16 a[216:217], v67 offset:24640
  ds_read_b64_tr_b16 a[218:219], v67 offset:25408
  v_cvt_pk_bf16_f32 v48, v48, v49
  v_cvt_pk_bf16_f32 v49, v50, v51
  v_accvgpr_write_b32 a40, v48
  v_accvgpr_write_b32 a41, v49
  v_mfma_f32_16x16x16_bf16 v[20:23], v[74:75], a[194:195], 0
  ds_read_b64_tr_b16 a[220:221], v67 offset:24648
  ds_read_b64_tr_b16 a[222:223], v67 offset:25416
  v_cvt_pk_bf16_f32 v52, v52, v53
  v_cvt_pk_bf16_f32 v53, v54, v55
  v_accvgpr_write_b32 a42, v52
  v_accvgpr_write_b32 a43, v53
  v_mfma_f32_16x16x16_bf16 v[24:27], v[72:73], a[196:197], 0
  ds_read_b64_tr_b16 a[224:225], v67 offset:24704
  ds_read_b64_tr_b16 a[226:227], v67 offset:25472
  v_cvt_pk_bf16_f32 v56, v56, v57
  v_cvt_pk_bf16_f32 v57, v58, v59
  v_accvgpr_write_b32 a44, v56
  v_accvgpr_write_b32 a45, v57
  v_mfma_f32_16x16x16_bf16 v[28:31], v[74:75], a[198:199], 0
  ds_read_b64_tr_b16 a[228:229], v67 offset:24712
  ds_read_b64_tr_b16 a[230:231], v67 offset:25480
  v_cvt_pk_bf16_f32 v60, v60, v61
  v_cvt_pk_bf16_f32 v61, v62, v63
  v_accvgpr_write_b32 a46, v60
  v_accvgpr_write_b32 a47, v61
  v_mfma_f32_16x16x16_bf16 v[32:35], v[72:73], a[200:201], 0
  ds_read_b64_tr_b16 a[232:233], v67 offset:24768
  ds_read_b64_tr_b16 a[234:235], v67 offset:25536
  v_cvt_pk_bf16_f32 v136, v16, v17
  v_cvt_pk_bf16_f32 v137, v18, v19
  v_mfma_f32_16x16x16_bf16 v[36:39], v[74:75], a[202:203], 0
  ds_read_b64_tr_b16 a[236:237], v67 offset:24776
  ds_read_b64_tr_b16 a[238:239], v67 offset:25544
  v_cvt_pk_bf16_f32 v138, v20, v21
  v_cvt_pk_bf16_f32 v139, v22, v23
  v_mfma_f32_16x16x16_bf16 v[40:43], v[72:73], a[204:205], 0
  s_add_u32 m0, s49, 98560
  s_add_u32 s50, s44, s45
  v_cvt_pk_bf16_f32 v140, v24, v25
  v_cvt_pk_bf16_f32 v141, v26, v27
  v_mfma_f32_16x16x16_bf16 v[44:47], v[74:75], a[206:207], 0
  buffer_load_dwordx4 v64, s[12:15], s50 offen offset:0 lds
  buffer_load_dwordx4 v65, s[12:15], s50 offen offset:1024 lds
  v_cvt_pk_bf16_f32 v142, v28, v29
  v_cvt_pk_bf16_f32 v143, v30, v31
  v_mfma_f32_16x16x16_bf16 v[48:51], v[72:73], a[208:209], 0
  buffer_load_dwordx4 v66, s[12:15], s50 offen offset:2048 lds
  s_add_u32 m0, s49, 101640
  v_cvt_pk_bf16_f32 v144, v32, v33
  v_cvt_pk_bf16_f32 v145, v34, v35
  v_mfma_f32_16x16x16_bf16 v[52:55], v[74:75], a[210:211], 0
  s_add_u32 s50, s50, 6144
  buffer_load_dwordx4 v64, s[12:15], s50 offen offset:0 lds
  v_cvt_pk_bf16_f32 v146, v36, v37
  v_cvt_pk_bf16_f32 v147, v38, v39
  v_mfma_f32_16x16x16_bf16 v[56:59], v[72:73], a[212:213], 0
  buffer_load_dwordx4 v65, s[12:15], s50 offen offset:1024 lds
  v_cvt_pk_bf16_f32 v148, v40, v41
  v_cvt_pk_bf16_f32 v149, v42, v43
  v_mfma_f32_16x16x16_bf16 v[60:63], v[74:75], a[214:215], 0
  buffer_load_dwordx4 v66, s[12:15], s50 offen offset:2048 lds
  v_cvt_pk_bf16_f32 v150, v44, v45
  v_cvt_pk_bf16_f32 v151, v46, v47
  s_waitcnt lgkmcnt(0)
  v_and_b32 v76, v69, v76
  v_and_b32 v77, v70, v77
  v_and_b32 v78, v69, v78
  v_and_b32 v79, v70, v79
  s_waitcnt vmcnt(12)
  ds_read_b128 v[72:75], v68 offset:384
  v_mfma_f32_16x16x16_bf16 v[16:19], v[76:77], a[216:217], 0
  ds_read_b64_tr_b16 a[192:193], v71 offset:0
  ds_read_b64_tr_b16 a[194:195], v71 offset:768
  v_cvt_pk_bf16_f32 v152, v48, v49
  v_cvt_pk_bf16_f32 v153, v50, v51
  v_mfma_f32_16x16x16_bf16 v[20:23], v[78:79], a[218:219], 0
  ds_read_b64_tr_b16 a[196:197], v71 offset:8
  ds_read_b64_tr_b16 a[198:199], v71 offset:776
  v_cvt_pk_bf16_f32 v154, v52, v53
  v_cvt_pk_bf16_f32 v155, v54, v55
  v_mfma_f32_16x16x16_bf16 v[24:27], v[76:77], a[220:221], 0
  ds_read_b64_tr_b16 a[200:201], v71 offset:64
  ds_read_b64_tr_b16 a[202:203], v71 offset:832
  v_cvt_pk_bf16_f32 v156, v56, v57
  v_cvt_pk_bf16_f32 v157, v58, v59
  v_mfma_f32_16x16x16_bf16 v[28:31], v[78:79], a[222:223], 0
  ds_read_b64_tr_b16 a[204:205], v71 offset:72
  ds_read_b64_tr_b16 a[206:207], v71 offset:840
  v_cvt_pk_bf16_f32 v158, v60, v61
  v_cvt_pk_bf16_f32 v159, v62, v63
  v_mfma_f32_16x16x16_bf16 v[32:35], v[76:77], a[224:225], 0
  ds_read_b64_tr_b16 a[208:209], v71 offset:128
  ds_read_b64_tr_b16 a[210:211], v71 offset:896
  v_cvt_pk_bf16_f32 v16, v16, v17
  v_cvt_pk_bf16_f32 v17, v18, v19
  v_accvgpr_write_b32 a48, v16
  v_accvgpr_write_b32 a49, v17
  v_mfma_f32_16x16x16_bf16 v[36:39], v[78:79], a[226:227], 0
  ds_read_b64_tr_b16 a[212:213], v71 offset:136
  ds_read_b64_tr_b16 a[214:215], v71 offset:904
  v_cvt_pk_bf16_f32 v20, v20, v21
  v_cvt_pk_bf16_f32 v21, v22, v23
  v_accvgpr_write_b32 a50, v20
  v_accvgpr_write_b32 a51, v21
  v_mfma_f32_16x16x16_bf16 v[40:43], v[76:77], a[228:229], 0
  s_add_u32 m0, s49, 123200
  s_add_u32 s50, s44, s46
  v_cvt_pk_bf16_f32 v24, v24, v25
  v_cvt_pk_bf16_f32 v25, v26, v27
  v_accvgpr_write_b32 a52, v24
  v_accvgpr_write_b32 a53, v25
  v_mfma_f32_16x16x16_bf16 v[44:47], v[78:79], a[230:231], 0
  buffer_load_dwordx4 v64, s[12:15], s50 offen offset:0 lds
  buffer_load_dwordx4 v65, s[12:15], s50 offen offset:1024 lds
  v_cvt_pk_bf16_f32 v28, v28, v29
  v_cvt_pk_bf16_f32 v29, v30, v31
  v_accvgpr_write_b32 a54, v28
  v_accvgpr_write_b32 a55, v29
  v_mfma_f32_16x16x16_bf16 v[48:51], v[76:77], a[232:233], 0
  buffer_load_dwordx4 v66, s[12:15], s50 offen offset:2048 lds
  s_add_u32 m0, s49, 126280
  v_cvt_pk_bf16_f32 v32, v32, v33
  v_cvt_pk_bf16_f32 v33, v34, v35
  v_accvgpr_write_b32 a56, v32
  v_accvgpr_write_b32 a57, v33
  v_mfma_f32_16x16x16_bf16 v[52:55], v[78:79], a[234:235], 0
  s_add_u32 s50, s50, 6144
  buffer_load_dwordx4 v64, s[12:15], s50 offen offset:0 lds
  v_cvt_pk_bf16_f32 v36, v36, v37
  v_cvt_pk_bf16_f32 v37, v38, v39
  v_accvgpr_write_b32 a58, v36
  v_accvgpr_write_b32 a59, v37
  v_mfma_f32_16x16x16_bf16 v[56:59], v[76:77], a[236:237], 0
  buffer_load_dwordx4 v65, s[12:15], s50 offen offset:1024 lds
  v_cvt_pk_bf16_f32 v40, v40, v41
  v_cvt_pk_bf16_f32 v41, v42, v43
  v_accvgpr_write_b32 a60, v40
  v_accvgpr_write_b32 a61, v41
  v_mfma_f32_16x16x16_bf16 v[60:63], v[78:79], a[238:239], 0
  buffer_load_dwordx4 v66, s[12:15], s50 offen offset:2048 lds
  v_cvt_pk_bf16_f32 v44, v44, v45
  v_cvt_pk_bf16_f32 v45, v46, v47
  v_accvgpr_write_b32 a62, v44
  v_accvgpr_write_b32 a63, v45
  s_waitcnt lgkmcnt(0)
  v_and_b32 v72, v69, v72
  v_and_b32 v73, v70, v73
  v_and_b32 v74, v69, v74
  v_and_b32 v75, v70, v75
  s_waitcnt vmcnt(12)
  ds_read_b128 v[76:79], v68 offset:448
  v_mfma_f32_16x16x16_bf16 v[16:19], v[72:73], a[192:193], 0
  ds_read_b64_tr_b16 a[216:217], v71 offset:24640
  ds_read_b64_tr_b16 a[218:219], v71 offset:25408
  v_cvt_pk_bf16_f32 v48, v48, v49
  v_cvt_pk_bf16_f32 v49, v50, v51
  v_accvgpr_write_b32 a64, v48
  v_accvgpr_write_b32 a65, v49
  v_mfma_f32_16x16x16_bf16 v[20:23], v[74:75], a[194:195], 0
  ds_read_b64_tr_b16 a[220:221], v71 offset:24648
  ds_read_b64_tr_b16 a[222:223], v71 offset:25416
  v_cvt_pk_bf16_f32 v52, v52, v53
  v_cvt_pk_bf16_f32 v53, v54, v55
  v_accvgpr_write_b32 a66, v52
  v_accvgpr_write_b32 a67, v53
  v_mfma_f32_16x16x16_bf16 v[24:27], v[72:73], a[196:197], 0
  ds_read_b64_tr_b16 a[224:225], v71 offset:24704
  ds_read_b64_tr_b16 a[226:227], v71 offset:25472
  v_cvt_pk_bf16_f32 v56, v56, v57
  v_cvt_pk_bf16_f32 v57, v58, v59
  v_accvgpr_write_b32 a68, v56
  v_accvgpr_write_b32 a69, v57
  v_mfma_f32_16x16x16_bf16 v[28:31], v[74:75], a[198:199], 0
  ds_read_b64_tr_b16 a[228:229], v71 offset:24712
  ds_read_b64_tr_b16 a[230:231], v71 offset:25480
  v_cvt_pk_bf16_f32 v60, v60, v61
  v_cvt_pk_bf16_f32 v61, v62, v63
  v_accvgpr_write_b32 a70, v60
  v_accvgpr_write_b32 a71, v61
  v_mfma_f32_16x16x16_bf16 v[32:35], v[72:73], a[200:201], 0
  ds_read_b64_tr_b16 a[232:233], v71 offset:24768
  ds_read_b64_tr_b16 a[234:235], v71 offset:25536
  v_cvt_pk_bf16_f32 v160, v16, v17
  v_cvt_pk_bf16_f32 v161, v18, v19
  v_mfma_f32_16x16x16_bf16 v[36:39], v[74:75], a[202:203], 0
  ds_read_b64_tr_b16 a[236:237], v71 offset:24776
  ds_read_b64_tr_b16 a[238:239], v71 offset:25544
  v_cvt_pk_bf16_f32 v162, v20, v21
  v_cvt_pk_bf16_f32 v163, v22, v23
  v_mfma_f32_16x16x16_bf16 v[40:43], v[72:73], a[204:205], 0
  s_add_u32 m0, s49, 49152
  s_add_u32 s50, s44, s47
  v_cvt_pk_bf16_f32 v164, v24, v25
  v_cvt_pk_bf16_f32 v165, v26, v27
  v_mfma_f32_16x16x16_bf16 v[44:47], v[74:75], a[206:207], 0
  buffer_load_dwordx4 v64, s[12:15], s50 offen offset:0 lds
  buffer_load_dwordx4 v65, s[12:15], s50 offen offset:1024 lds
  v_cvt_pk_bf16_f32 v166, v28, v29
  v_cvt_pk_bf16_f32 v167, v30, v31
  v_mfma_f32_16x16x16_bf16 v[48:51], v[72:73], a[208:209], 0
  buffer_load_dwordx4 v66, s[12:15], s50 offen offset:2048 lds
  s_add_u32 m0, s49, 52232
  v_cvt_pk_bf16_f32 v168, v32, v33
  v_cvt_pk_bf16_f32 v169, v34, v35
  v_mfma_f32_16x16x16_bf16 v[52:55], v[74:75], a[210:211], 0
  s_add_u32 s50, s50, 6144
  buffer_load_dwordx4 v64, s[12:15], s50 offen offset:0 lds
  v_cvt_pk_bf16_f32 v170, v36, v37
  v_cvt_pk_bf16_f32 v171, v38, v39
  v_mfma_f32_16x16x16_bf16 v[56:59], v[72:73], a[212:213], 0
  buffer_load_dwordx4 v65, s[12:15], s50 offen offset:1024 lds
  v_cvt_pk_bf16_f32 v172, v40, v41
  v_cvt_pk_bf16_f32 v173, v42, v43
  v_mfma_f32_16x16x16_bf16 v[60:63], v[74:75], a[214:215], 0
  buffer_load_dwordx4 v66, s[12:15], s50 offen offset:2048 lds
  v_cvt_pk_bf16_f32 v174, v44, v45
  v_cvt_pk_bf16_f32 v175, v46, v47
  s_waitcnt lgkmcnt(0)
  v_and_b32 v76, v69, v76
  v_and_b32 v77, v70, v77
  v_and_b32 v78, v69, v78
  v_and_b32 v79, v70, v79
  s_waitcnt vmcnt(12)
  ds_read_b128 v[72:75], v68 offset:512
  v_mfma_f32_16x16x16_bf16 v[16:19], v[76:77], a[216:217], 0
  ds_read_b64_tr_b16 a[192:193], v67 offset:0
  ds_read_b64_tr_b16 a[194:195], v67 offset:768
  ds_read_b64_tr_b16 a[196:197], v67 offset:8
  ds_read_b64_tr_b16 a[198:199], v67 offset:776
  ds_read_b64_tr_b16 a[200:201], v67 offset:64
  ds_read_b64_tr_b16 a[202:203], v67 offset:832
  v_cvt_pk_bf16_f32 v176, v48, v49
  v_cvt_pk_bf16_f32 v177, v50, v51
  v_mfma_f32_16x16x16_bf16 v[20:23], v[78:79], a[218:219], 0
  ds_read_b64_tr_b16 a[204:205], v67 offset:72
  ds_read_b64_tr_b16 a[206:207], v67 offset:840
  ds_read_b64_tr_b16 a[208:209], v67 offset:128
  ds_read_b64_tr_b16 a[210:211], v67 offset:896
  ds_read_b64_tr_b16 a[212:213], v67 offset:136
  ds_read_b64_tr_b16 a[214:215], v67 offset:904
  v_cvt_pk_bf16_f32 v178, v52, v53
  v_cvt_pk_bf16_f32 v179, v54, v55
  v_mfma_f32_16x16x16_bf16 v[24:27], v[76:77], a[220:221], 0
  s_add_u32 m0, s49, 73792
  s_add_u32 s50, s44, s48
  buffer_load_dwordx4 v64, s[12:15], s50 offen offset:0 lds
  buffer_load_dwordx4 v65, s[12:15], s50 offen offset:1024 lds
  buffer_load_dwordx4 v66, s[12:15], s50 offen offset:2048 lds
  s_add_u32 m0, s49, 76872
  v_cvt_pk_bf16_f32 v180, v56, v57
  v_cvt_pk_bf16_f32 v181, v58, v59
  v_mfma_f32_16x16x16_bf16 v[28:31], v[78:79], a[222:223], 0
  s_add_u32 s50, s50, 6144
  buffer_load_dwordx4 v64, s[12:15], s50 offen offset:0 lds
  buffer_load_dwordx4 v65, s[12:15], s50 offen offset:1024 lds
  buffer_load_dwordx4 v66, s[12:15], s50 offen offset:2048 lds
  s_mov_b64 s[82:83], s[80:81]
  s_mov_b64 s[80:81], s[78:79]
  v_cvt_pk_bf16_f32 v182, v60, v61
  v_cvt_pk_bf16_f32 v183, v62, v63
  v_mfma_f32_16x16x16_bf16 v[32:35], v[76:77], a[224:225], 0
  s_mov_b64 s[78:79], s[76:77]
  s_cmp_ge_u32 s32, s35
  s_cselect_b64 s[34:35], s[28:29], s[34:35]
  s_cselect_b64 s[28:29], s[30:31], s[28:29]
  s_add_u32 s76, s33, s32
  s_xor_b32 s76, s76, s34
  v_cvt_pk_bf16_f32 v16, v16, v17
  v_cvt_pk_bf16_f32 v17, v18, v19
  v_accvgpr_write_b32 a72, v16
  v_accvgpr_write_b32 a73, v17
  v_mfma_f32_16x16x16_bf16 v[36:39], v[78:79], a[226:227], 0
  s_bfe_u32 s77, s76, 65557
  s_bfe_u32 s76, s76, 65555
  s_lshl1_add_u32 s77, s76, s77
  s_sub_u32 s77, 1, s77
  s_and_b32 s77, s77, 3
  s_mul_i32 s77, s77, 24576
  v_cvt_pk_bf16_f32 v20, v20, v21
  v_cvt_pk_bf16_f32 v21, v22, v23
  v_accvgpr_write_b32 a74, v20
  v_accvgpr_write_b32 a75, v21
  v_mfma_f32_16x16x16_bf16 v[40:43], v[76:77], a[228:229], 0
  s_cmp_lt_u32 s32, s21
  s_cselect_b32 s76, s32, s40
  s_add_u32 s32, s32, 786432
  s_cmp_eq_u32 s77, 0
  s_cselect_b32 s57, 73728, s26
  s_add_u32 s22, s76, s77
  v_cvt_pk_bf16_f32 v24, v24, v25
  v_cvt_pk_bf16_f32 v25, v26, v27
  v_accvgpr_write_b32 a76, v24
  v_accvgpr_write_b32 a77, v25
  v_mfma_f32_16x16x16_bf16 v[44:47], v[78:79], a[230:231], 0
  s_add_u32 s22, s22, s57
  s_min_u32 s22, s22, s40
  s_add_u32 m0, s39, 0
  s_nop 0
  buffer_load_dwordx4 v8, s[4:7], s22 offen nt lds
  s_add_u32 m0, s39, 4096
  v_cvt_pk_bf16_f32 v28, v28, v29
  v_cvt_pk_bf16_f32 v29, v30, v31
  v_accvgpr_write_b32 a78, v28
  v_accvgpr_write_b32 a79, v29
  v_mfma_f32_16x16x16_bf16 v[48:51], v[76:77], a[232:233], 0
  s_nop 0
  buffer_load_dwordx4 v9, s[4:7], s22 offen nt lds
  v_and_b32 v15, s57, v11
  v_add3_u32 v15, v10, v15, s77
  s_add_u32 m0, s39, 8192
  s_nop 0
  v_cvt_pk_bf16_f32 v32, v32, v33
  v_cvt_pk_bf16_f32 v33, v34, v35
  v_accvgpr_write_b32 a80, v32
  v_accvgpr_write_b32 a81, v33
  v_mfma_f32_16x16x16_bf16 v[52:55], v[78:79], a[234:235], 0
  buffer_load_dwordx4 v15, s[4:7], s76 offen nt lds
  s_cmp_eq_u32 s77, 73728
  s_cselect_b32 s57, 4294893568, s27
  s_add_u32 s90, s77, 12288
  s_add_u32 s56, s76, s90
  s_add_u32 s56, s56, s57
  v_cvt_pk_bf16_f32 v36, v36, v37
  v_cvt_pk_bf16_f32 v37, v38, v39
  v_accvgpr_write_b32 a82, v36
  v_accvgpr_write_b32 a83, v37
  v_mfma_f32_16x16x16_bf16 v[56:59], v[76:77], a[236:237], 0
  s_min_u32 s56, s56, s40
  v_and_b32 v15, s57, v12
  v_add3_u32 v15, v8, v15, s90
  s_add_u32 m0, s39, 12288
  s_nop 0
  buffer_load_dwordx4 v15, s[4:7], s76 offen nt lds
  v_cvt_pk_bf16_f32 v40, v40, v41
  v_cvt_pk_bf16_f32 v41, v42, v43
  v_accvgpr_write_b32 a84, v40
  v_accvgpr_write_b32 a85, v41
  v_mfma_f32_16x16x16_bf16 v[60:63], v[78:79], a[238:239], 0
  s_add_u32 m0, s39, 16384
  s_nop 0
  buffer_load_dwordx4 v9, s[4:7], s56 offen nt lds
  s_add_u32 m0, s39, 20480
  s_nop 0
  buffer_load_dwordx4 v10, s[4:7], s56 offen nt lds
  v_cvt_pk_bf16_f32 v44, v44, v45
  v_cvt_pk_bf16_f32 v45, v46, v47
  v_accvgpr_write_b32 a86, v44
  v_accvgpr_write_b32 a87, v45
  s_waitcnt lgkmcnt(0)
  v_and_b32 v72, v69, v72
  v_and_b32 v73, v70, v73
  v_and_b32 v74, v69, v74
  v_and_b32 v75, v70, v75
  s_waitcnt vmcnt(18)
  ds_read_b128 v[76:79], v68 offset:576
  v_mfma_f32_16x16x16_bf16 v[16:19], v[72:73], a[192:193], 0
  ds_read_b64_tr_b16 a[216:217], v67 offset:24640
  ds_read_b64_tr_b16 a[218:219], v67 offset:25408
  ds_read_b64_tr_b16 a[220:221], v67 offset:24648
  ds_read_b64_tr_b16 a[222:223], v67 offset:25416
  v_cvt_pk_bf16_f32 v48, v48, v49
  v_cvt_pk_bf16_f32 v49, v50, v51
  v_accvgpr_write_b32 a88, v48
  v_accvgpr_write_b32 a89, v49
  v_mfma_f32_16x16x16_bf16 v[20:23], v[74:75], a[194:195], 0
  ds_read_b64_tr_b16 a[224:225], v67 offset:24704
  ds_read_b64_tr_b16 a[226:227], v67 offset:25472
  ds_read_b64_tr_b16 a[228:229], v67 offset:24712
  ds_read_b64_tr_b16 a[230:231], v67 offset:25480
  v_cvt_pk_bf16_f32 v52, v52, v53
  v_cvt_pk_bf16_f32 v53, v54, v55
  v_accvgpr_write_b32 a90, v52
  v_accvgpr_write_b32 a91, v53
  v_mfma_f32_16x16x16_bf16 v[24:27], v[72:73], a[196:197], 0
  ds_read_b64_tr_b16 a[232:233], v67 offset:24768
  ds_read_b64_tr_b16 a[234:235], v67 offset:25536
  ds_read_b64_tr_b16 a[236:237], v67 offset:24776
  ds_read_b64_tr_b16 a[238:239], v67 offset:25544
  v_cvt_pk_bf16_f32 v56, v56, v57
  v_cvt_pk_bf16_f32 v57, v58, v59
  v_accvgpr_write_b32 a92, v56
  v_accvgpr_write_b32 a93, v57
  v_mfma_f32_16x16x16_bf16 v[28:31], v[74:75], a[198:199], 0
  s_add_u32 s51, s32, 49152
  s_lshr_b32 s52, s51, 23
  s_sub_u32 s52, s52, 6
  s_lshr_b32 s88, s51, 24
  v_cvt_pk_bf16_f32 v60, v60, v61
  v_cvt_pk_bf16_f32 v61, v62, v63
  v_accvgpr_write_b32 a94, v60
  v_accvgpr_write_b32 a95, v61
  v_mfma_f32_16x16x16_bf16 v[32:35], v[72:73], a[200:201], 0
  s_max_i32 s88, s88, s52
  s_sub_u32 s51, s21, 737280
  s_lshr_b32 s52, s51, 23
  s_sub_u32 s52, s52, 6
  v_cvt_pk_bf16_f32 v184, v16, v17
  v_cvt_pk_bf16_f32 v185, v18, v19
  v_mfma_f32_16x16x16_bf16 v[36:39], v[74:75], a[202:203], 0
  s_lshr_b32 s95, s51, 24
  s_max_i32 s95, s95, s52
  s_add_u32 s51, s88, 1
  s_lshl_b32 s30, s51, 24
  v_cvt_pk_bf16_f32 v186, v20, v21
  v_cvt_pk_bf16_f32 v187, v22, v23
  v_mfma_f32_16x16x16_bf16 v[40:43], v[72:73], a[204:205], 0
  s_add_u32 s51, s51, 6
  s_lshl_b32 s51, s51, 23
  s_min_u32 s30, s30, s51
  v_cvt_pk_bf16_f32 v188, v24, v25
  v_cvt_pk_bf16_f32 v189, v26, v27
  v_mfma_f32_16x16x16_bf16 v[44:47], v[74:75], a[206:207], 0
  s_sub_u32 s30, s30, 49152
  s_add_u32 s51, s88, 2
  s_lshl_b32 s29, s51, 24
  v_cvt_pk_bf16_f32 v190, v28, v29
  v_cvt_pk_bf16_f32 v191, v30, v31
  v_mfma_f32_16x16x16_bf16 v[48:51], v[72:73], a[208:209], 0
  s_add_u32 s51, s51, 6
  s_lshl_b32 s51, s51, 23
  s_min_u32 s29, s29, s51
  v_cvt_pk_bf16_f32 v192, v32, v33
  v_cvt_pk_bf16_f32 v193, v34, v35
  v_mfma_f32_16x16x16_bf16 v[52:55], v[74:75], a[210:211], 0
  s_sub_u32 s29, s29, 49152
  s_add_u32 s89, s88, 1
  s_min_u32 s89, s89, s95
  v_cvt_pk_bf16_f32 v194, v36, v37
  v_cvt_pk_bf16_f32 v195, v38, v39
  v_mfma_f32_16x16x16_bf16 v[56:59], v[72:73], a[212:213], 0
  s_lshl_b32 s88, s88, 4
  s_load_dwordx4 s[44:47], s[92:93], s88
  s_lshl_b32 s89, s89, 4
  v_cvt_pk_bf16_f32 v196, v40, v41
  v_cvt_pk_bf16_f32 v197, v42, v43
  v_mfma_f32_16x16x16_bf16 v[60:63], v[74:75], a[214:215], 0
  s_load_dwordx4 s[84:87], s[92:93], s89
  s_lshl_b32 s95, s95, 4
  s_load_dwordx4 s[12:15], s[92:93], s95
  v_cvt_pk_bf16_f32 v198, v44, v45
  v_cvt_pk_bf16_f32 v199, v46, v47
  s_waitcnt lgkmcnt(0)
  v_and_b32 v76, v69, v76
  v_and_b32 v77, v70, v77
  v_and_b32 v78, v69, v78
  v_and_b32 v79, v70, v79
  s_min_u32 s51, s44, s45
  s_min_u32 s51, s51, s46
  s_min_u32 s51, s51, s47
  s_min_u32 s51, s51, s84
  s_min_u32 s51, s51, s85
  s_min_u32 s51, s51, s86
  s_min_u32 s51, s51, s87
  s_min_u32 s51, s51, s12
  s_min_u32 s51, s51, s13
  s_min_u32 s51, s51, s14
  s_min_u32 s51, s51, s15
  s_cmp_eq_u32 s51, 0
  s_cbranch_scc1 L_slow
L_back:
  s_waitcnt vmcnt(12)
  ds_read_b128 v[72:75], v68 offset:640
  v_mfma_f32_16x16x16_bf16 v[16:19], v[76:77], a[216:217], 0
  ds_read_b64_tr_b16 a[192:193], v71 offset:0
  ds_read_b64_tr_b16 a[194:195], v71 offset:768
  ds_read_b64_tr_b16 a[196:197], v71 offset:8
  ds_read_b64_tr_b16 a[198:199], v71 offset:776
  ds_read_b64_tr_b16 a[200:201], v71 offset:64
  ds_read_b64_tr_b16 a[202:203], v71 offset:832
  v_cvt_pk_bf16_f32 v200, v48, v49
  v_cvt_pk_bf16_f32 v201, v50, v51
  v_mfma_f32_16x16x16_bf16 v[20:23], v[78:79], a[218:219], 0
  ds_read_b64_tr_b16 a[204:205], v71 offset:72
  ds_read_b64_tr_b16 a[206:207], v71 offset:840
  ds_read_b64_tr_b16 a[208:209], v71 offset:128
  ds_read_b64_tr_b16 a[210:211], v71 offset:896
  ds_read_b64_tr_b16 a[212:213], v71 offset:136
  v_cvt_pk_bf16_f32 v202, v52, v53
  v_cvt_pk_bf16_f32 v203, v54, v55
  v_mfma_f32_16x16x16_bf16 v[24:27], v[76:77], a[220:221], 0
  ds_read_b64_tr_b16 a[214:215], v71 offset:904
  s_mov_b32 s35, s30
  s_mov_b32 s31, -1
  s_and_b32 s50, s2, 5
  s_lshl_b32 s50, s50, 19
  v_cvt_pk_bf16_f32 v204, v56, v57
  v_cvt_pk_bf16_f32 v205, v58, v59
  v_mfma_f32_16x16x16_bf16 v[28:31], v[78:79], a[222:223], 0
  s_min_u32 s51, s44, s46
  s_min_u32 s52, s45, s47
  s_cmp_gt_u32 s51, s52
  s_cselect_b32 s51, 4, 0
  s_xor_b32 s51, s51, s44
  v_cvt_pk_bf16_f32 v206, v60, v61
  v_cvt_pk_bf16_f32 v207, v62, v63
  v_mfma_f32_16x16x16_bf16 v[32:35], v[76:77], a[224:225], 0
  s_and_b32 s51, s51, 4
  s_lshl_b32 s51, s51, 17
  s_bitcmp1_b32 s2, 1
  s_cselect_b64 s[44:45], s[46:47], s[44:45]
  s_bitcmp1_b32 s2, 0
  v_cvt_pk_bf16_f32 v16, v16, v17
  v_cvt_pk_bf16_f32 v17, v18, v19
  v_accvgpr_write_b32 a96, v16
  v_accvgpr_write_b32 a97, v17
  v_mfma_f32_16x16x16_bf16 v[36:39], v[78:79], a[226:227], 0
  s_cselect_b32 s34, s45, s44
  s_and_b32 s34, s34, 2
  s_lshl_b32 s34, s34, 20
  s_or_b32 s34, s34, s51
  s_xor_b32 s34, s34, s50
  v_cvt_pk_bf16_f32 v20, v20, v21
  v_cvt_pk_bf16_f32 v21, v22, v23
  v_accvgpr_write_b32 a98, v20
  v_accvgpr_write_b32 a99, v21
  v_mfma_f32_16x16x16_bf16 v[40:43], v[76:77], a[228:229], 0
  s_min_u32 s51, s84, s86
  s_min_u32 s52, s85, s87
  s_cmp_gt_u32 s51, s52
  s_cselect_b32 s51, 4, 0
  s_xor_b32 s51, s51, s84
  v_cvt_pk_bf16_f32 v24, v24, v25
  v_cvt_pk_bf16_f32 v25, v26, v27
  v_accvgpr_write_b32 a100, v24
  v_accvgpr_write_b32 a101, v25
  v_mfma_f32_16x16x16_bf16 v[44:47], v[78:79], a[230:231], 0
  s_and_b32 s51, s51, 4
  s_lshl_b32 s51, s51, 17
  s_bitcmp1_b32 s2, 1
  s_cselect_b64 s[84:85], s[86:87], s[84:85]
  s_bitcmp1_b32 s2, 0
  v_cvt_pk_bf16_f32 v28, v28, v29
  v_cvt_pk_bf16_f32 v29, v30, v31
  v_accvgpr_write_b32 a102, v28
  v_accvgpr_write_b32 a103, v29
  v_mfma_f32_16x16x16_bf16 v[48:51], v[76:77], a[232:233], 0
  s_cselect_b32 s28, s85, s84
  s_and_b32 s28, s28, 2
  s_lshl_b32 s28, s28, 20
  s_or_b32 s28, s28, s51
  s_xor_b32 s28, s28, s50
  v_cvt_pk_bf16_f32 v32, v32, v33
  v_cvt_pk_bf16_f32 v33, v34, v35
  v_accvgpr_write_b32 a104, v32
  v_accvgpr_write_b32 a105, v33
  v_mfma_f32_16x16x16_bf16 v[52:55], v[78:79], a[234:235], 0
  s_min_u32 s51, s12, s14
  s_min_u32 s52, s13, s15
  s_cmp_gt_u32 s51, s52
  s_cselect_b32 s51, 4, 0
  s_xor_b32 s51, s51, s12
  v_cvt_pk_bf16_f32 v36, v36, v37
  v_cvt_pk_bf16_f32 v37, v38, v39
  v_accvgpr_write_b32 a106, v36
  v_accvgpr_write_b32 a107, v37
  v_mfma_f32_16x16x16_bf16 v[56:59], v[76:77], a[236:237], 0
  s_and_b32 s51, s51, 4
  s_lshl_b32 s51, s51, 17
  s_bitcmp1_b32 s2, 1
  s_cselect_b64 s[12:13], s[14:15], s[12:13]
  s_bitcmp1_b32 s2, 0
  v_cvt_pk_bf16_f32 v40, v40, v41
  v_cvt_pk_bf16_f32 v41, v42, v43
  v_accvgpr_write_b32 a108, v40
  v_accvgpr_write_b32 a109, v41
  v_mfma_f32_16x16x16_bf16 v[60:63], v[78:79], a[238:239], 0
  s_cselect_b32 s30, s13, s12
  s_and_b32 s30, s30, 2
  s_lshl_b32 s30, s30, 20
  s_or_b32 s30, s30, s51
  s_xor_b32 s30, s30, s50
  v_cvt_pk_bf16_f32 v44, v44, v45
  v_cvt_pk_bf16_f32 v45, v46, v47
  v_accvgpr_write_b32 a110, v44
  v_accvgpr_write_b32 a111, v45
  s_waitcnt lgkmcnt(0)
  v_and_b32 v72, v69, v72
  v_and_b32 v73, v70, v73
  v_and_b32 v74, v69, v74
  v_and_b32 v75, v70, v75
  s_waitcnt vmcnt(6)
  ds_read_b128 v[76:79], v68 offset:704
  v_mfma_f32_16x16x16_bf16 v[16:19], v[72:73], a[192:193], 0
  ds_read_b64_tr_b16 a[216:217], v71 offset:24640
  v_cvt_pk_bf16_f32 v48, v48, v49
  v_cvt_pk_bf16_f32 v49, v50, v51
  v_accvgpr_write_b32 a112, v48
  v_accvgpr_write_b32 a113, v49
  v_mfma_f32_16x16x16_bf16 v[20:23], v[74:75], a[194:195], 0
  ds_read_b64_tr_b16 a[218:219], v71 offset:25408
  v_cvt_pk_bf16_f32 v52, v52, v53
  v_cvt_pk_bf16_f32 v53, v54, v55
  v_accvgpr_write_b32 a114, v52
  v_accvgpr_write_b32 a115, v53
  v_mfma_f32_16x16x16_bf16 v[24:27], v[72:73], a[196:197], 0
  ds_read_b64_tr_b16 a[220:221], v71 offset:24648
  v_cvt_pk_bf16_f32 v56, v56, v57
  v_cvt_pk_bf16_f32 v57, v58, v59
  v_accvgpr_write_b32 a116, v56
  v_accvgpr_write_b32 a117, v57
  v_mfma_f32_16x16x16_bf16 v[28:31], v[74:75], a[198:199], 0
  ds_read_b64_tr_b16 a[222:223], v71 offset:25416
  v_cvt_pk_bf16_f32 v60, v60, v61
  v_cvt_pk_bf16_f32 v61, v62, v63
  v_accvgpr_write_b32 a118, v60
  v_accvgpr_write_b32 a119, v61
  v_mfma_f32_16x16x16_bf16 v[32:35], v[72:73], a[200:201], 0
  ds_read_b64_tr_b16 a[224:225], v71 offset:24704
  v_cvt_pk_bf16_f32 v208, v16, v17
  v_cvt_pk_bf16_f32 v209, v18, v19
  v_mfma_f32_16x16x16_bf16 v[36:39], v[74:75], a[202:203], 0
  ds_read_b64_tr_b16 a[226:227], v71 offset:25472
  v_cvt_pk_bf16_f32 v210, v20, v21
  v_cvt_pk_bf16_f32 v211, v22, v23
  v_mfma_f32_16x16x16_bf16 v[40:43], v[72:73], a[204:205], 0
  ds_read_b64_tr_b16 a[228:229], v71 offset:24712
  v_cvt_pk_bf16_f32 v212, v24, v25
  v_cvt_pk_bf16_f32 v213, v26, v27
  v_mfma_f32_16x16x16_bf16 v[44:47], v[74:75], a[206:207], 0
  ds_read_b64_tr_b16 a[230:231], v71 offset:25480
  v_cvt_pk_bf16_f32 v214, v28, v29
  v_cvt_pk_bf16_f32 v215, v30, v31
  v_mfma_f32_16x16x16_bf16 v[48:51], v[72:73], a[208:209], 0
  ds_read_b64_tr_b16 a[232:233], v71 offset:24768
  v_cvt_pk_bf16_f32 v216, v32, v33
  v_cvt_pk_bf16_f32 v217, v34, v35
  v_mfma_f32_16x16x16_bf16 v[52:55], v[74:75], a[210:211], 0
  ds_read_b64_tr_b16 a[234:235], v71 offset:25536
  v_cvt_pk_bf16_f32 v218, v36, v37
  v_cvt_pk_bf16_f32 v219, v38, v39
  v_mfma_f32_16x16x16_bf16 v[56:59], v[72:73], a[212:213], 0
  ds_read_b64_tr_b16 a[236:237], v71 offset:24776
  v_cvt_pk_bf16_f32 v220, v40, v41
  v_cvt_pk_bf16_f32 v221, v42, v43
  v_mfma_f32_16x16x16_bf16 v[60:63], v[74:75], a[214:215], 0
  ds_read_b64_tr_b16 a[238:239], v71 offset:25544
  v_cvt_pk_bf16_f32 v222, v44, v45
  v_cvt_pk_bf16_f32 v223, v46, v47
  s_waitcnt lgkmcnt(0)
  v_and_b32 v76, v69, v76
  v_and_b32 v77, v70, v77
  v_and_b32 v78, v69, v78
  v_and_b32 v79, v70, v79
  s_mov_b64 s[82:83], s[80:81]
  s_mov_b64 s[80:81], s[78:79]
  v_mfma_f32_16x16x16_bf16 v[16:19], v[76:77], a[216:217], 0
  s_mov_b64 s[78:79], s[76:77]
  s_cmp_ge_u32 s32, s35
  s_cselect_b64 s[34:35], s[28:29], s[34:35]
  s_cselect_b64 s[28:29], s[30:31], s[28:29]
  v_cvt_pk_bf16_f32 v224, v48, v49
  v_cvt_pk_bf16_f32 v225, v50, v51
  v_mfma_f32_16x16x16_bf16 v[20:23], v[78:79], a[218:219], 0
  s_add_u32 s76, s33, s32
  s_xor_b32 s76, s76, s34
  s_bfe_u32 s77, s76, 65557
  s_bfe_u32 s76, s76, 65555
  v_cvt_pk_bf16_f32 v226, v52, v53
  v_cvt_pk_bf16_f32 v227, v54, v55
  v_mfma_f32_16x16x16_bf16 v[24:27], v[76:77], a[220:221], 0
  s_lshl1_add_u32 s77, s76, s77
  s_sub_u32 s77, 1, s77
  s_and_b32 s77, s77, 3
  s_mul_i32 s77, s77, 24576
  v_cvt_pk_bf16_f32 v228, v56, v57
  v_cvt_pk_bf16_f32 v229, v58, v59
  v_mfma_f32_16x16x16_bf16 v[28:31], v[78:79], a[222:223], 0
  s_cmp_lt_u32 s32, s21
  s_cselect_b32 s76, s32, s40
  s_add_u32 s32, s32, 786432
  s_cmp_eq_u32 s77, 0
  v_cvt_pk_bf16_f32 v230, v60, v61
  v_cvt_pk_bf16_f32 v231, v62, v63
  v_mfma_f32_16x16x16_bf16 v[32:35], v[76:77], a[224:225], 0
  s_cselect_b32 s57, 73728, s26
  s_add_u32 s22, s76, s77
  s_add_u32 s22, s22, s57
  s_min_u32 s22, s22, s40
  v_cvt_pk_bf16_f32 v232, v16, v17
  v_cvt_pk_bf16_f32 v233, v18, v19
  v_mfma_f32_16x16x16_bf16 v[36:39], v[78:79], a[226:227], 0
  s_add_u32 m0, s39, 24576
  s_nop 0
  buffer_load_dwordx4 v8, s[4:7], s22 offen nt lds
  s_add_u32 m0, s39, 28672
  v_cvt_pk_bf16_f32 v234, v20, v21
  v_cvt_pk_bf16_f32 v235, v22, v23
  v_mfma_f32_16x16x16_bf16 v[40:43], v[76:77], a[228:229], 0
  s_nop 0
  buffer_load_dwordx4 v9, s[4:7], s22 offen nt lds
  v_and_b32 v15, s57, v11
  v_add3_u32 v15, v10, v15, s77
  v_cvt_pk_bf16_f32 v236, v24, v25
  v_cvt_pk_bf16_f32 v237, v26, v27
  v_mfma_f32_16x16x16_bf16 v[44:47], v[78:79], a[230:231], 0
  s_add_u32 m0, s39, 32768
  s_nop 0
  buffer_load_dwordx4 v15, s[4:7], s76 offen nt lds
  s_cmp_eq_u32 s77, 73728
  v_cvt_pk_bf16_f32 v238, v28, v29
  v_cvt_pk_bf16_f32 v239, v30, v31
  v_mfma_f32_16x16x16_bf16 v[48:51], v[76:77], a[232:233], 0
  s_cselect_b32 s57, 4294893568, s27
  s_add_u32 s90, s77, 12288
  s_add_u32 s56, s76, s90
  s_add_u32 s56, s56, s57
  v_cvt_pk_bf16_f32 v240, v32, v33
  v_cvt_pk_bf16_f32 v241, v34, v35
  v_mfma_f32_16x16x16_bf16 v[52:55], v[78:79], a[234:235], 0
  s_min_u32 s56, s56, s40
  v_and_b32 v15, s57, v12
  v_add3_u32 v15, v8, v15, s90
  s_add_u32 m0, s39, 36864
  v_cvt_pk_bf16_f32 v242, v36, v37
  v_cvt_pk_bf16_f32 v243, v38, v39
  v_mfma_f32_16x16x16_bf16 v[56:59], v[76:77], a[236:237], 0
  s_nop 0
  buffer_load_dwordx4 v15, s[4:7], s76 offen nt lds
  s_add_u32 m0, s39, 40960
  s_nop 0
  v_cvt_pk_bf16_f32 v244, v40, v41
  v_cvt_pk_bf16_f32 v245, v42, v43
  v_mfma_f32_16x16x16_bf16 v[60:63], v[78:79], a[238:239], 0
  buffer_load_dwordx4 v9, s[4:7], s56 offen nt lds
  s_add_u32 m0, s39, 45056
  s_xor_b32 s39, s39, 49152
  buffer_load_dwordx4 v10, s[4:7], s56 offen nt lds
  v_cvt_pk_bf16_f32 v246, v44, v45
  v_cvt_pk_bf16_f32 v247, v46, v47
  v_cvt_pk_bf16_f32 v248, v48, v49
  v_cvt_pk_bf16_f32 v249, v50, v51
  v_cvt_pk_bf16_f32 v250, v52, v53
  v_cvt_pk_bf16_f32 v251, v54, v55
  v_mov_b32 v13, 0
  v_mov_b32 v14, 0
  s_mov_b32 s58, s40
  s_mov_b32 s59, s40
  s_mov_b32 s62, s40
  s_mov_b32 s63, s40
  s_waitcnt vmcnt(6)
  s_barrier
  ds_read_b128 a[144:147], v1 offset:0
  ds_read_b128 a[148:151], v2 offset:0
  ds_read_b128 a[152:155], v3 offset:0
  ds_read_b128 a[156:159], v4 offset:0
  v_cvt_pk_bf16_f32 v252, v56, v57
  v_cvt_pk_bf16_f32 v253, v58, v59
  v_cvt_pk_bf16_f32 v254, v60, v61
  v_cvt_pk_bf16_f32 v255, v62, v63
L_loop:
  s_waitcnt lgkmcnt(2)
  v_mfma_f32_16x16x32_bf16 v[16:19], v[88:91], a[144:147], 0
  ds_read_b128 a[160:163], v1 offset:256
  v_mfma_f32_16x16x32_bf16 v[16:19], a[0:3], a[148:151], v[16:19]
  ds_read_b128 a[164:167], v2 offset:256
  v_mfma_f32_16x16x32_bf16 v[20:23], v[92:95], a[144:147], 0
  v_mfma_f32_16x16x32_bf16 v[20:23], a[4:7], a[148:151], v[20:23]
  v_cvt_pk_bf16_f32 v40, v40, v41
  v_mfma_f32_16x16x32_bf16 v[24:27], v[96:99], a[144:147], 0
  v_cvt_pk_bf16_f32 v41, v42, v43
  v_mfma_f32_16x16x32_bf16 v[24:27], a[8:11], a[148:151], v[24:27]
  v_cvt_pk_bf16_f32 v42, v44, v45
  v_mfma_f32_16x16x32_bf16 v[28:31], v[100:103], a[144:147], 0
  buffer_store_dwordx4 a[188:191], v82, s[8:11], s63 offen sc1
  v_mfma_f32_16x16x32_bf16 v[28:31], a[12:15], a[148:151], v[28:31]
  v_cvt_pk_bf16_f32 v43, v46, v47
  v_mfma_f32_16x16x32_bf16 v[32:35], v[104:107], a[144:147], 0
  ds_write_b128 v86, v[40:43] offset:12288
  v_mfma_f32_16x16x32_bf16 v[32:35], a[16:19], a[148:151], v[32:35]
  v_mfma_f32_16x16x32_bf16 v[36:39], v[108:111], a[144:147], 0
  v_mfma_f32_16x16x32_bf16 v[36:39], a[20:23], a[148:151], v[36:39]
  s_waitcnt lgkmcnt(3)
  v_mfma_f32_16x16x32_bf16 v[16:19], v[112:115], a[152:155], v[16:19]
  ds_read_b128 a[144:147], v3 offset:256
  v_mfma_f32_16x16x32_bf16 v[16:19], a[24:27], a[156:159], v[16:19]
  ds_read_b128 a[148:151], v4 offset:256
  v_mfma_f32_16x16x32_bf16 v[20:23], v[116:119], a[152:155], v[20:23]
  v_mfma_f32_16x16x32_bf16 v[20:23], a[28:31], a[156:159], v[20:23]
  v_cvt_pk_bf16_f32 v48, v48, v49
  v_mfma_f32_16x16x32_bf16 v[24:27], v[120:123], a[152:155], v[24:27]
  buffer_store_dwordx4 a[168:171], v80, s[8:11], s58 offen sc1
  v_mfma_f32_16x16x32_bf16 v[24:27], a[32:35], a[156:159], v[24:27]
  v_cvt_pk_bf16_f32 v49, v50, v51
  v_mfma_f32_16x16x32_bf16 v[28:31], v[124:127], a[152:155], v[28:31]
  v_cvt_pk_bf16_f32 v50, v52, v53
  v_mfma_f32_16x16x32_bf16 v[28:31], a[36:39], a[156:159], v[28:31]
  v_cvt_pk_bf16_f32 v51, v54, v55
  v_mfma_f32_16x16x32_bf16 v[32:35], v[128:131], a[152:155], v[32:35]
  ds_write_b128 v87, v[48:51] offset:12288
  v_mfma_f32_16x16x32_bf16 v[32:35], a[40:43], a[156:159], v[32:35]
  v_mfma_f32_16x16x32_bf16 v[36:39], v[132:135], a[152:155], v[36:39]
  v_mfma_f32_16x16x32_bf16 v[36:39], a[44:47], a[156:159], v[36:39]
  s_waitcnt lgkmcnt(4)
  v_mfma_f32_16x16x32_bf16 v[16:19], v[136:139], a[160:163], v[16:19]
  ds_read_b128 a[152:155], v1 offset:512
  v_mfma_f32_16x16x32_bf16 v[16:19], a[48:51], a[164:167], v[16:19]
  ds_read_b128 a[156:159], v2 offset:512
  v_mfma_f32_16x16x32_bf16 v[20:23], v[140:143], a[160:163], v[20:23]
  v_mfma_f32_16x16x32_bf16 v[20:23], a[52:55], a[164:167], v[20:23]
  v_mfma_f32_16x16x32_bf16 v[24:27], v[144:147], a[160:163], v[24:27]
  buffer_store_dwordx4 a[172:175], v81, s[8:11], s58 offen sc1
  v_mfma_f32_16x16x32_bf16 v[24:27], a[56:59], a[164:167], v[24:27]
  v_mfma_f32_16x16x32_bf16 v[28:31], v[148:151], a[160:163], v[28:31]
  v_mfma_f32_16x16x32_bf16 v[28:31], a[60:63], a[164:167], v[28:31]
  v_mfma_f32_16x16x32_bf16 v[32:35], v[152:155], a[160:163], v[32:35]
  v_mfma_f32_16x16x32_bf16 v[32:35], a[64:67], a[164:167], v[32:35]
  s_mov_b64 s[82:83], s[80:81]
  v_mfma_f32_16x16x32_bf16 v[36:39], v[156:159], a[160:163], v[36:39]
  s_mov_b64 s[80:81], s[78:79]
  s_mov_b64 s[78:79], s[76:77]
  v_mfma_f32_16x16x32_bf16 v[36:39], a[68:71], a[164:167], v[36:39]
  s_cmp_ge_u32 s32, s35
  s_waitcnt lgkmcnt(3)
  v_mfma_f32_16x16x32_bf16 v[16:19], v[160:163], a[144:147], v[16:19]
  ds_read_b128 a[160:163], v3 offset:512
  s_cselect_b64 s[34:35], s[28:29], s[34:35]
  v_mfma_f32_16x16x32_bf16 v[16:19], a[72:75], a[148:151], v[16:19]
  ds_read_b128 a[164:167], v4 offset:512
  s_cselect_b64 s[28:29], s[30:31], s[28:29]
  v_mfma_f32_16x16x32_bf16 v[20:23], v[164:167], a[144:147], v[20:23]
  s_add_u32 s76, s33, s32
  v_cvt_pk_bf16_f32 v56, v56, v57
  v_mfma_f32_16x16x32_bf16 v[20:23], a[76:79], a[148:151], v[20:23]
  s_xor_b32 s76, s76, s34
  v_cvt_pk_bf16_f32 v57, v58, v59
  v_mfma_f32_16x16x32_bf16 v[24:27], v[168:171], a[144:147], v[24:27]
  buffer_store_dwordx4 a[176:179], v13, s[8:11], s59 offen sc1
  v_mfma_f32_16x16x32_bf16 v[24:27], a[80:83], a[148:151], v[24:27]
  s_bfe_u32 s77, s76, 65557
  v_cvt_pk_bf16_f32 v58, v60, v61
  v_mfma_f32_16x16x32_bf16 v[28:31], v[172:175], a[144:147], v[28:31]
  s_bfe_u32 s76, s76, 65555
  v_cvt_pk_bf16_f32 v59, v62, v63
  v_mfma_f32_16x16x32_bf16 v[28:31], a[84:87], a[148:151], v[28:31]
  ds_write_b128 v86, v[56:59] offset:12416
  v_mfma_f32_16x16x32_bf16 v[32:35], v[176:179], a[144:147], v[32:35]
  s_lshl1_add_u32 s77, s76, s77
  s_sub_u32 s77, 1, s77
  v_mfma_f32_16x16x32_bf16 v[32:35], a[88:91], a[148:151], v[32:35]
  s_and_b32 s77, s77, 3
  s_mul_i32 s77, s77, 24576
  v_mfma_f32_16x16x32_bf16 v[36:39], v[180:183], a[144:147], v[36:39]
  s_cmp_lt_u32 s32, s21
  s_cselect_b32 s76, s32, s40
  v_mfma_f32_16x16x32_bf16 v[36:39], a[92:95], a[148:151], v[36:39]
  s_add_u32 s32, s32, 786432
  s_waitcnt lgkmcnt(3)
  v_mfma_f32_16x16x32_bf16 v[16:19], v[184:187], a[152:155], v[16:19]
  ds_read_b128 a[144:147], v1 offset:12288
  s_cmp_eq_u32 s77, 0
  v_mfma_f32_16x16x32_bf16 v[16:19], a[96:99], a[156:159], v[16:19]
  ds_read_b128 a[148:151], v2 offset:12288
  s_cselect_b32 s57, 73728, s26
  v_mfma_f32_16x16x32_bf16 v[20:23], v[188:191], a[152:155], v[20:23]
  s_add_u32 s22, s76, s77
  s_add_u32 s22, s22, s57
  v_mfma_f32_16x16x32_bf16 v[20:23], a[100:103], a[156:159], v[20:23]
  s_min_u32 s22, s22, s40
  s_add_u32 m0, s39, 0
  v_mfma_f32_16x16x32_bf16 v[24:27], v[192:195], a[152:155], v[24:27]
  buffer_load_dwordx4 v8, s[4:7], s22 offen nt lds
  v_mfma_f32_16x16x32_bf16 v[24:27], a[104:107], a[156:159], v[24:27]
  s_cmp_eq_u32 s81, 0
  s_cselect_b32 s91, 73728, s26
  v_mfma_f32_16x16x32_bf16 v[28:31], v[196:199], a[152:155], v[28:31]
  s_add_u32 s58, s80, s81
  s_add_u32 s58, s58, s91
  v_mfma_f32_16x16x32_bf16 v[28:31], a[108:111], a[156:159], v[28:31]
  s_min_u32 s58, s58, s40
  s_mov_b32 s59, s80
  v_mfma_f32_16x16x32_bf16 v[32:35], v[200:203], a[152:155], v[32:35]
  v_and_b32 v13, s91, v11
  v_add3_u32 v13, v82, v13, s81
  v_mfma_f32_16x16x32_bf16 v[32:35], a[112:115], a[156:159], v[32:35]
  s_cmp_eq_u32 s83, 73728
  s_cselect_b32 s91, 4294893568, s27
  v_mfma_f32_16x16x32_bf16 v[36:39], v[204:207], a[152:155], v[36:39]
  s_add_u32 s62, s83, 12288
  s_add_u32 s63, s82, s62
  v_mfma_f32_16x16x32_bf16 v[36:39], a[116:119], a[156:159], v[36:39]
  s_add_u32 s63, s63, s91
  s_waitcnt lgkmcnt(3)
  v_mfma_f32_16x16x32_bf16 v[16:19], v[208:211], a[160:163], v[16:19]
  ds_read_b128 a[152:155], v3 offset:12288
  s_min_u32 s63, s63, s40
  v_mfma_f32_16x16x32_bf16 v[16:19], v[232:235], a[164:167], v[16:19]
  ds_read_b128 a[156:159], v4 offset:12288
  v_and_b32 v14, s91, v12
  v_mfma_f32_16x16x32_bf16 v[20:23], v[212:215], a[160:163], v[20:23]
  v_add3_u32 v14, v80, v14, s62
  s_mov_b32 s62, s82
  v_mfma_f32_16x16x32_bf16 v[20:23], v[236:239], a[164:167], v[20:23]
  s_add_u32 m0, s39, 4096
  v_mfma_f32_16x16x32_bf16 v[24:27], v[216:219], a[160:163], v[24:27]
  buffer_load_dwordx4 v9, s[4:7], s22 offen nt lds
  v_mfma_f32_16x16x32_bf16 v[24:27], v[240:243], a[164:167], v[24:27]
  v_mfma_f32_16x16x32_bf16 v[28:31], v[220:223], a[160:163], v[28:31]
  v_mfma_f32_16x16x32_bf16 v[28:31], v[244:247], a[164:167], v[28:31]
  v_mfma_f32_16x16x32_bf16 v[32:35], v[224:227], a[160:163], v[32:35]
  v_mfma_f32_16x16x32_bf16 v[32:35], v[248:251], a[164:167], v[32:35]
  v_and_b32 v15, s57, v11
  v_mfma_f32_16x16x32_bf16 v[36:39], v[228:231], a[160:163], v[36:39]
  v_add3_u32 v15, v10, v15, s77
  v_mfma_f32_16x16x32_bf16 v[36:39], v[252:255], a[164:167], v[36:39]
  s_waitcnt lgkmcnt(2)
  v_mfma_f32_16x16x32_bf16 v[40:43], v[88:91], a[144:147], 0
  ds_read_b128 a[160:163], v1 offset:12544
  v_mfma_f32_16x16x32_bf16 v[40:43], a[0:3], a[148:151], v[40:43]
  ds_read_b128 a[164:167], v2 offset:12544
  v_mfma_f32_16x16x32_bf16 v[44:47], v[92:95], a[144:147], 0
  s_add_u32 m0, s39, 8192
  v_mfma_f32_16x16x32_bf16 v[44:47], a[4:7], a[148:151], v[44:47]
  v_cvt_pk_bf16_f32 v16, v16, v17
  v_mfma_f32_16x16x32_bf16 v[48:51], v[96:99], a[144:147], 0
  buffer_load_dwordx4 v15, s[4:7], s76 offen nt lds
  v_mfma_f32_16x16x32_bf16 v[48:51], a[8:11], a[148:151], v[48:51]
  v_cvt_pk_bf16_f32 v17, v18, v19
  v_mfma_f32_16x16x32_bf16 v[52:55], v[100:103], a[144:147], 0
  v_cvt_pk_bf16_f32 v18, v20, v21
  v_mfma_f32_16x16x32_bf16 v[52:55], a[12:15], a[148:151], v[52:55]
  s_cmp_eq_u32 s77, 73728
  v_cvt_pk_bf16_f32 v19, v22, v23
  v_mfma_f32_16x16x32_bf16 v[56:59], v[104:107], a[144:147], 0
  ds_write_b128 v86, v[16:19] offset:0
  v_mfma_f32_16x16x32_bf16 v[56:59], a[16:19], a[148:151], v[56:59]
  s_cselect_b32 s57, 4294893568, s27
  s_add_u32 s90, s77, 12288
  v_mfma_f32_16x16x32_bf16 v[60:63], v[108:111], a[144:147], 0
  s_add_u32 s56, s76, s90
  v_cvt_pk_bf16_f32 v24, v24, v25
  v_mfma_f32_16x16x32_bf16 v[60:63], a[20:23], a[148:151], v[60:63]
  s_add_u32 s56, s56, s57
  s_waitcnt lgkmcnt(3)
  v_mfma_f32_16x16x32_bf16 v[40:43], v[112:115], a[152:155], v[40:43]
  ds_read_b128 a[144:147], v3 offset:12544
  s_min_u32 s56, s56, s40
  v_mfma_f32_16x16x32_bf16 v[40:43], a[24:27], a[156:159], v[40:43]
  ds_read_b128 a[148:151], v4 offset:12544
  v_and_b32 v15, s57, v12
  v_mfma_f32_16x16x32_bf16 v[44:47], v[116:119], a[152:155], v[44:47]
  v_add3_u32 v15, v8, v15, s90
  v_cvt_pk_bf16_f32 v25, v26, v27
  v_mfma_f32_16x16x32_bf16 v[44:47], a[28:31], a[156:159], v[44:47]
  s_add_u32 m0, s39, 12288
  v_cvt_pk_bf16_f32 v26, v28, v29
  v_mfma_f32_16x16x32_bf16 v[48:51], v[120:123], a[152:155], v[48:51]
  buffer_load_dwordx4 v15, s[4:7], s76 offen nt lds
  v_mfma_f32_16x16x32_bf16 v[48:51], a[32:35], a[156:159], v[48:51]
  v_cvt_pk_bf16_f32 v27, v30, v31
  v_mfma_f32_16x16x32_bf16 v[52:55], v[124:127], a[152:155], v[52:55]
  ds_write_b128 v87, v[24:27] offset:0
  v_mfma_f32_16x16x32_bf16 v[52:55], a[36:39], a[156:159], v[52:55]
  v_mfma_f32_16x16x32_bf16 v[56:59], v[128:131], a[152:155], v[56:59]
  v_mfma_f32_16x16x32_bf16 v[56:59], a[40:43], a[156:159], v[56:59]
  v_mfma_f32_16x16x32_bf16 v[60:63], v[132:135], a[152:155], v[60:63]
  v_mfma_f32_16x16x32_bf16 v[60:63], a[44:47], a[156:159], v[60:63]
  s_waitcnt lgkmcnt(4)
  v_mfma_f32_16x16x32_bf16 v[40:43], v[136:139], a[160:163], v[40:43]
  ds_read_b128 a[152:155], v1 offset:12800
  v_mfma_f32_16x16x32_bf16 v[40:43], a[48:51], a[164:167], v[40:43]
  ds_read_b128 a[156:159], v2 offset:12800
  v_mfma_f32_16x16x32_bf16 v[44:47], v[140:143], a[160:163], v[44:47]
  s_add_u32 m0, s39, 16384
  v_mfma_f32_16x16x32_bf16 v[44:47], a[52:55], a[164:167], v[44:47]
  v_cvt_pk_bf16_f32 v32, v32, v33
  v_mfma_f32_16x16x32_bf16 v[48:51], v[144:147], a[160:163], v[48:51]
  buffer_load_dwordx4 v9, s[4:7], s56 offen nt lds
  v_mfma_f32_16x16x32_bf16 v[48:51], a[56:59], a[164:167], v[48:51]
  v_cvt_pk_bf16_f32 v33, v34, v35
  v_mfma_f32_16x16x32_bf16 v[52:55], v[148:151], a[160:163], v[52:55]
  v_cvt_pk_bf16_f32 v34, v36, v37
  v_mfma_f32_16x16x32_bf16 v[52:55], a[60:63], a[164:167], v[52:55]
  v_cvt_pk_bf16_f32 v35, v38, v39
  v_mfma_f32_16x16x32_bf16 v[56:59], v[152:155], a[160:163], v[56:59]
  ds_write_b128 v86, v[32:35] offset:128
  v_mfma_f32_16x16x32_bf16 v[56:59], a[64:67], a[164:167], v[56:59]
  v_mfma_f32_16x16x32_bf16 v[60:63], v[156:159], a[160:163], v[60:63]
  v_mfma_f32_16x16x32_bf16 v[60:63], a[68:71], a[164:167], v[60:63]
  s_waitcnt lgkmcnt(4)
  v_mfma_f32_16x16x32_bf16 v[40:43], v[160:163], a[144:147], v[40:43]
  ds_read_b128 a[160:163], v3 offset:12800
  v_mfma_f32_16x16x32_bf16 v[40:43], a[72:75], a[148:151], v[40:43]
  ds_read_b128 a[164:167], v4 offset:12800
  v_mfma_f32_16x16x32_bf16 v[44:47], v[164:167], a[144:147], v[44:47]
  v_mfma_f32_16x16x32_bf16 v[44:47], a[76:79], a[148:151], v[44:47]
  s_add_u32 m0, s39, 20480
  v_mfma_f32_16x16x32_bf16 v[48:51], v[168:171], a[144:147], v[48:51]
  buffer_load_dwordx4 v10, s[4:7], s56 offen nt lds
  v_mfma_f32_16x16x32_bf16 v[48:51], a[80:83], a[148:151], v[48:51]
  v_mfma_f32_16x16x32_bf16 v[52:55], v[172:175], a[144:147], v[52:55]
  v_mfma_f32_16x16x32_bf16 v[52:55], a[84:87], a[148:151], v[52:55]
  v_mfma_f32_16x16x32_bf16 v[56:59], v[176:179], a[144:147], v[56:59]
  v_mfma_f32_16x16x32_bf16 v[56:59], a[88:91], a[148:151], v[56:59]
  v_mfma_f32_16x16x32_bf16 v[60:63], v[180:183], a[144:147], v[60:63]
  v_mfma_f32_16x16x32_bf16 v[60:63], a[92:95], a[148:151], v[60:63]
  s_waitcnt vmcnt(10) lgkmcnt(2)
L_ent:
  s_barrier
  s_waitcnt lgkmcnt(3)
  v_mfma_f32_16x16x32_bf16 v[40:43], v[184:187], a[152:155], v[40:43]
  ds_read_b128 a[144:147], v1 offset:24576
  v_mfma_f32_16x16x32_bf16 v[40:43], a[96:99], a[156:159], v[40:43]
  ds_read_b128 a[148:151], v2 offset:24576
  v_mfma_f32_16x16x32_bf16 v[44:47], v[188:191], a[152:155], v[44:47]
  ds_read_b128 a[180:183], v5 offset:12288
  v_mfma_f32_16x16x32_bf16 v[44:47], a[100:103], a[156:159], v[44:47]
  ds_read_b128 a[184:187], v6 offset:12288
  v_mfma_f32_16x16x32_bf16 v[48:51], v[192:195], a[152:155], v[48:51]
  ds_read_b128 a[188:191], v7 offset:12288
  v_mfma_f32_16x16x32_bf16 v[48:51], a[104:107], a[156:159], v[48:51]
  ds_read_b128 a[168:171], v5 offset:0
  v_mfma_f32_16x16x32_bf16 v[52:55], v[196:199], a[152:155], v[52:55]
  ds_read_b128 a[172:175], v6 offset:0
  v_mfma_f32_16x16x32_bf16 v[52:55], a[108:111], a[156:159], v[52:55]
  ds_read_b128 a[176:179], v7 offset:0
  v_mfma_f32_16x16x32_bf16 v[56:59], v[200:203], a[152:155], v[56:59]
  v_mfma_f32_16x16x32_bf16 v[56:59], a[112:115], a[156:159], v[56:59]
  v_mfma_f32_16x16x32_bf16 v[60:63], v[204:207], a[152:155], v[60:63]
  v_mfma_f32_16x16x32_bf16 v[60:63], a[116:119], a[156:159], v[60:63]
  s_waitcnt lgkmcnt(8)
  v_mfma_f32_16x16x32_bf16 v[40:43], v[208:211], a[160:163], v[40:43]
  ds_read_b128 a[152:155], v3 offset:24576
  v_mfma_f32_16x16x32_bf16 v[40:43], v[232:235], a[164:167], v[40:43]
  ds_read_b128 a[156:159], v4 offset:24576
  v_mfma_f32_16x16x32_bf16 v[44:47], v[212:215], a[160:163], v[44:47]
  s_waitcnt lgkmcnt(7)
  buffer_store_dwordx4 a[180:183], v14, s[8:11], s62 offen sc1
  v_mfma_f32_16x16x32_bf16 v[44:47], v[236:239], a[164:167], v[44:47]
  v_mfma_f32_16x16x32_bf16 v[48:51], v[216:219], a[160:163], v[48:51]
  v_mfma_f32_16x16x32_bf16 v[48:51], v[240:243], a[164:167], v[48:51]
  v_mfma_f32_16x16x32_bf16 v[52:55], v[220:223], a[160:163], v[52:55]
  v_mfma_f32_16x16x32_bf16 v[52:55], v[244:247], a[164:167], v[52:55]
  v_mfma_f32_16x16x32_bf16 v[56:59], v[224:227], a[160:163], v[56:59]
  s_waitcnt lgkmcnt(6)
  buffer_store_dwordx4 a[184:187], v81, s[8:11], s63 offen sc1
  v_mfma_f32_16x16x32_bf16 v[56:59], v[248:251], a[164:167], v[56:59]
  v_mfma_f32_16x16x32_bf16 v[60:63], v[228:231], a[160:163], v[60:63]
  v_mfma_f32_16x16x32_bf16 v[60:63], v[252:255], a[164:167], v[60:63]
  s_waitcnt lgkmcnt(8)
  v_mfma_f32_16x16x32_bf16 v[16:19], v[88:91], a[144:147], 0
  ds_read_b128 a[160:163], v1 offset:24832
  v_mfma_f32_16x16x32_bf16 v[16:19], a[0:3], a[148:151], v[16:19]
  ds_read_b128 a[164:167], v2 offset:24832
  v_mfma_f32_16x16x32_bf16 v[20:23], v[92:95], a[144:147], 0
  v_mfma_f32_16x16x32_bf16 v[20:23], a[4:7], a[148:151], v[20:23]
  v_cvt_pk_bf16_f32 v40, v40, v41
  v_mfma_f32_16x16x32_bf16 v[24:27], v[96:99], a[144:147], 0
  v_cvt_pk_bf16_f32 v41, v42, v43
  v_mfma_f32_16x16x32_bf16 v[24:27], a[8:11], a[148:151], v[24:27]
  v_cvt_pk_bf16_f32 v42, v44, v45
  v_mfma_f32_16x16x32_bf16 v[28:31], v[100:103], a[144:147], 0
  s_waitcnt lgkmcnt(7)
  buffer_store_dwordx4 a[188:191], v82, s[8:11], s63 offen sc1
  v_mfma_f32_16x16x32_bf16 v[28:31], a[12:15], a[148:151], v[28:31]
  v_cvt_pk_bf16_f32 v43, v46, v47
  v_mfma_f32_16x16x32_bf16 v[32:35], v[104:107], a[144:147], 0
  ds_write_b128 v86, v[40:43] offset:36864
  v_mfma_f32_16x16x32_bf16 v[32:35], a[16:19], a[148:151], v[32:35]
  v_mfma_f32_16x16x32_bf16 v[36:39], v[108:111], a[144:147], 0
  v_mfma_f32_16x16x32_bf16 v[36:39], a[20:23], a[148:151], v[36:39]
  s_waitcnt lgkmcnt(3)
  v_mfma_f32_16x16x32_bf16 v[16:19], v[112:115], a[152:155], v[16:19]
  ds_read_b128 a[144:147], v3 offset:24832
  v_mfma_f32_16x16x32_bf16 v[16:19], a[24:27], a[156:159], v[16:19]
  ds_read_b128 a[148:151], v4 offset:24832
  v_mfma_f32_16x16x32_bf16 v[20:23], v[116:119], a[152:155], v[20:23]
  v_mfma_f32_16x16x32_bf16 v[20:23], a[28:31], a[156:159], v[20:23]
  v_cvt_pk_bf16_f32 v48, v48, v49
  v_mfma_f32_16x16x32_bf16 v[24:27], v[120:123], a[152:155], v[24:27]
  buffer_store_dwordx4 a[168:171], v80, s[8:11], s58 offen sc1
  v_mfma_f32_16x16x32_bf16 v[24:27], a[32:35], a[156:159], v[24:27]
  v_cvt_pk_bf16_f32 v49, v50, v51
  v_mfma_f32_16x16x32_bf16 v[28:31], v[124:127], a[152:155], v[28:31]
  v_cvt_pk_bf16_f32 v50, v52, v53
  v_mfma_f32_16x16x32_bf16 v[28:31], a[36:39], a[156:159], v[28:31]
  v_cvt_pk_bf16_f32 v51, v54, v55
  v_mfma_f32_16x16x32_bf16 v[32:35], v[128:131], a[152:155], v[32:35]
  ds_write_b128 v87, v[48:51] offset:36864
  v_mfma_f32_16x16x32_bf16 v[32:35], a[40:43], a[156:159], v[32:35]
  v_mfma_f32_16x16x32_bf16 v[36:39], v[132:135], a[152:155], v[36:39]
  v_mfma_f32_16x16x32_bf16 v[36:39], a[44:47], a[156:159], v[36:39]
  s_waitcnt lgkmcnt(4)
  v_mfma_f32_16x16x32_bf16 v[16:19], v[136:139], a[160:163], v[16:19]
  ds_read_b128 a[152:155], v1 offset:25088
  v_mfma_f32_16x16x32_bf16 v[16:19], a[48:51], a[164:167], v[16:19]
  ds_read_b128 a[156:159], v2 offset:25088
  v_mfma_f32_16x16x32_bf16 v[20:23], v[140:143], a[160:163], v[20:23]
  v_mfma_f32_16x16x32_bf16 v[20:23], a[52:55], a[164:167], v[20:23]
  v_mfma_f32_16x16x32_bf16 v[24:27], v[144:147], a[160:163], v[24:27]
  buffer_store_dwordx4 a[172:175], v81, s[8:11], s58 offen sc1
  v_mfma_f32_16x16x32_bf16 v[24:27], a[56:59], a[164:167], v[24:27]
  v_mfma_f32_16x16x32_bf16 v[28:31], v[148:151], a[160:163], v[28:31]
  v_mfma_f32_16x16x32_bf16 v[28:31], a[60:63], a[164:167], v[28:31]
  v_mfma_f32_16x16x32_bf16 v[32:35], v[152:155], a[160:163], v[32:35]
  v_mfma_f32_16x16x32_bf16 v[32:35], a[64:67], a[164:167], v[32:35]
  s_mov_b64 s[82:83], s[80:81]
  v_mfma_f32_16x16x32_bf16 v[36:39], v[156:159], a[160:163], v[36:39]
  s_mov_b64 s[80:81], s[78:79]
  s_mov_b64 s[78:79], s[76:77]
  v_mfma_f32_16x16x32_bf16 v[36:39], a[68:71], a[164:167], v[36:39]
  s_cmp_ge_u32 s32, s35
  s_waitcnt lgkmcnt(3)
  v_mfma_f32_16x16x32_bf16 v[16:19], v[160:163], a[144:147], v[16:19]
  ds_read_b128 a[160:163], v3 offset:25088
  s_cselect_b64 s[34:35], s[28:29], s[34:35]
  v_mfma_f32_16x16x32_bf16 v[16:19], a[72:75], a[148:151], v[16:19]
  ds_read_b128 a[164:167], v4 offset:25088
  s_cselect_b64 s[28:29], s[30:31], s[28:29]
  v_mfma_f32_16x16x32_bf16 v[20:23], v[164:167], a[144:147], v[20:23]
  s_add_u32 s76, s33, s32
  v_cvt_pk_bf16_f32 v56, v56, v57
  v_mfma_f32_16x16x32_bf16 v[20:23], a[76:79], a[148:151], v[20:23]
  s_xor_b32 s76, s76, s34
  v_cvt_pk_bf16_f32 v57, v58, v59
  v_mfma_f32_16x16x32_bf16 v[24:27], v[168:171], a[144:147], v[24:27]
  buffer_store_dwordx4 a[176:179], v13, s[8:11], s59 offen sc1
  v_mfma_f32_16x16x32_bf16 v[24:27], a[80:83], a[148:151], v[24:27]
  s_bfe_u32 s77, s76, 65557
  v_cvt_pk_bf16_f32 v58, v60, v61
  v_mfma_f32_16x16x32_bf16 v[28:31], v[172:175], a[144:147], v[28:31]
  s_bfe_u32 s76, s76, 65555
  v_cvt_pk_bf16_f32 v59, v62, v63
  v_mfma_f32_16x16x32_bf16 v[28:31], a[84:87], a[148:151], v[28:31]
  ds_write_b128 v86, v[56:59] offset:36992
  v_mfma_f32_16x16x32_bf16 v[32:35], v[176:179], a[144:147], v[32:35]
  s_lshl1_add_u32 s77, s76, s77
  s_sub_u32 s77, 1, s77
  v_mfma_f32_16x16x32_bf16 v[32:35], a[88:91], a[148:151], v[32:35]
  s_and_b32 s77, s77, 3
  s_mul_i32 s77, s77, 24576
  v_mfma_f32_16x16x32_bf16 v[36:39], v[180:183], a[144:147], v[36:39]
  s_cmp_lt_u32 s32, s21
  s_cselect_b32 s76, s32, s40
  v_mfma_f32_16x16x32_bf16 v[36:39], a[92:95], a[148:151], v[36:39]
  s_add_u32 s32, s32, 786432
  s_waitcnt lgkmcnt(3)
  v_mfma_f32_16x16x32_bf16 v[16:19], v[184:187], a[152:155], v[16:19]
  ds_read_b128 a[144:147], v1 offset:36864
  s_cmp_eq_u32 s77, 0
  v_mfma_f32_16x16x32_bf16 v[16:19], a[96:99], a[156:159], v[16:19]
  ds_read_b128 a[148:151], v2 offset:36864
  s_cselect_b32 s57, 73728, s26
  v_mfma_f32_16x16x32_bf16 v[20:23], v[188:191], a[152:155], v[20:23]
  s_add_u32 s22, s76, s77
  s_add_u32 s22, s22, s57
  v_mfma_f32_16x16x32_bf16 v[20:23], a[100:103], a[156:159], v[20:23]
  s_min_u32 s22, s22, s40
  s_add_u32 m0, s39, 24576
  v_mfma_f32_16x16x32_bf16 v[24:27], v[192:195], a[152:155], v[24:27]
  buffer_load_dwordx4 v8, s[4:7], s22 offen nt lds
  v_mfma_f32_16x16x32_bf16 v[24:27], a[104:107], a[156:159], v[24:27]
  s_cmp_eq_u32 s81, 0
  s_cselect_b32 s91, 73728, s26
  v_mfma_f32_16x16x32_bf16 v[28:31], v[196:199], a[152:155], v[28:31]
  s_add_u32 s58, s80, s81
  s_add_u32 s58, s58, s91
  v_mfma_f32_16x16x32_bf16 v[28:31], a[108:111], a[156:159], v[28:31]
  s_min_u32 s58, s58, s40
  s_mov_b32 s59, s80
  v_mfma_f32_16x16x32_bf16 v[32:35], v[200:203], a[152:155], v[32:35]
  v_and_b32 v13, s91, v11
  v_add3_u32 v13, v82, v13, s81
  v_mfma_f32_16x16x32_bf16 v[32:35], a[112:115], a[156:159], v[32:35]
  s_cmp_eq_u32 s83, 73728
  s_cselect_b32 s91, 4294893568, s27
  v_mfma_f32_16x16x32_bf16 v[36:39], v[204:207], a[152:155], v[36:39]
  s_add_u32 s62, s83, 12288
  s_add_u32 s63, s82, s62
  v_mfma_f32_16x16x32_bf16 v[36:39], a[116:119], a[156:159], v[36:39]
  s_add_u32 s63, s63, s91
  s_waitcnt lgkmcnt(3)
  v_mfma_f32_16x16x32_bf16 v[16:19], v[208:211], a[160:163], v[16:19]
  ds_read_b128 a[152:155], v3 offset:36864
  s_min_u32 s63, s63, s40
  v_mfma_f32_16x16x32_bf16 v[16:19], v[232:235], a[164:167], v[16:19]
  ds_read_b128 a[156:159], v4 offset:36864
  v_and_b32 v14, s91, v12
  v_mfma_f32_16x16x32_bf16 v[20:23], v[212:215], a[160:163], v[20:23]
  v_add3_u32 v14, v80, v14, s62
  s_mov_b32 s62, s82
  v_mfma_f32_16x16x32_bf16 v[20:23], v[236:239], a[164:167], v[20:23]
  s_add_u32 m0, s39, 28672
  v_mfma_f32_16x16x32_bf16 v[24:27], v[216:219], a[160:163], v[24:27]
  buffer_load_dwordx4 v9, s[4:7], s22 offen nt lds
  v_mfma_f32_16x16x32_bf16 v[24:27], v[240:243], a[164:167], v[24:27]
  v_mfma_f32_16x16x32_bf16 v[28:31], v[220:223], a[160:163], v[28:31]
  v_mfma_f32_16x16x32_bf16 v[28:31], v[244:247], a[164:167], v[28:31]
  v_mfma_f32_16x16x32_bf16 v[32:35], v[224:227], a[160:163], v[32:35]
  v_mfma_f32_16x16x32_bf16 v[32:35], v[248:251], a[164:167], v[32:35]
  v_and_b32 v15, s57, v11
  v_mfma_f32_16x16x32_bf16 v[36:39], v[228:231], a[160:163], v[36:39]
  v_add3_u32 v15, v10, v15, s77
  v_mfma_f32_16x16x32_bf16 v[36:39], v[252:255], a[164:167], v[36:39]
  s_waitcnt lgkmcnt(2)
  v_mfma_f32_16x16x32_bf16 v[40:43], v[88:91], a[144:147], 0
  ds_read_b128 a[160:163], v1 offset:37120
  v_mfma_f32_16x16x32_bf16 v[40:43], a[0:3], a[148:151], v[40:43]
  ds_read_b128 a[164:167], v2 offset:37120
  v_mfma_f32_16x16x32_bf16 v[44:47], v[92:95], a[144:147], 0
  s_add_u32 m0, s39, 32768
  v_mfma_f32_16x16x32_bf16 v[44:47], a[4:7], a[148:151], v[44:47]
  v_cvt_pk_bf16_f32 v16, v16, v17
  v_mfma_f32_16x16x32_bf16 v[48:51], v[96:99], a[144:147], 0
  buffer_load_dwordx4 v15, s[4:7], s76 offen nt lds
  v_mfma_f32_16x16x32_bf16 v[48:51], a[8:11], a[148:151], v[48:51]
  v_cvt_pk_bf16_f32 v17, v18, v19
  v_mfma_f32_16x16x32_bf16 v[52:55], v[100:103], a[144:147], 0
  v_cvt_pk_bf16_f32 v18, v20, v21
  v_mfma_f32_16x16x32_bf16 v[52:55], a[12:15], a[148:151], v[52:55]
  s_cmp_eq_u32 s77, 73728
  v_cvt_pk_bf16_f32 v19, v22, v23
  v_mfma_f32_16x16x32_bf16 v[56:59], v[104:107], a[144:147], 0
  ds_write_b128 v86, v[16:19] offset:24576
  v_mfma_f32_16x16x32_bf16 v[56:59], a[16:19], a[148:151], v[56:59]
  s_cselect_b32 s57, 4294893568, s27
  s_add_u32 s90, s77, 12288
  v_mfma_f32_16x16x32_bf16 v[60:63], v[108:111], a[144:147], 0
  s_add_u32 s56, s76, s90
  v_cvt_pk_bf16_f32 v24, v24, v25
  v_mfma_f32_16x16x32_bf16 v[60:63], a[20:23], a[148:151], v[60:63]
  s_add_u32 s56, s56, s57
  s_waitcnt lgkmcnt(3)
  v_mfma_f32_16x16x32_bf16 v[40:43], v[112:115], a[152:155], v[40:43]
  ds_read_b128 a[144:147], v3 offset:37120
  s_min_u32 s56, s56, s40
  v_mfma_f32_16x16x32_bf16 v[40:43], a[24:27], a[156:159], v[40:43]
  ds_read_b128 a[148:151], v4 offset:37120
  v_and_b32 v15, s57, v12
  v_mfma_f32_16x16x32_bf16 v[44:47], v[116:119], a[152:155], v[44:47]
  v_add3_u32 v15, v8, v15, s90
  v_cvt_pk_bf16_f32 v25, v26, v27
  v_mfma_f32_16x16x32_bf16 v[44:47], a[28:31], a[156:159], v[44:47]
  s_add_u32 m0, s39, 36864
  v_cvt_pk_bf16_f32 v26, v28, v29
  v_mfma_f32_16x16x32_bf16 v[48:51], v[120:123], a[152:155], v[48:51]
  buffer_load_dwordx4 v15, s[4:7], s76 offen nt lds
  v_mfma_f32_16x16x32_bf16 v[48:51], a[32:35], a[156:159], v[48:51]
  v_cvt_pk_bf16_f32 v27, v30, v31
  v_mfma_f32_16x16x32_bf16 v[52:55], v[124:127], a[152:155], v[52:55]
  ds_write_b128 v87, v[24:27] offset:24576
  v_mfma_f32_16x16x32_bf16 v[52:55], a[36:39], a[156:159], v[52:55]
  v_mfma_f32_16x16x32_bf16 v[56:59], v[128:131], a[152:155], v[56:59]
  v_mfma_f32_16x16x32_bf16 v[56:59], a[40:43], a[156:159], v[56:59]
  v_mfma_f32_16x16x32_bf16 v[60:63], v[132:135], a[152:155], v[60:63]
  v_mfma_f32_16x16x32_bf16 v[60:63], a[44:47], a[156:159], v[60:63]
  s_waitcnt lgkmcnt(4)
  v_mfma_f32_16x16x32_bf16 v[40:43], v[136:139], a[160:163], v[40:43]
  ds_read_b128 a[152:155], v1 offset:37376
  v_mfma_f32_16x16x32_bf16 v[40:43], a[48:51], a[164:167], v[40:43]
  ds_read_b128 a[156:159], v2 offset:37376
  v_mfma_f32_16x16x32_bf16 v[44:47], v[140:143], a[160:163], v[44:47]
  s_add_u32 m0, s39, 40960
  v_mfma_f32_16x16x32_bf16 v[44:47], a[52:55], a[164:167], v[44:47]
  v_cvt_pk_bf16_f32 v32, v32, v33
  v_mfma_f32_16x16x32_bf16 v[48:51], v[144:147], a[160:163], v[48:51]
  buffer_load_dwordx4 v9, s[4:7], s56 offen nt lds
  v_mfma_f32_16x16x32_bf16 v[48:51], a[56:59], a[164:167], v[48:51]
  v_cvt_pk_bf16_f32 v33, v34, v35
  v_mfma_f32_16x16x32_bf16 v[52:55], v[148:151], a[160:163], v[52:55]
  v_cvt_pk_bf16_f32 v34, v36, v37
  v_mfma_f32_16x16x32_bf16 v[52:55], a[60:63], a[164:167], v[52:55]
  v_cvt_pk_bf16_f32 v35, v38, v39
  v_mfma_f32_16x16x32_bf16 v[56:59], v[152:155], a[160:163], v[56:59]
  ds_write_b128 v86, v[32:35] offset:24704
  v_mfma_f32_16x16x32_bf16 v[56:59], a[64:67], a[164:167], v[56:59]
  v_mfma_f32_16x16x32_bf16 v[60:63], v[156:159], a[160:163], v[60:63]
  v_mfma_f32_16x16x32_bf16 v[60:63], a[68:71], a[164:167], v[60:63]
  s_waitcnt lgkmcnt(4)
  v_mfma_f32_16x16x32_bf16 v[40:43], v[160:163], a[144:147], v[40:43]
  ds_read_b128 a[160:163], v3 offset:37376
  v_mfma_f32_16x16x32_bf16 v[40:43], a[72:75], a[148:151], v[40:43]
  ds_read_b128 a[164:167], v4 offset:37376
  v_mfma_f32_16x16x32_bf16 v[44:47], v[164:167], a[144:147], v[44:47]
  s_add_u32 m0, s39, 45056
  v_mfma_f32_16x16x32_bf16 v[44:47], a[76:79], a[148:151], v[44:47]
  s_xor_b32 s39, s39, 49152
  v_mfma_f32_16x16x32_bf16 v[48:51], v[168:171], a[144:147], v[48:51]
  buffer_load_dwordx4 v10, s[4:7], s56 offen nt lds
  v_mfma_f32_16x16x32_bf16 v[48:51], a[80:83], a[148:151], v[48:51]
  v_mfma_f32_16x16x32_bf16 v[52:55], v[172:175], a[144:147], v[52:55]
  v_mfma_f32_16x16x32_bf16 v[52:55], a[84:87], a[148:151], v[52:55]
  v_mfma_f32_16x16x32_bf16 v[56:59], v[176:179], a[144:147], v[56:59]
  v_mfma_f32_16x16x32_bf16 v[56:59], a[88:91], a[148:151], v[56:59]
  v_mfma_f32_16x16x32_bf16 v[60:63], v[180:183], a[144:147], v[60:63]
  v_mfma_f32_16x16x32_bf16 v[60:63], a[92:95], a[148:151], v[60:63]
  s_waitcnt vmcnt(12) lgkmcnt(2)
  s_barrier
  v_xor_b32 v1, 49152, v1
  v_xor_b32 v2, 49152, v2
  v_xor_b32 v3, 49152, v3
  v_xor_b32 v4, 49152, v4
  s_waitcnt lgkmcnt(3)
  v_mfma_f32_16x16x32_bf16 v[40:43], v[184:187], a[152:155], v[40:43]
  ds_read_b128 a[144:147], v1 offset:0
  v_mfma_f32_16x16x32_bf16 v[40:43], a[96:99], a[156:159], v[40:43]
  ds_read_b128 a[148:151], v2 offset:0
  v_mfma_f32_16x16x32_bf16 v[44:47], v[188:191], a[152:155], v[44:47]
  ds_read_b128 a[180:183], v5 offset:36864
  v_mfma_f32_16x16x32_bf16 v[44:47], a[100:103], a[156:159], v[44:47]
  ds_read_b128 a[184:187], v6 offset:36864
  v_mfma_f32_16x16x32_bf16 v[48:51], v[192:195], a[152:155], v[48:51]
  ds_read_b128 a[188:191], v7 offset:36864
  v_mfma_f32_16x16x32_bf16 v[48:51], a[104:107], a[156:159], v[48:51]
  ds_read_b128 a[168:171], v5 offset:24576
  v_mfma_f32_16x16x32_bf16 v[52:55], v[196:199], a[152:155], v[52:55]
  ds_read_b128 a[172:175], v6 offset:24576
  v_mfma_f32_16x16x32_bf16 v[52:55], a[108:111], a[156:159], v[52:55]
  ds_read_b128 a[176:179], v7 offset:24576
  v_mfma_f32_16x16x32_bf16 v[56:59], v[200:203], a[152:155], v[56:59]
  v_mfma_f32_16x16x32_bf16 v[56:59], a[112:115], a[156:159], v[56:59]
  v_mfma_f32_16x16x32_bf16 v[60:63], v[204:207], a[152:155], v[60:63]
  v_mfma_f32_16x16x32_bf16 v[60:63], a[116:119], a[156:159], v[60:63]
  s_waitcnt lgkmcnt(8)
  v_mfma_f32_16x16x32_bf16 v[40:43], v[208:211], a[160:163], v[40:43]
  ds_read_b128 a[152:155], v3 offset:0
  v_mfma_f32_16x16x32_bf16 v[40:43], v[232:235], a[164:167], v[40:43]
  ds_read_b128 a[156:159], v4 offset:0
  v_mfma_f32_16x16x32_bf16 v[44:47], v[212:215], a[160:163], v[44:47]
  s_waitcnt lgkmcnt(7)
  buffer_store_dwordx4 a[180:183], v14, s[8:11], s62 offen sc1
  v_mfma_f32_16x16x32_bf16 v[44:47], v[236:239], a[164:167], v[44:47]
  v_mfma_f32_16x16x32_bf16 v[48:51], v[216:219], a[160:163], v[48:51]
  v_mfma_f32_16x16x32_bf16 v[48:51], v[240:243], a[164:167], v[48:51]
  v_mfma_f32_16x16x32_bf16 v[52:55], v[220:223], a[160:163], v[52:55]
  v_mfma_f32_16x16x32_bf16 v[52:55], v[244:247], a[164:167], v[52:55]
  v_mfma_f32_16x16x32_bf16 v[56:59], v[224:227], a[160:163], v[56:59]
  s_waitcnt lgkmcnt(6)
  buffer_store_dwordx4 a[184:187], v81, s[8:11], s63 offen sc1
  v_mfma_f32_16x16x32_bf16 v[56:59], v[248:251], a[164:167], v[56:59]
  v_mfma_f32_16x16x32_bf16 v[60:63], v[228:231], a[160:163], v[60:63]
  v_mfma_f32_16x16x32_bf16 v[60:63], v[252:255], a[164:167], v[60:63]
  s_cmp_lt_u32 s78, s40
  s_cbranch_scc1 L_loop
L_tail:
  s_nop 3
  v_cvt_pk_bf16_f32 v40, v40, v41
  v_cvt_pk_bf16_f32 v41, v42, v43
  v_cvt_pk_bf16_f32 v42, v44, v45
  v_cvt_pk_bf16_f32 v43, v46, v47
  ds_write_b128 v86, v[40:43] offset:12288
  v_cvt_pk_bf16_f32 v48, v48, v49
  v_cvt_pk_bf16_f32 v49, v50, v51
  v_cvt_pk_bf16_f32 v50, v52, v53
  v_cvt_pk_bf16_f32 v51, v54, v55
  ds_write_b128 v87, v[48:51] offset:12288
  v_cvt_pk_bf16_f32 v56, v56, v57
  v_cvt_pk_bf16_f32 v57, v58, v59
  v_cvt_pk_bf16_f32 v58, v60, v61
  v_cvt_pk_bf16_f32 v59, v62, v63
  ds_write_b128 v86, v[56:59] offset:12416
  s_waitcnt lgkmcnt(8)
  buffer_store_dwordx4 a[188:191], v82, s[8:11], s63 offen sc1
  s_waitcnt lgkmcnt(7)
  buffer_store_dwordx4 a[168:171], v80, s[8:11], s58 offen sc1
  s_waitcnt lgkmcnt(6)
  buffer_store_dwordx4 a[172:175], v81, s[8:11], s58 offen sc1
  s_waitcnt lgkmcnt(5)
  buffer_store_dwordx4 a[176:179], v13, s[8:11], s59 offen sc1
  s_cmp_eq_u32 s79, 0
  s_cselect_b32 s91, 73728, s26
  s_add_u32 s58, s78, s79
  s_add_u32 s58, s58, s91
  s_min_u32 s58, s58, s40
  s_mov_b32 s59, s78
  v_and_b32 v13, s91, v11
  v_add3_u32 v13, v82, v13, s79
  s_cmp_eq_u32 s81, 73728
  s_cselect_b32 s91, 4294893568, s27
  s_add_u32 s62, s81, 12288
  s_add_u32 s63, s80, s62
  s_add_u32 s63, s63, s91
  s_min_u32 s63, s63, s40
  v_and_b32 v14, s91, v12
  v_add3_u32 v14, v80, v14, s62
  s_mov_b32 s62, s80
  s_waitcnt lgkmcnt(0)
  s_barrier
  ds_read_b128 a[144:147], v5 offset:12288
  ds_read_b128 a[148:151], v6 offset:12288
  ds_read_b128 a[152:155], v7 offset:12288
  s_waitcnt lgkmcnt(2)
  buffer_store_dwordx4 a[144:147], v14, s[8:11], s62 offen sc1
  s_waitcnt lgkmcnt(1)
  buffer_store_dwordx4 a[148:151], v81, s[8:11], s63 offen sc1
  s_waitcnt lgkmcnt(0)
  buffer_store_dwordx4 a[152:155], v82, s[8:11], s63 offen sc1
  s_endpgm
L_slow:
  v_mbcnt_lo_u32_b32 v253, -1, 0
  v_and_b32 v253, 3, v253
  v_lshl_add_u32 v15, v253, 2, s88
  s_mov_b64 exec, 0xf0
  v_lshl_add_u32 v15, v253, 2, s89
  s_mov_b64 exec, 0xf00
  v_lshl_add_u32 v15, v253, 2, s95
  s_mov_b64 exec, -1
  v_mov_b32 v254, 1
  v_mov_b32 v255, 0
  s_mov_b64 exec, 0xfff
  buffer_atomic_cmpswap v[254:255], v15, s[16:19], 0 offen sc0 sc1
  s_waitcnt vmcnt(0)
  v_max_u32 v254, 1, v254
  s_nop 0
  v_readlane_b32 s44, v254, 0
  v_readlane_b32 s45, v254, 1
  v_readlane_b32 s46, v254, 2
  v_readlane_b32 s47, v254, 3
  v_readlane_b32 s84, v254, 4
  v_readlane_b32 s85, v254, 5
  v_readlane_b32 s86, v254, 6
  v_readlane_b32 s87, v254, 7
  v_readlane_b32 s12, v254, 8
  v_readlane_b32 s13, v254, 9
  v_readlane_b32 s14, v254, 10
  v_readlane_b32 s15, v254, 11
  s_nop 3
  s_mov_b64 exec, -1
  s_branch L_back
L_done:
  s_endpgm
.section .rodata,"a"
.p2align 6
.amdhsa_kernel standalone__depthwise_separable__vision_kernel
  .amdhsa_next_free_vgpr 512
  .amdhsa_next_free_sgpr 100
  .amdhsa_accum_offset 256
  .amdhsa_group_segment_fixed_size 0
  .amdhsa_kernarg_size 48
  .amdhsa_user_sgpr_count 2
  .amdhsa_user_sgpr_kernarg_segment_ptr 1
  .amdhsa_system_sgpr_workgroup_id_x 1
  .amdhsa_float_denorm_mode_32 3
.end_amdhsa_kernel
```

```asm
; @launch grid=(256,1,1) block=(256,1,1) lds=152128
.amdgcn_target "amdgcn-amd-amdhsa--gfx950"
.text
.globl standalone__depthwise_separable__vision_kernel
.p2align 8
.type standalone__depthwise_separable__vision_kernel,@function
standalone__depthwise_separable__vision_kernel:
  s_load_dwordx8 s[24:31], s[0:1], 0
  s_load_dwordx2 s[92:93], s[0:1], 32
  s_cmp_ge_u32 s2, 256
  s_cbranch_scc1 L_done
  v_lshrrev_b32 v16, 6, v0
  v_and_b32 v28, 63, v0
  v_readfirstlane_b32 s20, v16
  s_getpc_b64 s[50:51]
L_pc:
  v_mul_u32_u24 v18, 128, v0
  v_min_u32 v18, L_done-L_pc, v18
  v_mov_b32 v19, s51
  v_add_co_u32 v18, vcc, s50, v18
  s_nop 1
  v_addc_co_u32 v19, vcc, 0, v19, vcc
  global_load_dword v88, v[18:19], off
  s_lshr_b32 s50, s2, 3
  s_and_b32 s55, s50, 3
  s_lshr_b32 s54, s50, 2
  s_mul_i32 s51, s54, 11
  s_lshr_b32 s51, s51, 5
  s_mul_i32 s51, s51, 3
  s_sub_u32 s54, s54, s51
  s_mul_i32 s52, s20, 192
  v_mul_u32_u24 v18, 0xaaab, v28
  v_lshrrev_b32 v18, 19, v18
  v_mul_u32_u24 v19, 576, v18
  v_lshl_add_u32 v19, v28, 4, v19
  v_add_u32 v64, s52, v19
  v_add_u32 v17, 64, v28
  v_mul_u32_u24 v18, 0xaaab, v17
  v_lshrrev_b32 v18, 19, v18
  v_mul_u32_u24 v19, 576, v18
  v_lshl_add_u32 v19, v28, 4, v19
  v_lshrrev_b32 v18, 3, v18
  v_mul_u32_u24 v18, 6144, v18
  v_add_u32 v19, v19, v18
  v_add_u32 v65, s52, v19
  v_add_u32 v17, 128, v28
  v_mul_u32_u24 v18, 0xaaab, v17
  v_lshrrev_b32 v18, 19, v18
  v_mul_u32_u24 v19, 576, v18
  v_lshl_add_u32 v19, v28, 4, v19
  v_add_u32 v19, 6144, v19
  v_add_u32 v66, s52, v19
  s_mul_i32 s42, s54, 98304
  s_mul_i32 s45, s55, 24576
  s_mul_i32 s49, s20, 6160
  s_waitcnt lgkmcnt(0)
  s_mov_b32 s12, s28
  s_and_b32 s13, s29, 0xffff
  s_mov_b32 s14, 294912
  s_mov_b32 s15, 0x00020000
  s_add_u32 m0, s49, 98560
  s_add_u32 s50, s42, s45
  buffer_load_dwordx4 v64, s[12:15], s50 offen offset:0 lds
  buffer_load_dwordx4 v65, s[12:15], s50 offen offset:1024 lds
  buffer_load_dwordx4 v66, s[12:15], s50 offen offset:2048 lds
  s_add_u32 m0, s49, 101640
  s_add_u32 s50, s50, 6144
  buffer_load_dwordx4 v64, s[12:15], s50 offen offset:0 lds
  buffer_load_dwordx4 v65, s[12:15], s50 offen offset:1024 lds
  buffer_load_dwordx4 v66, s[12:15], s50 offen offset:2048 lds
  s_lshr_b32 s51, s2, 5
  s_and_b32 s52, s2, 3
  s_lshl2_add_u32 s36, s51, s52
  s_lshl_b32 s36, s36, 2
  s_mul_i32 s51, s51, 144
  s_lshr_b32 s52, s52, 1
  s_lshl1_add_u32 s52, s55, s52
  s_add_u32 s51, s51, s52
  s_mul_i32 s32, s51, 98304
  s_add_u32 s21, s32, 14155776
  s_lshl_b32 s51, s20, 11
  s_and_b32 s52, s2, 3
  s_lshl_b32 s52, s52, 8
  s_add_u32 s51, s51, s52
  s_lshr_b32 s52, s2, 5
  s_lshl_b32 s37, s52, 24
  s_add_u32 s37, s37, 8650752
  s_mul_i32 s52, s52, 6291456
  s_add_u32 s52, s52, 67371008
  s_min_u32 s37, s37, s52
  s_add_u32 s37, s37, s51
  s_and_b32 s23, s2, 28
  s_add_u32 s38, s37, 8192
  s_cmp_lg_u32 s23, 0
  s_cbranch_scc1 L_np0
  s_load_dword s84, s[24:25], s37 glc
  s_load_dword s85, s[24:25], s38 glc
L_np0:
  s_lshl_b32 s53, s55, 2
  v_lshrrev_b32 v17, 4, v28
  v_add_u32 v18, s54, v17
  v_subrev_u32 v19, 3, v18
  v_min_u32 v18, v18, v19
  v_and_b32 v20, 15, v28
  v_xor_b32 v19, s53, v20
  v_lshlrev_b32 v19, 4, v19
  v_lshl_add_u32 v19, v18, 8, v19
  v_cmp_lt_u32 vcc, 47, v28
  s_lshl_b32 s50, s20, 10
  s_add_u32 m0, s50, 147968
  v_cndmask_b32 v19, v19, v66, vcc
  s_mov_b32 s16, s26
  s_and_b32 s17, s27, 0xffff
  s_mov_b32 s18, 768
  s_mov_b32 s19, 0x00020000
  buffer_load_dwordx4 v19, s[16:19], 0 offen lds
  s_add_u32 s43, s42, 98304
  s_cmp_eq_u32 s54, 2
  s_cselect_b32 s43, 0, s43
  s_add_u32 s44, s43, 98304
  s_cmp_eq_u32 s54, 1
  s_cselect_b32 s44, 0, s44
  s_xor_b32 s46, s55, 1
  s_mul_i32 s46, s46, 24576
  s_xor_b32 s47, s55, 2
  s_mul_i32 s47, s47, 24576
  s_xor_b32 s48, s55, 3
  s_mul_i32 s48, s48, 24576
  s_mov_b32 s4, s24
  s_and_b32 s5, s25, 0xffff
  s_mov_b32 s6, 113246208
  s_mov_b32 s7, 0x00020000
  s_add_u32 s33, s24, 49152
  s_mov_b32 s40, 113246208
  s_mov_b32 s26, 4294942720
  s_mov_b32 s27, 24576
  s_lshl_b32 s39, s20, 10
  s_mov_b32 s76, s40
  s_mov_b32 s77, 0
  s_mov_b32 s78, s40
  s_mov_b32 s79, 0
  s_mov_b32 s80, s40
  s_mov_b32 s81, 0
  s_lshr_b32 s34, s2, 1
  s_xor_b32 s34, s34, s2
  s_and_b32 s34, s34, 4
  s_and_b32 s51, s2, 1
  s_or_b32 s34, s34, s51
  s_lshl_b32 s34, s34, 19
  s_mov_b32 s35, -1
  v_lshrrev_b32 v35, 4, v0
  v_xor_b32 v22, s53, v20
  v_mul_u32_u24 v32, 43, v35
  v_lshrrev_b32 v32, 7, v32
  v_mul_u32_u24 v18, 3, v32
  v_sub_u32 v19, v35, v18
  v_add_u32 v19, s54, v19
  v_subrev_u32 v21, 3, v19
  v_min_u32 v19, v19, v21
  v_add_u32 v19, v19, v18
  v_xor_b32 v21, v32, v22
  v_lshlrev_b32 v21, 4, v21
  v_lshl_add_u32 v8, v19, 8, v21
  v_cmp_eq_u32 vcc, 5, v32
  s_nop 1
  v_cndmask_b32 v12, 0, -1, vcc
  v_add_u32 v36, 16, v35
  v_mul_u32_u24 v33, 43, v36
  v_lshrrev_b32 v33, 7, v33
  v_mul_u32_u24 v18, 3, v33
  v_sub_u32 v19, v36, v18
  v_add_u32 v19, s54, v19
  v_subrev_u32 v21, 3, v19
  v_min_u32 v19, v19, v21
  v_add_u32 v19, v19, v18
  v_xor_b32 v21, v33, v22
  v_lshlrev_b32 v21, 4, v21
  v_lshl_add_u32 v9, v19, 8, v21
  v_add_u32 v37, 32, v35
  v_mul_u32_u24 v34, 43, v37
  v_lshrrev_b32 v34, 7, v34
  v_mul_u32_u24 v18, 3, v34
  v_sub_u32 v19, v37, v18
  v_add_u32 v19, s54, v19
  v_subrev_u32 v21, 3, v19
  v_min_u32 v19, v19, v21
  v_add_u32 v19, v19, v18
  v_xor_b32 v21, v34, v22
  v_lshlrev_b32 v21, 4, v21
  v_lshl_add_u32 v10, v19, 8, v21
  v_cmp_eq_u32 vcc, 10, v34
  s_nop 1
  v_cndmask_b32 v11, 0, -1, vcc
  s_mov_b32 s8, s30
  s_and_b32 s9, s31, 0xffff
  s_mov_b32 s10, 113246208
  s_mov_b32 s11, 0x00020000
  v_lshlrev_b32 v80, 4, v0
  v_and_b32 v21, 7, v32
  v_xor_b32 v21, v21, v20
  v_lshlrev_b32 v21, 4, v21
  v_lshl_add_u32 v21, v35, 8, v21
  v_add_u32 v5, 98560, v21
  v_add_u32 v81, 4096, v80
  v_and_b32 v21, 7, v33
  v_xor_b32 v21, v21, v20
  v_lshlrev_b32 v21, 4, v21
  v_lshl_add_u32 v21, v36, 8, v21
  v_add_u32 v6, 98560, v21
  v_add_u32 v82, 8192, v80
  v_and_b32 v21, 7, v34
  v_xor_b32 v21, v21, v20
  v_lshlrev_b32 v21, 4, v21
  v_lshl_add_u32 v21, v37, 8, v21
  v_add_u32 v7, 98560, v21
  v_mul_u32_u24 v16, 0x300, v20
  v_xor_b32 v18, v17, v20
  v_lshl_add_u32 v1, v18, 4, v16
  v_xor_b32 v2, 64, v1
  v_xor_b32 v3, 128, v1
  v_xor_b32 v4, 192, v1
  s_mul_i32 s51, s20, 12
  v_and_b32 v18, 7, v20
  v_add_u32 v19, s51, v17
  v_xor_b32 v19, v19, v18
  v_lshl_add_u32 v86, v19, 4, v16
  v_add_u32 v86, 98560, v86
  v_add_u32 v19, s51, v17
  v_add_u32 v19, 4, v19
  v_xor_b32 v19, v19, v18
  v_lshl_add_u32 v87, v19, 4, v16
  v_add_u32 v87, 98560, v87
  v_bfe_u32 v18, v28, 2, 2
  v_and_b32 v19, 3, v28
  v_lshrrev_b32 v21, 1, v17
  v_lshl_add_u32 v21, v21, 3, v18
  v_mul_u32_u24 v21, 192, v21
  v_and_b32 v23, 1, v17
  v_mul_u32_u24 v23, 3080, v23
  v_add_u32 v21, v21, v23
  v_lshl_add_u32 v21, v19, 4, v21
  s_add_u32 s51, s49, 49152
  v_add_u32 v71, s51, v21
  v_add_u32 v67, 49408, v71
  s_add_u32 s51, s39, 147968
  v_lshl_add_u32 v68, v17, 4, s51
  v_and_b32 v21, 1, v28
  v_lshlrev_b32 v21, 4, v21
  v_mov_b32 v23, 0xffff
  v_lshlrev_b32 v21, v21, v23
  v_lshlrev_b32 v16, 1, v17
  v_bfe_u32 v23, v28, 1, 3
  v_cmp_eq_u32 vcc, v16, v23
  v_add_u32 v16, 1, v16
  s_nop 0
  v_cndmask_b32 v69, 0, v21, vcc
  v_cmp_eq_u32 vcc, v16, v23
  s_mov_b32 s16, s92
  s_and_b32 s17, s93, 0xffff
  s_mov_b32 s18, 256
  s_mov_b32 s19, 0x00020000
  v_cndmask_b32 v70, 0, v21, vcc
  s_add_u32 m0, s49, 123200
  s_add_u32 s50, s42, s46
  buffer_load_dwordx4 v64, s[12:15], s50 offen offset:0 lds
  buffer_load_dwordx4 v65, s[12:15], s50 offen offset:1024 lds
  buffer_load_dwordx4 v66, s[12:15], s50 offen offset:2048 lds
  s_add_u32 m0, s49, 126280
  s_add_u32 s50, s50, 6144
  buffer_load_dwordx4 v64, s[12:15], s50 offen offset:0 lds
  buffer_load_dwordx4 v65, s[12:15], s50 offen offset:1024 lds
  buffer_load_dwordx4 v66, s[12:15], s50 offen offset:2048 lds
  s_add_u32 m0, s49, 49152
  s_add_u32 s50, s42, s47
  buffer_load_dwordx4 v64, s[12:15], s50 offen offset:0 lds
  buffer_load_dwordx4 v65, s[12:15], s50 offen offset:1024 lds
  buffer_load_dwordx4 v66, s[12:15], s50 offen offset:2048 lds
  s_add_u32 m0, s49, 52232
  s_add_u32 s50, s50, 6144
  buffer_load_dwordx4 v64, s[12:15], s50 offen offset:0 lds
  buffer_load_dwordx4 v65, s[12:15], s50 offen offset:1024 lds
  buffer_load_dwordx4 v66, s[12:15], s50 offen offset:2048 lds
  s_cmp_lg_u32 s23, 0
  s_cbranch_scc1 L_npr
  s_mov_b32 s41, 0xffff
  s_mov_b32 s88, 0xffff
  s_lshl_b32 s52, s20, 2
  s_add_u32 s52, s52, 152064
  v_mov_b32 v16, s52
  s_waitcnt lgkmcnt(0)
  s_memtime s[84:85]
  s_load_dword s52, s[24:25], s37 glc
  s_waitcnt lgkmcnt(0)
  s_memtime s[86:87]
  s_load_dword s52, s[24:25], s38 glc
  s_waitcnt lgkmcnt(0)
  s_sub_u32 s51, s86, s84
  s_memtime s[84:85]
  s_min_u32 s41, s41, s51
  s_waitcnt lgkmcnt(0)
  s_sub_u32 s51, s84, s86
  s_min_u32 s88, s88, s51
  s_lshl_b32 s41, s41, 16
  s_or_b32 s41, s41, s88
  v_mov_b32 v18, s41
  ds_write_b32 v16, v18
  s_waitcnt lgkmcnt(0)
L_npr:
  s_add_u32 m0, s49, 73792
  s_add_u32 s50, s42, s48
  buffer_load_dwordx4 v64, s[12:15], s50 offen offset:0 lds
  buffer_load_dwordx4 v65, s[12:15], s50 offen offset:1024 lds
  buffer_load_dwordx4 v66, s[12:15], s50 offen offset:2048 lds
  s_add_u32 m0, s49, 76872
  s_add_u32 s50, s50, 6144
  buffer_load_dwordx4 v64, s[12:15], s50 offen offset:0 lds
  buffer_load_dwordx4 v65, s[12:15], s50 offen offset:1024 lds
  buffer_load_dwordx4 v66, s[12:15], s50 offen offset:2048 lds
  s_waitcnt vmcnt(18)
  ds_read_b128 v[72:75], v68 offset:0
  ds_read_b64_tr_b16 a[192:193], v67 offset:0
  ds_read_b64_tr_b16 a[194:195], v67 offset:768
  ds_read_b64_tr_b16 a[196:197], v67 offset:8
  ds_read_b64_tr_b16 a[198:199], v67 offset:776
  ds_read_b64_tr_b16 a[200:201], v67 offset:64
  ds_read_b64_tr_b16 a[202:203], v67 offset:832
  ds_read_b64_tr_b16 a[204:205], v67 offset:72
  ds_read_b64_tr_b16 a[206:207], v67 offset:840
  ds_read_b64_tr_b16 a[208:209], v67 offset:128
  ds_read_b64_tr_b16 a[210:211], v67 offset:896
  ds_read_b64_tr_b16 a[212:213], v67 offset:136
  ds_read_b64_tr_b16 a[214:215], v67 offset:904
  s_waitcnt lgkmcnt(0)
  v_and_b32 v72, v69, v72
  v_and_b32 v73, v70, v73
  v_and_b32 v74, v69, v74
  v_and_b32 v75, v70, v75
  s_waitcnt vmcnt(12)
  ds_read_b128 v[76:79], v68 offset:64
  v_mfma_f32_16x16x16_bf16 v[16:19], v[72:73], a[192:193], 0
  ds_read_b64_tr_b16 a[216:217], v67 offset:24640
  ds_read_b64_tr_b16 a[218:219], v67 offset:25408
  v_mfma_f32_16x16x16_bf16 v[20:23], v[74:75], a[194:195], 0
  ds_read_b64_tr_b16 a[220:221], v67 offset:24648
  ds_read_b64_tr_b16 a[222:223], v67 offset:25416
  v_mfma_f32_16x16x16_bf16 v[24:27], v[72:73], a[196:197], 0
  ds_read_b64_tr_b16 a[224:225], v67 offset:24704
  ds_read_b64_tr_b16 a[226:227], v67 offset:25472
  v_mfma_f32_16x16x16_bf16 v[28:31], v[74:75], a[198:199], 0
  ds_read_b64_tr_b16 a[228:229], v67 offset:24712
  ds_read_b64_tr_b16 a[230:231], v67 offset:25480
  v_mfma_f32_16x16x16_bf16 v[32:35], v[72:73], a[200:201], 0
  ds_read_b64_tr_b16 a[232:233], v67 offset:24768
  ds_read_b64_tr_b16 a[234:235], v67 offset:25536
  v_cvt_pk_bf16_f32 v88, v16, v17
  v_cvt_pk_bf16_f32 v89, v18, v19
  v_mfma_f32_16x16x16_bf16 v[36:39], v[74:75], a[202:203], 0
  ds_read_b64_tr_b16 a[236:237], v67 offset:24776
  ds_read_b64_tr_b16 a[238:239], v67 offset:25544
  v_cvt_pk_bf16_f32 v90, v20, v21
  v_cvt_pk_bf16_f32 v91, v22, v23
  v_mfma_f32_16x16x16_bf16 v[40:43], v[72:73], a[204:205], 0
  s_add_u32 m0, s49, 98560
  s_add_u32 s50, s43, s45
  v_cvt_pk_bf16_f32 v92, v24, v25
  v_cvt_pk_bf16_f32 v93, v26, v27
  v_mfma_f32_16x16x16_bf16 v[44:47], v[74:75], a[206:207], 0
  buffer_load_dwordx4 v64, s[12:15], s50 offen offset:0 lds
  buffer_load_dwordx4 v65, s[12:15], s50 offen offset:1024 lds
  v_cvt_pk_bf16_f32 v94, v28, v29
  v_cvt_pk_bf16_f32 v95, v30, v31
  v_mfma_f32_16x16x16_bf16 v[48:51], v[72:73], a[208:209], 0
  buffer_load_dwordx4 v66, s[12:15], s50 offen offset:2048 lds
  s_add_u32 m0, s49, 101640
  v_cvt_pk_bf16_f32 v96, v32, v33
  v_cvt_pk_bf16_f32 v97, v34, v35
  v_mfma_f32_16x16x16_bf16 v[52:55], v[74:75], a[210:211], 0
  s_add_u32 s50, s50, 6144
  buffer_load_dwordx4 v64, s[12:15], s50 offen offset:0 lds
  v_cvt_pk_bf16_f32 v98, v36, v37
  v_cvt_pk_bf16_f32 v99, v38, v39
  v_mfma_f32_16x16x16_bf16 v[56:59], v[72:73], a[212:213], 0
  buffer_load_dwordx4 v65, s[12:15], s50 offen offset:1024 lds
  v_cvt_pk_bf16_f32 v100, v40, v41
  v_cvt_pk_bf16_f32 v101, v42, v43
  v_mfma_f32_16x16x16_bf16 v[60:63], v[74:75], a[214:215], 0
  buffer_load_dwordx4 v66, s[12:15], s50 offen offset:2048 lds
  v_cvt_pk_bf16_f32 v102, v44, v45
  v_cvt_pk_bf16_f32 v103, v46, v47
  s_cmp_lg_u32 s23, 0
  s_cbranch_scc1 L_np1
  s_barrier
  s_or_b32 s51, s23, s20
  s_cmp_lg_u32 s51, 0
  s_cbranch_scc1 L_np1
  v_mov_b32 v248, 152064
  ds_read_b128 v[240:243], v248
  s_add_u32 s51, s24, s37
  s_lshr_b32 s52, s51, 20
  s_lshr_b32 s50, s2, 1
  s_xor_b32 s52, s52, s50
  s_and_b32 s52, s52, 2
  s_lshr_b32 s51, s51, 17
  s_and_b32 s51, s51, 4
  s_or_b32 s51, s51, s52
  s_or_b32 s51, s51, 1
  v_mov_b32 v251, 0
  v_mov_b32 v248, s36
  s_waitcnt lgkmcnt(0)
  v_pk_min_u16 v240, v240, v241
  v_pk_min_u16 v242, v242, v243
  v_pk_min_u16 v240, v240, v242
  v_lshrrev_b32 v241, 16, v240
  v_and_b32 v240, 0xffff, v240
  v_cmp_gt_u32 vcc, v241, v240
  v_min_u32 v242, v240, v241
  s_nop 0
  v_cndmask_b32 v250, 0, 2, vcc
  v_xor_b32 v250, s51, v250
  s_mov_b64 exec, 1
  v_lshl_or_b32 v250, v242, 16, v250
  buffer_atomic_cmpswap v[250:251], v248, s[16:19], 0 offen sc1
  s_mov_b64 exec, -1
L_np1:
  s_waitcnt lgkmcnt(0)
  v_and_b32 v76, v69, v76
  v_and_b32 v77, v70, v77
  v_and_b32 v78, v69, v78
  v_and_b32 v79, v70, v79
  s_waitcnt vmcnt(12)
  ds_read_b128 v[72:75], v68 offset:128
  v_mfma_f32_16x16x16_bf16 v[16:19], v[76:77], a[216:217], 0
  ds_read_b64_tr_b16 a[192:193], v71 offset:0
  ds_read_b64_tr_b16 a[194:195], v71 offset:768
  v_cvt_pk_bf16_f32 v104, v48, v49
  v_cvt_pk_bf16_f32 v105, v50, v51
  v_mfma_f32_16x16x16_bf16 v[20:23], v[78:79], a[218:219], 0
  ds_read_b64_tr_b16 a[196:197], v71 offset:8
  ds_read_b64_tr_b16 a[198:199], v71 offset:776
  v_cvt_pk_bf16_f32 v106, v52, v53
  v_cvt_pk_bf16_f32 v107, v54, v55
  v_mfma_f32_16x16x16_bf16 v[24:27], v[76:77], a[220:221], 0
  ds_read_b64_tr_b16 a[200:201], v71 offset:64
  ds_read_b64_tr_b16 a[202:203], v71 offset:832
  v_cvt_pk_bf16_f32 v108, v56, v57
  v_cvt_pk_bf16_f32 v109, v58, v59
  v_mfma_f32_16x16x16_bf16 v[28:31], v[78:79], a[222:223], 0
  ds_read_b64_tr_b16 a[204:205], v71 offset:72
  ds_read_b64_tr_b16 a[206:207], v71 offset:840
  v_cvt_pk_bf16_f32 v110, v60, v61
  v_cvt_pk_bf16_f32 v111, v62, v63
  v_mfma_f32_16x16x16_bf16 v[32:35], v[76:77], a[224:225], 0
  ds_read_b64_tr_b16 a[208:209], v71 offset:128
  ds_read_b64_tr_b16 a[210:211], v71 offset:896
  v_cvt_pk_bf16_f32 v16, v16, v17
  v_cvt_pk_bf16_f32 v17, v18, v19
  v_accvgpr_write_b32 a0, v16
  v_accvgpr_write_b32 a1, v17
  v_mfma_f32_16x16x16_bf16 v[36:39], v[78:79], a[226:227], 0
  ds_read_b64_tr_b16 a[212:213], v71 offset:136
  ds_read_b64_tr_b16 a[214:215], v71 offset:904
  v_cvt_pk_bf16_f32 v20, v20, v21
  v_cvt_pk_bf16_f32 v21, v22, v23
  v_accvgpr_write_b32 a2, v20
  v_accvgpr_write_b32 a3, v21
  v_mfma_f32_16x16x16_bf16 v[40:43], v[76:77], a[228:229], 0
  s_add_u32 m0, s49, 123200
  s_add_u32 s50, s43, s46
  v_cvt_pk_bf16_f32 v24, v24, v25
  v_cvt_pk_bf16_f32 v25, v26, v27
  v_accvgpr_write_b32 a4, v24
  v_accvgpr_write_b32 a5, v25
  v_mfma_f32_16x16x16_bf16 v[44:47], v[78:79], a[230:231], 0
  buffer_load_dwordx4 v64, s[12:15], s50 offen offset:0 lds
  buffer_load_dwordx4 v65, s[12:15], s50 offen offset:1024 lds
  v_cvt_pk_bf16_f32 v28, v28, v29
  v_cvt_pk_bf16_f32 v29, v30, v31
  v_accvgpr_write_b32 a6, v28
  v_accvgpr_write_b32 a7, v29
  v_mfma_f32_16x16x16_bf16 v[48:51], v[76:77], a[232:233], 0
  buffer_load_dwordx4 v66, s[12:15], s50 offen offset:2048 lds
  s_add_u32 m0, s49, 126280
  v_cvt_pk_bf16_f32 v32, v32, v33
  v_cvt_pk_bf16_f32 v33, v34, v35
  v_accvgpr_write_b32 a8, v32
  v_accvgpr_write_b32 a9, v33
  v_mfma_f32_16x16x16_bf16 v[52:55], v[78:79], a[234:235], 0
  s_add_u32 s50, s50, 6144
  buffer_load_dwordx4 v64, s[12:15], s50 offen offset:0 lds
  v_cvt_pk_bf16_f32 v36, v36, v37
  v_cvt_pk_bf16_f32 v37, v38, v39
  v_accvgpr_write_b32 a10, v36
  v_accvgpr_write_b32 a11, v37
  v_mfma_f32_16x16x16_bf16 v[56:59], v[76:77], a[236:237], 0
  buffer_load_dwordx4 v65, s[12:15], s50 offen offset:1024 lds
  v_cvt_pk_bf16_f32 v40, v40, v41
  v_cvt_pk_bf16_f32 v41, v42, v43
  v_accvgpr_write_b32 a12, v40
  v_accvgpr_write_b32 a13, v41
  v_mfma_f32_16x16x16_bf16 v[60:63], v[78:79], a[238:239], 0
  buffer_load_dwordx4 v66, s[12:15], s50 offen offset:2048 lds
  v_cvt_pk_bf16_f32 v44, v44, v45
  v_cvt_pk_bf16_f32 v45, v46, v47
  v_accvgpr_write_b32 a14, v44
  v_accvgpr_write_b32 a15, v45
  s_waitcnt lgkmcnt(0)
  v_and_b32 v72, v69, v72
  v_and_b32 v73, v70, v73
  v_and_b32 v74, v69, v74
  v_and_b32 v75, v70, v75
  s_waitcnt vmcnt(12)
  ds_read_b128 v[76:79], v68 offset:192
  v_mfma_f32_16x16x16_bf16 v[16:19], v[72:73], a[192:193], 0
  ds_read_b64_tr_b16 a[216:217], v71 offset:24640
  ds_read_b64_tr_b16 a[218:219], v71 offset:25408
  v_cvt_pk_bf16_f32 v48, v48, v49
  v_cvt_pk_bf16_f32 v49, v50, v51
  v_accvgpr_write_b32 a16, v48
  v_accvgpr_write_b32 a17, v49
  v_mfma_f32_16x16x16_bf16 v[20:23], v[74:75], a[194:195], 0
  ds_read_b64_tr_b16 a[220:221], v71 offset:24648
  ds_read_b64_tr_b16 a[222:223], v71 offset:25416
  v_cvt_pk_bf16_f32 v52, v52, v53
  v_cvt_pk_bf16_f32 v53, v54, v55
  v_accvgpr_write_b32 a18, v52
  v_accvgpr_write_b32 a19, v53
  v_mfma_f32_16x16x16_bf16 v[24:27], v[72:73], a[196:197], 0
  ds_read_b64_tr_b16 a[224:225], v71 offset:24704
  ds_read_b64_tr_b16 a[226:227], v71 offset:25472
  v_cvt_pk_bf16_f32 v56, v56, v57
  v_cvt_pk_bf16_f32 v57, v58, v59
  v_accvgpr_write_b32 a20, v56
  v_accvgpr_write_b32 a21, v57
  v_mfma_f32_16x16x16_bf16 v[28:31], v[74:75], a[198:199], 0
  ds_read_b64_tr_b16 a[228:229], v71 offset:24712
  ds_read_b64_tr_b16 a[230:231], v71 offset:25480
  v_cvt_pk_bf16_f32 v60, v60, v61
  v_cvt_pk_bf16_f32 v61, v62, v63
  v_accvgpr_write_b32 a22, v60
  v_accvgpr_write_b32 a23, v61
  v_mfma_f32_16x16x16_bf16 v[32:35], v[72:73], a[200:201], 0
  ds_read_b64_tr_b16 a[232:233], v71 offset:24768
  ds_read_b64_tr_b16 a[234:235], v71 offset:25536
  v_cvt_pk_bf16_f32 v112, v16, v17
  v_cvt_pk_bf16_f32 v113, v18, v19
  v_mfma_f32_16x16x16_bf16 v[36:39], v[74:75], a[202:203], 0
  ds_read_b64_tr_b16 a[236:237], v71 offset:24776
  ds_read_b64_tr_b16 a[238:239], v71 offset:25544
  v_cvt_pk_bf16_f32 v114, v20, v21
  v_cvt_pk_bf16_f32 v115, v22, v23
  v_mfma_f32_16x16x16_bf16 v[40:43], v[72:73], a[204:205], 0
  s_add_u32 m0, s49, 49152
  s_add_u32 s50, s43, s47
  v_cvt_pk_bf16_f32 v116, v24, v25
  v_cvt_pk_bf16_f32 v117, v26, v27
  v_mfma_f32_16x16x16_bf16 v[44:47], v[74:75], a[206:207], 0
  buffer_load_dwordx4 v64, s[12:15], s50 offen offset:0 lds
  buffer_load_dwordx4 v65, s[12:15], s50 offen offset:1024 lds
  v_cvt_pk_bf16_f32 v118, v28, v29
  v_cvt_pk_bf16_f32 v119, v30, v31
  v_mfma_f32_16x16x16_bf16 v[48:51], v[72:73], a[208:209], 0
  buffer_load_dwordx4 v66, s[12:15], s50 offen offset:2048 lds
  s_add_u32 m0, s49, 52232
  v_cvt_pk_bf16_f32 v120, v32, v33
  v_cvt_pk_bf16_f32 v121, v34, v35
  v_mfma_f32_16x16x16_bf16 v[52:55], v[74:75], a[210:211], 0
  s_add_u32 s50, s50, 6144
  buffer_load_dwordx4 v64, s[12:15], s50 offen offset:0 lds
  v_cvt_pk_bf16_f32 v122, v36, v37
  v_cvt_pk_bf16_f32 v123, v38, v39
  v_mfma_f32_16x16x16_bf16 v[56:59], v[72:73], a[212:213], 0
  buffer_load_dwordx4 v65, s[12:15], s50 offen offset:1024 lds
  v_cvt_pk_bf16_f32 v124, v40, v41
  v_cvt_pk_bf16_f32 v125, v42, v43
  v_mfma_f32_16x16x16_bf16 v[60:63], v[74:75], a[214:215], 0
  buffer_load_dwordx4 v66, s[12:15], s50 offen offset:2048 lds
  v_cvt_pk_bf16_f32 v126, v44, v45
  v_cvt_pk_bf16_f32 v127, v46, v47
  s_waitcnt lgkmcnt(0)
  v_and_b32 v76, v69, v76
  v_and_b32 v77, v70, v77
  v_and_b32 v78, v69, v78
  v_and_b32 v79, v70, v79
  s_waitcnt vmcnt(12)
  ds_read_b128 v[72:75], v68 offset:256
  v_mfma_f32_16x16x16_bf16 v[16:19], v[76:77], a[216:217], 0
  ds_read_b64_tr_b16 a[192:193], v67 offset:0
  ds_read_b64_tr_b16 a[194:195], v67 offset:768
  v_cvt_pk_bf16_f32 v128, v48, v49
  v_cvt_pk_bf16_f32 v129, v50, v51
  v_mfma_f32_16x16x16_bf16 v[20:23], v[78:79], a[218:219], 0
  ds_read_b64_tr_b16 a[196:197], v67 offset:8
  ds_read_b64_tr_b16 a[198:199], v67 offset:776
  v_cvt_pk_bf16_f32 v130, v52, v53
  v_cvt_pk_bf16_f32 v131, v54, v55
  v_mfma_f32_16x16x16_bf16 v[24:27], v[76:77], a[220:221], 0
  ds_read_b64_tr_b16 a[200:201], v67 offset:64
  ds_read_b64_tr_b16 a[202:203], v67 offset:832
  v_cvt_pk_bf16_f32 v132, v56, v57
  v_cvt_pk_bf16_f32 v133, v58, v59
  v_mfma_f32_16x16x16_bf16 v[28:31], v[78:79], a[222:223], 0
  ds_read_b64_tr_b16 a[204:205], v67 offset:72
  ds_read_b64_tr_b16 a[206:207], v67 offset:840
  v_cvt_pk_bf16_f32 v134, v60, v61
  v_cvt_pk_bf16_f32 v135, v62, v63
  v_mfma_f32_16x16x16_bf16 v[32:35], v[76:77], a[224:225], 0
  ds_read_b64_tr_b16 a[208:209], v67 offset:128
  ds_read_b64_tr_b16 a[210:211], v67 offset:896
  v_cvt_pk_bf16_f32 v16, v16, v17
  v_cvt_pk_bf16_f32 v17, v18, v19
  v_accvgpr_write_b32 a24, v16
  v_accvgpr_write_b32 a25, v17
  v_mfma_f32_16x16x16_bf16 v[36:39], v[78:79], a[226:227], 0
  ds_read_b64_tr_b16 a[212:213], v67 offset:136
  ds_read_b64_tr_b16 a[214:215], v67 offset:904
  v_cvt_pk_bf16_f32 v20, v20, v21
  v_cvt_pk_bf16_f32 v21, v22, v23
  v_accvgpr_write_b32 a26, v20
  v_accvgpr_write_b32 a27, v21
  v_mfma_f32_16x16x16_bf16 v[40:43], v[76:77], a[228:229], 0
  s_add_u32 m0, s49, 73792
  s_add_u32 s50, s43, s48
  v_cvt_pk_bf16_f32 v24, v24, v25
  v_cvt_pk_bf16_f32 v25, v26, v27
  v_accvgpr_write_b32 a28, v24
  v_accvgpr_write_b32 a29, v25
  v_mfma_f32_16x16x16_bf16 v[44:47], v[78:79], a[230:231], 0
  buffer_load_dwordx4 v64, s[12:15], s50 offen offset:0 lds
  buffer_load_dwordx4 v65, s[12:15], s50 offen offset:1024 lds
  v_cvt_pk_bf16_f32 v28, v28, v29
  v_cvt_pk_bf16_f32 v29, v30, v31
  v_accvgpr_write_b32 a30, v28
  v_accvgpr_write_b32 a31, v29
  v_mfma_f32_16x16x16_bf16 v[48:51], v[76:77], a[232:233], 0
  buffer_load_dwordx4 v66, s[12:15], s50 offen offset:2048 lds
  s_add_u32 m0, s49, 76872
  v_cvt_pk_bf16_f32 v32, v32, v33
  v_cvt_pk_bf16_f32 v33, v34, v35
  v_accvgpr_write_b32 a32, v32
  v_accvgpr_write_b32 a33, v33
  v_mfma_f32_16x16x16_bf16 v[52:55], v[78:79], a[234:235], 0
  s_add_u32 s50, s50, 6144
  buffer_load_dwordx4 v64, s[12:15], s50 offen offset:0 lds
  v_cvt_pk_bf16_f32 v36, v36, v37
  v_cvt_pk_bf16_f32 v37, v38, v39
  v_accvgpr_write_b32 a34, v36
  v_accvgpr_write_b32 a35, v37
  v_mfma_f32_16x16x16_bf16 v[56:59], v[76:77], a[236:237], 0
  buffer_load_dwordx4 v65, s[12:15], s50 offen offset:1024 lds
  v_cvt_pk_bf16_f32 v40, v40, v41
  v_cvt_pk_bf16_f32 v41, v42, v43
  v_accvgpr_write_b32 a36, v40
  v_accvgpr_write_b32 a37, v41
  v_mfma_f32_16x16x16_bf16 v[60:63], v[78:79], a[238:239], 0
  buffer_load_dwordx4 v66, s[12:15], s50 offen offset:2048 lds
  v_cvt_pk_bf16_f32 v44, v44, v45
  v_cvt_pk_bf16_f32 v45, v46, v47
  v_accvgpr_write_b32 a38, v44
  v_accvgpr_write_b32 a39, v45
  s_waitcnt lgkmcnt(0)
  v_and_b32 v72, v69, v72
  v_and_b32 v73, v70, v73
  v_and_b32 v74, v69, v74
  v_and_b32 v75, v70, v75
  s_waitcnt vmcnt(12)
  ds_read_b128 v[76:79], v68 offset:320
  v_mfma_f32_16x16x16_bf16 v[16:19], v[72:73], a[192:193], 0
  ds_read_b64_tr_b16 a[216:217], v67 offset:24640
  ds_read_b64_tr_b16 a[218:219], v67 offset:25408
  v_cvt_pk_bf16_f32 v48, v48, v49
  v_cvt_pk_bf16_f32 v49, v50, v51
  v_accvgpr_write_b32 a40, v48
  v_accvgpr_write_b32 a41, v49
  v_mfma_f32_16x16x16_bf16 v[20:23], v[74:75], a[194:195], 0
  ds_read_b64_tr_b16 a[220:221], v67 offset:24648
  ds_read_b64_tr_b16 a[222:223], v67 offset:25416
  v_cvt_pk_bf16_f32 v52, v52, v53
  v_cvt_pk_bf16_f32 v53, v54, v55
  v_accvgpr_write_b32 a42, v52
  v_accvgpr_write_b32 a43, v53
  v_mfma_f32_16x16x16_bf16 v[24:27], v[72:73], a[196:197], 0
  ds_read_b64_tr_b16 a[224:225], v67 offset:24704
  ds_read_b64_tr_b16 a[226:227], v67 offset:25472
  v_cvt_pk_bf16_f32 v56, v56, v57
  v_cvt_pk_bf16_f32 v57, v58, v59
  v_accvgpr_write_b32 a44, v56
  v_accvgpr_write_b32 a45, v57
  v_mfma_f32_16x16x16_bf16 v[28:31], v[74:75], a[198:199], 0
  ds_read_b64_tr_b16 a[228:229], v67 offset:24712
  ds_read_b64_tr_b16 a[230:231], v67 offset:25480
  v_cvt_pk_bf16_f32 v60, v60, v61
  v_cvt_pk_bf16_f32 v61, v62, v63
  v_accvgpr_write_b32 a46, v60
  v_accvgpr_write_b32 a47, v61
  v_mfma_f32_16x16x16_bf16 v[32:35], v[72:73], a[200:201], 0
  ds_read_b64_tr_b16 a[232:233], v67 offset:24768
  ds_read_b64_tr_b16 a[234:235], v67 offset:25536
  v_cvt_pk_bf16_f32 v136, v16, v17
  v_cvt_pk_bf16_f32 v137, v18, v19
  v_mfma_f32_16x16x16_bf16 v[36:39], v[74:75], a[202:203], 0
  ds_read_b64_tr_b16 a[236:237], v67 offset:24776
  ds_read_b64_tr_b16 a[238:239], v67 offset:25544
  v_cvt_pk_bf16_f32 v138, v20, v21
  v_cvt_pk_bf16_f32 v139, v22, v23
  v_mfma_f32_16x16x16_bf16 v[40:43], v[72:73], a[204:205], 0
  s_add_u32 m0, s49, 98560
  s_add_u32 s50, s44, s45
  v_cvt_pk_bf16_f32 v140, v24, v25
  v_cvt_pk_bf16_f32 v141, v26, v27
  v_mfma_f32_16x16x16_bf16 v[44:47], v[74:75], a[206:207], 0
  buffer_load_dwordx4 v64, s[12:15], s50 offen offset:0 lds
  buffer_load_dwordx4 v65, s[12:15], s50 offen offset:1024 lds
  v_cvt_pk_bf16_f32 v142, v28, v29
  v_cvt_pk_bf16_f32 v143, v30, v31
  v_mfma_f32_16x16x16_bf16 v[48:51], v[72:73], a[208:209], 0
  buffer_load_dwordx4 v66, s[12:15], s50 offen offset:2048 lds
  s_add_u32 m0, s49, 101640
  v_cvt_pk_bf16_f32 v144, v32, v33
  v_cvt_pk_bf16_f32 v145, v34, v35
  v_mfma_f32_16x16x16_bf16 v[52:55], v[74:75], a[210:211], 0
  s_add_u32 s50, s50, 6144
  buffer_load_dwordx4 v64, s[12:15], s50 offen offset:0 lds
  v_cvt_pk_bf16_f32 v146, v36, v37
  v_cvt_pk_bf16_f32 v147, v38, v39
  v_mfma_f32_16x16x16_bf16 v[56:59], v[72:73], a[212:213], 0
  buffer_load_dwordx4 v65, s[12:15], s50 offen offset:1024 lds
  v_cvt_pk_bf16_f32 v148, v40, v41
  v_cvt_pk_bf16_f32 v149, v42, v43
  v_mfma_f32_16x16x16_bf16 v[60:63], v[74:75], a[214:215], 0
  buffer_load_dwordx4 v66, s[12:15], s50 offen offset:2048 lds
  v_cvt_pk_bf16_f32 v150, v44, v45
  v_cvt_pk_bf16_f32 v151, v46, v47
  s_waitcnt lgkmcnt(0)
  v_and_b32 v76, v69, v76
  v_and_b32 v77, v70, v77
  v_and_b32 v78, v69, v78
  v_and_b32 v79, v70, v79
  s_waitcnt vmcnt(12)
  ds_read_b128 v[72:75], v68 offset:384
  v_mfma_f32_16x16x16_bf16 v[16:19], v[76:77], a[216:217], 0
  ds_read_b64_tr_b16 a[192:193], v71 offset:0
  ds_read_b64_tr_b16 a[194:195], v71 offset:768
  v_cvt_pk_bf16_f32 v152, v48, v49
  v_cvt_pk_bf16_f32 v153, v50, v51
  v_mfma_f32_16x16x16_bf16 v[20:23], v[78:79], a[218:219], 0
  ds_read_b64_tr_b16 a[196:197], v71 offset:8
  ds_read_b64_tr_b16 a[198:199], v71 offset:776
  v_cvt_pk_bf16_f32 v154, v52, v53
  v_cvt_pk_bf16_f32 v155, v54, v55
  v_mfma_f32_16x16x16_bf16 v[24:27], v[76:77], a[220:221], 0
  ds_read_b64_tr_b16 a[200:201], v71 offset:64
  ds_read_b64_tr_b16 a[202:203], v71 offset:832
  v_cvt_pk_bf16_f32 v156, v56, v57
  v_cvt_pk_bf16_f32 v157, v58, v59
  v_mfma_f32_16x16x16_bf16 v[28:31], v[78:79], a[222:223], 0
  ds_read_b64_tr_b16 a[204:205], v71 offset:72
  ds_read_b64_tr_b16 a[206:207], v71 offset:840
  v_cvt_pk_bf16_f32 v158, v60, v61
  v_cvt_pk_bf16_f32 v159, v62, v63
  v_mfma_f32_16x16x16_bf16 v[32:35], v[76:77], a[224:225], 0
  ds_read_b64_tr_b16 a[208:209], v71 offset:128
  ds_read_b64_tr_b16 a[210:211], v71 offset:896
  v_cvt_pk_bf16_f32 v16, v16, v17
  v_cvt_pk_bf16_f32 v17, v18, v19
  v_accvgpr_write_b32 a48, v16
  v_accvgpr_write_b32 a49, v17
  v_mfma_f32_16x16x16_bf16 v[36:39], v[78:79], a[226:227], 0
  ds_read_b64_tr_b16 a[212:213], v71 offset:136
  ds_read_b64_tr_b16 a[214:215], v71 offset:904
  v_cvt_pk_bf16_f32 v20, v20, v21
  v_cvt_pk_bf16_f32 v21, v22, v23
  v_accvgpr_write_b32 a50, v20
  v_accvgpr_write_b32 a51, v21
  v_mfma_f32_16x16x16_bf16 v[40:43], v[76:77], a[228:229], 0
  s_add_u32 m0, s49, 123200
  s_add_u32 s50, s44, s46
  v_cvt_pk_bf16_f32 v24, v24, v25
  v_cvt_pk_bf16_f32 v25, v26, v27
  v_accvgpr_write_b32 a52, v24
  v_accvgpr_write_b32 a53, v25
  v_mfma_f32_16x16x16_bf16 v[44:47], v[78:79], a[230:231], 0
  buffer_load_dwordx4 v64, s[12:15], s50 offen offset:0 lds
  buffer_load_dwordx4 v65, s[12:15], s50 offen offset:1024 lds
  v_cvt_pk_bf16_f32 v28, v28, v29
  v_cvt_pk_bf16_f32 v29, v30, v31
  v_accvgpr_write_b32 a54, v28
  v_accvgpr_write_b32 a55, v29
  v_mfma_f32_16x16x16_bf16 v[48:51], v[76:77], a[232:233], 0
  buffer_load_dwordx4 v66, s[12:15], s50 offen offset:2048 lds
  s_add_u32 m0, s49, 126280
  v_cvt_pk_bf16_f32 v32, v32, v33
  v_cvt_pk_bf16_f32 v33, v34, v35
  v_accvgpr_write_b32 a56, v32
  v_accvgpr_write_b32 a57, v33
  v_mfma_f32_16x16x16_bf16 v[52:55], v[78:79], a[234:235], 0
  s_add_u32 s50, s50, 6144
  buffer_load_dwordx4 v64, s[12:15], s50 offen offset:0 lds
  v_cvt_pk_bf16_f32 v36, v36, v37
  v_cvt_pk_bf16_f32 v37, v38, v39
  v_accvgpr_write_b32 a58, v36
  v_accvgpr_write_b32 a59, v37
  v_mfma_f32_16x16x16_bf16 v[56:59], v[76:77], a[236:237], 0
  buffer_load_dwordx4 v65, s[12:15], s50 offen offset:1024 lds
  v_cvt_pk_bf16_f32 v40, v40, v41
  v_cvt_pk_bf16_f32 v41, v42, v43
  v_accvgpr_write_b32 a60, v40
  v_accvgpr_write_b32 a61, v41
  v_mfma_f32_16x16x16_bf16 v[60:63], v[78:79], a[238:239], 0
  buffer_load_dwordx4 v66, s[12:15], s50 offen offset:2048 lds
  v_cvt_pk_bf16_f32 v44, v44, v45
  v_cvt_pk_bf16_f32 v45, v46, v47
  v_accvgpr_write_b32 a62, v44
  v_accvgpr_write_b32 a63, v45
  s_waitcnt lgkmcnt(0)
  v_and_b32 v72, v69, v72
  v_and_b32 v73, v70, v73
  v_and_b32 v74, v69, v74
  v_and_b32 v75, v70, v75
  s_waitcnt vmcnt(12)
  ds_read_b128 v[76:79], v68 offset:448
  v_mfma_f32_16x16x16_bf16 v[16:19], v[72:73], a[192:193], 0
  ds_read_b64_tr_b16 a[216:217], v71 offset:24640
  ds_read_b64_tr_b16 a[218:219], v71 offset:25408
  v_cvt_pk_bf16_f32 v48, v48, v49
  v_cvt_pk_bf16_f32 v49, v50, v51
  v_accvgpr_write_b32 a64, v48
  v_accvgpr_write_b32 a65, v49
  v_mfma_f32_16x16x16_bf16 v[20:23], v[74:75], a[194:195], 0
  ds_read_b64_tr_b16 a[220:221], v71 offset:24648
  ds_read_b64_tr_b16 a[222:223], v71 offset:25416
  v_cvt_pk_bf16_f32 v52, v52, v53
  v_cvt_pk_bf16_f32 v53, v54, v55
  v_accvgpr_write_b32 a66, v52
  v_accvgpr_write_b32 a67, v53
  v_mfma_f32_16x16x16_bf16 v[24:27], v[72:73], a[196:197], 0
  ds_read_b64_tr_b16 a[224:225], v71 offset:24704
  ds_read_b64_tr_b16 a[226:227], v71 offset:25472
  v_cvt_pk_bf16_f32 v56, v56, v57
  v_cvt_pk_bf16_f32 v57, v58, v59
  v_accvgpr_write_b32 a68, v56
  v_accvgpr_write_b32 a69, v57
  v_mfma_f32_16x16x16_bf16 v[28:31], v[74:75], a[198:199], 0
  ds_read_b64_tr_b16 a[228:229], v71 offset:24712
  ds_read_b64_tr_b16 a[230:231], v71 offset:25480
  v_cvt_pk_bf16_f32 v60, v60, v61
  v_cvt_pk_bf16_f32 v61, v62, v63
  v_accvgpr_write_b32 a70, v60
  v_accvgpr_write_b32 a71, v61
  v_mfma_f32_16x16x16_bf16 v[32:35], v[72:73], a[200:201], 0
  ds_read_b64_tr_b16 a[232:233], v71 offset:24768
  ds_read_b64_tr_b16 a[234:235], v71 offset:25536
  v_cvt_pk_bf16_f32 v160, v16, v17
  v_cvt_pk_bf16_f32 v161, v18, v19
  v_mfma_f32_16x16x16_bf16 v[36:39], v[74:75], a[202:203], 0
  ds_read_b64_tr_b16 a[236:237], v71 offset:24776
  ds_read_b64_tr_b16 a[238:239], v71 offset:25544
  v_cvt_pk_bf16_f32 v162, v20, v21
  v_cvt_pk_bf16_f32 v163, v22, v23
  v_mfma_f32_16x16x16_bf16 v[40:43], v[72:73], a[204:205], 0
  s_add_u32 m0, s49, 49152
  s_add_u32 s50, s44, s47
  v_cvt_pk_bf16_f32 v164, v24, v25
  v_cvt_pk_bf16_f32 v165, v26, v27
  v_mfma_f32_16x16x16_bf16 v[44:47], v[74:75], a[206:207], 0
  buffer_load_dwordx4 v64, s[12:15], s50 offen offset:0 lds
  buffer_load_dwordx4 v65, s[12:15], s50 offen offset:1024 lds
  v_cvt_pk_bf16_f32 v166, v28, v29
  v_cvt_pk_bf16_f32 v167, v30, v31
  v_mfma_f32_16x16x16_bf16 v[48:51], v[72:73], a[208:209], 0
  buffer_load_dwordx4 v66, s[12:15], s50 offen offset:2048 lds
  s_add_u32 m0, s49, 52232
  v_cvt_pk_bf16_f32 v168, v32, v33
  v_cvt_pk_bf16_f32 v169, v34, v35
  v_mfma_f32_16x16x16_bf16 v[52:55], v[74:75], a[210:211], 0
  s_add_u32 s50, s50, 6144
  buffer_load_dwordx4 v64, s[12:15], s50 offen offset:0 lds
  v_cvt_pk_bf16_f32 v170, v36, v37
  v_cvt_pk_bf16_f32 v171, v38, v39
  v_mfma_f32_16x16x16_bf16 v[56:59], v[72:73], a[212:213], 0
  buffer_load_dwordx4 v65, s[12:15], s50 offen offset:1024 lds
  v_cvt_pk_bf16_f32 v172, v40, v41
  v_cvt_pk_bf16_f32 v173, v42, v43
  v_mfma_f32_16x16x16_bf16 v[60:63], v[74:75], a[214:215], 0
  buffer_load_dwordx4 v66, s[12:15], s50 offen offset:2048 lds
  v_cvt_pk_bf16_f32 v174, v44, v45
  v_cvt_pk_bf16_f32 v175, v46, v47
  s_waitcnt lgkmcnt(0)
  v_and_b32 v76, v69, v76
  v_and_b32 v77, v70, v77
  v_and_b32 v78, v69, v78
  v_and_b32 v79, v70, v79
  s_waitcnt vmcnt(12)
  ds_read_b128 v[72:75], v68 offset:512
  v_mfma_f32_16x16x16_bf16 v[16:19], v[76:77], a[216:217], 0
  ds_read_b64_tr_b16 a[192:193], v67 offset:0
  ds_read_b64_tr_b16 a[194:195], v67 offset:768
  ds_read_b64_tr_b16 a[196:197], v67 offset:8
  ds_read_b64_tr_b16 a[198:199], v67 offset:776
  ds_read_b64_tr_b16 a[200:201], v67 offset:64
  ds_read_b64_tr_b16 a[202:203], v67 offset:832
  v_cvt_pk_bf16_f32 v176, v48, v49
  v_cvt_pk_bf16_f32 v177, v50, v51
  v_mfma_f32_16x16x16_bf16 v[20:23], v[78:79], a[218:219], 0
  ds_read_b64_tr_b16 a[204:205], v67 offset:72
  ds_read_b64_tr_b16 a[206:207], v67 offset:840
  ds_read_b64_tr_b16 a[208:209], v67 offset:128
  ds_read_b64_tr_b16 a[210:211], v67 offset:896
  ds_read_b64_tr_b16 a[212:213], v67 offset:136
  ds_read_b64_tr_b16 a[214:215], v67 offset:904
  v_cvt_pk_bf16_f32 v178, v52, v53
  v_cvt_pk_bf16_f32 v179, v54, v55
  v_mfma_f32_16x16x16_bf16 v[24:27], v[76:77], a[220:221], 0
  s_add_u32 m0, s49, 73792
  s_add_u32 s50, s44, s48
  buffer_load_dwordx4 v64, s[12:15], s50 offen offset:0 lds
  buffer_load_dwordx4 v65, s[12:15], s50 offen offset:1024 lds
  buffer_load_dwordx4 v66, s[12:15], s50 offen offset:2048 lds
  s_add_u32 m0, s49, 76872
  v_cvt_pk_bf16_f32 v180, v56, v57
  v_cvt_pk_bf16_f32 v181, v58, v59
  v_mfma_f32_16x16x16_bf16 v[28:31], v[78:79], a[222:223], 0
  s_add_u32 s50, s50, 6144
  buffer_load_dwordx4 v64, s[12:15], s50 offen offset:0 lds
  buffer_load_dwordx4 v65, s[12:15], s50 offen offset:1024 lds
  buffer_load_dwordx4 v66, s[12:15], s50 offen offset:2048 lds
  s_mov_b64 s[82:83], s[80:81]
  s_mov_b64 s[80:81], s[78:79]
  v_cvt_pk_bf16_f32 v182, v60, v61
  v_cvt_pk_bf16_f32 v183, v62, v63
  v_mfma_f32_16x16x16_bf16 v[32:35], v[76:77], a[224:225], 0
  s_mov_b64 s[78:79], s[76:77]
  s_cmp_ge_u32 s32, s35
  s_cselect_b64 s[34:35], s[28:29], s[34:35]
  s_cselect_b64 s[28:29], s[30:31], s[28:29]
  s_add_u32 s76, s33, s32
  s_xor_b32 s76, s76, s34
  v_cvt_pk_bf16_f32 v16, v16, v17
  v_cvt_pk_bf16_f32 v17, v18, v19
  v_accvgpr_write_b32 a72, v16
  v_accvgpr_write_b32 a73, v17
  v_mfma_f32_16x16x16_bf16 v[36:39], v[78:79], a[226:227], 0
  s_bfe_u32 s77, s76, 65557
  s_bfe_u32 s76, s76, 65555
  s_lshl1_add_u32 s77, s76, s77
  s_sub_u32 s77, 1, s77
  s_and_b32 s77, s77, 3
  s_mul_i32 s77, s77, 24576
  v_cvt_pk_bf16_f32 v20, v20, v21
  v_cvt_pk_bf16_f32 v21, v22, v23
  v_accvgpr_write_b32 a74, v20
  v_accvgpr_write_b32 a75, v21
  v_mfma_f32_16x16x16_bf16 v[40:43], v[76:77], a[228:229], 0
  s_cmp_lt_u32 s32, s21
  s_cselect_b32 s76, s32, s40
  s_add_u32 s32, s32, 786432
  s_cmp_eq_u32 s77, 0
  s_cselect_b32 s57, 73728, s26
  s_add_u32 s22, s76, s77
  v_cvt_pk_bf16_f32 v24, v24, v25
  v_cvt_pk_bf16_f32 v25, v26, v27
  v_accvgpr_write_b32 a76, v24
  v_accvgpr_write_b32 a77, v25
  v_mfma_f32_16x16x16_bf16 v[44:47], v[78:79], a[230:231], 0
  s_add_u32 s22, s22, s57
  s_min_u32 s22, s22, s40
  s_add_u32 m0, s39, 0
  s_nop 0
  buffer_load_dwordx4 v8, s[4:7], s22 offen nt lds
  s_add_u32 m0, s39, 4096
  v_cvt_pk_bf16_f32 v28, v28, v29
  v_cvt_pk_bf16_f32 v29, v30, v31
  v_accvgpr_write_b32 a78, v28
  v_accvgpr_write_b32 a79, v29
  v_mfma_f32_16x16x16_bf16 v[48:51], v[76:77], a[232:233], 0
  s_nop 0
  buffer_load_dwordx4 v9, s[4:7], s22 offen nt lds
  v_and_b32 v15, s57, v11
  v_add3_u32 v15, v10, v15, s77
  s_add_u32 m0, s39, 8192
  s_nop 0
  v_cvt_pk_bf16_f32 v32, v32, v33
  v_cvt_pk_bf16_f32 v33, v34, v35
  v_accvgpr_write_b32 a80, v32
  v_accvgpr_write_b32 a81, v33
  v_mfma_f32_16x16x16_bf16 v[52:55], v[78:79], a[234:235], 0
  buffer_load_dwordx4 v15, s[4:7], s76 offen nt lds
  s_cmp_eq_u32 s77, 73728
  s_cselect_b32 s57, 4294893568, s27
  s_add_u32 s90, s77, 12288
  s_add_u32 s56, s76, s90
  s_add_u32 s56, s56, s57
  v_cvt_pk_bf16_f32 v36, v36, v37
  v_cvt_pk_bf16_f32 v37, v38, v39
  v_accvgpr_write_b32 a82, v36
  v_accvgpr_write_b32 a83, v37
  v_mfma_f32_16x16x16_bf16 v[56:59], v[76:77], a[236:237], 0
  s_min_u32 s56, s56, s40
  v_and_b32 v15, s57, v12
  v_add3_u32 v15, v8, v15, s90
  s_add_u32 m0, s39, 12288
  s_nop 0
  buffer_load_dwordx4 v15, s[4:7], s76 offen nt lds
  v_cvt_pk_bf16_f32 v40, v40, v41
  v_cvt_pk_bf16_f32 v41, v42, v43
  v_accvgpr_write_b32 a84, v40
  v_accvgpr_write_b32 a85, v41
  v_mfma_f32_16x16x16_bf16 v[60:63], v[78:79], a[238:239], 0
  s_add_u32 m0, s39, 16384
  s_nop 0
  buffer_load_dwordx4 v9, s[4:7], s56 offen nt lds
  s_add_u32 m0, s39, 20480
  s_nop 0
  buffer_load_dwordx4 v10, s[4:7], s56 offen nt lds
  v_cvt_pk_bf16_f32 v44, v44, v45
  v_cvt_pk_bf16_f32 v45, v46, v47
  v_accvgpr_write_b32 a86, v44
  v_accvgpr_write_b32 a87, v45
  s_waitcnt lgkmcnt(0)
  v_and_b32 v72, v69, v72
  v_and_b32 v73, v70, v73
  v_and_b32 v74, v69, v74
  v_and_b32 v75, v70, v75
  s_waitcnt vmcnt(18)
  ds_read_b128 v[76:79], v68 offset:576
  v_mfma_f32_16x16x16_bf16 v[16:19], v[72:73], a[192:193], 0
  ds_read_b64_tr_b16 a[216:217], v67 offset:24640
  ds_read_b64_tr_b16 a[218:219], v67 offset:25408
  ds_read_b64_tr_b16 a[220:221], v67 offset:24648
  ds_read_b64_tr_b16 a[222:223], v67 offset:25416
  v_cvt_pk_bf16_f32 v48, v48, v49
  v_cvt_pk_bf16_f32 v49, v50, v51
  v_accvgpr_write_b32 a88, v48
  v_accvgpr_write_b32 a89, v49
  v_mfma_f32_16x16x16_bf16 v[20:23], v[74:75], a[194:195], 0
  ds_read_b64_tr_b16 a[224:225], v67 offset:24704
  ds_read_b64_tr_b16 a[226:227], v67 offset:25472
  ds_read_b64_tr_b16 a[228:229], v67 offset:24712
  ds_read_b64_tr_b16 a[230:231], v67 offset:25480
  v_cvt_pk_bf16_f32 v52, v52, v53
  v_cvt_pk_bf16_f32 v53, v54, v55
  v_accvgpr_write_b32 a90, v52
  v_accvgpr_write_b32 a91, v53
  v_mfma_f32_16x16x16_bf16 v[24:27], v[72:73], a[196:197], 0
  ds_read_b64_tr_b16 a[232:233], v67 offset:24768
  ds_read_b64_tr_b16 a[234:235], v67 offset:25536
  ds_read_b64_tr_b16 a[236:237], v67 offset:24776
  ds_read_b64_tr_b16 a[238:239], v67 offset:25544
  v_cvt_pk_bf16_f32 v56, v56, v57
  v_cvt_pk_bf16_f32 v57, v58, v59
  v_accvgpr_write_b32 a92, v56
  v_accvgpr_write_b32 a93, v57
  v_mfma_f32_16x16x16_bf16 v[28:31], v[74:75], a[198:199], 0
  s_add_u32 s51, s32, 49152
  s_lshr_b32 s52, s51, 23
  s_sub_u32 s52, s52, 6
  s_lshr_b32 s88, s51, 24
  v_cvt_pk_bf16_f32 v60, v60, v61
  v_cvt_pk_bf16_f32 v61, v62, v63
  v_accvgpr_write_b32 a94, v60
  v_accvgpr_write_b32 a95, v61
  v_mfma_f32_16x16x16_bf16 v[32:35], v[72:73], a[200:201], 0
  s_max_i32 s88, s88, s52
  s_sub_u32 s51, s21, 737280
  s_lshr_b32 s52, s51, 23
  s_sub_u32 s52, s52, 6
  v_cvt_pk_bf16_f32 v184, v16, v17
  v_cvt_pk_bf16_f32 v185, v18, v19
  v_mfma_f32_16x16x16_bf16 v[36:39], v[74:75], a[202:203], 0
  s_lshr_b32 s95, s51, 24
  s_max_i32 s95, s95, s52
  s_add_u32 s51, s88, 1
  s_lshl_b32 s30, s51, 24
  v_cvt_pk_bf16_f32 v186, v20, v21
  v_cvt_pk_bf16_f32 v187, v22, v23
  v_mfma_f32_16x16x16_bf16 v[40:43], v[72:73], a[204:205], 0
  s_add_u32 s51, s51, 6
  s_lshl_b32 s51, s51, 23
  s_min_u32 s30, s30, s51
  v_cvt_pk_bf16_f32 v188, v24, v25
  v_cvt_pk_bf16_f32 v189, v26, v27
  v_mfma_f32_16x16x16_bf16 v[44:47], v[74:75], a[206:207], 0
  s_sub_u32 s30, s30, 49152
  s_add_u32 s51, s88, 2
  s_lshl_b32 s29, s51, 24
  v_cvt_pk_bf16_f32 v190, v28, v29
  v_cvt_pk_bf16_f32 v191, v30, v31
  v_mfma_f32_16x16x16_bf16 v[48:51], v[72:73], a[208:209], 0
  s_add_u32 s51, s51, 6
  s_lshl_b32 s51, s51, 23
  s_min_u32 s29, s29, s51
  v_cvt_pk_bf16_f32 v192, v32, v33
  v_cvt_pk_bf16_f32 v193, v34, v35
  v_mfma_f32_16x16x16_bf16 v[52:55], v[74:75], a[210:211], 0
  s_sub_u32 s29, s29, 49152
  s_add_u32 s89, s88, 1
  s_min_u32 s89, s89, s95
  v_cvt_pk_bf16_f32 v194, v36, v37
  v_cvt_pk_bf16_f32 v195, v38, v39
  v_mfma_f32_16x16x16_bf16 v[56:59], v[72:73], a[212:213], 0
  s_lshl_b32 s88, s88, 4
  s_load_dwordx4 s[44:47], s[92:93], s88
  s_lshl_b32 s89, s89, 4
  v_cvt_pk_bf16_f32 v196, v40, v41
  v_cvt_pk_bf16_f32 v197, v42, v43
  v_mfma_f32_16x16x16_bf16 v[60:63], v[74:75], a[214:215], 0
  s_load_dwordx4 s[84:87], s[92:93], s89
  s_lshl_b32 s95, s95, 4
  s_load_dwordx4 s[12:15], s[92:93], s95
  v_cvt_pk_bf16_f32 v198, v44, v45
  v_cvt_pk_bf16_f32 v199, v46, v47
  s_waitcnt lgkmcnt(0)
  v_and_b32 v76, v69, v76
  v_and_b32 v77, v70, v77
  v_and_b32 v78, v69, v78
  v_and_b32 v79, v70, v79
  s_min_u32 s51, s44, s45
  s_min_u32 s51, s51, s46
  s_min_u32 s51, s51, s47
  s_min_u32 s51, s51, s84
  s_min_u32 s51, s51, s85
  s_min_u32 s51, s51, s86
  s_min_u32 s51, s51, s87
  s_min_u32 s51, s51, s12
  s_min_u32 s51, s51, s13
  s_min_u32 s51, s51, s14
  s_min_u32 s51, s51, s15
  s_cmp_eq_u32 s51, 0
  s_cbranch_scc1 L_slow
L_back:
  s_waitcnt vmcnt(12)
  ds_read_b128 v[72:75], v68 offset:640
  v_mfma_f32_16x16x16_bf16 v[16:19], v[76:77], a[216:217], 0
  ds_read_b64_tr_b16 a[192:193], v71 offset:0
  ds_read_b64_tr_b16 a[194:195], v71 offset:768
  ds_read_b64_tr_b16 a[196:197], v71 offset:8
  ds_read_b64_tr_b16 a[198:199], v71 offset:776
  ds_read_b64_tr_b16 a[200:201], v71 offset:64
  ds_read_b64_tr_b16 a[202:203], v71 offset:832
  v_cvt_pk_bf16_f32 v200, v48, v49
  v_cvt_pk_bf16_f32 v201, v50, v51
  v_mfma_f32_16x16x16_bf16 v[20:23], v[78:79], a[218:219], 0
  ds_read_b64_tr_b16 a[204:205], v71 offset:72
  ds_read_b64_tr_b16 a[206:207], v71 offset:840
  ds_read_b64_tr_b16 a[208:209], v71 offset:128
  ds_read_b64_tr_b16 a[210:211], v71 offset:896
  ds_read_b64_tr_b16 a[212:213], v71 offset:136
  v_cvt_pk_bf16_f32 v202, v52, v53
  v_cvt_pk_bf16_f32 v203, v54, v55
  v_mfma_f32_16x16x16_bf16 v[24:27], v[76:77], a[220:221], 0
  ds_read_b64_tr_b16 a[214:215], v71 offset:904
  s_mov_b32 s35, s30
  s_mov_b32 s31, -1
  s_and_b32 s50, s2, 5
  s_lshl_b32 s50, s50, 19
  v_cvt_pk_bf16_f32 v204, v56, v57
  v_cvt_pk_bf16_f32 v205, v58, v59
  v_mfma_f32_16x16x16_bf16 v[28:31], v[78:79], a[222:223], 0
  s_min_u32 s51, s44, s46
  s_min_u32 s52, s45, s47
  s_cmp_gt_u32 s51, s52
  s_cselect_b32 s51, 4, 0
  s_xor_b32 s51, s51, s44
  v_cvt_pk_bf16_f32 v206, v60, v61
  v_cvt_pk_bf16_f32 v207, v62, v63
  v_mfma_f32_16x16x16_bf16 v[32:35], v[76:77], a[224:225], 0
  s_and_b32 s51, s51, 4
  s_lshl_b32 s51, s51, 17
  s_bitcmp1_b32 s2, 1
  s_cselect_b64 s[44:45], s[46:47], s[44:45]
  s_bitcmp1_b32 s2, 0
  v_cvt_pk_bf16_f32 v16, v16, v17
  v_cvt_pk_bf16_f32 v17, v18, v19
  v_accvgpr_write_b32 a96, v16
  v_accvgpr_write_b32 a97, v17
  v_mfma_f32_16x16x16_bf16 v[36:39], v[78:79], a[226:227], 0
  s_cselect_b32 s34, s45, s44
  s_and_b32 s34, s34, 2
  s_lshl_b32 s34, s34, 20
  s_or_b32 s34, s34, s51
  s_xor_b32 s34, s34, s50
  v_cvt_pk_bf16_f32 v20, v20, v21
  v_cvt_pk_bf16_f32 v21, v22, v23
  v_accvgpr_write_b32 a98, v20
  v_accvgpr_write_b32 a99, v21
  v_mfma_f32_16x16x16_bf16 v[40:43], v[76:77], a[228:229], 0
  s_min_u32 s51, s84, s86
  s_min_u32 s52, s85, s87
  s_cmp_gt_u32 s51, s52
  s_cselect_b32 s51, 4, 0
  s_xor_b32 s51, s51, s84
  v_cvt_pk_bf16_f32 v24, v24, v25
  v_cvt_pk_bf16_f32 v25, v26, v27
  v_accvgpr_write_b32 a100, v24
  v_accvgpr_write_b32 a101, v25
  v_mfma_f32_16x16x16_bf16 v[44:47], v[78:79], a[230:231], 0
  s_and_b32 s51, s51, 4
  s_lshl_b32 s51, s51, 17
  s_bitcmp1_b32 s2, 1
  s_cselect_b64 s[84:85], s[86:87], s[84:85]
  s_bitcmp1_b32 s2, 0
  v_cvt_pk_bf16_f32 v28, v28, v29
  v_cvt_pk_bf16_f32 v29, v30, v31
  v_accvgpr_write_b32 a102, v28
  v_accvgpr_write_b32 a103, v29
  v_mfma_f32_16x16x16_bf16 v[48:51], v[76:77], a[232:233], 0
  s_cselect_b32 s28, s85, s84
  s_and_b32 s28, s28, 2
  s_lshl_b32 s28, s28, 20
  s_or_b32 s28, s28, s51
  s_xor_b32 s28, s28, s50
  v_cvt_pk_bf16_f32 v32, v32, v33
  v_cvt_pk_bf16_f32 v33, v34, v35
  v_accvgpr_write_b32 a104, v32
  v_accvgpr_write_b32 a105, v33
  v_mfma_f32_16x16x16_bf16 v[52:55], v[78:79], a[234:235], 0
  s_min_u32 s51, s12, s14
  s_min_u32 s52, s13, s15
  s_cmp_gt_u32 s51, s52
  s_cselect_b32 s51, 4, 0
  s_xor_b32 s51, s51, s12
  v_cvt_pk_bf16_f32 v36, v36, v37
  v_cvt_pk_bf16_f32 v37, v38, v39
  v_accvgpr_write_b32 a106, v36
  v_accvgpr_write_b32 a107, v37
  v_mfma_f32_16x16x16_bf16 v[56:59], v[76:77], a[236:237], 0
  s_and_b32 s51, s51, 4
  s_lshl_b32 s51, s51, 17
  s_bitcmp1_b32 s2, 1
  s_cselect_b64 s[12:13], s[14:15], s[12:13]
  s_bitcmp1_b32 s2, 0
  v_cvt_pk_bf16_f32 v40, v40, v41
  v_cvt_pk_bf16_f32 v41, v42, v43
  v_accvgpr_write_b32 a108, v40
  v_accvgpr_write_b32 a109, v41
  v_mfma_f32_16x16x16_bf16 v[60:63], v[78:79], a[238:239], 0
  s_cselect_b32 s30, s13, s12
  s_and_b32 s30, s30, 2
  s_lshl_b32 s30, s30, 20
  s_or_b32 s30, s30, s51
  s_xor_b32 s30, s30, s50
  v_cvt_pk_bf16_f32 v44, v44, v45
  v_cvt_pk_bf16_f32 v45, v46, v47
  v_accvgpr_write_b32 a110, v44
  v_accvgpr_write_b32 a111, v45
  s_waitcnt lgkmcnt(0)
  v_and_b32 v72, v69, v72
  v_and_b32 v73, v70, v73
  v_and_b32 v74, v69, v74
  v_and_b32 v75, v70, v75
  s_waitcnt vmcnt(6)
  ds_read_b128 v[76:79], v68 offset:704
  v_mfma_f32_16x16x16_bf16 v[16:19], v[72:73], a[192:193], 0
  ds_read_b64_tr_b16 a[216:217], v71 offset:24640
  v_cvt_pk_bf16_f32 v48, v48, v49
  v_cvt_pk_bf16_f32 v49, v50, v51
  v_accvgpr_write_b32 a112, v48
  v_accvgpr_write_b32 a113, v49
  v_mfma_f32_16x16x16_bf16 v[20:23], v[74:75], a[194:195], 0
  ds_read_b64_tr_b16 a[218:219], v71 offset:25408
  v_cvt_pk_bf16_f32 v52, v52, v53
  v_cvt_pk_bf16_f32 v53, v54, v55
  v_accvgpr_write_b32 a114, v52
  v_accvgpr_write_b32 a115, v53
  v_mfma_f32_16x16x16_bf16 v[24:27], v[72:73], a[196:197], 0
  ds_read_b64_tr_b16 a[220:221], v71 offset:24648
  v_cvt_pk_bf16_f32 v56, v56, v57
  v_cvt_pk_bf16_f32 v57, v58, v59
  v_accvgpr_write_b32 a116, v56
  v_accvgpr_write_b32 a117, v57
  v_mfma_f32_16x16x16_bf16 v[28:31], v[74:75], a[198:199], 0
  ds_read_b64_tr_b16 a[222:223], v71 offset:25416
  v_cvt_pk_bf16_f32 v60, v60, v61
  v_cvt_pk_bf16_f32 v61, v62, v63
  v_accvgpr_write_b32 a118, v60
  v_accvgpr_write_b32 a119, v61
  v_mfma_f32_16x16x16_bf16 v[32:35], v[72:73], a[200:201], 0
  ds_read_b64_tr_b16 a[224:225], v71 offset:24704
  v_cvt_pk_bf16_f32 v208, v16, v17
  v_cvt_pk_bf16_f32 v209, v18, v19
  v_mfma_f32_16x16x16_bf16 v[36:39], v[74:75], a[202:203], 0
  ds_read_b64_tr_b16 a[226:227], v71 offset:25472
  v_cvt_pk_bf16_f32 v210, v20, v21
  v_cvt_pk_bf16_f32 v211, v22, v23
  v_mfma_f32_16x16x16_bf16 v[40:43], v[72:73], a[204:205], 0
  ds_read_b64_tr_b16 a[228:229], v71 offset:24712
  v_cvt_pk_bf16_f32 v212, v24, v25
  v_cvt_pk_bf16_f32 v213, v26, v27
  v_mfma_f32_16x16x16_bf16 v[44:47], v[74:75], a[206:207], 0
  ds_read_b64_tr_b16 a[230:231], v71 offset:25480
  v_cvt_pk_bf16_f32 v214, v28, v29
  v_cvt_pk_bf16_f32 v215, v30, v31
  v_mfma_f32_16x16x16_bf16 v[48:51], v[72:73], a[208:209], 0
  ds_read_b64_tr_b16 a[232:233], v71 offset:24768
  v_cvt_pk_bf16_f32 v216, v32, v33
  v_cvt_pk_bf16_f32 v217, v34, v35
  v_mfma_f32_16x16x16_bf16 v[52:55], v[74:75], a[210:211], 0
  ds_read_b64_tr_b16 a[234:235], v71 offset:25536
  v_cvt_pk_bf16_f32 v218, v36, v37
  v_cvt_pk_bf16_f32 v219, v38, v39
  v_mfma_f32_16x16x16_bf16 v[56:59], v[72:73], a[212:213], 0
  ds_read_b64_tr_b16 a[236:237], v71 offset:24776
  v_cvt_pk_bf16_f32 v220, v40, v41
  v_cvt_pk_bf16_f32 v221, v42, v43
  v_mfma_f32_16x16x16_bf16 v[60:63], v[74:75], a[214:215], 0
  ds_read_b64_tr_b16 a[238:239], v71 offset:25544
  v_cvt_pk_bf16_f32 v222, v44, v45
  v_cvt_pk_bf16_f32 v223, v46, v47
  s_waitcnt lgkmcnt(0)
  v_and_b32 v76, v69, v76
  v_and_b32 v77, v70, v77
  v_and_b32 v78, v69, v78
  v_and_b32 v79, v70, v79
  s_mov_b64 s[82:83], s[80:81]
  s_mov_b64 s[80:81], s[78:79]
  v_mfma_f32_16x16x16_bf16 v[16:19], v[76:77], a[216:217], 0
  s_mov_b64 s[78:79], s[76:77]
  s_cmp_ge_u32 s32, s35
  s_cselect_b64 s[34:35], s[28:29], s[34:35]
  s_cselect_b64 s[28:29], s[30:31], s[28:29]
  v_cvt_pk_bf16_f32 v224, v48, v49
  v_cvt_pk_bf16_f32 v225, v50, v51
  v_mfma_f32_16x16x16_bf16 v[20:23], v[78:79], a[218:219], 0
  s_add_u32 s76, s33, s32
  s_xor_b32 s76, s76, s34
  s_bfe_u32 s77, s76, 65557
  s_bfe_u32 s76, s76, 65555
  v_cvt_pk_bf16_f32 v226, v52, v53
  v_cvt_pk_bf16_f32 v227, v54, v55
  v_mfma_f32_16x16x16_bf16 v[24:27], v[76:77], a[220:221], 0
  s_lshl1_add_u32 s77, s76, s77
  s_sub_u32 s77, 1, s77
  s_and_b32 s77, s77, 3
  s_mul_i32 s77, s77, 24576
  v_cvt_pk_bf16_f32 v228, v56, v57
  v_cvt_pk_bf16_f32 v229, v58, v59
  v_mfma_f32_16x16x16_bf16 v[28:31], v[78:79], a[222:223], 0
  s_cmp_lt_u32 s32, s21
  s_cselect_b32 s76, s32, s40
  s_add_u32 s32, s32, 786432
  s_cmp_eq_u32 s77, 0
  v_cvt_pk_bf16_f32 v230, v60, v61
  v_cvt_pk_bf16_f32 v231, v62, v63
  v_mfma_f32_16x16x16_bf16 v[32:35], v[76:77], a[224:225], 0
  s_cselect_b32 s57, 73728, s26
  s_add_u32 s22, s76, s77
  s_add_u32 s22, s22, s57
  s_min_u32 s22, s22, s40
  v_cvt_pk_bf16_f32 v232, v16, v17
  v_cvt_pk_bf16_f32 v233, v18, v19
  v_mfma_f32_16x16x16_bf16 v[36:39], v[78:79], a[226:227], 0
  s_add_u32 m0, s39, 24576
  s_nop 0
  buffer_load_dwordx4 v8, s[4:7], s22 offen nt lds
  s_add_u32 m0, s39, 28672
  v_cvt_pk_bf16_f32 v234, v20, v21
  v_cvt_pk_bf16_f32 v235, v22, v23
  v_mfma_f32_16x16x16_bf16 v[40:43], v[76:77], a[228:229], 0
  s_nop 0
  buffer_load_dwordx4 v9, s[4:7], s22 offen nt lds
  v_and_b32 v15, s57, v11
  v_add3_u32 v15, v10, v15, s77
  v_cvt_pk_bf16_f32 v236, v24, v25
  v_cvt_pk_bf16_f32 v237, v26, v27
  v_mfma_f32_16x16x16_bf16 v[44:47], v[78:79], a[230:231], 0
  s_add_u32 m0, s39, 32768
  s_nop 0
  buffer_load_dwordx4 v15, s[4:7], s76 offen nt lds
  s_cmp_eq_u32 s77, 73728
  v_cvt_pk_bf16_f32 v238, v28, v29
  v_cvt_pk_bf16_f32 v239, v30, v31
  v_mfma_f32_16x16x16_bf16 v[48:51], v[76:77], a[232:233], 0
  s_cselect_b32 s57, 4294893568, s27
  s_add_u32 s90, s77, 12288
  s_add_u32 s56, s76, s90
  s_add_u32 s56, s56, s57
  v_cvt_pk_bf16_f32 v240, v32, v33
  v_cvt_pk_bf16_f32 v241, v34, v35
  v_mfma_f32_16x16x16_bf16 v[52:55], v[78:79], a[234:235], 0
  s_min_u32 s56, s56, s40
  v_and_b32 v15, s57, v12
  v_add3_u32 v15, v8, v15, s90
  s_add_u32 m0, s39, 36864
  v_cvt_pk_bf16_f32 v242, v36, v37
  v_cvt_pk_bf16_f32 v243, v38, v39
  v_mfma_f32_16x16x16_bf16 v[56:59], v[76:77], a[236:237], 0
  s_nop 0
  buffer_load_dwordx4 v15, s[4:7], s76 offen nt lds
  s_add_u32 m0, s39, 40960
  s_nop 0
  v_cvt_pk_bf16_f32 v244, v40, v41
  v_cvt_pk_bf16_f32 v245, v42, v43
  v_mfma_f32_16x16x16_bf16 v[60:63], v[78:79], a[238:239], 0
  buffer_load_dwordx4 v9, s[4:7], s56 offen nt lds
  s_add_u32 m0, s39, 45056
  s_xor_b32 s39, s39, 49152
  buffer_load_dwordx4 v10, s[4:7], s56 offen nt lds
  v_cvt_pk_bf16_f32 v246, v44, v45
  v_cvt_pk_bf16_f32 v247, v46, v47
  v_cvt_pk_bf16_f32 v248, v48, v49
  v_cvt_pk_bf16_f32 v249, v50, v51
  v_cvt_pk_bf16_f32 v250, v52, v53
  v_cvt_pk_bf16_f32 v251, v54, v55
  v_mov_b32 v13, 0
  v_mov_b32 v14, 0
  s_mov_b32 s58, s40
  s_mov_b32 s59, s40
  s_mov_b32 s62, s40
  s_mov_b32 s63, s40
  s_mov_b32 s37, 57350
  s_mov_b64 vcc, 0
  s_waitcnt vmcnt(6)
  s_barrier
  ds_read_b128 a[144:147], v1 offset:0
  ds_read_b128 a[148:151], v2 offset:0
  ds_read_b128 a[152:155], v3 offset:0
  ds_read_b128 a[156:159], v4 offset:0
  v_cvt_pk_bf16_f32 v252, v56, v57
  v_cvt_pk_bf16_f32 v253, v58, v59
  v_cvt_pk_bf16_f32 v254, v60, v61
  v_cvt_pk_bf16_f32 v255, v62, v63
L_loop:
  s_waitcnt lgkmcnt(2)
  v_mfma_f32_16x16x32_bf16 v[16:19], v[88:91], a[144:147], 0
  ds_read_b128 a[160:163], v1 offset:256
  v_mfma_f32_16x16x32_bf16 v[16:19], a[0:3], a[148:151], v[16:19]
  ds_read_b128 a[164:167], v2 offset:256
  v_mfma_f32_16x16x32_bf16 v[20:23], v[92:95], a[144:147], 0
  v_mfma_f32_16x16x32_bf16 v[20:23], a[4:7], a[148:151], v[20:23]
  v_cvt_pk_bf16_f32 v40, v40, v41
  v_mfma_f32_16x16x32_bf16 v[24:27], v[96:99], a[144:147], 0
  v_cvt_pk_bf16_f32 v41, v42, v43
  v_mfma_f32_16x16x32_bf16 v[24:27], a[8:11], a[148:151], v[24:27]
  v_cvt_pk_bf16_f32 v42, v44, v45
  v_mfma_f32_16x16x32_bf16 v[28:31], v[100:103], a[144:147], 0
  buffer_store_dwordx4 a[188:191], v82, s[8:11], s63 offen sc1
  v_mfma_f32_16x16x32_bf16 v[28:31], a[12:15], a[148:151], v[28:31]
  v_cvt_pk_bf16_f32 v43, v46, v47
  v_mfma_f32_16x16x32_bf16 v[32:35], v[104:107], a[144:147], 0
  ds_write_b128 v86, v[40:43] offset:12288
  v_mfma_f32_16x16x32_bf16 v[32:35], a[16:19], a[148:151], v[32:35]
  v_mfma_f32_16x16x32_bf16 v[36:39], v[108:111], a[144:147], 0
  v_mfma_f32_16x16x32_bf16 v[36:39], a[20:23], a[148:151], v[36:39]
  s_waitcnt lgkmcnt(3)
  v_mfma_f32_16x16x32_bf16 v[16:19], v[112:115], a[152:155], v[16:19]
  ds_read_b128 a[144:147], v3 offset:256
  v_mfma_f32_16x16x32_bf16 v[16:19], a[24:27], a[156:159], v[16:19]
  ds_read_b128 a[148:151], v4 offset:256
  v_mfma_f32_16x16x32_bf16 v[20:23], v[116:119], a[152:155], v[20:23]
  v_mfma_f32_16x16x32_bf16 v[20:23], a[28:31], a[156:159], v[20:23]
  v_cvt_pk_bf16_f32 v48, v48, v49
  v_mfma_f32_16x16x32_bf16 v[24:27], v[120:123], a[152:155], v[24:27]
  buffer_store_dwordx4 a[168:171], v80, s[8:11], s58 offen sc1
  v_mfma_f32_16x16x32_bf16 v[24:27], a[32:35], a[156:159], v[24:27]
  v_cvt_pk_bf16_f32 v49, v50, v51
  v_mfma_f32_16x16x32_bf16 v[28:31], v[124:127], a[152:155], v[28:31]
  v_cvt_pk_bf16_f32 v50, v52, v53
  v_mfma_f32_16x16x32_bf16 v[28:31], a[36:39], a[156:159], v[28:31]
  v_cvt_pk_bf16_f32 v51, v54, v55
  v_mfma_f32_16x16x32_bf16 v[32:35], v[128:131], a[152:155], v[32:35]
  ds_write_b128 v87, v[48:51] offset:12288
  v_mfma_f32_16x16x32_bf16 v[32:35], a[40:43], a[156:159], v[32:35]
  v_mfma_f32_16x16x32_bf16 v[36:39], v[132:135], a[152:155], v[36:39]
  v_mfma_f32_16x16x32_bf16 v[36:39], a[44:47], a[156:159], v[36:39]
  s_waitcnt lgkmcnt(4)
  v_mfma_f32_16x16x32_bf16 v[16:19], v[136:139], a[160:163], v[16:19]
  ds_read_b128 a[152:155], v1 offset:512
  v_mfma_f32_16x16x32_bf16 v[16:19], a[48:51], a[164:167], v[16:19]
  ds_read_b128 a[156:159], v2 offset:512
  v_mfma_f32_16x16x32_bf16 v[20:23], v[140:143], a[160:163], v[20:23]
  v_mfma_f32_16x16x32_bf16 v[20:23], a[52:55], a[164:167], v[20:23]
  v_mfma_f32_16x16x32_bf16 v[24:27], v[144:147], a[160:163], v[24:27]
  buffer_store_dwordx4 a[172:175], v81, s[8:11], s58 offen sc1
  v_mfma_f32_16x16x32_bf16 v[24:27], a[56:59], a[164:167], v[24:27]
  v_mfma_f32_16x16x32_bf16 v[28:31], v[148:151], a[160:163], v[28:31]
  v_mfma_f32_16x16x32_bf16 v[28:31], a[60:63], a[164:167], v[28:31]
  v_mfma_f32_16x16x32_bf16 v[32:35], v[152:155], a[160:163], v[32:35]
  s_cbranch_vccnz L_dr0
L_drb0:
  v_mfma_f32_16x16x32_bf16 v[32:35], a[64:67], a[164:167], v[32:35]
  s_waitcnt vmcnt(8)
  s_mov_b64 s[82:83], s[80:81]
  v_mfma_f32_16x16x32_bf16 v[36:39], v[156:159], a[160:163], v[36:39]
  s_mov_b64 s[80:81], s[78:79]
  s_mov_b64 s[78:79], s[76:77]
  v_mfma_f32_16x16x32_bf16 v[36:39], a[68:71], a[164:167], v[36:39]
  s_cmp_ge_u32 s32, s35
  s_waitcnt lgkmcnt(3)
  v_mfma_f32_16x16x32_bf16 v[16:19], v[160:163], a[144:147], v[16:19]
  ds_read_b128 a[160:163], v3 offset:512
  s_cselect_b64 s[34:35], s[28:29], s[34:35]
  v_mfma_f32_16x16x32_bf16 v[16:19], a[72:75], a[148:151], v[16:19]
  ds_read_b128 a[164:167], v4 offset:512
  s_cselect_b64 s[28:29], s[30:31], s[28:29]
  v_mfma_f32_16x16x32_bf16 v[20:23], v[164:167], a[144:147], v[20:23]
  s_add_u32 s76, s33, s32
  v_cvt_pk_bf16_f32 v56, v56, v57
  v_mfma_f32_16x16x32_bf16 v[20:23], a[76:79], a[148:151], v[20:23]
  s_xor_b32 s76, s76, s34
  v_cvt_pk_bf16_f32 v57, v58, v59
  v_mfma_f32_16x16x32_bf16 v[24:27], v[168:171], a[144:147], v[24:27]
  buffer_store_dwordx4 a[176:179], v13, s[8:11], s59 offen sc1
  v_mfma_f32_16x16x32_bf16 v[24:27], a[80:83], a[148:151], v[24:27]
  s_bfe_u32 s77, s76, 65557
  v_cvt_pk_bf16_f32 v58, v60, v61
  v_mfma_f32_16x16x32_bf16 v[28:31], v[172:175], a[144:147], v[28:31]
  s_bfe_u32 s76, s76, 65555
  v_cvt_pk_bf16_f32 v59, v62, v63
  v_mfma_f32_16x16x32_bf16 v[28:31], a[84:87], a[148:151], v[28:31]
  ds_write_b128 v86, v[56:59] offset:12416
  v_mfma_f32_16x16x32_bf16 v[32:35], v[176:179], a[144:147], v[32:35]
  s_lshl1_add_u32 s77, s76, s77
  s_sub_u32 s77, 1, s77
  v_mfma_f32_16x16x32_bf16 v[32:35], a[88:91], a[148:151], v[32:35]
  s_and_b32 s77, s77, 3
  s_mul_i32 s77, s77, 24576
  v_mfma_f32_16x16x32_bf16 v[36:39], v[180:183], a[144:147], v[36:39]
  s_cmp_lt_u32 s32, s21
  s_cselect_b32 s76, s32, s40
  v_mfma_f32_16x16x32_bf16 v[36:39], a[92:95], a[148:151], v[36:39]
  s_add_u32 s32, s32, 786432
  s_waitcnt lgkmcnt(3)
  v_mfma_f32_16x16x32_bf16 v[16:19], v[184:187], a[152:155], v[16:19]
  ds_read_b128 a[144:147], v1 offset:12288
  s_cmp_eq_u32 s77, 0
  v_mfma_f32_16x16x32_bf16 v[16:19], a[96:99], a[156:159], v[16:19]
  ds_read_b128 a[148:151], v2 offset:12288
  s_cselect_b32 s57, 73728, s26
  v_mfma_f32_16x16x32_bf16 v[20:23], v[188:191], a[152:155], v[20:23]
  s_add_u32 s22, s76, s77
  s_add_u32 s22, s22, s57
  v_mfma_f32_16x16x32_bf16 v[20:23], a[100:103], a[156:159], v[20:23]
  s_min_u32 s22, s22, s40
  s_add_u32 m0, s39, 0
  v_mfma_f32_16x16x32_bf16 v[24:27], v[192:195], a[152:155], v[24:27]
  buffer_load_dwordx4 v8, s[4:7], s22 offen nt lds
  v_mfma_f32_16x16x32_bf16 v[24:27], a[104:107], a[156:159], v[24:27]
  s_cmp_eq_u32 s81, 0
  s_cselect_b32 s91, 73728, s26
  v_mfma_f32_16x16x32_bf16 v[28:31], v[196:199], a[152:155], v[28:31]
  s_add_u32 s58, s80, s81
  s_add_u32 s58, s58, s91
  v_mfma_f32_16x16x32_bf16 v[28:31], a[108:111], a[156:159], v[28:31]
  s_min_u32 s58, s58, s40
  s_mov_b32 s59, s80
  v_mfma_f32_16x16x32_bf16 v[32:35], v[200:203], a[152:155], v[32:35]
  v_and_b32 v13, s91, v11
  v_add3_u32 v13, v82, v13, s81
  v_mfma_f32_16x16x32_bf16 v[32:35], a[112:115], a[156:159], v[32:35]
  s_cmp_eq_u32 s83, 73728
  s_cselect_b32 s91, 4294893568, s27
  v_mfma_f32_16x16x32_bf16 v[36:39], v[204:207], a[152:155], v[36:39]
  s_add_u32 s62, s83, 12288
  s_add_u32 s63, s82, s62
  v_mfma_f32_16x16x32_bf16 v[36:39], a[116:119], a[156:159], v[36:39]
  s_add_u32 s63, s63, s91
  s_waitcnt lgkmcnt(3)
  v_mfma_f32_16x16x32_bf16 v[16:19], v[208:211], a[160:163], v[16:19]
  ds_read_b128 a[152:155], v3 offset:12288
  s_min_u32 s63, s63, s40
  v_mfma_f32_16x16x32_bf16 v[16:19], v[232:235], a[164:167], v[16:19]
  ds_read_b128 a[156:159], v4 offset:12288
  v_and_b32 v14, s91, v12
  v_mfma_f32_16x16x32_bf16 v[20:23], v[212:215], a[160:163], v[20:23]
  v_add3_u32 v14, v80, v14, s62
  s_mov_b32 s62, s82
  v_mfma_f32_16x16x32_bf16 v[20:23], v[236:239], a[164:167], v[20:23]
  s_waitcnt vmcnt(8)
  s_add_u32 m0, s39, 4096
  v_mfma_f32_16x16x32_bf16 v[24:27], v[216:219], a[160:163], v[24:27]
  buffer_load_dwordx4 v9, s[4:7], s22 offen nt lds
  v_mfma_f32_16x16x32_bf16 v[24:27], v[240:243], a[164:167], v[24:27]
  v_mfma_f32_16x16x32_bf16 v[28:31], v[220:223], a[160:163], v[28:31]
  v_mfma_f32_16x16x32_bf16 v[28:31], v[244:247], a[164:167], v[28:31]
  v_mfma_f32_16x16x32_bf16 v[32:35], v[224:227], a[160:163], v[32:35]
  v_mfma_f32_16x16x32_bf16 v[32:35], v[248:251], a[164:167], v[32:35]
  v_and_b32 v15, s57, v11
  v_mfma_f32_16x16x32_bf16 v[36:39], v[228:231], a[160:163], v[36:39]
  v_add3_u32 v15, v10, v15, s77
  v_mfma_f32_16x16x32_bf16 v[36:39], v[252:255], a[164:167], v[36:39]
  s_waitcnt lgkmcnt(2)
  v_mfma_f32_16x16x32_bf16 v[40:43], v[88:91], a[144:147], 0
  ds_read_b128 a[160:163], v1 offset:12544
  v_mfma_f32_16x16x32_bf16 v[40:43], a[0:3], a[148:151], v[40:43]
  ds_read_b128 a[164:167], v2 offset:12544
  v_mfma_f32_16x16x32_bf16 v[44:47], v[92:95], a[144:147], 0
  s_add_u32 m0, s39, 8192
  v_mfma_f32_16x16x32_bf16 v[44:47], a[4:7], a[148:151], v[44:47]
  s_waitcnt vmcnt(8)
  v_cvt_pk_bf16_f32 v16, v16, v17
  v_mfma_f32_16x16x32_bf16 v[48:51], v[96:99], a[144:147], 0
  buffer_load_dwordx4 v15, s[4:7], s76 offen nt lds
  v_mfma_f32_16x16x32_bf16 v[48:51], a[8:11], a[148:151], v[48:51]
  v_cvt_pk_bf16_f32 v17, v18, v19
  v_mfma_f32_16x16x32_bf16 v[52:55], v[100:103], a[144:147], 0
  s_waitcnt vmcnt(8)
  v_cvt_pk_bf16_f32 v18, v20, v21
  v_mfma_f32_16x16x32_bf16 v[52:55], a[12:15], a[148:151], v[52:55]
  s_cmp_eq_u32 s77, 73728
  v_cvt_pk_bf16_f32 v19, v22, v23
  v_mfma_f32_16x16x32_bf16 v[56:59], v[104:107], a[144:147], 0
  ds_write_b128 v86, v[16:19] offset:0
  v_mfma_f32_16x16x32_bf16 v[56:59], a[16:19], a[148:151], v[56:59]
  s_cselect_b32 s57, 4294893568, s27
  s_add_u32 s90, s77, 12288
  v_mfma_f32_16x16x32_bf16 v[60:63], v[108:111], a[144:147], 0
  s_add_u32 s56, s76, s90
  v_cvt_pk_bf16_f32 v24, v24, v25
  v_mfma_f32_16x16x32_bf16 v[60:63], a[20:23], a[148:151], v[60:63]
  s_add_u32 s56, s56, s57
  s_waitcnt lgkmcnt(3)
  v_mfma_f32_16x16x32_bf16 v[40:43], v[112:115], a[152:155], v[40:43]
  ds_read_b128 a[144:147], v3 offset:12544
  s_min_u32 s56, s56, s40
  v_mfma_f32_16x16x32_bf16 v[40:43], a[24:27], a[156:159], v[40:43]
  ds_read_b128 a[148:151], v4 offset:12544
  v_and_b32 v15, s57, v12
  v_mfma_f32_16x16x32_bf16 v[44:47], v[116:119], a[152:155], v[44:47]
  v_add3_u32 v15, v8, v15, s90
  v_cvt_pk_bf16_f32 v25, v26, v27
  v_mfma_f32_16x16x32_bf16 v[44:47], a[28:31], a[156:159], v[44:47]
  s_add_u32 m0, s39, 12288
  v_cvt_pk_bf16_f32 v26, v28, v29
  v_mfma_f32_16x16x32_bf16 v[48:51], v[120:123], a[152:155], v[48:51]
  buffer_load_dwordx4 v15, s[4:7], s76 offen nt lds
  v_mfma_f32_16x16x32_bf16 v[48:51], a[32:35], a[156:159], v[48:51]
  v_cvt_pk_bf16_f32 v27, v30, v31
  v_mfma_f32_16x16x32_bf16 v[52:55], v[124:127], a[152:155], v[52:55]
  ds_write_b128 v87, v[24:27] offset:0
  v_mfma_f32_16x16x32_bf16 v[52:55], a[36:39], a[156:159], v[52:55]
  v_mfma_f32_16x16x32_bf16 v[56:59], v[128:131], a[152:155], v[56:59]
  v_mfma_f32_16x16x32_bf16 v[56:59], a[40:43], a[156:159], v[56:59]
  v_mfma_f32_16x16x32_bf16 v[60:63], v[132:135], a[152:155], v[60:63]
  v_mfma_f32_16x16x32_bf16 v[60:63], a[44:47], a[156:159], v[60:63]
  s_waitcnt lgkmcnt(4)
  v_mfma_f32_16x16x32_bf16 v[40:43], v[136:139], a[160:163], v[40:43]
  ds_read_b128 a[152:155], v1 offset:12800
  v_mfma_f32_16x16x32_bf16 v[40:43], a[48:51], a[164:167], v[40:43]
  ds_read_b128 a[156:159], v2 offset:12800
  v_mfma_f32_16x16x32_bf16 v[44:47], v[140:143], a[160:163], v[44:47]
  s_add_u32 m0, s39, 16384
  v_mfma_f32_16x16x32_bf16 v[44:47], a[52:55], a[164:167], v[44:47]
  s_waitcnt vmcnt(8)
  v_cvt_pk_bf16_f32 v32, v32, v33
  v_mfma_f32_16x16x32_bf16 v[48:51], v[144:147], a[160:163], v[48:51]
  buffer_load_dwordx4 v9, s[4:7], s56 offen nt lds
  v_mfma_f32_16x16x32_bf16 v[48:51], a[56:59], a[164:167], v[48:51]
  v_cvt_pk_bf16_f32 v33, v34, v35
  v_mfma_f32_16x16x32_bf16 v[52:55], v[148:151], a[160:163], v[52:55]
  v_cvt_pk_bf16_f32 v34, v36, v37
  v_mfma_f32_16x16x32_bf16 v[52:55], a[60:63], a[164:167], v[52:55]
  v_cvt_pk_bf16_f32 v35, v38, v39
  v_mfma_f32_16x16x32_bf16 v[56:59], v[152:155], a[160:163], v[56:59]
  ds_write_b128 v86, v[32:35] offset:128
  v_mfma_f32_16x16x32_bf16 v[56:59], a[64:67], a[164:167], v[56:59]
  v_mfma_f32_16x16x32_bf16 v[60:63], v[156:159], a[160:163], v[60:63]
  v_mfma_f32_16x16x32_bf16 v[60:63], a[68:71], a[164:167], v[60:63]
  s_waitcnt lgkmcnt(4)
  v_mfma_f32_16x16x32_bf16 v[40:43], v[160:163], a[144:147], v[40:43]
  ds_read_b128 a[160:163], v3 offset:12800
  v_mfma_f32_16x16x32_bf16 v[40:43], a[72:75], a[148:151], v[40:43]
  ds_read_b128 a[164:167], v4 offset:12800
  v_mfma_f32_16x16x32_bf16 v[44:47], v[164:167], a[144:147], v[44:47]
  v_mfma_f32_16x16x32_bf16 v[44:47], a[76:79], a[148:151], v[44:47]
  s_waitcnt vmcnt(8)
  s_add_u32 m0, s39, 20480
  v_mfma_f32_16x16x32_bf16 v[48:51], v[168:171], a[144:147], v[48:51]
  buffer_load_dwordx4 v10, s[4:7], s56 offen nt lds
  v_mfma_f32_16x16x32_bf16 v[48:51], a[80:83], a[148:151], v[48:51]
  v_mfma_f32_16x16x32_bf16 v[52:55], v[172:175], a[144:147], v[52:55]
  s_lshr_b32 s37, s37, 1
  v_mfma_f32_16x16x32_bf16 v[52:55], a[84:87], a[148:151], v[52:55]
  s_bitcmp1_b32 s37, 0
  v_mfma_f32_16x16x32_bf16 v[56:59], v[176:179], a[144:147], v[56:59]
  s_cselect_b64 vcc, -1, 0
  v_mfma_f32_16x16x32_bf16 v[56:59], a[88:91], a[148:151], v[56:59]
  v_mfma_f32_16x16x32_bf16 v[60:63], v[180:183], a[144:147], v[60:63]
  v_mfma_f32_16x16x32_bf16 v[60:63], a[92:95], a[148:151], v[60:63]
  s_waitcnt vmcnt(10) lgkmcnt(2)
L_ent:
  s_barrier
  s_waitcnt lgkmcnt(3)
  v_mfma_f32_16x16x32_bf16 v[40:43], v[184:187], a[152:155], v[40:43]
  ds_read_b128 a[144:147], v1 offset:24576
  v_mfma_f32_16x16x32_bf16 v[40:43], a[96:99], a[156:159], v[40:43]
  ds_read_b128 a[148:151], v2 offset:24576
  v_mfma_f32_16x16x32_bf16 v[44:47], v[188:191], a[152:155], v[44:47]
  ds_read_b128 a[180:183], v5 offset:12288
  v_mfma_f32_16x16x32_bf16 v[44:47], a[100:103], a[156:159], v[44:47]
  ds_read_b128 a[184:187], v6 offset:12288
  v_mfma_f32_16x16x32_bf16 v[48:51], v[192:195], a[152:155], v[48:51]
  ds_read_b128 a[188:191], v7 offset:12288
  v_mfma_f32_16x16x32_bf16 v[48:51], a[104:107], a[156:159], v[48:51]
  ds_read_b128 a[168:171], v5 offset:0
  v_mfma_f32_16x16x32_bf16 v[52:55], v[196:199], a[152:155], v[52:55]
  ds_read_b128 a[172:175], v6 offset:0
  v_mfma_f32_16x16x32_bf16 v[52:55], a[108:111], a[156:159], v[52:55]
  ds_read_b128 a[176:179], v7 offset:0
  v_mfma_f32_16x16x32_bf16 v[56:59], v[200:203], a[152:155], v[56:59]
  v_mfma_f32_16x16x32_bf16 v[56:59], a[112:115], a[156:159], v[56:59]
  v_mfma_f32_16x16x32_bf16 v[60:63], v[204:207], a[152:155], v[60:63]
  v_mfma_f32_16x16x32_bf16 v[60:63], a[116:119], a[156:159], v[60:63]
  s_waitcnt lgkmcnt(8)
  v_mfma_f32_16x16x32_bf16 v[40:43], v[208:211], a[160:163], v[40:43]
  ds_read_b128 a[152:155], v3 offset:24576
  v_mfma_f32_16x16x32_bf16 v[40:43], v[232:235], a[164:167], v[40:43]
  ds_read_b128 a[156:159], v4 offset:24576
  v_mfma_f32_16x16x32_bf16 v[44:47], v[212:215], a[160:163], v[44:47]
  s_waitcnt lgkmcnt(7)
  buffer_store_dwordx4 a[180:183], v14, s[8:11], s62 offen sc1
  v_mfma_f32_16x16x32_bf16 v[44:47], v[236:239], a[164:167], v[44:47]
  v_mfma_f32_16x16x32_bf16 v[48:51], v[216:219], a[160:163], v[48:51]
  v_mfma_f32_16x16x32_bf16 v[48:51], v[240:243], a[164:167], v[48:51]
  v_mfma_f32_16x16x32_bf16 v[52:55], v[220:223], a[160:163], v[52:55]
  v_mfma_f32_16x16x32_bf16 v[52:55], v[244:247], a[164:167], v[52:55]
  v_mfma_f32_16x16x32_bf16 v[56:59], v[224:227], a[160:163], v[56:59]
  s_waitcnt lgkmcnt(6)
  buffer_store_dwordx4 a[184:187], v81, s[8:11], s63 offen sc1
  v_mfma_f32_16x16x32_bf16 v[56:59], v[248:251], a[164:167], v[56:59]
  v_mfma_f32_16x16x32_bf16 v[60:63], v[228:231], a[160:163], v[60:63]
  v_mfma_f32_16x16x32_bf16 v[60:63], v[252:255], a[164:167], v[60:63]
  s_waitcnt lgkmcnt(8)
  v_mfma_f32_16x16x32_bf16 v[16:19], v[88:91], a[144:147], 0
  ds_read_b128 a[160:163], v1 offset:24832
  v_mfma_f32_16x16x32_bf16 v[16:19], a[0:3], a[148:151], v[16:19]
  ds_read_b128 a[164:167], v2 offset:24832
  v_mfma_f32_16x16x32_bf16 v[20:23], v[92:95], a[144:147], 0
  v_mfma_f32_16x16x32_bf16 v[20:23], a[4:7], a[148:151], v[20:23]
  v_cvt_pk_bf16_f32 v40, v40, v41
  v_mfma_f32_16x16x32_bf16 v[24:27], v[96:99], a[144:147], 0
  v_cvt_pk_bf16_f32 v41, v42, v43
  v_mfma_f32_16x16x32_bf16 v[24:27], a[8:11], a[148:151], v[24:27]
  v_cvt_pk_bf16_f32 v42, v44, v45
  v_mfma_f32_16x16x32_bf16 v[28:31], v[100:103], a[144:147], 0
  s_waitcnt lgkmcnt(7)
  buffer_store_dwordx4 a[188:191], v82, s[8:11], s63 offen sc1
  v_mfma_f32_16x16x32_bf16 v[28:31], a[12:15], a[148:151], v[28:31]
  v_cvt_pk_bf16_f32 v43, v46, v47
  v_mfma_f32_16x16x32_bf16 v[32:35], v[104:107], a[144:147], 0
  ds_write_b128 v86, v[40:43] offset:36864
  v_mfma_f32_16x16x32_bf16 v[32:35], a[16:19], a[148:151], v[32:35]
  v_mfma_f32_16x16x32_bf16 v[36:39], v[108:111], a[144:147], 0
  v_mfma_f32_16x16x32_bf16 v[36:39], a[20:23], a[148:151], v[36:39]
  s_waitcnt lgkmcnt(3)
  v_mfma_f32_16x16x32_bf16 v[16:19], v[112:115], a[152:155], v[16:19]
  ds_read_b128 a[144:147], v3 offset:24832
  v_mfma_f32_16x16x32_bf16 v[16:19], a[24:27], a[156:159], v[16:19]
  ds_read_b128 a[148:151], v4 offset:24832
  v_mfma_f32_16x16x32_bf16 v[20:23], v[116:119], a[152:155], v[20:23]
  v_mfma_f32_16x16x32_bf16 v[20:23], a[28:31], a[156:159], v[20:23]
  v_cvt_pk_bf16_f32 v48, v48, v49
  v_mfma_f32_16x16x32_bf16 v[24:27], v[120:123], a[152:155], v[24:27]
  buffer_store_dwordx4 a[168:171], v80, s[8:11], s58 offen sc1
  v_mfma_f32_16x16x32_bf16 v[24:27], a[32:35], a[156:159], v[24:27]
  v_cvt_pk_bf16_f32 v49, v50, v51
  v_mfma_f32_16x16x32_bf16 v[28:31], v[124:127], a[152:155], v[28:31]
  v_cvt_pk_bf16_f32 v50, v52, v53
  v_mfma_f32_16x16x32_bf16 v[28:31], a[36:39], a[156:159], v[28:31]
  v_cvt_pk_bf16_f32 v51, v54, v55
  v_mfma_f32_16x16x32_bf16 v[32:35], v[128:131], a[152:155], v[32:35]
  ds_write_b128 v87, v[48:51] offset:36864
  v_mfma_f32_16x16x32_bf16 v[32:35], a[40:43], a[156:159], v[32:35]
  v_mfma_f32_16x16x32_bf16 v[36:39], v[132:135], a[152:155], v[36:39]
  v_mfma_f32_16x16x32_bf16 v[36:39], a[44:47], a[156:159], v[36:39]
  s_waitcnt lgkmcnt(4)
  v_mfma_f32_16x16x32_bf16 v[16:19], v[136:139], a[160:163], v[16:19]
  ds_read_b128 a[152:155], v1 offset:25088
  v_mfma_f32_16x16x32_bf16 v[16:19], a[48:51], a[164:167], v[16:19]
  ds_read_b128 a[156:159], v2 offset:25088
  v_mfma_f32_16x16x32_bf16 v[20:23], v[140:143], a[160:163], v[20:23]
  v_mfma_f32_16x16x32_bf16 v[20:23], a[52:55], a[164:167], v[20:23]
  v_mfma_f32_16x16x32_bf16 v[24:27], v[144:147], a[160:163], v[24:27]
  buffer_store_dwordx4 a[172:175], v81, s[8:11], s58 offen sc1
  v_mfma_f32_16x16x32_bf16 v[24:27], a[56:59], a[164:167], v[24:27]
  v_mfma_f32_16x16x32_bf16 v[28:31], v[148:151], a[160:163], v[28:31]
  v_mfma_f32_16x16x32_bf16 v[28:31], a[60:63], a[164:167], v[28:31]
  v_mfma_f32_16x16x32_bf16 v[32:35], v[152:155], a[160:163], v[32:35]
  s_cbranch_vccnz L_dr1
L_drb1:
  v_mfma_f32_16x16x32_bf16 v[32:35], a[64:67], a[164:167], v[32:35]
  s_waitcnt vmcnt(8)
  s_mov_b64 s[82:83], s[80:81]
  v_mfma_f32_16x16x32_bf16 v[36:39], v[156:159], a[160:163], v[36:39]
  s_mov_b64 s[80:81], s[78:79]
  s_mov_b64 s[78:79], s[76:77]
  v_mfma_f32_16x16x32_bf16 v[36:39], a[68:71], a[164:167], v[36:39]
  s_cmp_ge_u32 s32, s35
  s_waitcnt lgkmcnt(3)
  v_mfma_f32_16x16x32_bf16 v[16:19], v[160:163], a[144:147], v[16:19]
  ds_read_b128 a[160:163], v3 offset:25088
  s_cselect_b64 s[34:35], s[28:29], s[34:35]
  v_mfma_f32_16x16x32_bf16 v[16:19], a[72:75], a[148:151], v[16:19]
  ds_read_b128 a[164:167], v4 offset:25088
  s_cselect_b64 s[28:29], s[30:31], s[28:29]
  v_mfma_f32_16x16x32_bf16 v[20:23], v[164:167], a[144:147], v[20:23]
  s_add_u32 s76, s33, s32
  v_cvt_pk_bf16_f32 v56, v56, v57
  v_mfma_f32_16x16x32_bf16 v[20:23], a[76:79], a[148:151], v[20:23]
  s_xor_b32 s76, s76, s34
  v_cvt_pk_bf16_f32 v57, v58, v59
  v_mfma_f32_16x16x32_bf16 v[24:27], v[168:171], a[144:147], v[24:27]
  buffer_store_dwordx4 a[176:179], v13, s[8:11], s59 offen sc1
  v_mfma_f32_16x16x32_bf16 v[24:27], a[80:83], a[148:151], v[24:27]
  s_bfe_u32 s77, s76, 65557
  v_cvt_pk_bf16_f32 v58, v60, v61
  v_mfma_f32_16x16x32_bf16 v[28:31], v[172:175], a[144:147], v[28:31]
  s_bfe_u32 s76, s76, 65555
  v_cvt_pk_bf16_f32 v59, v62, v63
  v_mfma_f32_16x16x32_bf16 v[28:31], a[84:87], a[148:151], v[28:31]
  ds_write_b128 v86, v[56:59] offset:36992
  v_mfma_f32_16x16x32_bf16 v[32:35], v[176:179], a[144:147], v[32:35]
  s_lshl1_add_u32 s77, s76, s77
  s_sub_u32 s77, 1, s77
  v_mfma_f32_16x16x32_bf16 v[32:35], a[88:91], a[148:151], v[32:35]
  s_and_b32 s77, s77, 3
  s_mul_i32 s77, s77, 24576
  v_mfma_f32_16x16x32_bf16 v[36:39], v[180:183], a[144:147], v[36:39]
  s_cmp_lt_u32 s32, s21
  s_cselect_b32 s76, s32, s40
  v_mfma_f32_16x16x32_bf16 v[36:39], a[92:95], a[148:151], v[36:39]
  s_add_u32 s32, s32, 786432
  s_waitcnt lgkmcnt(3)
  v_mfma_f32_16x16x32_bf16 v[16:19], v[184:187], a[152:155], v[16:19]
  ds_read_b128 a[144:147], v1 offset:36864
  s_cmp_eq_u32 s77, 0
  v_mfma_f32_16x16x32_bf16 v[16:19], a[96:99], a[156:159], v[16:19]
  ds_read_b128 a[148:151], v2 offset:36864
  s_cselect_b32 s57, 73728, s26
  v_mfma_f32_16x16x32_bf16 v[20:23], v[188:191], a[152:155], v[20:23]
  s_add_u32 s22, s76, s77
  s_add_u32 s22, s22, s57
  v_mfma_f32_16x16x32_bf16 v[20:23], a[100:103], a[156:159], v[20:23]
  s_min_u32 s22, s22, s40
  s_add_u32 m0, s39, 24576
  v_mfma_f32_16x16x32_bf16 v[24:27], v[192:195], a[152:155], v[24:27]
  buffer_load_dwordx4 v8, s[4:7], s22 offen nt lds
  v_mfma_f32_16x16x32_bf16 v[24:27], a[104:107], a[156:159], v[24:27]
  s_cmp_eq_u32 s81, 0
  s_cselect_b32 s91, 73728, s26
  v_mfma_f32_16x16x32_bf16 v[28:31], v[196:199], a[152:155], v[28:31]
  s_add_u32 s58, s80, s81
  s_add_u32 s58, s58, s91
  v_mfma_f32_16x16x32_bf16 v[28:31], a[108:111], a[156:159], v[28:31]
  s_min_u32 s58, s58, s40
  s_mov_b32 s59, s80
  v_mfma_f32_16x16x32_bf16 v[32:35], v[200:203], a[152:155], v[32:35]
  v_and_b32 v13, s91, v11
  v_add3_u32 v13, v82, v13, s81
  v_mfma_f32_16x16x32_bf16 v[32:35], a[112:115], a[156:159], v[32:35]
  s_cmp_eq_u32 s83, 73728
  s_cselect_b32 s91, 4294893568, s27
  v_mfma_f32_16x16x32_bf16 v[36:39], v[204:207], a[152:155], v[36:39]
  s_add_u32 s62, s83, 12288
  s_add_u32 s63, s82, s62
  v_mfma_f32_16x16x32_bf16 v[36:39], a[116:119], a[156:159], v[36:39]
  s_add_u32 s63, s63, s91
  s_waitcnt lgkmcnt(3)
  v_mfma_f32_16x16x32_bf16 v[16:19], v[208:211], a[160:163], v[16:19]
  ds_read_b128 a[152:155], v3 offset:36864
  s_min_u32 s63, s63, s40
  v_mfma_f32_16x16x32_bf16 v[16:19], v[232:235], a[164:167], v[16:19]
  ds_read_b128 a[156:159], v4 offset:36864
  v_and_b32 v14, s91, v12
  v_mfma_f32_16x16x32_bf16 v[20:23], v[212:215], a[160:163], v[20:23]
  v_add3_u32 v14, v80, v14, s62
  s_mov_b32 s62, s82
  v_mfma_f32_16x16x32_bf16 v[20:23], v[236:239], a[164:167], v[20:23]
  s_waitcnt vmcnt(8)
  s_add_u32 m0, s39, 28672
  v_mfma_f32_16x16x32_bf16 v[24:27], v[216:219], a[160:163], v[24:27]
  buffer_load_dwordx4 v9, s[4:7], s22 offen nt lds
  v_mfma_f32_16x16x32_bf16 v[24:27], v[240:243], a[164:167], v[24:27]
  v_mfma_f32_16x16x32_bf16 v[28:31], v[220:223], a[160:163], v[28:31]
  v_mfma_f32_16x16x32_bf16 v[28:31], v[244:247], a[164:167], v[28:31]
  v_mfma_f32_16x16x32_bf16 v[32:35], v[224:227], a[160:163], v[32:35]
  v_mfma_f32_16x16x32_bf16 v[32:35], v[248:251], a[164:167], v[32:35]
  v_and_b32 v15, s57, v11
  v_mfma_f32_16x16x32_bf16 v[36:39], v[228:231], a[160:163], v[36:39]
  v_add3_u32 v15, v10, v15, s77
  v_mfma_f32_16x16x32_bf16 v[36:39], v[252:255], a[164:167], v[36:39]
  s_waitcnt lgkmcnt(2)
  v_mfma_f32_16x16x32_bf16 v[40:43], v[88:91], a[144:147], 0
  ds_read_b128 a[160:163], v1 offset:37120
  v_mfma_f32_16x16x32_bf16 v[40:43], a[0:3], a[148:151], v[40:43]
  ds_read_b128 a[164:167], v2 offset:37120
  v_mfma_f32_16x16x32_bf16 v[44:47], v[92:95], a[144:147], 0
  s_add_u32 m0, s39, 32768
  v_mfma_f32_16x16x32_bf16 v[44:47], a[4:7], a[148:151], v[44:47]
  s_waitcnt vmcnt(8)
  v_cvt_pk_bf16_f32 v16, v16, v17
  v_mfma_f32_16x16x32_bf16 v[48:51], v[96:99], a[144:147], 0
  buffer_load_dwordx4 v15, s[4:7], s76 offen nt lds
  v_mfma_f32_16x16x32_bf16 v[48:51], a[8:11], a[148:151], v[48:51]
  v_cvt_pk_bf16_f32 v17, v18, v19
  v_mfma_f32_16x16x32_bf16 v[52:55], v[100:103], a[144:147], 0
  s_waitcnt vmcnt(8)
  v_cvt_pk_bf16_f32 v18, v20, v21
  v_mfma_f32_16x16x32_bf16 v[52:55], a[12:15], a[148:151], v[52:55]
  s_cmp_eq_u32 s77, 73728
  v_cvt_pk_bf16_f32 v19, v22, v23
  v_mfma_f32_16x16x32_bf16 v[56:59], v[104:107], a[144:147], 0
  ds_write_b128 v86, v[16:19] offset:24576
  v_mfma_f32_16x16x32_bf16 v[56:59], a[16:19], a[148:151], v[56:59]
  s_cselect_b32 s57, 4294893568, s27
  s_add_u32 s90, s77, 12288
  v_mfma_f32_16x16x32_bf16 v[60:63], v[108:111], a[144:147], 0
  s_add_u32 s56, s76, s90
  v_cvt_pk_bf16_f32 v24, v24, v25
  v_mfma_f32_16x16x32_bf16 v[60:63], a[20:23], a[148:151], v[60:63]
  s_add_u32 s56, s56, s57
  s_waitcnt lgkmcnt(3)
  v_mfma_f32_16x16x32_bf16 v[40:43], v[112:115], a[152:155], v[40:43]
  ds_read_b128 a[144:147], v3 offset:37120
  s_min_u32 s56, s56, s40
  v_mfma_f32_16x16x32_bf16 v[40:43], a[24:27], a[156:159], v[40:43]
  ds_read_b128 a[148:151], v4 offset:37120
  v_and_b32 v15, s57, v12
  v_mfma_f32_16x16x32_bf16 v[44:47], v[116:119], a[152:155], v[44:47]
  v_add3_u32 v15, v8, v15, s90
  v_cvt_pk_bf16_f32 v25, v26, v27
  v_mfma_f32_16x16x32_bf16 v[44:47], a[28:31], a[156:159], v[44:47]
  s_add_u32 m0, s39, 36864
  v_cvt_pk_bf16_f32 v26, v28, v29
  v_mfma_f32_16x16x32_bf16 v[48:51], v[120:123], a[152:155], v[48:51]
  buffer_load_dwordx4 v15, s[4:7], s76 offen nt lds
  v_mfma_f32_16x16x32_bf16 v[48:51], a[32:35], a[156:159], v[48:51]
  v_cvt_pk_bf16_f32 v27, v30, v31
  v_mfma_f32_16x16x32_bf16 v[52:55], v[124:127], a[152:155], v[52:55]
  ds_write_b128 v87, v[24:27] offset:24576
  v_mfma_f32_16x16x32_bf16 v[52:55], a[36:39], a[156:159], v[52:55]
  v_mfma_f32_16x16x32_bf16 v[56:59], v[128:131], a[152:155], v[56:59]
  v_mfma_f32_16x16x32_bf16 v[56:59], a[40:43], a[156:159], v[56:59]
  v_mfma_f32_16x16x32_bf16 v[60:63], v[132:135], a[152:155], v[60:63]
  v_mfma_f32_16x16x32_bf16 v[60:63], a[44:47], a[156:159], v[60:63]
  s_waitcnt lgkmcnt(4)
  v_mfma_f32_16x16x32_bf16 v[40:43], v[136:139], a[160:163], v[40:43]
  ds_read_b128 a[152:155], v1 offset:37376
  v_mfma_f32_16x16x32_bf16 v[40:43], a[48:51], a[164:167], v[40:43]
  ds_read_b128 a[156:159], v2 offset:37376
  v_mfma_f32_16x16x32_bf16 v[44:47], v[140:143], a[160:163], v[44:47]
  s_add_u32 m0, s39, 40960
  v_mfma_f32_16x16x32_bf16 v[44:47], a[52:55], a[164:167], v[44:47]
  s_waitcnt vmcnt(8)
  v_cvt_pk_bf16_f32 v32, v32, v33
  v_mfma_f32_16x16x32_bf16 v[48:51], v[144:147], a[160:163], v[48:51]
  buffer_load_dwordx4 v9, s[4:7], s56 offen nt lds
  v_mfma_f32_16x16x32_bf16 v[48:51], a[56:59], a[164:167], v[48:51]
  v_cvt_pk_bf16_f32 v33, v34, v35
  v_mfma_f32_16x16x32_bf16 v[52:55], v[148:151], a[160:163], v[52:55]
  v_cvt_pk_bf16_f32 v34, v36, v37
  v_mfma_f32_16x16x32_bf16 v[52:55], a[60:63], a[164:167], v[52:55]
  v_cvt_pk_bf16_f32 v35, v38, v39
  v_mfma_f32_16x16x32_bf16 v[56:59], v[152:155], a[160:163], v[56:59]
  ds_write_b128 v86, v[32:35] offset:24704
  v_mfma_f32_16x16x32_bf16 v[56:59], a[64:67], a[164:167], v[56:59]
  v_mfma_f32_16x16x32_bf16 v[60:63], v[156:159], a[160:163], v[60:63]
  v_mfma_f32_16x16x32_bf16 v[60:63], a[68:71], a[164:167], v[60:63]
  s_waitcnt lgkmcnt(4)
  v_mfma_f32_16x16x32_bf16 v[40:43], v[160:163], a[144:147], v[40:43]
  ds_read_b128 a[160:163], v3 offset:37376
  v_mfma_f32_16x16x32_bf16 v[40:43], a[72:75], a[148:151], v[40:43]
  ds_read_b128 a[164:167], v4 offset:37376
  v_mfma_f32_16x16x32_bf16 v[44:47], v[164:167], a[144:147], v[44:47]
  s_add_u32 m0, s39, 45056
  v_mfma_f32_16x16x32_bf16 v[44:47], a[76:79], a[148:151], v[44:47]
  s_waitcnt vmcnt(8)
  s_xor_b32 s39, s39, 49152
  v_mfma_f32_16x16x32_bf16 v[48:51], v[168:171], a[144:147], v[48:51]
  buffer_load_dwordx4 v10, s[4:7], s56 offen nt lds
  v_mfma_f32_16x16x32_bf16 v[48:51], a[80:83], a[148:151], v[48:51]
  v_mfma_f32_16x16x32_bf16 v[52:55], v[172:175], a[144:147], v[52:55]
  s_lshr_b32 s37, s37, 1
  v_mfma_f32_16x16x32_bf16 v[52:55], a[84:87], a[148:151], v[52:55]
  s_bitcmp1_b32 s37, 0
  v_mfma_f32_16x16x32_bf16 v[56:59], v[176:179], a[144:147], v[56:59]
  s_cselect_b64 vcc, -1, 0
  v_mfma_f32_16x16x32_bf16 v[56:59], a[88:91], a[148:151], v[56:59]
  v_mfma_f32_16x16x32_bf16 v[60:63], v[180:183], a[144:147], v[60:63]
  v_mfma_f32_16x16x32_bf16 v[60:63], a[92:95], a[148:151], v[60:63]
  s_waitcnt vmcnt(12) lgkmcnt(2)
  s_barrier
  v_xor_b32 v1, 49152, v1
  v_xor_b32 v2, 49152, v2
  v_xor_b32 v3, 49152, v3
  v_xor_b32 v4, 49152, v4
  s_waitcnt lgkmcnt(3)
  v_mfma_f32_16x16x32_bf16 v[40:43], v[184:187], a[152:155], v[40:43]
  ds_read_b128 a[144:147], v1 offset:0
  v_mfma_f32_16x16x32_bf16 v[40:43], a[96:99], a[156:159], v[40:43]
  ds_read_b128 a[148:151], v2 offset:0
  v_mfma_f32_16x16x32_bf16 v[44:47], v[188:191], a[152:155], v[44:47]
  ds_read_b128 a[180:183], v5 offset:36864
  v_mfma_f32_16x16x32_bf16 v[44:47], a[100:103], a[156:159], v[44:47]
  ds_read_b128 a[184:187], v6 offset:36864
  v_mfma_f32_16x16x32_bf16 v[48:51], v[192:195], a[152:155], v[48:51]
  ds_read_b128 a[188:191], v7 offset:36864
  v_mfma_f32_16x16x32_bf16 v[48:51], a[104:107], a[156:159], v[48:51]
  ds_read_b128 a[168:171], v5 offset:24576
  v_mfma_f32_16x16x32_bf16 v[52:55], v[196:199], a[152:155], v[52:55]
  ds_read_b128 a[172:175], v6 offset:24576
  v_mfma_f32_16x16x32_bf16 v[52:55], a[108:111], a[156:159], v[52:55]
  ds_read_b128 a[176:179], v7 offset:24576
  v_mfma_f32_16x16x32_bf16 v[56:59], v[200:203], a[152:155], v[56:59]
  v_mfma_f32_16x16x32_bf16 v[56:59], a[112:115], a[156:159], v[56:59]
  v_mfma_f32_16x16x32_bf16 v[60:63], v[204:207], a[152:155], v[60:63]
  v_mfma_f32_16x16x32_bf16 v[60:63], a[116:119], a[156:159], v[60:63]
  s_waitcnt lgkmcnt(8)
  v_mfma_f32_16x16x32_bf16 v[40:43], v[208:211], a[160:163], v[40:43]
  ds_read_b128 a[152:155], v3 offset:0
  v_mfma_f32_16x16x32_bf16 v[40:43], v[232:235], a[164:167], v[40:43]
  ds_read_b128 a[156:159], v4 offset:0
  v_mfma_f32_16x16x32_bf16 v[44:47], v[212:215], a[160:163], v[44:47]
  s_waitcnt lgkmcnt(7)
  buffer_store_dwordx4 a[180:183], v14, s[8:11], s62 offen sc1
  v_mfma_f32_16x16x32_bf16 v[44:47], v[236:239], a[164:167], v[44:47]
  v_mfma_f32_16x16x32_bf16 v[48:51], v[216:219], a[160:163], v[48:51]
  v_mfma_f32_16x16x32_bf16 v[48:51], v[240:243], a[164:167], v[48:51]
  v_mfma_f32_16x16x32_bf16 v[52:55], v[220:223], a[160:163], v[52:55]
  v_mfma_f32_16x16x32_bf16 v[52:55], v[244:247], a[164:167], v[52:55]
  v_mfma_f32_16x16x32_bf16 v[56:59], v[224:227], a[160:163], v[56:59]
  s_waitcnt lgkmcnt(6)
  buffer_store_dwordx4 a[184:187], v81, s[8:11], s63 offen sc1
  v_mfma_f32_16x16x32_bf16 v[56:59], v[248:251], a[164:167], v[56:59]
  v_mfma_f32_16x16x32_bf16 v[60:63], v[228:231], a[160:163], v[60:63]
  v_mfma_f32_16x16x32_bf16 v[60:63], v[252:255], a[164:167], v[60:63]
  s_cmp_lt_u32 s78, s40
  s_cbranch_scc1 L_loop
L_tail:
  s_nop 3
  v_cvt_pk_bf16_f32 v40, v40, v41
  v_cvt_pk_bf16_f32 v41, v42, v43
  v_cvt_pk_bf16_f32 v42, v44, v45
  v_cvt_pk_bf16_f32 v43, v46, v47
  ds_write_b128 v86, v[40:43] offset:12288
  v_cvt_pk_bf16_f32 v48, v48, v49
  v_cvt_pk_bf16_f32 v49, v50, v51
  v_cvt_pk_bf16_f32 v50, v52, v53
  v_cvt_pk_bf16_f32 v51, v54, v55
  ds_write_b128 v87, v[48:51] offset:12288
  v_cvt_pk_bf16_f32 v56, v56, v57
  v_cvt_pk_bf16_f32 v57, v58, v59
  v_cvt_pk_bf16_f32 v58, v60, v61
  v_cvt_pk_bf16_f32 v59, v62, v63
  ds_write_b128 v86, v[56:59] offset:12416
  s_waitcnt lgkmcnt(8)
  buffer_store_dwordx4 a[188:191], v82, s[8:11], s63 offen sc1
  s_waitcnt lgkmcnt(7)
  buffer_store_dwordx4 a[168:171], v80, s[8:11], s58 offen sc1
  s_waitcnt lgkmcnt(6)
  buffer_store_dwordx4 a[172:175], v81, s[8:11], s58 offen sc1
  s_waitcnt lgkmcnt(5)
  buffer_store_dwordx4 a[176:179], v13, s[8:11], s59 offen sc1
  s_cmp_eq_u32 s79, 0
  s_cselect_b32 s91, 73728, s26
  s_add_u32 s58, s78, s79
  s_add_u32 s58, s58, s91
  s_min_u32 s58, s58, s40
  s_mov_b32 s59, s78
  v_and_b32 v13, s91, v11
  v_add3_u32 v13, v82, v13, s79
  s_cmp_eq_u32 s81, 73728
  s_cselect_b32 s91, 4294893568, s27
  s_add_u32 s62, s81, 12288
  s_add_u32 s63, s80, s62
  s_add_u32 s63, s63, s91
  s_min_u32 s63, s63, s40
  v_and_b32 v14, s91, v12
  v_add3_u32 v14, v80, v14, s62
  s_mov_b32 s62, s80
  s_waitcnt lgkmcnt(0)
  s_barrier
  ds_read_b128 a[144:147], v5 offset:12288
  ds_read_b128 a[148:151], v6 offset:12288
  ds_read_b128 a[152:155], v7 offset:12288
  s_waitcnt lgkmcnt(2)
  buffer_store_dwordx4 a[144:147], v14, s[8:11], s62 offen sc1
  s_waitcnt lgkmcnt(1)
  buffer_store_dwordx4 a[148:151], v81, s[8:11], s63 offen sc1
  s_waitcnt lgkmcnt(0)
  buffer_store_dwordx4 a[152:155], v82, s[8:11], s63 offen sc1
  s_endpgm
L_slow:
  v_mbcnt_lo_u32_b32 v253, -1, 0
  v_and_b32 v253, 3, v253
  v_lshl_add_u32 v15, v253, 2, s88
  s_mov_b64 exec, 0xf0
  v_lshl_add_u32 v15, v253, 2, s89
  s_mov_b64 exec, 0xf00
  v_lshl_add_u32 v15, v253, 2, s95
  s_mov_b64 exec, -1
  v_mov_b32 v254, 1
  v_mov_b32 v255, 0
  s_mov_b64 exec, 0xfff
  buffer_atomic_cmpswap v[254:255], v15, s[16:19], 0 offen sc0 sc1
  s_waitcnt vmcnt(0)
  v_max_u32 v254, 1, v254
  s_nop 0
  v_readlane_b32 s44, v254, 0
  v_readlane_b32 s45, v254, 1
  v_readlane_b32 s46, v254, 2
  v_readlane_b32 s47, v254, 3
  v_readlane_b32 s84, v254, 4
  v_readlane_b32 s85, v254, 5
  v_readlane_b32 s86, v254, 6
  v_readlane_b32 s87, v254, 7
  v_readlane_b32 s12, v254, 8
  v_readlane_b32 s13, v254, 9
  v_readlane_b32 s14, v254, 10
  v_readlane_b32 s15, v254, 11
  s_nop 3
  s_mov_b64 exec, -1
  s_branch L_back
L_dr0:
  s_waitcnt vmcnt(1)
  s_branch L_drb0
L_dr1:
  s_waitcnt vmcnt(1)
  s_branch L_drb1
L_done:
  s_endpgm
.section .rodata,"a"
.p2align 6
.amdhsa_kernel standalone__depthwise_separable__vision_kernel
  .amdhsa_next_free_vgpr 512
  .amdhsa_next_free_sgpr 100
  .amdhsa_accum_offset 256
  .amdhsa_group_segment_fixed_size 0
  .amdhsa_kernarg_size 48
  .amdhsa_user_sgpr_count 2
  .amdhsa_user_sgpr_kernarg_segment_ptr 1
  .amdhsa_system_sgpr_workgroup_id_x 1
  .amdhsa_float_denorm_mode_32 3
.end_amdhsa_kernel
```
